```python
import torch

def _softmax(x, axis=-1):
    return torch.softmax(x, dim=axis)
def _gelu(x):
    return torch.nn.functional.gelu(x, approximate="tanh")
def _silu(x):
    return torch.nn.functional.silu(x)
def _sigmoid(x):
    return torch.sigmoid(x)
def _layernorm(x, axis=-1, eps=1e-5):
    m = x.mean(dim=axis, keepdim=True)
    v = x.var(dim=axis, keepdim=True, unbiased=False)
    return (x - m) / torch.sqrt(v + eps)
def _scatter_add(tgt, idx, src, axis=0):
    return tgt.clone().index_add_(axis, idx, src)
def _segment_sum(src, seg, n):
    out = torch.zeros((n,) + src.shape[1:], dtype=src.dtype)
    return out.index_add_(0, seg, src)
def _pad(x, pw):
    flat = tuple(v for pair in reversed(pw) for v in pair)
    return torch.nn.functional.pad(x, flat)

kernel_name = 'recurrent_scan__mha_block_cached__mixer_s_mlp__prompt'

def setup_inputs():

    _w = (lambda a: (lambda t: t.to(torch.bfloat16) if t.is_floating_point() else t)(torch.as_tensor(a)))
    def _A_setup():
        B, Sq, D = 1, 2048, 640
        H, Sk, Dh = 32, 2048, 192
        return {
            "x": _w((lambda *s: torch.randn(*s, dtype=torch.bfloat16) * 0.05)(B, Sq, D)),
            "k_cache": _w((lambda *s: torch.randn(*s, dtype=torch.bfloat16) * 0.8)(B, H, Sk, Dh)),
            "v_cache": _w((lambda *s: torch.randn(*s, dtype=torch.bfloat16) * 0.8)(B, H, Sk, Dh)),
            "wq": _w((lambda *s: torch.randn(*s, dtype=torch.bfloat16) * 0.8)(D, H * Dh) * (D ** -0.5)),
            "wo": _w((lambda *s: torch.randn(*s, dtype=torch.bfloat16) * 0.8)(H * Dh, D) * ((H * Dh) ** -0.5)),
        }
    _A_in = _A_setup()

    def _B_setup():
        B, S, D, F = 1, 2048, 640, 1536
        return {
            "x":  _w((lambda *s: torch.randn(*s, dtype=torch.bfloat16) * 0.05)(B, S, D)),
            "w1": _w((lambda *s: torch.randn(*s, dtype=torch.bfloat16) * 3.2)(D, D) * (D ** -0.5)),
            "w2": _w((lambda *s: torch.randn(*s, dtype=torch.bfloat16) * 3.2)(D, D) * (D ** -0.5)),
            "w3": _w((lambda *s: torch.randn(*s, dtype=torch.bfloat16) * 3.2)(D, F) * (D ** -0.5)),
            "w4": _w((lambda *s: torch.randn(*s, dtype=torch.bfloat16) * 3.2)(F, D) * (F ** -0.5)),
        }
    _B_in = _B_setup()

    return {
        "A_x": _A_in["x"],
        "A_k_cache": _A_in["k_cache"],
        "A_v_cache": _A_in["v_cache"],
        "A_wq": _A_in["wq"],
        "A_wo": _A_in["wo"],
        "B_x": _B_in["x"],
        "B_w1": _B_in["w1"],
        "B_w2": _B_in["w2"],
        "B_w3": _B_in["w3"],
        "B_w4": _B_in["w4"],
    }

def reference(A_x, A_k_cache, A_v_cache, A_wq, A_wo, B_x, B_w1, B_w2, B_w3, B_w4):
    def _A_ref(x, k_cache, v_cache, wq, wo):
        B, Sq, D = x.shape
        H, Dh = 32, 192
        q = (lambda x, *d: x.permute(*d))((x @ wq).reshape(B, Sq, H, Dh), 0, 2, 1, 3)
        scores = torch.einsum("bhqd,bhkd->bhqk", q, k_cache) * (Dh ** -0.5)
        p = _softmax(scores, axis=-1)
        o = torch.einsum("bhqk,bhkd->bhqd", p, v_cache)
        return (lambda x, *d: x.permute(*d))(o, 0, 2, 1, 3).reshape(B, Sq, H * Dh) @ wo

    def _B_ref(x, w1, w2, w3, w4):
        B, S, D = x.shape
        h = _gelu(_layernorm(x, axis=-1) @ w1)
        c = D // 4
        g0 = _pad(h[:, :, 0*c:1*c], ((0, 0), (1, 0), (0, 0)))[:, :S, :]
        g1 = _pad(h[:, :, 1*c:2*c], ((0, 0), (0, 1), (0, 0)))[:, 1:, :]
        g2 = _pad(h[:, :, 2*c:3*c], ((0, 0), (2, 0), (0, 0)))[:, :S, :]
        g3 = _pad(h[:, :, 3*c:   ], ((0, 0), (0, 2), (0, 0)))[:, 2:, :]
        hs = torch.concatenate([g0, g1, g2, g3], axis=-1) @ w2
        x1 = x + hs
        h2 = _gelu(_layernorm(x1, axis=-1) @ w3) @ w4
        return x1 + h2

    x = A_x
    xn = _layernorm(x, axis=-1)
    s = _A_ref(xn, A_k_cache, A_v_cache, A_wq, A_wo)
    g = _silu(_B_ref(xn, B_w1, B_w2, B_w3, B_w4))
    return x + s * g
```

```asm
; @launch grid=(256,1,1) block=(256,1,1) lds=163840
.amdgcn_target "amdgcn-amd-amdhsa--gfx950"
.text
.globl recurrent_scan__mha_block_cached__mixer_s_mlp__prompt_kernel
.p2align 8
.type recurrent_scan__mha_block_cached__mixer_s_mlp__prompt_kernel,@function
recurrent_scan__mha_block_cached__mixer_s_mlp__prompt_kernel:
    s_cmp_lt_u32 s2, 256
    s_cbranch_scc1 L_go
    s_endpgm
L_go:
    s_load_dwordx16 s[4:19], s[0:1], 0
    s_load_dwordx8 s[20:27], s[0:1], 64
    s_load_dwordx2 s[28:29], s[0:1], 96
    s_getpc_b64 s[100:101]
L_pc1:
    s_add_u32 s100, s100, L_pf0-L_pc1
    s_addc_u32 s101, s101, 0
    s_lshr_b32 s3, s2, 3
    s_lshl_b32 s3, s3, 11
    v_and_b32 v249, 248, v0
    v_lshl_add_u32 v249, v249, 3, s3
    v_min_u32 v249, L_pf1-L_pf0, v249
    global_load_dword v249, v249, s[100:101]
L_pf0:
    v_and_b32 v2, 63, v0
    v_lshrrev_b32 v3, 6, v0
    v_lshlrev_b32 v1, 4, v2
    v_readfirstlane_b32 s30, v3
    s_and_b32 s31, s2, 7
    s_bfe_u32 s32, s2, 0x20003
    s_lshr_b32 s33, s2, 5
    v_lshrrev_b32 v12, 3, v2
    v_mul_u32_u24 v12, 1280, v12
    v_lshrrev_b32 v13, 4, v2
    v_and_b32 v14, 7, v2
    v_xor_b32 v13, v13, v14
    v_lshl_add_u32 v240, v13, 4, v12
    v_xor_b32_e64 v241, 64, v240
    v_add_u32 v241, 10240, v241
    s_lshl_b32 s34, s30, 10
    s_mul_i32 s66, s30, 20480
    s_lshl_b32 s77, s31, 2
    s_add_u32 s77, s77, s32
    s_lshl_b32 s77, s77, 2
    s_add_u32 s77, s77, s30
    s_mul_i32 s77, s77, 20480
    s_lshl_b32 s83, s33, 1
    s_cmp_ge_u32 s33, 5
    s_cselect_b32 s3, 9, 0
    s_sub_u32 s83, s83, s3
    s_lshl_b32 s3, s83, 7
    s_add_u32 s80, s77, s3
    s_add_u32 s81, s77, 1280
    s_mul_i32 s3, s2, 3277
    s_lshr_b32 s3, s3, 16
    s_mul_i32 s70, s3, 160
    s_mul_i32 s3, s3, 20
    s_sub_u32 s3, s2, s3
    s_mul_i32 s3, s3, 40960
    s_add_u32 s70, s70, s3
    s_mul_i32 s72, s2, 5120
    s_add_u32 s72, s72, 81788928
    s_cmp_ge_u32 s33, 5
    s_cselect_b32 s72, 234881024, s72
    s_cselect_b32 s70, 0x200000, s70
    v_add_u32_e64 v14, 0, v0
    v_mul_u32_u24 v15, 6554, v14
    v_lshrrev_b32_e64 v15, 16, v15
    v_mul_u32_u24_e64 v236, 10, v15
    v_sub_u32_e64 v14, v14, v236
    v_mul_u32_u24 v15, 1280, v15
    v_lshl_add_u32 v236, v14, 4, v15
    v_add_u32 v14, 256, v0
    v_mul_u32_u24 v15, 6554, v14
    v_lshrrev_b32_e64 v15, 16, v15
    v_mul_u32_u24_e64 v237, 10, v15
    v_sub_u32_e64 v14, v14, v237
    v_mul_u32_u24 v15, 1280, v15
    v_lshl_add_u32 v237, v14, 4, v15
    v_lshlrev_b32 v238, 4, v0
    v_cmp_gt_u32 vcc, 64, v0
    v_mov_b32 v14, 0x80000000
    v_add_u32 v15, 4096, v238
    v_cndmask_b32 v237, v14, v237, vcc
    v_cndmask_b32 v239, v14, v15, vcc
    s_waitcnt lgkmcnt(0)
    s_mov_b32 s36, s4
    s_and_b32 s37, s5, 0xffff
    s_mov_b32 s38, 2621440
    s_mov_b32 s39, 0x00020000
    s_add_u32 m0, s66, 0
    s_nop 0
    buffer_load_dwordx4 v240, s[36:39], s80 offen lds
    s_add_u32 m0, s66, 1024
    s_nop 0
    buffer_load_dwordx4 v241, s[36:39], s80 offen lds
    s_add_u32 s80, s80, 128
    s_cmp_eq_u32 s80, s81
    s_cselect_b32 s80, s77, s80
    s_add_u32 m0, s66, 2048
    s_nop 0
    buffer_load_dwordx4 v240, s[36:39], s80 offen lds
    s_add_u32 m0, s66, 3072
    s_nop 0
    buffer_load_dwordx4 v241, s[36:39], s80 offen lds
    s_add_u32 s80, s80, 128
    s_cmp_eq_u32 s80, s81
    s_cselect_b32 s80, s77, s80
    s_mov_b32 s52, s18
    s_and_b32 s53, s19, 0xffff
    s_mov_b32 s54, 819200
    s_mov_b32 s55, 0x00020000
    buffer_load_dwordx4 v[228:231], v236, s[52:55], s70 offen
    buffer_load_dwordx4 v[232:235], v237, s[52:55], s70 offen
    s_add_u32 m0, s66, 4096
    s_nop 0
    buffer_load_dwordx4 v240, s[36:39], s80 offen lds
    s_add_u32 m0, s66, 5120
    s_nop 0
    buffer_load_dwordx4 v241, s[36:39], s80 offen lds
    s_add_u32 s80, s80, 128
    s_cmp_eq_u32 s80, s81
    s_cselect_b32 s80, s77, s80
    s_add_u32 m0, s66, 6144
    s_nop 0
    buffer_load_dwordx4 v240, s[36:39], s80 offen lds
    s_add_u32 m0, s66, 7168
    s_nop 0
    buffer_load_dwordx4 v241, s[36:39], s80 offen lds
    s_add_u32 s80, s80, 128
    s_cmp_eq_u32 s80, s81
    s_cselect_b32 s80, s77, s80
    s_mov_b32 s40, s16
    s_and_b32 s41, s17, 0xffff
    s_mov_b32 s42, 819200
    s_mov_b32 s43, 0x00020000
    s_mov_b32 s44, s10
    s_and_b32 s45, s11, 0xffff
    s_mov_b32 s46, 7864320
    s_mov_b32 s47, 0x00020000
    s_add_u32 s48, s28, 0
    s_addc_u32 s49, s29, 0
    s_and_b32 s49, s49, 0xffff
    s_mov_b32 s50, 134217728
    s_mov_b32 s51, 0x00020000
    s_mov_b32 s56, s26
    s_nop 0
    s_and_b32 s57, s27, 0xffff
    s_mov_b32 s58, 256
    s_mov_b32 s59, 0x00020000
    s_mul_i32 s67, s33, 160
    s_mov_b32 s73, 0x3f803f80
    s_mov_b32 s76, 0xffff0000
    s_lshl_b32 s71, s31, 2
    s_add_u32 s71, s71, s32
    s_mul_i32 s71, s71, 384
    s_mov_b32 s79, s71
    s_movk_i32 s35, 10240
    s_add_u32 m0, s66, 8192
    s_nop 0
    buffer_load_dwordx4 v240, s[36:39], s80 offen lds
    s_add_u32 m0, s66, 9216
    s_nop 0
    buffer_load_dwordx4 v241, s[36:39], s80 offen lds
    s_add_u32 s80, s80, 128
    s_cmp_eq_u32 s80, s81
    s_cselect_b32 s80, s77, s80
    v_mov_b32_e64 v14, v0
    v_mul_u32_u24 v15, 6554, v14
    v_lshrrev_b32 v15, 16, v15
    v_mul_u32_u24 v3, 10, v15
    v_sub_u32 v14, v14, v3
    v_lshlrev_b32 v14, 4, v14
    v_bfe_u32 v3, v15, 2, 2
    v_mad_u32_u24 v14, v3, s35, v14
    v_bfe_u32 v3, v15, 4, 1
    v_lshlrev_b32 v3, 2, v3
    v_and_b32 v15, 0x63, v15
    v_or_b32 v15, v15, v3
    v_mul_u32_u24 v15, 1280, v15
    v_add_u32 v3, v14, v15
    v_add_u32 v14, 256, v0
    v_mul_u32_u24 v15, 6554, v14
    v_lshrrev_b32 v15, 16, v15
    v_mul_u32_u24 v4, 10, v15
    v_sub_u32 v14, v14, v4
    v_lshlrev_b32_e64 v14, 4, v14
    v_bfe_u32 v4, v15, 2, 2
    v_mad_u32_u24 v14, v4, s35, v14
    v_bfe_u32 v4, v15, 4, 1
    v_lshlrev_b32 v4, 2, v4
    v_and_b32 v15, 0x63, v15
    v_or_b32 v15, v15, v4
    v_mul_u32_u24 v15, 1280, v15
    v_add_u32 v4, v14, v15
    v_add_u32 v14, 512, v0
    v_mul_u32_u24 v15, 6554, v14
    v_lshrrev_b32 v15, 16, v15
    v_mul_u32_u24 v5, 10, v15
    v_sub_u32 v14, v14, v5
    v_lshlrev_b32 v14, 4, v14
    v_bfe_u32 v5, v15, 2, 2
    v_mad_u32_u24 v14, v5, s35, v14
    v_bfe_u32 v5, v15, 4, 1
    v_lshlrev_b32 v5, 2, v5
    v_and_b32 v15, 0x63, v15
    v_or_b32 v15, v15, v5
    v_mul_u32_u24 v15, 1280, v15
    v_add_u32 v5, v14, v15
    v_add_u32 v14, 768, v0
    v_mul_u32_u24 v15, 6554, v14
    v_lshrrev_b32 v15, 16, v15
    v_mul_u32_u24 v6, 10, v15
    v_sub_u32 v14, v14, v6
    v_lshlrev_b32 v14, 4, v14
    v_bfe_u32 v6, v15, 2, 2
    v_mad_u32_u24 v14, v6, s35, v14
    v_bfe_u32 v6, v15, 4, 1
    v_lshlrev_b32_e64 v6, 2, v6
    v_and_b32 v15, 0x63, v15
    s_add_u32 m0, s66, 10240
    s_nop 0
    buffer_load_dwordx4 v240, s[36:39], s80 offen lds
    s_add_u32 m0, s66, 11264
    s_nop 0
    buffer_load_dwordx4 v241, s[36:39], s80 offen lds
    s_add_u32 s80, s80, 128
    s_cmp_eq_u32 s80, s81
    s_cselect_b32 s80, s77, s80
    v_or_b32_e64 v15, v15, v6
    v_mul_u32_u24 v15, 1280, v15
    v_add_u32 v6, v14, v15
    v_add_u32 v14, 1024, v0
    v_mul_u32_u24 v15, 6554, v14
    v_lshrrev_b32 v15, 16, v15
    v_mul_u32_u24 v7, 10, v15
    v_sub_u32 v14, v14, v7
    v_lshlrev_b32_e64 v14, 4, v14
    v_bfe_u32 v7, v15, 2, 2
    v_mad_u32_u24 v14, v7, s35, v14
    v_bfe_u32 v7, v15, 4, 1
    v_lshlrev_b32 v7, 2, v7
    v_and_b32 v15, 0x63, v15
    v_or_b32 v15, v15, v7
    v_mul_u32_u24 v15, 1280, v15
    v_add_u32 v7, v14, v15
    v_and_b32 v12, 15, v2
    v_lshrrev_b32 v13, 4, v2
    v_lshrrev_b32 v14, 1, v12
    v_xor_b32 v14, v14, v13
    v_lshlrev_b32 v14, 4, v14
    v_lshl_add_u32 v242, v12, 7, v14
    v_add_u32 v242, s66, v242
    v_xor_b32 v243, 64, v242
    v_lshrrev_b32 v14, 3, v0
    v_bfe_u32 v15, v14, 2, 2
    v_lshlrev_b32 v15, 3, v15
    v_and_or_b32 v15, v14, 3, v15
    v_lshrrev_b32 v14, 4, v14
    v_lshl_add_u32 v14, v14, 2, v15
    v_mul_u32_u24 v14, 12288, v14
    v_bfe_u32 v15, v0, 4, 2
    v_lshlrev_b32 v15, 1, v15
    v_and_b32 v11, 7, v0
    v_xor_b32 v15, v15, v11
    v_lshl_add_u32 v11, v15, 4, v14
    v_lshrrev_b32_e64 v14, 6, v1
    v_mul_u32_u24 v14, 160, v14
    v_bfe_u32 v15, v1, 4, 2
    v_lshl_add_u32 v8, v15, 3, v14
    v_add_u32 v8, 61440, v8
    v_mul_u32_u24 v14, 21846, v0
    v_lshrrev_b32 v14, 16, v14
    v_mul_u32_u24 v15, 3, v14
    v_sub_u32 v15, v0, v15
    v_min_u32 v14, 63, v14
    v_mul_u32_u24 v14, 12288, v14
    v_lshl_add_u32 v9, v15, 7, v14
    v_mov_b32_e64 v252, 0
    v_cmp_gt_u32 vcc, 8, v0
    v_mov_b32 v253, 0x80000000
    v_lshlrev_b32_e64 v254, 2, v0
    v_cndmask_b32 v253, v253, v254, vcc
    s_waitcnt vmcnt(12)
    ds_read_b128 v[16:19], v242 offset:0
    ds_read_b128 v[20:23], v243 offset:0
    s_waitcnt vmcnt(10)
    ds_read_b128 v[24:27], v242 offset:2048
    ds_read_b128 v[28:31], v243 offset:2048
    v_mov_b32_e64 v12, 0
    v_mov_b32_e64 v13, 0
    v_mov_b32_e64 v14, 0
    v_mov_b32 v15, 0
    s_add_u32 m0, s66, 12288
    s_nop 0
    buffer_load_dwordx4 v240, s[36:39], s80 offen lds
    s_add_u32 m0, s66, 13312
    s_nop 0
    buffer_load_dwordx4 v241, s[36:39], s80 offen lds
    s_add_u32 s80, s80, 128
    s_cmp_eq_u32 s80, s81
    s_cselect_b32 s80, s77, s80
    s_waitcnt vmcnt(8)
    ds_read_b128 v[32:35], v242 offset:4096
    ds_read_b128 v[36:39], v243 offset:4096
    s_waitcnt lgkmcnt(5)
    v_dot2c_f32_bf16 v12, s73, v16
    v_dot2c_f32_bf16 v14, v16, v16
    v_dot2c_f32_bf16 v13, s73, v17
    v_dot2c_f32_bf16 v15, v17, v17
    v_dot2c_f32_bf16 v12, s73, v18
    v_dot2c_f32_bf16 v14, v18, v18
    v_dot2c_f32_bf16 v13, s73, v19
    v_dot2c_f32_bf16 v15, v19, v19
    s_waitcnt lgkmcnt(4)
    v_dot2c_f32_bf16 v12, s73, v20
    v_dot2c_f32_bf16 v14, v20, v20
    v_dot2c_f32_bf16 v13, s73, v21
    v_dot2c_f32_bf16 v15, v21, v21
    v_dot2c_f32_bf16 v12, s73, v22
    v_dot2c_f32_bf16 v14, v22, v22
    v_dot2c_f32_bf16 v13, s73, v23
    v_dot2c_f32_bf16 v15, v23, v23
    s_add_u32 m0, s66, 14336
    s_nop 0
    buffer_load_dwordx4 v240, s[36:39], s80 offen lds
    s_add_u32 m0, s66, 15360
    s_nop 0
    buffer_load_dwordx4 v241, s[36:39], s80 offen lds
    s_add_u32 s80, s80, 128
    s_cmp_eq_u32 s80, s81
    s_cselect_b32 s80, s77, s80
    s_waitcnt vmcnt(8)
    ds_read_b128 v[40:43], v242 offset:6144
    ds_read_b128 v[44:47], v243 offset:6144
    s_waitcnt lgkmcnt(5)
    v_dot2c_f32_bf16 v12, s73, v24
    v_dot2c_f32_bf16 v14, v24, v24
    v_dot2c_f32_bf16 v13, s73, v25
    v_dot2c_f32_bf16 v15, v25, v25
    v_dot2c_f32_bf16 v12, s73, v26
    v_dot2c_f32_bf16 v14, v26, v26
    v_dot2c_f32_bf16 v13, s73, v27
    v_dot2c_f32_bf16 v15, v27, v27
    s_waitcnt lgkmcnt(4)
    v_dot2c_f32_bf16 v12, s73, v28
    v_dot2c_f32_bf16 v14, v28, v28
    v_dot2c_f32_bf16 v13, s73, v29
    v_dot2c_f32_bf16 v15, v29, v29
    v_dot2c_f32_bf16 v12, s73, v30
    v_dot2c_f32_bf16 v14, v30, v30
    v_dot2c_f32_bf16 v13, s73, v31
    v_dot2c_f32_bf16 v15, v31, v31
    s_add_u32 m0, s66, 16384
    s_nop 0
    buffer_load_dwordx4 v240, s[36:39], s80 offen lds
    s_add_u32 m0, s66, 17408
    s_nop 0
    buffer_load_dwordx4 v241, s[36:39], s80 offen lds
    s_add_u32 s80, s80, 128
    s_cmp_eq_u32 s80, s81
    s_cselect_b32 s80, s77, s80
    s_waitcnt vmcnt(8)
    ds_read_b128 v[48:51], v242 offset:8192
    ds_read_b128 v[52:55], v243 offset:8192
    s_waitcnt lgkmcnt(5)
    v_dot2c_f32_bf16 v12, s73, v32
    v_dot2c_f32_bf16 v14, v32, v32
    v_dot2c_f32_bf16 v13, s73, v33
    v_dot2c_f32_bf16 v15, v33, v33
    v_dot2c_f32_bf16 v12, s73, v34
    v_dot2c_f32_bf16 v14, v34, v34
    v_dot2c_f32_bf16 v13, s73, v35
    v_dot2c_f32_bf16 v15, v35, v35
    s_waitcnt lgkmcnt(4)
    v_dot2c_f32_bf16 v12, s73, v36
    v_dot2c_f32_bf16 v14, v36, v36
    v_dot2c_f32_bf16 v13, s73, v37
    v_dot2c_f32_bf16 v15, v37, v37
    v_dot2c_f32_bf16 v12, s73, v38
    v_dot2c_f32_bf16 v14, v38, v38
    v_dot2c_f32_bf16 v13, s73, v39
    v_dot2c_f32_bf16 v15, v39, v39
    s_add_u32 m0, s66, 18432
    s_nop 0
    buffer_load_dwordx4 v240, s[36:39], s80 offen lds
    s_add_u32 m0, s66, 19456
    s_nop 0
    buffer_load_dwordx4 v241, s[36:39], s80 offen lds
    s_waitcnt vmcnt(8)
    ds_read_b128 v[56:59], v242 offset:10240
    ds_read_b128 v[60:63], v243 offset:10240
    s_waitcnt lgkmcnt(5)
    v_dot2c_f32_bf16 v12, s73, v40
    v_dot2c_f32_bf16 v14, v40, v40
    v_dot2c_f32_bf16 v13, s73, v41
    v_dot2c_f32_bf16 v15, v41, v41
    v_dot2c_f32_bf16 v12, s73, v42
    v_dot2c_f32_bf16 v14, v42, v42
    v_dot2c_f32_bf16 v13, s73, v43
    v_dot2c_f32_bf16 v15, v43, v43
    s_waitcnt lgkmcnt(4)
    v_dot2c_f32_bf16 v12, s73, v44
    v_dot2c_f32_bf16 v14, v44, v44
    v_dot2c_f32_bf16 v13, s73, v45
    v_dot2c_f32_bf16 v15, v45, v45
    v_dot2c_f32_bf16 v12, s73, v46
    v_dot2c_f32_bf16 v14, v46, v46
    v_dot2c_f32_bf16 v13, s73, v47
    v_dot2c_f32_bf16 v15, v47, v47
    s_lshl_b32 s3, s2, 8
    s_add_u32 s3, s3, 79691776
    buffer_store_dword v252, v253, s[48:51], s3 offen sc1
    s_add_u32 s3, s32, 0
    s_and_b32 s3, s3, 3
    s_add_u32 s3, s3, 1
    s_mul_i32 s78, s3, 163840
    s_add_u32 s78, s78, s67
    s_mul_i32 s68, s3, 20480
    s_nop 0
    s_add_u32 s68, s68, s34
    s_add_u32 m0, s68, 61440
    s_nop 0
    buffer_load_dwordx4 v3, s[40:43], s78 offen lds
    s_waitcnt vmcnt(8)
    ds_read_b128 v[64:67], v242 offset:12288
    ds_read_b128 v[68:71], v243 offset:12288
    s_waitcnt lgkmcnt(5)
    v_dot2c_f32_bf16 v12, s73, v48
    v_dot2c_f32_bf16 v14, v48, v48
    v_dot2c_f32_bf16 v13, s73, v49
    v_dot2c_f32_bf16 v15, v49, v49
    v_dot2c_f32_bf16 v12, s73, v50
    v_dot2c_f32_bf16 v14, v50, v50
    v_dot2c_f32_bf16 v13, s73, v51
    v_dot2c_f32_bf16 v15, v51, v51
    s_waitcnt lgkmcnt(4)
    v_dot2c_f32_bf16 v12, s73, v52
    v_dot2c_f32_bf16 v14, v52, v52
    v_dot2c_f32_bf16 v13, s73, v53
    v_dot2c_f32_bf16 v15, v53, v53
    v_dot2c_f32_bf16 v12, s73, v54
    v_dot2c_f32_bf16 v14, v54, v54
    v_dot2c_f32_bf16 v13, s73, v55
    v_dot2c_f32_bf16 v15, v55, v55
    s_waitcnt vmcnt(6)
    s_nop 0
    ds_read_b128 v[72:75], v242 offset:14336
    ds_read_b128 v[76:79], v243 offset:14336
    s_waitcnt lgkmcnt(5)
    v_dot2c_f32_bf16 v12, s73, v56
    v_dot2c_f32_bf16 v14, v56, v56
    v_dot2c_f32_bf16 v13, s73, v57
    v_dot2c_f32_bf16 v15, v57, v57
    v_dot2c_f32_bf16 v12, s73, v58
    v_dot2c_f32_bf16 v14, v58, v58
    v_dot2c_f32_bf16 v13, s73, v59
    v_dot2c_f32_bf16 v15, v59, v59
    s_waitcnt lgkmcnt(4)
    v_dot2c_f32_bf16 v12, s73, v60
    v_dot2c_f32_bf16 v14, v60, v60
    v_dot2c_f32_bf16 v13, s73, v61
    v_dot2c_f32_bf16 v15, v61, v61
    s_add_u32 m0, s68, 65536
    s_nop 0
    buffer_load_dwordx4 v4, s[40:43], s78 offen lds
    v_dot2c_f32_bf16 v12, s73, v62
    v_dot2c_f32_bf16 v14, v62, v62
    v_dot2c_f32_bf16 v13, s73, v63
    v_dot2c_f32_bf16 v15, v63, v63
    s_waitcnt vmcnt(5)
    ds_read_b128 v[80:83], v242 offset:16384
    ds_read_b128 v[84:87], v243 offset:16384
    s_waitcnt lgkmcnt(5)
    v_dot2c_f32_bf16 v12, s73, v64
    v_dot2c_f32_bf16 v14, v64, v64
    v_dot2c_f32_bf16 v13, s73, v65
    v_dot2c_f32_bf16 v15, v65, v65
    v_dot2c_f32_bf16 v12, s73, v66
    v_dot2c_f32_bf16 v14, v66, v66
    v_dot2c_f32_bf16 v13, s73, v67
    v_dot2c_f32_bf16 v15, v67, v67
    s_waitcnt lgkmcnt(4)
    v_dot2c_f32_bf16 v12, s73, v68
    v_dot2c_f32_bf16 v14, v68, v68
    v_dot2c_f32_bf16 v13, s73, v69
    v_dot2c_f32_bf16 v15, v69, v69
    v_dot2c_f32_bf16 v12, s73, v70
    v_dot2c_f32_bf16 v14, v70, v70
    v_dot2c_f32_bf16 v13, s73, v71
    v_dot2c_f32_bf16 v15, v71, v71
    s_waitcnt vmcnt(3)
    ds_read_b128 v[88:91], v242 offset:18432
    ds_read_b128 v[92:95], v243 offset:18432
    s_waitcnt lgkmcnt(5)
    v_dot2c_f32_bf16 v12, s73, v72
    v_dot2c_f32_bf16 v14, v72, v72
    v_dot2c_f32_bf16 v13, s73, v73
    v_dot2c_f32_bf16 v15, v73, v73
    v_dot2c_f32_bf16 v12, s73, v74
    v_dot2c_f32_bf16 v14, v74, v74
    v_dot2c_f32_bf16 v13, s73, v75
    v_dot2c_f32_bf16 v15, v75, v75
    s_add_u32 m0, s68, 69632
    s_nop 0
    buffer_load_dwordx4 v5, s[40:43], s78 offen lds
    s_waitcnt lgkmcnt(4)
    v_dot2c_f32_bf16 v12, s73, v76
    v_dot2c_f32_bf16 v14, v76, v76
    v_dot2c_f32_bf16 v13, s73, v77
    v_dot2c_f32_bf16 v15, v77, v77
    v_dot2c_f32_bf16 v12, s73, v78
    v_dot2c_f32_bf16 v14, v78, v78
    v_dot2c_f32_bf16 v13, s73, v79
    v_dot2c_f32_bf16 v15, v79, v79
    s_waitcnt lgkmcnt(3)
    v_dot2c_f32_bf16 v12, s73, v80
    v_dot2c_f32_bf16 v14, v80, v80
    v_dot2c_f32_bf16 v13, s73, v81
    v_dot2c_f32_bf16 v15, v81, v81
    v_dot2c_f32_bf16 v12, s73, v82
    v_dot2c_f32_bf16 v14, v82, v82
    v_dot2c_f32_bf16 v13, s73, v83
    v_dot2c_f32_bf16 v15, v83, v83
    s_waitcnt lgkmcnt(2)
    v_dot2c_f32_bf16 v12, s73, v84
    v_dot2c_f32_bf16 v14, v84, v84
    v_dot2c_f32_bf16 v13, s73, v85
    v_dot2c_f32_bf16 v15, v85, v85
    v_dot2c_f32_bf16 v12, s73, v86
    v_dot2c_f32_bf16 v14, v86, v86
    v_dot2c_f32_bf16 v13, s73, v87
    v_dot2c_f32_bf16 v15, v87, v87
    s_waitcnt lgkmcnt(1)
    v_dot2c_f32_bf16 v12, s73, v88
    v_dot2c_f32_bf16 v14, v88, v88
    v_dot2c_f32_bf16 v13, s73, v89
    v_dot2c_f32_bf16 v15, v89, v89
    v_dot2c_f32_bf16 v12, s73, v90
    v_dot2c_f32_bf16 v14, v90, v90
    v_dot2c_f32_bf16 v13, s73, v91
    v_dot2c_f32_bf16 v15, v91, v91
    s_waitcnt lgkmcnt(0)
    v_dot2c_f32_bf16 v12, s73, v92
    v_dot2c_f32_bf16 v14, v92, v92
    s_add_u32 m0, s68, 73728
    s_nop 0
    buffer_load_dwordx4 v6, s[40:43], s78 offen lds
    v_dot2c_f32_bf16 v13, s73, v93
    v_dot2c_f32_bf16 v15, v93, v93
    v_dot2c_f32_bf16 v12, s73, v94
    v_dot2c_f32_bf16 v14, v94, v94
    v_dot2c_f32_bf16 v13, s73, v95
    v_dot2c_f32_bf16 v15, v95, v95
    s_nop 2
    v_add_f32 v12, v12, v13
    v_add_f32 v14, v14, v15
    v_mov_b32 v10, v12
    s_nop 1
    v_permlane32_swap_b32 v12, v10
    s_nop 1
    v_add_f32 v12, v12, v10
    v_mov_b32 v10, v12
    s_nop 1
    v_permlane16_swap_b32 v12, v10
    s_nop 1
    v_add_f32 v12, v12, v10
    v_mov_b32 v10, v14
    s_nop 1
    v_permlane32_swap_b32 v14, v10
    s_nop 1
    v_add_f32 v14, v14, v10
    v_mov_b32 v10, v14
    s_nop 1
    v_permlane16_swap_b32 v14, v10
    s_nop 1
    v_add_f32 v14, v14, v10
    v_mul_f32 v12, 0x3acccccd, v12
    v_mul_f32 v14, 0x3acccccd, v14
    v_fma_f32 v14, -v12, v12, v14
    v_max_f32 v14, 0, v14
    v_add_f32 v14, 0x3727c5ac, v14
    s_add_u32 m0, s68, 77824
    s_nop 0
    buffer_load_dwordx4 v7, s[40:43], s78 offen lds
    v_rsq_f32 v14, v14
    s_nop 0
    v_mov_b32 v15, v14
    v_mul_f32 v12, -v12, v14
    v_mov_b32 v13, v12
    v_lshlrev_b32 v96, 16, v16
    v_and_b32 v97, s76, v16
    v_pk_fma_f32 v[96:97], v[96:97], v[14:15], v[12:13]
    v_cvt_pk_bf16_f32 v16, v96, v97
    v_lshlrev_b32 v98, 16, v17
    v_and_b32 v99, s76, v17
    v_pk_fma_f32 v[98:99], v[98:99], v[14:15], v[12:13]
    v_cvt_pk_bf16_f32 v17, v98, v99
    v_lshlrev_b32 v100, 16, v18
    v_and_b32 v101, s76, v18
    v_pk_fma_f32 v[100:101], v[100:101], v[14:15], v[12:13]
    v_cvt_pk_bf16_f32 v18, v100, v101
    v_lshlrev_b32 v102, 16, v19
    v_and_b32 v103, s76, v19
    v_pk_fma_f32 v[102:103], v[102:103], v[14:15], v[12:13]
    v_cvt_pk_bf16_f32 v19, v102, v103
    v_lshlrev_b32 v104, 16, v20
    v_and_b32 v105, s76, v20
    v_pk_fma_f32 v[104:105], v[104:105], v[14:15], v[12:13]
    v_cvt_pk_bf16_f32 v20, v104, v105
    v_lshlrev_b32 v106, 16, v21
    v_and_b32 v107, s76, v21
    v_pk_fma_f32 v[106:107], v[106:107], v[14:15], v[12:13]
    v_cvt_pk_bf16_f32 v21, v106, v107
    v_lshlrev_b32_e64 v108, 16, v22
    v_and_b32_e64 v109, s76, v22
    v_pk_fma_f32 v[108:109], v[108:109], v[14:15], v[12:13]
    v_cvt_pk_bf16_f32 v22, v108, v109
    v_lshlrev_b32 v110, 16, v23
    s_add_u32 s3, s32, 1
    s_and_b32 s3, s3, 3
    s_add_u32 s3, s3, 1
    s_mul_i32 s78, s3, 163840
    s_add_u32 s78, s78, s67
    s_mul_i32 s68, s3, 20480
    s_add_u32 s68, s68, s34
    s_add_u32 m0, s68, 61440
    s_nop 0
    buffer_load_dwordx4 v3, s[40:43], s78 offen lds
    v_and_b32 v111, s76, v23
    v_pk_fma_f32 v[110:111], v[110:111], v[14:15], v[12:13]
    v_cvt_pk_bf16_f32 v23, v110, v111
    v_lshlrev_b32 v112, 16, v24
    v_and_b32 v113, s76, v24
    v_pk_fma_f32 v[112:113], v[112:113], v[14:15], v[12:13]
    v_cvt_pk_bf16_f32 v24, v112, v113
    v_lshlrev_b32 v114, 16, v25
    v_and_b32 v115, s76, v25
    v_pk_fma_f32 v[114:115], v[114:115], v[14:15], v[12:13]
    v_cvt_pk_bf16_f32 v25, v114, v115
    v_lshlrev_b32 v116, 16, v26
    v_and_b32 v117, s76, v26
    v_pk_fma_f32 v[116:117], v[116:117], v[14:15], v[12:13]
    v_cvt_pk_bf16_f32 v26, v116, v117
    v_lshlrev_b32 v118, 16, v27
    v_and_b32 v119, s76, v27
    v_pk_fma_f32 v[118:119], v[118:119], v[14:15], v[12:13]
    v_cvt_pk_bf16_f32 v27, v118, v119
    v_lshlrev_b32 v120, 16, v28
    v_and_b32 v121, s76, v28
    v_pk_fma_f32 v[120:121], v[120:121], v[14:15], v[12:13]
    v_cvt_pk_bf16_f32 v28, v120, v121
    v_lshlrev_b32_e64 v122, 16, v29
    v_and_b32_e64 v123, s76, v29
    v_pk_fma_f32 v[122:123], v[122:123], v[14:15], v[12:13]
    v_cvt_pk_bf16_f32 v29, v122, v123
    v_lshlrev_b32_e64 v124, 16, v30
    v_and_b32_e64 v125, s76, v30
    v_pk_fma_f32 v[124:125], v[124:125], v[14:15], v[12:13]
    v_cvt_pk_bf16_f32 v30, v124, v125
    v_lshlrev_b32_e64 v126, 16, v31
    v_and_b32 v127, s76, v31
    v_pk_fma_f32 v[126:127], v[126:127], v[14:15], v[12:13]
    v_cvt_pk_bf16_f32 v31, v126, v127
    s_lshl_b32 s3, s83, 11
    s_add_u32 s3, s3, s77
    s_cmp_ge_u32 s33, 5
    s_cselect_b32 s3, 234881024, s3
    buffer_store_dwordx4 v[16:19], v1, s[48:51], s3 offen offset:0 sc1
    buffer_store_dwordx4 v[20:23], v1, s[48:51], s3 offen offset:1024 sc1
    buffer_store_dwordx4 v[24:27], v1, s[48:51], s3 offen offset:2048 sc1
    buffer_store_dwordx4 v[28:31], v1, s[48:51], s3 offen offset:3072 sc1
    buffer_store_dwordx4 v[228:231], v238, s[48:51], s72 offen sc1
    buffer_store_dwordx4 v[232:235], v239, s[48:51], s72 offen sc1
    s_add_u32 m0, s68, 65536
    s_nop 0
    buffer_load_dwordx4 v4, s[40:43], s78 offen lds
    v_lshlrev_b32 v128, 16, v32
    v_and_b32_e64 v129, s76, v32
    v_pk_fma_f32 v[128:129], v[128:129], v[14:15], v[12:13]
    v_cvt_pk_bf16_f32 v32, v128, v129
    v_lshlrev_b32 v130, 16, v33
    v_and_b32 v131, s76, v33
    v_pk_fma_f32 v[130:131], v[130:131], v[14:15], v[12:13]
    v_cvt_pk_bf16_f32 v33, v130, v131
    v_lshlrev_b32 v132, 16, v34
    v_and_b32 v133, s76, v34
    v_pk_fma_f32 v[132:133], v[132:133], v[14:15], v[12:13]
    v_cvt_pk_bf16_f32 v34, v132, v133
    v_lshlrev_b32 v134, 16, v35
    v_and_b32 v135, s76, v35
    v_pk_fma_f32 v[134:135], v[134:135], v[14:15], v[12:13]
    v_cvt_pk_bf16_f32 v35, v134, v135
    v_lshlrev_b32 v136, 16, v36
    v_and_b32 v137, s76, v36
    v_pk_fma_f32 v[136:137], v[136:137], v[14:15], v[12:13]
    v_cvt_pk_bf16_f32 v36, v136, v137
    v_lshlrev_b32 v138, 16, v37
    s_add_u32 m0, s68, 69632
    s_nop 0
    buffer_load_dwordx4 v5, s[40:43], s78 offen lds
    v_and_b32 v139, s76, v37
    v_pk_fma_f32 v[138:139], v[138:139], v[14:15], v[12:13]
    v_cvt_pk_bf16_f32 v37, v138, v139
    v_lshlrev_b32 v140, 16, v38
    v_and_b32_e64 v141, s76, v38
    v_pk_fma_f32 v[140:141], v[140:141], v[14:15], v[12:13]
    v_cvt_pk_bf16_f32 v38, v140, v141
    v_lshlrev_b32 v142, 16, v39
    v_and_b32 v143, s76, v39
    v_pk_fma_f32 v[142:143], v[142:143], v[14:15], v[12:13]
    v_cvt_pk_bf16_f32 v39, v142, v143
    v_lshlrev_b32 v144, 16, v40
    v_and_b32 v145, s76, v40
    v_pk_fma_f32 v[144:145], v[144:145], v[14:15], v[12:13]
    v_cvt_pk_bf16_f32 v40, v144, v145
    v_lshlrev_b32 v146, 16, v41
    v_and_b32 v147, s76, v41
    v_pk_fma_f32 v[146:147], v[146:147], v[14:15], v[12:13]
    v_cvt_pk_bf16_f32 v41, v146, v147
    v_lshlrev_b32_e64 v148, 16, v42
    v_and_b32 v149, s76, v42
    s_add_u32 m0, s68, 73728
    s_nop 0
    buffer_load_dwordx4 v6, s[40:43], s78 offen lds
    v_pk_fma_f32 v[148:149], v[148:149], v[14:15], v[12:13]
    v_cvt_pk_bf16_f32 v42, v148, v149
    v_lshlrev_b32 v150, 16, v43
    v_and_b32 v151, s76, v43
    v_pk_fma_f32 v[150:151], v[150:151], v[14:15], v[12:13]
    v_cvt_pk_bf16_f32 v43, v150, v151
    v_lshlrev_b32 v152, 16, v44
    v_and_b32 v153, s76, v44
    v_pk_fma_f32 v[152:153], v[152:153], v[14:15], v[12:13]
    v_cvt_pk_bf16_f32 v44, v152, v153
    v_lshlrev_b32 v154, 16, v45
    v_and_b32 v155, s76, v45
    v_pk_fma_f32 v[154:155], v[154:155], v[14:15], v[12:13]
    v_cvt_pk_bf16_f32 v45, v154, v155
    v_lshlrev_b32 v156, 16, v46
    v_and_b32 v157, s76, v46
    v_pk_fma_f32 v[156:157], v[156:157], v[14:15], v[12:13]
    v_cvt_pk_bf16_f32 v46, v156, v157
    v_lshlrev_b32 v158, 16, v47
    v_and_b32 v159, s76, v47
    v_pk_fma_f32 v[158:159], v[158:159], v[14:15], v[12:13]
    s_add_u32 m0, s68, 77824
    s_nop 0
    buffer_load_dwordx4 v7, s[40:43], s78 offen lds
    v_cvt_pk_bf16_f32 v47, v158, v159
    v_lshlrev_b32 v160, 16, v48
    v_and_b32_e64 v161, s76, v48
    v_pk_fma_f32 v[160:161], v[160:161], v[14:15], v[12:13]
    v_cvt_pk_bf16_f32 v48, v160, v161
    v_lshlrev_b32 v162, 16, v49
    v_and_b32 v163, s76, v49
    v_pk_fma_f32 v[162:163], v[162:163], v[14:15], v[12:13]
    v_cvt_pk_bf16_f32 v49, v162, v163
    v_lshlrev_b32 v164, 16, v50
    v_and_b32 v165, s76, v50
    v_pk_fma_f32 v[164:165], v[164:165], v[14:15], v[12:13]
    v_cvt_pk_bf16_f32 v50, v164, v165
    v_lshlrev_b32 v166, 16, v51
    v_and_b32 v167, s76, v51
    v_pk_fma_f32 v[166:167], v[166:167], v[14:15], v[12:13]
    v_cvt_pk_bf16_f32 v51, v166, v167
    v_lshlrev_b32_e64 v168, 16, v52
    v_and_b32 v169, s76, v52
    v_pk_fma_f32 v[168:169], v[168:169], v[14:15], v[12:13]
    v_cvt_pk_bf16_f32 v52, v168, v169
    s_add_u32 s3, s32, 2
    s_and_b32 s3, s3, 3
    s_add_u32 s3, s3, 1
    s_mul_i32 s78, s3, 163840
    s_add_u32 s78, s78, s67
    s_mul_i32 s68, s3, 20480
    s_add_u32 s68, s68, s34
    s_add_u32 m0, s68, 61440
    s_nop 0
    buffer_load_dwordx4 v3, s[40:43], s78 offen lds
    v_lshlrev_b32 v170, 16, v53
    v_and_b32_e64 v171, s76, v53
    v_pk_fma_f32 v[170:171], v[170:171], v[14:15], v[12:13]
    v_cvt_pk_bf16_f32 v53, v170, v171
    v_lshlrev_b32 v172, 16, v54
    v_and_b32 v173, s76, v54
    v_pk_fma_f32 v[172:173], v[172:173], v[14:15], v[12:13]
    v_cvt_pk_bf16_f32 v54, v172, v173
    v_lshlrev_b32 v174, 16, v55
    v_and_b32 v175, s76, v55
    v_pk_fma_f32 v[174:175], v[174:175], v[14:15], v[12:13]
    v_cvt_pk_bf16_f32 v55, v174, v175
    v_lshlrev_b32 v176, 16, v56
    v_and_b32 v177, s76, v56
    v_pk_fma_f32 v[176:177], v[176:177], v[14:15], v[12:13]
    v_cvt_pk_bf16_f32 v56, v176, v177
    v_lshlrev_b32 v178, 16, v57
    v_and_b32 v179, s76, v57
    v_pk_fma_f32 v[178:179], v[178:179], v[14:15], v[12:13]
    v_cvt_pk_bf16_f32 v57, v178, v179
    v_lshlrev_b32 v180, 16, v58
    s_add_u32 m0, s68, 65536
    s_nop 0
    buffer_load_dwordx4 v4, s[40:43], s78 offen lds
    v_and_b32 v181, s76, v58
    v_pk_fma_f32 v[180:181], v[180:181], v[14:15], v[12:13]
    v_cvt_pk_bf16_f32 v58, v180, v181
    v_lshlrev_b32 v182, 16, v59
    v_and_b32_e64 v183, s76, v59
    v_pk_fma_f32 v[182:183], v[182:183], v[14:15], v[12:13]
    v_cvt_pk_bf16_f32 v59, v182, v183
    v_lshlrev_b32 v184, 16, v60
    v_and_b32 v185, s76, v60
    v_pk_fma_f32 v[184:185], v[184:185], v[14:15], v[12:13]
    v_cvt_pk_bf16_f32 v60, v184, v185
    v_lshlrev_b32 v186, 16, v61
    v_and_b32 v187, s76, v61
    v_pk_fma_f32 v[186:187], v[186:187], v[14:15], v[12:13]
    v_cvt_pk_bf16_f32 v61, v186, v187
    v_lshlrev_b32 v188, 16, v62
    v_and_b32 v189, s76, v62
    v_pk_fma_f32 v[188:189], v[188:189], v[14:15], v[12:13]
    v_cvt_pk_bf16_f32 v62, v188, v189
    v_lshlrev_b32_e64 v190, 16, v63
    v_and_b32 v191, s76, v63
    s_add_u32 m0, s68, 69632
    s_nop 0
    buffer_load_dwordx4 v5, s[40:43], s78 offen lds
    v_pk_fma_f32 v[190:191], v[190:191], v[14:15], v[12:13]
    v_cvt_pk_bf16_f32 v63, v190, v191
    v_lshlrev_b32 v192, 16, v64
    v_and_b32 v193, s76, v64
    v_pk_fma_f32 v[192:193], v[192:193], v[14:15], v[12:13]
    v_cvt_pk_bf16_f32 v64, v192, v193
    v_lshlrev_b32 v194, 16, v65
    v_and_b32 v195, s76, v65
    v_pk_fma_f32 v[194:195], v[194:195], v[14:15], v[12:13]
    v_cvt_pk_bf16_f32 v65, v194, v195
    v_lshlrev_b32 v196, 16, v66
    v_and_b32 v197, s76, v66
    v_pk_fma_f32 v[196:197], v[196:197], v[14:15], v[12:13]
    v_cvt_pk_bf16_f32 v66, v196, v197
    v_lshlrev_b32 v198, 16, v67
    v_and_b32 v199, s76, v67
    v_pk_fma_f32 v[198:199], v[198:199], v[14:15], v[12:13]
    v_cvt_pk_bf16_f32 v67, v198, v199
    v_lshlrev_b32 v200, 16, v68
    v_and_b32 v201, s76, v68
    v_pk_fma_f32 v[200:201], v[200:201], v[14:15], v[12:13]
    v_cvt_pk_bf16_f32 v68, v200, v201
    s_add_u32 m0, s68, 73728
    s_nop 0
    buffer_load_dwordx4 v6, s[40:43], s78 offen lds
    v_lshlrev_b32 v202, 16, v69
    v_and_b32_e64 v203, s76, v69
    v_pk_fma_f32 v[202:203], v[202:203], v[14:15], v[12:13]
    v_cvt_pk_bf16_f32 v69, v202, v203
    v_lshlrev_b32 v204, 16, v70
    v_and_b32 v205, s76, v70
    v_pk_fma_f32 v[204:205], v[204:205], v[14:15], v[12:13]
    v_cvt_pk_bf16_f32 v70, v204, v205
    v_lshlrev_b32 v206, 16, v71
    v_and_b32 v207, s76, v71
    v_pk_fma_f32 v[206:207], v[206:207], v[14:15], v[12:13]
    v_cvt_pk_bf16_f32 v71, v206, v207
    v_lshlrev_b32 v208, 16, v72
    v_and_b32 v209, s76, v72
    v_pk_fma_f32 v[208:209], v[208:209], v[14:15], v[12:13]
    v_cvt_pk_bf16_f32 v72, v208, v209
    v_lshlrev_b32 v210, 16, v73
    v_and_b32 v211, s76, v73
    v_pk_fma_f32 v[210:211], v[210:211], v[14:15], v[12:13]
    v_cvt_pk_bf16_f32 v73, v210, v211
    v_lshlrev_b32 v212, 16, v74
    s_add_u32 m0, s68, 77824
    s_nop 0
    buffer_load_dwordx4 v7, s[40:43], s78 offen lds
    v_and_b32 v213, s76, v74
    v_pk_fma_f32 v[212:213], v[212:213], v[14:15], v[12:13]
    v_cvt_pk_bf16_f32 v74, v212, v213
    v_lshlrev_b32 v214, 16, v75
    v_and_b32 v215, s76, v75
    v_pk_fma_f32 v[214:215], v[214:215], v[14:15], v[12:13]
    v_cvt_pk_bf16_f32 v75, v214, v215
    v_lshlrev_b32 v216, 16, v76
    v_and_b32_e64 v217, s76, v76
    v_pk_fma_f32 v[216:217], v[216:217], v[14:15], v[12:13]
    v_cvt_pk_bf16_f32 v76, v216, v217
    v_lshlrev_b32 v218, 16, v77
    v_and_b32 v219, s76, v77
    v_pk_fma_f32 v[218:219], v[218:219], v[14:15], v[12:13]
    v_cvt_pk_bf16_f32 v77, v218, v219
    v_lshlrev_b32 v220, 16, v78
    v_and_b32 v221, s76, v78
    v_pk_fma_f32 v[220:221], v[220:221], v[14:15], v[12:13]
    v_cvt_pk_bf16_f32 v78, v220, v221
    v_lshlrev_b32 v222, 16, v79
    v_and_b32 v223, s76, v79
    s_add_u32 s3, s32, 3
    s_and_b32 s3, s3, 3
    s_add_u32 s3, s3, 1
    s_mul_i32 s78, s3, 163840
    s_add_u32 s78, s78, s67
    s_mul_i32 s68, s3, 20480
    s_add_u32 s68, s68, s34
    s_add_u32 m0, s68, 61440
    s_nop 0
    buffer_load_dwordx4 v3, s[40:43], s78 offen lds
    v_pk_fma_f32 v[222:223], v[222:223], v[14:15], v[12:13]
    v_cvt_pk_bf16_f32 v79, v222, v223
    v_lshlrev_b32 v224, 16, v80
    v_and_b32 v225, s76, v80
    v_pk_fma_f32 v[224:225], v[224:225], v[14:15], v[12:13]
    v_cvt_pk_bf16_f32 v80, v224, v225
    v_lshlrev_b32 v226, 16, v81
    v_and_b32 v227, s76, v81
    v_pk_fma_f32 v[226:227], v[226:227], v[14:15], v[12:13]
    v_cvt_pk_bf16_f32 v81, v226, v227
    v_lshlrev_b32 v228, 16, v82
    v_and_b32 v229, s76, v82
    v_pk_fma_f32 v[228:229], v[228:229], v[14:15], v[12:13]
    v_cvt_pk_bf16_f32 v82, v228, v229
    v_lshlrev_b32 v230, 16, v83
    v_and_b32 v231, s76, v83
    v_pk_fma_f32 v[230:231], v[230:231], v[14:15], v[12:13]
    v_cvt_pk_bf16_f32 v83, v230, v231
    v_lshlrev_b32 v232, 16, v84
    v_and_b32 v233, s76, v84
    v_pk_fma_f32 v[232:233], v[232:233], v[14:15], v[12:13]
    s_add_u32 m0, s68, 65536
    s_nop 0
    buffer_load_dwordx4 v4, s[40:43], s78 offen lds
    v_cvt_pk_bf16_f32 v84, v232, v233
    v_lshlrev_b32 v234, 16, v85
    v_and_b32 v235, s76, v85
    v_pk_fma_f32 v[234:235], v[234:235], v[14:15], v[12:13]
    v_cvt_pk_bf16_f32 v85, v234, v235
    v_lshlrev_b32 v236, 16, v86
    v_and_b32_e64 v237, s76, v86
    v_pk_fma_f32 v[236:237], v[236:237], v[14:15], v[12:13]
    v_cvt_pk_bf16_f32 v86, v236, v237
    v_lshlrev_b32 v238, 16, v87
    v_and_b32 v239, s76, v87
    v_pk_fma_f32 v[238:239], v[238:239], v[14:15], v[12:13]
    v_cvt_pk_bf16_f32 v87, v238, v239
    v_lshlrev_b32 v240, 16, v88
    v_and_b32 v241, s76, v88
    v_pk_fma_f32 v[240:241], v[240:241], v[14:15], v[12:13]
    v_cvt_pk_bf16_f32 v88, v240, v241
    v_lshlrev_b32 v242, 16, v89
    v_and_b32 v243, s76, v89
    v_pk_fma_f32 v[242:243], v[242:243], v[14:15], v[12:13]
    v_cvt_pk_bf16_f32 v89, v242, v243
    s_add_u32 m0, s68, 69632
    s_nop 0
    buffer_load_dwordx4 v5, s[40:43], s78 offen lds
    v_lshlrev_b32 v244, 16, v90
    v_and_b32_e64 v245, s76, v90
    v_pk_fma_f32 v[244:245], v[244:245], v[14:15], v[12:13]
    v_cvt_pk_bf16_f32 v90, v244, v245
    v_lshlrev_b32 v246, 16, v91
    v_and_b32 v247, s76, v91
    v_pk_fma_f32 v[246:247], v[246:247], v[14:15], v[12:13]
    v_cvt_pk_bf16_f32 v91, v246, v247
    v_lshlrev_b32 v248, 16, v92
    v_and_b32 v249, s76, v92
    v_pk_fma_f32 v[248:249], v[248:249], v[14:15], v[12:13]
    v_cvt_pk_bf16_f32 v92, v248, v249
    v_lshlrev_b32 v250, 16, v93
    v_and_b32 v251, s76, v93
    v_pk_fma_f32 v[250:251], v[250:251], v[14:15], v[12:13]
    v_cvt_pk_bf16_f32 v93, v250, v251
    v_lshlrev_b32 v252, 16, v94
    v_and_b32 v253, s76, v94
    v_pk_fma_f32 v[252:253], v[252:253], v[14:15], v[12:13]
    v_cvt_pk_bf16_f32 v94, v252, v253
    v_lshlrev_b32 v254, 16, v95
    s_add_u32 m0, s68, 73728
    s_nop 0
    buffer_load_dwordx4 v6, s[40:43], s78 offen lds
    v_and_b32 v255, s76, v95
    v_pk_fma_f32 v[254:255], v[254:255], v[14:15], v[12:13]
    v_cvt_pk_bf16_f32 v95, v254, v255
    v_mov_b32 v12, 0
    v_mov_b32 v13, 0
    v_mov_b32 v14, 0
    v_mov_b32_e64 v15, 0
    v_dot2c_f32_bf16 v12, s73, v16
    v_dot2c_f32_bf16 v14, v16, v16
    v_dot2c_f32_bf16 v13, s73, v17
    v_dot2c_f32_bf16 v15, v17, v17
    v_dot2c_f32_bf16 v12, s73, v18
    v_dot2c_f32_bf16 v14, v18, v18
    v_dot2c_f32_bf16 v13, s73, v19
    v_dot2c_f32_bf16 v15, v19, v19
    v_dot2c_f32_bf16 v12, s73, v20
    v_dot2c_f32_bf16 v14, v20, v20
    v_dot2c_f32_bf16 v13, s73, v21
    v_dot2c_f32_bf16 v15, v21, v21
    v_dot2c_f32_bf16 v12, s73, v22
    v_dot2c_f32_bf16 v14, v22, v22
    s_add_u32 m0, s68, 77824
    s_nop 0
    buffer_load_dwordx4 v7, s[40:43], s78 offen lds
    v_dot2c_f32_bf16 v13, s73, v23
    v_dot2c_f32_bf16 v15, v23, v23
    v_dot2c_f32_bf16 v12, s73, v24
    v_dot2c_f32_bf16 v14, v24, v24
    v_dot2c_f32_bf16 v13, s73, v25
    v_dot2c_f32_bf16 v15, v25, v25
    v_dot2c_f32_bf16 v12, s73, v26
    v_dot2c_f32_bf16 v14, v26, v26
    v_dot2c_f32_bf16 v13, s73, v27
    v_dot2c_f32_bf16 v15, v27, v27
    v_dot2c_f32_bf16 v12, s73, v28
    v_dot2c_f32_bf16 v14, v28, v28
    v_dot2c_f32_bf16 v13, s73, v29
    v_dot2c_f32_bf16 v15, v29, v29
    v_dot2c_f32_bf16 v12, s73, v30
    v_dot2c_f32_bf16 v14, v30, v30
    v_dot2c_f32_bf16 v13, s73, v31
    v_dot2c_f32_bf16 v15, v31, v31
    v_dot2c_f32_bf16 v12, s73, v32
    v_dot2c_f32_bf16 v14, v32, v32
    v_dot2c_f32_bf16 v13, s73, v33
    v_dot2c_f32_bf16 v15, v33, v33
    s_waitcnt vmcnt(14)
    s_barrier
    s_cmp_ge_u32 s33, 5
    s_cbranch_scc1 L_nosx
    s_cmp_lg_u32 s30, 0
    s_cbranch_scc1 L_sig2
    s_lshl_b32 s3, s31, 5
    s_mov_b64 exec, 1
    v_mov_b32 v2, 0
    v_mov_b32_e64 v10, 1
    buffer_atomic_add v10, v2, s[56:59], s3 offen
    s_mov_b64 exec, -1
L_sig2:
L_nosx:
    s_mov_b32 s3, 0
    s_mul_i32 s78, s3, 163840
    s_add_u32 s78, s78, s67
    s_mul_i32 s68, s3, 20480
    s_add_u32 s68, s68, s34
    s_add_u32 m0, s68, 61440
    s_nop 0
    buffer_load_dwordx4 v3, s[40:43], s78 offen lds
    v_dot2c_f32_bf16 v12, s73, v34
    v_dot2c_f32_bf16 v14, v34, v34
    v_dot2c_f32_bf16 v13, s73, v35
    v_dot2c_f32_bf16 v15, v35, v35
    v_dot2c_f32_bf16 v12, s73, v36
    v_dot2c_f32_bf16 v14, v36, v36
    v_dot2c_f32_bf16 v13, s73, v37
    v_dot2c_f32_bf16 v15, v37, v37
    v_dot2c_f32_bf16 v12, s73, v38
    v_dot2c_f32_bf16 v14, v38, v38
    v_dot2c_f32_bf16 v13, s73, v39
    v_dot2c_f32_bf16 v15, v39, v39
    v_dot2c_f32_bf16 v12, s73, v40
    v_dot2c_f32_bf16 v14, v40, v40
    v_dot2c_f32_bf16 v13, s73, v41
    v_dot2c_f32_bf16 v15, v41, v41
    v_dot2c_f32_bf16 v12, s73, v42
    v_dot2c_f32_bf16 v14, v42, v42
    v_dot2c_f32_bf16 v13, s73, v43
    v_dot2c_f32_bf16 v15, v43, v43
    v_dot2c_f32_bf16 v12, s73, v44
    v_dot2c_f32_bf16 v14, v44, v44
    v_dot2c_f32_bf16 v13, s73, v45
    v_dot2c_f32_bf16 v15, v45, v45
    v_dot2c_f32_bf16 v12, s73, v46
    v_dot2c_f32_bf16 v14, v46, v46
    v_dot2c_f32_bf16 v13, s73, v47
    v_dot2c_f32_bf16 v15, v47, v47
    s_add_u32 m0, s68, 65536
    s_nop 0
    buffer_load_dwordx4 v4, s[40:43], s78 offen lds
    v_dot2c_f32_bf16 v12, s73, v48
    v_dot2c_f32_bf16 v14, v48, v48
    v_dot2c_f32_bf16 v13, s73, v49
    v_dot2c_f32_bf16 v15, v49, v49
    v_dot2c_f32_bf16 v12, s73, v50
    v_dot2c_f32_bf16 v14, v50, v50
    v_dot2c_f32_bf16 v13, s73, v51
    v_dot2c_f32_bf16 v15, v51, v51
    v_dot2c_f32_bf16 v12, s73, v52
    v_dot2c_f32_bf16 v14, v52, v52
    v_dot2c_f32_bf16 v13, s73, v53
    v_dot2c_f32_bf16 v15, v53, v53
    v_dot2c_f32_bf16 v12, s73, v54
    v_dot2c_f32_bf16 v14, v54, v54
    v_dot2c_f32_bf16 v13, s73, v55
    v_dot2c_f32_bf16 v15, v55, v55
    v_dot2c_f32_bf16 v12, s73, v56
    v_dot2c_f32_bf16 v14, v56, v56
    v_dot2c_f32_bf16 v13, s73, v57
    v_dot2c_f32_bf16 v15, v57, v57
    v_dot2c_f32_bf16 v12, s73, v58
    v_dot2c_f32_bf16 v14, v58, v58
    v_dot2c_f32_bf16 v13, s73, v59
    v_dot2c_f32_bf16 v15, v59, v59
    v_dot2c_f32_bf16 v12, s73, v60
    v_dot2c_f32_bf16 v14, v60, v60
    v_dot2c_f32_bf16 v13, s73, v61
    v_dot2c_f32_bf16 v15, v61, v61
    v_dot2c_f32_bf16 v12, s73, v62
    s_add_u32 m0, s68, 69632
    s_nop 0
    buffer_load_dwordx4 v5, s[40:43], s78 offen lds
    v_dot2c_f32_bf16 v14, v62, v62
    v_dot2c_f32_bf16 v13, s73, v63
    v_dot2c_f32_bf16 v15, v63, v63
    v_dot2c_f32_bf16 v12, s73, v64
    v_dot2c_f32_bf16 v14, v64, v64
    v_dot2c_f32_bf16 v13, s73, v65
    v_dot2c_f32_bf16 v15, v65, v65
    v_dot2c_f32_bf16 v12, s73, v66
    v_dot2c_f32_bf16 v14, v66, v66
    v_dot2c_f32_bf16 v13, s73, v67
    v_dot2c_f32_bf16 v15, v67, v67
    v_dot2c_f32_bf16 v12, s73, v68
    v_dot2c_f32_bf16 v14, v68, v68
    v_dot2c_f32_bf16 v13, s73, v69
    v_dot2c_f32_bf16 v15, v69, v69
    v_dot2c_f32_bf16 v12, s73, v70
    v_dot2c_f32_bf16 v14, v70, v70
    v_dot2c_f32_bf16 v13, s73, v71
    v_dot2c_f32_bf16 v15, v71, v71
    v_dot2c_f32_bf16 v12, s73, v72
    v_dot2c_f32_bf16 v14, v72, v72
    v_dot2c_f32_bf16 v13, s73, v73
    v_dot2c_f32_bf16 v15, v73, v73
    v_dot2c_f32_bf16 v12, s73, v74
    v_dot2c_f32_bf16 v14, v74, v74
    v_dot2c_f32_bf16 v13, s73, v75
    v_dot2c_f32_bf16 v15, v75, v75
    v_dot2c_f32_bf16 v12, s73, v76
    v_dot2c_f32_bf16 v14, v76, v76
    s_add_u32 m0, s68, 73728
    s_nop 0
    buffer_load_dwordx4 v6, s[40:43], s78 offen lds
    v_dot2c_f32_bf16 v13, s73, v77
    v_dot2c_f32_bf16 v15, v77, v77
    v_dot2c_f32_bf16 v12, s73, v78
    v_dot2c_f32_bf16 v14, v78, v78
    v_dot2c_f32_bf16 v13, s73, v79
    v_dot2c_f32_bf16 v15, v79, v79
    v_dot2c_f32_bf16 v12, s73, v80
    v_dot2c_f32_bf16 v14, v80, v80
    v_dot2c_f32_bf16 v13, s73, v81
    v_dot2c_f32_bf16 v15, v81, v81
    v_dot2c_f32_bf16 v12, s73, v82
    v_dot2c_f32_bf16 v14, v82, v82
    v_dot2c_f32_bf16 v13, s73, v83
    v_dot2c_f32_bf16 v15, v83, v83
    v_dot2c_f32_bf16 v12, s73, v84
    v_dot2c_f32_bf16 v14, v84, v84
    v_dot2c_f32_bf16 v13, s73, v85
    v_dot2c_f32_bf16 v15, v85, v85
    v_dot2c_f32_bf16 v12, s73, v86
    v_dot2c_f32_bf16 v14, v86, v86
    v_dot2c_f32_bf16 v13, s73, v87
    v_dot2c_f32_bf16 v15, v87, v87
    v_dot2c_f32_bf16 v12, s73, v88
    v_dot2c_f32_bf16 v14, v88, v88
    v_dot2c_f32_bf16 v13, s73, v89
    v_dot2c_f32_bf16 v15, v89, v89
    v_dot2c_f32_bf16 v12, s73, v90
    v_dot2c_f32_bf16 v14, v90, v90
    v_dot2c_f32_bf16 v13, s73, v91
    s_add_u32 m0, s68, 77824
    s_nop 0
    buffer_load_dwordx4 v7, s[40:43], s78 offen lds
    v_dot2c_f32_bf16 v15, v91, v91
    v_dot2c_f32_bf16 v12, s73, v92
    v_dot2c_f32_bf16 v14, v92, v92
    v_dot2c_f32_bf16 v13, s73, v93
    v_dot2c_f32_bf16 v15, v93, v93
    v_dot2c_f32_bf16 v12, s73, v94
    v_dot2c_f32_bf16 v14, v94, v94
    v_dot2c_f32_bf16 v13, s73, v95
    v_dot2c_f32_bf16 v15, v95, v95
    s_nop 2
    v_add_f32 v12, v12, v13
    v_add_f32 v14, v14, v15
    v_mov_b32 v10, v12
    s_nop 1
    v_permlane32_swap_b32 v12, v10
    s_nop 1
    v_add_f32 v12, v12, v10
    v_mov_b32 v10, v12
    s_nop 1
    v_permlane16_swap_b32 v12, v10
    s_nop 1
    v_add_f32 v12, v12, v10
    v_mov_b32 v10, v14
    s_nop 1
    v_permlane32_swap_b32 v14, v10
    s_nop 1
    v_add_f32 v14, v14, v10
    v_mov_b32 v10, v14
    s_nop 1
    s_add_u32 m0, s34, 0
    s_nop 0
    buffer_load_dwordx4 v11, s[44:47], s79 offen lds
    v_permlane16_swap_b32 v14, v10
    s_nop 1
    v_add_f32 v14, v14, v10
    v_mul_f32 v12, 0x3acccccd, v12
    v_mul_f32 v14, 0x3acccccd, v14
    v_fma_f32 v14, -v12, v12, v14
    v_max_f32_e64 v14, 0, v14
    v_add_f32 v14, 0x3727c5ac, v14
    v_rsq_f32 v14, v14
    s_nop 0
    v_mov_b32 v15, v14
    v_mul_f32 v12, -v12, v14
    v_mov_b32 v13, v12
    v_pk_fma_f32 v[96:97], v[96:97], v[14:15], v[12:13]
    v_cvt_pk_bf16_f32 v96, v96, v97
    v_pk_fma_f32 v[98:99], v[98:99], v[14:15], v[12:13]
    v_cvt_pk_bf16_f32 v97, v98, v99
    v_pk_fma_f32 v[100:101], v[100:101], v[14:15], v[12:13]
    v_cvt_pk_bf16_f32 v98, v100, v101
    v_pk_fma_f32 v[102:103], v[102:103], v[14:15], v[12:13]
    v_cvt_pk_bf16_f32 v99, v102, v103
    v_pk_fma_f32 v[104:105], v[104:105], v[14:15], v[12:13]
    v_cvt_pk_bf16_f32 v100, v104, v105
    v_pk_fma_f32 v[106:107], v[106:107], v[14:15], v[12:13]
    v_cvt_pk_bf16_f32 v101, v106, v107
    v_pk_fma_f32 v[108:109], v[108:109], v[14:15], v[12:13]
    v_cvt_pk_bf16_f32 v102, v108, v109
    v_pk_fma_f32 v[110:111], v[110:111], v[14:15], v[12:13]
    s_add_u32 m0, s34, 3968
    s_nop 0
    buffer_load_dwordx4 v11, s[44:47], s79 offen offset:128 lds
    v_cvt_pk_bf16_f32 v103, v110, v111
    s_nop 0
    v_pk_fma_f32 v[112:113], v[112:113], v[14:15], v[12:13]
    v_cvt_pk_bf16_f32 v104, v112, v113
    v_pk_fma_f32 v[114:115], v[114:115], v[14:15], v[12:13]
    v_cvt_pk_bf16_f32 v105, v114, v115
    v_pk_fma_f32 v[116:117], v[116:117], v[14:15], v[12:13]
    v_cvt_pk_bf16_f32 v106, v116, v117
    v_pk_fma_f32 v[118:119], v[118:119], v[14:15], v[12:13]
    v_cvt_pk_bf16_f32 v107, v118, v119
    v_pk_fma_f32 v[120:121], v[120:121], v[14:15], v[12:13]
    v_cvt_pk_bf16_f32 v108, v120, v121
    v_pk_fma_f32 v[122:123], v[122:123], v[14:15], v[12:13]
    v_cvt_pk_bf16_f32 v109, v122, v123
    v_pk_fma_f32 v[124:125], v[124:125], v[14:15], v[12:13]
    v_cvt_pk_bf16_f32 v110, v124, v125
    v_pk_fma_f32 v[126:127], v[126:127], v[14:15], v[12:13]
    v_cvt_pk_bf16_f32 v111, v126, v127
    v_pk_fma_f32 v[128:129], v[128:129], v[14:15], v[12:13]
    v_cvt_pk_bf16_f32 v112, v128, v129
    v_pk_fma_f32 v[130:131], v[130:131], v[14:15], v[12:13]
    v_cvt_pk_bf16_f32 v113, v130, v131
    v_pk_fma_f32 v[132:133], v[132:133], v[14:15], v[12:13]
    v_cvt_pk_bf16_f32 v114, v132, v133
    v_pk_fma_f32 v[134:135], v[134:135], v[14:15], v[12:13]
    v_cvt_pk_bf16_f32 v115, v134, v135
    v_pk_fma_f32 v[136:137], v[136:137], v[14:15], v[12:13]
    v_cvt_pk_bf16_f32 v116, v136, v137
    v_pk_fma_f32 v[138:139], v[138:139], v[14:15], v[12:13]
    v_cvt_pk_bf16_f32 v117, v138, v139
    s_add_u32 m0, s34, 7936
    s_nop 0
    buffer_load_dwordx4 v11, s[44:47], s79 offen offset:256 lds
    v_pk_fma_f32 v[140:141], v[140:141], v[14:15], v[12:13]
    s_nop 0
    v_cvt_pk_bf16_f32 v118, v140, v141
    v_pk_fma_f32 v[142:143], v[142:143], v[14:15], v[12:13]
    v_cvt_pk_bf16_f32 v119, v142, v143
    v_pk_fma_f32 v[144:145], v[144:145], v[14:15], v[12:13]
    v_cvt_pk_bf16_f32 v120, v144, v145
    v_pk_fma_f32 v[146:147], v[146:147], v[14:15], v[12:13]
    v_cvt_pk_bf16_f32 v121, v146, v147
    v_pk_fma_f32 v[148:149], v[148:149], v[14:15], v[12:13]
    v_cvt_pk_bf16_f32 v122, v148, v149
    v_pk_fma_f32 v[150:151], v[150:151], v[14:15], v[12:13]
    v_cvt_pk_bf16_f32 v123, v150, v151
    v_pk_fma_f32 v[152:153], v[152:153], v[14:15], v[12:13]
    v_cvt_pk_bf16_f32 v124, v152, v153
    v_pk_fma_f32 v[154:155], v[154:155], v[14:15], v[12:13]
    v_cvt_pk_bf16_f32 v125, v154, v155
    v_pk_fma_f32 v[156:157], v[156:157], v[14:15], v[12:13]
    v_cvt_pk_bf16_f32 v126, v156, v157
    v_pk_fma_f32 v[158:159], v[158:159], v[14:15], v[12:13]
    v_cvt_pk_bf16_f32 v127, v158, v159
    v_pk_fma_f32 v[160:161], v[160:161], v[14:15], v[12:13]
    v_cvt_pk_bf16_f32 v128, v160, v161
    v_pk_fma_f32 v[162:163], v[162:163], v[14:15], v[12:13]
    v_cvt_pk_bf16_f32 v129, v162, v163
    v_pk_fma_f32 v[164:165], v[164:165], v[14:15], v[12:13]
    v_cvt_pk_bf16_f32 v130, v164, v165
    v_pk_fma_f32 v[166:167], v[166:167], v[14:15], v[12:13]
    v_cvt_pk_bf16_f32 v131, v166, v167
    v_pk_fma_f32 v[168:169], v[168:169], v[14:15], v[12:13]
    s_add_u32 s79, s79, 393216
    s_add_u32 m0, s34, 12288
    s_nop 0
    buffer_load_dwordx4 v11, s[44:47], s79 offen lds
    s_nop 0
    v_cvt_pk_bf16_f32 v132, v168, v169
    v_pk_fma_f32 v[170:171], v[170:171], v[14:15], v[12:13]
    v_cvt_pk_bf16_f32 v133, v170, v171
    v_pk_fma_f32 v[172:173], v[172:173], v[14:15], v[12:13]
    v_cvt_pk_bf16_f32 v134, v172, v173
    v_pk_fma_f32 v[174:175], v[174:175], v[14:15], v[12:13]
    v_cvt_pk_bf16_f32 v135, v174, v175
    v_pk_fma_f32 v[176:177], v[176:177], v[14:15], v[12:13]
    v_cvt_pk_bf16_f32 v136, v176, v177
    v_pk_fma_f32 v[178:179], v[178:179], v[14:15], v[12:13]
    v_cvt_pk_bf16_f32 v137, v178, v179
    v_pk_fma_f32 v[180:181], v[180:181], v[14:15], v[12:13]
    v_cvt_pk_bf16_f32 v138, v180, v181
    v_pk_fma_f32 v[182:183], v[182:183], v[14:15], v[12:13]
    v_cvt_pk_bf16_f32 v139, v182, v183
    v_pk_fma_f32 v[184:185], v[184:185], v[14:15], v[12:13]
    v_cvt_pk_bf16_f32 v140, v184, v185
    v_pk_fma_f32 v[186:187], v[186:187], v[14:15], v[12:13]
    v_cvt_pk_bf16_f32 v141, v186, v187
    v_pk_fma_f32 v[188:189], v[188:189], v[14:15], v[12:13]
    v_cvt_pk_bf16_f32 v142, v188, v189
    v_pk_fma_f32 v[190:191], v[190:191], v[14:15], v[12:13]
    v_cvt_pk_bf16_f32 v143, v190, v191
    v_pk_fma_f32 v[192:193], v[192:193], v[14:15], v[12:13]
    v_cvt_pk_bf16_f32 v144, v192, v193
    v_pk_fma_f32 v[194:195], v[194:195], v[14:15], v[12:13]
    v_cvt_pk_bf16_f32 v145, v194, v195
    v_pk_fma_f32 v[196:197], v[196:197], v[14:15], v[12:13]
    v_cvt_pk_bf16_f32 v146, v196, v197
    s_add_u32 m0, s34, 16256
    s_nop 0
    buffer_load_dwordx4 v11, s[44:47], s79 offen offset:128 lds
    s_nop 0
    v_pk_fma_f32 v[198:199], v[198:199], v[14:15], v[12:13]
    v_cvt_pk_bf16_f32 v147, v198, v199
    v_pk_fma_f32 v[200:201], v[200:201], v[14:15], v[12:13]
    v_cvt_pk_bf16_f32 v148, v200, v201
    v_pk_fma_f32 v[202:203], v[202:203], v[14:15], v[12:13]
    v_cvt_pk_bf16_f32 v149, v202, v203
    v_pk_fma_f32 v[204:205], v[204:205], v[14:15], v[12:13]
    v_cvt_pk_bf16_f32 v150, v204, v205
    v_pk_fma_f32 v[206:207], v[206:207], v[14:15], v[12:13]
    v_cvt_pk_bf16_f32 v151, v206, v207
    v_pk_fma_f32 v[208:209], v[208:209], v[14:15], v[12:13]
    v_cvt_pk_bf16_f32 v152, v208, v209
    v_pk_fma_f32 v[210:211], v[210:211], v[14:15], v[12:13]
    v_cvt_pk_bf16_f32 v153, v210, v211
    v_pk_fma_f32 v[212:213], v[212:213], v[14:15], v[12:13]
    v_cvt_pk_bf16_f32 v154, v212, v213
    v_pk_fma_f32 v[214:215], v[214:215], v[14:15], v[12:13]
    v_cvt_pk_bf16_f32 v155, v214, v215
    v_pk_fma_f32 v[216:217], v[216:217], v[14:15], v[12:13]
    v_cvt_pk_bf16_f32 v156, v216, v217
    v_pk_fma_f32 v[218:219], v[218:219], v[14:15], v[12:13]
    v_cvt_pk_bf16_f32 v157, v218, v219
    v_pk_fma_f32 v[220:221], v[220:221], v[14:15], v[12:13]
    v_cvt_pk_bf16_f32 v158, v220, v221
    v_pk_fma_f32 v[222:223], v[222:223], v[14:15], v[12:13]
    v_cvt_pk_bf16_f32 v159, v222, v223
    v_pk_fma_f32 v[224:225], v[224:225], v[14:15], v[12:13]
    v_cvt_pk_bf16_f32 v160, v224, v225
    v_pk_fma_f32 v[226:227], v[226:227], v[14:15], v[12:13]
    s_add_u32 m0, s34, 20224
    s_nop 0
    buffer_load_dwordx4 v11, s[44:47], s79 offen offset:256 lds
    s_nop 0
    v_cvt_pk_bf16_f32 v161, v226, v227
    v_pk_fma_f32 v[228:229], v[228:229], v[14:15], v[12:13]
    v_cvt_pk_bf16_f32 v162, v228, v229
    v_pk_fma_f32 v[230:231], v[230:231], v[14:15], v[12:13]
    v_cvt_pk_bf16_f32 v163, v230, v231
    v_pk_fma_f32 v[232:233], v[232:233], v[14:15], v[12:13]
    v_cvt_pk_bf16_f32 v164, v232, v233
    v_pk_fma_f32 v[234:235], v[234:235], v[14:15], v[12:13]
    v_cvt_pk_bf16_f32 v165, v234, v235
    v_pk_fma_f32 v[236:237], v[236:237], v[14:15], v[12:13]
    v_cvt_pk_bf16_f32 v166, v236, v237
    v_pk_fma_f32 v[238:239], v[238:239], v[14:15], v[12:13]
    v_cvt_pk_bf16_f32 v167, v238, v239
    v_pk_fma_f32 v[240:241], v[240:241], v[14:15], v[12:13]
    v_cvt_pk_bf16_f32 v168, v240, v241
    v_pk_fma_f32 v[242:243], v[242:243], v[14:15], v[12:13]
    v_cvt_pk_bf16_f32 v169, v242, v243
    v_pk_fma_f32 v[244:245], v[244:245], v[14:15], v[12:13]
    v_cvt_pk_bf16_f32 v170, v244, v245
    v_pk_fma_f32 v[246:247], v[246:247], v[14:15], v[12:13]
    v_cvt_pk_bf16_f32 v171, v246, v247
    v_pk_fma_f32 v[248:249], v[248:249], v[14:15], v[12:13]
    v_cvt_pk_bf16_f32 v172, v248, v249
    v_pk_fma_f32 v[250:251], v[250:251], v[14:15], v[12:13]
    v_cvt_pk_bf16_f32 v173, v250, v251
    v_pk_fma_f32 v[252:253], v[252:253], v[14:15], v[12:13]
    v_cvt_pk_bf16_f32 v174, v252, v253
    v_pk_fma_f32 v[254:255], v[254:255], v[14:15], v[12:13]
    v_cvt_pk_bf16_f32 v175, v254, v255
    s_mul_i32 s3, s83, 10240
    v_add_u32 v16, s3, v8
    s_add_u32 s3, s3, 10240
    s_cmp_eq_u32 s3, 102400
    s_cselect_b32 s3, 0, s3
    v_add_u32 v17, s3, v8
    s_add_u32 s3, s3, 10240
    s_cmp_eq_u32 s3, 102400
    s_cselect_b32 s3, 0, s3
    v_add_u32_e64 v18, s3, v8
    s_add_u32 s3, s3, 10240
    s_cmp_eq_u32 s3, 102400
    s_cselect_b32 s3, 0, s3
    v_add_u32 v19, s3, v8
    s_add_u32 s3, s3, 10240
    s_cmp_eq_u32 s3, 102400
    s_cselect_b32 s3, 0, s3
    v_add_u32 v20, s3, v8
    s_add_u32 s3, s3, 10240
    s_cmp_eq_u32 s3, 102400
    s_cselect_b32 s3, 0, s3
    v_add_u32 v21, s3, v8
    s_add_u32 s3, s3, 10240
    s_cmp_eq_u32 s3, 102400
    s_cselect_b32 s3, 0, s3
    v_add_u32 v22, s3, v8
    s_add_u32 s3, s3, 10240
    s_cmp_eq_u32 s3, 102400
    s_cselect_b32 s3, 0, s3
    v_add_u32 v23, s3, v8
    s_add_u32 s3, s3, 10240
    s_cmp_eq_u32 s3, 102400
    s_cselect_b32 s3, 0, s3
    v_add_u32 v24, s3, v8
    s_add_u32 s3, s3, 10240
    s_cmp_eq_u32 s3, 102400
    s_cselect_b32 s3, 0, s3
    v_add_u32 v25, s3, v8
    s_lshl_b32 s78, s33, 5
    v_mov_b32 v14, 0
    s_lshl_b32 s80, s33, 2
    s_add_u32 s80, s80, s30
    s_mul_i32 s80, s80, 81920
    s_add_u32 s3, s32, 0
    s_and_b32 s3, s3, 3
    s_mul_i32 s3, s3, 20480
    v_add_u32_e64 v60, s3, v1
    s_add_u32 s3, s32, 1
    s_and_b32 s3, s3, 3
    s_mul_i32 s3, s3, 20480
    v_add_u32_e64 v61, s3, v1
    s_add_u32 s3, s32, 2
    s_and_b32 s3, s3, 3
    s_mul_i32 s3, s3, 20480
    v_add_u32_e64 v62, s3, v1
    s_add_u32 s3, s32, 3
    s_and_b32 s3, s3, 3
    s_mul_i32 s3, s3, 20480
    v_add_u32_e64 v63, s3, v1
    v_lshrrev_b32_e64 v12, 6, v1
    v_bfe_u32 v13, v1, 7, 2
    v_bfe_u32 v54, v1, 4, 2
    v_lshlrev_b32_e64 v13, 1, v13
    v_xor_b32 v13, v13, v54
    v_lshlrev_b32_e64 v13, 4, v13
    v_lshl_add_u32 v48, v12, 7, v13
    v_xor_b32_e64 v49, 64, v48
    s_waitcnt vmcnt(6)
    s_barrier
    s_mul_i32 s69, s33, 786432
    s_add_u32 s69, s69, s71
    s_add_u32 s69, s69, 1572864
    ds_read_b64_tr_b16 v[196:197], v16 offset:0
    ds_read_b64_tr_b16 v[198:199], v16 offset:2560
    ds_read_b64_tr_b16 v[200:201], v16 offset:5120
    ds_read_b64_tr_b16 v[202:203], v16 offset:7680
    ds_read_b64_tr_b16 v[204:205], v17 offset:0
    ds_read_b64_tr_b16 v[206:207], v17 offset:2560
    ds_read_b64_tr_b16 v[208:209], v17 offset:5120
    ds_read_b64_tr_b16 v[210:211], v17 offset:7680
    ds_read_b64_tr_b16 v[212:213], v17 offset:5152
    ds_read_b64_tr_b16 v[214:215], v17 offset:7712
    ds_read_b64_tr_b16 v[216:217], v17 offset:32
    ds_read_b64_tr_b16 v[218:219], v17 offset:2592
    ds_read_b64_tr_b16 v[220:221], v16 offset:5152
    ds_read_b64_tr_b16 v[222:223], v16 offset:7712
    ds_read_b64_tr_b16 v[224:225], v16 offset:32
    ds_read_b64_tr_b16 v[226:227], v16 offset:2592
    ds_read_b64_tr_b16 v[228:229], v16 offset:64
    ds_read_b64_tr_b16 v[230:231], v16 offset:2624
    s_waitcnt lgkmcnt(15)
    v_mfma_f32_16x16x32_bf16 a[100:103], v[196:199], v[96:99], 0
    s_waitcnt lgkmcnt(14)
    s_add_u32 s79, s79, 393216
    s_add_u32 m0, s34, 24576
    ds_read_b64_tr_b16 v[232:233], v16 offset:5184
    ds_read_b64_tr_b16 v[234:235], v16 offset:7744
    buffer_load_dwordx4 v11, s[44:47], s79 offen lds
    v_mfma_f32_16x16x32_bf16 a[100:103], v[200:203], v[100:103], a[100:103]
    s_waitcnt lgkmcnt(14)
    ds_read_b64_tr_b16 v[236:237], v17 offset:64
    ds_read_b64_tr_b16 v[238:239], v17 offset:2624
    v_mfma_f32_16x16x32_bf16 a[100:103], v[204:207], v[104:107], a[100:103]
    s_waitcnt lgkmcnt(14)
    ds_read_b64_tr_b16 v[240:241], v17 offset:5184
    ds_read_b64_tr_b16 v[242:243], v17 offset:7744
    v_mfma_f32_16x16x32_bf16 a[100:103], v[208:211], v[108:111], a[100:103]
    s_waitcnt lgkmcnt(14)
    ds_read_b64_tr_b16 v[196:197], v17 offset:5216
    ds_read_b64_tr_b16 v[198:199], v17 offset:7776
    v_mfma_f32_16x16x32_bf16 a[104:107], v[212:215], v[108:111], 0
    s_waitcnt lgkmcnt(14)
    s_add_u32 m0, s34, 28544
    ds_read_b64_tr_b16 v[200:201], v17 offset:96
    ds_read_b64_tr_b16 v[202:203], v17 offset:2656
    buffer_load_dwordx4 v11, s[44:47], s79 offen offset:128 lds
    v_mfma_f32_16x16x32_bf16 a[104:107], v[216:219], v[104:107], a[104:107]
    s_waitcnt lgkmcnt(10)
    ds_read_b64_tr_b16 v[204:205], v16 offset:5216
    s_nop 0
    ds_read_b64_tr_b16 v[206:207], v16 offset:7776
    v_mfma_f32_16x16x32_bf16 a[104:107], v[220:223], v[100:103], a[104:107]
    ds_read_b64_tr_b16 v[208:209], v16 offset:96
    ds_read_b64_tr_b16 v[210:211], v16 offset:2656
    v_mfma_f32_16x16x32_bf16 a[104:107], v[224:227], v[96:99], a[104:107]
    s_nop 0
    ds_read_b64_tr_b16 v[212:213], v16 offset:128
    ds_read_b64_tr_b16 v[214:215], v16 offset:2688
    v_mfma_f32_16x16x32_bf16 a[108:111], v[228:231], v[96:99], 0
    s_waitcnt lgkmcnt(10)
    s_add_u32 m0, s34, 32512
    ds_read_b64_tr_b16 v[216:217], v16 offset:5248
    ds_read_b64_tr_b16 v[218:219], v16 offset:7808
    buffer_load_dwordx4 v11, s[44:47], s79 offen offset:256 lds
    v_mfma_f32_16x16x32_bf16 a[108:111], v[232:235], v[100:103], a[108:111]
    ds_read_b64_tr_b16 v[220:221], v17 offset:128
    ds_read_b64_tr_b16 v[222:223], v17 offset:2688
    v_mfma_f32_16x16x32_bf16 a[108:111], v[236:239], v[104:107], a[108:111]
    s_nop 0
    ds_read_b64_tr_b16 v[224:225], v17 offset:5248
    ds_read_b64_tr_b16 v[226:227], v17 offset:7808
    v_mfma_f32_16x16x32_bf16 a[108:111], v[240:243], v[108:111], a[108:111]
    s_waitcnt lgkmcnt(10)
    s_add_u32 s79, s79, 393216
    ds_read_b64_tr_b16 v[228:229], v18 offset:0
    ds_read_b64_tr_b16 v[230:231], v18 offset:2560
    v_mfma_f32_16x16x32_bf16 a[112:115], v[196:199], v[108:111], 0
    s_add_u32 m0, s34, 36864
    ds_read_b64_tr_b16 v[232:233], v18 offset:5120
    ds_read_b64_tr_b16 v[234:235], v18 offset:7680
    buffer_load_dwordx4 v11, s[44:47], s79 offen lds
    v_mfma_f32_16x16x32_bf16 a[112:115], v[200:203], v[104:107], a[112:115]
    ds_read_b64_tr_b16 v[236:237], v19 offset:0
    ds_read_b64_tr_b16 v[238:239], v19 offset:2560
    v_mfma_f32_16x16x32_bf16 a[112:115], v[204:207], v[100:103], a[112:115]
    s_waitcnt lgkmcnt(10)
    ds_read_b64_tr_b16 v[240:241], v19 offset:5120
    ds_read_b64_tr_b16 v[242:243], v19 offset:7680
    v_mfma_f32_16x16x32_bf16 a[112:115], v[208:211], v[96:99], a[112:115]
    s_nop 0
    ds_read_b64_tr_b16 v[196:197], v19 offset:5152
    ds_read_b64_tr_b16 v[198:199], v19 offset:7712
    v_mfma_f32_16x16x32_bf16 a[116:119], v[212:215], v[96:99], 0
    s_add_u32 m0, s34, 40832
    ds_read_b64_tr_b16 v[200:201], v19 offset:32
    ds_read_b64_tr_b16 v[202:203], v19 offset:2592
    buffer_load_dwordx4 v11, s[44:47], s79 offen offset:128 lds
    v_mfma_f32_16x16x32_bf16 a[116:119], v[216:219], v[100:103], a[116:119]
    s_waitcnt lgkmcnt(10)
    ds_read_b64_tr_b16 v[204:205], v18 offset:5152
    ds_read_b64_tr_b16 v[206:207], v18 offset:7712
    v_mfma_f32_16x16x32_bf16 a[116:119], v[220:223], v[104:107], a[116:119]
    s_nop 0
    ds_read_b64_tr_b16 v[208:209], v18 offset:32
    ds_read_b64_tr_b16 v[210:211], v18 offset:2592
    v_mfma_f32_16x16x32_bf16 a[116:119], v[224:227], v[108:111], a[116:119]
    ds_read_b64_tr_b16 v[212:213], v18 offset:64
    ds_read_b64_tr_b16 v[214:215], v18 offset:2624
    v_mfma_f32_16x16x32_bf16 a[100:103], v[228:231], v[112:115], a[100:103]
    s_waitcnt lgkmcnt(10)
    s_nop 0
    s_add_u32 m0, s34, 44800
    ds_read_b64_tr_b16 v[216:217], v18 offset:5184
    ds_read_b64_tr_b16 v[218:219], v18 offset:7744
    buffer_load_dwordx4 v11, s[44:47], s79 offen offset:256 lds
    v_mfma_f32_16x16x32_bf16 a[100:103], v[232:235], v[116:119], a[100:103]
    ds_read_b64_tr_b16 v[220:221], v19 offset:64
    ds_read_b64_tr_b16 v[222:223], v19 offset:2624
    v_mfma_f32_16x16x32_bf16 a[100:103], v[236:239], v[120:123], a[100:103]
    ds_read_b64_tr_b16 v[224:225], v19 offset:5184
    ds_read_b64_tr_b16 v[226:227], v19 offset:7744
    v_mfma_f32_16x16x32_bf16 a[100:103], v[240:243], v[124:127], a[100:103]
    s_waitcnt lgkmcnt(10)
    s_nop 0
    ds_read_b64_tr_b16 v[228:229], v19 offset:5216
    ds_read_b64_tr_b16 v[230:231], v19 offset:7776
    v_mfma_f32_16x16x32_bf16 a[104:107], v[196:199], v[124:127], a[104:107]
    ds_read_b64_tr_b16 v[232:233], v19 offset:96
    ds_read_b64_tr_b16 v[234:235], v19 offset:2656
    v_mfma_f32_16x16x32_bf16 a[104:107], v[200:203], v[120:123], a[104:107]
    ds_read_b64_tr_b16 v[236:237], v18 offset:5216
    ds_read_b64_tr_b16 v[238:239], v18 offset:7776
    v_mfma_f32_16x16x32_bf16 a[104:107], v[204:207], v[116:119], a[104:107]
    s_waitcnt lgkmcnt(10)
    ds_read_b64_tr_b16 v[240:241], v18 offset:96
    ds_read_b64_tr_b16 v[242:243], v18 offset:2656
    v_mfma_f32_16x16x32_bf16 a[104:107], v[208:211], v[112:115], a[104:107]
    s_nop 0
    ds_read_b64_tr_b16 v[196:197], v18 offset:128
    ds_read_b64_tr_b16 v[198:199], v18 offset:2688
    v_mfma_f32_16x16x32_bf16 a[108:111], v[212:215], v[112:115], a[108:111]
    ds_read_b64_tr_b16 v[200:201], v18 offset:5248
    ds_read_b64_tr_b16 v[202:203], v18 offset:7808
    buffer_load_dword v15, v14, s[56:59], s78 offen sc1
    v_mfma_f32_16x16x32_bf16 a[108:111], v[216:219], v[116:119], a[108:111]
    s_nop 0
    s_waitcnt lgkmcnt(10)
    ds_read_b64_tr_b16 v[204:205], v19 offset:128
    ds_read_b64_tr_b16 v[206:207], v19 offset:2688
    v_mfma_f32_16x16x32_bf16 a[108:111], v[220:223], v[120:123], a[108:111]
    ds_read_b64_tr_b16 v[208:209], v19 offset:5248
    ds_read_b64_tr_b16 v[210:211], v19 offset:7808
    buffer_load_dword v9, v9, s[44:47], s69 offen
    v_mfma_f32_16x16x32_bf16 a[108:111], v[224:227], v[124:127], a[108:111]
    ds_read_b64_tr_b16 v[212:213], v20 offset:0
    ds_read_b64_tr_b16 v[214:215], v20 offset:2560
    v_mfma_f32_16x16x32_bf16 a[112:115], v[228:231], v[124:127], a[112:115]
    s_waitcnt lgkmcnt(10)
    s_nop 0
    ds_read_b64_tr_b16 v[216:217], v20 offset:5120
    ds_read_b64_tr_b16 v[218:219], v20 offset:7680
    v_mfma_f32_16x16x32_bf16 a[112:115], v[232:235], v[120:123], a[112:115]
    ds_read_b64_tr_b16 v[220:221], v21 offset:0
    ds_read_b64_tr_b16 v[222:223], v21 offset:2560
    v_mfma_f32_16x16x32_bf16 a[112:115], v[236:239], v[116:119], a[112:115]
    ds_read_b64_tr_b16 v[224:225], v21 offset:5120
    ds_read_b64_tr_b16 v[226:227], v21 offset:7680
    v_mfma_f32_16x16x32_bf16 a[112:115], v[240:243], v[112:115], a[112:115]
    s_waitcnt lgkmcnt(10)
    ds_read_b64_tr_b16 v[228:229], v21 offset:5152
    ds_read_b64_tr_b16 v[230:231], v21 offset:7712
    v_mfma_f32_16x16x32_bf16 a[116:119], v[196:199], v[112:115], a[116:119]
    s_nop 0
    ds_read_b64_tr_b16 v[232:233], v21 offset:32
    ds_read_b64_tr_b16 v[234:235], v21 offset:2592
    v_mfma_f32_16x16x32_bf16 a[116:119], v[200:203], v[116:119], a[116:119]
    ds_read_b64_tr_b16 v[236:237], v20 offset:5152
    ds_read_b64_tr_b16 v[238:239], v20 offset:7712
    v_mfma_f32_16x16x32_bf16 a[116:119], v[204:207], v[120:123], a[116:119]
    s_waitcnt lgkmcnt(10)
    s_nop 0
    ds_read_b64_tr_b16 v[240:241], v20 offset:32
    ds_read_b64_tr_b16 v[242:243], v20 offset:2592
    v_mfma_f32_16x16x32_bf16 a[116:119], v[208:211], v[124:127], a[116:119]
    ds_read_b64_tr_b16 v[196:197], v20 offset:64
    ds_read_b64_tr_b16 v[198:199], v20 offset:2624
    v_mfma_f32_16x16x32_bf16 a[100:103], v[212:215], v[128:131], a[100:103]
    ds_read_b64_tr_b16 v[200:201], v20 offset:5184
    ds_read_b64_tr_b16 v[202:203], v20 offset:7744
    v_mfma_f32_16x16x32_bf16 a[100:103], v[216:219], v[132:135], a[100:103]
    s_waitcnt lgkmcnt(10)
    ds_read_b64_tr_b16 v[204:205], v21 offset:64
    ds_read_b64_tr_b16 v[206:207], v21 offset:2624
    v_mfma_f32_16x16x32_bf16 a[100:103], v[220:223], v[136:139], a[100:103]
    s_nop 0
    ds_read_b64_tr_b16 v[208:209], v21 offset:5184
    ds_read_b64_tr_b16 v[210:211], v21 offset:7744
    v_mfma_f32_16x16x32_bf16 a[100:103], v[224:227], v[140:143], a[100:103]
    ds_read_b64_tr_b16 v[212:213], v21 offset:5216
    ds_read_b64_tr_b16 v[214:215], v21 offset:7776
    v_mfma_f32_16x16x32_bf16 a[104:107], v[228:231], v[140:143], a[104:107]
    s_waitcnt lgkmcnt(10)
    s_nop 0
    ds_read_b64_tr_b16 v[216:217], v21 offset:96
    ds_read_b64_tr_b16 v[218:219], v21 offset:2656
    v_mfma_f32_16x16x32_bf16 a[104:107], v[232:235], v[136:139], a[104:107]
    ds_read_b64_tr_b16 v[220:221], v20 offset:5216
    ds_read_b64_tr_b16 v[222:223], v20 offset:7776
    v_mfma_f32_16x16x32_bf16 a[104:107], v[236:239], v[132:135], a[104:107]
    ds_read_b64_tr_b16 v[224:225], v20 offset:96
    ds_read_b64_tr_b16 v[226:227], v20 offset:2656
    v_mfma_f32_16x16x32_bf16 a[104:107], v[240:243], v[128:131], a[104:107]
    s_waitcnt lgkmcnt(10)
    ds_read_b64_tr_b16 v[228:229], v20 offset:128
    ds_read_b64_tr_b16 v[230:231], v20 offset:2688
    v_mfma_f32_16x16x32_bf16 a[108:111], v[196:199], v[128:131], a[108:111]
    s_nop 0
    ds_read_b64_tr_b16 v[232:233], v20 offset:5248
    ds_read_b64_tr_b16 v[234:235], v20 offset:7808
    v_mfma_f32_16x16x32_bf16 a[108:111], v[200:203], v[132:135], a[108:111]
    ds_read_b64_tr_b16 v[236:237], v21 offset:128
    ds_read_b64_tr_b16 v[238:239], v21 offset:2688
    v_mfma_f32_16x16x32_bf16 a[108:111], v[204:207], v[136:139], a[108:111]
    s_waitcnt lgkmcnt(10)
    s_nop 0
    ds_read_b64_tr_b16 v[240:241], v21 offset:5248
    ds_read_b64_tr_b16 v[242:243], v21 offset:7808
    v_mfma_f32_16x16x32_bf16 a[108:111], v[208:211], v[140:143], a[108:111]
    ds_read_b64_tr_b16 v[196:197], v22 offset:0
    ds_read_b64_tr_b16 v[198:199], v22 offset:2560
    v_mfma_f32_16x16x32_bf16 a[112:115], v[212:215], v[140:143], a[112:115]
    ds_read_b64_tr_b16 v[200:201], v22 offset:5120
    ds_read_b64_tr_b16 v[202:203], v22 offset:7680
    v_mfma_f32_16x16x32_bf16 a[112:115], v[216:219], v[136:139], a[112:115]
    s_waitcnt lgkmcnt(10)
    ds_read_b64_tr_b16 v[204:205], v23 offset:0
    ds_read_b64_tr_b16 v[206:207], v23 offset:2560
    v_mfma_f32_16x16x32_bf16 a[112:115], v[220:223], v[132:135], a[112:115]
    s_nop 0
    ds_read_b64_tr_b16 v[208:209], v23 offset:5120
    ds_read_b64_tr_b16 v[210:211], v23 offset:7680
    v_mfma_f32_16x16x32_bf16 a[112:115], v[224:227], v[128:131], a[112:115]
    ds_read_b64_tr_b16 v[212:213], v23 offset:5152
    ds_read_b64_tr_b16 v[214:215], v23 offset:7712
    v_mfma_f32_16x16x32_bf16 a[116:119], v[228:231], v[128:131], a[116:119]
    s_waitcnt lgkmcnt(10)
    s_nop 0
    ds_read_b64_tr_b16 v[216:217], v23 offset:32
    ds_read_b64_tr_b16 v[218:219], v23 offset:2592
    v_mfma_f32_16x16x32_bf16 a[116:119], v[232:235], v[132:135], a[116:119]
    ds_read_b64_tr_b16 v[220:221], v22 offset:5152
    ds_read_b64_tr_b16 v[222:223], v22 offset:7712
    v_mfma_f32_16x16x32_bf16 a[116:119], v[236:239], v[136:139], a[116:119]
    ds_read_b64_tr_b16 v[224:225], v22 offset:32
    ds_read_b64_tr_b16 v[226:227], v22 offset:2592
    v_mfma_f32_16x16x32_bf16 a[116:119], v[240:243], v[140:143], a[116:119]
    s_waitcnt lgkmcnt(10)
    ds_read_b64_tr_b16 v[228:229], v22 offset:64
    ds_read_b64_tr_b16 v[230:231], v22 offset:2624
    v_mfma_f32_16x16x32_bf16 a[100:103], v[196:199], v[144:147], a[100:103]
    s_nop 0
    ds_read_b64_tr_b16 v[232:233], v22 offset:5184
    ds_read_b64_tr_b16 v[234:235], v22 offset:7744
    v_mfma_f32_16x16x32_bf16 a[100:103], v[200:203], v[148:151], a[100:103]
    ds_read_b64_tr_b16 v[236:237], v23 offset:64
    ds_read_b64_tr_b16 v[238:239], v23 offset:2624
    v_mfma_f32_16x16x32_bf16 a[100:103], v[204:207], v[152:155], a[100:103]
    s_waitcnt vmcnt(1)
    v_cmp_gt_u32 vcc, 20, v15
    s_cbranch_vccnz L_slow3
L_ok3:
    s_waitcnt lgkmcnt(10)
    v_mfma_f32_16x16x32_bf16 a[100:103], v[208:211], v[156:159], a[100:103]
    ds_read_b64_tr_b16 v[240:241], v23 offset:5184
    ds_read_b64_tr_b16 v[242:243], v23 offset:7744
    buffer_load_dwordx4 a[224:227], v60, s[48:51], s80 offen sc1
    v_mfma_f32_16x16x32_bf16 a[104:107], v[212:215], v[156:159], a[104:107]
    ds_read_b64_tr_b16 v[196:197], v23 offset:5216
    ds_read_b64_tr_b16 v[198:199], v23 offset:7776
    v_mfma_f32_16x16x32_bf16 a[104:107], v[216:219], v[152:155], a[104:107]
    s_waitcnt lgkmcnt(8)
    ds_read_b64_tr_b16 v[200:201], v23 offset:96
    ds_read_b64_tr_b16 v[202:203], v23 offset:2656
    v_mfma_f32_16x16x32_bf16 a[104:107], v[220:223], v[148:151], a[104:107]
    s_nop 0
    ds_read_b64_tr_b16 v[204:205], v22 offset:5216
    ds_read_b64_tr_b16 v[206:207], v22 offset:7776
    buffer_load_dwordx4 a[228:231], v61, s[48:51], s80 offen sc1
    v_mfma_f32_16x16x32_bf16 a[104:107], v[224:227], v[144:147], a[104:107]
    s_nop 0
    ds_read_b64_tr_b16 v[208:209], v22 offset:96
    ds_read_b64_tr_b16 v[210:211], v22 offset:2656
    v_mfma_f32_16x16x32_bf16 a[108:111], v[228:231], v[144:147], a[108:111]
    s_waitcnt lgkmcnt(10)
    ds_read_b64_tr_b16 v[212:213], v22 offset:128
    ds_read_b64_tr_b16 v[214:215], v22 offset:2688
    v_mfma_f32_16x16x32_bf16 a[108:111], v[232:235], v[148:151], a[108:111]
    ds_read_b64_tr_b16 v[216:217], v22 offset:5248
    ds_read_b64_tr_b16 v[218:219], v22 offset:7808
    buffer_load_dwordx4 a[232:235], v62, s[48:51], s80 offen sc1
    v_mfma_f32_16x16x32_bf16 a[108:111], v[236:239], v[152:155], a[108:111]
    s_waitcnt lgkmcnt(10)
    ds_read_b64_tr_b16 v[220:221], v23 offset:128
    ds_read_b64_tr_b16 v[222:223], v23 offset:2688
    v_mfma_f32_16x16x32_bf16 a[108:111], v[240:243], v[156:159], a[108:111]
    ds_read_b64_tr_b16 v[224:225], v23 offset:5248
    ds_read_b64_tr_b16 v[226:227], v23 offset:7808
    v_mfma_f32_16x16x32_bf16 a[112:115], v[196:199], v[156:159], a[112:115]
    s_waitcnt lgkmcnt(10)
    ds_read_b64_tr_b16 v[228:229], v24 offset:0
    ds_read_b64_tr_b16 v[230:231], v24 offset:2560
    buffer_load_dwordx4 a[236:239], v63, s[48:51], s80 offen sc1
    v_mfma_f32_16x16x32_bf16 a[112:115], v[200:203], v[152:155], a[112:115]
    ds_read_b64_tr_b16 v[232:233], v24 offset:5120
    ds_read_b64_tr_b16 v[234:235], v24 offset:7680
    v_mfma_f32_16x16x32_bf16 a[112:115], v[204:207], v[148:151], a[112:115]
    s_waitcnt lgkmcnt(10)
    ds_read_b64_tr_b16 v[236:237], v25 offset:0
    s_nop 0
    ds_read_b64_tr_b16 v[238:239], v25 offset:2560
    v_mfma_f32_16x16x32_bf16 a[112:115], v[208:211], v[144:147], a[112:115]
    ds_read_b64_tr_b16 v[240:241], v25 offset:5120
    ds_read_b64_tr_b16 v[242:243], v25 offset:7680
    buffer_load_dwordx4 a[240:243], v60, s[48:51], s80 offen offset:1024 sc1
    v_mfma_f32_16x16x32_bf16 a[116:119], v[212:215], v[144:147], a[116:119]
    s_waitcnt lgkmcnt(10)
    ds_read_b64_tr_b16 v[196:197], v25 offset:5152
    s_nop 0
    ds_read_b64_tr_b16 v[198:199], v25 offset:7712
    v_mfma_f32_16x16x32_bf16 a[116:119], v[216:219], v[148:151], a[116:119]
    ds_read_b64_tr_b16 v[200:201], v25 offset:32
    ds_read_b64_tr_b16 v[202:203], v25 offset:2592
    v_mfma_f32_16x16x32_bf16 a[116:119], v[220:223], v[152:155], a[116:119]
    s_waitcnt lgkmcnt(10)
    ds_read_b64_tr_b16 v[204:205], v24 offset:5152
    ds_read_b64_tr_b16 v[206:207], v24 offset:7712
    s_nop 0
    buffer_load_dwordx4 a[244:247], v61, s[48:51], s80 offen offset:1024 sc1
    v_mfma_f32_16x16x32_bf16 a[116:119], v[224:227], v[156:159], a[116:119]
    ds_read_b64_tr_b16 v[208:209], v24 offset:32
    ds_read_b64_tr_b16 v[210:211], v24 offset:2592
    v_mfma_f32_16x16x32_bf16 a[100:103], v[228:231], v[160:163], a[100:103]
    s_waitcnt lgkmcnt(10)
    ds_read_b64_tr_b16 v[212:213], v24 offset:64
    ds_read_b64_tr_b16 v[214:215], v24 offset:2624
    v_mfma_f32_16x16x32_bf16 a[100:103], v[232:235], v[164:167], a[100:103]
    s_nop 0
    ds_read_b64_tr_b16 v[216:217], v24 offset:5184
    ds_read_b64_tr_b16 v[218:219], v24 offset:7744
    buffer_load_dwordx4 a[248:251], v62, s[48:51], s80 offen offset:1024 sc1
    v_mfma_f32_16x16x32_bf16 a[100:103], v[236:239], v[168:171], a[100:103]
    s_waitcnt lgkmcnt(10)
    ds_read_b64_tr_b16 v[220:221], v25 offset:64
    ds_read_b64_tr_b16 v[222:223], v25 offset:2624
    v_mfma_f32_16x16x32_bf16 a[100:103], v[240:243], v[172:175], a[100:103]
    s_nop 0
    ds_read_b64_tr_b16 v[224:225], v25 offset:5184
    ds_read_b64_tr_b16 v[226:227], v25 offset:7744
    v_mfma_f32_16x16x32_bf16 a[104:107], v[196:199], v[172:175], a[104:107]
    s_nop 0
    s_waitcnt lgkmcnt(10)
    ds_read_b64_tr_b16 v[228:229], v25 offset:5216
    ds_read_b64_tr_b16 v[230:231], v25 offset:7776
    buffer_load_dwordx4 a[252:255], v63, s[48:51], s80 offen offset:1024 sc1
    v_mfma_f32_16x16x32_bf16 a[104:107], v[200:203], v[168:171], a[104:107]
    s_nop 0
    ds_read_b64_tr_b16 v[232:233], v25 offset:96
    ds_read_b64_tr_b16 v[234:235], v25 offset:2656
    v_mfma_f32_16x16x32_bf16 a[104:107], v[204:207], v[164:167], a[104:107]
    s_waitcnt lgkmcnt(10)
    ds_read_b64_tr_b16 v[236:237], v24 offset:5216
    ds_read_b64_tr_b16 v[238:239], v24 offset:7776
    v_mfma_f32_16x16x32_bf16 a[104:107], v[208:211], v[160:163], a[104:107]
    ds_read_b64_tr_b16 v[240:241], v24 offset:96
    ds_read_b64_tr_b16 v[242:243], v24 offset:2656
    buffer_load_dwordx4 a[144:147], v60, s[48:51], s80 offen offset:2048 sc1
    v_mfma_f32_16x16x32_bf16 a[108:111], v[212:215], v[160:163], a[108:111]
    s_nop 0
    s_waitcnt lgkmcnt(10)
    ds_read_b64_tr_b16 v[196:197], v24 offset:128
    ds_read_b64_tr_b16 v[198:199], v24 offset:2688
    v_mfma_f32_16x16x32_bf16 a[108:111], v[216:219], v[164:167], a[108:111]
    ds_read_b64_tr_b16 v[200:201], v24 offset:5248
    ds_read_b64_tr_b16 v[202:203], v24 offset:7808
    v_mfma_f32_16x16x32_bf16 a[108:111], v[220:223], v[168:171], a[108:111]
    s_waitcnt lgkmcnt(10)
    s_nop 0
    ds_read_b64_tr_b16 v[204:205], v25 offset:128
    ds_read_b64_tr_b16 v[206:207], v25 offset:2688
    buffer_load_dwordx4 a[148:151], v61, s[48:51], s80 offen offset:2048 sc1
    v_mfma_f32_16x16x32_bf16 a[108:111], v[224:227], v[172:175], a[108:111]
    ds_read_b64_tr_b16 v[208:209], v25 offset:5248
    ds_read_b64_tr_b16 v[210:211], v25 offset:7808
    v_mfma_f32_16x16x32_bf16 a[112:115], v[228:231], v[172:175], a[112:115]
    s_waitcnt lgkmcnt(10)
    v_mfma_f32_16x16x32_bf16 a[112:115], v[232:235], v[168:171], a[112:115]
    buffer_load_dwordx4 a[152:155], v62, s[48:51], s80 offen offset:2048 sc1
    v_mfma_f32_16x16x32_bf16 a[112:115], v[236:239], v[164:167], a[112:115]
    s_waitcnt lgkmcnt(6)
    v_mfma_f32_16x16x32_bf16 a[112:115], v[240:243], v[160:163], a[112:115]
    v_mfma_f32_16x16x32_bf16 a[116:119], v[196:199], v[160:163], a[116:119]
    s_waitcnt lgkmcnt(2)
    buffer_load_dwordx4 a[156:159], v63, s[48:51], s80 offen offset:2048 sc1
    v_mfma_f32_16x16x32_bf16 a[116:119], v[200:203], v[164:167], a[116:119]
    v_mfma_f32_16x16x32_bf16 a[116:119], v[204:207], v[168:171], a[116:119]
    s_waitcnt lgkmcnt(0)
    v_mfma_f32_16x16x32_bf16 a[116:119], v[208:211], v[172:175], a[116:119]
    s_lshl_b32 s60, s31, 2
    s_add_u32 s60, s60, s32
    s_lshl_b32 s60, s60, 2
    s_add_u32 s60, s60, s30
    s_mul_i32 s60, s60, 20480
    s_add_u32 s60, s60, 3145728
    s_lshr_b32 s3, s33, 1
    s_mul_i32 s3, s3, 5120
    s_add_u32 s60, s60, s3
    s_and_b32 s3, s33, 1
    s_lshl_b32 s35, s3, 3
    s_add_u32 s61, s60, s35
    s_add_u32 s61, s61, 4096
    s_lshl_b32 s3, s3, 11
    s_add_u32 s60, s60, s3
    s_lshl_b32 s62, s31, 2
    s_add_u32 s62, s62, s32
    s_lshl_b32 s62, s62, 2
    s_add_u32 s62, s62, s30
    s_mul_i32 s62, s62, 16
    s_movk_i32 s68, 2048
    s_barrier
    s_mov_b32 s81, 79693824
    s_mov_b32 s63, 3145728
    s_mul_i32 s78, s33, 102400
    s_add_u32 s78, s78, 81788928
    s_mul_i32 s64, s33, 2560
    s_add_u32 s64, s64, s77
    s_nop 1
    ds_read_b64_tr_b16 v[16:17], v48 offset:0
    ds_read_b64_tr_b16 v[18:19], v48 offset:2048
    ds_read_b64_tr_b16 v[20:21], v48 offset:12288
    ds_read_b64_tr_b16 v[22:23], v48 offset:14336
    ds_read_b64_tr_b16 v[24:25], v48 offset:8
    ds_read_b64_tr_b16 v[26:27], v48 offset:2056
    ds_read_b64_tr_b16 v[28:29], v48 offset:12296
    ds_read_b64_tr_b16 v[30:31], v48 offset:14344
    ds_read_b64_tr_b16 v[32:33], v49 offset:0
    ds_read_b64_tr_b16 v[34:35], v49 offset:2048
    ds_read_b64_tr_b16 v[36:37], v49 offset:12288
    ds_read_b64_tr_b16 v[38:39], v49 offset:14336
    s_waitcnt vmcnt(11) lgkmcnt(10)
    v_mfma_f32_16x16x32_bf16 v[64:67], v[16:19], a[224:227], 0
    s_waitcnt vmcnt(7) lgkmcnt(8)
    v_mfma_f32_16x16x32_bf16 v[64:67], v[20:23], a[240:243], v[64:67]
    s_nop 0
    s_waitcnt vmcnt(6)
    s_add_u32 s79, s79, 393216
    s_add_u32 m0, s34, 49152
    v_mfma_f32_16x16x32_bf16 v[68:71], v[20:23], a[244:247], 0
    buffer_load_dwordx4 v11, s[44:47], s79 offen lds
    v_mfma_f32_16x16x32_bf16 v[68:71], v[16:19], a[228:231], v[68:71]
    v_lshlrev_b32_e64 v3, 4, v0
    v_bfe_u32 v55, v1, 4, 3
    v_mfma_f32_16x16x32_bf16 v[72:75], v[16:19], a[232:235], 0
    s_waitcnt vmcnt(6)
    ds_read_b64_tr_b16 v[40:41], v49 offset:8
    ds_read_b64_tr_b16 v[42:43], v49 offset:2056
    v_mfma_f32_16x16x32_bf16 v[72:75], v[20:23], a[248:251], v[72:75]
    s_waitcnt vmcnt(5)
    buffer_load_dwordx4 a[160:163], v60, s[48:51], s80 offen offset:3072 sc1
    v_mfma_f32_16x16x32_bf16 v[76:79], v[20:23], a[252:255], 0
    v_lshlrev_b32 v55, 5, v55
    v_add_u32 v50, 49152, v48
    v_mfma_f32_16x16x32_bf16 v[76:79], v[16:19], a[236:239], v[76:79]
    s_waitcnt lgkmcnt(2)
    s_add_u32 m0, s34, 53120
    ds_read_b64_tr_b16 v[44:45], v49 offset:12296
    ds_read_b64_tr_b16 v[46:47], v49 offset:14344
    v_mfma_f32_16x16x32_bf16 v[92:95], v[24:27], a[236:239], 0
    buffer_load_dwordx4 v11, s[44:47], s79 offen offset:128 lds
    v_mfma_f32_16x16x32_bf16 v[92:95], v[28:31], a[252:255], v[92:95]
    v_add_u32 v51, 49152, v49
    v_add_u32 v52, 98304, v48
    v_mfma_f32_16x16x32_bf16 v[88:91], v[28:31], a[248:251], 0
    v_add_u32 v53, 98304, v49
    v_mov_b32 v56, 0xbdd2d3e8
    v_mfma_f32_16x16x32_bf16 v[88:91], v[24:27], a[232:235], v[88:91]
    v_accvgpr_read_b32 v12, a100
    v_accvgpr_read_b32 v13, a101
    v_mfma_f32_16x16x32_bf16 v[84:87], v[24:27], a[228:231], 0
    ds_read_b64_tr_b16 v[16:17], v48 offset:4096
    ds_read_b64_tr_b16 v[18:19], v48 offset:6144
    v_mfma_f32_16x16x32_bf16 v[84:87], v[28:31], a[244:247], v[84:87]
    v_mul_f32 v14, v12, v12
    v_mul_f32 v15, v13, v13
    v_mfma_f32_16x16x32_bf16 v[80:83], v[28:31], a[240:243], 0
    v_fmaak_f32 v14, v14, v56, 0xc0135761
    v_fmaak_f32 v15, v15, v56, 0xc0135761
    v_mfma_f32_16x16x32_bf16 v[80:83], v[24:27], a[224:227], v[80:83]
    s_add_u32 m0, s34, 57088
    ds_read_b64_tr_b16 v[20:21], v48 offset:16384
    ds_read_b64_tr_b16 v[22:23], v48 offset:18432
    v_mfma_f32_16x16x32_bf16 v[96:99], v[32:35], a[224:227], 0
    buffer_load_dwordx4 v11, s[44:47], s79 offen offset:256 lds
    v_mfma_f32_16x16x32_bf16 v[96:99], v[36:39], a[240:243], v[96:99]
    v_mfma_f32_16x16x32_bf16 v[100:103], v[36:39], a[244:247], 0
    buffer_load_dwordx4 a[164:167], v61, s[48:51], s80 offen offset:3072 sc1
    v_mfma_f32_16x16x32_bf16 v[100:103], v[32:35], a[228:231], v[100:103]
    v_mul_f32_e64 v14, v14, v12
    v_mul_f32_e64 v15, v15, v13
    v_mfma_f32_16x16x32_bf16 v[104:107], v[32:35], a[232:235], 0
    ds_read_b64_tr_b16 v[24:25], v48 offset:4104
    ds_read_b64_tr_b16 v[26:27], v48 offset:6152
    v_mfma_f32_16x16x32_bf16 v[104:107], v[36:39], a[248:251], v[104:107]
    s_add_u32 s79, s79, 393216
    s_add_u32 m0, s34, 61440
    v_mfma_f32_16x16x32_bf16 v[108:111], v[36:39], a[252:255], 0
    buffer_load_dwordx4 v11, s[44:47], s79 offen lds
    v_mfma_f32_16x16x32_bf16 v[108:111], v[32:35], a[236:239], v[108:111]
    s_waitcnt lgkmcnt(2)
    ds_read_b64_tr_b16 v[28:29], v48 offset:16392
    ds_read_b64_tr_b16 v[30:31], v48 offset:18440
    v_mfma_f32_16x16x32_bf16 v[124:127], v[40:43], a[236:239], 0
    v_exp_f32 v14, v14
    v_mfma_f32_16x16x32_bf16 v[124:127], v[44:47], a[252:255], v[124:127]
    v_mfma_f32_16x16x32_bf16 v[120:123], v[44:47], a[248:251], 0
    buffer_load_dwordx4 a[168:171], v62, s[48:51], s80 offen offset:3072 sc1
    v_mfma_f32_16x16x32_bf16 v[120:123], v[40:43], a[232:235], v[120:123]
    v_exp_f32_e64 v15, v15
    v_mfma_f32_16x16x32_bf16 v[116:119], v[40:43], a[228:231], 0
    s_add_u32 m0, s34, 65408
    ds_read_b64_tr_b16 v[32:33], v49 offset:4096
    ds_read_b64_tr_b16 v[34:35], v49 offset:6144
    v_mfma_f32_16x16x32_bf16 v[116:119], v[44:47], a[244:247], v[116:119]
    buffer_load_dwordx4 v11, s[44:47], s79 offen offset:128 lds
    v_mfma_f32_16x16x32_bf16 v[112:115], v[44:47], a[240:243], 0
    v_add_f32 v14, 1.0, v14
    v_add_f32 v15, 1.0, v15
    v_mfma_f32_16x16x32_bf16 v[112:115], v[40:43], a[224:227], v[112:115]
    ds_read_b64_tr_b16 v[36:37], v49 offset:16384
    ds_read_b64_tr_b16 v[38:39], v49 offset:18432
    v_mfma_f32_16x16x32_bf16 v[128:131], v[16:19], a[224:227], 0
    v_rcp_f32_e64 v14, v14
    v_mfma_f32_16x16x32_bf16 v[128:131], v[20:23], a[240:243], v[128:131]
    s_add_u32 m0, s34, 69376
    v_mfma_f32_16x16x32_bf16 v[132:135], v[20:23], a[244:247], 0
    buffer_load_dwordx4 v11, s[44:47], s79 offen offset:256 lds
    v_mfma_f32_16x16x32_bf16 v[132:135], v[16:19], a[228:231], v[132:135]
    v_rcp_f32_e64 v15, v15
    v_mfma_f32_16x16x32_bf16 v[136:139], v[16:19], a[232:235], 0
    ds_read_b64_tr_b16 v[40:41], v49 offset:4104
    ds_read_b64_tr_b16 v[42:43], v49 offset:6152
    v_mfma_f32_16x16x32_bf16 v[136:139], v[20:23], a[248:251], v[136:139]
    s_nop 0
    v_mfma_f32_16x16x32_bf16 v[140:143], v[20:23], a[252:255], 0
    buffer_load_dwordx4 a[172:175], v63, s[48:51], s80 offen offset:3072 sc1
    v_mfma_f32_16x16x32_bf16 v[140:143], v[16:19], a[236:239], v[140:143]
    s_waitcnt lgkmcnt(2)
    ds_read_b64_tr_b16 v[44:45], v49 offset:16392
    ds_read_b64_tr_b16 v[46:47], v49 offset:18440
    v_mfma_f32_16x16x32_bf16 v[156:159], v[24:27], a[236:239], 0
    s_add_u32 s79, s79, 393216
    s_add_u32 m0, s34, 73728
    v_mfma_f32_16x16x32_bf16 v[156:159], v[28:31], a[252:255], v[156:159]
    buffer_load_dwordx4 v11, s[44:47], s79 offen lds
    v_mfma_f32_16x16x32_bf16 v[152:155], v[28:31], a[248:251], 0
    v_mul_f32 v14, v14, v12
    v_mul_f32 v15, v15, v13
    v_mfma_f32_16x16x32_bf16 v[152:155], v[24:27], a[232:235], v[152:155]
    v_cvt_pk_bf16_f32 v54, v14, v15
    v_accvgpr_write_b32 a120, v54
    v_mfma_f32_16x16x32_bf16 v[148:151], v[24:27], a[228:231], 0
    ds_read_b64_tr_b16 v[16:17], v48 offset:8192
    ds_read_b64_tr_b16 v[18:19], v48 offset:10240
    v_mfma_f32_16x16x32_bf16 v[148:151], v[28:31], a[244:247], v[148:151]
    v_accvgpr_read_b32 v12, a102
    v_accvgpr_read_b32 v13, a103
    v_mfma_f32_16x16x32_bf16 v[144:147], v[28:31], a[240:243], 0
    v_mul_f32 v14, v12, v12
    v_mul_f32 v15, v13, v13
    v_mfma_f32_16x16x32_bf16 v[144:147], v[24:27], a[224:227], v[144:147]
    s_add_u32 m0, s34, 77696
    ds_read_b64_tr_b16 v[20:21], v48 offset:20480
    ds_read_b64_tr_b16 v[22:23], v48 offset:22528
    v_mfma_f32_16x16x32_bf16 v[160:163], v[32:35], a[224:227], 0
    buffer_load_dwordx4 v11, s[44:47], s79 offen offset:128 lds
    v_mfma_f32_16x16x32_bf16 v[160:163], v[36:39], a[240:243], v[160:163]
    s_add_u32 s80, s80, 4096
    v_mfma_f32_16x16x32_bf16 v[164:167], v[36:39], a[244:247], 0
    buffer_load_dwordx4 a[192:195], v60, s[48:51], s80 offen sc1
    v_mfma_f32_16x16x32_bf16 v[164:167], v[32:35], a[228:231], v[164:167]
    v_fmaak_f32 v14, v14, v56, 0xc0135761
    v_fmaak_f32 v15, v15, v56, 0xc0135761
    v_mfma_f32_16x16x32_bf16 v[168:171], v[32:35], a[232:235], 0
    ds_read_b64_tr_b16 v[24:25], v48 offset:8200
    ds_read_b64_tr_b16 v[26:27], v48 offset:10248
    v_mfma_f32_16x16x32_bf16 v[168:171], v[36:39], a[248:251], v[168:171]
    s_add_u32 m0, s34, 81664
    v_mfma_f32_16x16x32_bf16 v[172:175], v[36:39], a[252:255], 0
    buffer_load_dwordx4 v11, s[44:47], s79 offen offset:256 lds
    v_mfma_f32_16x16x32_bf16 v[172:175], v[32:35], a[236:239], v[172:175]
    s_waitcnt lgkmcnt(2)
    ds_read_b64_tr_b16 v[28:29], v48 offset:20488
    ds_read_b64_tr_b16 v[30:31], v48 offset:22536
    v_mfma_f32_16x16x32_bf16 v[188:191], v[40:43], a[236:239], 0
    v_mul_f32 v14, v14, v12
    v_mul_f32 v15, v15, v13
    v_mfma_f32_16x16x32_bf16 v[188:191], v[44:47], a[252:255], v[188:191]
    v_exp_f32 v14, v14
    v_mfma_f32_16x16x32_bf16 v[184:187], v[44:47], a[248:251], 0
    v_exp_f32 v15, v15
    v_mfma_f32_16x16x32_bf16 v[184:187], v[40:43], a[232:235], v[184:187]
    v_add_f32 v14, 1.0, v14
    v_add_f32_e64 v15, 1.0, v15
    v_mfma_f32_16x16x32_bf16 v[180:183], v[40:43], a[228:231], 0
    ds_read_b64_tr_b16 v[32:33], v49 offset:8192
    ds_read_b64_tr_b16 v[34:35], v49 offset:10240
    v_mfma_f32_16x16x32_bf16 v[180:183], v[44:47], a[244:247], v[180:183]
    s_add_u32 s79, s79, 393216
    s_add_u32 m0, s34, 86016
    v_mfma_f32_16x16x32_bf16 v[176:179], v[44:47], a[240:243], 0
    buffer_load_dwordx4 v11, s[44:47], s79 offen lds
    v_mfma_f32_16x16x32_bf16 v[176:179], v[40:43], a[224:227], v[176:179]
    ds_read_b64_tr_b16 v[36:37], v49 offset:20480
    ds_read_b64_tr_b16 v[38:39], v49 offset:22528
    v_mfma_f32_16x16x32_bf16 v[192:195], v[16:19], a[224:227], 0
    buffer_load_dwordx4 a[196:199], v61, s[48:51], s80 offen sc1
    v_mfma_f32_16x16x32_bf16 v[192:195], v[20:23], a[240:243], v[192:195]
    v_rcp_f32_e64 v14, v14
    v_mfma_f32_16x16x32_bf16 v[196:199], v[20:23], a[244:247], 0
    s_add_u32 m0, s34, 89984
    v_mfma_f32_16x16x32_bf16 v[196:199], v[16:19], a[228:231], v[196:199]
    buffer_load_dwordx4 v11, s[44:47], s79 offen offset:128 lds
    v_mfma_f32_16x16x32_bf16 v[200:203], v[16:19], a[232:235], 0
    ds_read_b64_tr_b16 v[40:41], v49 offset:8200
    ds_read_b64_tr_b16 v[42:43], v49 offset:10248
    v_mfma_f32_16x16x32_bf16 v[200:203], v[20:23], a[248:251], v[200:203]
    v_rcp_f32_e64 v15, v15
    v_mfma_f32_16x16x32_bf16 v[204:207], v[20:23], a[252:255], 0
    v_mul_f32 v14, v14, v12
    v_mul_f32_e64 v15, v15, v13
    v_mfma_f32_16x16x32_bf16 v[204:207], v[16:19], a[236:239], v[204:207]
    s_waitcnt lgkmcnt(2)
    ds_read_b64_tr_b16 v[44:45], v49 offset:20488
    ds_read_b64_tr_b16 v[46:47], v49 offset:22536
    v_mfma_f32_16x16x32_bf16 v[220:223], v[24:27], a[236:239], 0
    buffer_load_dwordx4 a[200:203], v62, s[48:51], s80 offen sc1
    v_mfma_f32_16x16x32_bf16 v[220:223], v[28:31], a[252:255], v[220:223]
    s_add_u32 m0, s34, 93952
    v_mfma_f32_16x16x32_bf16 v[216:219], v[28:31], a[248:251], 0
    buffer_load_dwordx4 v11, s[44:47], s79 offen offset:256 lds
    v_mfma_f32_16x16x32_bf16 v[216:219], v[24:27], a[232:235], v[216:219]
    v_cvt_pk_bf16_f32 v54, v14, v15
    v_accvgpr_write_b32 a121, v54
    v_mfma_f32_16x16x32_bf16 v[212:215], v[24:27], a[228:231], 0
    ds_read_b64_tr_b16 v[16:17], v48 offset:24576
    ds_read_b64_tr_b16 v[18:19], v48 offset:26624
    v_mfma_f32_16x16x32_bf16 v[212:215], v[28:31], a[244:247], v[212:215]
    v_accvgpr_read_b32 v12, a104
    v_accvgpr_read_b32 v13, a105
    v_mfma_f32_16x16x32_bf16 v[208:211], v[28:31], a[240:243], 0
    v_mul_f32_e64 v14, v12, v12
    v_mul_f32_e64 v15, v13, v13
    v_mfma_f32_16x16x32_bf16 v[208:211], v[24:27], a[224:227], v[208:211]
    ds_read_b64_tr_b16 v[20:21], v48 offset:36864
    ds_read_b64_tr_b16 v[22:23], v48 offset:38912
    v_mfma_f32_16x16x32_bf16 v[224:227], v[32:35], a[224:227], 0
    v_fmaak_f32 v14, v14, v56, 0xc0135761
    v_fmaak_f32 v15, v15, v56, 0xc0135761
    v_mfma_f32_16x16x32_bf16 v[224:227], v[36:39], a[240:243], v[224:227]
    v_mul_f32_e64 v14, v14, v12
    v_mul_f32_e64 v15, v15, v13
    v_mfma_f32_16x16x32_bf16 v[228:231], v[36:39], a[244:247], 0
    v_mfma_f32_16x16x32_bf16 v[228:231], v[32:35], a[228:231], v[228:231]
    buffer_load_dwordx4 a[204:207], v63, s[48:51], s80 offen sc1
    v_mfma_f32_16x16x32_bf16 v[232:235], v[32:35], a[232:235], 0
    ds_read_b64_tr_b16 v[24:25], v48 offset:24584
    ds_read_b64_tr_b16 v[26:27], v48 offset:26632
    v_mfma_f32_16x16x32_bf16 v[232:235], v[36:39], a[248:251], v[232:235]
    s_add_u32 s79, s79, 393216
    s_add_u32 m0, s34, 98304
    v_mfma_f32_16x16x32_bf16 v[236:239], v[36:39], a[252:255], 0
    buffer_load_dwordx4 v11, s[44:47], s79 offen lds
    v_mfma_f32_16x16x32_bf16 v[236:239], v[32:35], a[236:239], v[236:239]
    s_waitcnt lgkmcnt(2)
    ds_read_b64_tr_b16 v[28:29], v48 offset:36872
    ds_read_b64_tr_b16 v[30:31], v48 offset:38920
    v_mfma_f32_16x16x32_bf16 v[252:255], v[40:43], a[236:239], 0
    v_exp_f32 v14, v14
    v_mfma_f32_16x16x32_bf16 v[252:255], v[44:47], a[252:255], v[252:255]
    v_exp_f32_e64 v15, v15
    v_mfma_f32_16x16x32_bf16 v[248:251], v[44:47], a[248:251], 0
    s_add_u32 m0, s34, 102272
    v_mfma_f32_16x16x32_bf16 v[248:251], v[40:43], a[232:235], v[248:251]
    buffer_load_dwordx4 v11, s[44:47], s79 offen offset:128 lds
    v_mfma_f32_16x16x32_bf16 v[244:247], v[40:43], a[228:231], 0
    ds_read_b64_tr_b16 v[32:33], v49 offset:24576
    ds_read_b64_tr_b16 v[34:35], v49 offset:26624
    v_mfma_f32_16x16x32_bf16 v[244:247], v[44:47], a[244:247], v[244:247]
    v_mfma_f32_16x16x32_bf16 v[240:243], v[44:47], a[240:243], 0
    buffer_load_dwordx4 a[208:211], v60, s[48:51], s80 offen offset:1024 sc1
    v_mfma_f32_16x16x32_bf16 v[240:243], v[40:43], a[224:227], v[240:243]
    s_waitcnt vmcnt(26)
    ds_read_b64_tr_b16 v[36:37], v49 offset:36864
    ds_read_b64_tr_b16 v[38:39], v49 offset:38912
    v_mfma_f32_16x16x32_bf16 v[64:67], v[16:19], a[144:147], v[64:67]
    s_waitcnt vmcnt(21)
    v_add_f32 v14, 1.0, v14
    v_add_f32_e64 v15, 1.0, v15
    v_mfma_f32_16x16x32_bf16 v[64:67], v[20:23], a[160:163], v[64:67]
    s_waitcnt vmcnt(18)
    s_add_u32 m0, s34, 106240
    v_mfma_f32_16x16x32_bf16 v[68:71], v[20:23], a[164:167], v[68:71]
    buffer_load_dwordx4 v11, s[44:47], s79 offen offset:256 lds
    v_mfma_f32_16x16x32_bf16 v[68:71], v[16:19], a[148:151], v[68:71]
    v_rcp_f32 v14, v14
    v_mfma_f32_16x16x32_bf16 v[72:75], v[16:19], a[152:155], v[72:75]
    s_waitcnt vmcnt(17)
    ds_read_b64_tr_b16 v[40:41], v49 offset:24584
    ds_read_b64_tr_b16 v[42:43], v49 offset:26632
    v_mfma_f32_16x16x32_bf16 v[72:75], v[20:23], a[168:171], v[72:75]
    s_waitcnt vmcnt(14)
    v_rcp_f32 v15, v15
    v_mfma_f32_16x16x32_bf16 v[76:79], v[20:23], a[172:175], v[76:79]
    v_mul_f32_e64 v14, v14, v12
    v_mul_f32 v15, v15, v13
    v_mfma_f32_16x16x32_bf16 v[76:79], v[16:19], a[156:159], v[76:79]
    s_waitcnt lgkmcnt(2)
    ds_read_b64_tr_b16 v[44:45], v49 offset:36872
    ds_read_b64_tr_b16 v[46:47], v49 offset:38920
    v_mfma_f32_16x16x32_bf16 v[92:95], v[24:27], a[156:159], v[92:95]
    s_add_u32 s79, s79, 393216
    s_add_u32 m0, s34, 110592
    v_mfma_f32_16x16x32_bf16 v[92:95], v[28:31], a[172:175], v[92:95]
    buffer_load_dwordx4 v11, s[44:47], s79 offen lds
    v_mfma_f32_16x16x32_bf16 v[88:91], v[28:31], a[168:171], v[88:91]
    v_mfma_f32_16x16x32_bf16 v[88:91], v[24:27], a[152:155], v[88:91]
    buffer_load_dwordx4 a[212:215], v61, s[48:51], s80 offen offset:1024 sc1
    v_mfma_f32_16x16x32_bf16 v[84:87], v[24:27], a[148:151], v[84:87]
    ds_read_b64_tr_b16 v[16:17], v48 offset:28672
    ds_read_b64_tr_b16 v[18:19], v48 offset:30720
    v_mfma_f32_16x16x32_bf16 v[84:87], v[28:31], a[164:167], v[84:87]
    v_cvt_pk_bf16_f32 v54, v14, v15
    v_accvgpr_write_b32 a122, v54
    v_mfma_f32_16x16x32_bf16 v[80:83], v[28:31], a[160:163], v[80:83]
    v_accvgpr_read_b32 v12, a106
    v_accvgpr_read_b32 v13, a107
    v_mfma_f32_16x16x32_bf16 v[80:83], v[24:27], a[144:147], v[80:83]
    s_add_u32 m0, s34, 114560
    ds_read_b64_tr_b16 v[20:21], v48 offset:40960
    ds_read_b64_tr_b16 v[22:23], v48 offset:43008
    v_mfma_f32_16x16x32_bf16 v[96:99], v[32:35], a[144:147], v[96:99]
    buffer_load_dwordx4 v11, s[44:47], s79 offen offset:128 lds
    v_mfma_f32_16x16x32_bf16 v[96:99], v[36:39], a[160:163], v[96:99]
    v_mul_f32 v14, v12, v12
    v_mul_f32 v15, v13, v13
    v_mfma_f32_16x16x32_bf16 v[100:103], v[36:39], a[164:167], v[100:103]
    v_fmaak_f32 v14, v14, v56, 0xc0135761
    v_fmaak_f32 v15, v15, v56, 0xc0135761
    v_mfma_f32_16x16x32_bf16 v[100:103], v[32:35], a[148:151], v[100:103]
    v_mul_f32 v14, v14, v12
    v_mul_f32 v15, v15, v13
    v_mfma_f32_16x16x32_bf16 v[104:107], v[32:35], a[152:155], v[104:107]
    ds_read_b64_tr_b16 v[24:25], v48 offset:28680
    ds_read_b64_tr_b16 v[26:27], v48 offset:30728
    v_mfma_f32_16x16x32_bf16 v[104:107], v[36:39], a[168:171], v[104:107]
    buffer_load_dwordx4 a[216:219], v62, s[48:51], s80 offen offset:1024 sc1
    v_mfma_f32_16x16x32_bf16 v[108:111], v[36:39], a[172:175], v[108:111]
    v_exp_f32 v14, v14
    v_mfma_f32_16x16x32_bf16 v[108:111], v[32:35], a[156:159], v[108:111]
    s_waitcnt lgkmcnt(2)
    s_add_u32 m0, s34, 118528
    ds_read_b64_tr_b16 v[28:29], v48 offset:40968
    ds_read_b64_tr_b16 v[30:31], v48 offset:43016
    v_mfma_f32_16x16x32_bf16 v[124:127], v[40:43], a[156:159], v[124:127]
    buffer_load_dwordx4 v11, s[44:47], s79 offen offset:256 lds
    v_mfma_f32_16x16x32_bf16 v[124:127], v[44:47], a[172:175], v[124:127]
    v_exp_f32 v15, v15
    v_mfma_f32_16x16x32_bf16 v[120:123], v[44:47], a[168:171], v[120:123]
    v_add_f32 v14, 1.0, v14
    v_add_f32 v15, 1.0, v15
    v_mfma_f32_16x16x32_bf16 v[120:123], v[40:43], a[152:155], v[120:123]
    v_rcp_f32 v14, v14
    v_mfma_f32_16x16x32_bf16 v[116:119], v[40:43], a[148:151], v[116:119]
    ds_read_b64_tr_b16 v[32:33], v49 offset:28672
    ds_read_b64_tr_b16 v[34:35], v49 offset:30720
    v_mfma_f32_16x16x32_bf16 v[116:119], v[44:47], a[164:167], v[116:119]
    v_rcp_f32 v15, v15
    v_mfma_f32_16x16x32_bf16 v[112:115], v[44:47], a[160:163], v[112:115]
    v_mul_f32 v14, v14, v12
    v_mul_f32_e64 v15, v15, v13
    v_mfma_f32_16x16x32_bf16 v[112:115], v[40:43], a[144:147], v[112:115]
    ds_read_b64_tr_b16 v[36:37], v49 offset:40960
    ds_read_b64_tr_b16 v[38:39], v49 offset:43008
    v_mfma_f32_16x16x32_bf16 v[128:131], v[16:19], a[144:147], v[128:131]
    s_add_u32 s79, s79, 393216
    s_add_u32 m0, s34, 122880
    v_mfma_f32_16x16x32_bf16 v[128:131], v[20:23], a[160:163], v[128:131]
    buffer_load_dwordx4 v11, s[44:47], s79 offen lds
    v_mfma_f32_16x16x32_bf16 v[132:135], v[20:23], a[164:167], v[132:135]
    v_mfma_f32_16x16x32_bf16 v[132:135], v[16:19], a[148:151], v[132:135]
    buffer_load_dwordx4 a[220:223], v63, s[48:51], s80 offen offset:1024 sc1
    v_mfma_f32_16x16x32_bf16 v[136:139], v[16:19], a[152:155], v[136:139]
    ds_read_b64_tr_b16 v[40:41], v49 offset:28680
    ds_read_b64_tr_b16 v[42:43], v49 offset:30728
    v_mfma_f32_16x16x32_bf16 v[136:139], v[20:23], a[168:171], v[136:139]
    s_add_u32 m0, s34, 126848
    v_mfma_f32_16x16x32_bf16 v[140:143], v[20:23], a[172:175], v[140:143]
    buffer_load_dwordx4 v11, s[44:47], s79 offen offset:128 lds
    v_mfma_f32_16x16x32_bf16 v[140:143], v[16:19], a[156:159], v[140:143]
    s_waitcnt lgkmcnt(2)
    s_nop 0
    ds_read_b64_tr_b16 v[44:45], v49 offset:40968
    ds_read_b64_tr_b16 v[46:47], v49 offset:43016
    v_mfma_f32_16x16x32_bf16 v[156:159], v[24:27], a[156:159], v[156:159]
    v_cvt_pk_bf16_f32 v54, v14, v15
    v_accvgpr_write_b32 a123, v54
    v_mfma_f32_16x16x32_bf16 v[156:159], v[28:31], a[172:175], v[156:159]
    v_accvgpr_read_b32 v12, a108
    v_accvgpr_read_b32 v13, a109
    v_mfma_f32_16x16x32_bf16 v[152:155], v[28:31], a[168:171], v[152:155]
    v_mul_f32 v14, v12, v12
    v_mul_f32 v15, v13, v13
    v_mfma_f32_16x16x32_bf16 v[152:155], v[24:27], a[152:155], v[152:155]
    v_fmaak_f32 v14, v14, v56, 0xc0135761
    v_fmaak_f32 v15, v15, v56, 0xc0135761
    v_mfma_f32_16x16x32_bf16 v[148:151], v[24:27], a[148:151], v[148:151]
    s_add_u32 m0, s34, 130816
    ds_read_b64_tr_b16 v[16:17], v48 offset:32768
    ds_read_b64_tr_b16 v[18:19], v48 offset:34816
    v_mfma_f32_16x16x32_bf16 v[148:151], v[28:31], a[164:167], v[148:151]
    buffer_load_dwordx4 v11, s[44:47], s79 offen offset:256 lds
    v_mfma_f32_16x16x32_bf16 v[144:147], v[28:31], a[160:163], v[144:147]
    v_mul_f32_e64 v14, v14, v12
    v_mul_f32_e64 v15, v15, v13
    v_mfma_f32_16x16x32_bf16 v[144:147], v[24:27], a[144:147], v[144:147]
    ds_read_b64_tr_b16 v[20:21], v48 offset:45056
    ds_read_b64_tr_b16 v[22:23], v48 offset:47104
    v_mfma_f32_16x16x32_bf16 v[160:163], v[32:35], a[144:147], v[160:163]
    buffer_store_dwordx4 a[120:123], v1, s[48:51], s60 offen sc1
    v_mfma_f32_16x16x32_bf16 v[160:163], v[36:39], a[160:163], v[160:163]
    v_mfma_f32_16x16x32_bf16 v[164:167], v[36:39], a[164:167], v[164:167]
    buffer_load_dwordx4 a[224:227], v60, s[48:51], s80 offen offset:2048 sc1
    v_mfma_f32_16x16x32_bf16 v[164:167], v[32:35], a[148:151], v[164:167]
    v_exp_f32_e64 v14, v14
    v_mfma_f32_16x16x32_bf16 v[168:171], v[32:35], a[152:155], v[168:171]
    ds_read_b64_tr_b16 v[24:25], v48 offset:32776
    ds_read_b64_tr_b16 v[26:27], v48 offset:34824
    v_mfma_f32_16x16x32_bf16 v[168:171], v[36:39], a[168:171], v[168:171]
    s_add_u32 s79, s79, 393216
    s_add_u32 m0, s34, 135168
    v_mfma_f32_16x16x32_bf16 v[172:175], v[36:39], a[172:175], v[172:175]
    buffer_load_dwordx4 v11, s[44:47], s79 offen lds
    v_mfma_f32_16x16x32_bf16 v[172:175], v[32:35], a[156:159], v[172:175]
    s_waitcnt lgkmcnt(2)
    ds_read_b64_tr_b16 v[28:29], v48 offset:45064
    ds_read_b64_tr_b16 v[30:31], v48 offset:47112
    v_mfma_f32_16x16x32_bf16 v[188:191], v[40:43], a[156:159], v[188:191]
    v_exp_f32 v15, v15
    v_mfma_f32_16x16x32_bf16 v[188:191], v[44:47], a[172:175], v[188:191]
    v_add_f32 v14, 1.0, v14
    v_add_f32 v15, 1.0, v15
    v_mfma_f32_16x16x32_bf16 v[184:187], v[44:47], a[168:171], v[184:187]
    s_add_u32 m0, s34, 139136
    v_mfma_f32_16x16x32_bf16 v[184:187], v[40:43], a[152:155], v[184:187]
    buffer_load_dwordx4 v11, s[44:47], s79 offen offset:128 lds
    v_mfma_f32_16x16x32_bf16 v[180:183], v[40:43], a[148:151], v[180:183]
    ds_read_b64_tr_b16 v[32:33], v49 offset:32768
    ds_read_b64_tr_b16 v[34:35], v49 offset:34816
    v_mfma_f32_16x16x32_bf16 v[180:183], v[44:47], a[164:167], v[180:183]
    buffer_load_dwordx4 a[228:231], v61, s[48:51], s80 offen offset:2048 sc1
    v_mfma_f32_16x16x32_bf16 v[176:179], v[44:47], a[160:163], v[176:179]
    v_rcp_f32_e64 v14, v14
    v_mfma_f32_16x16x32_bf16 v[176:179], v[40:43], a[144:147], v[176:179]
    ds_read_b64_tr_b16 v[36:37], v49 offset:45056
    ds_read_b64_tr_b16 v[38:39], v49 offset:47104
    v_mfma_f32_16x16x32_bf16 v[192:195], v[16:19], a[144:147], v[192:195]
    v_rcp_f32 v15, v15
    v_mfma_f32_16x16x32_bf16 v[192:195], v[20:23], a[160:163], v[192:195]
    v_mul_f32 v14, v14, v12
    v_mul_f32_e64 v15, v15, v13
    v_mfma_f32_16x16x32_bf16 v[196:199], v[20:23], a[164:167], v[196:199]
    s_add_u32 m0, s34, 143104
    ds_read_b64_tr_b16 v[40:41], v49 offset:32776
    ds_read_b64_tr_b16 v[42:43], v49 offset:34824
    v_mfma_f32_16x16x32_bf16 v[196:199], v[16:19], a[148:151], v[196:199]
    buffer_load_dwordx4 v11, s[44:47], s79 offen offset:256 lds
    v_mfma_f32_16x16x32_bf16 v[200:203], v[16:19], a[152:155], v[200:203]
    v_cvt_pk_bf16_f32 v54, v14, v15
    v_accvgpr_write_b32 a124, v54
    v_mfma_f32_16x16x32_bf16 v[200:203], v[20:23], a[168:171], v[200:203]
    ds_read_b64_tr_b16 v[44:45], v49 offset:45064
    ds_read_b64_tr_b16 v[46:47], v49 offset:47112
    v_mfma_f32_16x16x32_bf16 v[204:207], v[20:23], a[172:175], v[204:207]
    v_accvgpr_read_b32 v12, a110
    v_accvgpr_read_b32 v13, a111
    v_mfma_f32_16x16x32_bf16 v[204:207], v[16:19], a[156:159], v[204:207]
    s_waitcnt lgkmcnt(4)
    v_mfma_f32_16x16x32_bf16 v[220:223], v[24:27], a[156:159], v[220:223]
    buffer_load_dwordx4 a[232:235], v62, s[48:51], s80 offen offset:2048 sc1
    v_mfma_f32_16x16x32_bf16 v[220:223], v[28:31], a[172:175], v[220:223]
    s_nop 0
    v_mul_f32 v14, v12, v12
    v_mul_f32_e64 v15, v13, v13
    v_mfma_f32_16x16x32_bf16 v[216:219], v[28:31], a[168:171], v[216:219]
    s_nop 0
    v_fmaak_f32 v14, v14, v56, 0xc0135761
    v_fmaak_f32 v15, v15, v56, 0xc0135761
    v_mfma_f32_16x16x32_bf16 v[216:219], v[24:27], a[152:155], v[216:219]
    v_mul_f32_e64 v14, v14, v12
    v_mul_f32_e64 v15, v15, v13
    v_mfma_f32_16x16x32_bf16 v[212:215], v[24:27], a[148:151], v[212:215]
    s_waitcnt vmcnt(21) lgkmcnt(0)
    s_barrier
    v_mfma_f32_16x16x32_bf16 v[212:215], v[28:31], a[164:167], v[212:215]
    ds_read_b64_tr_b16 v[16:17], v50 offset:0
    ds_read_b64_tr_b16 v[18:19], v50 offset:2048
    v_mfma_f32_16x16x32_bf16 v[208:211], v[28:31], a[160:163], v[208:211]
    v_exp_f32_e64 v14, v14
    v_mfma_f32_16x16x32_bf16 v[208:211], v[24:27], a[144:147], v[208:211]
    ds_read_b64_tr_b16 v[20:21], v50 offset:12288
    ds_read_b64_tr_b16 v[22:23], v50 offset:14336
    v_mfma_f32_16x16x32_bf16 v[224:227], v[32:35], a[144:147], v[224:227]
    s_add_u32 s79, s79, 393216
    s_add_u32 m0, s34, 0
    v_mfma_f32_16x16x32_bf16 v[224:227], v[36:39], a[160:163], v[224:227]
    buffer_load_dwordx4 v11, s[44:47], s79 offen lds
    v_mfma_f32_16x16x32_bf16 v[228:231], v[36:39], a[164:167], v[228:231]
    s_nop 0
    v_mfma_f32_16x16x32_bf16 v[228:231], v[32:35], a[148:151], v[228:231]
    buffer_load_dwordx4 a[236:239], v63, s[48:51], s80 offen offset:2048 sc1
    v_mfma_f32_16x16x32_bf16 v[232:235], v[32:35], a[152:155], v[232:235]
    ds_read_b64_tr_b16 v[24:25], v50 offset:8
    ds_read_b64_tr_b16 v[26:27], v50 offset:2056
    v_mfma_f32_16x16x32_bf16 v[232:235], v[36:39], a[168:171], v[232:235]
    v_exp_f32 v15, v15
    v_mfma_f32_16x16x32_bf16 v[236:239], v[36:39], a[172:175], v[236:239]
    v_add_f32 v14, 1.0, v14
    v_add_f32_e64 v15, 1.0, v15
    v_mfma_f32_16x16x32_bf16 v[236:239], v[32:35], a[156:159], v[236:239]
    ds_read_b64_tr_b16 v[28:29], v50 offset:12296
    ds_read_b64_tr_b16 v[30:31], v50 offset:14344
    v_mfma_f32_16x16x32_bf16 v[252:255], v[40:43], a[156:159], v[252:255]
    v_rcp_f32_e64 v14, v14
    v_mfma_f32_16x16x32_bf16 v[252:255], v[44:47], a[172:175], v[252:255]
    v_rcp_f32_e64 v15, v15
    v_mfma_f32_16x16x32_bf16 v[248:251], v[44:47], a[168:171], v[248:251]
    v_mul_f32_e64 v14, v14, v12
    v_mul_f32_e64 v15, v15, v13
    v_mfma_f32_16x16x32_bf16 v[248:251], v[40:43], a[152:155], v[248:251]
    v_cvt_pk_bf16_f32 v54, v14, v15
    v_accvgpr_write_b32 a125, v54
    v_mfma_f32_16x16x32_bf16 v[244:247], v[40:43], a[148:151], v[244:247]
    s_add_u32 m0, s34, 3968
    ds_read_b64_tr_b16 v[32:33], v51 offset:0
    ds_read_b64_tr_b16 v[34:35], v51 offset:2048
    v_mfma_f32_16x16x32_bf16 v[244:247], v[44:47], a[164:167], v[244:247]
    buffer_load_dwordx4 v11, s[44:47], s79 offen offset:128 lds
    v_mfma_f32_16x16x32_bf16 v[240:243], v[44:47], a[160:163], v[240:243]
    v_accvgpr_read_b32 v12, a112
    v_accvgpr_read_b32 v13, a113
    v_mfma_f32_16x16x32_bf16 v[240:243], v[40:43], a[144:147], v[240:243]
    s_waitcnt lgkmcnt(2)
    ds_read_b64_tr_b16 v[36:37], v51 offset:12288
    ds_read_b64_tr_b16 v[38:39], v51 offset:14336
    v_mfma_f32_16x16x32_bf16 v[64:67], v[16:19], a[192:195], v[64:67]
    s_waitcnt vmcnt(20)
    buffer_load_dwordx4 a[240:243], v60, s[48:51], s80 offen offset:3072 sc1
    v_mfma_f32_16x16x32_bf16 v[64:67], v[20:23], a[208:211], v[64:67]
    s_waitcnt vmcnt(18)
    v_mul_f32 v14, v12, v12
    v_mul_f32_e64 v15, v13, v13
    v_mfma_f32_16x16x32_bf16 v[68:71], v[20:23], a[212:215], v[68:71]
    v_fmaak_f32 v14, v14, v56, 0xc0135761
    v_fmaak_f32 v15, v15, v56, 0xc0135761
    v_mfma_f32_16x16x32_bf16 v[68:71], v[16:19], a[196:199], v[68:71]
    v_mul_f32 v14, v14, v12
    v_mul_f32_e64 v15, v15, v13
    v_mfma_f32_16x16x32_bf16 v[72:75], v[16:19], a[200:203], v[72:75]
    s_waitcnt vmcnt(16)
    ds_read_b64_tr_b16 v[40:41], v51 offset:8
    ds_read_b64_tr_b16 v[42:43], v51 offset:2056
    v_mfma_f32_16x16x32_bf16 v[72:75], v[20:23], a[216:219], v[72:75]
    s_waitcnt vmcnt(13)
    v_exp_f32 v14, v14
    v_mfma_f32_16x16x32_bf16 v[76:79], v[20:23], a[220:223], v[76:79]
    v_exp_f32_e64 v15, v15
    v_mfma_f32_16x16x32_bf16 v[76:79], v[16:19], a[204:207], v[76:79]
    ds_read_b64_tr_b16 v[44:45], v51 offset:12296
    ds_read_b64_tr_b16 v[46:47], v51 offset:14344
    v_mfma_f32_16x16x32_bf16 v[92:95], v[24:27], a[204:207], v[92:95]
    v_mfma_f32_16x16x32_bf16 v[92:95], v[28:31], a[220:223], v[92:95]
    buffer_load_dwordx4 a[244:247], v61, s[48:51], s80 offen offset:3072 sc1
    v_mfma_f32_16x16x32_bf16 v[88:91], v[28:31], a[216:219], v[88:91]
    v_add_f32 v14, 1.0, v14
    v_add_f32 v15, 1.0, v15
    v_mfma_f32_16x16x32_bf16 v[88:91], v[24:27], a[200:203], v[88:91]
    v_rcp_f32_e64 v14, v14
    v_mfma_f32_16x16x32_bf16 v[84:87], v[24:27], a[196:199], v[84:87]
    s_add_u32 m0, s34, 7936
    ds_read_b64_tr_b16 v[16:17], v50 offset:4096
    ds_read_b64_tr_b16 v[18:19], v50 offset:6144
    v_mfma_f32_16x16x32_bf16 v[84:87], v[28:31], a[212:215], v[84:87]
    buffer_load_dwordx4 v11, s[44:47], s79 offen offset:256 lds
    v_mfma_f32_16x16x32_bf16 v[80:83], v[28:31], a[208:211], v[80:83]
    v_rcp_f32 v15, v15
    v_mfma_f32_16x16x32_bf16 v[80:83], v[24:27], a[192:195], v[80:83]
    s_waitcnt lgkmcnt(2)
    ds_read_b64_tr_b16 v[20:21], v50 offset:16384
    ds_read_b64_tr_b16 v[22:23], v50 offset:18432
    v_mfma_f32_16x16x32_bf16 v[96:99], v[32:35], a[192:195], v[96:99]
    v_mul_f32 v14, v14, v12
    v_mul_f32 v15, v15, v13
    v_mfma_f32_16x16x32_bf16 v[96:99], v[36:39], a[208:211], v[96:99]
    v_cvt_pk_bf16_f32 v54, v14, v15
    v_accvgpr_write_b32 a126, v54
    v_mfma_f32_16x16x32_bf16 v[100:103], v[36:39], a[212:215], v[100:103]
    v_accvgpr_read_b32 v12, a114
    v_accvgpr_read_b32 v13, a115
    v_mfma_f32_16x16x32_bf16 v[100:103], v[32:35], a[196:199], v[100:103]
    v_mul_f32 v14, v12, v12
    v_mul_f32 v15, v13, v13
    v_mfma_f32_16x16x32_bf16 v[104:107], v[32:35], a[200:203], v[104:107]
    ds_read_b64_tr_b16 v[24:25], v50 offset:4104
    ds_read_b64_tr_b16 v[26:27], v50 offset:6152
    v_mfma_f32_16x16x32_bf16 v[104:107], v[36:39], a[216:219], v[104:107]
    buffer_load_dwordx4 a[248:251], v62, s[48:51], s80 offen offset:3072 sc1
    v_mfma_f32_16x16x32_bf16 v[108:111], v[36:39], a[220:223], v[108:111]
    v_fmaak_f32 v14, v14, v56, 0xc0135761
    v_fmaak_f32 v15, v15, v56, 0xc0135761
    v_mfma_f32_16x16x32_bf16 v[108:111], v[32:35], a[204:207], v[108:111]
    ds_read_b64_tr_b16 v[28:29], v50 offset:16392
    ds_read_b64_tr_b16 v[30:31], v50 offset:18440
    v_mfma_f32_16x16x32_bf16 v[124:127], v[40:43], a[204:207], v[124:127]
    v_mul_f32 v14, v14, v12
    v_mul_f32 v15, v15, v13
    v_mfma_f32_16x16x32_bf16 v[124:127], v[44:47], a[220:223], v[124:127]
    v_exp_f32 v14, v14
    v_mfma_f32_16x16x32_bf16 v[120:123], v[44:47], a[216:219], v[120:123]
    v_exp_f32 v15, v15
    v_mfma_f32_16x16x32_bf16 v[120:123], v[40:43], a[200:203], v[120:123]
    v_add_f32 v14, 1.0, v14
    v_add_f32 v15, 1.0, v15
    v_mfma_f32_16x16x32_bf16 v[116:119], v[40:43], a[196:199], v[116:119]
    ds_read_b64_tr_b16 v[32:33], v51 offset:4096
    ds_read_b64_tr_b16 v[34:35], v51 offset:6144
    v_mfma_f32_16x16x32_bf16 v[116:119], v[44:47], a[212:215], v[116:119]
    s_add_u32 s79, s79, 393216
    s_add_u32 m0, s34, 12288
    v_mfma_f32_16x16x32_bf16 v[112:115], v[44:47], a[208:211], v[112:115]
    buffer_load_dwordx4 v11, s[44:47], s79 offen lds
    v_mfma_f32_16x16x32_bf16 v[112:115], v[40:43], a[192:195], v[112:115]
    s_nop 0
    s_waitcnt lgkmcnt(2)
    ds_read_b64_tr_b16 v[36:37], v51 offset:16384
    ds_read_b64_tr_b16 v[38:39], v51 offset:18432
    v_mfma_f32_16x16x32_bf16 v[128:131], v[16:19], a[192:195], v[128:131]
    buffer_load_dwordx4 a[252:255], v63, s[48:51], s80 offen offset:3072 sc1
    v_mfma_f32_16x16x32_bf16 v[128:131], v[20:23], a[208:211], v[128:131]
    v_rcp_f32 v14, v14
    v_mfma_f32_16x16x32_bf16 v[132:135], v[20:23], a[212:215], v[132:135]
    v_rcp_f32 v15, v15
    v_mfma_f32_16x16x32_bf16 v[132:135], v[16:19], a[196:199], v[132:135]
    v_mul_f32 v14, v14, v12
    v_mul_f32 v15, v15, v13
    v_mfma_f32_16x16x32_bf16 v[136:139], v[16:19], a[200:203], v[136:139]
    ds_read_b64_tr_b16 v[40:41], v51 offset:4104
    ds_read_b64_tr_b16 v[42:43], v51 offset:6152
    v_mfma_f32_16x16x32_bf16 v[136:139], v[20:23], a[216:219], v[136:139]
    v_cvt_pk_bf16_f32 v54, v14, v15
    v_accvgpr_write_b32 a127, v54
    v_mfma_f32_16x16x32_bf16 v[140:143], v[20:23], a[220:223], v[140:143]
    v_accvgpr_read_b32 v12, a116
    v_accvgpr_read_b32 v13, a117
    v_mfma_f32_16x16x32_bf16 v[140:143], v[16:19], a[204:207], v[140:143]
    ds_read_b64_tr_b16 v[44:45], v51 offset:16392
    ds_read_b64_tr_b16 v[46:47], v51 offset:18440
    v_mfma_f32_16x16x32_bf16 v[156:159], v[24:27], a[204:207], v[156:159]
    v_mul_f32 v14, v12, v12
    v_mul_f32 v15, v13, v13
    v_mfma_f32_16x16x32_bf16 v[156:159], v[28:31], a[220:223], v[156:159]
    s_add_u32 s80, s80, 4096
    v_mfma_f32_16x16x32_bf16 v[152:155], v[28:31], a[216:219], v[152:155]
    buffer_load_dwordx4 a[144:147], v60, s[48:51], s80 offen sc1
    v_mfma_f32_16x16x32_bf16 v[152:155], v[24:27], a[200:203], v[152:155]
    v_fmaak_f32 v14, v14, v56, 0xc0135761
    v_fmaak_f32 v15, v15, v56, 0xc0135761
    v_mfma_f32_16x16x32_bf16 v[148:151], v[24:27], a[196:199], v[148:151]
    s_add_u32 m0, s34, 16256
    ds_read_b64_tr_b16 v[16:17], v50 offset:8192
    ds_read_b64_tr_b16 v[18:19], v50 offset:10240
    v_mfma_f32_16x16x32_bf16 v[148:151], v[28:31], a[212:215], v[148:151]
    buffer_load_dwordx4 v11, s[44:47], s79 offen offset:128 lds
    v_mfma_f32_16x16x32_bf16 v[144:147], v[28:31], a[208:211], v[144:147]
    v_mul_f32 v14, v14, v12
    v_mul_f32_e64 v15, v15, v13
    v_mfma_f32_16x16x32_bf16 v[144:147], v[24:27], a[192:195], v[144:147]
    s_waitcnt lgkmcnt(2)
    ds_read_b64_tr_b16 v[20:21], v50 offset:20480
    ds_read_b64_tr_b16 v[22:23], v50 offset:22528
    v_mfma_f32_16x16x32_bf16 v[160:163], v[32:35], a[192:195], v[160:163]
    buffer_store_dwordx4 a[124:127], v1, s[48:51], s60 offen offset:1024 sc1
    v_mfma_f32_16x16x32_bf16 v[160:163], v[36:39], a[208:211], v[160:163]
    v_exp_f32 v14, v14
    v_mfma_f32_16x16x32_bf16 v[164:167], v[36:39], a[212:215], v[164:167]
    v_exp_f32 v15, v15
    v_mfma_f32_16x16x32_bf16 v[164:167], v[32:35], a[196:199], v[164:167]
    v_add_f32_e64 v14, 1.0, v14
    v_add_f32_e64 v15, 1.0, v15
    v_mfma_f32_16x16x32_bf16 v[168:171], v[32:35], a[200:203], v[168:171]
    ds_read_b64_tr_b16 v[24:25], v50 offset:8200
    ds_read_b64_tr_b16 v[26:27], v50 offset:10248
    v_mfma_f32_16x16x32_bf16 v[168:171], v[36:39], a[216:219], v[168:171]
    buffer_load_dwordx4 a[148:151], v61, s[48:51], s80 offen sc1
    v_mfma_f32_16x16x32_bf16 v[172:175], v[36:39], a[220:223], v[172:175]
    v_rcp_f32_e64 v14, v14
    v_mfma_f32_16x16x32_bf16 v[172:175], v[32:35], a[204:207], v[172:175]
    ds_read_b64_tr_b16 v[28:29], v50 offset:20488
    ds_read_b64_tr_b16 v[30:31], v50 offset:22536
    v_mfma_f32_16x16x32_bf16 v[188:191], v[40:43], a[204:207], v[188:191]
    v_rcp_f32_e64 v15, v15
    v_mfma_f32_16x16x32_bf16 v[188:191], v[44:47], a[220:223], v[188:191]
    v_mul_f32_e64 v14, v14, v12
    v_mul_f32_e64 v15, v15, v13
    v_mfma_f32_16x16x32_bf16 v[184:187], v[44:47], a[216:219], v[184:187]
    s_add_u32 m0, s34, 20224
    v_mfma_f32_16x16x32_bf16 v[184:187], v[40:43], a[200:203], v[184:187]
    buffer_load_dwordx4 v11, s[44:47], s79 offen offset:256 lds
    v_mfma_f32_16x16x32_bf16 v[180:183], v[40:43], a[196:199], v[180:183]
    ds_read_b64_tr_b16 v[32:33], v51 offset:8192
    ds_read_b64_tr_b16 v[34:35], v51 offset:10240
    v_mfma_f32_16x16x32_bf16 v[180:183], v[44:47], a[212:215], v[180:183]
    v_cvt_pk_bf16_f32 v54, v14, v15
    v_accvgpr_write_b32 a128, v54
    v_mfma_f32_16x16x32_bf16 v[176:179], v[44:47], a[208:211], v[176:179]
    s_nop 0
    v_accvgpr_read_b32 v12, a118
    v_accvgpr_read_b32 v13, a119
    v_mfma_f32_16x16x32_bf16 v[176:179], v[40:43], a[192:195], v[176:179]
    s_waitcnt lgkmcnt(2)
    ds_read_b64_tr_b16 v[36:37], v51 offset:20480
    ds_read_b64_tr_b16 v[38:39], v51 offset:22528
    v_mfma_f32_16x16x32_bf16 v[192:195], v[16:19], a[192:195], v[192:195]
    buffer_load_dwordx4 a[152:155], v62, s[48:51], s80 offen sc1
    v_mfma_f32_16x16x32_bf16 v[192:195], v[20:23], a[208:211], v[192:195]
    v_mul_f32 v14, v12, v12
    v_mul_f32 v15, v13, v13
    v_mfma_f32_16x16x32_bf16 v[196:199], v[20:23], a[212:215], v[196:199]
    v_fmaak_f32 v14, v14, v56, 0xc0135761
    v_fmaak_f32 v15, v15, v56, 0xc0135761
    v_mfma_f32_16x16x32_bf16 v[196:199], v[16:19], a[196:199], v[196:199]
    v_mul_f32 v14, v14, v12
    v_mul_f32 v15, v15, v13
    v_mfma_f32_16x16x32_bf16 v[200:203], v[16:19], a[200:203], v[200:203]
    ds_read_b64_tr_b16 v[40:41], v51 offset:8200
    ds_read_b64_tr_b16 v[42:43], v51 offset:10248
    v_mfma_f32_16x16x32_bf16 v[200:203], v[20:23], a[216:219], v[200:203]
    v_exp_f32_e64 v14, v14
    v_mfma_f32_16x16x32_bf16 v[204:207], v[20:23], a[220:223], v[204:207]
    v_exp_f32_e64 v15, v15
    v_mfma_f32_16x16x32_bf16 v[204:207], v[16:19], a[204:207], v[204:207]
    ds_read_b64_tr_b16 v[44:45], v51 offset:20488
    ds_read_b64_tr_b16 v[46:47], v51 offset:22536
    v_mfma_f32_16x16x32_bf16 v[220:223], v[24:27], a[204:207], v[220:223]
    v_add_f32_e64 v14, 1.0, v14
    v_add_f32_e64 v15, 1.0, v15
    v_mfma_f32_16x16x32_bf16 v[220:223], v[28:31], a[220:223], v[220:223]
    v_rcp_f32_e64 v14, v14
    v_mfma_f32_16x16x32_bf16 v[216:219], v[28:31], a[216:219], v[216:219]
    s_add_u32 s79, s79, 393216
    s_add_u32 m0, s34, 24576
    v_mfma_f32_16x16x32_bf16 v[216:219], v[24:27], a[200:203], v[216:219]
    buffer_load_dwordx4 v11, s[44:47], s79 offen lds
    v_mfma_f32_16x16x32_bf16 v[212:215], v[24:27], a[196:199], v[212:215]
    ds_read_b64_tr_b16 v[16:17], v50 offset:24576
    ds_read_b64_tr_b16 v[18:19], v50 offset:26624
    v_mfma_f32_16x16x32_bf16 v[212:215], v[28:31], a[212:215], v[212:215]
    buffer_load_dwordx4 a[156:159], v63, s[48:51], s80 offen sc1
    v_mfma_f32_16x16x32_bf16 v[208:211], v[28:31], a[208:211], v[208:211]
    v_rcp_f32 v15, v15
    v_mfma_f32_16x16x32_bf16 v[208:211], v[24:27], a[192:195], v[208:211]
    s_waitcnt lgkmcnt(2)
    ds_read_b64_tr_b16 v[20:21], v50 offset:36864
    ds_read_b64_tr_b16 v[22:23], v50 offset:38912
    v_mfma_f32_16x16x32_bf16 v[224:227], v[32:35], a[192:195], v[224:227]
    v_mul_f32_e64 v14, v14, v12
    v_mul_f32_e64 v15, v15, v13
    v_mfma_f32_16x16x32_bf16 v[224:227], v[36:39], a[208:211], v[224:227]
    v_cvt_pk_bf16_f32 v54, v14, v15
    v_accvgpr_write_b32 a129, v54
    v_mfma_f32_16x16x32_bf16 v[228:231], v[36:39], a[212:215], v[228:231]
    v_lshrrev_b32_e64 v14, 9, v1
    v_lshlrev_b32_e64 v14, 8, v14
    v_mfma_f32_16x16x32_bf16 v[228:231], v[32:35], a[196:199], v[228:231]
    v_and_b32 v15, 0xf0, v1
    v_or_b32_e64 v14, v14, v15
    v_mfma_f32_16x16x32_bf16 v[232:235], v[32:35], a[200:203], v[232:235]
    ds_read_b64_tr_b16 v[24:25], v50 offset:24584
    ds_read_b64_tr_b16 v[26:27], v50 offset:26632
    v_mfma_f32_16x16x32_bf16 v[232:235], v[36:39], a[216:219], v[232:235]
    buffer_store_dwordx2 a[128:129], v1, s[48:51], s61 offen sc1
    v_mfma_f32_16x16x32_bf16 v[236:239], v[36:39], a[220:223], v[236:239]
    v_bfe_u32 v15, v1, 8, 1
    v_lshl_add_u32 v58, v15, 3, v14
    v_mfma_f32_16x16x32_bf16 v[236:239], v[32:35], a[204:207], v[236:239]
    ds_read_b64_tr_b16 v[28:29], v50 offset:36872
    ds_read_b64_tr_b16 v[30:31], v50 offset:38920
    v_mfma_f32_16x16x32_bf16 v[252:255], v[40:43], a[204:207], v[252:255]
    buffer_load_dwordx4 a[160:163], v60, s[48:51], s80 offen offset:1024 sc1
    v_mfma_f32_16x16x32_bf16 v[252:255], v[44:47], a[220:223], v[252:255]
    s_add_u32 m0, s34, 28544
    v_mfma_f32_16x16x32_bf16 v[248:251], v[44:47], a[216:219], v[248:251]
    buffer_load_dwordx4 v11, s[44:47], s79 offen offset:128 lds
    v_mfma_f32_16x16x32_bf16 v[248:251], v[40:43], a[200:203], v[248:251]
    v_bfe_u32 v12, v1, 4, 4
    v_add_u32_e64 v12, s62, v12
    v_mfma_f32_16x16x32_bf16 v[244:247], v[40:43], a[196:199], v[244:247]
    ds_read_b64_tr_b16 v[32:33], v51 offset:24576
    ds_read_b64_tr_b16 v[34:35], v51 offset:26624
    v_mfma_f32_16x16x32_bf16 v[244:247], v[44:47], a[212:215], v[244:247]
    v_and_b32 v54, 0x300, v1
    v_mov_b32 v56, 0x80000000
    v_mfma_f32_16x16x32_bf16 v[240:243], v[44:47], a[208:211], v[240:243]
    v_add_u32_e64 v14, -1, v12
    v_cmp_gt_u32 vcc, s68, v14
    v_mfma_f32_16x16x32_bf16 v[240:243], v[40:43], a[192:195], v[240:243]
    s_waitcnt vmcnt(25) lgkmcnt(2)
    ds_read_b64_tr_b16 v[36:37], v51 offset:36864
    ds_read_b64_tr_b16 v[38:39], v51 offset:38912
    v_mfma_f32_16x16x32_bf16 v[64:67], v[16:19], a[224:227], v[64:67]
    s_waitcnt vmcnt(16)
    v_mfma_f32_16x16x32_bf16 v[64:67], v[20:23], a[240:243], v[64:67]
    s_waitcnt vmcnt(15)
    buffer_load_dwordx4 a[164:167], v61, s[48:51], s80 offen offset:1024 sc1
    v_mfma_f32_16x16x32_bf16 v[68:71], v[20:23], a[244:247], v[68:71]
    v_lshrrev_b32_e64 v15, 4, v14
    v_mul_u32_u24 v15, 20480, v15
    v_mfma_f32_16x16x32_bf16 v[68:71], v[16:19], a[228:231], v[68:71]
    v_and_b32_e64 v14, 15, v14
    v_lshl_add_u32 v14, v14, 4, v15
    v_mfma_f32_16x16x32_bf16 v[72:75], v[16:19], a[232:235], v[72:75]
    s_waitcnt vmcnt(14)
    ds_read_b64_tr_b16 v[40:41], v51 offset:24584
    ds_read_b64_tr_b16 v[42:43], v51 offset:26632
    v_mfma_f32_16x16x32_bf16 v[72:75], v[20:23], a[248:251], v[72:75]
    s_waitcnt vmcnt(12)
    v_add_u32_e64 v14, v14, v54
    v_cndmask_b32 v6, v56, v14, vcc
    v_mfma_f32_16x16x32_bf16 v[76:79], v[20:23], a[252:255], v[76:79]
    v_add_u32_e64 v14, 1, v12
    v_cmp_gt_u32 vcc, s68, v14
    v_mfma_f32_16x16x32_bf16 v[76:79], v[16:19], a[236:239], v[76:79]
    ds_read_b64_tr_b16 v[44:45], v51 offset:36872
    ds_read_b64_tr_b16 v[46:47], v51 offset:38920
    v_mfma_f32_16x16x32_bf16 v[92:95], v[24:27], a[236:239], v[92:95]
    v_lshrrev_b32_e64 v15, 4, v14
    v_mul_u32_u24 v15, 20480, v15
    v_mfma_f32_16x16x32_bf16 v[92:95], v[28:31], a[252:255], v[92:95]
    s_add_u32 m0, s34, 32512
    v_mfma_f32_16x16x32_bf16 v[88:91], v[28:31], a[248:251], v[88:91]
    buffer_load_dwordx4 v11, s[44:47], s79 offen offset:256 lds
    v_mfma_f32_16x16x32_bf16 v[88:91], v[24:27], a[232:235], v[88:91]
    v_and_b32_e64 v14, 15, v14
    v_lshl_add_u32 v14, v14, 4, v15
    v_mfma_f32_16x16x32_bf16 v[84:87], v[24:27], a[228:231], v[84:87]
    ds_read_b64_tr_b16 v[16:17], v50 offset:28672
    ds_read_b64_tr_b16 v[18:19], v50 offset:30720
    v_mfma_f32_16x16x32_bf16 v[84:87], v[28:31], a[244:247], v[84:87]
    buffer_load_dwordx4 a[168:171], v62, s[48:51], s80 offen offset:1024 sc1
    v_mfma_f32_16x16x32_bf16 v[80:83], v[28:31], a[240:243], v[80:83]
    v_add_u32_e64 v14, v14, v54
    v_cndmask_b32 v7, v56, v14, vcc
    v_mfma_f32_16x16x32_bf16 v[80:83], v[24:27], a[224:227], v[80:83]
    s_waitcnt lgkmcnt(2)
    ds_read_b64_tr_b16 v[20:21], v50 offset:40960
    ds_read_b64_tr_b16 v[22:23], v50 offset:43008
    v_mfma_f32_16x16x32_bf16 v[96:99], v[32:35], a[224:227], v[96:99]
    v_add_u32 v14, -2, v12
    v_cmp_gt_u32 vcc, s68, v14
    v_mfma_f32_16x16x32_bf16 v[96:99], v[36:39], a[240:243], v[96:99]
    v_lshrrev_b32_e64 v15, 4, v14
    v_mul_u32_u24 v15, 20480, v15
    v_mfma_f32_16x16x32_bf16 v[100:103], v[36:39], a[244:247], v[100:103]
    v_and_b32_e64 v14, 15, v14
    v_lshl_add_u32 v14, v14, 4, v15
    v_mfma_f32_16x16x32_bf16 v[100:103], v[32:35], a[228:231], v[100:103]
    v_add_u32 v14, v14, v54
    v_cndmask_b32 v57, v56, v14, vcc
    v_mfma_f32_16x16x32_bf16 v[104:107], v[32:35], a[232:235], v[104:107]
    ds_read_b64_tr_b16 v[24:25], v50 offset:28680
    ds_read_b64_tr_b16 v[26:27], v50 offset:30728
    v_mfma_f32_16x16x32_bf16 v[104:107], v[36:39], a[248:251], v[104:107]
    v_add_u32 v14, 2, v12
    v_cmp_gt_u32 vcc, s68, v14
    v_mfma_f32_16x16x32_bf16 v[108:111], v[36:39], a[252:255], v[108:111]
    v_lshrrev_b32_e64 v15, 4, v14
    v_mul_u32_u24 v15, 20480, v15
    v_mfma_f32_16x16x32_bf16 v[108:111], v[32:35], a[236:239], v[108:111]
    ds_read_b64_tr_b16 v[28:29], v50 offset:40968
    ds_read_b64_tr_b16 v[30:31], v50 offset:43016
    v_mfma_f32_16x16x32_bf16 v[124:127], v[40:43], a[236:239], v[124:127]
    buffer_load_dwordx4 a[172:175], v63, s[48:51], s80 offen offset:1024 sc1
    v_mfma_f32_16x16x32_bf16 v[124:127], v[44:47], a[252:255], v[124:127]
    s_add_u32 s79, s79, 393216
    s_add_u32 m0, s34, 36864
    v_mfma_f32_16x16x32_bf16 v[120:123], v[44:47], a[248:251], v[120:123]
    buffer_load_dwordx4 v11, s[44:47], s79 offen lds
    v_mfma_f32_16x16x32_bf16 v[120:123], v[40:43], a[232:235], v[120:123]
    v_and_b32_e64 v14, 15, v14
    v_lshl_add_u32 v14, v14, 4, v15
    v_mfma_f32_16x16x32_bf16 v[116:119], v[40:43], a[228:231], v[116:119]
    ds_read_b64_tr_b16 v[32:33], v51 offset:28672
    ds_read_b64_tr_b16 v[34:35], v51 offset:30720
    v_mfma_f32_16x16x32_bf16 v[116:119], v[44:47], a[244:247], v[116:119]
    v_add_u32 v14, v14, v54
    v_cndmask_b32 v59, v56, v14, vcc
    v_mfma_f32_16x16x32_bf16 v[112:115], v[44:47], a[240:243], v[112:115]
    v_bfe_u32 v14, v1, 4, 2
    v_min_u32 v14, 2, v14
    v_mfma_f32_16x16x32_bf16 v[112:115], v[40:43], a[224:227], v[112:115]
    s_waitcnt lgkmcnt(2)
    ds_read_b64_tr_b16 v[36:37], v51 offset:40960
    ds_read_b64_tr_b16 v[38:39], v51 offset:43008
    v_mfma_f32_16x16x32_bf16 v[128:131], v[16:19], a[224:227], v[128:131]
    v_add3_u32 v14, v14, s31, 7
    v_and_b32_e64 v14, 7, v14
    v_mfma_f32_16x16x32_bf16 v[128:131], v[20:23], a[240:243], v[128:131]
    v_mfma_f32_16x16x32_bf16 v[132:135], v[20:23], a[244:247], v[132:135]
    buffer_load_dwordx4 a[192:195], v60, s[48:51], s80 offen offset:2048 sc1
    v_mfma_f32_16x16x32_bf16 v[132:135], v[16:19], a[228:231], v[132:135]
    v_lshlrev_b32_e64 v14, 8, v14
    v_mfma_f32_16x16x32_bf16 v[136:139], v[16:19], a[232:235], v[136:139]
    ds_read_b64_tr_b16 v[40:41], v51 offset:28680
    ds_read_b64_tr_b16 v[42:43], v51 offset:30728
    v_mfma_f32_16x16x32_bf16 v[136:139], v[20:23], a[248:251], v[136:139]
    v_mfma_f32_16x16x32_bf16 v[140:143], v[20:23], a[252:255], v[140:143]
    v_mfma_f32_16x16x32_bf16 v[140:143], v[16:19], a[236:239], v[140:143]
    ds_read_b64_tr_b16 v[44:45], v51 offset:40968
    ds_read_b64_tr_b16 v[46:47], v51 offset:43016
    v_mfma_f32_16x16x32_bf16 v[156:159], v[24:27], a[236:239], v[156:159]
    s_add_u32 m0, s34, 40832
    v_mfma_f32_16x16x32_bf16 v[156:159], v[28:31], a[252:255], v[156:159]
    buffer_load_dwordx4 v11, s[44:47], s79 offen offset:128 lds
    v_mfma_f32_16x16x32_bf16 v[152:155], v[28:31], a[248:251], v[152:155]
    v_mfma_f32_16x16x32_bf16 v[152:155], v[24:27], a[232:235], v[152:155]
    v_mfma_f32_16x16x32_bf16 v[148:151], v[24:27], a[228:231], v[148:151]
    ds_read_b64_tr_b16 v[16:17], v50 offset:32768
    ds_read_b64_tr_b16 v[18:19], v50 offset:34816
    v_mfma_f32_16x16x32_bf16 v[148:151], v[28:31], a[244:247], v[148:151]
    buffer_load_dwordx4 a[196:199], v61, s[48:51], s80 offen offset:2048 sc1
    v_mfma_f32_16x16x32_bf16 v[144:147], v[28:31], a[240:243], v[144:147]
    s_nop 0
    v_mfma_f32_16x16x32_bf16 v[144:147], v[24:27], a[224:227], v[144:147]
    s_waitcnt lgkmcnt(2)
    ds_read_b64_tr_b16 v[20:21], v50 offset:45056
    ds_read_b64_tr_b16 v[22:23], v50 offset:47104
    v_mfma_f32_16x16x32_bf16 v[160:163], v[32:35], a[224:227], v[160:163]
    v_mfma_f32_16x16x32_bf16 v[160:163], v[36:39], a[240:243], v[160:163]
    v_mfma_f32_16x16x32_bf16 v[164:167], v[36:39], a[244:247], v[164:167]
    v_mfma_f32_16x16x32_bf16 v[164:167], v[32:35], a[228:231], v[164:167]
    v_mfma_f32_16x16x32_bf16 v[168:171], v[32:35], a[232:235], v[168:171]
    ds_read_b64_tr_b16 v[24:25], v50 offset:32776
    ds_read_b64_tr_b16 v[26:27], v50 offset:34824
    v_mfma_f32_16x16x32_bf16 v[168:171], v[36:39], a[248:251], v[168:171]
    buffer_load_dword v13, v55, s[56:59], 0 offen sc1
    v_mfma_f32_16x16x32_bf16 v[172:175], v[36:39], a[252:255], v[172:175]
    v_mfma_f32_16x16x32_bf16 v[172:175], v[32:35], a[236:239], v[172:175]
    s_add_u32 m0, s34, 44800
    ds_read_b64_tr_b16 v[28:29], v50 offset:45064
    ds_read_b64_tr_b16 v[30:31], v50 offset:47112
    v_mfma_f32_16x16x32_bf16 v[188:191], v[40:43], a[236:239], v[188:191]
    buffer_load_dwordx4 v11, s[44:47], s79 offen offset:256 lds
    v_mfma_f32_16x16x32_bf16 v[188:191], v[44:47], a[252:255], v[188:191]
    v_mfma_f32_16x16x32_bf16 v[184:187], v[44:47], a[248:251], v[184:187]
    buffer_load_dwordx4 a[200:203], v62, s[48:51], s80 offen offset:2048 sc1
    v_mfma_f32_16x16x32_bf16 v[184:187], v[40:43], a[232:235], v[184:187]
    v_mfma_f32_16x16x32_bf16 v[180:183], v[40:43], a[228:231], v[180:183]
    ds_read_b64_tr_b16 v[32:33], v51 offset:32768
    ds_read_b64_tr_b16 v[34:35], v51 offset:34816
    v_mfma_f32_16x16x32_bf16 v[180:183], v[44:47], a[244:247], v[180:183]
    v_mfma_f32_16x16x32_bf16 v[176:179], v[44:47], a[240:243], v[176:179]
    v_mfma_f32_16x16x32_bf16 v[176:179], v[40:43], a[224:227], v[176:179]
    s_waitcnt lgkmcnt(2)
    ds_read_b64_tr_b16 v[36:37], v51 offset:45056
    ds_read_b64_tr_b16 v[38:39], v51 offset:47104
    v_mfma_f32_16x16x32_bf16 v[192:195], v[16:19], a[224:227], v[192:195]
    s_nop 0
    v_mfma_f32_16x16x32_bf16 v[192:195], v[20:23], a[240:243], v[192:195]
    v_mfma_f32_16x16x32_bf16 v[196:199], v[20:23], a[244:247], v[196:199]
    ds_read_b64_tr_b16 v[40:41], v51 offset:32776
    ds_read_b64_tr_b16 v[42:43], v51 offset:34824
    v_mfma_f32_16x16x32_bf16 v[196:199], v[16:19], a[228:231], v[196:199]
    buffer_load_dwordx4 a[204:207], v63, s[48:51], s80 offen offset:2048 sc1
    v_mfma_f32_16x16x32_bf16 v[200:203], v[16:19], a[232:235], v[200:203]
    v_mfma_f32_16x16x32_bf16 v[200:203], v[20:23], a[248:251], v[200:203]
    ds_read_b64_tr_b16 v[44:45], v51 offset:45064
    ds_read_b64_tr_b16 v[46:47], v51 offset:47112
    v_mfma_f32_16x16x32_bf16 v[204:207], v[20:23], a[252:255], v[204:207]
    v_mfma_f32_16x16x32_bf16 v[204:207], v[16:19], a[236:239], v[204:207]
    v_mfma_f32_16x16x32_bf16 v[220:223], v[24:27], a[236:239], v[220:223]
    v_mfma_f32_16x16x32_bf16 v[220:223], v[28:31], a[252:255], v[220:223]
    v_mfma_f32_16x16x32_bf16 v[216:219], v[28:31], a[248:251], v[216:219]
    v_mfma_f32_16x16x32_bf16 v[216:219], v[24:27], a[232:235], v[216:219]
    v_mfma_f32_16x16x32_bf16 v[212:215], v[24:27], a[228:231], v[212:215]
    s_waitcnt lgkmcnt(0)
    s_barrier
    v_mfma_f32_16x16x32_bf16 v[212:215], v[28:31], a[244:247], v[212:215]
    ds_read_b64_tr_b16 v[16:17], v52 offset:0
    ds_read_b64_tr_b16 v[18:19], v52 offset:2048
    v_mfma_f32_16x16x32_bf16 v[208:211], v[28:31], a[240:243], v[208:211]
    v_mfma_f32_16x16x32_bf16 v[208:211], v[24:27], a[224:227], v[208:211]
    ds_read_b64_tr_b16 v[20:21], v52 offset:12288
    ds_read_b64_tr_b16 v[22:23], v52 offset:14336
    v_mfma_f32_16x16x32_bf16 v[224:227], v[32:35], a[224:227], v[224:227]
    s_add_u32 s79, s79, 393216
    s_add_u32 m0, s34, 49152
    v_mfma_f32_16x16x32_bf16 v[224:227], v[36:39], a[240:243], v[224:227]
    buffer_load_dwordx4 v11, s[44:47], s79 offen lds
    v_mfma_f32_16x16x32_bf16 v[228:231], v[36:39], a[244:247], v[228:231]
    v_mfma_f32_16x16x32_bf16 v[228:231], v[32:35], a[228:231], v[228:231]
    buffer_load_dwordx4 a[208:211], v60, s[48:51], s80 offen offset:3072 sc1
    v_mfma_f32_16x16x32_bf16 v[232:235], v[32:35], a[232:235], v[232:235]
    ds_read_b64_tr_b16 v[24:25], v52 offset:8
    ds_read_b64_tr_b16 v[26:27], v52 offset:2056
    v_mfma_f32_16x16x32_bf16 v[232:235], v[36:39], a[248:251], v[232:235]
    v_mfma_f32_16x16x32_bf16 v[236:239], v[36:39], a[252:255], v[236:239]
    v_mfma_f32_16x16x32_bf16 v[236:239], v[32:35], a[236:239], v[236:239]
    ds_read_b64_tr_b16 v[28:29], v52 offset:12296
    ds_read_b64_tr_b16 v[30:31], v52 offset:14344
    v_mfma_f32_16x16x32_bf16 v[252:255], v[40:43], a[236:239], v[252:255]
    v_mfma_f32_16x16x32_bf16 v[252:255], v[44:47], a[252:255], v[252:255]
    buffer_load_dwordx4 a[212:215], v61, s[48:51], s80 offen offset:3072 sc1
    v_mfma_f32_16x16x32_bf16 v[248:251], v[44:47], a[248:251], v[248:251]
    s_add_u32 m0, s34, 53120
    v_mfma_f32_16x16x32_bf16 v[248:251], v[40:43], a[232:235], v[248:251]
    buffer_load_dwordx4 v11, s[44:47], s79 offen offset:128 lds
    v_mfma_f32_16x16x32_bf16 v[244:247], v[40:43], a[228:231], v[244:247]
    ds_read_b64_tr_b16 v[32:33], v53 offset:0
    ds_read_b64_tr_b16 v[34:35], v53 offset:2048
    v_mfma_f32_16x16x32_bf16 v[244:247], v[44:47], a[244:247], v[244:247]
    v_mfma_f32_16x16x32_bf16 v[240:243], v[44:47], a[240:243], v[240:243]
    s_nop 0
    v_mfma_f32_16x16x32_bf16 v[240:243], v[40:43], a[224:227], v[240:243]
    s_waitcnt vmcnt(26) lgkmcnt(2)
    ds_read_b64_tr_b16 v[36:37], v53 offset:12288
    ds_read_b64_tr_b16 v[38:39], v53 offset:14336
    v_mfma_f32_16x16x32_bf16 v[64:67], v[16:19], a[144:147], v[64:67]
    s_waitcnt vmcnt(17)
    v_mfma_f32_16x16x32_bf16 v[64:67], v[20:23], a[160:163], v[64:67]
    s_waitcnt vmcnt(15)
    v_mfma_f32_16x16x32_bf16 v[68:71], v[20:23], a[164:167], v[68:71]
    s_nop 0
    v_mfma_f32_16x16x32_bf16 v[68:71], v[16:19], a[148:151], v[68:71]
    s_nop 0
    v_mfma_f32_16x16x32_bf16 v[72:75], v[16:19], a[152:155], v[72:75]
    s_waitcnt vmcnt(13)
    ds_read_b64_tr_b16 v[40:41], v53 offset:8
    ds_read_b64_tr_b16 v[42:43], v53 offset:2056
    v_mfma_f32_16x16x32_bf16 v[72:75], v[20:23], a[168:171], v[72:75]
    s_waitcnt vmcnt(12)
    buffer_load_dwordx4 a[216:219], v62, s[48:51], s80 offen offset:3072 sc1
    v_mfma_f32_16x16x32_bf16 v[76:79], v[20:23], a[172:175], v[76:79]
    v_mfma_f32_16x16x32_bf16 v[76:79], v[16:19], a[156:159], v[76:79]
    ds_read_b64_tr_b16 v[44:45], v53 offset:12296
    ds_read_b64_tr_b16 v[46:47], v53 offset:14344
    v_mfma_f32_16x16x32_bf16 v[92:95], v[24:27], a[156:159], v[92:95]
    v_mfma_f32_16x16x32_bf16 v[92:95], v[28:31], a[172:175], v[92:95]
    v_mfma_f32_16x16x32_bf16 v[88:91], v[28:31], a[168:171], v[88:91]
    s_add_u32 m0, s34, 57088
    v_mfma_f32_16x16x32_bf16 v[88:91], v[24:27], a[152:155], v[88:91]
    buffer_load_dwordx4 v11, s[44:47], s79 offen offset:256 lds
    v_mfma_f32_16x16x32_bf16 v[84:87], v[24:27], a[148:151], v[84:87]
    ds_read_b64_tr_b16 v[16:17], v52 offset:4096
    ds_read_b64_tr_b16 v[18:19], v52 offset:6144
    v_mfma_f32_16x16x32_bf16 v[84:87], v[28:31], a[164:167], v[84:87]
    v_mfma_f32_16x16x32_bf16 v[80:83], v[28:31], a[160:163], v[80:83]
    s_nop 0
    v_mfma_f32_16x16x32_bf16 v[80:83], v[24:27], a[144:147], v[80:83]
    s_waitcnt lgkmcnt(2)
    ds_read_b64_tr_b16 v[20:21], v52 offset:16384
    ds_read_b64_tr_b16 v[22:23], v52 offset:18432
    v_mfma_f32_16x16x32_bf16 v[96:99], v[32:35], a[144:147], v[96:99]
    buffer_load_dwordx4 a[220:223], v63, s[48:51], s80 offen offset:3072 sc1
    v_mfma_f32_16x16x32_bf16 v[96:99], v[36:39], a[160:163], v[96:99]
    v_mfma_f32_16x16x32_bf16 v[100:103], v[36:39], a[164:167], v[100:103]
    v_mfma_f32_16x16x32_bf16 v[100:103], v[32:35], a[148:151], v[100:103]
    v_mfma_f32_16x16x32_bf16 v[104:107], v[32:35], a[152:155], v[104:107]
    ds_read_b64_tr_b16 v[24:25], v52 offset:4104
    ds_read_b64_tr_b16 v[26:27], v52 offset:6152
    v_mfma_f32_16x16x32_bf16 v[104:107], v[36:39], a[168:171], v[104:107]
    v_mfma_f32_16x16x32_bf16 v[108:111], v[36:39], a[172:175], v[108:111]
    v_mfma_f32_16x16x32_bf16 v[108:111], v[32:35], a[156:159], v[108:111]
    ds_read_b64_tr_b16 v[28:29], v52 offset:16392
    ds_read_b64_tr_b16 v[30:31], v52 offset:18440
    v_mfma_f32_16x16x32_bf16 v[124:127], v[40:43], a[156:159], v[124:127]
    v_mfma_f32_16x16x32_bf16 v[124:127], v[44:47], a[172:175], v[124:127]
    s_add_u32 s80, s80, 4096
    v_mfma_f32_16x16x32_bf16 v[120:123], v[44:47], a[168:171], v[120:123]
    buffer_load_dwordx4 a[224:227], v60, s[48:51], s80 offen sc1
    v_mfma_f32_16x16x32_bf16 v[120:123], v[40:43], a[152:155], v[120:123]
    v_mfma_f32_16x16x32_bf16 v[116:119], v[40:43], a[148:151], v[116:119]
    ds_read_b64_tr_b16 v[32:33], v53 offset:4096
    ds_read_b64_tr_b16 v[34:35], v53 offset:6144
    v_mfma_f32_16x16x32_bf16 v[116:119], v[44:47], a[164:167], v[116:119]
    s_add_u32 s79, s79, 393216
    s_add_u32 m0, s34, 61440
    v_mfma_f32_16x16x32_bf16 v[112:115], v[44:47], a[160:163], v[112:115]
    buffer_load_dwordx4 v11, s[44:47], s79 offen lds
    v_mfma_f32_16x16x32_bf16 v[112:115], v[40:43], a[144:147], v[112:115]
    s_waitcnt lgkmcnt(2)
    ds_read_b64_tr_b16 v[36:37], v53 offset:16384
    ds_read_b64_tr_b16 v[38:39], v53 offset:18432
    v_mfma_f32_16x16x32_bf16 v[128:131], v[16:19], a[144:147], v[128:131]
    s_nop 0
    v_mfma_f32_16x16x32_bf16 v[128:131], v[20:23], a[160:163], v[128:131]
    v_mfma_f32_16x16x32_bf16 v[132:135], v[20:23], a[164:167], v[132:135]
    v_mfma_f32_16x16x32_bf16 v[132:135], v[16:19], a[148:151], v[132:135]
    v_mfma_f32_16x16x32_bf16 v[136:139], v[16:19], a[152:155], v[136:139]
    ds_read_b64_tr_b16 v[40:41], v53 offset:4104
    ds_read_b64_tr_b16 v[42:43], v53 offset:6152
    v_mfma_f32_16x16x32_bf16 v[136:139], v[20:23], a[168:171], v[136:139]
    buffer_load_dwordx4 a[228:231], v61, s[48:51], s80 offen sc1
    v_mfma_f32_16x16x32_bf16 v[140:143], v[20:23], a[172:175], v[140:143]
    s_nop 0
    v_mfma_f32_16x16x32_bf16 v[140:143], v[16:19], a[156:159], v[140:143]
    s_nop 0
    ds_read_b64_tr_b16 v[44:45], v53 offset:16392
    ds_read_b64_tr_b16 v[46:47], v53 offset:18440
    v_mfma_f32_16x16x32_bf16 v[156:159], v[24:27], a[156:159], v[156:159]
    v_mfma_f32_16x16x32_bf16 v[156:159], v[28:31], a[172:175], v[156:159]
    s_add_u32 m0, s34, 65408
    v_mfma_f32_16x16x32_bf16 v[152:155], v[28:31], a[168:171], v[152:155]
    buffer_load_dwordx4 v11, s[44:47], s79 offen offset:128 lds
    v_mfma_f32_16x16x32_bf16 v[152:155], v[24:27], a[152:155], v[152:155]
    v_mfma_f32_16x16x32_bf16 v[148:151], v[24:27], a[148:151], v[148:151]
    ds_read_b64_tr_b16 v[16:17], v52 offset:8192
    ds_read_b64_tr_b16 v[18:19], v52 offset:10240
    v_mfma_f32_16x16x32_bf16 v[148:151], v[28:31], a[164:167], v[148:151]
    v_mfma_f32_16x16x32_bf16 v[144:147], v[28:31], a[160:163], v[144:147]
    s_nop 0
    v_mfma_f32_16x16x32_bf16 v[144:147], v[24:27], a[144:147], v[144:147]
    s_waitcnt lgkmcnt(2)
    ds_read_b64_tr_b16 v[20:21], v52 offset:20480
    ds_read_b64_tr_b16 v[22:23], v52 offset:22528
    v_mfma_f32_16x16x32_bf16 v[160:163], v[32:35], a[144:147], v[160:163]
    buffer_load_dwordx4 a[232:235], v62, s[48:51], s80 offen sc1
    v_mfma_f32_16x16x32_bf16 v[160:163], v[36:39], a[160:163], v[160:163]
    v_mfma_f32_16x16x32_bf16 v[164:167], v[36:39], a[164:167], v[164:167]
    v_mfma_f32_16x16x32_bf16 v[164:167], v[32:35], a[148:151], v[164:167]
    v_mfma_f32_16x16x32_bf16 v[168:171], v[32:35], a[152:155], v[168:171]
    s_barrier
    s_waitcnt vmcnt(15)
    v_cmp_gt_u32 vcc, 20, v13
    s_cbranch_vccnz L_slow4
L_ok4:
    s_cmp_lg_u32 s30, 0
    s_cbranch_scc1 L_sig6
    s_lshl_b32 s3, s31, 8
    s_add_u32 s3, s3, 79693824
    s_mov_b64 exec, 1
    v_mov_b32_e64 v2, 0
    v_mov_b32_e64 v10, 1
    buffer_atomic_add v10, v2, s[48:51], s3 offen
    s_mov_b64 exec, -1
L_sig6:
    v_mfma_f32_16x16x32_bf16 v[168:171], v[36:39], a[168:171], v[168:171]
    s_nop 0
    ds_read_b64_tr_b16 v[24:25], v52 offset:8200
    ds_read_b64_tr_b16 v[26:27], v52 offset:10248
    v_mfma_f32_16x16x32_bf16 v[172:175], v[36:39], a[172:175], v[172:175]
    v_mfma_f32_16x16x32_bf16 v[172:175], v[32:35], a[156:159], v[172:175]
    ds_read_b64_tr_b16 v[28:29], v52 offset:20488
    ds_read_b64_tr_b16 v[30:31], v52 offset:22536
    v_mfma_f32_16x16x32_bf16 v[188:191], v[40:43], a[156:159], v[188:191]
    v_mfma_f32_16x16x32_bf16 v[188:191], v[44:47], a[172:175], v[188:191]
    s_add_u32 m0, s34, 69376
    v_mfma_f32_16x16x32_bf16 v[184:187], v[44:47], a[168:171], v[184:187]
    buffer_load_dwordx4 v11, s[44:47], s79 offen offset:256 lds
    v_mfma_f32_16x16x32_bf16 v[184:187], v[40:43], a[152:155], v[184:187]
    v_mfma_f32_16x16x32_bf16 v[180:183], v[40:43], a[148:151], v[180:183]
    ds_read_b64_tr_b16 v[32:33], v53 offset:8192
    ds_read_b64_tr_b16 v[34:35], v53 offset:10240
    v_mfma_f32_16x16x32_bf16 v[180:183], v[44:47], a[164:167], v[180:183]
    buffer_load_dwordx4 a[236:239], v63, s[48:51], s80 offen sc1
    v_mfma_f32_16x16x32_bf16 v[176:179], v[44:47], a[160:163], v[176:179]
    s_nop 0
    v_mfma_f32_16x16x32_bf16 v[176:179], v[40:43], a[144:147], v[176:179]
    s_waitcnt lgkmcnt(2)
    ds_read_b64_tr_b16 v[36:37], v53 offset:20480
    ds_read_b64_tr_b16 v[38:39], v53 offset:22528
    v_mfma_f32_16x16x32_bf16 v[192:195], v[16:19], a[144:147], v[192:195]
    v_mfma_f32_16x16x32_bf16 v[192:195], v[20:23], a[160:163], v[192:195]
    v_mfma_f32_16x16x32_bf16 v[196:199], v[20:23], a[164:167], v[196:199]
    v_mfma_f32_16x16x32_bf16 v[196:199], v[16:19], a[148:151], v[196:199]
    v_mfma_f32_16x16x32_bf16 v[200:203], v[16:19], a[152:155], v[200:203]
    ds_read_b64_tr_b16 v[40:41], v53 offset:8200
    ds_read_b64_tr_b16 v[42:43], v53 offset:10248
    v_mfma_f32_16x16x32_bf16 v[200:203], v[20:23], a[168:171], v[200:203]
    v_mfma_f32_16x16x32_bf16 v[204:207], v[20:23], a[172:175], v[204:207]
    v_mfma_f32_16x16x32_bf16 v[204:207], v[16:19], a[156:159], v[204:207]
    ds_read_b64_tr_b16 v[44:45], v53 offset:20488
    ds_read_b64_tr_b16 v[46:47], v53 offset:22536
    v_mfma_f32_16x16x32_bf16 v[220:223], v[24:27], a[156:159], v[220:223]
    buffer_load_dwordx4 a[240:243], v60, s[48:51], s80 offen offset:1024 sc1
    v_mfma_f32_16x16x32_bf16 v[220:223], v[28:31], a[172:175], v[220:223]
    s_add_u32 s79, s79, 393216
    s_add_u32 m0, s34, 73728
    v_mfma_f32_16x16x32_bf16 v[216:219], v[28:31], a[168:171], v[216:219]
    buffer_load_dwordx4 v11, s[44:47], s79 offen lds
    v_mfma_f32_16x16x32_bf16 v[216:219], v[24:27], a[152:155], v[216:219]
    v_mfma_f32_16x16x32_bf16 v[212:215], v[24:27], a[148:151], v[212:215]
    ds_read_b64_tr_b16 v[16:17], v52 offset:24576
    ds_read_b64_tr_b16 v[18:19], v52 offset:26624
    v_mfma_f32_16x16x32_bf16 v[212:215], v[28:31], a[164:167], v[212:215]
    v_mfma_f32_16x16x32_bf16 v[208:211], v[28:31], a[160:163], v[208:211]
    v_mfma_f32_16x16x32_bf16 v[208:211], v[24:27], a[144:147], v[208:211]
    s_waitcnt lgkmcnt(2)
    ds_read_b64_tr_b16 v[20:21], v52 offset:36864
    ds_read_b64_tr_b16 v[22:23], v52 offset:38912
    v_mfma_f32_16x16x32_bf16 v[224:227], v[32:35], a[144:147], v[224:227]
    s_nop 0
    v_mfma_f32_16x16x32_bf16 v[224:227], v[36:39], a[160:163], v[224:227]
    v_mfma_f32_16x16x32_bf16 v[228:231], v[36:39], a[164:167], v[228:231]
    buffer_load_dwordx4 a[244:247], v61, s[48:51], s80 offen offset:1024 sc1
    v_mfma_f32_16x16x32_bf16 v[228:231], v[32:35], a[148:151], v[228:231]
    v_mfma_f32_16x16x32_bf16 v[232:235], v[32:35], a[152:155], v[232:235]
    ds_read_b64_tr_b16 v[24:25], v52 offset:24584
    ds_read_b64_tr_b16 v[26:27], v52 offset:26632
    v_mfma_f32_16x16x32_bf16 v[232:235], v[36:39], a[168:171], v[232:235]
    v_mfma_f32_16x16x32_bf16 v[236:239], v[36:39], a[172:175], v[236:239]
    v_mfma_f32_16x16x32_bf16 v[236:239], v[32:35], a[156:159], v[236:239]
    ds_read_b64_tr_b16 v[28:29], v52 offset:36872
    ds_read_b64_tr_b16 v[30:31], v52 offset:38920
    v_mfma_f32_16x16x32_bf16 v[252:255], v[40:43], a[156:159], v[252:255]
    s_add_u32 m0, s34, 77696
    v_mfma_f32_16x16x32_bf16 v[252:255], v[44:47], a[172:175], v[252:255]
    buffer_load_dwordx4 v11, s[44:47], s79 offen offset:128 lds
    v_mfma_f32_16x16x32_bf16 v[248:251], v[44:47], a[168:171], v[248:251]
    v_mfma_f32_16x16x32_bf16 v[248:251], v[40:43], a[152:155], v[248:251]
    v_mfma_f32_16x16x32_bf16 v[244:247], v[40:43], a[148:151], v[244:247]
    ds_read_b64_tr_b16 v[32:33], v53 offset:24576
    ds_read_b64_tr_b16 v[34:35], v53 offset:26624
    v_mfma_f32_16x16x32_bf16 v[244:247], v[44:47], a[164:167], v[244:247]
    buffer_load_dwordx4 a[248:251], v62, s[48:51], s80 offen offset:1024 sc1
    v_mfma_f32_16x16x32_bf16 v[240:243], v[44:47], a[160:163], v[240:243]
    s_nop 0
    v_mfma_f32_16x16x32_bf16 v[240:243], v[40:43], a[144:147], v[240:243]
    s_waitcnt lgkmcnt(2)
    ds_read_b64_tr_b16 v[36:37], v53 offset:36864
    ds_read_b64_tr_b16 v[38:39], v53 offset:38912
    v_mfma_f32_16x16x32_bf16 v[64:67], v[16:19], a[192:195], v[64:67]
    s_waitcnt vmcnt(17)
    v_mfma_f32_16x16x32_bf16 v[64:67], v[20:23], a[208:211], v[64:67]
    s_waitcnt vmcnt(16)
    v_mfma_f32_16x16x32_bf16 v[68:71], v[20:23], a[212:215], v[68:71]
    v_mfma_f32_16x16x32_bf16 v[68:71], v[16:19], a[196:199], v[68:71]
    s_nop 0
    v_mfma_f32_16x16x32_bf16 v[72:75], v[16:19], a[200:203], v[72:75]
    s_waitcnt vmcnt(14)
    ds_read_b64_tr_b16 v[40:41], v53 offset:24584
    ds_read_b64_tr_b16 v[42:43], v53 offset:26632
    v_mfma_f32_16x16x32_bf16 v[72:75], v[20:23], a[216:219], v[72:75]
    s_waitcnt vmcnt(12)
    v_mfma_f32_16x16x32_bf16 v[76:79], v[20:23], a[220:223], v[76:79]
    s_nop 0
    v_mfma_f32_16x16x32_bf16 v[76:79], v[16:19], a[204:207], v[76:79]
    ds_read_b64_tr_b16 v[44:45], v53 offset:36872
    ds_read_b64_tr_b16 v[46:47], v53 offset:38920
    v_mfma_f32_16x16x32_bf16 v[92:95], v[24:27], a[204:207], v[92:95]
    buffer_load_dwordx4 a[252:255], v63, s[48:51], s80 offen offset:1024 sc1
    v_mfma_f32_16x16x32_bf16 v[92:95], v[28:31], a[220:223], v[92:95]
    s_add_u32 m0, s34, 81664
    v_mfma_f32_16x16x32_bf16 v[88:91], v[28:31], a[216:219], v[88:91]
    buffer_load_dwordx4 v11, s[44:47], s79 offen offset:256 lds
    v_mfma_f32_16x16x32_bf16 v[88:91], v[24:27], a[200:203], v[88:91]
    v_mfma_f32_16x16x32_bf16 v[84:87], v[24:27], a[196:199], v[84:87]
    ds_read_b64_tr_b16 v[16:17], v52 offset:28672
    ds_read_b64_tr_b16 v[18:19], v52 offset:30720
    v_mfma_f32_16x16x32_bf16 v[84:87], v[28:31], a[212:215], v[84:87]
    v_mfma_f32_16x16x32_bf16 v[80:83], v[28:31], a[208:211], v[80:83]
    v_mfma_f32_16x16x32_bf16 v[80:83], v[24:27], a[192:195], v[80:83]
    s_waitcnt lgkmcnt(2)
    ds_read_b64_tr_b16 v[20:21], v52 offset:40960
    ds_read_b64_tr_b16 v[22:23], v52 offset:43008
    v_mfma_f32_16x16x32_bf16 v[96:99], v[32:35], a[192:195], v[96:99]
    s_nop 0
    v_mfma_f32_16x16x32_bf16 v[96:99], v[36:39], a[208:211], v[96:99]
    v_mfma_f32_16x16x32_bf16 v[100:103], v[36:39], a[212:215], v[100:103]
    v_mfma_f32_16x16x32_bf16 v[100:103], v[32:35], a[196:199], v[100:103]
    buffer_load_dwordx4 a[144:147], v60, s[48:51], s80 offen offset:2048 sc1
    v_mfma_f32_16x16x32_bf16 v[104:107], v[32:35], a[200:203], v[104:107]
    ds_read_b64_tr_b16 v[24:25], v52 offset:28680
    ds_read_b64_tr_b16 v[26:27], v52 offset:30728
    v_mfma_f32_16x16x32_bf16 v[104:107], v[36:39], a[216:219], v[104:107]
    v_mfma_f32_16x16x32_bf16 v[108:111], v[36:39], a[220:223], v[108:111]
    s_nop 0
    v_mfma_f32_16x16x32_bf16 v[108:111], v[32:35], a[204:207], v[108:111]
    s_nop 0
    ds_read_b64_tr_b16 v[28:29], v52 offset:40968
    ds_read_b64_tr_b16 v[30:31], v52 offset:43016
    v_mfma_f32_16x16x32_bf16 v[124:127], v[40:43], a[204:207], v[124:127]
    s_add_u32 s79, s79, 393216
    s_add_u32 m0, s34, 86016
    v_mfma_f32_16x16x32_bf16 v[124:127], v[44:47], a[220:223], v[124:127]
    buffer_load_dwordx4 v11, s[44:47], s79 offen lds
    v_mfma_f32_16x16x32_bf16 v[120:123], v[44:47], a[216:219], v[120:123]
    v_mfma_f32_16x16x32_bf16 v[120:123], v[40:43], a[200:203], v[120:123]
    v_mfma_f32_16x16x32_bf16 v[116:119], v[40:43], a[196:199], v[116:119]
    ds_read_b64_tr_b16 v[32:33], v53 offset:28672
    ds_read_b64_tr_b16 v[34:35], v53 offset:30720
    v_mfma_f32_16x16x32_bf16 v[116:119], v[44:47], a[212:215], v[116:119]
    s_nop 0
    v_mfma_f32_16x16x32_bf16 v[112:115], v[44:47], a[208:211], v[112:115]
    buffer_load_dwordx4 a[148:151], v61, s[48:51], s80 offen offset:2048 sc1
    v_mfma_f32_16x16x32_bf16 v[112:115], v[40:43], a[192:195], v[112:115]
    s_waitcnt lgkmcnt(2)
    ds_read_b64_tr_b16 v[36:37], v53 offset:40960
    ds_read_b64_tr_b16 v[38:39], v53 offset:43008
    v_mfma_f32_16x16x32_bf16 v[128:131], v[16:19], a[192:195], v[128:131]
    v_mfma_f32_16x16x32_bf16 v[128:131], v[20:23], a[208:211], v[128:131]
    v_mfma_f32_16x16x32_bf16 v[132:135], v[20:23], a[212:215], v[132:135]
    v_mfma_f32_16x16x32_bf16 v[132:135], v[16:19], a[196:199], v[132:135]
    v_mfma_f32_16x16x32_bf16 v[136:139], v[16:19], a[200:203], v[136:139]
    ds_read_b64_tr_b16 v[40:41], v53 offset:28680
    ds_read_b64_tr_b16 v[42:43], v53 offset:30728
    v_mfma_f32_16x16x32_bf16 v[136:139], v[20:23], a[216:219], v[136:139]
    v_mfma_f32_16x16x32_bf16 v[140:143], v[20:23], a[220:223], v[140:143]
    v_mfma_f32_16x16x32_bf16 v[140:143], v[16:19], a[204:207], v[140:143]
    s_add_u32 m0, s34, 89984
    ds_read_b64_tr_b16 v[44:45], v53 offset:40968
    ds_read_b64_tr_b16 v[46:47], v53 offset:43016
    v_mfma_f32_16x16x32_bf16 v[156:159], v[24:27], a[204:207], v[156:159]
    buffer_load_dwordx4 v11, s[44:47], s79 offen offset:128 lds
    v_mfma_f32_16x16x32_bf16 v[156:159], v[28:31], a[220:223], v[156:159]
    v_mfma_f32_16x16x32_bf16 v[152:155], v[28:31], a[216:219], v[152:155]
    buffer_load_dwordx4 a[152:155], v62, s[48:51], s80 offen offset:2048 sc1
    v_mfma_f32_16x16x32_bf16 v[152:155], v[24:27], a[200:203], v[152:155]
    v_mfma_f32_16x16x32_bf16 v[148:151], v[24:27], a[196:199], v[148:151]
    ds_read_b64_tr_b16 v[16:17], v52 offset:32768
    ds_read_b64_tr_b16 v[18:19], v52 offset:34816
    v_mfma_f32_16x16x32_bf16 v[148:151], v[28:31], a[212:215], v[148:151]
    v_mfma_f32_16x16x32_bf16 v[144:147], v[28:31], a[208:211], v[144:147]
    s_nop 0
    v_mfma_f32_16x16x32_bf16 v[144:147], v[24:27], a[192:195], v[144:147]
    s_waitcnt lgkmcnt(2)
    ds_read_b64_tr_b16 v[20:21], v52 offset:45056
    ds_read_b64_tr_b16 v[22:23], v52 offset:47104
    v_mfma_f32_16x16x32_bf16 v[160:163], v[32:35], a[192:195], v[160:163]
    v_mfma_f32_16x16x32_bf16 v[160:163], v[36:39], a[208:211], v[160:163]
    v_mfma_f32_16x16x32_bf16 v[164:167], v[36:39], a[212:215], v[164:167]
    v_mfma_f32_16x16x32_bf16 v[164:167], v[32:35], a[196:199], v[164:167]
    v_mfma_f32_16x16x32_bf16 v[168:171], v[32:35], a[200:203], v[168:171]
    ds_read_b64_tr_b16 v[24:25], v52 offset:32776
    ds_read_b64_tr_b16 v[26:27], v52 offset:34824
    v_mfma_f32_16x16x32_bf16 v[168:171], v[36:39], a[216:219], v[168:171]
    buffer_load_dwordx4 a[156:159], v63, s[48:51], s80 offen offset:2048 sc1
    v_mfma_f32_16x16x32_bf16 v[172:175], v[36:39], a[220:223], v[172:175]
    v_mfma_f32_16x16x32_bf16 v[172:175], v[32:35], a[204:207], v[172:175]
    s_add_u32 m0, s34, 93952
    ds_read_b64_tr_b16 v[28:29], v52 offset:45064
    ds_read_b64_tr_b16 v[30:31], v52 offset:47112
    v_mfma_f32_16x16x32_bf16 v[188:191], v[40:43], a[204:207], v[188:191]
    buffer_load_dwordx4 v11, s[44:47], s79 offen offset:256 lds
    v_mfma_f32_16x16x32_bf16 v[188:191], v[44:47], a[220:223], v[188:191]
    v_mfma_f32_16x16x32_bf16 v[184:187], v[44:47], a[216:219], v[184:187]
    v_mfma_f32_16x16x32_bf16 v[184:187], v[40:43], a[200:203], v[184:187]
    v_mfma_f32_16x16x32_bf16 v[180:183], v[40:43], a[196:199], v[180:183]
    ds_read_b64_tr_b16 v[32:33], v53 offset:32768
    ds_read_b64_tr_b16 v[34:35], v53 offset:34816
    v_mfma_f32_16x16x32_bf16 v[180:183], v[44:47], a[212:215], v[180:183]
    v_mfma_f32_16x16x32_bf16 v[176:179], v[44:47], a[208:211], v[176:179]
    s_nop 0
    v_mfma_f32_16x16x32_bf16 v[176:179], v[40:43], a[192:195], v[176:179]
    s_waitcnt lgkmcnt(2)
    ds_read_b64_tr_b16 v[36:37], v53 offset:45056
    ds_read_b64_tr_b16 v[38:39], v53 offset:47104
    v_mfma_f32_16x16x32_bf16 v[192:195], v[16:19], a[192:195], v[192:195]
    buffer_load_dwordx4 a[160:163], v60, s[48:51], s80 offen offset:3072 sc1
    v_mfma_f32_16x16x32_bf16 v[192:195], v[20:23], a[208:211], v[192:195]
    v_mfma_f32_16x16x32_bf16 v[196:199], v[20:23], a[212:215], v[196:199]
    ds_read_b64_tr_b16 v[40:41], v53 offset:32776
    ds_read_b64_tr_b16 v[42:43], v53 offset:34824
    v_mfma_f32_16x16x32_bf16 v[196:199], v[16:19], a[196:199], v[196:199]
    v_mfma_f32_16x16x32_bf16 v[200:203], v[16:19], a[200:203], v[200:203]
    v_mfma_f32_16x16x32_bf16 v[200:203], v[20:23], a[216:219], v[200:203]
    ds_read_b64_tr_b16 v[44:45], v53 offset:45064
    ds_read_b64_tr_b16 v[46:47], v53 offset:47112
    v_mfma_f32_16x16x32_bf16 v[204:207], v[20:23], a[220:223], v[204:207]
    v_mfma_f32_16x16x32_bf16 v[204:207], v[16:19], a[204:207], v[204:207]
    v_mfma_f32_16x16x32_bf16 v[220:223], v[24:27], a[204:207], v[220:223]
    v_mfma_f32_16x16x32_bf16 v[220:223], v[28:31], a[220:223], v[220:223]
    v_mfma_f32_16x16x32_bf16 v[216:219], v[28:31], a[216:219], v[216:219]
    buffer_load_dwordx4 a[164:167], v61, s[48:51], s80 offen offset:3072 sc1
    v_mfma_f32_16x16x32_bf16 v[216:219], v[24:27], a[200:203], v[216:219]
    v_mfma_f32_16x16x32_bf16 v[212:215], v[24:27], a[196:199], v[212:215]
    s_waitcnt lgkmcnt(0)
    s_barrier
    v_mfma_f32_16x16x32_bf16 v[212:215], v[28:31], a[212:215], v[212:215]
    s_add_u32 m0, s34, 98304
    ds_read_b64_tr_b16 v[16:17], v48 offset:0
    ds_read_b64_tr_b16 v[18:19], v48 offset:2048
    v_mfma_f32_16x16x32_bf16 v[208:211], v[28:31], a[208:211], v[208:211]
    buffer_load_dwordx4 v3, s[48:51], s78 offen sc1 lds
    v_mfma_f32_16x16x32_bf16 v[208:211], v[24:27], a[192:195], v[208:211]
    ds_read_b64_tr_b16 v[20:21], v48 offset:12288
    ds_read_b64_tr_b16 v[22:23], v48 offset:14336
    v_mfma_f32_16x16x32_bf16 v[224:227], v[32:35], a[192:195], v[224:227]
    v_mfma_f32_16x16x32_bf16 v[224:227], v[36:39], a[208:211], v[224:227]
    v_mfma_f32_16x16x32_bf16 v[228:231], v[36:39], a[212:215], v[228:231]
    v_mfma_f32_16x16x32_bf16 v[228:231], v[32:35], a[196:199], v[228:231]
    v_mfma_f32_16x16x32_bf16 v[232:235], v[32:35], a[200:203], v[232:235]
    ds_read_b64_tr_b16 v[24:25], v48 offset:8
    ds_read_b64_tr_b16 v[26:27], v48 offset:2056
    v_mfma_f32_16x16x32_bf16 v[232:235], v[36:39], a[216:219], v[232:235]
    buffer_load_dwordx4 a[168:171], v62, s[48:51], s80 offen offset:3072 sc1
    v_mfma_f32_16x16x32_bf16 v[236:239], v[36:39], a[220:223], v[236:239]
    v_mfma_f32_16x16x32_bf16 v[236:239], v[32:35], a[204:207], v[236:239]
    ds_read_b64_tr_b16 v[28:29], v48 offset:12296
    ds_read_b64_tr_b16 v[30:31], v48 offset:14344
    v_mfma_f32_16x16x32_bf16 v[252:255], v[40:43], a[204:207], v[252:255]
    v_mfma_f32_16x16x32_bf16 v[252:255], v[44:47], a[220:223], v[252:255]
    v_mfma_f32_16x16x32_bf16 v[248:251], v[44:47], a[216:219], v[248:251]
    v_mfma_f32_16x16x32_bf16 v[248:251], v[40:43], a[200:203], v[248:251]
    v_mfma_f32_16x16x32_bf16 v[244:247], v[40:43], a[196:199], v[244:247]
    ds_read_b64_tr_b16 v[32:33], v49 offset:0
    ds_read_b64_tr_b16 v[34:35], v49 offset:2048
    v_mfma_f32_16x16x32_bf16 v[244:247], v[44:47], a[212:215], v[244:247]
    s_add_u32 s78, s78, 4096
    s_add_u32 m0, s34, 102400
    v_mfma_f32_16x16x32_bf16 v[240:243], v[44:47], a[208:211], v[240:243]
    buffer_load_dwordx4 v3, s[48:51], s78 offen sc1 lds
    v_mfma_f32_16x16x32_bf16 v[240:243], v[40:43], a[192:195], v[240:243]
    s_waitcnt vmcnt(25) lgkmcnt(2)
    ds_read_b64_tr_b16 v[36:37], v49 offset:12288
    s_nop 0
    ds_read_b64_tr_b16 v[38:39], v49 offset:14336
    v_mfma_f32_16x16x32_bf16 v[64:67], v[16:19], a[224:227], v[64:67]
    s_waitcnt vmcnt(18)
    buffer_load_dwordx4 a[172:175], v63, s[48:51], s80 offen offset:3072 sc1
    v_mfma_f32_16x16x32_bf16 v[64:67], v[20:23], a[240:243], v[64:67]
    s_waitcnt vmcnt(17)
    v_mfma_f32_16x16x32_bf16 v[68:71], v[20:23], a[244:247], v[68:71]
    s_nop 0
    v_mfma_f32_16x16x32_bf16 v[68:71], v[16:19], a[228:231], v[68:71]
    s_nop 0
    v_mfma_f32_16x16x32_bf16 v[72:75], v[16:19], a[232:235], v[72:75]
    s_waitcnt vmcnt(15)
    ds_read_b64_tr_b16 v[40:41], v49 offset:8
    ds_read_b64_tr_b16 v[42:43], v49 offset:2056
    v_mfma_f32_16x16x32_bf16 v[72:75], v[20:23], a[248:251], v[72:75]
    s_waitcnt vmcnt(14)
    v_mfma_f32_16x16x32_bf16 v[76:79], v[20:23], a[252:255], v[76:79]
    v_mfma_f32_16x16x32_bf16 v[76:79], v[16:19], a[236:239], v[76:79]
    ds_read_b64_tr_b16 v[44:45], v49 offset:12296
    ds_read_b64_tr_b16 v[46:47], v49 offset:14344
    v_mfma_f32_16x16x32_bf16 v[92:95], v[24:27], a[236:239], v[92:95]
    s_nop 0
    v_mfma_f32_16x16x32_bf16 v[92:95], v[28:31], a[252:255], v[92:95]
    s_nop 0
    v_mfma_f32_16x16x32_bf16 v[88:91], v[28:31], a[248:251], v[88:91]
    s_add_u32 s80, s80, 4096
    v_mfma_f32_16x16x32_bf16 v[88:91], v[24:27], a[232:235], v[88:91]
    buffer_load_dwordx4 a[192:195], v60, s[48:51], s80 offen sc1
    v_mfma_f32_16x16x32_bf16 v[84:87], v[24:27], a[228:231], v[84:87]
    ds_read_b64_tr_b16 v[16:17], v48 offset:4096
    ds_read_b64_tr_b16 v[18:19], v48 offset:6144
    v_mfma_f32_16x16x32_bf16 v[84:87], v[28:31], a[244:247], v[84:87]
    s_add_u32 s78, s78, 4096
    s_add_u32 m0, s34, 106496
    v_mfma_f32_16x16x32_bf16 v[80:83], v[28:31], a[240:243], v[80:83]
    buffer_load_dwordx4 v3, s[48:51], s78 offen sc1 lds
    v_mfma_f32_16x16x32_bf16 v[80:83], v[24:27], a[224:227], v[80:83]
    s_waitcnt lgkmcnt(2)
    ds_read_b64_tr_b16 v[20:21], v48 offset:16384
    ds_read_b64_tr_b16 v[22:23], v48 offset:18432
    v_mfma_f32_16x16x32_bf16 v[96:99], v[32:35], a[224:227], v[96:99]
    s_nop 0
    v_mfma_f32_16x16x32_bf16 v[96:99], v[36:39], a[240:243], v[96:99]
    v_mfma_f32_16x16x32_bf16 v[100:103], v[36:39], a[244:247], v[100:103]
    v_mfma_f32_16x16x32_bf16 v[100:103], v[32:35], a[228:231], v[100:103]
    v_mfma_f32_16x16x32_bf16 v[104:107], v[32:35], a[232:235], v[104:107]
    ds_read_b64_tr_b16 v[24:25], v48 offset:4104
    ds_read_b64_tr_b16 v[26:27], v48 offset:6152
    v_mfma_f32_16x16x32_bf16 v[104:107], v[36:39], a[248:251], v[104:107]
    v_mfma_f32_16x16x32_bf16 v[108:111], v[36:39], a[252:255], v[108:111]
    buffer_load_dwordx4 a[196:199], v61, s[48:51], s80 offen sc1
    v_mfma_f32_16x16x32_bf16 v[108:111], v[32:35], a[236:239], v[108:111]
    ds_read_b64_tr_b16 v[28:29], v48 offset:16392
    ds_read_b64_tr_b16 v[30:31], v48 offset:18440
    v_mfma_f32_16x16x32_bf16 v[124:127], v[40:43], a[236:239], v[124:127]
    s_lshl_b32 s3, s31, 2
    v_mfma_f32_16x16x32_bf16 v[124:127], v[44:47], a[252:255], v[124:127]
    s_add_u32 s3, s3, s32
    v_mfma_f32_16x16x32_bf16 v[120:123], v[44:47], a[248:251], v[120:123]
    s_mul_i32 s3, s3, 786432
    v_mfma_f32_16x16x32_bf16 v[120:123], v[40:43], a[232:235], v[120:123]
    s_add_u32 s36, s6, s3
    s_addc_u32 s37, s7, 0
    v_mfma_f32_16x16x32_bf16 v[116:119], v[40:43], a[228:231], v[116:119]
    s_and_b32 s37, s37, 0xffff
    ds_read_b64_tr_b16 v[32:33], v49 offset:4096
    ds_read_b64_tr_b16 v[34:35], v49 offset:6144
    v_mfma_f32_16x16x32_bf16 v[116:119], v[44:47], a[244:247], v[116:119]
    s_add_u32 s78, s78, 4096
    s_add_u32 m0, s34, 110592
    v_mfma_f32_16x16x32_bf16 v[112:115], v[44:47], a[240:243], v[112:115]
    buffer_load_dwordx4 v3, s[48:51], s78 offen sc1 lds
    v_mfma_f32_16x16x32_bf16 v[112:115], v[40:43], a[224:227], v[112:115]
    s_waitcnt lgkmcnt(2)
    s_mov_b32 s38, 786432
    s_nop 0
    ds_read_b64_tr_b16 v[36:37], v49 offset:16384
    ds_read_b64_tr_b16 v[38:39], v49 offset:18432
    v_mfma_f32_16x16x32_bf16 v[128:131], v[16:19], a[224:227], v[128:131]
    s_mov_b32 s39, 0x00020000
    v_mfma_f32_16x16x32_bf16 v[128:131], v[20:23], a[240:243], v[128:131]
    buffer_load_dwordx4 a[200:203], v62, s[48:51], s80 offen sc1
    v_mfma_f32_16x16x32_bf16 v[132:135], v[20:23], a[244:247], v[132:135]
    s_add_u32 s40, s8, s3
    s_addc_u32 s41, s9, 0
    v_mfma_f32_16x16x32_bf16 v[132:135], v[16:19], a[228:231], v[132:135]
    s_and_b32 s41, s41, 0xffff
    v_mfma_f32_16x16x32_bf16 v[136:139], v[16:19], a[232:235], v[136:139]
    s_mov_b32 s42, 786432
    ds_read_b64_tr_b16 v[40:41], v49 offset:4104
    ds_read_b64_tr_b16 v[42:43], v49 offset:6152
    v_mfma_f32_16x16x32_bf16 v[136:139], v[20:23], a[248:251], v[136:139]
    s_mov_b32 s43, 0x00020000
    v_mfma_f32_16x16x32_bf16 v[140:143], v[20:23], a[252:255], v[140:143]
    s_mov_b32 s14, 0x3dd53b95
    v_mfma_f32_16x16x32_bf16 v[140:143], v[16:19], a[236:239], v[140:143]
    s_mov_b32 s15, 0x3dd53b95
    ds_read_b64_tr_b16 v[44:45], v49 offset:16392
    ds_read_b64_tr_b16 v[46:47], v49 offset:18440
    v_mfma_f32_16x16x32_bf16 v[156:159], v[24:27], a[236:239], v[156:159]
    s_lshl_b32 s79, s31, 2
    v_mfma_f32_16x16x32_bf16 v[156:159], v[28:31], a[252:255], v[156:159]
    s_add_u32 s79, s79, s32
    v_mfma_f32_16x16x32_bf16 v[152:155], v[28:31], a[248:251], v[152:155]
    s_lshl_b32 s79, s79, 2
    v_mfma_f32_16x16x32_bf16 v[152:155], v[24:27], a[232:235], v[152:155]
    s_add_u32 s79, s79, s30
    v_mfma_f32_16x16x32_bf16 v[148:151], v[24:27], a[228:231], v[148:151]
    s_mul_i32 s79, s79, 20480
    ds_read_b64_tr_b16 v[16:17], v48 offset:8192
    ds_read_b64_tr_b16 v[18:19], v48 offset:10240
    v_mfma_f32_16x16x32_bf16 v[148:151], v[28:31], a[244:247], v[148:151]
    buffer_load_dwordx4 a[204:207], v63, s[48:51], s80 offen sc1
    v_mfma_f32_16x16x32_bf16 v[144:147], v[28:31], a[240:243], v[144:147]
    s_add_u32 s79, s79, 6291456
    v_mfma_f32_16x16x32_bf16 v[144:147], v[24:27], a[224:227], v[144:147]
    s_waitcnt lgkmcnt(2)
    s_lshr_b32 s3, s33, 1
    ds_read_b64_tr_b16 v[20:21], v48 offset:20480
    ds_read_b64_tr_b16 v[22:23], v48 offset:22528
    v_mfma_f32_16x16x32_bf16 v[160:163], v[32:35], a[224:227], v[160:163]
    s_add_u32 s78, s78, 4096
    s_add_u32 m0, s34, 114688
    v_mfma_f32_16x16x32_bf16 v[160:163], v[36:39], a[240:243], v[160:163]
    buffer_load_dwordx4 v3, s[48:51], s78 offen sc1 lds
    v_mfma_f32_16x16x32_bf16 v[164:167], v[36:39], a[244:247], v[164:167]
    s_mul_i32 s3, s3, 5120
    v_mfma_f32_16x16x32_bf16 v[164:167], v[32:35], a[228:231], v[164:167]
    s_add_u32 s79, s79, s3
    v_mfma_f32_16x16x32_bf16 v[168:171], v[32:35], a[232:235], v[168:171]
    s_and_b32 s3, s33, 1
    ds_read_b64_tr_b16 v[24:25], v48 offset:8200
    ds_read_b64_tr_b16 v[26:27], v48 offset:10248
    v_mfma_f32_16x16x32_bf16 v[168:171], v[36:39], a[248:251], v[168:171]
    s_lshl_b32 s35, s3, 3
    v_mfma_f32_16x16x32_bf16 v[172:175], v[36:39], a[252:255], v[172:175]
    s_add_u32 s83, s79, s35
    v_mfma_f32_16x16x32_bf16 v[172:175], v[32:35], a[236:239], v[172:175]
    s_add_u32 s83, s83, 4096
    ds_read_b64_tr_b16 v[28:29], v48 offset:20488
    ds_read_b64_tr_b16 v[30:31], v48 offset:22536
    v_mfma_f32_16x16x32_bf16 v[188:191], v[40:43], a[236:239], v[188:191]
    buffer_load_dwordx4 a[208:211], v60, s[48:51], s80 offen offset:1024 sc1
    v_mfma_f32_16x16x32_bf16 v[188:191], v[44:47], a[252:255], v[188:191]
    s_lshl_b32 s3, s3, 11
    v_mfma_f32_16x16x32_bf16 v[184:187], v[44:47], a[248:251], v[184:187]
    s_add_u32 s79, s79, s3
    v_mfma_f32_16x16x32_bf16 v[184:187], v[40:43], a[232:235], v[184:187]
    s_lshl_b32 s82, s31, 2
    v_mfma_f32_16x16x32_bf16 v[180:183], v[40:43], a[228:231], v[180:183]
    s_add_u32 s82, s82, s32
    ds_read_b64_tr_b16 v[32:33], v49 offset:8192
    ds_read_b64_tr_b16 v[34:35], v49 offset:10240
    v_mfma_f32_16x16x32_bf16 v[180:183], v[44:47], a[244:247], v[180:183]
    s_lshl_b32 s82, s82, 2
    v_mfma_f32_16x16x32_bf16 v[176:179], v[44:47], a[240:243], v[176:179]
    s_add_u32 s82, s82, s30
    v_mfma_f32_16x16x32_bf16 v[176:179], v[40:43], a[224:227], v[176:179]
    s_waitcnt lgkmcnt(2)
    s_mul_i32 s82, s82, 1024
    ds_read_b64_tr_b16 v[36:37], v49 offset:20480
    s_nop 0
    ds_read_b64_tr_b16 v[38:39], v49 offset:22528
    v_mfma_f32_16x16x32_bf16 v[192:195], v[16:19], a[224:227], v[192:195]
    s_add_u32 s78, s78, 4096
    s_add_u32 m0, s34, 118784
    v_mfma_f32_16x16x32_bf16 v[192:195], v[20:23], a[240:243], v[192:195]
    buffer_load_dwordx4 v3, s[48:51], s78 offen sc1 lds
    v_mfma_f32_16x16x32_bf16 v[196:199], v[20:23], a[244:247], v[196:199]
    s_add_u32 s82, s82, 78643200
    v_mfma_f32_16x16x32_bf16 v[196:199], v[16:19], a[228:231], v[196:199]
    buffer_load_dwordx4 a[212:215], v61, s[48:51], s80 offen offset:1024 sc1
    v_mfma_f32_16x16x32_bf16 v[200:203], v[16:19], a[232:235], v[200:203]
    s_lshl_b32 s3, s33, 3
    s_nop 0
    ds_read_b64_tr_b16 v[40:41], v49 offset:8200
    ds_read_b64_tr_b16 v[42:43], v49 offset:10248
    v_mfma_f32_16x16x32_bf16 v[200:203], v[20:23], a[248:251], v[200:203]
    s_add_u32 s82, s82, s3
    v_mfma_f32_16x16x32_bf16 v[204:207], v[20:23], a[252:255], v[204:207]
    s_mov_b32 s44, s48
    v_mfma_f32_16x16x32_bf16 v[204:207], v[16:19], a[236:239], v[204:207]
    s_mov_b32 s45, s49
    ds_read_b64_tr_b16 v[44:45], v49 offset:20488
    ds_read_b64_tr_b16 v[46:47], v49 offset:22536
    v_mfma_f32_16x16x32_bf16 v[220:223], v[24:27], a[236:239], v[220:223]
    s_mov_b32 s52, s12
    v_mfma_f32_16x16x32_bf16 v[220:223], v[28:31], a[252:255], v[220:223]
    s_and_b32 s53, s13, 0xffff
    v_mfma_f32_16x16x32_bf16 v[216:219], v[28:31], a[248:251], v[216:219]
    s_mov_b32 s54, 7864320
    v_mfma_f32_16x16x32_bf16 v[216:219], v[24:27], a[232:235], v[216:219]
    s_mov_b32 s55, 0x00020000
    v_mfma_f32_16x16x32_bf16 v[212:215], v[24:27], a[228:231], v[212:215]
    s_mov_b32 s17, 234881024
    ds_read_b64_tr_b16 v[16:17], v48 offset:24576
    ds_read_b64_tr_b16 v[18:19], v48 offset:26624
    v_mfma_f32_16x16x32_bf16 v[212:215], v[28:31], a[244:247], v[212:215]
    buffer_load_dwordx4 a[216:219], v62, s[48:51], s80 offen offset:1024 sc1
    v_mfma_f32_16x16x32_bf16 v[208:211], v[28:31], a[240:243], v[208:211]
    s_mov_b32 s18, 0
    v_mfma_f32_16x16x32_bf16 v[208:211], v[24:27], a[224:227], v[208:211]
    s_waitcnt lgkmcnt(2)
    s_mov_b32 s10, 0
    ds_read_b64_tr_b16 v[20:21], v48 offset:36864
    ds_read_b64_tr_b16 v[22:23], v48 offset:38912
    s_nop 0
    v_mfma_f32_16x16x32_bf16 v[224:227], v[32:35], a[224:227], v[224:227]
    s_add_u32 s78, s78, 4096
    s_add_u32 m0, s34, 122880
    v_mfma_f32_16x16x32_bf16 v[224:227], v[36:39], a[240:243], v[224:227]
    buffer_load_dwordx4 v3, s[48:51], s78 offen sc1 lds
    v_mfma_f32_16x16x32_bf16 v[228:231], v[36:39], a[244:247], v[228:231]
    s_mov_b32 s62, 49152
    v_mfma_f32_16x16x32_bf16 v[228:231], v[32:35], a[228:231], v[228:231]
    s_mov_b32 s70, 49152
    v_mfma_f32_16x16x32_bf16 v[232:235], v[32:35], a[232:235], v[232:235]
    s_mov_b32 s71, -98304
    ds_read_b64_tr_b16 v[24:25], v48 offset:24584
    ds_read_b64_tr_b16 v[26:27], v48 offset:26632
    v_mfma_f32_16x16x32_bf16 v[232:235], v[36:39], a[248:251], v[232:235]
    buffer_load_dword v15, v14, s[48:51], s81 offen sc1
    v_mfma_f32_16x16x32_bf16 v[236:239], v[36:39], a[252:255], v[236:239]
    s_mov_b32 s72, 49152
    v_mfma_f32_16x16x32_bf16 v[236:239], v[32:35], a[236:239], v[236:239]
    s_lshl_b32 s3, s31, 3
    ds_read_b64_tr_b16 v[28:29], v48 offset:36872
    ds_read_b64_tr_b16 v[30:31], v48 offset:38920
    v_mfma_f32_16x16x32_bf16 v[252:255], v[40:43], a[236:239], v[252:255]
    buffer_load_dwordx4 a[220:223], v63, s[48:51], s80 offen offset:1024 sc1
    v_mfma_f32_16x16x32_bf16 v[252:255], v[44:47], a[252:255], v[252:255]
    s_add_u32 s3, s3, s33
    v_mfma_f32_16x16x32_bf16 v[248:251], v[44:47], a[248:251], v[248:251]
    s_mul_i32 s11, s3, 122880
    v_mfma_f32_16x16x32_bf16 v[248:251], v[40:43], a[232:235], v[248:251]
    s_mul_i32 s3, s32, 320
    v_mfma_f32_16x16x32_bf16 v[244:247], v[40:43], a[228:231], v[244:247]
    s_add_u32 s11, s11, s3
    ds_read_b64_tr_b16 v[32:33], v49 offset:24576
    ds_read_b64_tr_b16 v[34:35], v49 offset:26624
    v_mfma_f32_16x16x32_bf16 v[244:247], v[44:47], a[244:247], v[244:247]
    s_lshl_b32 s3, s31, 2
    v_mfma_f32_16x16x32_bf16 v[240:243], v[44:47], a[240:243], v[240:243]
    s_add_u32 s3, s3, s32
    v_mfma_f32_16x16x32_bf16 v[240:243], v[40:43], a[224:227], v[240:243]
    s_waitcnt vmcnt(26) lgkmcnt(2)
    s_lshl_b32 s3, s3, 3
    ds_read_b64_tr_b16 v[36:37], v49 offset:36864
    ds_read_b64_tr_b16 v[38:39], v49 offset:38912
    v_mfma_f32_16x16x32_bf16 v[64:67], v[16:19], a[144:147], v[64:67]
    s_waitcnt vmcnt(19)
    s_add_u32 s78, s78, 4096
    s_add_u32 m0, s34, 126976
    v_mfma_f32_16x16x32_bf16 v[64:67], v[20:23], a[160:163], v[64:67]
    s_waitcnt vmcnt(18)
    buffer_load_dwordx4 v3, s[48:51], s78 offen sc1 lds
    v_mfma_f32_16x16x32_bf16 v[68:71], v[20:23], a[164:167], v[68:71]
    s_add_u32 s3, s3, s33
    v_mfma_f32_16x16x32_bf16 v[68:71], v[16:19], a[148:151], v[68:71]
    buffer_load_dwordx4 a[224:227], v60, s[48:51], s80 offen offset:2048 sc1
    v_mfma_f32_16x16x32_bf16 v[72:75], v[16:19], a[152:155], v[72:75]
    s_waitcnt vmcnt(18)
    s_mul_i32 s9, s3, 30720
    ds_read_b64_tr_b16 v[40:41], v49 offset:24584
    ds_read_b64_tr_b16 v[42:43], v49 offset:26632
    v_mfma_f32_16x16x32_bf16 v[72:75], v[20:23], a[168:171], v[72:75]
    s_waitcnt vmcnt(16)
    s_add_u32 s9, s9, 87818240
    v_mfma_f32_16x16x32_bf16 v[76:79], v[20:23], a[172:175], v[76:79]
    s_add_u32 s46, s9, 30720
    v_mfma_f32_16x16x32_bf16 v[76:79], v[16:19], a[156:159], v[76:79]
    ds_read_b64_tr_b16 v[44:45], v49 offset:36872
    ds_read_b64_tr_b16 v[46:47], v49 offset:38920
    v_mfma_f32_16x16x32_bf16 v[92:95], v[24:27], a[156:159], v[92:95]
    v_mfma_f32_16x16x32_bf16 v[92:95], v[28:31], a[172:175], v[92:95]
    s_nop 0
    v_mfma_f32_16x16x32_bf16 v[88:91], v[28:31], a[168:171], v[88:91]
    s_nop 0
    v_mfma_f32_16x16x32_bf16 v[88:91], v[24:27], a[152:155], v[88:91]
    v_mfma_f32_16x16x32_bf16 v[84:87], v[24:27], a[148:151], v[84:87]
    ds_read_b64_tr_b16 v[16:17], v48 offset:28672
    ds_read_b64_tr_b16 v[18:19], v48 offset:30720
    v_mfma_f32_16x16x32_bf16 v[84:87], v[28:31], a[164:167], v[84:87]
    s_nop 0
    v_mfma_f32_16x16x32_bf16 v[80:83], v[28:31], a[160:163], v[80:83]
    buffer_load_dwordx4 a[228:231], v61, s[48:51], s80 offen offset:2048 sc1
    v_mfma_f32_16x16x32_bf16 v[80:83], v[24:27], a[144:147], v[80:83]
    s_waitcnt lgkmcnt(2)
    ds_read_b64_tr_b16 v[20:21], v48 offset:40960
    ds_read_b64_tr_b16 v[22:23], v48 offset:43008
    v_mfma_f32_16x16x32_bf16 v[96:99], v[32:35], a[144:147], v[96:99]
    v_mfma_f32_16x16x32_bf16 v[96:99], v[36:39], a[160:163], v[96:99]
    s_add_u32 s78, s78, 4096
    s_add_u32 m0, s34, 131072
    v_mfma_f32_16x16x32_bf16 v[100:103], v[36:39], a[164:167], v[100:103]
    buffer_load_dwordx4 v3, s[48:51], s78 offen sc1 lds
    v_mfma_f32_16x16x32_bf16 v[100:103], v[32:35], a[148:151], v[100:103]
    v_mfma_f32_16x16x32_bf16 v[104:107], v[32:35], a[152:155], v[104:107]
    ds_read_b64_tr_b16 v[24:25], v48 offset:28680
    ds_read_b64_tr_b16 v[26:27], v48 offset:30728
    v_mfma_f32_16x16x32_bf16 v[104:107], v[36:39], a[168:171], v[104:107]
    v_mfma_f32_16x16x32_bf16 v[108:111], v[36:39], a[172:175], v[108:111]
    v_mfma_f32_16x16x32_bf16 v[108:111], v[32:35], a[156:159], v[108:111]
    ds_read_b64_tr_b16 v[28:29], v48 offset:40968
    ds_read_b64_tr_b16 v[30:31], v48 offset:43016
    v_mfma_f32_16x16x32_bf16 v[124:127], v[40:43], a[156:159], v[124:127]
    v_mfma_f32_16x16x32_bf16 v[124:127], v[44:47], a[172:175], v[124:127]
    buffer_load_dwordx4 a[232:235], v62, s[48:51], s80 offen offset:2048 sc1
    v_mfma_f32_16x16x32_bf16 v[120:123], v[44:47], a[168:171], v[120:123]
    v_mfma_f32_16x16x32_bf16 v[120:123], v[40:43], a[152:155], v[120:123]
    v_mfma_f32_16x16x32_bf16 v[116:119], v[40:43], a[148:151], v[116:119]
    ds_read_b64_tr_b16 v[32:33], v49 offset:28672
    ds_read_b64_tr_b16 v[34:35], v49 offset:30720
    v_mfma_f32_16x16x32_bf16 v[116:119], v[44:47], a[164:167], v[116:119]
    v_mfma_f32_16x16x32_bf16 v[112:115], v[44:47], a[160:163], v[112:115]
    v_mfma_f32_16x16x32_bf16 v[112:115], v[40:43], a[144:147], v[112:115]
    s_waitcnt lgkmcnt(2)
    ds_read_b64_tr_b16 v[36:37], v49 offset:40960
    ds_read_b64_tr_b16 v[38:39], v49 offset:43008
    v_mfma_f32_16x16x32_bf16 v[128:131], v[16:19], a[144:147], v[128:131]
    s_nop 0
    v_mfma_f32_16x16x32_bf16 v[128:131], v[20:23], a[160:163], v[128:131]
    v_mfma_f32_16x16x32_bf16 v[132:135], v[20:23], a[164:167], v[132:135]
    s_add_u32 s78, s78, 4096
    s_add_u32 m0, s34, 135168
    v_mfma_f32_16x16x32_bf16 v[132:135], v[16:19], a[148:151], v[132:135]
    buffer_load_dwordx4 v3, s[48:51], s78 offen sc1 lds
    v_mfma_f32_16x16x32_bf16 v[136:139], v[16:19], a[152:155], v[136:139]
    ds_read_b64_tr_b16 v[40:41], v49 offset:28680
    ds_read_b64_tr_b16 v[42:43], v49 offset:30728
    v_mfma_f32_16x16x32_bf16 v[136:139], v[20:23], a[168:171], v[136:139]
    buffer_load_dwordx4 a[236:239], v63, s[48:51], s80 offen offset:2048 sc1
    v_mfma_f32_16x16x32_bf16 v[140:143], v[20:23], a[172:175], v[140:143]
    v_mfma_f32_16x16x32_bf16 v[140:143], v[16:19], a[156:159], v[140:143]
    ds_read_b64_tr_b16 v[44:45], v49 offset:40968
    ds_read_b64_tr_b16 v[46:47], v49 offset:43016
    v_mfma_f32_16x16x32_bf16 v[156:159], v[24:27], a[156:159], v[156:159]
    v_mfma_f32_16x16x32_bf16 v[156:159], v[28:31], a[172:175], v[156:159]
    v_mfma_f32_16x16x32_bf16 v[152:155], v[28:31], a[168:171], v[152:155]
    v_mfma_f32_16x16x32_bf16 v[152:155], v[24:27], a[152:155], v[152:155]
    v_mfma_f32_16x16x32_bf16 v[148:151], v[24:27], a[148:151], v[148:151]
    ds_read_b64_tr_b16 v[16:17], v48 offset:32768
    ds_read_b64_tr_b16 v[18:19], v48 offset:34816
    v_mfma_f32_16x16x32_bf16 v[148:151], v[28:31], a[164:167], v[148:151]
    v_mfma_f32_16x16x32_bf16 v[144:147], v[28:31], a[160:163], v[144:147]
    s_nop 0
    v_mfma_f32_16x16x32_bf16 v[144:147], v[24:27], a[144:147], v[144:147]
    s_waitcnt lgkmcnt(2)
    ds_read_b64_tr_b16 v[20:21], v48 offset:45056
    ds_read_b64_tr_b16 v[22:23], v48 offset:47104
    v_mfma_f32_16x16x32_bf16 v[160:163], v[32:35], a[144:147], v[160:163]
    buffer_load_dwordx4 a[240:243], v60, s[48:51], s80 offen offset:3072 sc1
    v_mfma_f32_16x16x32_bf16 v[160:163], v[36:39], a[160:163], v[160:163]
    v_mfma_f32_16x16x32_bf16 v[164:167], v[36:39], a[164:167], v[164:167]
    v_mfma_f32_16x16x32_bf16 v[164:167], v[32:35], a[148:151], v[164:167]
    v_mfma_f32_16x16x32_bf16 v[168:171], v[32:35], a[152:155], v[168:171]
    ds_read_b64_tr_b16 v[24:25], v48 offset:32776
    ds_read_b64_tr_b16 v[26:27], v48 offset:34824
    v_mfma_f32_16x16x32_bf16 v[168:171], v[36:39], a[168:171], v[168:171]
    s_add_u32 s78, s78, 4096
    s_add_u32 m0, s34, 139264
    v_mfma_f32_16x16x32_bf16 v[172:175], v[36:39], a[172:175], v[172:175]
    buffer_load_dwordx4 v3, s[48:51], s78 offen sc1 lds
    v_mfma_f32_16x16x32_bf16 v[172:175], v[32:35], a[156:159], v[172:175]
    ds_read_b64_tr_b16 v[28:29], v48 offset:45064
    ds_read_b64_tr_b16 v[30:31], v48 offset:47112
    v_mfma_f32_16x16x32_bf16 v[188:191], v[40:43], a[156:159], v[188:191]
    v_mfma_f32_16x16x32_bf16 v[188:191], v[44:47], a[172:175], v[188:191]
    v_mfma_f32_16x16x32_bf16 v[184:187], v[44:47], a[168:171], v[184:187]
    buffer_load_dwordx4 a[244:247], v61, s[48:51], s80 offen offset:3072 sc1
    v_mfma_f32_16x16x32_bf16 v[184:187], v[40:43], a[152:155], v[184:187]
    v_mfma_f32_16x16x32_bf16 v[180:183], v[40:43], a[148:151], v[180:183]
    ds_read_b64_tr_b16 v[32:33], v49 offset:32768
    ds_read_b64_tr_b16 v[34:35], v49 offset:34816
    v_mfma_f32_16x16x32_bf16 v[180:183], v[44:47], a[164:167], v[180:183]
    v_mfma_f32_16x16x32_bf16 v[176:179], v[44:47], a[160:163], v[176:179]
    s_nop 0
    v_mfma_f32_16x16x32_bf16 v[176:179], v[40:43], a[144:147], v[176:179]
    s_waitcnt lgkmcnt(2)
    ds_read_b64_tr_b16 v[36:37], v49 offset:45056
    ds_read_b64_tr_b16 v[38:39], v49 offset:47104
    v_mfma_f32_16x16x32_bf16 v[192:195], v[16:19], a[144:147], v[192:195]
    v_mfma_f32_16x16x32_bf16 v[192:195], v[20:23], a[160:163], v[192:195]
    v_mfma_f32_16x16x32_bf16 v[196:199], v[20:23], a[164:167], v[196:199]
    ds_read_b64_tr_b16 v[40:41], v49 offset:32776
    ds_read_b64_tr_b16 v[42:43], v49 offset:34824
    v_mfma_f32_16x16x32_bf16 v[196:199], v[16:19], a[148:151], v[196:199]
    s_add_u32 s78, s78, 4096
    s_add_u32 m0, s34, 143360
    v_mfma_f32_16x16x32_bf16 v[200:203], v[16:19], a[152:155], v[200:203]
    buffer_load_dwordx4 v3, s[48:51], s78 offen sc1 lds
    v_mfma_f32_16x16x32_bf16 v[200:203], v[20:23], a[168:171], v[200:203]
    ds_read_b64_tr_b16 v[44:45], v49 offset:45064
    ds_read_b64_tr_b16 v[46:47], v49 offset:47112
    v_mfma_f32_16x16x32_bf16 v[204:207], v[20:23], a[172:175], v[204:207]
    buffer_load_dwordx4 a[248:251], v62, s[48:51], s80 offen offset:3072 sc1
    v_mfma_f32_16x16x32_bf16 v[204:207], v[16:19], a[156:159], v[204:207]
    v_mfma_f32_16x16x32_bf16 v[220:223], v[24:27], a[156:159], v[220:223]
    v_mfma_f32_16x16x32_bf16 v[220:223], v[28:31], a[172:175], v[220:223]
    v_mfma_f32_16x16x32_bf16 v[216:219], v[28:31], a[168:171], v[216:219]
    v_mfma_f32_16x16x32_bf16 v[216:219], v[24:27], a[152:155], v[216:219]
    v_mfma_f32_16x16x32_bf16 v[212:215], v[24:27], a[148:151], v[212:215]
    s_waitcnt lgkmcnt(0)
    s_barrier
    s_waitcnt vmcnt(13)
    v_cmp_gt_u32 vcc, 32, v15
    s_cbranch_vccnz L_slow5
L_ok5:
    v_mfma_f32_16x16x32_bf16 v[212:215], v[28:31], a[164:167], v[212:215]
    s_nop 0
    ds_read_b64_tr_b16 v[16:17], v50 offset:0
    ds_read_b64_tr_b16 v[18:19], v50 offset:2048
    v_mfma_f32_16x16x32_bf16 v[208:211], v[28:31], a[160:163], v[208:211]
    v_mfma_f32_16x16x32_bf16 v[208:211], v[24:27], a[144:147], v[208:211]
    ds_read_b64_tr_b16 v[20:21], v50 offset:12288
    ds_read_b64_tr_b16 v[22:23], v50 offset:14336
    v_mfma_f32_16x16x32_bf16 v[224:227], v[32:35], a[144:147], v[224:227]
    buffer_load_dwordx4 a[252:255], v63, s[48:51], s80 offen offset:3072 sc1
    v_mfma_f32_16x16x32_bf16 v[224:227], v[36:39], a[160:163], v[224:227]
    v_mfma_f32_16x16x32_bf16 v[228:231], v[36:39], a[164:167], v[228:231]
    v_mfma_f32_16x16x32_bf16 v[228:231], v[32:35], a[148:151], v[228:231]
    v_mfma_f32_16x16x32_bf16 v[232:235], v[32:35], a[152:155], v[232:235]
    ds_read_b64_tr_b16 v[24:25], v50 offset:8
    ds_read_b64_tr_b16 v[26:27], v50 offset:2056
    v_mfma_f32_16x16x32_bf16 v[232:235], v[36:39], a[168:171], v[232:235]
    buffer_load_dwordx4 a[0:3], v6, s[48:51], s63 offen sc1
    v_mfma_f32_16x16x32_bf16 v[236:239], v[36:39], a[172:175], v[236:239]
    v_mfma_f32_16x16x32_bf16 v[236:239], v[32:35], a[156:159], v[236:239]
    ds_read_b64_tr_b16 v[28:29], v50 offset:12296
    ds_read_b64_tr_b16 v[30:31], v50 offset:14344
    v_mfma_f32_16x16x32_bf16 v[252:255], v[40:43], a[156:159], v[252:255]
    s_add_u32 s78, s78, 4096
    s_add_u32 m0, s34, 147456
    v_mfma_f32_16x16x32_bf16 v[252:255], v[44:47], a[172:175], v[252:255]
    buffer_load_dwordx4 v3, s[48:51], s78 offen sc1 lds
    v_mfma_f32_16x16x32_bf16 v[248:251], v[44:47], a[168:171], v[248:251]
    v_mfma_f32_16x16x32_bf16 v[248:251], v[40:43], a[152:155], v[248:251]
    v_mfma_f32_16x16x32_bf16 v[244:247], v[40:43], a[148:151], v[244:247]
    ds_read_b64_tr_b16 v[32:33], v51 offset:0
    ds_read_b64_tr_b16 v[34:35], v51 offset:2048
    v_mfma_f32_16x16x32_bf16 v[244:247], v[44:47], a[164:167], v[244:247]
    buffer_load_dwordx4 a[4:7], v6, s[48:51], s63 offen offset:1024 sc1
    v_mfma_f32_16x16x32_bf16 v[240:243], v[44:47], a[160:163], v[240:243]
    s_nop 0
    v_mfma_f32_16x16x32_bf16 v[240:243], v[40:43], a[144:147], v[240:243]
    s_waitcnt lgkmcnt(2)
    ds_read_b64_tr_b16 v[36:37], v51 offset:12288
    ds_read_b64_tr_b16 v[38:39], v51 offset:14336
    v_mfma_f32_16x16x32_bf16 v[64:67], v[16:19], a[192:195], v[64:67]
    v_mfma_f32_16x16x32_bf16 v[64:67], v[20:23], a[208:211], v[64:67]
    v_mfma_f32_16x16x32_bf16 v[68:71], v[20:23], a[212:215], v[68:71]
    v_mfma_f32_16x16x32_bf16 v[68:71], v[16:19], a[196:199], v[68:71]
    v_mfma_f32_16x16x32_bf16 v[72:75], v[16:19], a[200:203], v[72:75]
    ds_read_b64_tr_b16 v[40:41], v51 offset:8
    ds_read_b64_tr_b16 v[42:43], v51 offset:2056
    v_mfma_f32_16x16x32_bf16 v[72:75], v[20:23], a[216:219], v[72:75]
    s_waitcnt vmcnt(16)
    s_add_u32 s78, s78, 4096
    s_add_u32 m0, s34, 151552
    s_nop 0
    v_mfma_f32_16x16x32_bf16 v[76:79], v[20:23], a[220:223], v[76:79]
    buffer_load_dwordx4 v3, s[48:51], s78 offen sc1 lds
    v_mfma_f32_16x16x32_bf16 v[76:79], v[16:19], a[204:207], v[76:79]
    ds_read_b64_tr_b16 v[44:45], v51 offset:12296
    ds_read_b64_tr_b16 v[46:47], v51 offset:14344
    v_mfma_f32_16x16x32_bf16 v[92:95], v[24:27], a[204:207], v[92:95]
    buffer_load_dwordx4 a[8:11], v6, s[48:51], s63 offen offset:2048 sc1
    v_mfma_f32_16x16x32_bf16 v[92:95], v[28:31], a[220:223], v[92:95]
    v_mfma_f32_16x16x32_bf16 v[88:91], v[28:31], a[216:219], v[88:91]
    v_mfma_f32_16x16x32_bf16 v[88:91], v[24:27], a[200:203], v[88:91]
    v_mfma_f32_16x16x32_bf16 v[84:87], v[24:27], a[196:199], v[84:87]
    ds_read_b64_tr_b16 v[16:17], v50 offset:4096
    ds_read_b64_tr_b16 v[18:19], v50 offset:6144
    v_mfma_f32_16x16x32_bf16 v[84:87], v[28:31], a[212:215], v[84:87]
    v_lshrrev_b32_e64 v54, 3, v0
    v_mul_u32_u24 v54, 384, v54
    v_mfma_f32_16x16x32_bf16 v[80:83], v[28:31], a[208:211], v[80:83]
    v_and_b32 v55, 7, v0
    v_bfe_u32 v14, v0, 4, 3
    v_mfma_f32_16x16x32_bf16 v[80:83], v[24:27], a[192:195], v[80:83]
    s_waitcnt lgkmcnt(2)
    ds_read_b64_tr_b16 v[20:21], v50 offset:16384
    ds_read_b64_tr_b16 v[22:23], v50 offset:18432
    v_mfma_f32_16x16x32_bf16 v[96:99], v[32:35], a[192:195], v[96:99]
    buffer_load_dwordx4 a[12:15], v6, s[48:51], s63 offen offset:3072 sc1
    v_mfma_f32_16x16x32_bf16 v[96:99], v[36:39], a[208:211], v[96:99]
    v_xor_b32 v14, v14, v55
    v_lshl_add_u32 v4, v14, 4, v54
    v_mfma_f32_16x16x32_bf16 v[100:103], v[36:39], a[212:215], v[100:103]
    v_bfe_u32 v14, v0, 4, 2
    v_lshlrev_b32 v14, 1, v14
    v_mfma_f32_16x16x32_bf16 v[100:103], v[32:35], a[196:199], v[100:103]
    v_xor_b32_e64 v14, v14, v55
    v_lshl_add_u32 v5, v14, 4, v54
    v_mfma_f32_16x16x32_bf16 v[104:107], v[32:35], a[200:203], v[104:107]
    ds_read_b64_tr_b16 v[24:25], v50 offset:4104
    ds_read_b64_tr_b16 v[26:27], v50 offset:6152
    v_mfma_f32_16x16x32_bf16 v[104:107], v[36:39], a[216:219], v[104:107]
    v_lshrrev_b32_e64 v54, 6, v1
    v_bfe_u32 v55, v1, 7, 2
    v_mfma_f32_16x16x32_bf16 v[108:111], v[36:39], a[220:223], v[108:111]
    v_bfe_u32 v14, v1, 4, 2
    v_lshlrev_b32_e64 v8, 7, v54
    v_mfma_f32_16x16x32_bf16 v[108:111], v[32:35], a[204:207], v[108:111]
    ds_read_b64_tr_b16 v[28:29], v50 offset:16392
    ds_read_b64_tr_b16 v[30:31], v50 offset:18440
    v_mfma_f32_16x16x32_bf16 v[124:127], v[40:43], a[204:207], v[124:127]
    s_add_u32 s78, s78, 4096
    s_add_u32 m0, s34, 155648
    v_mfma_f32_16x16x32_bf16 v[124:127], v[44:47], a[220:223], v[124:127]
    buffer_load_dwordx4 v3, s[48:51], s78 offen sc1 lds
    v_mfma_f32_16x16x32_bf16 v[120:123], v[44:47], a[216:219], v[120:123]
    s_add_u32 s63, s63, 4096
    v_mfma_f32_16x16x32_bf16 v[120:123], v[40:43], a[200:203], v[120:123]
    buffer_load_dwordx4 a[16:19], v6, s[48:51], s63 offen sc1
    v_mfma_f32_16x16x32_bf16 v[116:119], v[40:43], a[196:199], v[116:119]
    ds_read_b64_tr_b16 v[32:33], v51 offset:4096
    ds_read_b64_tr_b16 v[34:35], v51 offset:6144
    v_mfma_f32_16x16x32_bf16 v[116:119], v[44:47], a[212:215], v[116:119]
    v_lshl_add_u32 v8, v55, 5, v8
    v_lshl_add_u32 v8, v14, 3, v8
    v_mfma_f32_16x16x32_bf16 v[112:115], v[44:47], a[208:211], v[112:115]
    v_add_u32 v8, 49152, v8
    v_xor_b32 v9, 32, v8
    v_mfma_f32_16x16x32_bf16 v[112:115], v[40:43], a[192:195], v[112:115]
    s_waitcnt lgkmcnt(2)
    ds_read_b64_tr_b16 v[36:37], v51 offset:16384
    ds_read_b64_tr_b16 v[38:39], v51 offset:18432
    v_mfma_f32_16x16x32_bf16 v[128:131], v[16:19], a[192:195], v[128:131]
    v_mfma_f32_16x16x32_bf16 v[128:131], v[20:23], a[208:211], v[128:131]
    buffer_load_dwordx4 a[20:23], v7, s[48:51], s63 offen offset:1024 sc1
    v_mfma_f32_16x16x32_bf16 v[132:135], v[20:23], a[212:215], v[132:135]
    v_xor_b32 v10, 64, v8
    v_xor_b32 v11, 96, v8
    v_mfma_f32_16x16x32_bf16 v[132:135], v[16:19], a[196:199], v[132:135]
    v_mul_u32_u24 v14, 3277, v0
    v_lshrrev_b32 v14, 16, v14
    v_mfma_f32_16x16x32_bf16 v[136:139], v[16:19], a[200:203], v[136:139]
    ds_read_b64_tr_b16 v[40:41], v51 offset:4104
    ds_read_b64_tr_b16 v[42:43], v51 offset:6152
    v_mfma_f32_16x16x32_bf16 v[136:139], v[20:23], a[216:219], v[136:139]
    v_mul_u32_u24 v15, 20, v14
    v_sub_u32 v15, v0, v15
    v_mfma_f32_16x16x32_bf16 v[140:143], v[20:23], a[220:223], v[140:143]
    v_lshrrev_b32_e64 v56, 1, v14
    v_and_b32_e64 v56, 2, v56
    v_mfma_f32_16x16x32_bf16 v[140:143], v[16:19], a[204:207], v[140:143]
    ds_read_b64_tr_b16 v[44:45], v51 offset:16392
    ds_read_b64_tr_b16 v[46:47], v51 offset:18440
    v_mfma_f32_16x16x32_bf16 v[156:159], v[24:27], a[204:207], v[156:159]
    v_xor_b32 v15, v15, v56
    v_cmp_gt_u32 vcc, 8, v14
    v_mfma_f32_16x16x32_bf16 v[156:159], v[28:31], a[220:223], v[156:159]
    v_mfma_f32_16x16x32_bf16 v[152:155], v[28:31], a[216:219], v[152:155]
    buffer_load_dwordx4 a[24:27], v7, s[48:51], s63 offen offset:2048 sc1
    v_mfma_f32_16x16x32_bf16 v[152:155], v[24:27], a[200:203], v[152:155]
    v_mul_u32_u24 v14, 1280, v14
    v_lshl_add_u32 v14, v15, 4, v14
    v_mfma_f32_16x16x32_bf16 v[148:151], v[24:27], a[196:199], v[148:151]
    ds_read_b64_tr_b16 v[16:17], v50 offset:8192
    ds_read_b64_tr_b16 v[18:19], v50 offset:10240
    v_mfma_f32_16x16x32_bf16 v[148:151], v[28:31], a[212:215], v[148:151]
    s_add_u32 s78, s78, 4096
    s_add_u32 m0, s34, 0
    v_mfma_f32_16x16x32_bf16 v[144:147], v[28:31], a[208:211], v[144:147]
    buffer_load_dwordx4 v3, s[48:51], s78 offen sc1 lds
    v_mfma_f32_16x16x32_bf16 v[144:147], v[24:27], a[192:195], v[144:147]
    s_waitcnt lgkmcnt(2)
    ds_read_b64_tr_b16 v[20:21], v50 offset:20480
    ds_read_b64_tr_b16 v[22:23], v50 offset:22528
    v_mfma_f32_16x16x32_bf16 v[160:163], v[32:35], a[192:195], v[160:163]
    v_mov_b32 v56, 0x80000000
    v_cndmask_b32 v12, v56, v14, vcc
    v_mfma_f32_16x16x32_bf16 v[160:163], v[36:39], a[208:211], v[160:163]
    v_cndmask_b32 v13, v56, v3, vcc
    v_lshrrev_b32_e64 v14, 6, v1
    v_mfma_f32_16x16x32_bf16 v[164:167], v[36:39], a[212:215], v[164:167]
    v_mfma_f32_16x16x32_bf16 v[164:167], v[32:35], a[196:199], v[164:167]
    buffer_load_dwordx4 a[28:31], v7, s[48:51], s63 offen offset:3072 sc1
    v_mfma_f32_16x16x32_bf16 v[168:171], v[32:35], a[200:203], v[168:171]
    ds_read_b64_tr_b16 v[24:25], v50 offset:8200
    ds_read_b64_tr_b16 v[26:27], v50 offset:10248
    v_mfma_f32_16x16x32_bf16 v[168:171], v[36:39], a[216:219], v[168:171]
    v_mul_u32_u24 v14, 160, v14
    v_bfe_u32 v15, v1, 4, 2
    v_mfma_f32_16x16x32_bf16 v[172:175], v[36:39], a[220:223], v[172:175]
    v_lshl_add_u32 v61, v15, 3, v14
    v_add_u32 v60, 98304, v61
    v_mfma_f32_16x16x32_bf16 v[172:175], v[32:35], a[204:207], v[172:175]
    ds_read_b64_tr_b16 v[28:29], v50 offset:20488
    ds_read_b64_tr_b16 v[30:31], v50 offset:22536
    v_mfma_f32_16x16x32_bf16 v[188:191], v[40:43], a[204:207], v[188:191]
    s_add_u32 s78, s78, 4096
    s_add_u32 m0, s34, 4096
    v_mfma_f32_16x16x32_bf16 v[188:191], v[44:47], a[220:223], v[188:191]
    buffer_load_dwordx4 v3, s[48:51], s78 offen sc1 lds
    v_mfma_f32_16x16x32_bf16 v[184:187], v[44:47], a[216:219], v[184:187]
    v_mfma_f32_16x16x32_bf16 v[184:187], v[40:43], a[200:203], v[184:187]
    v_mfma_f32_16x16x32_bf16 v[180:183], v[40:43], a[196:199], v[180:183]
    s_add_u32 s63, s63, 4096
    ds_read_b64_tr_b16 v[32:33], v51 offset:8192
    ds_read_b64_tr_b16 v[34:35], v51 offset:10240
    v_mfma_f32_16x16x32_bf16 v[180:183], v[44:47], a[212:215], v[180:183]
    buffer_load_dwordx4 a[32:35], v7, s[48:51], s63 offen sc1
    v_mfma_f32_16x16x32_bf16 v[176:179], v[44:47], a[208:211], v[176:179]
    s_nop 0
    v_mfma_f32_16x16x32_bf16 v[176:179], v[40:43], a[192:195], v[176:179]
    s_waitcnt lgkmcnt(2)
    ds_read_b64_tr_b16 v[36:37], v51 offset:20480
    ds_read_b64_tr_b16 v[38:39], v51 offset:22528
    v_mfma_f32_16x16x32_bf16 v[192:195], v[16:19], a[192:195], v[192:195]
    v_mfma_f32_16x16x32_bf16 v[192:195], v[20:23], a[208:211], v[192:195]
    v_mfma_f32_16x16x32_bf16 v[196:199], v[20:23], a[212:215], v[196:199]
    v_mfma_f32_16x16x32_bf16 v[196:199], v[16:19], a[196:199], v[196:199]
    v_mfma_f32_16x16x32_bf16 v[200:203], v[16:19], a[200:203], v[200:203]
    ds_read_b64_tr_b16 v[40:41], v51 offset:8200
    ds_read_b64_tr_b16 v[42:43], v51 offset:10248
    v_mfma_f32_16x16x32_bf16 v[200:203], v[20:23], a[216:219], v[200:203]
    s_add_u32 s78, s78, 4096
    s_add_u32 m0, s34, 8192
    v_mfma_f32_16x16x32_bf16 v[204:207], v[20:23], a[220:223], v[204:207]
    buffer_load_dwordx4 v3, s[48:51], s78 offen sc1 lds
    v_mfma_f32_16x16x32_bf16 v[204:207], v[16:19], a[204:207], v[204:207]
    ds_read_b64_tr_b16 v[44:45], v51 offset:20488
    ds_read_b64_tr_b16 v[46:47], v51 offset:22536
    v_mfma_f32_16x16x32_bf16 v[220:223], v[24:27], a[204:207], v[220:223]
    buffer_load_dwordx4 a[36:39], v7, s[48:51], s63 offen offset:1024 sc1
    v_mfma_f32_16x16x32_bf16 v[220:223], v[28:31], a[220:223], v[220:223]
    v_mfma_f32_16x16x32_bf16 v[216:219], v[28:31], a[216:219], v[216:219]
    v_mfma_f32_16x16x32_bf16 v[216:219], v[24:27], a[200:203], v[216:219]
    v_mfma_f32_16x16x32_bf16 v[212:215], v[24:27], a[196:199], v[212:215]
    ds_read_b64_tr_b16 v[16:17], v50 offset:24576
    ds_read_b64_tr_b16 v[18:19], v50 offset:26624
    v_mfma_f32_16x16x32_bf16 v[212:215], v[28:31], a[212:215], v[212:215]
    s_nop 0
    v_mfma_f32_16x16x32_bf16 v[208:211], v[28:31], a[208:211], v[208:211]
    buffer_load_dwordx4 a[40:43], v57, s[48:51], s63 offen offset:2048 sc1
    v_mfma_f32_16x16x32_bf16 v[208:211], v[24:27], a[192:195], v[208:211]
    s_waitcnt lgkmcnt(2)
    ds_read_b64_tr_b16 v[20:21], v50 offset:36864
    ds_read_b64_tr_b16 v[22:23], v50 offset:38912
    v_mfma_f32_16x16x32_bf16 v[224:227], v[32:35], a[192:195], v[224:227]
    s_add_u32 s78, s78, 4096
    s_add_u32 m0, s34, 12288
    v_mfma_f32_16x16x32_bf16 v[224:227], v[36:39], a[208:211], v[224:227]
    buffer_load_dwordx4 v3, s[48:51], s78 offen sc1 lds
    v_mfma_f32_16x16x32_bf16 v[228:231], v[36:39], a[212:215], v[228:231]
    v_mfma_f32_16x16x32_bf16 v[228:231], v[32:35], a[196:199], v[228:231]
    v_mfma_f32_16x16x32_bf16 v[232:235], v[32:35], a[200:203], v[232:235]
    ds_read_b64_tr_b16 v[24:25], v50 offset:24584
    ds_read_b64_tr_b16 v[26:27], v50 offset:26632
    v_mfma_f32_16x16x32_bf16 v[232:235], v[36:39], a[216:219], v[232:235]
    v_mfma_f32_16x16x32_bf16 v[236:239], v[36:39], a[220:223], v[236:239]
    v_mfma_f32_16x16x32_bf16 v[236:239], v[32:35], a[204:207], v[236:239]
    ds_read_b64_tr_b16 v[28:29], v50 offset:36872
    ds_read_b64_tr_b16 v[30:31], v50 offset:38920
    v_mfma_f32_16x16x32_bf16 v[252:255], v[40:43], a[204:207], v[252:255]
    buffer_load_dwordx4 a[44:47], v57, s[48:51], s63 offen offset:3072 sc1
    v_mfma_f32_16x16x32_bf16 v[252:255], v[44:47], a[220:223], v[252:255]
    v_mfma_f32_16x16x32_bf16 v[248:251], v[44:47], a[216:219], v[248:251]
    v_mfma_f32_16x16x32_bf16 v[248:251], v[40:43], a[200:203], v[248:251]
    v_mfma_f32_16x16x32_bf16 v[244:247], v[40:43], a[196:199], v[244:247]
    ds_read_b64_tr_b16 v[32:33], v51 offset:24576
    ds_read_b64_tr_b16 v[34:35], v51 offset:26624
    v_mfma_f32_16x16x32_bf16 v[244:247], v[44:47], a[212:215], v[244:247]
    s_add_u32 s78, s78, 4096
    s_add_u32 m0, s34, 16384
    v_mfma_f32_16x16x32_bf16 v[240:243], v[44:47], a[208:211], v[240:243]
    buffer_load_dwordx4 v3, s[48:51], s78 offen sc1 lds
    v_mfma_f32_16x16x32_bf16 v[240:243], v[40:43], a[192:195], v[240:243]
    s_nop 0
    s_waitcnt vmcnt(31) lgkmcnt(2)
    s_add_u32 s63, s63, 4096
    ds_read_b64_tr_b16 v[36:37], v51 offset:36864
    ds_read_b64_tr_b16 v[38:39], v51 offset:38912
    v_mfma_f32_16x16x32_bf16 v[64:67], v[16:19], a[224:227], v[64:67]
    s_waitcnt vmcnt(25)
    buffer_load_dwordx4 a[48:51], v57, s[48:51], s63 offen sc1
    v_mfma_f32_16x16x32_bf16 v[64:67], v[20:23], a[240:243], v[64:67]
    s_waitcnt vmcnt(24)
    v_mfma_f32_16x16x32_bf16 v[68:71], v[20:23], a[244:247], v[68:71]
    v_mfma_f32_16x16x32_bf16 v[68:71], v[16:19], a[228:231], v[68:71]
    s_nop 0
    v_mfma_f32_16x16x32_bf16 v[72:75], v[16:19], a[232:235], v[72:75]
    s_waitcnt vmcnt(22)
    ds_read_b64_tr_b16 v[40:41], v51 offset:24584
    ds_read_b64_tr_b16 v[42:43], v51 offset:26632
    v_mfma_f32_16x16x32_bf16 v[72:75], v[20:23], a[248:251], v[72:75]
    s_waitcnt vmcnt(21)
    v_mfma_f32_16x16x32_bf16 v[76:79], v[20:23], a[252:255], v[76:79]
    s_nop 0
    v_mfma_f32_16x16x32_bf16 v[76:79], v[16:19], a[236:239], v[76:79]
    ds_read_b64_tr_b16 v[44:45], v51 offset:36872
    ds_read_b64_tr_b16 v[46:47], v51 offset:38920
    v_mfma_f32_16x16x32_bf16 v[92:95], v[24:27], a[236:239], v[92:95]
    s_add_u32 s78, s78, 4096
    s_add_u32 m0, s34, 20480
    v_mfma_f32_16x16x32_bf16 v[92:95], v[28:31], a[252:255], v[92:95]
    buffer_load_dwordx4 v3, s[48:51], s78 offen sc1 lds
    v_mfma_f32_16x16x32_bf16 v[88:91], v[28:31], a[248:251], v[88:91]
    v_mfma_f32_16x16x32_bf16 v[88:91], v[24:27], a[232:235], v[88:91]
    buffer_load_dwordx4 a[52:55], v57, s[48:51], s63 offen offset:1024 sc1
    v_mfma_f32_16x16x32_bf16 v[84:87], v[24:27], a[228:231], v[84:87]
    ds_read_b64_tr_b16 v[16:17], v50 offset:28672
    ds_read_b64_tr_b16 v[18:19], v50 offset:30720
    v_mfma_f32_16x16x32_bf16 v[84:87], v[28:31], a[244:247], v[84:87]
    v_mfma_f32_16x16x32_bf16 v[80:83], v[28:31], a[240:243], v[80:83]
    s_nop 0
    v_mfma_f32_16x16x32_bf16 v[80:83], v[24:27], a[224:227], v[80:83]
    s_waitcnt lgkmcnt(2)
    ds_read_b64_tr_b16 v[20:21], v50 offset:40960
    ds_read_b64_tr_b16 v[22:23], v50 offset:43008
    v_mfma_f32_16x16x32_bf16 v[96:99], v[32:35], a[224:227], v[96:99]
    v_mfma_f32_16x16x32_bf16 v[96:99], v[36:39], a[240:243], v[96:99]
    v_mfma_f32_16x16x32_bf16 v[100:103], v[36:39], a[244:247], v[100:103]
    buffer_load_dwordx4 a[56:59], v57, s[48:51], s63 offen offset:2048 sc1
    v_mfma_f32_16x16x32_bf16 v[100:103], v[32:35], a[228:231], v[100:103]
    v_mfma_f32_16x16x32_bf16 v[104:107], v[32:35], a[232:235], v[104:107]
    ds_read_b64_tr_b16 v[24:25], v50 offset:28680
    ds_read_b64_tr_b16 v[26:27], v50 offset:30728
    v_mfma_f32_16x16x32_bf16 v[104:107], v[36:39], a[248:251], v[104:107]
    s_add_u32 s78, s78, 4096
    s_add_u32 m0, s34, 24576
    v_mfma_f32_16x16x32_bf16 v[108:111], v[36:39], a[252:255], v[108:111]
    buffer_load_dwordx4 v3, s[48:51], s78 offen sc1 lds
    v_mfma_f32_16x16x32_bf16 v[108:111], v[32:35], a[236:239], v[108:111]
    ds_read_b64_tr_b16 v[28:29], v50 offset:40968
    ds_read_b64_tr_b16 v[30:31], v50 offset:43016
    v_mfma_f32_16x16x32_bf16 v[124:127], v[40:43], a[236:239], v[124:127]
    v_mfma_f32_16x16x32_bf16 v[124:127], v[44:47], a[252:255], v[124:127]
    v_mfma_f32_16x16x32_bf16 v[120:123], v[44:47], a[248:251], v[120:123]
    v_mfma_f32_16x16x32_bf16 v[120:123], v[40:43], a[232:235], v[120:123]
    buffer_load_dwordx4 a[60:63], v59, s[48:51], s63 offen offset:3072 sc1
    v_mfma_f32_16x16x32_bf16 v[116:119], v[40:43], a[228:231], v[116:119]
    ds_read_b64_tr_b16 v[32:33], v51 offset:28672
    ds_read_b64_tr_b16 v[34:35], v51 offset:30720
    v_mfma_f32_16x16x32_bf16 v[116:119], v[44:47], a[244:247], v[116:119]
    v_mfma_f32_16x16x32_bf16 v[112:115], v[44:47], a[240:243], v[112:115]
    s_nop 0
    v_mfma_f32_16x16x32_bf16 v[112:115], v[40:43], a[224:227], v[112:115]
    s_waitcnt lgkmcnt(2)
    ds_read_b64_tr_b16 v[36:37], v51 offset:40960
    ds_read_b64_tr_b16 v[38:39], v51 offset:43008
    v_mfma_f32_16x16x32_bf16 v[128:131], v[16:19], a[224:227], v[128:131]
    s_add_u32 s78, s78, 4096
    s_add_u32 m0, s34, 28672
    v_mfma_f32_16x16x32_bf16 v[128:131], v[20:23], a[240:243], v[128:131]
    buffer_load_dwordx4 v3, s[48:51], s78 offen sc1 lds
    v_mfma_f32_16x16x32_bf16 v[132:135], v[20:23], a[244:247], v[132:135]
    s_nop 0
    v_mfma_f32_16x16x32_bf16 v[132:135], v[16:19], a[228:231], v[132:135]
    s_nop 0
    v_mfma_f32_16x16x32_bf16 v[136:139], v[16:19], a[232:235], v[136:139]
    s_add_u32 s63, s63, 4096
    ds_read_b64_tr_b16 v[40:41], v51 offset:28680
    ds_read_b64_tr_b16 v[42:43], v51 offset:30728
    v_mfma_f32_16x16x32_bf16 v[136:139], v[20:23], a[248:251], v[136:139]
    buffer_load_dwordx4 a[64:67], v59, s[48:51], s63 offen sc1
    v_mfma_f32_16x16x32_bf16 v[140:143], v[20:23], a[252:255], v[140:143]
    v_bfe_u32 v54, v1, 4, 4
    v_lshrrev_b32_e64 v55, 8, v1
    v_mfma_f32_16x16x32_bf16 v[140:143], v[16:19], a[236:239], v[140:143]
    ds_read_b64_tr_b16 v[44:45], v51 offset:40968
    ds_read_b64_tr_b16 v[46:47], v51 offset:43016
    v_mfma_f32_16x16x32_bf16 v[156:159], v[24:27], a[236:239], v[156:159]
    v_lshrrev_b32_e64 v14, 1, v54
    v_xor_b32_e64 v14, v14, v55
    v_mfma_f32_16x16x32_bf16 v[156:159], v[28:31], a[252:255], v[156:159]
    s_add_u32 s78, s78, 4096
    s_add_u32 m0, s34, 32768
    v_mfma_f32_16x16x32_bf16 v[152:155], v[28:31], a[248:251], v[152:155]
    buffer_load_dwordx4 v3, s[48:51], s78 offen sc1 lds
    v_mfma_f32_16x16x32_bf16 v[152:155], v[24:27], a[232:235], v[152:155]
    v_lshlrev_b32_e64 v14, 4, v14
    v_lshl_add_u32 v6, v54, 7, v14
    v_mfma_f32_16x16x32_bf16 v[148:151], v[24:27], a[228:231], v[148:151]
    ds_read_b64_tr_b16 v[16:17], v50 offset:32768
    ds_read_b64_tr_b16 v[18:19], v50 offset:34816
    v_mfma_f32_16x16x32_bf16 v[148:151], v[28:31], a[244:247], v[148:151]
    buffer_load_dwordx4 a[68:71], v59, s[48:51], s63 offen offset:1024 sc1
    v_mfma_f32_16x16x32_bf16 v[144:147], v[28:31], a[240:243], v[144:147]
    v_add_u32 v6, 49152, v6
    v_xor_b32 v7, 64, v6
    v_mfma_f32_16x16x32_bf16 v[144:147], v[24:27], a[224:227], v[144:147]
    s_waitcnt lgkmcnt(2)
    ds_read_b64_tr_b16 v[20:21], v50 offset:45056
    ds_read_b64_tr_b16 v[22:23], v50 offset:47104
    v_mfma_f32_16x16x32_bf16 v[160:163], v[32:35], a[224:227], v[160:163]
    v_mfma_f32_16x16x32_bf16 v[160:163], v[36:39], a[240:243], v[160:163]
    v_mfma_f32_16x16x32_bf16 v[164:167], v[36:39], a[244:247], v[164:167]
    v_mfma_f32_16x16x32_bf16 v[164:167], v[32:35], a[228:231], v[164:167]
    v_mfma_f32_16x16x32_bf16 v[168:171], v[32:35], a[232:235], v[168:171]
    ds_read_b64_tr_b16 v[24:25], v50 offset:32776
    ds_read_b64_tr_b16 v[26:27], v50 offset:34824
    v_mfma_f32_16x16x32_bf16 v[168:171], v[36:39], a[248:251], v[168:171]
    s_add_u32 s78, s78, 4096
    s_add_u32 m0, s34, 36864
    v_mfma_f32_16x16x32_bf16 v[172:175], v[36:39], a[252:255], v[172:175]
    buffer_load_dwordx4 v3, s[48:51], s78 offen sc1 lds
    v_mfma_f32_16x16x32_bf16 v[172:175], v[32:35], a[236:239], v[172:175]
    ds_read_b64_tr_b16 v[28:29], v50 offset:45064
    ds_read_b64_tr_b16 v[30:31], v50 offset:47112
    v_mfma_f32_16x16x32_bf16 v[188:191], v[40:43], a[236:239], v[188:191]
    buffer_load_dwordx4 a[72:75], v59, s[48:51], s63 offen offset:2048 sc1
    v_mfma_f32_16x16x32_bf16 v[188:191], v[44:47], a[252:255], v[188:191]
    v_mfma_f32_16x16x32_bf16 v[184:187], v[44:47], a[248:251], v[184:187]
    v_mfma_f32_16x16x32_bf16 v[184:187], v[40:43], a[232:235], v[184:187]
    v_mfma_f32_16x16x32_bf16 v[180:183], v[40:43], a[228:231], v[180:183]
    ds_read_b64_tr_b16 v[32:33], v51 offset:32768
    ds_read_b64_tr_b16 v[34:35], v51 offset:34816
    v_mfma_f32_16x16x32_bf16 v[180:183], v[44:47], a[244:247], v[180:183]
    v_mfma_f32_16x16x32_bf16 v[176:179], v[44:47], a[240:243], v[176:179]
    s_nop 0
    v_mfma_f32_16x16x32_bf16 v[176:179], v[40:43], a[224:227], v[176:179]
    s_waitcnt lgkmcnt(2)
    ds_read_b64_tr_b16 v[36:37], v51 offset:45056
    ds_read_b64_tr_b16 v[38:39], v51 offset:47104
    v_mfma_f32_16x16x32_bf16 v[192:195], v[16:19], a[224:227], v[192:195]
    buffer_load_dwordx4 a[76:79], v59, s[48:51], s63 offen offset:3072 sc1
    v_mfma_f32_16x16x32_bf16 v[192:195], v[20:23], a[240:243], v[192:195]
    v_mfma_f32_16x16x32_bf16 v[196:199], v[20:23], a[244:247], v[196:199]
    v_mfma_f32_16x16x32_bf16 v[196:199], v[16:19], a[228:231], v[196:199]
    v_mfma_f32_16x16x32_bf16 v[200:203], v[16:19], a[232:235], v[200:203]
    ds_read_b64_tr_b16 v[40:41], v51 offset:32776
    ds_read_b64_tr_b16 v[42:43], v51 offset:34824
    v_mfma_f32_16x16x32_bf16 v[200:203], v[20:23], a[248:251], v[200:203]
    v_mfma_f32_16x16x32_bf16 v[204:207], v[20:23], a[252:255], v[204:207]
    v_mfma_f32_16x16x32_bf16 v[204:207], v[16:19], a[236:239], v[204:207]
    ds_read_b64_tr_b16 v[44:45], v51 offset:45064
    ds_read_b64_tr_b16 v[46:47], v51 offset:47112
    v_mfma_f32_16x16x32_bf16 v[220:223], v[24:27], a[236:239], v[220:223]
    v_mfma_f32_16x16x32_bf16 v[220:223], v[28:31], a[252:255], v[220:223]
    v_mfma_f32_16x16x32_bf16 v[216:219], v[28:31], a[248:251], v[216:219]
    v_mfma_f32_16x16x32_bf16 v[216:219], v[24:27], a[232:235], v[216:219]
    s_nop 0
    v_mfma_f32_16x16x32_bf16 v[212:215], v[24:27], a[228:231], v[212:215]
    s_waitcnt lgkmcnt(0)
    s_barrier
    s_mov_b32 s66, 0
    s_mov_b32 s67, 0
    s_mov_b32 s68, 12288
    s_mov_b32 s69, 0
    s_add_u32 s61, s34, 49152
    v_mfma_f32_16x16x32_bf16 v[212:215], v[28:31], a[244:247], v[212:215]
    buffer_load_dwordx2 a[80:81], v58, s[48:51], s64 offen offset:0 sc1
    v_mfma_f32_16x16x32_bf16 v[208:211], v[28:31], a[240:243], v[208:211]
    v_mfma_f32_16x16x32_bf16 v[208:211], v[24:27], a[224:227], v[208:211]
    v_mfma_f32_16x16x32_bf16 v[224:227], v[32:35], a[224:227], v[224:227]
    v_mfma_f32_16x16x32_bf16 v[224:227], v[36:39], a[240:243], v[224:227]
    buffer_load_dwordx2 a[82:83], v58, s[48:51], s64 offen offset:512 sc1
    v_mfma_f32_16x16x32_bf16 v[228:231], v[36:39], a[244:247], v[228:231]
    v_mfma_f32_16x16x32_bf16 v[228:231], v[32:35], a[228:231], v[228:231]
    v_mfma_f32_16x16x32_bf16 v[232:235], v[32:35], a[232:235], v[232:235]
    v_mfma_f32_16x16x32_bf16 v[232:235], v[36:39], a[248:251], v[232:235]
    v_mfma_f32_16x16x32_bf16 v[236:239], v[36:39], a[252:255], v[236:239]
    buffer_load_dwordx2 a[84:85], v58, s[48:51], s64 offen offset:1024 sc1
    v_mfma_f32_16x16x32_bf16 v[236:239], v[32:35], a[236:239], v[236:239]
    v_mfma_f32_16x16x32_bf16 v[252:255], v[40:43], a[236:239], v[252:255]
    v_mfma_f32_16x16x32_bf16 v[252:255], v[44:47], a[252:255], v[252:255]
    v_mfma_f32_16x16x32_bf16 v[248:251], v[44:47], a[248:251], v[248:251]
    buffer_load_dwordx2 a[86:87], v58, s[48:51], s64 offen offset:1536 sc1
    v_mfma_f32_16x16x32_bf16 v[248:251], v[40:43], a[232:235], v[248:251]
    v_mfma_f32_16x16x32_bf16 v[244:247], v[40:43], a[228:231], v[244:247]
    v_mfma_f32_16x16x32_bf16 v[244:247], v[44:47], a[244:247], v[244:247]
    s_nop 0
    v_mfma_f32_16x16x32_bf16 v[240:243], v[44:47], a[240:243], v[240:243]
    s_nop 0
    v_mfma_f32_16x16x32_bf16 v[240:243], v[40:43], a[224:227], v[240:243]
    v_pk_mul_f32 v[64:65], v[64:65], s[14:15]
    v_pk_mul_f32 v[66:67], v[66:67], s[14:15]
    v_pk_mul_f32 v[80:81], v[80:81], s[14:15]
    v_pk_mul_f32 v[82:83], v[82:83], s[14:15]
    buffer_load_dwordx2 a[88:89], v58, s[48:51], s64 offen offset:2048 sc1
    v_cvt_pk_bf16_f32 v48, v64, v65
    v_cvt_pk_bf16_f32 v49, v66, v67
    v_cvt_pk_bf16_f32 v50, v80, v81
    v_cvt_pk_bf16_f32 v51, v82, v83
    v_accvgpr_write_b32 a192, v48
    v_accvgpr_write_b32 a193, v49
    v_accvgpr_write_b32 a194, v50
    v_accvgpr_write_b32 a195, v51
    v_pk_mul_f32 v[68:69], v[68:69], s[14:15]
    v_pk_mul_f32 v[70:71], v[70:71], s[14:15]
    v_pk_mul_f32 v[84:85], v[84:85], s[14:15]
    v_pk_mul_f32 v[86:87], v[86:87], s[14:15]
    v_cvt_pk_bf16_f32 v52, v68, v69
    v_cvt_pk_bf16_f32 v53, v70, v71
    v_cvt_pk_bf16_f32 v54, v84, v85
    v_cvt_pk_bf16_f32 v55, v86, v87
    v_accvgpr_write_b32 a216, v52
    s_add_u32 m0, s61, 0
    s_nop 0
    buffer_load_dwordx4 v4, s[36:39], s66 offen nt lds
    v_accvgpr_write_b32 a217, v53
    v_accvgpr_write_b32 a218, v54
    v_accvgpr_write_b32 a219, v55
    v_pk_mul_f32 v[72:73], v[72:73], s[14:15]
    v_pk_mul_f32 v[74:75], v[74:75], s[14:15]
    v_pk_mul_f32 v[88:89], v[88:89], s[14:15]
    v_pk_mul_f32 v[90:91], v[90:91], s[14:15]
    v_cvt_pk_bf16_f32 v48, v72, v73
    v_cvt_pk_bf16_f32 v49, v74, v75
    v_cvt_pk_bf16_f32 v50, v88, v89
    v_cvt_pk_bf16_f32 v51, v90, v91
    v_accvgpr_write_b32 a240, v48
    v_accvgpr_write_b32 a241, v49
    v_accvgpr_write_b32 a242, v50
    v_accvgpr_write_b32 a243, v51
    v_pk_mul_f32 v[76:77], v[76:77], s[14:15]
    v_pk_mul_f32 v[78:79], v[78:79], s[14:15]
    v_pk_mul_f32 v[92:93], v[92:93], s[14:15]
    s_add_u32 m0, s61, 3968
    s_nop 0
    s_nop 0
    buffer_load_dwordx4 v4, s[36:39], s66 offen offset:128 nt lds
    v_pk_mul_f32 v[94:95], v[94:95], s[14:15]
    v_cvt_pk_bf16_f32 v24, v76, v77
    v_cvt_pk_bf16_f32 v25, v78, v79
    v_cvt_pk_bf16_f32 v26, v92, v93
    v_cvt_pk_bf16_f32 v27, v94, v95
    v_pk_mul_f32 v[96:97], v[96:97], s[14:15]
    v_pk_mul_f32 v[98:99], v[98:99], s[14:15]
    v_pk_mul_f32 v[112:113], v[112:113], s[14:15]
    v_pk_mul_f32 v[114:115], v[114:115], s[14:15]
    v_cvt_pk_bf16_f32 v48, v96, v97
    v_cvt_pk_bf16_f32 v49, v98, v99
    v_cvt_pk_bf16_f32 v50, v112, v113
    v_cvt_pk_bf16_f32 v51, v114, v115
    v_accvgpr_write_b32 a196, v48
    v_accvgpr_write_b32 a197, v49
    v_accvgpr_write_b32 a198, v50
    v_accvgpr_write_b32 a199, v51
    s_add_u32 m0, s61, 7936
    s_nop 0
    s_nop 0
    buffer_load_dwordx4 v4, s[36:39], s66 offen offset:256 nt lds
    v_pk_mul_f32 v[100:101], v[100:101], s[14:15]
    v_pk_mul_f32 v[102:103], v[102:103], s[14:15]
    v_pk_mul_f32 v[116:117], v[116:117], s[14:15]
    v_pk_mul_f32 v[118:119], v[118:119], s[14:15]
    v_cvt_pk_bf16_f32 v52, v100, v101
    v_cvt_pk_bf16_f32 v53, v102, v103
    v_cvt_pk_bf16_f32 v54, v116, v117
    v_cvt_pk_bf16_f32 v55, v118, v119
    v_accvgpr_write_b32 a220, v52
    v_accvgpr_write_b32 a221, v53
    v_accvgpr_write_b32 a222, v54
    v_accvgpr_write_b32 a223, v55
    v_pk_mul_f32 v[104:105], v[104:105], s[14:15]
    v_pk_mul_f32 v[106:107], v[106:107], s[14:15]
    v_pk_mul_f32 v[120:121], v[120:121], s[14:15]
    v_pk_mul_f32 v[122:123], v[122:123], s[14:15]
    v_cvt_pk_bf16_f32 v48, v104, v105
    v_cvt_pk_bf16_f32 v49, v106, v107
    s_add_u32 m0, s61, 24576
    s_nop 0
    buffer_load_dwordx4 v4, s[36:39], s68 offen nt lds
    v_cvt_pk_bf16_f32 v50, v120, v121
    s_nop 0
    v_cvt_pk_bf16_f32 v51, v122, v123
    v_accvgpr_write_b32 a244, v48
    v_accvgpr_write_b32 a245, v49
    v_accvgpr_write_b32 a246, v50
    v_accvgpr_write_b32 a247, v51
    v_pk_mul_f32 v[108:109], v[108:109], s[14:15]
    v_pk_mul_f32 v[110:111], v[110:111], s[14:15]
    v_pk_mul_f32 v[124:125], v[124:125], s[14:15]
    v_pk_mul_f32 v[126:127], v[126:127], s[14:15]
    v_cvt_pk_bf16_f32 v28, v108, v109
    v_cvt_pk_bf16_f32 v29, v110, v111
    v_cvt_pk_bf16_f32 v30, v124, v125
    v_cvt_pk_bf16_f32 v31, v126, v127
    v_pk_mul_f32 v[128:129], v[128:129], s[14:15]
    v_pk_mul_f32 v[130:131], v[130:131], s[14:15]
    v_pk_mul_f32 v[144:145], v[144:145], s[14:15]
    v_pk_mul_f32 v[146:147], v[146:147], s[14:15]
    s_add_u32 m0, s61, 28544
    s_nop 0
    buffer_load_dwordx4 v4, s[36:39], s68 offen offset:128 nt lds
    s_nop 0
    v_cvt_pk_bf16_f32 v48, v128, v129
    v_cvt_pk_bf16_f32 v49, v130, v131
    v_cvt_pk_bf16_f32 v50, v144, v145
    v_cvt_pk_bf16_f32 v51, v146, v147
    v_accvgpr_write_b32 a200, v48
    v_accvgpr_write_b32 a201, v49
    v_accvgpr_write_b32 a202, v50
    v_accvgpr_write_b32 a203, v51
    v_pk_mul_f32 v[132:133], v[132:133], s[14:15]
    v_pk_mul_f32 v[134:135], v[134:135], s[14:15]
    v_pk_mul_f32 v[148:149], v[148:149], s[14:15]
    v_pk_mul_f32 v[150:151], v[150:151], s[14:15]
    v_cvt_pk_bf16_f32 v52, v132, v133
    v_cvt_pk_bf16_f32 v53, v134, v135
    v_cvt_pk_bf16_f32 v54, v148, v149
    v_cvt_pk_bf16_f32 v55, v150, v151
    v_accvgpr_write_b32 a224, v52
    s_add_u32 m0, s61, 32512
    s_nop 0
    buffer_load_dwordx4 v4, s[36:39], s68 offen offset:256 nt lds
    s_nop 0
    v_accvgpr_write_b32 a225, v53
    v_accvgpr_write_b32 a226, v54
    v_accvgpr_write_b32 a227, v55
    v_pk_mul_f32 v[136:137], v[136:137], s[14:15]
    v_pk_mul_f32 v[138:139], v[138:139], s[14:15]
    v_pk_mul_f32 v[152:153], v[152:153], s[14:15]
    v_pk_mul_f32 v[154:155], v[154:155], s[14:15]
    v_cvt_pk_bf16_f32 v48, v136, v137
    v_cvt_pk_bf16_f32 v49, v138, v139
    v_cvt_pk_bf16_f32 v50, v152, v153
    v_cvt_pk_bf16_f32 v51, v154, v155
    v_accvgpr_write_b32 a248, v48
    v_accvgpr_write_b32 a249, v49
    v_accvgpr_write_b32 a250, v50
    v_accvgpr_write_b32 a251, v51
    v_pk_mul_f32 v[140:141], v[140:141], s[14:15]
    v_pk_mul_f32 v[142:143], v[142:143], s[14:15]
    v_pk_mul_f32 v[156:157], v[156:157], s[14:15]
    s_add_u32 m0, s61, 36864
    s_nop 0
    s_nop 0
    buffer_load_dwordx4 v5, s[40:43], s69 offen nt lds
    v_pk_mul_f32 v[158:159], v[158:159], s[14:15]
    v_cvt_pk_bf16_f32 v32, v140, v141
    v_cvt_pk_bf16_f32 v33, v142, v143
    v_cvt_pk_bf16_f32 v34, v156, v157
    v_cvt_pk_bf16_f32 v35, v158, v159
    v_pk_mul_f32 v[160:161], v[160:161], s[14:15]
    v_pk_mul_f32 v[162:163], v[162:163], s[14:15]
    v_pk_mul_f32 v[176:177], v[176:177], s[14:15]
    v_pk_mul_f32 v[178:179], v[178:179], s[14:15]
    v_pk_mul_f32 v[164:165], v[164:165], s[14:15]
    v_pk_mul_f32 v[166:167], v[166:167], s[14:15]
    v_pk_mul_f32 v[180:181], v[180:181], s[14:15]
    v_pk_mul_f32 v[182:183], v[182:183], s[14:15]
    v_pk_mul_f32 v[168:169], v[168:169], s[14:15]
    v_pk_mul_f32 v[170:171], v[170:171], s[14:15]
    v_pk_mul_f32 v[184:185], v[184:185], s[14:15]
    v_pk_mul_f32 v[186:187], v[186:187], s[14:15]
    s_add_u32 m0, s61, 40832
    s_nop 0
    s_nop 0
    buffer_load_dwordx4 v5, s[40:43], s69 offen offset:128 nt lds
    v_pk_mul_f32 v[172:173], v[172:173], s[14:15]
    v_pk_mul_f32 v[174:175], v[174:175], s[14:15]
    v_pk_mul_f32 v[188:189], v[188:189], s[14:15]
    v_pk_mul_f32 v[190:191], v[190:191], s[14:15]
    v_pk_mul_f32 v[192:193], v[192:193], s[14:15]
    v_pk_mul_f32 v[194:195], v[194:195], s[14:15]
    v_pk_mul_f32 v[208:209], v[208:209], s[14:15]
    v_pk_mul_f32 v[210:211], v[210:211], s[14:15]
    v_pk_mul_f32 v[196:197], v[196:197], s[14:15]
    v_pk_mul_f32 v[198:199], v[198:199], s[14:15]
    v_pk_mul_f32 v[212:213], v[212:213], s[14:15]
    v_pk_mul_f32 v[214:215], v[214:215], s[14:15]
    v_pk_mul_f32 v[200:201], v[200:201], s[14:15]
    v_pk_mul_f32 v[202:203], v[202:203], s[14:15]
    v_pk_mul_f32 v[216:217], v[216:217], s[14:15]
    v_pk_mul_f32 v[218:219], v[218:219], s[14:15]
    v_pk_mul_f32 v[204:205], v[204:205], s[14:15]
    v_pk_mul_f32 v[206:207], v[206:207], s[14:15]
    s_add_u32 m0, s61, 44800
    s_nop 0
    s_nop 0
    buffer_load_dwordx4 v5, s[40:43], s69 offen offset:256 nt lds
    v_pk_mul_f32 v[220:221], v[220:221], s[14:15]
    v_pk_mul_f32 v[222:223], v[222:223], s[14:15]
    v_pk_mul_f32 v[224:225], v[224:225], s[14:15]
    v_pk_mul_f32 v[226:227], v[226:227], s[14:15]
    v_pk_mul_f32 v[240:241], v[240:241], s[14:15]
    v_pk_mul_f32 v[242:243], v[242:243], s[14:15]
    v_pk_mul_f32 v[228:229], v[228:229], s[14:15]
    v_pk_mul_f32 v[230:231], v[230:231], s[14:15]
    v_pk_mul_f32 v[244:245], v[244:245], s[14:15]
    v_pk_mul_f32 v[246:247], v[246:247], s[14:15]
    v_pk_mul_f32 v[232:233], v[232:233], s[14:15]
    v_pk_mul_f32 v[234:235], v[234:235], s[14:15]
    v_pk_mul_f32 v[248:249], v[248:249], s[14:15]
    v_pk_mul_f32 v[250:251], v[250:251], s[14:15]
    v_pk_mul_f32 v[236:237], v[236:237], s[14:15]
    v_pk_mul_f32 v[238:239], v[238:239], s[14:15]
    v_pk_mul_f32 v[252:253], v[252:253], s[14:15]
    v_pk_mul_f32 v[254:255], v[254:255], s[14:15]
    s_waitcnt vmcnt(40)
    s_barrier
    ds_read_b64_tr_b16 v[84:85], v60 offset:0
    ds_read_b64_tr_b16 v[86:87], v60 offset:2560
    ds_read_b64_tr_b16 v[88:89], v60 offset:5120
    ds_read_b64_tr_b16 v[90:91], v60 offset:7680
    ds_read_b64_tr_b16 v[92:93], v60 offset:12800
    ds_read_b64_tr_b16 v[94:95], v60 offset:15360
    ds_read_b64_tr_b16 v[96:97], v60 offset:17920
    ds_read_b64_tr_b16 v[98:99], v60 offset:20480
    ds_read_b64_tr_b16 v[100:101], v60 offset:17952
    ds_read_b64_tr_b16 v[102:103], v60 offset:20512
    ds_read_b64_tr_b16 v[104:105], v60 offset:12832
    ds_read_b64_tr_b16 v[106:107], v60 offset:15392
    ds_read_b64_tr_b16 v[108:109], v60 offset:5152
    ds_read_b64_tr_b16 v[110:111], v60 offset:7712
    ds_read_b64_tr_b16 v[112:113], v60 offset:32
    ds_read_b64_tr_b16 v[114:115], v60 offset:2592
    ds_read_b64_tr_b16 v[116:117], v60 offset:64
    ds_read_b64_tr_b16 v[118:119], v60 offset:2624
    ds_read_b64_tr_b16 v[120:121], v60 offset:5184
    ds_read_b64_tr_b16 v[122:123], v60 offset:7744
    ds_read_b64_tr_b16 v[124:125], v60 offset:12864
    ds_read_b64_tr_b16 v[126:127], v60 offset:15424
    ds_read_b64_tr_b16 v[128:129], v60 offset:17984
    ds_read_b64_tr_b16 v[130:131], v60 offset:20544
    s_waitcnt lgkmcnt(15)
    v_mfma_f32_16x16x32_bf16 v[64:67], v[84:87], a[0:3], 0
    s_nop 0
    ds_read_b64_tr_b16 v[132:133], v60 offset:18016
    ds_read_b64_tr_b16 v[134:135], v60 offset:20576
    v_cvt_pk_bf16_f32 v48, v160, v161
    v_mfma_f32_16x16x32_bf16 v[64:67], v[88:91], a[4:7], v[64:67]
    ds_read_b64_tr_b16 v[136:137], v60 offset:12896
    ds_read_b64_tr_b16 v[138:139], v60 offset:15456
    v_cvt_pk_bf16_f32 v49, v162, v163
    v_mfma_f32_16x16x32_bf16 v[64:67], v[92:95], a[8:11], v[64:67]
    ds_read_b64_tr_b16 v[140:141], v60 offset:5216
    ds_read_b64_tr_b16 v[142:143], v60 offset:7776
    v_cvt_pk_bf16_f32 v50, v176, v177
    v_mfma_f32_16x16x32_bf16 v[64:67], v[96:99], a[12:15], v[64:67]
    s_waitcnt lgkmcnt(15)
    s_nop 0
    ds_read_b64_tr_b16 v[144:145], v60 offset:96
    ds_read_b64_tr_b16 v[146:147], v60 offset:2656
    v_cvt_pk_bf16_f32 v51, v178, v179
    v_mfma_f32_16x16x32_bf16 v[68:71], v[100:103], a[12:15], 0
    ds_read_b64_tr_b16 v[84:85], v60 offset:128
    ds_read_b64_tr_b16 v[86:87], v60 offset:2688
    v_accvgpr_write_b32 a204, v48
    v_mfma_f32_16x16x32_bf16 v[68:71], v[104:107], a[8:11], v[68:71]
    ds_read_b64_tr_b16 v[88:89], v60 offset:5248
    ds_read_b64_tr_b16 v[90:91], v60 offset:7808
    v_accvgpr_write_b32 a205, v49
    v_mfma_f32_16x16x32_bf16 v[68:71], v[108:111], a[4:7], v[68:71]
    s_nop 0
    s_waitcnt lgkmcnt(10)
    ds_read_b64_tr_b16 v[92:93], v60 offset:12928
    ds_read_b64_tr_b16 v[94:95], v60 offset:15488
    v_accvgpr_write_b32 a206, v50
    v_mfma_f32_16x16x32_bf16 v[68:71], v[112:115], a[0:3], v[68:71]
    ds_read_b64_tr_b16 v[96:97], v60 offset:18048
    ds_read_b64_tr_b16 v[98:99], v60 offset:20608
    v_accvgpr_write_b32 a207, v51
    v_mfma_f32_16x16x32_bf16 v[72:75], v[116:119], a[0:3], 0
    ds_read_b64_tr_b16 v[100:101], v60 offset:10240
    ds_read_b64_tr_b16 v[102:103], v60 offset:23040
    v_cvt_pk_bf16_f32 v52, v164, v165
    v_mfma_f32_16x16x32_bf16 v[72:75], v[120:123], a[4:7], v[72:75]
    ds_read_b64_tr_b16 v[104:105], v60 offset:25600
    ds_read_b64_tr_b16 v[106:107], v60 offset:28160
    v_cvt_pk_bf16_f32 v53, v166, v167
    v_mfma_f32_16x16x32_bf16 v[72:75], v[124:127], a[8:11], v[72:75]
    ds_read_b64_tr_b16 v[108:109], v60 offset:30720
    ds_read_b64_tr_b16 v[110:111], v60 offset:33280
    v_cvt_pk_bf16_f32 v54, v180, v181
    v_mfma_f32_16x16x32_bf16 v[72:75], v[128:131], a[12:15], v[72:75]
    ds_read_b64_tr_b16 v[112:113], v60 offset:38400
    ds_read_b64_tr_b16 v[114:115], v60 offset:40960
    v_cvt_pk_bf16_f32 v55, v182, v183
    v_mfma_f32_16x16x32_bf16 v[76:79], v[132:135], a[12:15], 0
    s_waitcnt lgkmcnt(10)
    ds_read_b64_tr_b16 v[116:117], v60 offset:38432
    ds_read_b64_tr_b16 v[118:119], v60 offset:40992
    s_nop 0
    v_accvgpr_write_b32 a228, v52
    v_mfma_f32_16x16x32_bf16 v[76:79], v[136:139], a[8:11], v[76:79]
    ds_read_b64_tr_b16 v[120:121], v60 offset:30752
    ds_read_b64_tr_b16 v[122:123], v60 offset:33312
    v_accvgpr_write_b32 a229, v53
    v_mfma_f32_16x16x32_bf16 v[76:79], v[140:143], a[4:7], v[76:79]
    ds_read_b64_tr_b16 v[124:125], v60 offset:25632
    ds_read_b64_tr_b16 v[126:127], v60 offset:28192
    v_accvgpr_write_b32 a230, v54
    v_mfma_f32_16x16x32_bf16 v[76:79], v[144:147], a[0:3], v[76:79]
    ds_read_b64_tr_b16 v[128:129], v60 offset:10272
    ds_read_b64_tr_b16 v[130:131], v60 offset:23072
    v_accvgpr_write_b32 a231, v55
    v_mfma_f32_16x16x32_bf16 v[80:83], v[84:87], a[0:3], 0
    ds_read_b64_tr_b16 v[132:133], v60 offset:10304
    ds_read_b64_tr_b16 v[134:135], v60 offset:23104
    v_cvt_pk_bf16_f32 v48, v168, v169
    v_mfma_f32_16x16x32_bf16 v[80:83], v[88:91], a[4:7], v[80:83]
    ds_read_b64_tr_b16 v[136:137], v60 offset:25664
    ds_read_b64_tr_b16 v[138:139], v60 offset:28224
    v_cvt_pk_bf16_f32 v49, v170, v171
    v_mfma_f32_16x16x32_bf16 v[80:83], v[92:95], a[8:11], v[80:83]
    s_waitcnt lgkmcnt(10)
    ds_read_b64_tr_b16 v[140:141], v60 offset:30784
    ds_read_b64_tr_b16 v[142:143], v60 offset:33344
    v_cvt_pk_bf16_f32 v50, v184, v185
    v_mfma_f32_16x16x32_bf16 v[80:83], v[96:99], a[12:15], v[80:83]
    s_waitcnt vmcnt(39)
    ds_read_b64_tr_b16 v[144:145], v60 offset:38464
    ds_read_b64_tr_b16 v[146:147], v60 offset:41024
    v_cvt_pk_bf16_f32 v51, v186, v187
    v_mfma_f32_16x16x32_bf16 v[64:67], v[100:103], a[16:19], v[64:67]
    s_waitcnt vmcnt(38)
    ds_read_b64_tr_b16 v[84:85], v60 offset:38496
    ds_read_b64_tr_b16 v[86:87], v60 offset:41056
    v_accvgpr_write_b32 a252, v48
    v_mfma_f32_16x16x32_bf16 v[64:67], v[104:107], a[20:23], v[64:67]
    s_waitcnt vmcnt(37)
    ds_read_b64_tr_b16 v[88:89], v60 offset:30816
    ds_read_b64_tr_b16 v[90:91], v60 offset:33376
    v_accvgpr_write_b32 a253, v49
    v_mfma_f32_16x16x32_bf16 v[64:67], v[108:111], a[24:27], v[64:67]
    s_waitcnt vmcnt(35)
    ds_read_b64_tr_b16 v[92:93], v60 offset:25696
    ds_read_b64_tr_b16 v[94:95], v60 offset:28256
    v_accvgpr_write_b32 a254, v50
    v_mfma_f32_16x16x32_bf16 v[64:67], v[112:115], a[28:31], v[64:67]
    ds_read_b64_tr_b16 v[96:97], v60 offset:10336
    ds_read_b64_tr_b16 v[98:99], v60 offset:23136
    v_accvgpr_write_b32 a255, v51
    v_mfma_f32_16x16x32_bf16 v[68:71], v[116:119], a[28:31], v[68:71]
    s_waitcnt lgkmcnt(10)
    ds_read_b64_tr_b16 v[100:101], v60 offset:10368
    ds_read_b64_tr_b16 v[102:103], v60 offset:23168
    v_cvt_pk_bf16_f32 v36, v172, v173
    v_mfma_f32_16x16x32_bf16 v[68:71], v[120:123], a[24:27], v[68:71]
    ds_read_b64_tr_b16 v[104:105], v60 offset:25728
    ds_read_b64_tr_b16 v[106:107], v60 offset:28288
    v_cvt_pk_bf16_f32 v37, v174, v175
    v_mfma_f32_16x16x32_bf16 v[68:71], v[124:127], a[20:23], v[68:71]
    ds_read_b64_tr_b16 v[108:109], v60 offset:30848
    ds_read_b64_tr_b16 v[110:111], v60 offset:33408
    v_cvt_pk_bf16_f32 v38, v188, v189
    v_mfma_f32_16x16x32_bf16 v[68:71], v[128:131], a[16:19], v[68:71]
    ds_read_b64_tr_b16 v[112:113], v60 offset:38528
    ds_read_b64_tr_b16 v[114:115], v60 offset:41088
    v_cvt_pk_bf16_f32 v39, v190, v191
    v_mfma_f32_16x16x32_bf16 v[72:75], v[132:135], a[16:19], v[72:75]
    ds_read_b64_tr_b16 v[116:117], v60 offset:43520
    ds_read_b64_tr_b16 v[118:119], v60 offset:46080
    v_cvt_pk_bf16_f32 v48, v192, v193
    v_mfma_f32_16x16x32_bf16 v[72:75], v[136:139], a[20:23], v[72:75]
    ds_read_b64_tr_b16 v[120:121], v60 offset:35840
    ds_read_b64_tr_b16 v[122:123], v60 offset:48640
    v_cvt_pk_bf16_f32 v49, v194, v195
    v_mfma_f32_16x16x32_bf16 v[72:75], v[140:143], a[24:27], v[72:75]
    s_waitcnt lgkmcnt(10)
    ds_read_b64_tr_b16 v[124:125], v60 offset:51200
    ds_read_b64_tr_b16 v[126:127], v60 offset:53760
    s_nop 0
    v_cvt_pk_bf16_f32 v50, v208, v209
    v_mfma_f32_16x16x32_bf16 v[72:75], v[144:147], a[28:31], v[72:75]
    ds_read_b64_tr_b16 v[128:129], v60 offset:56320
    ds_read_b64_tr_b16 v[130:131], v60 offset:58880
    v_cvt_pk_bf16_f32 v51, v210, v211
    v_mfma_f32_16x16x32_bf16 v[76:79], v[84:87], a[28:31], v[76:79]
    ds_read_b64_tr_b16 v[132:133], v60 offset:56352
    ds_read_b64_tr_b16 v[134:135], v60 offset:58912
    v_accvgpr_write_b32 a208, v48
    v_mfma_f32_16x16x32_bf16 v[76:79], v[88:91], a[24:27], v[76:79]
    ds_read_b64_tr_b16 v[136:137], v60 offset:51232
    ds_read_b64_tr_b16 v[138:139], v60 offset:53792
    v_accvgpr_write_b32 a209, v49
    v_mfma_f32_16x16x32_bf16 v[76:79], v[92:95], a[20:23], v[76:79]
    ds_read_b64_tr_b16 v[140:141], v60 offset:35872
    ds_read_b64_tr_b16 v[142:143], v60 offset:48672
    v_accvgpr_write_b32 a210, v50
    v_mfma_f32_16x16x32_bf16 v[76:79], v[96:99], a[16:19], v[76:79]
    ds_read_b64_tr_b16 v[144:145], v60 offset:43552
    ds_read_b64_tr_b16 v[146:147], v60 offset:46112
    v_accvgpr_write_b32 a211, v51
    v_mfma_f32_16x16x32_bf16 v[80:83], v[100:103], a[16:19], v[80:83]
    s_waitcnt lgkmcnt(10)
    ds_read_b64_tr_b16 v[84:85], v60 offset:43584
    s_nop 0
    ds_read_b64_tr_b16 v[86:87], v60 offset:46144
    v_cvt_pk_bf16_f32 v52, v196, v197
    v_mfma_f32_16x16x32_bf16 v[80:83], v[104:107], a[20:23], v[80:83]
    ds_read_b64_tr_b16 v[88:89], v60 offset:35904
    ds_read_b64_tr_b16 v[90:91], v60 offset:48704
    v_cvt_pk_bf16_f32 v53, v198, v199
    v_mfma_f32_16x16x32_bf16 v[80:83], v[108:111], a[24:27], v[80:83]
    ds_read_b64_tr_b16 v[92:93], v60 offset:51264
    ds_read_b64_tr_b16 v[94:95], v60 offset:53824
    v_cvt_pk_bf16_f32 v54, v212, v213
    v_mfma_f32_16x16x32_bf16 v[80:83], v[112:115], a[28:31], v[80:83]
    s_waitcnt vmcnt(33)
    ds_read_b64_tr_b16 v[96:97], v60 offset:56384
    ds_read_b64_tr_b16 v[98:99], v60 offset:58944
    v_cvt_pk_bf16_f32 v55, v214, v215
    v_mfma_f32_16x16x32_bf16 v[64:67], v[116:119], a[32:35], v[64:67]
    s_waitcnt vmcnt(31)
    ds_read_b64_tr_b16 v[100:101], v60 offset:56416
    ds_read_b64_tr_b16 v[102:103], v60 offset:58976
    v_accvgpr_write_b32 a232, v52
    v_mfma_f32_16x16x32_bf16 v[64:67], v[120:123], a[36:39], v[64:67]
    s_waitcnt vmcnt(30)
    ds_read_b64_tr_b16 v[104:105], v60 offset:51296
    ds_read_b64_tr_b16 v[106:107], v60 offset:53856
    v_accvgpr_write_b32 a233, v53
    v_mfma_f32_16x16x32_bf16 v[64:67], v[124:127], a[40:43], v[64:67]
    s_waitcnt vmcnt(28) lgkmcnt(10)
    ds_read_b64_tr_b16 v[108:109], v60 offset:35936
    ds_read_b64_tr_b16 v[110:111], v60 offset:48736
    v_accvgpr_write_b32 a234, v54
    v_mfma_f32_16x16x32_bf16 v[64:67], v[128:131], a[44:47], v[64:67]
    ds_read_b64_tr_b16 v[112:113], v60 offset:43616
    ds_read_b64_tr_b16 v[114:115], v60 offset:46176
    v_accvgpr_write_b32 a235, v55
    v_mfma_f32_16x16x32_bf16 v[68:71], v[132:135], a[44:47], v[68:71]
    ds_read_b64_tr_b16 v[116:117], v60 offset:43648
    ds_read_b64_tr_b16 v[118:119], v60 offset:46208
    v_cvt_pk_bf16_f32 v16, v200, v201
    v_mfma_f32_16x16x32_bf16 v[68:71], v[136:139], a[40:43], v[68:71]
    ds_read_b64_tr_b16 v[120:121], v60 offset:35968
    ds_read_b64_tr_b16 v[122:123], v60 offset:48768
    v_cvt_pk_bf16_f32 v17, v202, v203
    v_mfma_f32_16x16x32_bf16 v[68:71], v[140:143], a[36:39], v[68:71]
    ds_read_b64_tr_b16 v[124:125], v60 offset:51328
    ds_read_b64_tr_b16 v[126:127], v60 offset:53888
    v_cvt_pk_bf16_f32 v18, v216, v217
    v_mfma_f32_16x16x32_bf16 v[68:71], v[144:147], a[32:35], v[68:71]
    s_waitcnt vmcnt(16)
    s_barrier
    v_mfma_f32_16x16x32_bf16 v[72:75], v[84:87], a[32:35], v[72:75]
    s_waitcnt lgkmcnt(8)
    s_nop 0
    ds_read_b64_tr_b16 v[128:129], v60 offset:56448
    ds_read_b64_tr_b16 v[130:131], v60 offset:59008
    v_cvt_pk_bf16_f32 v19, v218, v219
    v_mfma_f32_16x16x32_bf16 v[72:75], v[88:91], a[36:39], v[72:75]
    ds_read_b64_tr_b16 v[132:133], v61 offset:2560
    ds_read_b64_tr_b16 v[134:135], v61 offset:5120
    v_cvt_pk_bf16_f32 v40, v204, v205
    v_mfma_f32_16x16x32_bf16 v[72:75], v[92:95], a[40:43], v[72:75]
    ds_read_b64_tr_b16 v[136:137], v61 offset:7680
    ds_read_b64_tr_b16 v[138:139], v61 offset:10240
    v_cvt_pk_bf16_f32 v41, v206, v207
    v_mfma_f32_16x16x32_bf16 v[72:75], v[96:99], a[44:47], v[72:75]
    ds_read_b64_tr_b16 v[140:141], v61 offset:0
    ds_read_b64_tr_b16 v[142:143], v61 offset:12800
    v_cvt_pk_bf16_f32 v42, v220, v221
    v_mfma_f32_16x16x32_bf16 v[76:79], v[100:103], a[44:47], v[76:79]
    ds_read_b64_tr_b16 v[144:145], v61 offset:15360
    ds_read_b64_tr_b16 v[146:147], v61 offset:17920
    v_cvt_pk_bf16_f32 v43, v222, v223
    v_mfma_f32_16x16x32_bf16 v[76:79], v[104:107], a[40:43], v[76:79]
    ds_read_b64_tr_b16 v[84:85], v61 offset:15392
    ds_read_b64_tr_b16 v[86:87], v61 offset:17952
    v_cvt_pk_bf16_f32 v48, v224, v225
    v_mfma_f32_16x16x32_bf16 v[76:79], v[108:111], a[36:39], v[76:79]
    s_nop 0
    s_waitcnt lgkmcnt(10)
    ds_read_b64_tr_b16 v[88:89], v61 offset:32
    ds_read_b64_tr_b16 v[90:91], v61 offset:12832
    v_cvt_pk_bf16_f32 v49, v226, v227
    v_mfma_f32_16x16x32_bf16 v[76:79], v[112:115], a[32:35], v[76:79]
    ds_read_b64_tr_b16 v[92:93], v61 offset:7712
    ds_read_b64_tr_b16 v[94:95], v61 offset:10272
    v_cvt_pk_bf16_f32 v50, v240, v241
    v_mfma_f32_16x16x32_bf16 v[80:83], v[116:119], a[32:35], v[80:83]
    ds_read_b64_tr_b16 v[96:97], v61 offset:2592
    ds_read_b64_tr_b16 v[98:99], v61 offset:5152
    v_cvt_pk_bf16_f32 v51, v242, v243
    v_mfma_f32_16x16x32_bf16 v[80:83], v[120:123], a[36:39], v[80:83]
    ds_read_b64_tr_b16 v[100:101], v61 offset:2624
    ds_read_b64_tr_b16 v[102:103], v61 offset:5184
    v_accvgpr_write_b32 a212, v48
    v_mfma_f32_16x16x32_bf16 v[80:83], v[124:127], a[40:43], v[80:83]
    ds_read_b64_tr_b16 v[104:105], v61 offset:7744
    ds_read_b64_tr_b16 v[106:107], v61 offset:10304
    v_accvgpr_write_b32 a213, v49
    v_mfma_f32_16x16x32_bf16 v[80:83], v[128:131], a[44:47], v[80:83]
    s_waitcnt lgkmcnt(10)
    ds_read_b64_tr_b16 v[108:109], v61 offset:64
    ds_read_b64_tr_b16 v[110:111], v61 offset:12864
    s_nop 0
    v_accvgpr_write_b32 a214, v50
    v_mfma_f32_16x16x32_bf16 v[64:67], v[132:135], a[48:51], v[64:67]
    ds_read_b64_tr_b16 v[112:113], v61 offset:15424
    ds_read_b64_tr_b16 v[114:115], v61 offset:17984
    v_accvgpr_write_b32 a215, v51
    v_mfma_f32_16x16x32_bf16 v[64:67], v[136:139], a[52:55], v[64:67]
    ds_read_b64_tr_b16 v[116:117], v61 offset:15456
    ds_read_b64_tr_b16 v[118:119], v61 offset:18016
    v_cvt_pk_bf16_f32 v52, v228, v229
    v_mfma_f32_16x16x32_bf16 v[64:67], v[140:143], a[56:59], v[64:67]
    s_barrier
    v_mfma_f32_16x16x32_bf16 v[64:67], v[144:147], a[60:63], v[64:67]
    s_nop 0
    s_mov_b32 s66, 24576
    s_mov_b32 s67, 12288
    s_mov_b32 s68, 36864
    s_mov_b32 s69, 24576
    s_add_u32 s61, s34, 98304
    ds_read_b64_tr_b16 v[120:121], v61 offset:96
    ds_read_b64_tr_b16 v[122:123], v61 offset:12896
    v_mfma_f32_16x16x32_bf16 v[68:71], v[84:87], a[60:63], v[68:71]
    s_waitcnt lgkmcnt(8)
    s_add_u32 m0, s61, 0
    ds_read_b64_tr_b16 v[124:125], v61 offset:7776
    ds_read_b64_tr_b16 v[126:127], v61 offset:10336
    buffer_load_dwordx4 v4, s[36:39], s66 offen nt lds
    v_mfma_f32_16x16x32_bf16 v[68:71], v[88:91], a[56:59], v[68:71]
    ds_read_b64_tr_b16 v[128:129], v61 offset:2656
    ds_read_b64_tr_b16 v[130:131], v61 offset:5216
    v_cvt_pk_bf16_f32 v53, v230, v231
    v_mfma_f32_16x16x32_bf16 v[68:71], v[92:95], a[52:55], v[68:71]
    ds_read_b64_tr_b16 v[132:133], v61 offset:2688
    ds_read_b64_tr_b16 v[134:135], v61 offset:5248
    v_cvt_pk_bf16_f32 v54, v244, v245
    v_mfma_f32_16x16x32_bf16 v[68:71], v[96:99], a[48:51], v[68:71]
    ds_read_b64_tr_b16 v[136:137], v61 offset:7808
    ds_read_b64_tr_b16 v[138:139], v61 offset:10368
    v_cvt_pk_bf16_f32 v55, v246, v247
    v_mfma_f32_16x16x32_bf16 v[72:75], v[100:103], a[48:51], v[72:75]
    s_nop 0
    ds_read_b64_tr_b16 v[140:141], v61 offset:128
    ds_read_b64_tr_b16 v[142:143], v61 offset:12928
    v_mfma_f32_16x16x32_bf16 v[72:75], v[104:107], a[52:55], v[72:75]
    s_waitcnt lgkmcnt(10)
    s_add_u32 m0, s61, 3968
    ds_read_b64_tr_b16 v[144:145], v61 offset:15488
    ds_read_b64_tr_b16 v[146:147], v61 offset:18048
    buffer_load_dwordx4 v4, s[36:39], s66 offen offset:128 nt lds
    v_mfma_f32_16x16x32_bf16 v[72:75], v[108:111], a[56:59], v[72:75]
    ds_read_b64_tr_b16 v[84:85], v61 offset:20480
    ds_read_b64_tr_b16 v[86:87], v61 offset:23040
    v_accvgpr_write_b32 a236, v52
    v_mfma_f32_16x16x32_bf16 v[72:75], v[112:115], a[60:63], v[72:75]
    ds_read_b64_tr_b16 v[88:89], v61 offset:28160
    ds_read_b64_tr_b16 v[90:91], v61 offset:30720
    v_accvgpr_write_b32 a237, v53
    v_mfma_f32_16x16x32_bf16 v[76:79], v[116:119], a[60:63], v[76:79]
    ds_read_b64_tr_b16 v[92:93], v61 offset:33280
    ds_read_b64_tr_b16 v[94:95], v61 offset:35840
    v_accvgpr_write_b32 a238, v54
    v_mfma_f32_16x16x32_bf16 v[76:79], v[120:123], a[56:59], v[76:79]
    s_waitcnt lgkmcnt(10)
    ds_read_b64_tr_b16 v[96:97], v61 offset:25600
    s_nop 0
    ds_read_b64_tr_b16 v[98:99], v61 offset:38400
    v_accvgpr_write_b32 a239, v55
    v_mfma_f32_16x16x32_bf16 v[76:79], v[124:127], a[52:55], v[76:79]
    ds_read_b64_tr_b16 v[100:101], v61 offset:25632
    ds_read_b64_tr_b16 v[102:103], v61 offset:38432
    v_mfma_f32_16x16x32_bf16 v[76:79], v[128:131], a[48:51], v[76:79]
    s_add_u32 m0, s61, 7936
    ds_read_b64_tr_b16 v[104:105], v61 offset:33312
    ds_read_b64_tr_b16 v[106:107], v61 offset:35872
    buffer_load_dwordx4 v4, s[36:39], s66 offen offset:256 nt lds
    v_mfma_f32_16x16x32_bf16 v[80:83], v[132:135], a[48:51], v[80:83]
    ds_read_b64_tr_b16 v[108:109], v61 offset:28192
    ds_read_b64_tr_b16 v[110:111], v61 offset:30752
    v_cvt_pk_bf16_f32 v20, v232, v233
    v_mfma_f32_16x16x32_bf16 v[80:83], v[136:139], a[52:55], v[80:83]
    s_waitcnt lgkmcnt(10)
    s_nop 0
    ds_read_b64_tr_b16 v[112:113], v61 offset:20512
    ds_read_b64_tr_b16 v[114:115], v61 offset:23072
    v_cvt_pk_bf16_f32 v21, v234, v235
    v_mfma_f32_16x16x32_bf16 v[80:83], v[140:143], a[56:59], v[80:83]
    ds_read_b64_tr_b16 v[116:117], v61 offset:20544
    ds_read_b64_tr_b16 v[118:119], v61 offset:23104
    v_cvt_pk_bf16_f32 v22, v248, v249
    v_mfma_f32_16x16x32_bf16 v[80:83], v[144:147], a[60:63], v[80:83]
    ds_read_b64_tr_b16 v[120:121], v61 offset:28224
    ds_read_b64_tr_b16 v[122:123], v61 offset:30784
    v_cvt_pk_bf16_f32 v23, v250, v251
    v_mfma_f32_16x16x32_bf16 v[64:67], v[84:87], a[64:67], v[64:67]
    ds_read_b64_tr_b16 v[124:125], v61 offset:33344
    ds_read_b64_tr_b16 v[126:127], v61 offset:35904
    v_mfma_f32_16x16x32_bf16 v[64:67], v[88:91], a[68:71], v[64:67]
    s_waitcnt vmcnt(18) lgkmcnt(10)
    s_add_u32 m0, s61, 12288
    ds_read_b64_tr_b16 v[128:129], v61 offset:25664
    ds_read_b64_tr_b16 v[130:131], v61 offset:38464
    buffer_load_dwordx4 v5, s[40:43], s67 offen nt lds
    v_mfma_f32_16x16x32_bf16 v[64:67], v[92:95], a[72:75], v[64:67]
    s_waitcnt vmcnt(18)
    ds_read_b64_tr_b16 v[132:133], v61 offset:25696
    ds_read_b64_tr_b16 v[134:135], v61 offset:38496
    v_cvt_pk_bf16_f32 v44, v236, v237
    v_mfma_f32_16x16x32_bf16 v[64:67], v[96:99], a[76:79], v[64:67]
    ds_read_b64_tr_b16 v[136:137], v61 offset:33376
    ds_read_b64_tr_b16 v[138:139], v61 offset:35936
    v_cvt_pk_bf16_f32 v45, v238, v239
    v_mfma_f32_16x16x32_bf16 v[68:71], v[100:103], a[76:79], v[68:71]
    ds_read_b64_tr_b16 v[140:141], v61 offset:28256
    ds_read_b64_tr_b16 v[142:143], v61 offset:30816
    v_cvt_pk_bf16_f32 v46, v252, v253
    v_mfma_f32_16x16x32_bf16 v[68:71], v[104:107], a[72:75], v[68:71]
    s_waitcnt lgkmcnt(10)
    ds_read_b64_tr_b16 v[144:145], v61 offset:20576
    ds_read_b64_tr_b16 v[146:147], v61 offset:23136
    s_nop 0
    v_mfma_f32_16x16x32_bf16 v[68:71], v[108:111], a[68:71], v[68:71]
    s_add_u32 m0, s61, 16256
    ds_read_b64_tr_b16 v[84:85], v61 offset:20608
    ds_read_b64_tr_b16 v[86:87], v61 offset:23168
    buffer_load_dwordx4 v5, s[40:43], s67 offen offset:128 nt lds
    v_mfma_f32_16x16x32_bf16 v[68:71], v[112:115], a[64:67], v[68:71]
    ds_read_b64_tr_b16 v[88:89], v61 offset:28288
    ds_read_b64_tr_b16 v[90:91], v61 offset:30848
    v_cvt_pk_bf16_f32 v47, v254, v255
    v_mfma_f32_16x16x32_bf16 v[72:75], v[116:119], a[64:67], v[72:75]
    ds_read_b64_tr_b16 v[92:93], v61 offset:33408
    ds_read_b64_tr_b16 v[94:95], v61 offset:35968
    v_mfma_f32_16x16x32_bf16 v[72:75], v[120:123], a[68:71], v[72:75]
    s_waitcnt lgkmcnt(10)
    ds_read_b64_tr_b16 v[96:97], v61 offset:25728
    ds_read_b64_tr_b16 v[98:99], v61 offset:38528
    v_mfma_f32_16x16x32_bf16 v[72:75], v[124:127], a[72:75], v[72:75]
    s_nop 0
    v_mfma_f32_16x16x32_bf16 v[72:75], v[128:131], a[76:79], v[72:75]
    s_nop 0
    v_mfma_f32_16x16x32_bf16 v[76:79], v[132:135], a[76:79], v[76:79]
    s_add_u32 m0, s61, 20224
    s_nop 0
    buffer_load_dwordx4 v5, s[40:43], s67 offen offset:256 nt lds
    v_mfma_f32_16x16x32_bf16 v[76:79], v[136:139], a[72:75], v[76:79]
    s_waitcnt lgkmcnt(4)
    v_mfma_f32_16x16x32_bf16 v[76:79], v[140:143], a[68:71], v[76:79]
    s_nop 0
    v_mfma_f32_16x16x32_bf16 v[76:79], v[144:147], a[64:67], v[76:79]
    s_nop 0
    v_mfma_f32_16x16x32_bf16 v[80:83], v[84:87], a[64:67], v[80:83]
    s_nop 0
    v_mfma_f32_16x16x32_bf16 v[80:83], v[88:91], a[68:71], v[80:83]
    s_waitcnt lgkmcnt(0)
    v_mfma_f32_16x16x32_bf16 v[80:83], v[92:95], a[72:75], v[80:83]
    s_nop 0
    v_mfma_f32_16x16x32_bf16 v[80:83], v[96:99], a[76:79], v[80:83]
    s_add_u32 m0, s61, 24576
    s_nop 0
    buffer_load_dwordx4 v4, s[36:39], s68 offen nt lds
    s_waitcnt vmcnt(20)
    v_accvgpr_read_b32 v148, a80
    v_accvgpr_read_b32 v149, a81
    s_waitcnt vmcnt(19)
    v_accvgpr_read_b32 v150, a82
    v_accvgpr_read_b32 v151, a83
    s_waitcnt vmcnt(18)
    v_accvgpr_read_b32 v152, a84
    v_accvgpr_read_b32 v153, a85
    s_waitcnt vmcnt(17)
    v_accvgpr_read_b32 v154, a86
    v_accvgpr_read_b32 v155, a87
    s_waitcnt vmcnt(16)
    v_accvgpr_read_b32 v156, a88
    v_accvgpr_read_b32 v157, a89
    v_lshlrev_b32 v50, 16, v148
    v_and_b32 v51, s76, v148
    v_pk_add_f32 v[64:65], v[64:65], v[50:51]
    v_cvt_pk_bf16_f32 v148, v64, v65
    v_lshlrev_b32 v50, 16, v149
    s_add_u32 m0, s61, 28544
    s_nop 0
    buffer_load_dwordx4 v4, s[36:39], s68 offen offset:128 nt lds
    v_and_b32 v51, s76, v149
    v_pk_add_f32 v[66:67], v[66:67], v[50:51]
    v_cvt_pk_bf16_f32 v149, v66, v67
    v_lshlrev_b32 v50, 16, v150
    v_and_b32_e64 v51, s76, v150
    v_pk_add_f32 v[68:69], v[68:69], v[50:51]
    v_cvt_pk_bf16_f32 v150, v68, v69
    v_lshlrev_b32 v50, 16, v151
    v_and_b32 v51, s76, v151
    v_pk_add_f32 v[70:71], v[70:71], v[50:51]
    v_cvt_pk_bf16_f32 v151, v70, v71
    v_lshlrev_b32 v50, 16, v152
    v_and_b32 v51, s76, v152
    v_pk_add_f32 v[72:73], v[72:73], v[50:51]
    v_cvt_pk_bf16_f32 v152, v72, v73
    s_add_u32 m0, s61, 32512
    s_nop 0
    buffer_load_dwordx4 v4, s[36:39], s68 offen offset:256 nt lds
    v_lshlrev_b32 v50, 16, v153
    v_and_b32_e64 v51, s76, v153
    v_pk_add_f32 v[74:75], v[74:75], v[50:51]
    v_cvt_pk_bf16_f32 v153, v74, v75
    v_lshlrev_b32 v50, 16, v154
    v_and_b32 v51, s76, v154
    v_pk_add_f32 v[76:77], v[76:77], v[50:51]
    v_cvt_pk_bf16_f32 v154, v76, v77
    v_lshlrev_b32 v50, 16, v155
    v_and_b32 v51, s76, v155
    v_pk_add_f32 v[78:79], v[78:79], v[50:51]
    v_cvt_pk_bf16_f32 v155, v78, v79
    v_lshlrev_b32 v50, 16, v156
    v_and_b32_e64 v51, s76, v156
    v_pk_add_f32 v[80:81], v[80:81], v[50:51]
    s_add_u32 m0, s61, 36864
    s_nop 0
    buffer_load_dwordx4 v5, s[40:43], s69 offen nt lds
    v_cvt_pk_bf16_f32 v156, v80, v81
    v_lshlrev_b32 v50, 16, v157
    v_and_b32 v51, s76, v157
    v_pk_add_f32 v[82:83], v[82:83], v[50:51]
    v_cvt_pk_bf16_f32 v157, v82, v83
    buffer_store_dwordx4 v[148:151], v1, s[48:51], s79 offen sc1
    buffer_store_dwordx4 v[152:155], v1, s[48:51], s79 offen offset:1024 sc1
    buffer_store_dwordx2 v[156:157], v1, s[48:51], s83 offen sc1
    v_mov_b32_e64 v50, 0
    v_mov_b32_e64 v51, 0
    v_dot2c_f32_bf16 v50, s73, v148
    v_dot2c_f32_bf16 v51, v148, v148
    v_dot2c_f32_bf16 v50, s73, v149
    v_dot2c_f32_bf16 v51, v149, v149
    v_dot2c_f32_bf16 v50, s73, v150
    s_add_u32 m0, s61, 40832
    s_nop 0
    buffer_load_dwordx4 v5, s[40:43], s69 offen offset:128 nt lds
    v_dot2c_f32_bf16 v51, v150, v150
    v_dot2c_f32_bf16 v50, s73, v151
    v_dot2c_f32_bf16 v51, v151, v151
    v_dot2c_f32_bf16 v50, s73, v152
    v_dot2c_f32_bf16 v51, v152, v152
    v_dot2c_f32_bf16 v50, s73, v153
    v_dot2c_f32_bf16 v51, v153, v153
    v_dot2c_f32_bf16 v50, s73, v154
    v_dot2c_f32_bf16 v51, v154, v154
    v_dot2c_f32_bf16 v50, s73, v155
    v_dot2c_f32_bf16 v51, v155, v155
    v_dot2c_f32_bf16 v50, s73, v156
    v_dot2c_f32_bf16 v51, v156, v156
    v_dot2c_f32_bf16 v50, s73, v157
    v_dot2c_f32_bf16 v51, v157, v157
    s_add_u32 m0, s61, 44800
    s_nop 0
    buffer_load_dwordx4 v5, s[40:43], s69 offen offset:256 nt lds
    s_nop 2
    v_mov_b32 v52, v50
    s_nop 1
    v_permlane32_swap_b32 v50, v52
    s_nop 1
    v_add_f32 v50, v50, v52
    v_mov_b32 v52, v50
    s_nop 1
    v_permlane16_swap_b32 v50, v52
    s_nop 1
    v_add_f32 v50, v50, v52
    v_mov_b32 v52, v51
    s_nop 1
    v_permlane32_swap_b32 v51, v52
    s_nop 1
    v_add_f32_e64 v51, v51, v52
    v_mov_b32_e64 v52, v51
    s_nop 1
    v_permlane16_swap_b32 v51, v52
    s_nop 1
    v_add_f32 v51, v51, v52
    v_lshlrev_b32_e64 v52, 2, v1
    s_mov_b64 exec, 0xffff
    buffer_store_dwordx2 v[50:51], v52, s[48:51], s82 offen sc1
    s_mov_b64 exec, -1
    s_waitcnt vmcnt(16)
    s_barrier
    ds_read_b128 v[144:147], v6 offset:0
    ds_read_b128 v[148:151], v7 offset:0
    ds_read_b128 v[152:155], v6 offset:4096
    ds_read_b128 v[156:159], v7 offset:4096
    ds_read_b128 v[160:163], v6 offset:8192
    ds_read_b128 v[164:167], v7 offset:8192
    ds_read_b128 v[168:171], v6 offset:2048
    ds_read_b128 v[172:175], v7 offset:2048
    ds_read_b128 v[176:179], v6 offset:6144
    ds_read_b128 v[180:183], v7 offset:6144
    ds_read_b128 v[184:187], v6 offset:10240
    ds_read_b128 v[188:191], v7 offset:10240
    v_mov_b32_e64 v224, 0
    v_mov_b32_e64 v225, 0
    v_mov_b32_e64 v226, 0
    v_mov_b32 v227, 0
    s_mov_b32 s63, 0x2e000000
    s_mov_b32 s64, 0
    s_waitcnt lgkmcnt(11)
    v_mfma_f32_16x16x32_bf16 v[64:67], v[144:147], a[192:195], 0
    s_waitcnt lgkmcnt(10)
    v_mfma_f32_16x16x32_bf16 v[64:67], v[148:151], a[196:199], v[64:67]
    s_waitcnt lgkmcnt(9)
    s_mov_b32 s66, 49152
    s_mov_b32 s67, 36864
    s_mov_b32 s68, 61440
    s_mov_b32 s69, 49152
    s_add_u32 s61, s34, 0
    s_add_u32 m0, s61, 0
    s_nop 0
    buffer_load_dwordx4 v4, s[36:39], s66 offen nt lds
    v_mfma_f32_16x16x32_bf16 v[64:67], v[152:155], a[200:203], v[64:67]
    s_waitcnt lgkmcnt(8)
    ds_read_b64_tr_b16 v[112:113], v8 offset:36864
    ds_read_b64_tr_b16 v[114:115], v8 offset:38912
    v_mfma_f32_16x16x32_bf16 v[64:67], v[156:159], a[204:207], v[64:67]
    s_waitcnt lgkmcnt(9)
    ds_read_b64_tr_b16 v[116:117], v9 offset:36864
    ds_read_b64_tr_b16 v[118:119], v9 offset:38912
    v_mfma_f32_16x16x32_bf16 v[64:67], v[160:163], a[208:211], v[64:67]
    s_waitcnt lgkmcnt(10)
    ds_read_b64_tr_b16 v[120:121], v10 offset:36864
    ds_read_b64_tr_b16 v[122:123], v10 offset:38912
    v_mfma_f32_16x16x32_bf16 v[64:67], v[164:167], a[212:215], v[64:67]
    s_waitcnt lgkmcnt(6)
    ds_read_b64_tr_b16 v[124:125], v11 offset:36864
    ds_read_b64_tr_b16 v[126:127], v11 offset:38912
    v_mfma_f32_16x16x32_bf16 v[80:83], v[168:171], a[192:195], 0
    ds_read_b64_tr_b16 v[128:129], v8 offset:40960
    ds_read_b64_tr_b16 v[130:131], v8 offset:43008
    v_mfma_f32_16x16x32_bf16 v[80:83], v[172:175], a[196:199], v[80:83]
    ds_read_b64_tr_b16 v[132:133], v9 offset:40960
    ds_read_b64_tr_b16 v[134:135], v9 offset:43008
    v_mfma_f32_16x16x32_bf16 v[80:83], v[176:179], a[200:203], v[80:83]
    ds_read_b64_tr_b16 v[136:137], v10 offset:40960
    ds_read_b64_tr_b16 v[138:139], v10 offset:43008
    v_mfma_f32_16x16x32_bf16 v[80:83], v[180:183], a[204:207], v[80:83]
    s_add_u32 m0, s61, 3968
    s_nop 0
    buffer_load_dwordx4 v4, s[36:39], s66 offen offset:128 nt lds
    v_mfma_f32_16x16x32_bf16 v[80:83], v[184:187], a[208:211], v[80:83]
    s_nop 0
    ds_read_b64_tr_b16 v[140:141], v11 offset:40960
    ds_read_b64_tr_b16 v[142:143], v11 offset:43008
    v_mfma_f32_16x16x32_bf16 v[80:83], v[188:191], a[212:215], v[80:83]
    ds_read_b64_tr_b16 v[192:193], v8 offset:45056
    ds_read_b64_tr_b16 v[194:195], v8 offset:47104
    v_mfma_f32_16x16x32_bf16 v[68:71], v[144:147], a[216:219], 0
    ds_read_b64_tr_b16 v[196:197], v9 offset:45056
    ds_read_b64_tr_b16 v[198:199], v9 offset:47104
    v_mfma_f32_16x16x32_bf16 v[68:71], v[148:151], a[220:223], v[68:71]
    ds_read_b64_tr_b16 v[200:201], v10 offset:45056
    ds_read_b64_tr_b16 v[202:203], v10 offset:47104
    v_mfma_f32_16x16x32_bf16 v[68:71], v[152:155], a[224:227], v[68:71]
    s_nop 0
    ds_read_b64_tr_b16 v[204:205], v11 offset:45056
    ds_read_b64_tr_b16 v[206:207], v11 offset:47104
    v_mfma_f32_16x16x32_bf16 v[68:71], v[156:159], a[228:231], v[68:71]
    s_waitcnt lgkmcnt(10)
    v_max3_f32 v112, |v112|, |v113|, |v114|
    v_max_f32 v112, v112, |v115|
    v_mfma_f32_16x16x32_bf16 v[68:71], v[160:163], a[232:235], v[68:71]
    v_mfma_f32_16x16x32_bf16 v[68:71], v[164:167], a[236:239], v[68:71]
    s_add_u32 m0, s61, 7936
    s_nop 0
    buffer_load_dwordx4 v4, s[36:39], s66 offen offset:256 nt lds
    v_mfma_f32_16x16x32_bf16 v[84:87], v[168:171], a[216:219], 0
    s_nop 0
    v_max3_f32 v48, v64, v65, v66
    v_max3_f32 v48, v48, v67, v80
    v_mfma_f32_16x16x32_bf16 v[84:87], v[172:175], a[220:223], v[84:87]
    v_max3_f32 v48, v48, v81, v82
    v_max_f32_e64 v48, v48, v83
    v_mfma_f32_16x16x32_bf16 v[84:87], v[176:179], a[224:227], v[84:87]
    v_max3_f32 v116, |v116|, |v117|, |v118|
    v_max_f32 v116, v116, |v119|
    v_mfma_f32_16x16x32_bf16 v[84:87], v[180:183], a[228:231], v[84:87]
    v_max_f32 v216, v112, v116
    v_min_f32 v217, v112, v116
    v_mfma_f32_16x16x32_bf16 v[84:87], v[184:187], a[232:235], v[84:87]
    v_max3_f32 v120, |v120|, |v121|, |v122|
    v_max_f32 v120, v120, |v123|
    v_mfma_f32_16x16x32_bf16 v[84:87], v[188:191], a[236:239], v[84:87]
    v_max3_f32 v124, |v124|, |v125|, |v126|
    v_max_f32 v124, v124, |v127|
    v_mfma_f32_16x16x32_bf16 v[72:75], v[144:147], a[240:243], 0
    s_nop 0
    v_mfma_f32_16x16x32_bf16 v[72:75], v[148:151], a[244:247], v[72:75]
    s_add_u32 m0, s61, 12288
    s_nop 0
    buffer_load_dwordx4 v5, s[40:43], s67 offen nt lds
    v_mfma_f32_16x16x32_bf16 v[72:75], v[152:155], a[248:251], v[72:75]
    v_max3_f32 v216, v216, v120, v124
    v_min3_f32 v217, v217, v120, v124
    v_mfma_f32_16x16x32_bf16 v[72:75], v[156:159], a[252:255], v[72:75]
    v_max3_f32 v128, |v128|, |v129|, |v130|
    v_max_f32 v128, v128, |v131|
    v_mfma_f32_16x16x32_bf16 v[72:75], v[160:163], v[16:19], v[72:75]
    v_max3_f32 v49, v68, v69, v70
    v_max3_f32 v49, v49, v71, v84
    v_mfma_f32_16x16x32_bf16 v[72:75], v[164:167], v[20:23], v[72:75]
    v_max3_f32 v49, v49, v85, v86
    v_max_f32_e64 v49, v49, v87
    v_mfma_f32_16x16x32_bf16 v[88:91], v[168:171], a[240:243], 0
    v_max3_f32 v132, |v132|, |v133|, |v134|
    v_max_f32 v132, v132, |v135|
    v_mfma_f32_16x16x32_bf16 v[88:91], v[172:175], a[244:247], v[88:91]
    v_max3_f32 v216, v216, v128, v132
    v_min3_f32 v217, v217, v128, v132
    v_mfma_f32_16x16x32_bf16 v[88:91], v[176:179], a[248:251], v[88:91]
    s_nop 0
    v_mfma_f32_16x16x32_bf16 v[88:91], v[180:183], a[252:255], v[88:91]
    s_add_u32 m0, s61, 16256
    s_nop 0
    buffer_load_dwordx4 v5, s[40:43], s67 offen offset:128 nt lds
    v_mfma_f32_16x16x32_bf16 v[88:91], v[184:187], v[16:19], v[88:91]
    v_max3_f32 v136, |v136|, |v137|, |v138|
    v_max_f32 v136, v136, |v139|
    v_mfma_f32_16x16x32_bf16 v[88:91], v[188:191], v[20:23], v[88:91]
    s_waitcnt lgkmcnt(0)
    v_max3_f32 v140, |v140|, |v141|, |v142|
    v_max_f32 v140, v140, |v143|
    v_mfma_f32_16x16x32_bf16 v[76:79], v[144:147], v[24:27], 0
    s_nop 0
    v_max3_f32 v216, v216, v136, v140
    v_min3_f32 v217, v217, v136, v140
    v_mfma_f32_16x16x32_bf16 v[76:79], v[148:151], v[28:31], v[76:79]
    v_max3_f32 v192, |v192|, |v193|, |v194|
    v_max_f32 v192, v192, |v195|
    v_mfma_f32_16x16x32_bf16 v[76:79], v[152:155], v[32:35], v[76:79]
    v_max3_f32 v196, |v196|, |v197|, |v198|
    v_max_f32 v196, v196, |v199|
    v_mfma_f32_16x16x32_bf16 v[76:79], v[156:159], v[36:39], v[76:79]
    v_max3_f32 v216, v216, v192, v196
    v_min3_f32 v217, v217, v192, v196
    v_mfma_f32_16x16x32_bf16 v[76:79], v[160:163], v[40:43], v[76:79]
    s_nop 0
    v_mfma_f32_16x16x32_bf16 v[76:79], v[164:167], v[44:47], v[76:79]
    s_add_u32 m0, s61, 20224
    s_nop 0
    buffer_load_dwordx4 v5, s[40:43], s67 offen offset:256 nt lds
    v_mfma_f32_16x16x32_bf16 v[92:95], v[168:171], v[24:27], 0
    ds_read_b128 v[144:147], v6 offset:24576
    v_max3_f32 v50, v72, v73, v74
    v_mfma_f32_16x16x32_bf16 v[92:95], v[172:175], v[28:31], v[92:95]
    s_nop 0
    ds_read_b128 v[148:151], v7 offset:24576
    v_max3_f32 v50, v50, v75, v88
    v_mfma_f32_16x16x32_bf16 v[92:95], v[176:179], v[32:35], v[92:95]
    s_nop 0
    ds_read_b128 v[152:155], v6 offset:28672
    v_max3_f32 v50, v50, v89, v90
    v_mfma_f32_16x16x32_bf16 v[92:95], v[180:183], v[36:39], v[92:95]
    ds_read_b128 v[156:159], v7 offset:28672
    v_max_f32_e64 v50, v50, v91
    v_mfma_f32_16x16x32_bf16 v[92:95], v[184:187], v[40:43], v[92:95]
    ds_read_b128 v[160:163], v6 offset:32768
    v_max3_f32 v200, |v200|, |v201|, |v202|
    v_mfma_f32_16x16x32_bf16 v[92:95], v[188:191], v[44:47], v[92:95]
    ds_read_b128 v[164:167], v7 offset:32768
    v_max_f32 v200, v200, |v203|
    v_max3_f32 v204, |v204|, |v205|, |v206|
    v_max_f32 v204, v204, |v207|
    v_max3_f32 v216, v216, v200, v204
    v_min3_f32 v217, v217, v200, v204
    s_nop 0
    v_readfirstlane_b32 s3, v216
    s_nop 3
    s_and_b32 s3, s3, 0x7f800000
    s_sub_u32 s35, s3, 58720256
    v_cmp_nle_f32 vcc, s35, v217
    s_sub_u32 s35, s3, 587202560
    s_cmp_lt_u32 s35, 838860800
    s_cselect_b32 s35, 1, 0
    s_sub_u32 s3, s3, 348127232
    s_mul_i32 s3, s3, s35
    s_cmp_eq_u64 vcc, 0
    s_cselect_b32 s3, s3, 0
    v_max3_f32 v51, v76, v77, v78
    v_max3_f32 v51, v51, v79, v92
    v_max3_f32 v51, v51, v93, v94
    v_max_f32 v51, v51, v95
    v_mov_b32 v14, s3
    v_mov_b32 v15, s3
    v_mov_b32 v56, s3
    v_mov_b32_e64 v57, s3
    v_accvgpr_write_b32 a160, v14
    v_accvgpr_write_b32 a161, v14
    v_accvgpr_write_b32 a162, v14
    v_accvgpr_write_b32 a163, v14
    v_mov_b32 v52, v48
    v_mov_b32 v53, v49
    v_mov_b32 v54, v50
    v_mov_b32 v55, v51
    v_permlane32_swap_b32 v48, v52
    v_permlane32_swap_b32 v49, v53
    v_permlane32_swap_b32 v50, v54
    v_permlane32_swap_b32 v51, v55
    v_max_f32 v48, v48, v52
    v_max_f32 v49, v49, v53
    v_max_f32 v50, v50, v54
    v_max_f32 v51, v51, v55
    v_mov_b32 v52, v48
    v_mov_b32 v53, v49
    v_mov_b32 v54, v50
    v_mov_b32 v55, v51
    v_permlane16_swap_b32 v48, v52
    v_permlane16_swap_b32 v49, v53
    v_permlane16_swap_b32 v50, v54
    v_permlane16_swap_b32 v51, v55
    v_max_f32 v48, v48, v52
    v_max_f32 v49, v49, v53
    v_max_f32 v50, v50, v54
    v_max_f32 v51, v51, v55
    v_sub_f32 v96, 0xc23c0000, v48
    v_sub_f32 v97, 0xc23c0000, v48
    v_sub_f32 v98, 0xc23c0000, v48
    v_sub_f32 v99, 0xc23c0000, v48
    v_pk_add_f32 v[64:65], v[64:65], v[96:97]
    v_pk_add_f32 v[66:67], v[66:67], v[96:97]
    v_pk_add_f32 v[80:81], v[80:81], v[96:97]
    v_pk_add_f32 v[82:83], v[82:83], v[96:97]
    v_sub_f32 v100, 0xc23c0000, v49
    v_sub_f32 v101, 0xc23c0000, v49
    v_sub_f32 v102, 0xc23c0000, v49
    v_sub_f32 v103, 0xc23c0000, v49
    v_pk_add_f32 v[68:69], v[68:69], v[100:101]
    v_pk_add_f32 v[70:71], v[70:71], v[100:101]
    v_pk_add_f32 v[84:85], v[84:85], v[100:101]
    v_pk_add_f32 v[86:87], v[86:87], v[100:101]
    v_sub_f32 v104, 0xc23c0000, v50
    v_sub_f32 v105, 0xc23c0000, v50
    v_sub_f32 v106, 0xc23c0000, v50
    v_sub_f32 v107, 0xc23c0000, v50
    v_pk_add_f32 v[72:73], v[72:73], v[104:105]
    v_pk_add_f32 v[74:75], v[74:75], v[104:105]
    v_pk_add_f32 v[88:89], v[88:89], v[104:105]
    v_pk_add_f32 v[90:91], v[90:91], v[104:105]
    v_sub_f32 v108, 0xc23c0000, v51
    v_sub_f32 v109, 0xc23c0000, v51
    v_sub_f32 v110, 0xc23c0000, v51
    v_sub_f32 v111, 0xc23c0000, v51
    v_pk_add_f32 v[76:77], v[76:77], v[108:109]
    v_pk_add_f32 v[78:79], v[78:79], v[108:109]
    v_pk_add_f32 v[92:93], v[92:93], v[108:109]
    v_pk_add_f32 v[94:95], v[94:95], v[108:109]
    v_exp_f32 v216, v64
    v_exp_f32 v217, v65
    v_exp_f32 v218, v66
    v_exp_f32 v219, v67
    v_exp_f32 v220, v80
    v_exp_f32 v221, v81
    v_exp_f32 v222, v82
    v_exp_f32 v223, v83
    v_add_f32 v228, v216, v217
    v_add_f32 v228, v228, v218
    v_add_f32 v228, v228, v219
    v_add_f32 v228, v228, v220
    v_add_f32 v228, v228, v221
    v_add_f32 v228, v228, v222
    v_add_f32_e64 v228, v228, v223
    v_cvt_pk_bf16_f32 v112, v216, v217
    v_cvt_pk_bf16_f32 v113, v218, v219
    v_cvt_pk_bf16_f32 v114, v220, v221
    v_cvt_pk_bf16_f32 v115, v222, v223
    v_exp_f32 v216, v68
    v_exp_f32 v217, v69
    v_exp_f32 v218, v70
    v_exp_f32 v219, v71
    v_exp_f32 v220, v84
    v_exp_f32 v221, v85
    v_exp_f32 v222, v86
    v_exp_f32 v223, v87
    v_add_f32 v229, v216, v217
    v_add_f32 v229, v229, v218
    v_add_f32 v229, v229, v219
    v_add_f32 v229, v229, v220
    v_add_f32 v229, v229, v221
    v_add_f32 v229, v229, v222
    v_add_f32_e64 v229, v229, v223
    v_cvt_pk_bf16_f32 v116, v216, v217
    v_cvt_pk_bf16_f32 v117, v218, v219
    v_cvt_pk_bf16_f32 v118, v220, v221
    v_cvt_pk_bf16_f32 v119, v222, v223
    v_exp_f32 v216, v72
    v_exp_f32 v217, v73
    v_exp_f32 v218, v74
    v_exp_f32 v219, v75
    v_exp_f32 v220, v88
    v_exp_f32 v221, v89
    v_exp_f32 v222, v90
    v_exp_f32 v223, v91
    v_add_f32 v230, v216, v217
    v_add_f32 v230, v230, v218
    v_add_f32 v230, v230, v219
    v_add_f32 v230, v230, v220
    v_add_f32 v230, v230, v221
    v_add_f32 v230, v230, v222
    v_add_f32_e64 v230, v230, v223
    v_cvt_pk_bf16_f32 v120, v216, v217
    v_cvt_pk_bf16_f32 v121, v218, v219
    v_cvt_pk_bf16_f32 v122, v220, v221
    v_cvt_pk_bf16_f32 v123, v222, v223
    v_exp_f32 v216, v76
    v_exp_f32 v217, v77
    v_exp_f32 v218, v78
    v_exp_f32 v219, v79
    v_exp_f32 v220, v92
    v_exp_f32 v221, v93
    v_exp_f32 v222, v94
    v_exp_f32 v223, v95
    v_add_f32 v231, v216, v217
    v_add_f32 v231, v231, v218
    v_add_f32 v231, v231, v219
    v_add_f32 v231, v231, v220
    v_add_f32 v231, v231, v221
    v_add_f32 v231, v231, v222
    v_add_f32_e64 v231, v231, v223
    v_cvt_pk_bf16_f32 v124, v216, v217
    v_cvt_pk_bf16_f32 v125, v218, v219
    v_cvt_pk_bf16_f32 v126, v220, v221
    v_cvt_pk_bf16_f32 v127, v222, v223
    s_mov_b32 s60, 0
    s_waitcnt lgkmcnt(0)
    v_mfma_f32_16x16x32_bf16 v[64:67], v[144:147], a[192:195], v[96:99]
    ds_read_b128 v[168:171], v6 offset:26624
    v_add_f32 v224, v224, v228
    v_mfma_f32_16x16x32_bf16 v[64:67], v[148:151], a[196:199], v[64:67]
    ds_read_b128 v[172:175], v7 offset:26624
    v_add_f32 v225, v225, v229
    v_mfma_f32_16x16x32_bf16 v[64:67], v[152:155], a[200:203], v[64:67]
    ds_read_b128 v[176:179], v6 offset:30720
    v_add_f32 v226, v226, v230
    v_mfma_f32_16x16x32_bf16 v[64:67], v[156:159], a[204:207], v[64:67]
    s_waitcnt lgkmcnt(3)
    ds_read_b128 v[180:183], v7 offset:30720
    v_add_f32_e64 v227, v227, v231
    v_mfma_f32_16x16x32_bf16 v[64:67], v[160:163], a[208:211], v[64:67]
    ds_read_b128 v[184:187], v6 offset:34816
    v_mfma_f32_16x16x32_bf16 v[64:67], v[164:167], a[212:215], v[64:67]
    ds_read_b128 v[188:191], v7 offset:34816
    v_mfma_f32_16x16x32_bf16 v[68:71], v[164:167], a[236:239], v[100:103]
    v_add_u32 v6, s70, v6
    v_add_u32 v7, s70, v7
    v_mfma_f32_16x16x32_bf16 v[68:71], v[160:163], a[232:235], v[68:71]
    s_add_u32 m0, s61, 24576
    ds_read_b64_tr_b16 v[192:193], v8 offset:36864
    ds_read_b64_tr_b16 v[194:195], v8 offset:38912
    v_mfma_f32_16x16x32_bf16 v[68:71], v[156:159], a[228:231], v[68:71]
    buffer_load_dwordx4 v4, s[36:39], s68 offen nt lds
    v_mfma_f32_16x16x32_bf16 v[68:71], v[152:155], a[224:227], v[68:71]
    v_mfma_f32_16x16x32_bf16 v[68:71], v[148:151], a[220:223], v[68:71]
    v_exp_f32 v216, v64
    v_mfma_f32_16x16x32_bf16 v[68:71], v[144:147], a[216:219], v[68:71]
    v_mfma_f32_16x16x32_bf16 v[72:75], v[144:147], a[240:243], v[104:107]
    v_exp_f32 v217, v65
    v_mfma_f32_16x16x32_bf16 v[72:75], v[148:151], a[244:247], v[72:75]
    s_add_u32 m0, s61, 28544
    ds_read_b64_tr_b16 v[196:197], v9 offset:36864
    ds_read_b64_tr_b16 v[198:199], v9 offset:38912
    v_mfma_f32_16x16x32_bf16 v[72:75], v[152:155], a[248:251], v[72:75]
    buffer_load_dwordx4 v4, s[36:39], s68 offen offset:128 nt lds
    v_mfma_f32_16x16x32_bf16 v[72:75], v[156:159], a[252:255], v[72:75]
    v_exp_f32 v218, v66
    v_mfma_f32_16x16x32_bf16 v[72:75], v[160:163], v[16:19], v[72:75]
    v_add_f32 v228, v216, v217
    v_cvt_pk_bf16_f32 v128, v216, v217
    v_mfma_f32_16x16x32_bf16 v[72:75], v[164:167], v[20:23], v[72:75]
    v_exp_f32 v219, v67
    v_mfma_f32_16x16x32_bf16 v[76:79], v[164:167], v[44:47], v[108:111]
    v_add_f32 v228, v228, v218
    v_add_f32_e64 v228, v228, v219
    v_mfma_f32_16x16x32_bf16 v[76:79], v[160:163], v[40:43], v[76:79]
    s_add_u32 m0, s61, 32512
    ds_read_b64_tr_b16 v[200:201], v10 offset:36864
    ds_read_b64_tr_b16 v[202:203], v10 offset:38912
    v_mfma_f32_16x16x32_bf16 v[76:79], v[156:159], v[36:39], v[76:79]
    buffer_load_dwordx4 v4, s[36:39], s68 offen offset:256 nt lds
    v_mfma_f32_16x16x32_bf16 v[76:79], v[152:155], v[32:35], v[76:79]
    v_exp_f32 v220, v68
    v_mfma_f32_16x16x32_bf16 v[76:79], v[148:151], v[28:31], v[76:79]
    v_exp_f32_e64 v221, v69
    v_mfma_f32_16x16x32_bf16 v[76:79], v[144:147], v[24:27], v[76:79]
    s_waitcnt lgkmcnt(2)
    v_cvt_pk_bf16_f32 v129, v218, v219
    v_add_f32 v229, v220, v221
    v_mfma_f32_16x16x32_bf16 v[80:83], v[168:171], a[192:195], v[96:99]
    v_exp_f32 v222, v70
    v_mfma_f32_16x16x32_bf16 v[80:83], v[172:175], a[196:199], v[80:83]
    s_add_u32 m0, s61, 36864
    ds_read_b64_tr_b16 v[204:205], v11 offset:36864
    ds_read_b64_tr_b16 v[206:207], v11 offset:38912
    v_mfma_f32_16x16x32_bf16 v[80:83], v[176:179], a[200:203], v[80:83]
    buffer_load_dwordx4 v5, s[40:43], s69 offen nt lds
    v_mfma_f32_16x16x32_bf16 v[80:83], v[180:183], a[204:207], v[80:83]
    v_exp_f32_e64 v223, v71
    v_mfma_f32_16x16x32_bf16 v[80:83], v[184:187], a[208:211], v[80:83]
    v_cvt_pk_bf16_f32 v132, v220, v221
    v_add_f32 v229, v229, v222
    v_mfma_f32_16x16x32_bf16 v[80:83], v[188:191], a[212:215], v[80:83]
    v_exp_f32 v216, v72
    v_mfma_f32_16x16x32_bf16 v[84:87], v[188:191], a[236:239], v[100:103]
    v_add_f32_e64 v229, v229, v223
    v_cvt_pk_bf16_f32 v133, v222, v223
    v_mfma_f32_16x16x32_bf16 v[84:87], v[184:187], a[232:235], v[84:87]
    s_add_u32 m0, s61, 40832
    ds_read_b64_tr_b16 v[208:209], v8 offset:40960
    ds_read_b64_tr_b16 v[210:211], v8 offset:43008
    v_mfma_f32_16x16x32_bf16 v[84:87], v[180:183], a[228:231], v[84:87]
    buffer_load_dwordx4 v5, s[40:43], s69 offen offset:128 nt lds
    v_mfma_f32_16x16x32_bf16 v[84:87], v[176:179], a[224:227], v[84:87]
    v_exp_f32 v217, v73
    v_mfma_f32_16x16x32_bf16 v[84:87], v[172:175], a[220:223], v[84:87]
    v_exp_f32 v218, v74
    v_mfma_f32_16x16x32_bf16 v[84:87], v[168:171], a[216:219], v[84:87]
    v_add_f32 v230, v216, v217
    v_cvt_pk_bf16_f32 v136, v216, v217
    v_mfma_f32_16x16x32_bf16 v[88:91], v[168:171], a[240:243], v[104:107]
    v_exp_f32 v219, v75
    v_mfma_f32_16x16x32_bf16 v[88:91], v[172:175], a[244:247], v[88:91]
    s_add_u32 m0, s61, 44800
    ds_read_b64_tr_b16 v[212:213], v9 offset:40960
    ds_read_b64_tr_b16 v[214:215], v9 offset:43008
    v_mfma_f32_16x16x32_bf16 v[88:91], v[176:179], a[248:251], v[88:91]
    buffer_load_dwordx4 v5, s[40:43], s69 offen offset:256 nt lds
    v_mfma_f32_16x16x32_bf16 v[88:91], v[180:183], a[252:255], v[88:91]
    v_exp_f32 v220, v76
    v_mfma_f32_16x16x32_bf16 v[88:91], v[184:187], v[16:19], v[88:91]
    v_add_f32 v230, v230, v218
    v_add_f32 v230, v230, v219
    v_mfma_f32_16x16x32_bf16 v[88:91], v[188:191], v[20:23], v[88:91]
    v_exp_f32 v221, v77
    v_mfma_f32_16x16x32_bf16 v[92:95], v[188:191], v[44:47], v[108:111]
    s_add_u32 s66, s66, 24576
    v_cvt_pk_bf16_f32 v137, v218, v219
    v_add_f32_e64 v231, v220, v221
    v_mfma_f32_16x16x32_bf16 v[92:95], v[184:187], v[40:43], v[92:95]
    s_add_u32 s67, s67, 24576
    v_cvt_pk_bf16_f32 v140, v220, v221
    v_mfma_f32_16x16x32_bf16 v[92:95], v[180:183], v[36:39], v[92:95]
    s_add_u32 s68, s68, 24576
    v_exp_f32_e64 v222, v78
    v_mfma_f32_16x16x32_bf16 v[92:95], v[176:179], v[32:35], v[92:95]
    s_add_u32 s69, s69, 24576
    v_add_f32 v231, v231, v222
    v_mfma_f32_16x16x32_bf16 v[92:95], v[172:175], v[28:31], v[92:95]
    s_mov_b32 s16, s17
    v_exp_f32 v223, v79
    v_mfma_f32_16x16x32_bf16 v[92:95], v[168:171], v[24:27], v[92:95]
    s_add_u32 s17, s17, s18
    v_add_f32_e64 v231, v231, v223
    v_cvt_pk_bf16_f32 v141, v222, v223
    v_mfma_f32_16x16x32_bf16 a[0:3], v[112:115], v[192:195], a[160:163]
    s_add_u32 s11, s11, s10
    v_mfma_f32_16x16x32_bf16 a[16:19], v[112:115], v[196:199], a[160:163]
    s_add_u32 s61, s62, s34
    v_exp_f32_e64 v216, v80
    v_mfma_f32_16x16x32_bf16 a[20:23], v[116:119], v[196:199], a[160:163]
    s_add_u32 s62, s62, s70
    v_add_f32 v228, v228, v216
    v_mfma_f32_16x16x32_bf16 a[4:7], v[116:119], v[192:195], a[160:163]
    s_mov_b32 s3, s70
    v_exp_f32 v217, v81
    v_mfma_f32_16x16x32_bf16 a[8:11], v[120:123], v[192:195], a[160:163]
    s_mov_b32 s70, s71
    v_add_f32 v228, v228, v217
    v_cvt_pk_bf16_f32 v130, v216, v217
    v_mfma_f32_16x16x32_bf16 a[24:27], v[120:123], v[196:199], a[160:163]
    s_mov_b32 s71, s72
    v_mfma_f32_16x16x32_bf16 a[28:31], v[124:127], v[196:199], a[160:163]
    s_mov_b32 s72, s3
    v_exp_f32 v218, v82
    v_mfma_f32_16x16x32_bf16 a[12:15], v[124:127], v[192:195], a[160:163]
    s_waitcnt lgkmcnt(0)
    v_add_f32 v228, v228, v218
    v_mfma_f32_16x16x32_bf16 a[44:47], v[124:127], v[200:203], a[160:163]
    s_sub_u32 s60, s60, 1
    ds_read_b64_tr_b16 v[192:193], v10 offset:40960
    v_mfma_f32_16x16x32_bf16 a[60:63], v[124:127], v[204:207], a[160:163]
    s_cselect_b32 s19, -1.0, s63
    ds_read_b64_tr_b16 v[194:195], v10 offset:43008
    v_mfma_f32_16x16x32_bf16 a[56:59], v[120:123], v[204:207], a[160:163]
    s_nop 0
    ds_read_b64_tr_b16 v[196:197], v11 offset:40960
    v_mfma_f32_16x16x32_bf16 a[40:43], v[120:123], v[200:203], a[160:163]
    ds_read_b64_tr_b16 v[198:199], v11 offset:43008
    v_mfma_f32_16x16x32_bf16 a[36:39], v[116:119], v[200:203], a[160:163]
    v_exp_f32_e64 v219, v83
    v_mfma_f32_16x16x32_bf16 a[52:55], v[116:119], v[204:207], a[160:163]
    v_exp_f32 v220, v84
    v_mfma_f32_16x16x32_bf16 a[48:51], v[112:115], v[204:207], a[160:163]
    v_exp_f32 v221, v85
    v_mfma_f32_16x16x32_bf16 a[32:35], v[112:115], v[200:203], a[160:163]
    v_exp_f32 v222, v86
    v_mfma_f32_16x16x32_bf16 a[64:67], v[112:115], v[208:211], a[160:163]
    ds_read_b64_tr_b16 v[200:201], v8 offset:45056
    v_add_f32 v228, v228, v219
    v_mfma_f32_16x16x32_bf16 a[80:83], v[112:115], v[212:215], a[160:163]
    ds_read_b64_tr_b16 v[202:203], v8 offset:47104
    v_cvt_pk_bf16_f32 v131, v218, v219
    v_mfma_f32_16x16x32_bf16 a[84:87], v[116:119], v[212:215], a[160:163]
    ds_read_b64_tr_b16 v[204:205], v9 offset:45056
    v_add_f32 v229, v229, v220
    v_mfma_f32_16x16x32_bf16 a[68:71], v[116:119], v[208:211], a[160:163]
    ds_read_b64_tr_b16 v[206:207], v9 offset:47104
    v_add_f32 v229, v229, v221
    v_mfma_f32_16x16x32_bf16 a[72:75], v[120:123], v[208:211], a[160:163]
    v_exp_f32 v223, v87
    v_mfma_f32_16x16x32_bf16 a[88:91], v[120:123], v[212:215], a[160:163]
    v_exp_f32 v216, v88
    v_mfma_f32_16x16x32_bf16 a[92:95], v[124:127], v[212:215], a[160:163]
    v_cvt_pk_bf16_f32 v134, v220, v221
    v_add_f32 v229, v229, v222
    v_mfma_f32_16x16x32_bf16 a[76:79], v[124:127], v[208:211], a[160:163]
    s_waitcnt lgkmcnt(1)
    v_exp_f32_e64 v217, v89
    v_mfma_f32_16x16x32_bf16 a[108:111], v[124:127], v[192:195], a[160:163]
    ds_read_b64_tr_b16 v[208:209], v10 offset:45056
    v_add_f32_e64 v229, v229, v223
    v_mfma_f32_16x16x32_bf16 a[124:127], v[124:127], v[196:199], a[160:163]
    ds_read_b64_tr_b16 v[210:211], v10 offset:47104
    v_cvt_pk_bf16_f32 v135, v222, v223
    v_mfma_f32_16x16x32_bf16 a[120:123], v[120:123], v[196:199], a[160:163]
    ds_read_b64_tr_b16 v[212:213], v11 offset:45056
    v_add_f32_e64 v230, v230, v216
    v_mfma_f32_16x16x32_bf16 a[104:107], v[120:123], v[192:195], a[160:163]
    ds_read_b64_tr_b16 v[214:215], v11 offset:47104
    v_add_f32 v230, v230, v217
    v_mfma_f32_16x16x32_bf16 a[100:103], v[116:119], v[192:195], a[160:163]
    v_exp_f32 v218, v90
    v_mfma_f32_16x16x32_bf16 a[116:119], v[116:119], v[196:199], a[160:163]
    v_exp_f32 v219, v91
    v_mfma_f32_16x16x32_bf16 a[112:115], v[112:115], v[196:199], a[160:163]
    v_exp_f32 v220, v92
    v_mfma_f32_16x16x32_bf16 a[96:99], v[112:115], v[192:195], a[160:163]
    v_cvt_pk_bf16_f32 v138, v216, v217
    v_add_f32 v230, v230, v218
    v_mfma_f32_16x16x32_bf16 a[128:131], v[112:115], v[200:203], a[160:163]
    s_waitcnt lgkmcnt(0)
    v_add_f32_e64 v230, v230, v219
    v_cvt_pk_bf16_f32 v139, v218, v219
    v_mfma_f32_16x16x32_bf16 a[144:147], v[112:115], v[204:207], a[160:163]
    v_mfma_f32_16x16x32_bf16 a[148:151], v[116:119], v[204:207], a[160:163]
    s_waitcnt vmcnt(12) lgkmcnt(0)
    s_barrier
    v_mfma_f32_16x16x32_bf16 a[132:135], v[116:119], v[200:203], a[160:163]
    v_exp_f32 v221, v93
    v_mfma_f32_16x16x32_bf16 a[136:139], v[120:123], v[200:203], a[160:163]
    ds_read_b128 v[144:147], v6 offset:0
    v_add_f32 v231, v231, v220
    v_mfma_f32_16x16x32_bf16 a[152:155], v[120:123], v[204:207], a[160:163]
    ds_read_b128 v[148:151], v7 offset:0
    v_add_f32 v231, v231, v221
    v_mfma_f32_16x16x32_bf16 a[156:159], v[124:127], v[204:207], a[160:163]
    v_exp_f32 v222, v94
    v_mfma_f32_16x16x32_bf16 a[140:143], v[124:127], v[200:203], a[160:163]
    ds_read_b128 v[152:155], v6 offset:4096
    v_cvt_pk_bf16_f32 v142, v220, v221
    v_mfma_f32_16x16x32_bf16 a[172:175], v[124:127], v[208:211], a[160:163]
    ds_read_b128 v[156:159], v7 offset:4096
    v_add_f32 v231, v231, v222
    v_mfma_f32_16x16x32_bf16 a[188:191], v[124:127], v[212:215], a[160:163]
    v_exp_f32 v223, v95
    v_mfma_f32_16x16x32_bf16 a[184:187], v[120:123], v[212:215], a[160:163]
    ds_read_b128 v[160:163], v6 offset:8192
    v_add_f32_e64 v231, v231, v223
    v_mfma_f32_16x16x32_bf16 a[168:171], v[120:123], v[208:211], a[160:163]
    ds_read_b128 v[164:167], v7 offset:8192
    v_cvt_pk_bf16_f32 v143, v222, v223
    v_mfma_f32_16x16x32_bf16 a[164:167], v[116:119], v[208:211], a[160:163]
    v_max3_f32 v232, v228, v229, v230
    v_max_f32_e64 v232, v232, v231
    v_mfma_f32_16x16x32_bf16 a[180:183], v[116:119], v[212:215], a[160:163]
    v_cmp_nge_f32 vcc, s19, v232
    v_mfma_f32_16x16x32_bf16 a[176:179], v[112:115], v[212:215], a[160:163]
    s_waitcnt lgkmcnt(2)
    v_mfma_f32_16x16x32_bf16 a[160:163], v[112:115], v[208:211], a[160:163]
    s_branch L_hand
L_jobs:
    s_cmp_ge_u32 s64, 4
    s_cbranch_scc1 L_jhi
    s_cmp_eq_u32 s64, 1
    s_cbranch_scc1 L_job1
    s_cmp_eq_u32 s64, 2
    s_cbranch_scc1 L_job2
    s_cmp_eq_u32 s64, 3
    s_cbranch_scc1 L_job3
    s_cmp_lg_u32 s30, 0
    s_cbranch_scc1 L_sig8
    s_lshl_b32 s3, s31, 8
    s_add_u32 s3, s3, 79691776
    s_mov_b64 exec, 1
    v_mov_b32 v234, 0
    v_mov_b32 v235, 1
    buffer_atomic_add v235, v234, s[48:51], s3 offen
    s_mov_b64 exec, -1
L_sig8:
    s_mov_b32 s17, s9
    s_movk_i32 s18, 2560
    s_movk_i32 s10, 10240
    s_mov_b32 s64, 1
    s_mov_b32 s60, 12
    s_branch L_main_head
L_job1:
    s_lshl_b32 s77, s31, 8
    s_add_u32 s77, s77, 79691776
    v_mov_b32 v234, 0
    buffer_load_dword v235, v234, s[48:51], s77 offen sc1
    s_getpc_b64 s[100:101]
L_pc9:
    s_add_u32 s100, s100, L_job2-L_pc9
    s_addc_u32 s101, s101, 0
    s_lshr_b32 s3, s2, 3
    s_lshl_b32 s3, s3, 11
    v_and_b32 v236, 248, v0
    v_lshl_add_u32 v236, v236, 3, s3
    v_min_u32 v236, L_main_head-L_job2, v236
    global_load_dword v236, v236, s[100:101]
    s_mov_b32 s16, 234881024
    s_cmp_ge_u32 s2, 128
    s_cbranch_scc1 L_r4
    s_mov_b32 s52, s20
    s_and_b32 s53, s21, 0xffff
    s_mov_b32 s54, 1966080
    s_mov_b32 s55, 0x00020000
    s_mul_i32 s6, s2, 10923
    s_lshr_b32 s6, s6, 16
    s_mul_i32 s3, s6, 6
    s_sub_u32 s3, s2, s3
    s_lshr_b32 s8, s3, 1
    s_and_b32 s3, s3, 1
    s_mul_i32 s11, s6, 192
    s_mul_i32 s35, s3, 983040
    s_add_u32 s11, s11, s35
    s_mul_i32 s17, s6, 122880
    s_mul_i32 s35, s3, 61440
    s_add_u32 s17, s17, s35
    s_lshl_b32 s35, s8, 7
    s_add_u32 s17, s17, s35
    s_add_u32 s17, s17, 83886080
    s_lshl_b32 s8, s8, 8
    s_cmp_ge_u32 s2, 96
    s_cselect_b32 s46, 0, 134217728
    s_cselect_b32 s54, 0, s54
    s_movk_i32 s18, 12288
    s_mov_b32 s10, 196608
    v_add_u32 v12, s8, v0
    v_mul_u32_u24 v237, 5462, v12
    v_lshrrev_b32 v237, 16, v237
    v_mul_u32_u24 v238, 12, v237
    v_sub_u32 v238, v12, v238
    v_lshrrev_b32 v239, 1, v237
    v_and_b32 v239, 2, v239
    v_xor_b32 v238, v238, v239
    v_mul_u32_u24 v237, 3072, v237
    v_lshl_add_u32 v12, v238, 4, v237
    v_lshrrev_b32 v237, 3, v0
    v_lshlrev_b32 v237, 8, v237
    v_add_u32 v13, v237, v3
    s_mov_b32 s64, 2
    s_mov_b32 s60, 0
    s_branch L_main_head
L_r4:
    v_mul_u32_u24 v237, 6554, v0
    v_lshrrev_b32 v237, 16, v237
    v_mul_u32_u24 v238, 10, v237
    v_sub_u32 v238, v0, v238
    v_cmp_gt_u32 vcc, 24, v237
    v_mul_u32_u24 v237, 1280, v237
    v_lshl_add_u32 v237, v238, 4, v237
    v_mov_b32 v239, 0x80000000
    v_cndmask_b32 v12, v239, v237, vcc
    v_cndmask_b32 v13, v239, v3, vcc
    s_mov_b32 s52, s22
    s_and_b32 s53, s23, 0xffff
    s_mov_b32 s54, 1966080
    s_mov_b32 s55, 0x00020000
    s_bfe_u32 s3, s2, 0x30004
    s_mul_i32 s11, s3, 160
    s_and_b32 s3, s2, 15
    s_mul_i32 s3, s3, 122880
    s_add_u32 s11, s11, s3
    s_mul_i32 s17, s2, 15360
    s_add_u32 s17, s17, 83886080
    s_add_u32 s46, s17, 15360
    s_movk_i32 s18, 3840
    s_movk_i32 s10, 30720
    s_mov_b32 s64, 2
    s_mov_b32 s60, 0
    s_branch L_main_head
L_job2:
    v_cmp_gt_u32 vcc, 32, v235
    s_cbranch_vccnz L_slow7
L_ok7:
    s_lshr_b32 s3, s2, 4
    s_lshl_b32 s35, s31, 4
    s_add_u32 s3, s3, s35
    s_lshl_b32 s81, s3, 10
    s_add_u32 s81, s81, 78643200
    s_mul_i32 s78, s3, 20480
    s_and_b32 s3, s32, 1
    s_mul_i32 s3, s3, 10240
    s_add_u32 s78, s78, s3
    s_add_u32 s78, s78, s34
    s_add_u32 s78, s78, 6291456
    s_add_u32 s79, s78, 4096
    s_add_u32 s80, s78, 8192
    s_cmp_ge_u32 s30, 2
    s_cselect_b32 s80, 134217728, s80
    v_and_b32 v234, 0xf0, v1
    v_lshlrev_b32 v234, 2, v234
    v_lshrrev_b32 v235, 4, v1
    v_and_b32 v235, 0x30, v235
    v_add_u32_e64 v234, v234, v235
    buffer_load_dwordx4 v[248:251], v234, s[48:51], s81 offen sc1
    buffer_load_dwordx4 v[236:239], v1, s[48:51], s78 offen sc1
    buffer_load_dwordx4 v[240:243], v1, s[48:51], s79 offen sc1
    buffer_load_dwordx4 v[244:247], v1, s[48:51], s80 offen sc1
    s_mov_b32 s64, 3
    s_mov_b32 s60, 0
    s_branch L_main_head
L_job3:
    v_add_f32 v252, v248, v250
    v_add_f32_e64 v254, v249, v251
    v_add_u32 v235, 69206016, v1
    v_mov_b32 v234, v252
    s_nop 1
    v_permlane32_swap_b32 v252, v234
    s_nop 1
    v_add_f32 v252, v252, v234
    v_mov_b32 v234, v252
    s_nop 1
    v_permlane16_swap_b32 v252, v234
    s_nop 1
    v_add_f32 v252, v252, v234
    v_mov_b32 v234, v254
    s_nop 1
    v_permlane32_swap_b32 v254, v234
    s_nop 1
    v_add_f32 v254, v254, v234
    v_mov_b32 v234, v254
    s_nop 1
    v_permlane16_swap_b32 v254, v234
    s_nop 1
    v_add_f32 v254, v254, v234
    v_mul_f32 v252, 0x3acccccd, v252
    v_mul_f32 v254, 0x3acccccd, v254
    v_fma_f32 v254, -v252, v252, v254
    v_max_f32 v254, 0, v254
    v_add_f32 v254, 0x3727c5ac, v254
    v_rsq_f32 v254, v254
    s_nop 0
    v_mov_b32 v255, v254
    v_mul_f32 v252, -v252, v254
    v_mov_b32 v253, v252
    v_lshlrev_b32 v248, 16, v236
    v_and_b32_e64 v249, s76, v236
    v_pk_fma_f32 v[248:249], v[248:249], v[254:255], v[252:253]
    v_cvt_pk_bf16_f32 v236, v248, v249
    v_lshlrev_b32 v250, 16, v237
    v_and_b32 v251, s76, v237
    v_pk_fma_f32 v[250:251], v[250:251], v[254:255], v[252:253]
    v_cvt_pk_bf16_f32 v237, v250, v251
    v_lshlrev_b32 v248, 16, v238
    v_and_b32 v249, s76, v238
    v_pk_fma_f32 v[248:249], v[248:249], v[254:255], v[252:253]
    v_cvt_pk_bf16_f32 v238, v248, v249
    v_lshlrev_b32 v250, 16, v239
    v_and_b32 v251, s76, v239
    v_pk_fma_f32 v[250:251], v[250:251], v[254:255], v[252:253]
    v_cvt_pk_bf16_f32 v239, v250, v251
    buffer_store_dwordx4 v[236:239], v235, s[48:51], s78 offen sc1
    v_lshlrev_b32 v248, 16, v240
    v_and_b32 v249, s76, v240
    v_pk_fma_f32 v[248:249], v[248:249], v[254:255], v[252:253]
    v_cvt_pk_bf16_f32 v240, v248, v249
    v_lshlrev_b32 v250, 16, v241
    v_and_b32 v251, s76, v241
    v_pk_fma_f32 v[250:251], v[250:251], v[254:255], v[252:253]
    v_cvt_pk_bf16_f32 v241, v250, v251
    v_lshlrev_b32 v248, 16, v242
    v_and_b32 v249, s76, v242
    v_pk_fma_f32 v[248:249], v[248:249], v[254:255], v[252:253]
    v_cvt_pk_bf16_f32 v242, v248, v249
    v_lshlrev_b32 v250, 16, v243
    v_and_b32 v251, s76, v243
    v_pk_fma_f32 v[250:251], v[250:251], v[254:255], v[252:253]
    v_cvt_pk_bf16_f32 v243, v250, v251
    buffer_store_dwordx4 v[240:243], v235, s[48:51], s79 offen sc1
    v_lshlrev_b32 v248, 16, v244
    v_and_b32 v249, s76, v244
    v_pk_fma_f32 v[248:249], v[248:249], v[254:255], v[252:253]
    v_cvt_pk_bf16_f32 v244, v248, v249
    v_lshlrev_b32 v250, 16, v245
    v_and_b32 v251, s76, v245
    v_pk_fma_f32 v[250:251], v[250:251], v[254:255], v[252:253]
    v_cvt_pk_bf16_f32 v245, v250, v251
    v_lshlrev_b32 v248, 16, v246
    v_and_b32 v249, s76, v246
    v_pk_fma_f32 v[248:249], v[248:249], v[254:255], v[252:253]
    v_cvt_pk_bf16_f32 v246, v248, v249
    v_lshlrev_b32_e64 v250, 16, v247
    v_and_b32_e64 v251, s76, v247
    v_pk_fma_f32 v[250:251], v[250:251], v[254:255], v[252:253]
    v_cvt_pk_bf16_f32 v247, v250, v251
    buffer_store_dwordx4 v[244:247], v235, s[48:51], s80 offen sc1
    s_mov_b32 s64, 4
    s_mov_b32 s60, 3
    s_branch L_main_head
L_jhi:
    s_cmp_eq_u32 s64, 7
    s_cbranch_scc1 L_job7
    s_cmp_eq_u32 s64, 8
    s_cbranch_scc1 L_job8
    s_cmp_eq_u32 s64, 5
    s_cbranch_scc1 L_job5
    s_cmp_eq_u32 s64, 6
    s_cbranch_scc1 L_job6
    s_cmp_lg_u32 s30, 0
    s_cbranch_scc1 L_sig10
    s_lshl_b32 s3, s31, 8
    s_add_u32 s3, s3, 79697920
    s_mov_b64 exec, 1
    v_mov_b32 v234, 0
    v_mov_b32 v235, 1
    buffer_atomic_add v235, v234, s[48:51], s3 offen
    s_mov_b64 exec, -1
L_sig10:
    s_mov_b32 s54, 0
    s_mov_b32 s46, 0
    s_mov_b32 s10, 0
    s_mov_b32 s18, 0
    s_mov_b32 s64, 5
    s_mov_b32 s60, 3
    s_branch L_main_head
L_job5:
    s_and_b32 s82, s31, 5
    s_and_b32 s3, s32, 2
    s_or_b32 s82, s82, s3
    s_lshl_b32 s82, s82, 1
    s_and_b32 s3, s32, 1
    s_add_u32 s82, s82, s3
    s_and_b32 s83, s31, 2
    s_lshl_b32 s83, s83, 2
    s_add_u32 s83, s83, s33
    s_mov_b32 s77, 79697920
    v_bfe_u32 v234, v1, 4, 3
    v_lshlrev_b32 v234, 8, v234
    buffer_load_dword v235, v234, s[48:51], s77 offen sc1
    s_mov_b32 s56, s4
    s_and_b32 s57, s5, 0xffff
    s_mov_b32 s58, 2621440
    s_mov_b32 s59, 0x00020000
    s_lshl_b32 s80, s31, 2
    s_add_u32 s80, s80, s32
    s_lshl_b32 s80, s80, 2
    s_add_u32 s80, s80, s30
    s_mul_i32 s80, s80, 20480
    s_mul_i32 s3, s33, 160
    s_add_u32 s80, s80, s3
    v_bfe_u32 v237, v1, 4, 4
    v_mul_u32_u24 v237, 1280, v237
    v_lshrrev_b32 v238, 8, v1
    v_lshl_add_u32 v237, v238, 3, v237
    buffer_load_dwordx2 v[58:59], v237, s[56:59], s80 offen offset:0
    buffer_load_dwordx2 v[248:249], v237, s[56:59], s80 offen offset:32
    buffer_load_dwordx2 v[250:251], v237, s[56:59], s80 offen offset:64
    buffer_load_dwordx2 v[252:253], v237, s[56:59], s80 offen offset:96
    buffer_load_dwordx2 v[254:255], v237, s[56:59], s80 offen offset:128
    s_getpc_b64 s[100:101]
L_pc12:
    s_add_u32 s100, s100, L_job6-L_pc12
    s_addc_u32 s101, s101, 0
    s_lshr_b32 s3, s2, 3
    s_lshl_b32 s3, s3, 11
    v_and_b32 v236, 248, v0
    v_lshl_add_u32 v236, v236, 3, s3
    v_min_u32 v236, L_va-L_job6, v236
    global_load_dword v236, v236, s[100:101]
    s_getpc_b64 s[100:101]
L_pc13:
    s_add_u32 s100, s100, L_va-L_pc13
    s_addc_u32 s101, s101, 0
    s_nop 0
    s_bitcmp1_b32 s2, 0
    s_cselect_b32 s3, L_vb-L_va, 0
    s_add_u32 s100, s100, s3
    s_addc_u32 s101, s101, 0
    s_lshr_b32 s3, s2, 3
    s_lshl_b32 s3, s3, 11
    v_and_b32 v239, 248, v0
    v_lshl_add_u32 v239, v239, 3, s3
    v_min_u32 v239, L_va+(L_pf2-L_vb)+2700-L_va, v239
    global_load_dword v239, v239, s[100:101]
    s_mov_b32 s64, 6
    s_mov_b32 s60, 0
    s_branch L_main_head
L_job6:
    v_cmp_gt_u32 vcc, 32, v235
    s_cbranch_vccnz L_slow11
L_ok11:
    v_lshrrev_b32 v246, 6, v1
    v_mul_u32_u24 v246, 192, v246
    v_bfe_u32 v247, v1, 4, 2
    v_lshl_add_u32 v240, v247, 3, v246
    v_bfe_u32 v247, v1, 8, 1
    v_lshlrev_b32 v247, 5, v247
    v_xor_b32 v246, 32, v247
    v_add_u32_e64 v241, v240, v246
    v_add_u32 v240, v240, v247
    v_add_u32 v242, 61440, v240
    v_add_u32 v243, 61440, v241
    v_add_u32 v244, 122880, v240
    v_add_u32 v245, 122880, v241
    s_mul_i32 s78, s83, 122880
    s_add_u32 s78, s78, 83886080
    s_mul_i32 s11, s32, 30720
    s_add_u32 s11, s11, s78
    s_movk_i32 s10, 30720
    s_lshr_b32 s35, s2, 3
    s_lshl_b32 s3, s31, 5
    s_add_u32 s3, s3, s35
    s_lshl_b32 s3, s3, 1
    s_add_u32 s3, s3, s30
    s_mul_i32 s3, s3, 15360
    s_add_u32 s3, s3, 87787520
    s_cmp_ge_u32 s30, 2
    s_cselect_b32 s11, s3, s11
    s_cselect_b32 s10, 15360, s10
    s_lshl_b32 s3, s82, 3
    s_add_u32 s3, s3, s33
    s_mul_i32 s3, s3, 20480
    s_add_u32 s3, s3, 75497472
    s_cmp_eq_u32 s30, 1
    s_cselect_b32 s11, s3, s11
    s_cselect_b32 s10, 20480, s10
    s_mov_b32 s52, s48
    s_mov_b32 s53, s49
    s_add_u32 s54, s11, s10
    s_cmp_eq_u32 s30, 0
    s_cselect_b32 s10, 64, 32
    s_lshl_b32 s3, s10, 4
    s_sub_u32 s3, s3, 16
    s_lshl_b32 s10, s10, 7
    v_min_u32 v12, s3, v1
    v_lshlrev_b32 v12, 3, v12
    s_mov_b32 s64, 7
    s_mov_b32 s60, 4
    s_branch L_main_head
L_job7:
    s_mov_b32 s36, s48
    s_mov_b32 s37, s49
    s_mov_b32 s38, s50
    v_lshrrev_b32 v4, 3, v0
    v_lshlrev_b32 v4, 8, v4
    v_add_u32 v4, v4, v3
    s_add_u32 s66, s78, 0
    s_add_u32 s68, s78, 12288
    s_mov_b32 s64, 8
    s_mov_b32 s60, 0
    s_branch L_main_head
L_job8:
    s_mov_b32 s40, s48
    s_mov_b32 s41, s49
    s_mov_b32 s42, s50
    v_lshrrev_b32 v5, 3, v0
    v_lshlrev_b32 v5, 8, v5
    v_add_u32_e64 v5, v5, v3
    s_add_u32 s66, s78, 24576
    s_add_u32 s67, s78, 36864
    s_add_u32 s68, s78, 49152
    s_add_u32 s69, s78, 61440
    s_mov_b32 s64, 9
    s_mov_b32 s60, 0
    s_branch L_main_head
.p2align 6
L_main_head:
    v_mfma_f32_16x16x32_bf16 v[64:67], v[144:147], a[192:195], v[96:99]
    ds_read_b128 v[168:171], v6 offset:2048
    ds_read_b128 v[172:175], v7 offset:2048
    v_mfma_f32_16x16x32_bf16 v[64:67], v[148:151], a[196:199], v[64:67]
    buffer_store_dwordx4 v[60:63], v13, s[44:47], s16 offen sc1
    v_mfma_f32_16x16x32_bf16 v[64:67], v[152:155], a[200:203], v[64:67]
    s_waitcnt lgkmcnt(2)
    ds_read_b128 v[176:179], v6 offset:6144
    ds_read_b128 v[180:183], v7 offset:6144
    v_mfma_f32_16x16x32_bf16 v[64:67], v[156:159], a[204:207], v[64:67]
    buffer_load_dwordx4 v[60:63], v12, s[52:55], s11 offen
    v_mfma_f32_16x16x32_bf16 v[64:67], v[160:163], a[208:211], v[64:67]
    ds_read_b128 v[184:187], v6 offset:10240
    v_add_u32 v8, s72, v8
    v_mfma_f32_16x16x32_bf16 v[64:67], v[164:167], a[212:215], v[64:67]
    ds_read_b128 v[188:191], v7 offset:10240
    v_add_f32 v224, v224, v228
    v_mfma_f32_16x16x32_bf16 v[68:71], v[164:167], a[236:239], v[100:103]
    v_add_f32 v225, v225, v229
    v_add_u32 v9, s72, v9
    v_mfma_f32_16x16x32_bf16 v[68:71], v[160:163], a[232:235], v[68:71]
    s_add_u32 m0, s61, 0
    ds_read_b64_tr_b16 v[192:193], v8 offset:12288
    ds_read_b64_tr_b16 v[194:195], v8 offset:14336
    v_mfma_f32_16x16x32_bf16 v[68:71], v[156:159], a[228:231], v[68:71]
    buffer_load_dwordx4 v4, s[36:39], s66 offen nt lds
    v_mfma_f32_16x16x32_bf16 v[68:71], v[152:155], a[224:227], v[68:71]
    v_add_f32 v226, v226, v230
    v_add_f32 v227, v227, v231
    v_mfma_f32_16x16x32_bf16 v[68:71], v[148:151], a[220:223], v[68:71]
    v_add_u32 v10, s72, v10
    v_add_u32 v11, s72, v11
    v_mfma_f32_16x16x32_bf16 v[68:71], v[144:147], a[216:219], v[68:71]
    v_exp_f32 v216, v64
    v_mfma_f32_16x16x32_bf16 v[72:75], v[144:147], a[240:243], v[104:107]
    v_mfma_f32_16x16x32_bf16 v[72:75], v[148:151], a[244:247], v[72:75]
    s_add_u32 m0, s61, 3968
    ds_read_b64_tr_b16 v[196:197], v9 offset:12288
    ds_read_b64_tr_b16 v[198:199], v9 offset:14336
    v_mfma_f32_16x16x32_bf16 v[72:75], v[152:155], a[248:251], v[72:75]
    buffer_load_dwordx4 v4, s[36:39], s66 offen offset:128 nt lds
    v_mfma_f32_16x16x32_bf16 v[72:75], v[156:159], a[252:255], v[72:75]
    v_exp_f32 v217, v65
    v_mfma_f32_16x16x32_bf16 v[72:75], v[160:163], v[16:19], v[72:75]
    v_exp_f32 v218, v66
    v_mfma_f32_16x16x32_bf16 v[72:75], v[164:167], v[20:23], v[72:75]
    v_add_f32 v228, v216, v217
    v_cvt_pk_bf16_f32 v112, v216, v217
    v_mfma_f32_16x16x32_bf16 v[76:79], v[164:167], v[44:47], v[108:111]
    v_exp_f32 v219, v67
    v_mfma_f32_16x16x32_bf16 v[76:79], v[160:163], v[40:43], v[76:79]
    s_add_u32 m0, s61, 7936
    ds_read_b64_tr_b16 v[200:201], v10 offset:12288
    ds_read_b64_tr_b16 v[202:203], v10 offset:14336
    v_mfma_f32_16x16x32_bf16 v[76:79], v[156:159], v[36:39], v[76:79]
    buffer_load_dwordx4 v4, s[36:39], s66 offen offset:256 nt lds
    v_mfma_f32_16x16x32_bf16 v[76:79], v[152:155], v[32:35], v[76:79]
    v_exp_f32 v220, v68
    v_mfma_f32_16x16x32_bf16 v[76:79], v[148:151], v[28:31], v[76:79]
    v_add_f32 v228, v228, v218
    v_add_f32 v228, v228, v219
    v_mfma_f32_16x16x32_bf16 v[76:79], v[144:147], v[24:27], v[76:79]
    s_waitcnt lgkmcnt(2)
    v_exp_f32 v221, v69
    v_mfma_f32_16x16x32_bf16 v[80:83], v[168:171], a[192:195], v[96:99]
    v_cvt_pk_bf16_f32 v113, v218, v219
    v_add_f32 v229, v220, v221
    v_mfma_f32_16x16x32_bf16 v[80:83], v[172:175], a[196:199], v[80:83]
    s_add_u32 m0, s61, 12288
    ds_read_b64_tr_b16 v[204:205], v11 offset:12288
    ds_read_b64_tr_b16 v[206:207], v11 offset:14336
    v_mfma_f32_16x16x32_bf16 v[80:83], v[176:179], a[200:203], v[80:83]
    buffer_load_dwordx4 v5, s[40:43], s67 offen nt lds
    v_mfma_f32_16x16x32_bf16 v[80:83], v[180:183], a[204:207], v[80:83]
    v_exp_f32 v222, v70
    v_mfma_f32_16x16x32_bf16 v[80:83], v[184:187], a[208:211], v[80:83]
    v_exp_f32 v223, v71
    v_mfma_f32_16x16x32_bf16 v[80:83], v[188:191], a[212:215], v[80:83]
    v_cvt_pk_bf16_f32 v116, v220, v221
    v_add_f32 v229, v229, v222
    v_mfma_f32_16x16x32_bf16 v[84:87], v[188:191], a[236:239], v[100:103]
    v_exp_f32 v216, v72
    v_mfma_f32_16x16x32_bf16 v[84:87], v[184:187], a[232:235], v[84:87]
    s_add_u32 m0, s61, 16256
    ds_read_b64_tr_b16 v[208:209], v8 offset:16384
    ds_read_b64_tr_b16 v[210:211], v8 offset:18432
    v_mfma_f32_16x16x32_bf16 v[84:87], v[180:183], a[228:231], v[84:87]
    buffer_load_dwordx4 v5, s[40:43], s67 offen offset:128 nt lds
    v_mfma_f32_16x16x32_bf16 v[84:87], v[176:179], a[224:227], v[84:87]
    v_exp_f32 v217, v73
    v_mfma_f32_16x16x32_bf16 v[84:87], v[172:175], a[220:223], v[84:87]
    v_add_f32 v229, v229, v223
    v_cvt_pk_bf16_f32 v117, v222, v223
    v_mfma_f32_16x16x32_bf16 v[84:87], v[168:171], a[216:219], v[84:87]
    v_exp_f32 v218, v74
    v_mfma_f32_16x16x32_bf16 v[88:91], v[168:171], a[240:243], v[104:107]
    v_add_f32 v230, v216, v217
    v_cvt_pk_bf16_f32 v120, v216, v217
    v_mfma_f32_16x16x32_bf16 v[88:91], v[172:175], a[244:247], v[88:91]
    s_add_u32 m0, s61, 20224
    ds_read_b64_tr_b16 v[212:213], v9 offset:16384
    ds_read_b64_tr_b16 v[214:215], v9 offset:18432
    v_mfma_f32_16x16x32_bf16 v[88:91], v[176:179], a[248:251], v[88:91]
    buffer_load_dwordx4 v5, s[40:43], s67 offen offset:256 nt lds
    v_mfma_f32_16x16x32_bf16 v[88:91], v[180:183], a[252:255], v[88:91]
    v_exp_f32 v219, v75
    v_mfma_f32_16x16x32_bf16 v[88:91], v[184:187], v[16:19], v[88:91]
    v_exp_f32 v220, v76
    v_mfma_f32_16x16x32_bf16 v[88:91], v[188:191], v[20:23], v[88:91]
    v_add_f32 v230, v230, v218
    v_add_f32 v230, v230, v219
    v_mfma_f32_16x16x32_bf16 v[92:95], v[188:191], v[44:47], v[108:111]
    v_exp_f32 v221, v77
    v_mfma_f32_16x16x32_bf16 v[92:95], v[184:187], v[40:43], v[92:95]
    v_cvt_pk_bf16_f32 v121, v218, v219
    v_add_f32 v231, v220, v221
    v_mfma_f32_16x16x32_bf16 v[92:95], v[180:183], v[36:39], v[92:95]
    v_exp_f32 v222, v78
    v_mfma_f32_16x16x32_bf16 v[92:95], v[176:179], v[32:35], v[92:95]
    v_cvt_pk_bf16_f32 v124, v220, v221
    v_add_f32 v231, v231, v222
    v_mfma_f32_16x16x32_bf16 v[92:95], v[172:175], v[28:31], v[92:95]
    v_mfma_f32_16x16x32_bf16 v[92:95], v[168:171], v[24:27], v[92:95]
    v_exp_f32 v223, v79
    v_mfma_f32_16x16x32_bf16 a[0:3], v[128:131], v[192:195], a[0:3]
    v_add_f32 v231, v231, v223
    v_cvt_pk_bf16_f32 v125, v222, v223
    v_mfma_f32_16x16x32_bf16 a[16:19], v[128:131], v[196:199], a[16:19]
    v_exp_f32 v216, v80
    v_mfma_f32_16x16x32_bf16 a[20:23], v[132:135], v[196:199], a[20:23]
    v_add_f32 v228, v228, v216
    v_mfma_f32_16x16x32_bf16 a[4:7], v[132:135], v[192:195], a[4:7]
    v_mfma_f32_16x16x32_bf16 a[8:11], v[136:139], v[192:195], a[8:11]
    v_exp_f32 v217, v81
    v_mfma_f32_16x16x32_bf16 a[24:27], v[136:139], v[196:199], a[24:27]
    v_add_f32 v228, v228, v217
    v_cvt_pk_bf16_f32 v114, v216, v217
    v_mfma_f32_16x16x32_bf16 a[28:31], v[140:143], v[196:199], a[28:31]
    v_exp_f32 v218, v82
    v_mfma_f32_16x16x32_bf16 a[12:15], v[140:143], v[192:195], a[12:15]
    s_waitcnt lgkmcnt(0)
    v_add_f32 v228, v228, v218
    v_mfma_f32_16x16x32_bf16 a[44:47], v[140:143], v[200:203], a[44:47]
    ds_read_b64_tr_b16 v[192:193], v10 offset:16384
    v_mfma_f32_16x16x32_bf16 a[60:63], v[140:143], v[204:207], a[60:63]
    ds_read_b64_tr_b16 v[194:195], v10 offset:18432
    v_mfma_f32_16x16x32_bf16 a[56:59], v[136:139], v[204:207], a[56:59]
    ds_read_b64_tr_b16 v[196:197], v11 offset:16384
    v_mfma_f32_16x16x32_bf16 a[40:43], v[136:139], v[200:203], a[40:43]
    ds_read_b64_tr_b16 v[198:199], v11 offset:18432
    v_mfma_f32_16x16x32_bf16 a[36:39], v[132:135], v[200:203], a[36:39]
    v_exp_f32 v219, v83
    v_mfma_f32_16x16x32_bf16 a[52:55], v[132:135], v[204:207], a[52:55]
    v_exp_f32 v220, v84
    v_mfma_f32_16x16x32_bf16 a[48:51], v[128:131], v[204:207], a[48:51]
    v_exp_f32 v221, v85
    v_mfma_f32_16x16x32_bf16 a[32:35], v[128:131], v[200:203], a[32:35]
    v_add_f32 v228, v228, v219
    v_cvt_pk_bf16_f32 v115, v218, v219
    v_mfma_f32_16x16x32_bf16 a[64:67], v[128:131], v[208:211], a[64:67]
    ds_read_b64_tr_b16 v[200:201], v8 offset:20480
    v_add_f32 v229, v229, v220
    v_mfma_f32_16x16x32_bf16 a[80:83], v[128:131], v[212:215], a[80:83]
    ds_read_b64_tr_b16 v[202:203], v8 offset:22528
    v_add_f32 v229, v229, v221
    v_mfma_f32_16x16x32_bf16 a[84:87], v[132:135], v[212:215], a[84:87]
    ds_read_b64_tr_b16 v[204:205], v9 offset:20480
    v_cvt_pk_bf16_f32 v118, v220, v221
    v_mfma_f32_16x16x32_bf16 a[68:71], v[132:135], v[208:211], a[68:71]
    ds_read_b64_tr_b16 v[206:207], v9 offset:22528
    v_mfma_f32_16x16x32_bf16 a[72:75], v[136:139], v[208:211], a[72:75]
    v_exp_f32 v222, v86
    v_mfma_f32_16x16x32_bf16 a[88:91], v[136:139], v[212:215], a[88:91]
    v_exp_f32 v223, v87
    v_mfma_f32_16x16x32_bf16 a[92:95], v[140:143], v[212:215], a[92:95]
    v_exp_f32 v216, v88
    v_mfma_f32_16x16x32_bf16 a[76:79], v[140:143], v[208:211], a[76:79]
    s_waitcnt lgkmcnt(1)
    v_exp_f32 v217, v89
    v_mfma_f32_16x16x32_bf16 a[108:111], v[140:143], v[192:195], a[108:111]
    ds_read_b64_tr_b16 v[208:209], v10 offset:20480
    v_add_f32 v229, v229, v222
    v_mfma_f32_16x16x32_bf16 a[124:127], v[140:143], v[196:199], a[124:127]
    ds_read_b64_tr_b16 v[210:211], v10 offset:22528
    v_add_f32 v229, v229, v223
    v_mfma_f32_16x16x32_bf16 a[120:123], v[136:139], v[196:199], a[120:123]
    ds_read_b64_tr_b16 v[212:213], v11 offset:20480
    v_cvt_pk_bf16_f32 v119, v222, v223
    v_mfma_f32_16x16x32_bf16 a[104:107], v[136:139], v[192:195], a[104:107]
    ds_read_b64_tr_b16 v[214:215], v11 offset:22528
    v_add_f32 v230, v230, v216
    v_mfma_f32_16x16x32_bf16 a[100:103], v[132:135], v[192:195], a[100:103]
    v_exp_f32 v218, v90
    v_mfma_f32_16x16x32_bf16 a[116:119], v[132:135], v[196:199], a[116:119]
    v_exp_f32 v219, v91
    v_mfma_f32_16x16x32_bf16 a[112:115], v[128:131], v[196:199], a[112:115]
    v_exp_f32 v220, v92
    v_mfma_f32_16x16x32_bf16 a[96:99], v[128:131], v[192:195], a[96:99]
    v_add_f32 v230, v230, v217
    v_cvt_pk_bf16_f32 v122, v216, v217
    v_mfma_f32_16x16x32_bf16 a[128:131], v[128:131], v[200:203], a[128:131]
    s_waitcnt lgkmcnt(0)
    v_add_f32 v230, v230, v218
    v_add_f32 v230, v230, v219
    v_mfma_f32_16x16x32_bf16 a[144:147], v[128:131], v[204:207], a[144:147]
    v_exp_f32 v221, v93
    v_mfma_f32_16x16x32_bf16 a[148:151], v[132:135], v[204:207], a[148:151]
    v_cvt_pk_bf16_f32 v123, v218, v219
    v_add_f32 v231, v231, v220
    v_mfma_f32_16x16x32_bf16 a[132:135], v[132:135], v[200:203], a[132:135]
    v_exp_f32 v222, v94
    v_mfma_f32_16x16x32_bf16 a[136:139], v[136:139], v[200:203], a[136:139]
    ds_read_b128 v[144:147], v6 offset:24576
    v_add_f32 v231, v231, v221
    v_mfma_f32_16x16x32_bf16 a[152:155], v[136:139], v[204:207], a[152:155]
    ds_read_b128 v[148:151], v7 offset:24576
    v_cvt_pk_bf16_f32 v126, v220, v221
    v_mfma_f32_16x16x32_bf16 a[156:159], v[140:143], v[204:207], a[156:159]
    v_exp_f32 v223, v95
    v_mfma_f32_16x16x32_bf16 a[140:143], v[140:143], v[200:203], a[140:143]
    ds_read_b128 v[152:155], v6 offset:28672
    v_add_f32 v231, v231, v222
    v_mfma_f32_16x16x32_bf16 a[172:175], v[140:143], v[208:211], a[172:175]
    ds_read_b128 v[156:159], v7 offset:28672
    v_add_f32 v231, v231, v223
    v_mfma_f32_16x16x32_bf16 a[188:191], v[140:143], v[212:215], a[188:191]
    v_cvt_pk_bf16_f32 v127, v222, v223
    v_mfma_f32_16x16x32_bf16 a[184:187], v[136:139], v[212:215], a[184:187]
    ds_read_b128 v[160:163], v6 offset:32768
    v_max3_f32 v232, v228, v229, v230
    v_mfma_f32_16x16x32_bf16 a[168:171], v[136:139], v[208:211], a[168:171]
    ds_read_b128 v[164:167], v7 offset:32768
    v_max_f32 v232, v232, v231
    v_mfma_f32_16x16x32_bf16 a[164:167], v[132:135], v[208:211], a[164:167]
    v_cmp_lt_f32 vcc, s63, v232
    v_mfma_f32_16x16x32_bf16 a[180:183], v[132:135], v[212:215], a[180:183]
    v_mfma_f32_16x16x32_bf16 a[176:179], v[128:131], v[212:215], a[176:179]
    s_waitcnt lgkmcnt(2)
    v_mfma_f32_16x16x32_bf16 a[160:163], v[128:131], v[208:211], a[160:163]
    s_cbranch_vccnz L_rare0
L_back0:
    v_mfma_f32_16x16x32_bf16 v[64:67], v[144:147], a[192:195], v[96:99]
    ds_read_b128 v[168:171], v6 offset:26624
    v_add_f32 v224, v224, v228
    v_mfma_f32_16x16x32_bf16 v[64:67], v[148:151], a[196:199], v[64:67]
    ds_read_b128 v[172:175], v7 offset:26624
    v_add_f32 v225, v225, v229
    v_mfma_f32_16x16x32_bf16 v[64:67], v[152:155], a[200:203], v[64:67]
    ds_read_b128 v[176:179], v6 offset:30720
    v_add_f32 v226, v226, v230
    v_mfma_f32_16x16x32_bf16 v[64:67], v[156:159], a[204:207], v[64:67]
    s_waitcnt lgkmcnt(3)
    ds_read_b128 v[180:183], v7 offset:30720
    v_add_f32 v227, v227, v231
    v_mfma_f32_16x16x32_bf16 v[64:67], v[160:163], a[208:211], v[64:67]
    ds_read_b128 v[184:187], v6 offset:34816
    v_mfma_f32_16x16x32_bf16 v[64:67], v[164:167], a[212:215], v[64:67]
    ds_read_b128 v[188:191], v7 offset:34816
    v_mfma_f32_16x16x32_bf16 v[68:71], v[164:167], a[236:239], v[100:103]
    v_add_u32 v6, s70, v6
    v_add_u32 v7, s70, v7
    v_mfma_f32_16x16x32_bf16 v[68:71], v[160:163], a[232:235], v[68:71]
    s_add_u32 m0, s61, 24576
    ds_read_b64_tr_b16 v[192:193], v8 offset:36864
    ds_read_b64_tr_b16 v[194:195], v8 offset:38912
    v_mfma_f32_16x16x32_bf16 v[68:71], v[156:159], a[228:231], v[68:71]
    buffer_load_dwordx4 v4, s[36:39], s68 offen nt lds
    v_mfma_f32_16x16x32_bf16 v[68:71], v[152:155], a[224:227], v[68:71]
    v_mfma_f32_16x16x32_bf16 v[68:71], v[148:151], a[220:223], v[68:71]
    v_exp_f32 v216, v64
    v_mfma_f32_16x16x32_bf16 v[68:71], v[144:147], a[216:219], v[68:71]
    v_mfma_f32_16x16x32_bf16 v[72:75], v[144:147], a[240:243], v[104:107]
    v_exp_f32 v217, v65
    v_mfma_f32_16x16x32_bf16 v[72:75], v[148:151], a[244:247], v[72:75]
    s_add_u32 m0, s61, 28544
    ds_read_b64_tr_b16 v[196:197], v9 offset:36864
    ds_read_b64_tr_b16 v[198:199], v9 offset:38912
    v_mfma_f32_16x16x32_bf16 v[72:75], v[152:155], a[248:251], v[72:75]
    buffer_load_dwordx4 v4, s[36:39], s68 offen offset:128 nt lds
    v_mfma_f32_16x16x32_bf16 v[72:75], v[156:159], a[252:255], v[72:75]
    v_exp_f32 v218, v66
    v_mfma_f32_16x16x32_bf16 v[72:75], v[160:163], v[16:19], v[72:75]
    v_add_f32 v228, v216, v217
    v_cvt_pk_bf16_f32 v128, v216, v217
    v_mfma_f32_16x16x32_bf16 v[72:75], v[164:167], v[20:23], v[72:75]
    v_exp_f32 v219, v67
    v_mfma_f32_16x16x32_bf16 v[76:79], v[164:167], v[44:47], v[108:111]
    v_add_f32 v228, v228, v218
    v_add_f32 v228, v228, v219
    v_mfma_f32_16x16x32_bf16 v[76:79], v[160:163], v[40:43], v[76:79]
    s_add_u32 m0, s61, 32512
    ds_read_b64_tr_b16 v[200:201], v10 offset:36864
    ds_read_b64_tr_b16 v[202:203], v10 offset:38912
    v_mfma_f32_16x16x32_bf16 v[76:79], v[156:159], v[36:39], v[76:79]
    buffer_load_dwordx4 v4, s[36:39], s68 offen offset:256 nt lds
    v_mfma_f32_16x16x32_bf16 v[76:79], v[152:155], v[32:35], v[76:79]
    v_exp_f32 v220, v68
    v_mfma_f32_16x16x32_bf16 v[76:79], v[148:151], v[28:31], v[76:79]
    v_exp_f32 v221, v69
    v_mfma_f32_16x16x32_bf16 v[76:79], v[144:147], v[24:27], v[76:79]
    s_waitcnt lgkmcnt(2)
    v_cvt_pk_bf16_f32 v129, v218, v219
    v_add_f32 v229, v220, v221
    v_mfma_f32_16x16x32_bf16 v[80:83], v[168:171], a[192:195], v[96:99]
    v_exp_f32 v222, v70
    v_mfma_f32_16x16x32_bf16 v[80:83], v[172:175], a[196:199], v[80:83]
    s_add_u32 m0, s61, 36864
    ds_read_b64_tr_b16 v[204:205], v11 offset:36864
    ds_read_b64_tr_b16 v[206:207], v11 offset:38912
    v_mfma_f32_16x16x32_bf16 v[80:83], v[176:179], a[200:203], v[80:83]
    buffer_load_dwordx4 v5, s[40:43], s69 offen nt lds
    v_mfma_f32_16x16x32_bf16 v[80:83], v[180:183], a[204:207], v[80:83]
    v_exp_f32 v223, v71
    v_mfma_f32_16x16x32_bf16 v[80:83], v[184:187], a[208:211], v[80:83]
    v_cvt_pk_bf16_f32 v132, v220, v221
    v_add_f32 v229, v229, v222
    v_mfma_f32_16x16x32_bf16 v[80:83], v[188:191], a[212:215], v[80:83]
    v_exp_f32 v216, v72
    v_mfma_f32_16x16x32_bf16 v[84:87], v[188:191], a[236:239], v[100:103]
    v_add_f32 v229, v229, v223
    v_cvt_pk_bf16_f32 v133, v222, v223
    v_mfma_f32_16x16x32_bf16 v[84:87], v[184:187], a[232:235], v[84:87]
    s_add_u32 m0, s61, 40832
    ds_read_b64_tr_b16 v[208:209], v8 offset:40960
    ds_read_b64_tr_b16 v[210:211], v8 offset:43008
    v_mfma_f32_16x16x32_bf16 v[84:87], v[180:183], a[228:231], v[84:87]
    buffer_load_dwordx4 v5, s[40:43], s69 offen offset:128 nt lds
    v_mfma_f32_16x16x32_bf16 v[84:87], v[176:179], a[224:227], v[84:87]
    v_exp_f32 v217, v73
    v_mfma_f32_16x16x32_bf16 v[84:87], v[172:175], a[220:223], v[84:87]
    v_exp_f32 v218, v74
    v_mfma_f32_16x16x32_bf16 v[84:87], v[168:171], a[216:219], v[84:87]
    v_add_f32 v230, v216, v217
    v_cvt_pk_bf16_f32 v136, v216, v217
    v_mfma_f32_16x16x32_bf16 v[88:91], v[168:171], a[240:243], v[104:107]
    v_exp_f32 v219, v75
    v_mfma_f32_16x16x32_bf16 v[88:91], v[172:175], a[244:247], v[88:91]
    s_add_u32 m0, s61, 44800
    ds_read_b64_tr_b16 v[212:213], v9 offset:40960
    ds_read_b64_tr_b16 v[214:215], v9 offset:43008
    v_mfma_f32_16x16x32_bf16 v[88:91], v[176:179], a[248:251], v[88:91]
    buffer_load_dwordx4 v5, s[40:43], s69 offen offset:256 nt lds
    v_mfma_f32_16x16x32_bf16 v[88:91], v[180:183], a[252:255], v[88:91]
    v_exp_f32 v220, v76
    v_mfma_f32_16x16x32_bf16 v[88:91], v[184:187], v[16:19], v[88:91]
    v_add_f32 v230, v230, v218
    v_add_f32 v230, v230, v219
    v_mfma_f32_16x16x32_bf16 v[88:91], v[188:191], v[20:23], v[88:91]
    v_exp_f32 v221, v77
    v_mfma_f32_16x16x32_bf16 v[92:95], v[188:191], v[44:47], v[108:111]
    s_add_u32 s66, s66, 24576
    v_cvt_pk_bf16_f32 v137, v218, v219
    v_add_f32 v231, v220, v221
    v_mfma_f32_16x16x32_bf16 v[92:95], v[184:187], v[40:43], v[92:95]
    s_add_u32 s67, s67, 24576
    v_cvt_pk_bf16_f32 v140, v220, v221
    v_mfma_f32_16x16x32_bf16 v[92:95], v[180:183], v[36:39], v[92:95]
    s_add_u32 s68, s68, 24576
    v_exp_f32 v222, v78
    v_mfma_f32_16x16x32_bf16 v[92:95], v[176:179], v[32:35], v[92:95]
    s_add_u32 s69, s69, 24576
    v_add_f32 v231, v231, v222
    v_mfma_f32_16x16x32_bf16 v[92:95], v[172:175], v[28:31], v[92:95]
    s_mov_b32 s16, s17
    v_exp_f32 v223, v79
    v_mfma_f32_16x16x32_bf16 v[92:95], v[168:171], v[24:27], v[92:95]
    s_add_u32 s17, s17, s18
    v_add_f32 v231, v231, v223
    v_cvt_pk_bf16_f32 v141, v222, v223
    v_mfma_f32_16x16x32_bf16 a[0:3], v[112:115], v[192:195], a[0:3]
    s_add_u32 s11, s11, s10
    v_mfma_f32_16x16x32_bf16 a[16:19], v[112:115], v[196:199], a[16:19]
    s_add_u32 s61, s62, s34
    v_exp_f32 v216, v80
    v_mfma_f32_16x16x32_bf16 a[20:23], v[116:119], v[196:199], a[20:23]
    s_add_u32 s62, s62, s70
    v_add_f32 v228, v228, v216
    v_mfma_f32_16x16x32_bf16 a[4:7], v[116:119], v[192:195], a[4:7]
    s_mov_b32 s3, s70
    v_exp_f32 v217, v81
    v_mfma_f32_16x16x32_bf16 a[8:11], v[120:123], v[192:195], a[8:11]
    s_mov_b32 s70, s71
    v_add_f32 v228, v228, v217
    v_cvt_pk_bf16_f32 v130, v216, v217
    v_mfma_f32_16x16x32_bf16 a[24:27], v[120:123], v[196:199], a[24:27]
    s_mov_b32 s71, s72
    v_mfma_f32_16x16x32_bf16 a[28:31], v[124:127], v[196:199], a[28:31]
    s_mov_b32 s72, s3
    v_exp_f32 v218, v82
    v_mfma_f32_16x16x32_bf16 a[12:15], v[124:127], v[192:195], a[12:15]
    s_waitcnt lgkmcnt(0)
    v_add_f32 v228, v228, v218
    v_mfma_f32_16x16x32_bf16 a[44:47], v[124:127], v[200:203], a[44:47]
    s_sub_u32 s60, s60, 1
    ds_read_b64_tr_b16 v[192:193], v10 offset:40960
    v_mfma_f32_16x16x32_bf16 a[60:63], v[124:127], v[204:207], a[60:63]
    s_cselect_b32 s19, -1.0, s63
    ds_read_b64_tr_b16 v[194:195], v10 offset:43008
    v_mfma_f32_16x16x32_bf16 a[56:59], v[120:123], v[204:207], a[56:59]
    ds_read_b64_tr_b16 v[196:197], v11 offset:40960
    v_mfma_f32_16x16x32_bf16 a[40:43], v[120:123], v[200:203], a[40:43]
    ds_read_b64_tr_b16 v[198:199], v11 offset:43008
    v_mfma_f32_16x16x32_bf16 a[36:39], v[116:119], v[200:203], a[36:39]
    v_exp_f32 v219, v83
    v_mfma_f32_16x16x32_bf16 a[52:55], v[116:119], v[204:207], a[52:55]
    v_exp_f32 v220, v84
    v_mfma_f32_16x16x32_bf16 a[48:51], v[112:115], v[204:207], a[48:51]
    v_exp_f32 v221, v85
    v_mfma_f32_16x16x32_bf16 a[32:35], v[112:115], v[200:203], a[32:35]
    v_exp_f32 v222, v86
    v_mfma_f32_16x16x32_bf16 a[64:67], v[112:115], v[208:211], a[64:67]
    ds_read_b64_tr_b16 v[200:201], v8 offset:45056
    v_add_f32 v228, v228, v219
    v_mfma_f32_16x16x32_bf16 a[80:83], v[112:115], v[212:215], a[80:83]
    ds_read_b64_tr_b16 v[202:203], v8 offset:47104
    v_cvt_pk_bf16_f32 v131, v218, v219
    v_mfma_f32_16x16x32_bf16 a[84:87], v[116:119], v[212:215], a[84:87]
    ds_read_b64_tr_b16 v[204:205], v9 offset:45056
    v_add_f32 v229, v229, v220
    v_mfma_f32_16x16x32_bf16 a[68:71], v[116:119], v[208:211], a[68:71]
    ds_read_b64_tr_b16 v[206:207], v9 offset:47104
    v_add_f32 v229, v229, v221
    v_mfma_f32_16x16x32_bf16 a[72:75], v[120:123], v[208:211], a[72:75]
    v_exp_f32 v223, v87
    v_mfma_f32_16x16x32_bf16 a[88:91], v[120:123], v[212:215], a[88:91]
    v_exp_f32 v216, v88
    v_mfma_f32_16x16x32_bf16 a[92:95], v[124:127], v[212:215], a[92:95]
    v_cvt_pk_bf16_f32 v134, v220, v221
    v_add_f32 v229, v229, v222
    v_mfma_f32_16x16x32_bf16 a[76:79], v[124:127], v[208:211], a[76:79]
    s_waitcnt lgkmcnt(1)
    v_exp_f32 v217, v89
    v_mfma_f32_16x16x32_bf16 a[108:111], v[124:127], v[192:195], a[108:111]
    ds_read_b64_tr_b16 v[208:209], v10 offset:45056
    v_add_f32 v229, v229, v223
    v_mfma_f32_16x16x32_bf16 a[124:127], v[124:127], v[196:199], a[124:127]
    ds_read_b64_tr_b16 v[210:211], v10 offset:47104
    v_cvt_pk_bf16_f32 v135, v222, v223
    v_mfma_f32_16x16x32_bf16 a[120:123], v[120:123], v[196:199], a[120:123]
    ds_read_b64_tr_b16 v[212:213], v11 offset:45056
    v_add_f32 v230, v230, v216
    v_mfma_f32_16x16x32_bf16 a[104:107], v[120:123], v[192:195], a[104:107]
    ds_read_b64_tr_b16 v[214:215], v11 offset:47104
    v_add_f32 v230, v230, v217
    v_mfma_f32_16x16x32_bf16 a[100:103], v[116:119], v[192:195], a[100:103]
    v_exp_f32 v218, v90
    v_mfma_f32_16x16x32_bf16 a[116:119], v[116:119], v[196:199], a[116:119]
    v_exp_f32 v219, v91
    v_mfma_f32_16x16x32_bf16 a[112:115], v[112:115], v[196:199], a[112:115]
    v_exp_f32 v220, v92
    v_mfma_f32_16x16x32_bf16 a[96:99], v[112:115], v[192:195], a[96:99]
    v_cvt_pk_bf16_f32 v138, v216, v217
    v_add_f32 v230, v230, v218
    v_mfma_f32_16x16x32_bf16 a[128:131], v[112:115], v[200:203], a[128:131]
    s_waitcnt lgkmcnt(0)
    v_add_f32 v230, v230, v219
    v_cvt_pk_bf16_f32 v139, v218, v219
    v_mfma_f32_16x16x32_bf16 a[144:147], v[112:115], v[204:207], a[144:147]
    v_mfma_f32_16x16x32_bf16 a[148:151], v[116:119], v[204:207], a[148:151]
    s_waitcnt vmcnt(12) lgkmcnt(0)
    s_barrier
    v_mfma_f32_16x16x32_bf16 a[132:135], v[116:119], v[200:203], a[132:135]
    v_exp_f32 v221, v93
    v_mfma_f32_16x16x32_bf16 a[136:139], v[120:123], v[200:203], a[136:139]
    ds_read_b128 v[144:147], v6 offset:0
    v_add_f32 v231, v231, v220
    v_mfma_f32_16x16x32_bf16 a[152:155], v[120:123], v[204:207], a[152:155]
    ds_read_b128 v[148:151], v7 offset:0
    v_add_f32 v231, v231, v221
    v_mfma_f32_16x16x32_bf16 a[156:159], v[124:127], v[204:207], a[156:159]
    v_exp_f32 v222, v94
    v_mfma_f32_16x16x32_bf16 a[140:143], v[124:127], v[200:203], a[140:143]
    ds_read_b128 v[152:155], v6 offset:4096
    v_cvt_pk_bf16_f32 v142, v220, v221
    v_mfma_f32_16x16x32_bf16 a[172:175], v[124:127], v[208:211], a[172:175]
    ds_read_b128 v[156:159], v7 offset:4096
    v_add_f32 v231, v231, v222
    v_mfma_f32_16x16x32_bf16 a[188:191], v[124:127], v[212:215], a[188:191]
    v_exp_f32_e64 v223, v95
    v_mfma_f32_16x16x32_bf16 a[184:187], v[120:123], v[212:215], a[184:187]
    ds_read_b128 v[160:163], v6 offset:8192
    v_add_f32_e64 v231, v231, v223
    v_mfma_f32_16x16x32_bf16 a[168:171], v[120:123], v[208:211], a[168:171]
    ds_read_b128 v[164:167], v7 offset:8192
    v_cvt_pk_bf16_f32 v143, v222, v223
    v_mfma_f32_16x16x32_bf16 a[164:167], v[116:119], v[208:211], a[164:167]
    v_max3_f32 v232, v228, v229, v230
    v_max_f32_e64 v232, v232, v231
    v_mfma_f32_16x16x32_bf16 a[180:183], v[116:119], v[212:215], a[180:183]
    v_cmp_nge_f32 vcc, s19, v232
    v_mfma_f32_16x16x32_bf16 a[176:179], v[112:115], v[212:215], a[176:179]
    s_waitcnt lgkmcnt(2)
    v_mfma_f32_16x16x32_bf16 a[160:163], v[112:115], v[208:211], a[160:163]
    s_cbranch_vccz L_main_head
L_hand:
    v_cmp_lt_f32 vcc, s63, v232
    s_cbranch_vccnz L_rare1
L_back1:
    s_cmp_ge_i32 s60, 0
    s_cbranch_scc1 L_main_head
    s_cmp_lt_u32 s64, 9
    s_cbranch_scc1 L_jobs
L_pf1:
    s_waitcnt lgkmcnt(0)
    s_add_u32 s78, s78, 61440
    s_lshl_b32 s81, s82, 2
    s_add_u32 s81, s81, s30
    s_mul_i32 s79, s81, 40960
    s_add_u32 s79, s79, 75497472
    s_add_u32 s80, s79, 20480
    v_add_u32 v8, s72, v8
    v_add_u32 v9, s72, v9
    v_add_u32 v10, s72, v10
    v_add_u32 v11, s72, v11
    ds_read_b64_tr_b16 v[192:193], v8 offset:12288
    ds_read_b64_tr_b16 v[194:195], v8 offset:14336
    ds_read_b64_tr_b16 v[196:197], v9 offset:12288
    ds_read_b64_tr_b16 v[198:199], v9 offset:14336
    ds_read_b64_tr_b16 v[200:201], v10 offset:12288
    ds_read_b64_tr_b16 v[202:203], v10 offset:14336
    ds_read_b64_tr_b16 v[204:205], v11 offset:12288
    ds_read_b64_tr_b16 v[206:207], v11 offset:14336
    ds_read_b64_tr_b16 v[208:209], v8 offset:16384
    ds_read_b64_tr_b16 v[210:211], v8 offset:18432
    ds_read_b64_tr_b16 v[212:213], v9 offset:16384
    ds_read_b64_tr_b16 v[214:215], v9 offset:18432
    buffer_load_dwordx4 v[144:147], v1, s[48:51], s79 offen sc1
    buffer_load_dwordx4 v[148:151], v1, s[48:51], s80 offen sc1
    buffer_load_dwordx4 v[152:155], v1, s[48:51], s79 offen offset:1024 sc1
    buffer_load_dwordx4 v[156:159], v1, s[48:51], s80 offen offset:1024 sc1
    v_add_f32 v224, v224, v228
    v_add_f32 v225, v225, v229
    v_add_f32 v226, v226, v230
    v_add_f32 v227, v227, v231
    v_mov_b32 v48, v224
    v_mov_b32 v49, v225
    v_mov_b32 v50, v226
    v_mov_b32 v51, v227
    v_permlane32_swap_b32 v224, v48
    v_permlane32_swap_b32 v225, v49
    v_permlane32_swap_b32 v226, v50
    v_permlane32_swap_b32 v227, v51
    s_waitcnt lgkmcnt(10)
    v_mfma_f32_16x16x32_bf16 a[0:3], v[128:131], v[192:195], a[0:3]
    buffer_load_dwordx4 v[160:163], v1, s[48:51], s79 offen offset:2048 sc1
    v_mfma_f32_16x16x32_bf16 a[4:7], v[132:135], v[192:195], a[4:7]
    s_lshl_b32 s35, s34, 2
    v_add_f32 v224, v224, v48
    v_add_f32 v225, v225, v49
    v_mfma_f32_16x16x32_bf16 a[8:11], v[136:139], v[192:195], a[8:11]
    s_add_u32 s35, s35, 147456
    v_add_f32 v226, v226, v50
    v_add_f32 v227, v227, v51
    v_mfma_f32_16x16x32_bf16 a[12:15], v[140:143], v[192:195], a[12:15]
    s_waitcnt lgkmcnt(8)
    s_lshl_b32 s3, s33, 2
    ds_read_b64_tr_b16 v[192:193], v10 offset:16384
    ds_read_b64_tr_b16 v[194:195], v10 offset:18432
    v_mfma_f32_16x16x32_bf16 a[28:31], v[140:143], v[196:199], a[28:31]
    buffer_load_dwordx4 v[164:167], v1, s[48:51], s80 offen offset:2048 sc1
    v_mfma_f32_16x16x32_bf16 a[24:27], v[136:139], v[196:199], a[24:27]
    s_add_u32 s3, s3, s30
    v_mov_b32 v48, v224
    v_mov_b32_e64 v49, v225
    v_mfma_f32_16x16x32_bf16 a[20:23], v[132:135], v[196:199], a[20:23]
    s_mul_i32 s72, s3, 786432
    v_mov_b32_e64 v50, v226
    v_mov_b32 v51, v227
    v_mfma_f32_16x16x32_bf16 a[16:19], v[128:131], v[196:199], a[16:19]
    s_waitcnt lgkmcnt(2)
    s_mul_i32 s3, s31, 24576
    ds_read_b64_tr_b16 v[196:197], v11 offset:16384
    ds_read_b64_tr_b16 v[198:199], v11 offset:18432
    v_mfma_f32_16x16x32_bf16 a[32:35], v[128:131], v[200:203], a[32:35]
    buffer_load_dwordx4 v[168:171], v1, s[48:51], s79 offen offset:3072 sc1
    v_mfma_f32_16x16x32_bf16 a[36:39], v[132:135], v[200:203], a[36:39]
    s_add_u32 s72, s72, s3
    v_permlane16_swap_b32 v224, v48
    v_permlane16_swap_b32 v225, v49
    v_mfma_f32_16x16x32_bf16 a[40:43], v[136:139], v[200:203], a[40:43]
    s_add_u32 s72, s72, 16777216
    v_permlane16_swap_b32 v226, v50
    v_permlane16_swap_b32 v227, v51
    v_mfma_f32_16x16x32_bf16 a[44:47], v[140:143], v[200:203], a[44:47]
    s_mul_i32 s3, s32, 6144
    ds_read_b64_tr_b16 v[200:201], v8 offset:20480
    ds_read_b64_tr_b16 v[202:203], v8 offset:22528
    v_mfma_f32_16x16x32_bf16 a[60:63], v[140:143], v[204:207], a[60:63]
    buffer_load_dwordx4 v[172:175], v1, s[48:51], s80 offen offset:3072 sc1
    v_mfma_f32_16x16x32_bf16 a[56:59], v[136:139], v[204:207], a[56:59]
    s_add_u32 s3, s72, s3
    v_add_f32 v224, v224, v48
    v_add_f32_e64 v225, v225, v49
    v_mfma_f32_16x16x32_bf16 a[52:55], v[132:135], v[204:207], a[52:55]
    s_add_u32 s66, s32, 0
    v_add_f32_e64 v226, v226, v50
    v_add_f32 v227, v227, v51
    v_mfma_f32_16x16x32_bf16 a[48:51], v[128:131], v[204:207], a[48:51]
    s_and_b32 s66, s66, 3
    ds_read_b64_tr_b16 v[204:205], v9 offset:20480
    ds_read_b64_tr_b16 v[206:207], v9 offset:22528
    v_mfma_f32_16x16x32_bf16 a[64:67], v[128:131], v[208:211], a[64:67]
    s_add_u32 s79, s79, 4096
    buffer_load_dwordx4 v[176:179], v1, s[48:51], s79 offen sc1
    v_mfma_f32_16x16x32_bf16 a[68:71], v[132:135], v[208:211], a[68:71]
    s_mul_i32 s66, s66, 196608
    v_lshrrev_b32_e64 v52, 8, v1
    v_lshl_add_u32 v52, v52, 4, s35
    v_mfma_f32_16x16x32_bf16 a[72:75], v[136:139], v[208:211], a[72:75]
    s_add_u32 s66, s66, s3
    v_bfe_u32 v54, v1, 4, 4
    v_lshl_add_u32 v54, v54, 2, s35
    v_mfma_f32_16x16x32_bf16 a[76:79], v[140:143], v[208:211], a[76:79]
    s_add_u32 s67, s32, 1
    ds_read_b64_tr_b16 v[208:209], v10 offset:20480
    ds_read_b64_tr_b16 v[210:211], v10 offset:22528
    v_mfma_f32_16x16x32_bf16 a[92:95], v[140:143], v[212:215], a[92:95]
    s_add_u32 s80, s80, 4096
    buffer_load_dwordx4 v[180:183], v1, s[48:51], s80 offen sc1
    v_mfma_f32_16x16x32_bf16 a[88:91], v[136:139], v[212:215], a[88:91]
    s_and_b32 s67, s67, 3
    v_rcp_f32 v48, v224
    v_mfma_f32_16x16x32_bf16 a[84:87], v[132:135], v[212:215], a[84:87]
    s_mul_i32 s67, s67, 196608
    v_rcp_f32_e64 v49, v225
    v_mfma_f32_16x16x32_bf16 a[80:83], v[128:131], v[212:215], a[80:83]
    s_waitcnt lgkmcnt(2)
    s_add_u32 s67, s67, s3
    ds_read_b64_tr_b16 v[212:213], v11 offset:20480
    ds_read_b64_tr_b16 v[214:215], v11 offset:22528
    v_mfma_f32_16x16x32_bf16 a[96:99], v[128:131], v[192:195], a[96:99]
    s_add_u32 s78, s78, 12288
    s_add_u32 m0, s34, 98304
    s_nop 0
    buffer_load_dwordx4 v5, s[48:51], s78 offen sc1 lds
    v_mfma_f32_16x16x32_bf16 a[100:103], v[132:135], v[192:195], a[100:103]
    s_add_u32 s68, s32, 2
    v_rcp_f32 v50, v226
    v_mfma_f32_16x16x32_bf16 a[104:107], v[136:139], v[192:195], a[104:107]
    s_and_b32 s68, s68, 3
    v_rcp_f32_e64 v51, v227
    v_mfma_f32_16x16x32_bf16 a[108:111], v[140:143], v[192:195], a[108:111]
    s_mul_i32 s68, s68, 196608
    v_lshrrev_b32 v53, 1, v1
    v_lshrrev_b32 v55, 3, v1
    v_mfma_f32_16x16x32_bf16 a[124:127], v[140:143], v[196:199], a[124:127]
    buffer_load_dwordx4 v[184:187], v1, s[48:51], s79 offen offset:1024 sc1
    v_mfma_f32_16x16x32_bf16 a[120:123], v[136:139], v[196:199], a[120:123]
    s_add_u32 s68, s68, s3
    v_mul_f32 v14, -v14, v48
    v_mul_f32 v15, -v15, v49
    v_mfma_f32_16x16x32_bf16 a[116:119], v[132:135], v[196:199], a[116:119]
    s_add_u32 s69, s32, 3
    v_mul_f32 v56, -v56, v50
    v_mul_f32 v57, -v57, v51
    v_mfma_f32_16x16x32_bf16 a[112:115], v[128:131], v[196:199], a[112:115]
    s_and_b32 s69, s69, 3
    ds_write2_b32 v54, v48, v14 offset0:0 offset1:16
    ds_write2_b32 v54, v49, v15 offset0:32 offset1:48
    v_mfma_f32_16x16x32_bf16 a[128:131], v[128:131], v[200:203], a[128:131]
    buffer_load_dwordx4 v[188:191], v1, s[48:51], s80 offen offset:1024 sc1
    v_mfma_f32_16x16x32_bf16 a[132:135], v[132:135], v[200:203], a[132:135]
    s_mul_i32 s69, s69, 196608
    ds_write2_b32 v54, v50, v56 offset0:64 offset1:80
    ds_write2_b32 v54, v51, v57 offset0:96 offset1:112
    v_mfma_f32_16x16x32_bf16 a[136:139], v[136:139], v[200:203], a[136:139]
    s_add_u32 s69, s69, s3
    ds_read_b128 v[96:99], v52 offset:0
    ds_read_b128 v[112:115], v52 offset:64
    v_mfma_f32_16x16x32_bf16 a[140:143], v[140:143], v[200:203], a[140:143]
    ds_read_b128 v[100:103], v52 offset:128
    ds_read_b128 v[116:119], v52 offset:192
    v_mfma_f32_16x16x32_bf16 a[156:159], v[140:143], v[204:207], a[156:159]
    s_add_u32 m0, s34, 102272
    s_nop 0
    buffer_load_dwordx4 v5, s[48:51], s78 offen offset:128 sc1 lds
    v_mfma_f32_16x16x32_bf16 a[152:155], v[136:139], v[204:207], a[152:155]
    s_nop 0
    ds_read_b128 v[104:107], v52 offset:256
    ds_read_b128 v[120:123], v52 offset:320
    v_mfma_f32_16x16x32_bf16 a[148:151], v[132:135], v[204:207], a[148:151]
    ds_read_b128 v[108:111], v52 offset:384
    ds_read_b128 v[124:127], v52 offset:448
    v_mfma_f32_16x16x32_bf16 a[144:147], v[128:131], v[204:207], a[144:147]
    s_waitcnt lgkmcnt(8)
    v_and_b32 v55, 64, v55
    v_xor_b32_e64 v53, v53, v55
    v_mfma_f32_16x16x32_bf16 a[160:163], v[128:131], v[208:211], a[160:163]
    buffer_load_dwordx4 v[16:19], v1, s[48:51], s79 offen offset:2048 sc1
    v_mfma_f32_16x16x32_bf16 a[164:167], v[132:135], v[208:211], a[164:167]
    v_add_u32 v53, s35, v53
    v_lshrrev_b32 v54, 6, v1
    v_mfma_f32_16x16x32_bf16 a[168:171], v[136:139], v[208:211], a[168:171]
    v_lshlrev_b32_e64 v54, 3, v54
    v_lshlrev_b32_e64 v55, 1, v1
    v_mfma_f32_16x16x32_bf16 a[172:175], v[140:143], v[208:211], a[172:175]
    v_and_b32_e64 v55, 64, v55
    v_xor_b32_e64 v54, v54, v55
    v_mfma_f32_16x16x32_bf16 a[188:191], v[140:143], v[212:215], a[188:191]
    buffer_load_dwordx4 v[20:23], v1, s[48:51], s80 offen offset:2048 sc1
    v_mfma_f32_16x16x32_bf16 a[184:187], v[136:139], v[212:215], a[184:187]
    v_bfe_u32 v55, v1, 4, 2
    v_lshl_add_u32 v54, v55, 7, v54
    v_mfma_f32_16x16x32_bf16 a[180:183], v[132:135], v[212:215], a[180:183]
    v_add_u32 v54, s35, v54
    v_add_u32 v2, 4096, v1
    v_mfma_f32_16x16x32_bf16 a[176:179], v[128:131], v[212:215], a[176:179]
    s_add_u32 m0, s34, 106240
    s_nop 0
    buffer_load_dwordx4 v5, s[48:51], s78 offen offset:256 sc1 lds
    v_accvgpr_read_b32 v64, a0
    v_accvgpr_read_b32 v65, a1
    v_accvgpr_read_b32 v66, a2
    v_accvgpr_read_b32 v67, a3
    v_accvgpr_read_b32 v68, a16
    v_accvgpr_read_b32 v69, a17
    v_accvgpr_read_b32 v70, a18
    v_accvgpr_read_b32 v71, a19
    s_waitcnt lgkmcnt(0)
    v_pk_fma_f32 v[64:65], v[64:65], v[96:97], v[112:113]
    s_nop 0
    v_pk_fma_f32 v[66:67], v[66:67], v[98:99], v[114:115]
    v_pk_fma_f32 v[68:69], v[68:69], v[96:97], v[112:113]
    v_pk_fma_f32 v[70:71], v[70:71], v[98:99], v[114:115]
    buffer_load_dwordx4 v[24:27], v1, s[48:51], s79 offen offset:3072 sc1
    v_cvt_pk_bf16_f32 v80, v64, v65
    v_cvt_pk_bf16_f32 v81, v66, v67
    v_cvt_pk_bf16_f32 v82, v68, v69
    v_cvt_pk_bf16_f32 v83, v70, v71
    ds_write2st64_b64 v53, v[80:81], v[82:83] offset0:0 offset1:1
    v_accvgpr_read_b32 v72, a4
    v_accvgpr_read_b32 v73, a5
    v_accvgpr_read_b32 v74, a6
    v_accvgpr_read_b32 v75, a7
    v_accvgpr_read_b32 v76, a20
    v_accvgpr_read_b32 v77, a21
    v_accvgpr_read_b32 v78, a22
    v_accvgpr_read_b32 v79, a23
    buffer_load_dwordx4 v[28:31], v1, s[48:51], s80 offen offset:3072 sc1
    v_pk_fma_f32 v[72:73], v[72:73], v[100:101], v[116:117]
    v_pk_fma_f32 v[74:75], v[74:75], v[102:103], v[118:119]
    v_pk_fma_f32 v[76:77], v[76:77], v[100:101], v[116:117]
    v_pk_fma_f32 v[78:79], v[78:79], v[102:103], v[118:119]
    v_cvt_pk_bf16_f32 v84, v72, v73
    v_cvt_pk_bf16_f32 v85, v74, v75
    v_cvt_pk_bf16_f32 v86, v76, v77
    v_cvt_pk_bf16_f32 v87, v78, v79
    ds_read_b64_tr_b16 a[0:1], v54 offset:0
    ds_read_b64_tr_b16 a[2:3], v54 offset:512
    ds_write2st64_b64 v53, v[84:85], v[86:87] offset0:2 offset1:3
    v_accvgpr_read_b32 v64, a8
    v_accvgpr_read_b32 v65, a9
    s_add_u32 s78, s78, 12288
    s_add_u32 m0, s34, 110592
    s_nop 0
    buffer_load_dwordx4 v5, s[48:51], s78 offen sc1 lds
    v_accvgpr_read_b32 v66, a10
    v_accvgpr_read_b32 v67, a11
    v_accvgpr_read_b32 v68, a24
    v_accvgpr_read_b32 v69, a25
    v_accvgpr_read_b32 v70, a26
    v_accvgpr_read_b32 v71, a27
    v_pk_fma_f32 v[64:65], v[64:65], v[104:105], v[120:121]
    v_pk_fma_f32 v[66:67], v[66:67], v[106:107], v[122:123]
    v_pk_fma_f32 v[68:69], v[68:69], v[104:105], v[120:121]
    v_pk_fma_f32 v[70:71], v[70:71], v[106:107], v[122:123]
    v_cvt_pk_bf16_f32 v88, v64, v65
    v_cvt_pk_bf16_f32 v89, v66, v67
    s_waitcnt lgkmcnt(1)
    buffer_store_dwordx4 a[0:3], v1, s[48:51], s66 offen sc1
    v_cvt_pk_bf16_f32 v90, v68, v69
    v_cvt_pk_bf16_f32 v91, v70, v71
    ds_read_b64_tr_b16 a[4:5], v54 offset:1024
    ds_read_b64_tr_b16 a[6:7], v54 offset:1536
    ds_write2st64_b64 v53, v[88:89], v[90:91] offset0:4 offset1:5
    v_accvgpr_read_b32 v72, a12
    v_accvgpr_read_b32 v73, a13
    v_accvgpr_read_b32 v74, a14
    v_accvgpr_read_b32 v75, a15
    v_accvgpr_read_b32 v76, a28
    v_accvgpr_read_b32 v77, a29
    v_accvgpr_read_b32 v78, a30
    v_accvgpr_read_b32 v79, a31
    s_add_u32 s79, s79, 4096
    buffer_load_dwordx4 v[32:35], v1, s[48:51], s79 offen sc1
    v_pk_fma_f32 v[72:73], v[72:73], v[108:109], v[124:125]
    v_pk_fma_f32 v[74:75], v[74:75], v[110:111], v[126:127]
    v_pk_fma_f32 v[76:77], v[76:77], v[108:109], v[124:125]
    v_pk_fma_f32 v[78:79], v[78:79], v[110:111], v[126:127]
    v_cvt_pk_bf16_f32 v92, v72, v73
    v_cvt_pk_bf16_f32 v93, v74, v75
    v_cvt_pk_bf16_f32 v94, v76, v77
    v_cvt_pk_bf16_f32 v95, v78, v79
    ds_read_b64_tr_b16 a[8:9], v54 offset:2048
    ds_read_b64_tr_b16 a[10:11], v54 offset:2560
    ds_write2st64_b64 v53, v[92:93], v[94:95] offset0:6 offset1:7
    v_accvgpr_read_b32 v64, a32
    v_accvgpr_read_b32 v65, a33
    s_add_u32 s80, s80, 4096
    buffer_load_dwordx4 v[36:39], v1, s[48:51], s80 offen sc1
    v_accvgpr_read_b32 v66, a34
    v_accvgpr_read_b32 v67, a35
    v_accvgpr_read_b32 v68, a48
    v_accvgpr_read_b32 v69, a49
    v_accvgpr_read_b32 v70, a50
    v_accvgpr_read_b32 v71, a51
    v_pk_fma_f32 v[64:65], v[64:65], v[96:97], v[112:113]
    v_pk_fma_f32 v[66:67], v[66:67], v[98:99], v[114:115]
    v_pk_fma_f32 v[68:69], v[68:69], v[96:97], v[112:113]
    v_pk_fma_f32 v[70:71], v[70:71], v[98:99], v[114:115]
    v_cvt_pk_bf16_f32 v80, v64, v65
    v_cvt_pk_bf16_f32 v81, v66, v67
    s_add_u32 m0, s34, 114560
    s_nop 0
    s_nop 0
    buffer_load_dwordx4 v5, s[48:51], s78 offen offset:128 sc1 lds
    v_cvt_pk_bf16_f32 v82, v68, v69
    v_cvt_pk_bf16_f32 v83, v70, v71
    ds_read_b64_tr_b16 a[12:13], v54 offset:3072
    ds_read_b64_tr_b16 a[14:15], v54 offset:3584
    ds_write2st64_b64 v53, v[80:81], v[82:83] offset0:0 offset1:1
    v_accvgpr_read_b32 v72, a36
    v_accvgpr_read_b32 v73, a37
    v_accvgpr_read_b32 v74, a38
    v_accvgpr_read_b32 v75, a39
    v_accvgpr_read_b32 v76, a52
    v_accvgpr_read_b32 v77, a53
    v_accvgpr_read_b32 v78, a54
    v_accvgpr_read_b32 v79, a55
    s_waitcnt lgkmcnt(7)
    buffer_store_dwordx4 a[4:7], v1, s[48:51], s67 offen sc1
    s_nop 0
    v_pk_fma_f32 v[72:73], v[72:73], v[100:101], v[116:117]
    v_pk_fma_f32 v[74:75], v[74:75], v[102:103], v[118:119]
    v_pk_fma_f32 v[76:77], v[76:77], v[100:101], v[116:117]
    v_pk_fma_f32 v[78:79], v[78:79], v[102:103], v[118:119]
    v_cvt_pk_bf16_f32 v84, v72, v73
    v_cvt_pk_bf16_f32 v85, v74, v75
    v_cvt_pk_bf16_f32 v86, v76, v77
    v_cvt_pk_bf16_f32 v87, v78, v79
    ds_read_b64_tr_b16 a[32:33], v54 offset:0
    ds_read_b64_tr_b16 a[34:35], v54 offset:512
    ds_write2st64_b64 v53, v[84:85], v[86:87] offset0:2 offset1:3
    v_accvgpr_read_b32 v64, a40
    v_accvgpr_read_b32 v65, a41
    buffer_load_dwordx4 v[40:43], v1, s[48:51], s79 offen offset:1024 sc1
    v_accvgpr_read_b32 v66, a42
    v_accvgpr_read_b32 v67, a43
    v_accvgpr_read_b32 v68, a56
    v_accvgpr_read_b32 v69, a57
    v_accvgpr_read_b32 v70, a58
    v_accvgpr_read_b32 v71, a59
    v_pk_fma_f32 v[64:65], v[64:65], v[104:105], v[120:121]
    v_pk_fma_f32 v[66:67], v[66:67], v[106:107], v[122:123]
    v_pk_fma_f32 v[68:69], v[68:69], v[104:105], v[120:121]
    v_pk_fma_f32 v[70:71], v[70:71], v[106:107], v[122:123]
    v_cvt_pk_bf16_f32 v88, v64, v65
    v_cvt_pk_bf16_f32 v89, v66, v67
    buffer_load_dwordx4 v[44:47], v1, s[48:51], s80 offen offset:1024 sc1
    v_cvt_pk_bf16_f32 v90, v68, v69
    v_cvt_pk_bf16_f32 v91, v70, v71
    ds_read_b64_tr_b16 a[36:37], v54 offset:1024
    ds_read_b64_tr_b16 a[38:39], v54 offset:1536
    ds_write2st64_b64 v53, v[88:89], v[90:91] offset0:4 offset1:5
    v_accvgpr_read_b32 v72, a44
    v_accvgpr_read_b32 v73, a45
    v_accvgpr_read_b32 v74, a46
    v_accvgpr_read_b32 v75, a47
    v_accvgpr_read_b32 v76, a60
    v_accvgpr_read_b32 v77, a61
    v_accvgpr_read_b32 v78, a62
    v_accvgpr_read_b32 v79, a63
    s_add_u32 m0, s34, 118528
    s_nop 0
    buffer_load_dwordx4 v5, s[48:51], s78 offen offset:256 sc1 lds
    v_pk_fma_f32 v[72:73], v[72:73], v[108:109], v[124:125]
    s_nop 0
    v_pk_fma_f32 v[74:75], v[74:75], v[110:111], v[126:127]
    v_pk_fma_f32 v[76:77], v[76:77], v[108:109], v[124:125]
    v_pk_fma_f32 v[78:79], v[78:79], v[110:111], v[126:127]
    v_cvt_pk_bf16_f32 v92, v72, v73
    v_cvt_pk_bf16_f32 v93, v74, v75
    v_cvt_pk_bf16_f32 v94, v76, v77
    v_cvt_pk_bf16_f32 v95, v78, v79
    ds_read_b64_tr_b16 a[40:41], v54 offset:2048
    ds_read_b64_tr_b16 a[42:43], v54 offset:2560
    ds_write2st64_b64 v53, v[92:93], v[94:95] offset0:6 offset1:7
    v_accvgpr_read_b32 v64, a64
    v_accvgpr_read_b32 v65, a65
    buffer_load_dwordx4 a[192:195], v1, s[48:51], s79 offen offset:2048 sc1
    v_accvgpr_read_b32 v66, a66
    v_accvgpr_read_b32 v67, a67
    v_accvgpr_read_b32 v68, a80
    v_accvgpr_read_b32 v69, a81
    v_accvgpr_read_b32 v70, a82
    v_accvgpr_read_b32 v71, a83
    v_pk_fma_f32 v[64:65], v[64:65], v[96:97], v[112:113]
    v_pk_fma_f32 v[66:67], v[66:67], v[98:99], v[114:115]
    v_pk_fma_f32 v[68:69], v[68:69], v[96:97], v[112:113]
    v_pk_fma_f32 v[70:71], v[70:71], v[98:99], v[114:115]
    v_cvt_pk_bf16_f32 v80, v64, v65
    v_cvt_pk_bf16_f32 v81, v66, v67
    s_waitcnt lgkmcnt(13)
    buffer_store_dwordx4 a[8:11], v1, s[48:51], s68 offen sc1
    v_cvt_pk_bf16_f32 v82, v68, v69
    s_nop 0
    v_cvt_pk_bf16_f32 v83, v70, v71
    ds_read_b64_tr_b16 a[44:45], v54 offset:3072
    ds_read_b64_tr_b16 a[46:47], v54 offset:3584
    ds_write2st64_b64 v53, v[80:81], v[82:83] offset0:0 offset1:1
    v_accvgpr_read_b32 v72, a68
    v_accvgpr_read_b32 v73, a69
    v_accvgpr_read_b32 v74, a70
    v_accvgpr_read_b32 v75, a71
    v_accvgpr_read_b32 v76, a84
    v_accvgpr_read_b32 v77, a85
    v_accvgpr_read_b32 v78, a86
    v_accvgpr_read_b32 v79, a87
    buffer_load_dwordx4 a[196:199], v1, s[48:51], s80 offen offset:2048 sc1
    v_pk_fma_f32 v[72:73], v[72:73], v[100:101], v[116:117]
    v_pk_fma_f32 v[74:75], v[74:75], v[102:103], v[118:119]
    v_pk_fma_f32 v[76:77], v[76:77], v[100:101], v[116:117]
    v_pk_fma_f32 v[78:79], v[78:79], v[102:103], v[118:119]
    v_cvt_pk_bf16_f32 v84, v72, v73
    v_cvt_pk_bf16_f32 v85, v74, v75
    v_cvt_pk_bf16_f32 v86, v76, v77
    v_cvt_pk_bf16_f32 v87, v78, v79
    ds_read_b64_tr_b16 a[64:65], v54 offset:0
    ds_read_b64_tr_b16 a[66:67], v54 offset:512
    ds_write2st64_b64 v53, v[84:85], v[86:87] offset0:2 offset1:3
    v_accvgpr_read_b32 v64, a72
    v_accvgpr_read_b32 v65, a73
    s_add_u32 s78, s78, 12288
    s_add_u32 m0, s34, 122880
    s_nop 0
    s_nop 0
    buffer_load_dwordx4 v5, s[48:51], s78 offen sc1 lds
    v_accvgpr_read_b32 v66, a74
    v_accvgpr_read_b32 v67, a75
    v_accvgpr_read_b32 v68, a88
    v_accvgpr_read_b32 v69, a89
    v_accvgpr_read_b32 v70, a90
    v_accvgpr_read_b32 v71, a91
    v_pk_fma_f32 v[64:65], v[64:65], v[104:105], v[120:121]
    v_pk_fma_f32 v[66:67], v[66:67], v[106:107], v[122:123]
    v_pk_fma_f32 v[68:69], v[68:69], v[104:105], v[120:121]
    v_pk_fma_f32 v[70:71], v[70:71], v[106:107], v[122:123]
    v_cvt_pk_bf16_f32 v88, v64, v65
    v_cvt_pk_bf16_f32 v89, v66, v67
    buffer_load_dwordx4 a[200:203], v1, s[48:51], s79 offen offset:3072 sc1
    v_cvt_pk_bf16_f32 v90, v68, v69
    v_cvt_pk_bf16_f32 v91, v70, v71
    ds_read_b64_tr_b16 a[68:69], v54 offset:1024
    ds_read_b64_tr_b16 a[70:71], v54 offset:1536
    ds_write2st64_b64 v53, v[88:89], v[90:91] offset0:4 offset1:5
    v_accvgpr_read_b32 v72, a76
    v_accvgpr_read_b32 v73, a77
    v_accvgpr_read_b32 v74, a78
    v_accvgpr_read_b32 v75, a79
    v_accvgpr_read_b32 v76, a92
    v_accvgpr_read_b32 v77, a93
    v_accvgpr_read_b32 v78, a94
    v_accvgpr_read_b32 v79, a95
    s_nop 0
    s_waitcnt lgkmcnt(15)
    buffer_store_dwordx4 a[12:15], v1, s[48:51], s69 offen sc1
    v_pk_fma_f32 v[72:73], v[72:73], v[108:109], v[124:125]
    v_pk_fma_f32 v[74:75], v[74:75], v[110:111], v[126:127]
    v_pk_fma_f32 v[76:77], v[76:77], v[108:109], v[124:125]
    v_pk_fma_f32 v[78:79], v[78:79], v[110:111], v[126:127]
    v_cvt_pk_bf16_f32 v92, v72, v73
    v_cvt_pk_bf16_f32 v93, v74, v75
    v_cvt_pk_bf16_f32 v94, v76, v77
    v_cvt_pk_bf16_f32 v95, v78, v79
    ds_read_b64_tr_b16 a[72:73], v54 offset:2048
    ds_read_b64_tr_b16 a[74:75], v54 offset:2560
    ds_write2st64_b64 v53, v[92:93], v[94:95] offset0:6 offset1:7
    v_accvgpr_read_b32 v64, a96
    v_accvgpr_read_b32 v65, a97
    buffer_load_dwordx4 a[204:207], v1, s[48:51], s80 offen offset:3072 sc1
    v_accvgpr_read_b32 v66, a98
    v_accvgpr_read_b32 v67, a99
    v_accvgpr_read_b32 v68, a112
    v_accvgpr_read_b32 v69, a113
    v_accvgpr_read_b32 v70, a114
    v_accvgpr_read_b32 v71, a115
    v_pk_fma_f32 v[64:65], v[64:65], v[96:97], v[112:113]
    v_pk_fma_f32 v[66:67], v[66:67], v[98:99], v[114:115]
    v_pk_fma_f32 v[68:69], v[68:69], v[96:97], v[112:113]
    v_pk_fma_f32 v[70:71], v[70:71], v[98:99], v[114:115]
    v_cvt_pk_bf16_f32 v80, v64, v65
    v_cvt_pk_bf16_f32 v81, v66, v67
    s_add_u32 m0, s34, 126848
    s_nop 0
    buffer_load_dwordx4 v5, s[48:51], s78 offen offset:128 sc1 lds
    v_cvt_pk_bf16_f32 v82, v68, v69
    s_nop 0
    v_cvt_pk_bf16_f32 v83, v70, v71
    ds_read_b64_tr_b16 a[76:77], v54 offset:3072
    ds_read_b64_tr_b16 a[78:79], v54 offset:3584
    ds_write2st64_b64 v53, v[80:81], v[82:83] offset0:0 offset1:1
    v_accvgpr_read_b32 v72, a100
    v_accvgpr_read_b32 v73, a101
    v_accvgpr_read_b32 v74, a102
    v_accvgpr_read_b32 v75, a103
    v_accvgpr_read_b32 v76, a116
    v_accvgpr_read_b32 v77, a117
    v_accvgpr_read_b32 v78, a118
    v_accvgpr_read_b32 v79, a119
    s_add_u32 s79, s79, 4096
    buffer_load_dwordx4 a[208:211], v1, s[48:51], s79 offen sc1
    v_pk_fma_f32 v[72:73], v[72:73], v[100:101], v[116:117]
    v_pk_fma_f32 v[74:75], v[74:75], v[102:103], v[118:119]
    v_pk_fma_f32 v[76:77], v[76:77], v[100:101], v[116:117]
    v_pk_fma_f32 v[78:79], v[78:79], v[102:103], v[118:119]
    v_cvt_pk_bf16_f32 v84, v72, v73
    v_cvt_pk_bf16_f32 v85, v74, v75
    v_cvt_pk_bf16_f32 v86, v76, v77
    v_cvt_pk_bf16_f32 v87, v78, v79
    ds_read_b64_tr_b16 a[96:97], v54 offset:0
    ds_read_b64_tr_b16 a[98:99], v54 offset:512
    ds_write2st64_b64 v53, v[84:85], v[86:87] offset0:2 offset1:3
    v_accvgpr_read_b32 v64, a104
    v_accvgpr_read_b32 v65, a105
    s_add_u32 s80, s80, 4096
    buffer_load_dwordx4 a[212:215], v1, s[48:51], s80 offen sc1
    v_accvgpr_read_b32 v66, a106
    v_accvgpr_read_b32 v67, a107
    v_accvgpr_read_b32 v68, a120
    v_accvgpr_read_b32 v69, a121
    v_accvgpr_read_b32 v70, a122
    v_accvgpr_read_b32 v71, a123
    v_pk_fma_f32 v[64:65], v[64:65], v[104:105], v[120:121]
    v_pk_fma_f32 v[66:67], v[66:67], v[106:107], v[122:123]
    v_pk_fma_f32 v[68:69], v[68:69], v[104:105], v[120:121]
    v_pk_fma_f32 v[70:71], v[70:71], v[106:107], v[122:123]
    v_cvt_pk_bf16_f32 v88, v64, v65
    v_cvt_pk_bf16_f32 v89, v66, v67
    buffer_store_dwordx4 a[32:35], v1, s[48:51], s66 offen offset:1024 sc1
    v_cvt_pk_bf16_f32 v90, v68, v69
    v_cvt_pk_bf16_f32 v91, v70, v71
    ds_read_b64_tr_b16 a[100:101], v54 offset:1024
    ds_read_b64_tr_b16 a[102:103], v54 offset:1536
    ds_write2st64_b64 v53, v[88:89], v[90:91] offset0:4 offset1:5
    v_accvgpr_read_b32 v72, a108
    v_accvgpr_read_b32 v73, a109
    v_accvgpr_read_b32 v74, a110
    v_accvgpr_read_b32 v75, a111
    v_accvgpr_read_b32 v76, a124
    v_accvgpr_read_b32 v77, a125
    v_accvgpr_read_b32 v78, a126
    v_accvgpr_read_b32 v79, a127
    s_add_u32 m0, s34, 130816
    s_nop 0
    s_nop 0
    buffer_load_dwordx4 v5, s[48:51], s78 offen offset:256 sc1 lds
    v_pk_fma_f32 v[72:73], v[72:73], v[108:109], v[124:125]
    v_pk_fma_f32 v[74:75], v[74:75], v[110:111], v[126:127]
    v_pk_fma_f32 v[76:77], v[76:77], v[108:109], v[124:125]
    v_pk_fma_f32 v[78:79], v[78:79], v[110:111], v[126:127]
    v_cvt_pk_bf16_f32 v92, v72, v73
    v_cvt_pk_bf16_f32 v93, v74, v75
    v_cvt_pk_bf16_f32 v94, v76, v77
    v_cvt_pk_bf16_f32 v95, v78, v79
    ds_read_b64_tr_b16 a[104:105], v54 offset:2048
    ds_read_b64_tr_b16 a[106:107], v54 offset:2560
    ds_write2st64_b64 v53, v[92:93], v[94:95] offset0:6 offset1:7
    v_accvgpr_read_b32 v64, a128
    v_accvgpr_read_b32 v65, a129
    buffer_load_dwordx4 a[216:219], v1, s[48:51], s79 offen offset:1024 sc1
    v_accvgpr_read_b32 v66, a130
    v_accvgpr_read_b32 v67, a131
    v_accvgpr_read_b32 v68, a144
    v_accvgpr_read_b32 v69, a145
    v_accvgpr_read_b32 v70, a146
    v_accvgpr_read_b32 v71, a147
    v_pk_fma_f32 v[64:65], v[64:65], v[96:97], v[112:113]
    v_pk_fma_f32 v[66:67], v[66:67], v[98:99], v[114:115]
    v_pk_fma_f32 v[68:69], v[68:69], v[96:97], v[112:113]
    v_pk_fma_f32 v[70:71], v[70:71], v[98:99], v[114:115]
    v_cvt_pk_bf16_f32 v80, v64, v65
    v_cvt_pk_bf16_f32 v81, v66, v67
    buffer_load_dwordx4 a[220:223], v1, s[48:51], s80 offen offset:1024 sc1
    v_cvt_pk_bf16_f32 v82, v68, v69
    v_cvt_pk_bf16_f32 v83, v70, v71
    ds_read_b64_tr_b16 a[108:109], v54 offset:3072
    ds_read_b64_tr_b16 a[110:111], v54 offset:3584
    ds_write2st64_b64 v53, v[80:81], v[82:83] offset0:0 offset1:1
    v_accvgpr_read_b32 v72, a132
    v_accvgpr_read_b32 v73, a133
    v_accvgpr_read_b32 v74, a134
    v_accvgpr_read_b32 v75, a135
    v_accvgpr_read_b32 v76, a148
    v_accvgpr_read_b32 v77, a149
    v_accvgpr_read_b32 v78, a150
    v_accvgpr_read_b32 v79, a151
    s_waitcnt lgkmcnt(15)
    buffer_store_dwordx4 a[36:39], v1, s[48:51], s67 offen offset:1024 sc1
    s_nop 0
    v_pk_fma_f32 v[72:73], v[72:73], v[100:101], v[116:117]
    v_pk_fma_f32 v[74:75], v[74:75], v[102:103], v[118:119]
    v_pk_fma_f32 v[76:77], v[76:77], v[100:101], v[116:117]
    v_pk_fma_f32 v[78:79], v[78:79], v[102:103], v[118:119]
    v_cvt_pk_bf16_f32 v84, v72, v73
    v_cvt_pk_bf16_f32 v85, v74, v75
    v_cvt_pk_bf16_f32 v86, v76, v77
    v_cvt_pk_bf16_f32 v87, v78, v79
    ds_read_b64_tr_b16 a[128:129], v54 offset:0
    ds_read_b64_tr_b16 a[130:131], v54 offset:512
    ds_write2st64_b64 v53, v[84:85], v[86:87] offset0:2 offset1:3
    v_accvgpr_read_b32 v64, a136
    v_accvgpr_read_b32 v65, a137
    s_add_u32 s78, s78, 12288
    s_add_u32 m0, s34, 135168
    s_nop 0
    s_nop 0
    buffer_load_dwordx4 v5, s[48:51], s78 offen sc1 lds
    v_accvgpr_read_b32 v66, a138
    v_accvgpr_read_b32 v67, a139
    v_accvgpr_read_b32 v68, a152
    v_accvgpr_read_b32 v69, a153
    v_accvgpr_read_b32 v70, a154
    v_accvgpr_read_b32 v71, a155
    v_pk_fma_f32 v[64:65], v[64:65], v[104:105], v[120:121]
    v_pk_fma_f32 v[66:67], v[66:67], v[106:107], v[122:123]
    v_pk_fma_f32 v[68:69], v[68:69], v[104:105], v[120:121]
    v_pk_fma_f32 v[70:71], v[70:71], v[106:107], v[122:123]
    v_cvt_pk_bf16_f32 v88, v64, v65
    v_cvt_pk_bf16_f32 v89, v66, v67
    buffer_load_dwordx4 a[224:227], v1, s[48:51], s79 offen offset:2048 sc1
    v_cvt_pk_bf16_f32 v90, v68, v69
    v_cvt_pk_bf16_f32 v91, v70, v71
    ds_read_b64_tr_b16 a[132:133], v54 offset:1024
    ds_read_b64_tr_b16 a[134:135], v54 offset:1536
    ds_write2st64_b64 v53, v[88:89], v[90:91] offset0:4 offset1:5
    v_accvgpr_read_b32 v72, a140
    v_accvgpr_read_b32 v73, a141
    v_accvgpr_read_b32 v74, a142
    v_accvgpr_read_b32 v75, a143
    v_accvgpr_read_b32 v76, a156
    v_accvgpr_read_b32 v77, a157
    v_accvgpr_read_b32 v78, a158
    v_accvgpr_read_b32 v79, a159
    buffer_load_dwordx4 a[228:231], v1, s[48:51], s80 offen offset:2048 sc1
    v_pk_fma_f32 v[72:73], v[72:73], v[108:109], v[124:125]
    v_pk_fma_f32 v[74:75], v[74:75], v[110:111], v[126:127]
    v_pk_fma_f32 v[76:77], v[76:77], v[108:109], v[124:125]
    v_pk_fma_f32 v[78:79], v[78:79], v[110:111], v[126:127]
    v_cvt_pk_bf16_f32 v92, v72, v73
    v_cvt_pk_bf16_f32 v93, v74, v75
    v_cvt_pk_bf16_f32 v94, v76, v77
    v_cvt_pk_bf16_f32 v95, v78, v79
    ds_read_b64_tr_b16 a[136:137], v54 offset:2048
    ds_read_b64_tr_b16 a[138:139], v54 offset:2560
    ds_write2st64_b64 v53, v[92:93], v[94:95] offset0:6 offset1:7
    v_accvgpr_read_b32 v64, a160
    v_accvgpr_read_b32 v65, a161
    s_waitcnt vmcnt(40)
    s_add_u32 m0, s34, 139136
    s_nop 0
    buffer_load_dwordx4 v5, s[48:51], s78 offen offset:128 sc1 lds
    v_accvgpr_read_b32 v66, a162
    v_accvgpr_read_b32 v67, a163
    v_accvgpr_read_b32 v68, a176
    v_accvgpr_read_b32 v69, a177
    v_accvgpr_read_b32 v70, a178
    v_accvgpr_read_b32 v71, a179
    v_pk_fma_f32 v[64:65], v[64:65], v[96:97], v[112:113]
    v_pk_fma_f32 v[66:67], v[66:67], v[98:99], v[114:115]
    v_pk_fma_f32 v[68:69], v[68:69], v[96:97], v[112:113]
    v_pk_fma_f32 v[70:71], v[70:71], v[98:99], v[114:115]
    v_cvt_pk_bf16_f32 v80, v64, v65
    v_cvt_pk_bf16_f32 v81, v66, v67
    buffer_store_dwordx4 a[40:43], v1, s[48:51], s68 offen offset:1024 sc1
    v_cvt_pk_bf16_f32 v82, v68, v69
    v_cvt_pk_bf16_f32 v83, v70, v71
    ds_read_b64_tr_b16 a[140:141], v54 offset:3072
    ds_read_b64_tr_b16 a[142:143], v54 offset:3584
    ds_write2st64_b64 v53, v[80:81], v[82:83] offset0:0 offset1:1
    v_accvgpr_read_b32 v72, a164
    v_accvgpr_read_b32 v73, a165
    v_accvgpr_read_b32 v74, a166
    v_accvgpr_read_b32 v75, a167
    v_accvgpr_read_b32 v76, a180
    v_accvgpr_read_b32 v77, a181
    v_accvgpr_read_b32 v78, a182
    v_accvgpr_read_b32 v79, a183
    buffer_load_dwordx4 a[232:235], v1, s[48:51], s79 offen offset:3072 sc1
    v_pk_fma_f32 v[72:73], v[72:73], v[100:101], v[116:117]
    v_pk_fma_f32 v[74:75], v[74:75], v[102:103], v[118:119]
    v_pk_fma_f32 v[76:77], v[76:77], v[100:101], v[116:117]
    v_pk_fma_f32 v[78:79], v[78:79], v[102:103], v[118:119]
    v_cvt_pk_bf16_f32 v84, v72, v73
    v_cvt_pk_bf16_f32 v85, v74, v75
    v_cvt_pk_bf16_f32 v86, v76, v77
    v_cvt_pk_bf16_f32 v87, v78, v79
    ds_read_b64_tr_b16 a[160:161], v54 offset:0
    ds_read_b64_tr_b16 a[162:163], v54 offset:512
    ds_write2st64_b64 v53, v[84:85], v[86:87] offset0:2 offset1:3
    v_accvgpr_read_b32 v64, a168
    v_accvgpr_read_b32 v65, a169
    buffer_load_dwordx4 a[236:239], v1, s[48:51], s80 offen offset:3072 sc1
    v_accvgpr_read_b32 v66, a170
    v_accvgpr_read_b32 v67, a171
    v_accvgpr_read_b32 v68, a184
    v_accvgpr_read_b32 v69, a185
    v_accvgpr_read_b32 v70, a186
    v_accvgpr_read_b32 v71, a187
    v_pk_fma_f32 v[64:65], v[64:65], v[104:105], v[120:121]
    v_pk_fma_f32 v[66:67], v[66:67], v[106:107], v[122:123]
    v_pk_fma_f32 v[68:69], v[68:69], v[104:105], v[120:121]
    v_pk_fma_f32 v[70:71], v[70:71], v[106:107], v[122:123]
    v_cvt_pk_bf16_f32 v88, v64, v65
    v_cvt_pk_bf16_f32 v89, v66, v67
    s_add_u32 m0, s34, 143104
    s_nop 0
    buffer_load_dwordx4 v5, s[48:51], s78 offen offset:256 sc1 lds
    s_nop 0
    v_cvt_pk_bf16_f32 v90, v68, v69
    v_cvt_pk_bf16_f32 v91, v70, v71
    ds_read_b64_tr_b16 a[164:165], v54 offset:1024
    ds_read_b64_tr_b16 a[166:167], v54 offset:1536
    ds_write2st64_b64 v53, v[88:89], v[90:91] offset0:4 offset1:5
    v_accvgpr_read_b32 v72, a172
    v_accvgpr_read_b32 v73, a173
    v_accvgpr_read_b32 v74, a174
    v_accvgpr_read_b32 v75, a175
    v_accvgpr_read_b32 v76, a188
    v_accvgpr_read_b32 v77, a189
    v_accvgpr_read_b32 v78, a190
    v_accvgpr_read_b32 v79, a191
    buffer_store_dwordx4 a[44:47], v1, s[48:51], s69 offen offset:1024 sc1
    v_pk_fma_f32 v[72:73], v[72:73], v[108:109], v[124:125]
    v_pk_fma_f32 v[74:75], v[74:75], v[110:111], v[126:127]
    v_pk_fma_f32 v[76:77], v[76:77], v[108:109], v[124:125]
    v_pk_fma_f32 v[78:79], v[78:79], v[110:111], v[126:127]
    v_cvt_pk_bf16_f32 v92, v72, v73
    v_cvt_pk_bf16_f32 v93, v74, v75
    v_cvt_pk_bf16_f32 v94, v76, v77
    v_cvt_pk_bf16_f32 v95, v78, v79
    ds_read_b64_tr_b16 a[168:169], v54 offset:2048
    ds_read_b64_tr_b16 a[170:171], v54 offset:2560
    ds_write2st64_b64 v53, v[92:93], v[94:95] offset0:6 offset1:7
    ds_read_b64_tr_b16 a[172:173], v54 offset:3072
    ds_read_b64_tr_b16 a[174:175], v54 offset:3584
    s_lshl_b32 s70, s31, 2
    s_add_u32 s70, s70, s32
    s_mul_i32 s70, s70, 245760
    s_add_u32 s70, s70, 87818240
    s_lshl_b32 s3, s33, 3
    s_add_u32 s3, s3, s31
    s_lshl_b32 s71, s3, 8
    s_add_u32 s71, s71, 79699968
    v_lshrrev_b32 v14, 6, v1
    v_mul_u32_u24 v14, 320, v14
    v_bfe_u32 v15, v1, 4, 2
    v_lshl_add_u32 v8, v15, 3, v14
    v_bfe_u32 v15, v1, 8, 1
    v_lshlrev_b32 v15, 5, v15
    v_xor_b32 v14, 32, v15
    v_add_u32_e64 v9, v8, v14
    v_add_u32_e64 v8, v8, v15
    v_add_u32 v10, 40960, v8
    v_add_u32 v11, 40960, v9
    v_add_u32 v12, 81920, v8
    v_add_u32 v13, 81920, v9
    s_add_u32 s3, s32, 0
    s_and_b32 s3, s3, 3
    s_mul_i32 s3, s3, 196608
    v_add_u32_e64 v60, s3, v1
    s_add_u32 s3, s32, 1
    s_and_b32 s3, s3, 3
    s_mul_i32 s3, s3, 196608
    v_add_u32_e64 v61, s3, v1
    s_add_u32 s3, s32, 2
    s_and_b32 s3, s3, 3
    s_mul_i32 s3, s3, 196608
    v_add_u32_e64 v62, s3, v1
    s_add_u32 s3, s32, 3
    s_and_b32 s3, s3, 3
    s_mul_i32 s3, s3, 196608
    v_add_u32_e64 v63, s3, v1
    v_mov_b32_e64 v4, 0
    s_waitcnt lgkmcnt(0)
    s_barrier
    ds_read_b64_tr_b16 v[192:193], v240 offset:0
    ds_read_b64_tr_b16 v[194:195], v240 offset:3072
    ds_read_b64_tr_b16 v[196:197], v240 offset:6144
    ds_read_b64_tr_b16 v[198:199], v240 offset:9216
    ds_read_b64_tr_b16 v[200:201], v241 offset:0
    ds_read_b64_tr_b16 v[202:203], v241 offset:3072
    ds_read_b64_tr_b16 v[204:205], v241 offset:6144
    ds_read_b64_tr_b16 v[206:207], v241 offset:9216
    ds_read_b64_tr_b16 v[208:209], v240 offset:64
    ds_read_b64_tr_b16 v[210:211], v240 offset:3136
    ds_read_b64_tr_b16 v[212:213], v240 offset:6208
    ds_read_b64_tr_b16 v[214:215], v240 offset:9280
    s_waitcnt lgkmcnt(10)
    v_mfma_f32_16x16x32_bf16 v[64:67], v[192:195], v[144:147], 0
    s_waitcnt lgkmcnt(8)
    s_add_u32 s79, s79, 4096
    v_mfma_f32_16x16x32_bf16 v[64:67], v[196:199], v[152:155], v[64:67]
    buffer_load_dwordx4 a[240:243], v1, s[48:51], s79 offen sc1
    v_mfma_f32_16x16x32_bf16 v[68:71], v[196:199], v[156:159], 0
    ds_read_b64_tr_b16 v[216:217], v241 offset:64
    ds_read_b64_tr_b16 v[218:219], v241 offset:3136
    v_mfma_f32_16x16x32_bf16 v[68:71], v[192:195], v[148:151], v[68:71]
    s_waitcnt lgkmcnt(8)
    ds_read_b64_tr_b16 v[220:221], v241 offset:6208
    ds_read_b64_tr_b16 v[222:223], v241 offset:9280
    v_mfma_f32_16x16x32_bf16 v[76:79], v[200:203], v[148:151], 0
    s_waitcnt lgkmcnt(8)
    v_mfma_f32_16x16x32_bf16 v[76:79], v[204:207], v[156:159], v[76:79]
    v_mfma_f32_16x16x32_bf16 v[72:75], v[204:207], v[152:155], 0
    s_nop 0
    ds_read_b64_tr_b16 v[192:193], v240 offset:128
    ds_read_b64_tr_b16 v[194:195], v240 offset:3200
    v_mfma_f32_16x16x32_bf16 v[72:75], v[200:203], v[144:147], v[72:75]
    s_waitcnt lgkmcnt(6)
    ds_read_b64_tr_b16 v[196:197], v240 offset:6272
    ds_read_b64_tr_b16 v[198:199], v240 offset:9344
    v_mfma_f32_16x16x32_bf16 v[80:83], v[208:211], v[144:147], 0
    buffer_store_dwordx4 a[64:67], v1, s[48:51], s66 offen offset:2048 sc1
    v_mfma_f32_16x16x32_bf16 v[80:83], v[212:215], v[152:155], v[80:83]
    v_mfma_f32_16x16x32_bf16 v[84:87], v[212:215], v[156:159], 0
    ds_read_b64_tr_b16 v[200:201], v241 offset:128
    ds_read_b64_tr_b16 v[202:203], v241 offset:3200
    v_mfma_f32_16x16x32_bf16 v[84:87], v[208:211], v[148:151], v[84:87]
    s_waitcnt lgkmcnt(6)
    s_add_u32 s80, s80, 4096
    s_nop 0
    ds_read_b64_tr_b16 v[204:205], v241 offset:6272
    ds_read_b64_tr_b16 v[206:207], v241 offset:9344
    v_mfma_f32_16x16x32_bf16 v[92:95], v[216:219], v[148:151], 0
    buffer_load_dwordx4 a[244:247], v1, s[48:51], s80 offen sc1
    v_mfma_f32_16x16x32_bf16 v[92:95], v[220:223], v[156:159], v[92:95]
    s_nop 0
    v_mfma_f32_16x16x32_bf16 v[88:91], v[220:223], v[152:155], 0
    s_nop 0
    ds_read_b64_tr_b16 v[208:209], v240 offset:27648
    ds_read_b64_tr_b16 v[210:211], v240 offset:30720
    v_mfma_f32_16x16x32_bf16 v[88:91], v[216:219], v[144:147], v[88:91]
    s_waitcnt lgkmcnt(6)
    ds_read_b64_tr_b16 v[212:213], v240 offset:33792
    s_nop 0
    ds_read_b64_tr_b16 v[214:215], v240 offset:49152
    v_mfma_f32_16x16x32_bf16 v[96:99], v[192:195], v[144:147], 0
    v_mfma_f32_16x16x32_bf16 v[96:99], v[196:199], v[152:155], v[96:99]
    buffer_store_dwordx4 a[68:71], v1, s[48:51], s67 offen offset:2048 sc1
    v_mfma_f32_16x16x32_bf16 v[100:103], v[196:199], v[156:159], 0
    s_nop 0
    ds_read_b64_tr_b16 v[216:217], v241 offset:27648
    ds_read_b64_tr_b16 v[218:219], v241 offset:30720
    v_mfma_f32_16x16x32_bf16 v[100:103], v[192:195], v[148:151], v[100:103]
    s_waitcnt lgkmcnt(6)
    ds_read_b64_tr_b16 v[220:221], v241 offset:33792
    ds_read_b64_tr_b16 v[222:223], v241 offset:49152
    v_mfma_f32_16x16x32_bf16 v[108:111], v[200:203], v[148:151], 0
    v_mfma_f32_16x16x32_bf16 v[108:111], v[204:207], v[156:159], v[108:111]
    v_mfma_f32_16x16x32_bf16 v[104:107], v[204:207], v[152:155], 0
    ds_read_b64_tr_b16 v[192:193], v240 offset:27712
    ds_read_b64_tr_b16 v[194:195], v240 offset:30784
    v_mfma_f32_16x16x32_bf16 v[104:107], v[200:203], v[144:147], v[104:107]
    s_waitcnt lgkmcnt(6)
    ds_read_b64_tr_b16 v[196:197], v240 offset:33856
    ds_read_b64_tr_b16 v[198:199], v240 offset:49216
    v_mfma_f32_16x16x32_bf16 v[64:67], v[208:211], v[160:163], v[64:67]
    s_waitcnt vmcnt(49)
    buffer_load_dwordx4 a[248:251], v1, s[48:51], s79 offen offset:1024 sc1
    v_mfma_f32_16x16x32_bf16 v[64:67], v[212:215], v[168:171], v[64:67]
    s_waitcnt vmcnt(49)
    v_mfma_f32_16x16x32_bf16 v[68:71], v[212:215], v[172:175], v[68:71]
    ds_read_b64_tr_b16 v[200:201], v241 offset:27712
    ds_read_b64_tr_b16 v[202:203], v241 offset:30784
    v_mfma_f32_16x16x32_bf16 v[68:71], v[208:211], v[164:167], v[68:71]
    s_waitcnt lgkmcnt(6)
    ds_read_b64_tr_b16 v[204:205], v241 offset:33856
    ds_read_b64_tr_b16 v[206:207], v241 offset:49216
    v_mfma_f32_16x16x32_bf16 v[76:79], v[216:219], v[164:167], v[76:79]
    buffer_store_dwordx4 a[72:75], v1, s[48:51], s68 offen offset:2048 sc1
    v_mfma_f32_16x16x32_bf16 v[76:79], v[220:223], v[172:175], v[76:79]
    v_mfma_f32_16x16x32_bf16 v[72:75], v[220:223], v[168:171], v[72:75]
    ds_read_b64_tr_b16 v[208:209], v240 offset:27776
    ds_read_b64_tr_b16 v[210:211], v240 offset:30848
    v_mfma_f32_16x16x32_bf16 v[72:75], v[216:219], v[160:163], v[72:75]
    s_waitcnt lgkmcnt(6)
    ds_read_b64_tr_b16 v[212:213], v240 offset:33920
    ds_read_b64_tr_b16 v[214:215], v240 offset:49280
    v_mfma_f32_16x16x32_bf16 v[80:83], v[192:195], v[160:163], v[80:83]
    s_nop 0
    v_mfma_f32_16x16x32_bf16 v[80:83], v[196:199], v[168:171], v[80:83]
    buffer_load_dwordx4 a[252:255], v1, s[48:51], s80 offen offset:1024 sc1
    v_mfma_f32_16x16x32_bf16 v[84:87], v[196:199], v[172:175], v[84:87]
    ds_read_b64_tr_b16 v[216:217], v241 offset:27776
    ds_read_b64_tr_b16 v[218:219], v241 offset:30848
    v_mfma_f32_16x16x32_bf16 v[84:87], v[192:195], v[164:167], v[84:87]
    s_waitcnt lgkmcnt(6)
    s_nop 0
    ds_read_b64_tr_b16 v[220:221], v241 offset:33920
    ds_read_b64_tr_b16 v[222:223], v241 offset:49280
    v_mfma_f32_16x16x32_bf16 v[92:95], v[200:203], v[164:167], v[92:95]
    v_mfma_f32_16x16x32_bf16 v[92:95], v[204:207], v[172:175], v[92:95]
    v_mfma_f32_16x16x32_bf16 v[88:91], v[204:207], v[168:171], v[88:91]
    s_nop 0
    ds_read_b64_tr_b16 v[192:193], v240 offset:24576
    ds_read_b64_tr_b16 v[194:195], v240 offset:52224
    v_mfma_f32_16x16x32_bf16 v[88:91], v[200:203], v[160:163], v[88:91]
    s_waitcnt lgkmcnt(6)
    ds_read_b64_tr_b16 v[196:197], v240 offset:55296
    ds_read_b64_tr_b16 v[198:199], v240 offset:58368
    v_mfma_f32_16x16x32_bf16 v[96:99], v[208:211], v[160:163], v[96:99]
    buffer_store_dwordx4 a[76:79], v1, s[48:51], s69 offen offset:2048 sc1
    v_mfma_f32_16x16x32_bf16 v[96:99], v[212:215], v[168:171], v[96:99]
    s_nop 0
    v_mfma_f32_16x16x32_bf16 v[100:103], v[212:215], v[172:175], v[100:103]
    s_nop 0
    ds_read_b64_tr_b16 v[200:201], v241 offset:24576
    ds_read_b64_tr_b16 v[202:203], v241 offset:52224
    v_mfma_f32_16x16x32_bf16 v[100:103], v[208:211], v[164:167], v[100:103]
    s_waitcnt lgkmcnt(6)
    s_nop 0
    ds_read_b64_tr_b16 v[204:205], v241 offset:55296
    ds_read_b64_tr_b16 v[206:207], v241 offset:58368
    v_mfma_f32_16x16x32_bf16 v[108:111], v[216:219], v[164:167], v[108:111]
    buffer_load_dwordx4 v[112:115], v1, s[48:51], s79 offen offset:2048 sc1
    v_mfma_f32_16x16x32_bf16 v[108:111], v[220:223], v[172:175], v[108:111]
    v_mfma_f32_16x16x32_bf16 v[104:107], v[220:223], v[168:171], v[104:107]
    ds_read_b64_tr_b16 v[208:209], v240 offset:24640
    ds_read_b64_tr_b16 v[210:211], v240 offset:52288
    v_mfma_f32_16x16x32_bf16 v[104:107], v[216:219], v[160:163], v[104:107]
    s_waitcnt vmcnt(52) lgkmcnt(6)
    ds_read_b64_tr_b16 v[212:213], v240 offset:55360
    ds_read_b64_tr_b16 v[214:215], v240 offset:58432
    v_mfma_f32_16x16x32_bf16 v[64:67], v[192:195], v[176:179], v[64:67]
    s_waitcnt vmcnt(49)
    v_mfma_f32_16x16x32_bf16 v[64:67], v[196:199], v[184:187], v[64:67]
    s_waitcnt vmcnt(48)
    buffer_store_dwordx4 a[96:99], v1, s[48:51], s66 offen offset:3072 sc1
    v_mfma_f32_16x16x32_bf16 v[68:71], v[196:199], v[188:191], v[68:71]
    ds_read_b64_tr_b16 v[216:217], v241 offset:24640
    ds_read_b64_tr_b16 v[218:219], v241 offset:52288
    v_mfma_f32_16x16x32_bf16 v[68:71], v[192:195], v[180:183], v[68:71]
    s_waitcnt lgkmcnt(6)
    ds_read_b64_tr_b16 v[220:221], v241 offset:55360
    ds_read_b64_tr_b16 v[222:223], v241 offset:58432
    v_mfma_f32_16x16x32_bf16 v[76:79], v[200:203], v[180:183], v[76:79]
    v_mfma_f32_16x16x32_bf16 v[76:79], v[204:207], v[188:191], v[76:79]
    v_mfma_f32_16x16x32_bf16 v[72:75], v[204:207], v[184:187], v[72:75]
    s_nop 0
    ds_read_b64_tr_b16 v[192:193], v240 offset:24704
    ds_read_b64_tr_b16 v[194:195], v240 offset:52352
    v_mfma_f32_16x16x32_bf16 v[72:75], v[200:203], v[176:179], v[72:75]
    s_waitcnt lgkmcnt(6)
    ds_read_b64_tr_b16 v[196:197], v240 offset:55424
    ds_read_b64_tr_b16 v[198:199], v240 offset:58496
    v_mfma_f32_16x16x32_bf16 v[80:83], v[208:211], v[176:179], v[80:83]
    buffer_load_dwordx4 v[116:119], v1, s[48:51], s80 offen offset:2048 sc1
    v_mfma_f32_16x16x32_bf16 v[80:83], v[212:215], v[184:187], v[80:83]
    s_nop 0
    v_mfma_f32_16x16x32_bf16 v[84:87], v[212:215], v[188:191], v[84:87]
    s_nop 0
    ds_read_b64_tr_b16 v[200:201], v241 offset:24704
    ds_read_b64_tr_b16 v[202:203], v241 offset:52352
    v_mfma_f32_16x16x32_bf16 v[84:87], v[208:211], v[180:183], v[84:87]
    s_waitcnt lgkmcnt(6)
    s_nop 0
    ds_read_b64_tr_b16 v[204:205], v241 offset:55424
    ds_read_b64_tr_b16 v[206:207], v241 offset:58496
    v_mfma_f32_16x16x32_bf16 v[92:95], v[216:219], v[180:183], v[92:95]
    buffer_store_dwordx4 a[100:103], v1, s[48:51], s67 offen offset:3072 sc1
    v_mfma_f32_16x16x32_bf16 v[92:95], v[220:223], v[188:191], v[92:95]
    v_mfma_f32_16x16x32_bf16 v[88:91], v[220:223], v[184:187], v[88:91]
    ds_read_b64_tr_b16 v[208:209], v242 offset:0
    ds_read_b64_tr_b16 v[210:211], v242 offset:3072
    v_mfma_f32_16x16x32_bf16 v[88:91], v[216:219], v[176:179], v[88:91]
    s_waitcnt lgkmcnt(6)
    ds_read_b64_tr_b16 v[212:213], v242 offset:9216
    ds_read_b64_tr_b16 v[214:215], v242 offset:12288
    v_mfma_f32_16x16x32_bf16 v[96:99], v[192:195], v[176:179], v[96:99]
    s_nop 0
    v_mfma_f32_16x16x32_bf16 v[96:99], v[196:199], v[184:187], v[96:99]
    s_nop 0
    v_mfma_f32_16x16x32_bf16 v[100:103], v[196:199], v[188:191], v[100:103]
    s_nop 0
    ds_read_b64_tr_b16 v[216:217], v243 offset:0
    ds_read_b64_tr_b16 v[218:219], v243 offset:3072
    v_mfma_f32_16x16x32_bf16 v[100:103], v[192:195], v[180:183], v[100:103]
    s_waitcnt lgkmcnt(6)
    s_nop 0
    ds_read_b64_tr_b16 v[220:221], v243 offset:9216
    ds_read_b64_tr_b16 v[222:223], v243 offset:12288
    v_mfma_f32_16x16x32_bf16 v[108:111], v[200:203], v[180:183], v[108:111]
    buffer_load_dwordx4 v[120:123], v1, s[48:51], s79 offen offset:3072 sc1
    v_mfma_f32_16x16x32_bf16 v[108:111], v[204:207], v[188:191], v[108:111]
    v_mfma_f32_16x16x32_bf16 v[104:107], v[204:207], v[184:187], v[104:107]
    ds_read_b64_tr_b16 v[192:193], v242 offset:64
    ds_read_b64_tr_b16 v[194:195], v242 offset:3136
    v_mfma_f32_16x16x32_bf16 v[104:107], v[200:203], v[176:179], v[104:107]
    s_waitcnt vmcnt(50) lgkmcnt(6)
    ds_read_b64_tr_b16 v[196:197], v242 offset:9280
    ds_read_b64_tr_b16 v[198:199], v242 offset:12352
    v_mfma_f32_16x16x32_bf16 v[64:67], v[208:211], v[16:19], v[64:67]
    s_waitcnt vmcnt(47)
    buffer_store_dwordx4 a[104:107], v1, s[48:51], s68 offen offset:3072 sc1
    v_mfma_f32_16x16x32_bf16 v[64:67], v[212:215], v[24:27], v[64:67]
    s_waitcnt vmcnt(47)
    v_mfma_f32_16x16x32_bf16 v[68:71], v[212:215], v[28:31], v[68:71]
    ds_read_b64_tr_b16 v[200:201], v243 offset:64
    ds_read_b64_tr_b16 v[202:203], v243 offset:3136
    v_mfma_f32_16x16x32_bf16 v[68:71], v[208:211], v[20:23], v[68:71]
    s_waitcnt lgkmcnt(6)
    ds_read_b64_tr_b16 v[204:205], v243 offset:9280
    ds_read_b64_tr_b16 v[206:207], v243 offset:12352
    v_mfma_f32_16x16x32_bf16 v[76:79], v[216:219], v[20:23], v[76:79]
    v_mfma_f32_16x16x32_bf16 v[76:79], v[220:223], v[28:31], v[76:79]
    buffer_load_dwordx4 v[124:127], v1, s[48:51], s80 offen offset:3072 sc1
    v_mfma_f32_16x16x32_bf16 v[72:75], v[220:223], v[24:27], v[72:75]
    ds_read_b64_tr_b16 v[208:209], v242 offset:128
    ds_read_b64_tr_b16 v[210:211], v242 offset:3200
    v_mfma_f32_16x16x32_bf16 v[72:75], v[216:219], v[16:19], v[72:75]
    s_waitcnt lgkmcnt(6)
    ds_read_b64_tr_b16 v[212:213], v242 offset:9344
    ds_read_b64_tr_b16 v[214:215], v242 offset:12416
    v_mfma_f32_16x16x32_bf16 v[80:83], v[192:195], v[16:19], v[80:83]
    s_nop 0
    v_mfma_f32_16x16x32_bf16 v[80:83], v[196:199], v[24:27], v[80:83]
    v_mfma_f32_16x16x32_bf16 v[84:87], v[196:199], v[28:31], v[84:87]
    ds_read_b64_tr_b16 v[216:217], v243 offset:128
    ds_read_b64_tr_b16 v[218:219], v243 offset:3200
    v_mfma_f32_16x16x32_bf16 v[84:87], v[192:195], v[20:23], v[84:87]
    s_waitcnt lgkmcnt(6)
    ds_read_b64_tr_b16 v[220:221], v243 offset:9344
    s_nop 0
    ds_read_b64_tr_b16 v[222:223], v243 offset:12416
    v_mfma_f32_16x16x32_bf16 v[92:95], v[200:203], v[20:23], v[92:95]
    buffer_store_dwordx4 a[108:111], v1, s[48:51], s69 offen offset:3072 sc1
    v_mfma_f32_16x16x32_bf16 v[92:95], v[204:207], v[28:31], v[92:95]
    v_mfma_f32_16x16x32_bf16 v[88:91], v[204:207], v[24:27], v[88:91]
    s_nop 0
    ds_read_b64_tr_b16 v[192:193], v242 offset:15360
    ds_read_b64_tr_b16 v[194:195], v242 offset:18432
    v_mfma_f32_16x16x32_bf16 v[88:91], v[200:203], v[16:19], v[88:91]
    s_waitcnt lgkmcnt(6)
    ds_read_b64_tr_b16 v[196:197], v242 offset:6144
    ds_read_b64_tr_b16 v[198:199], v242 offset:21504
    v_mfma_f32_16x16x32_bf16 v[96:99], v[208:211], v[16:19], v[96:99]
    v_mfma_f32_16x16x32_bf16 v[96:99], v[212:215], v[24:27], v[96:99]
    v_mfma_f32_16x16x32_bf16 v[100:103], v[212:215], v[28:31], v[100:103]
    ds_read_b64_tr_b16 v[200:201], v243 offset:15360
    ds_read_b64_tr_b16 v[202:203], v243 offset:18432
    v_mfma_f32_16x16x32_bf16 v[100:103], v[208:211], v[20:23], v[100:103]
    s_waitcnt lgkmcnt(6)
    ds_read_b64_tr_b16 v[204:205], v243 offset:6144
    ds_read_b64_tr_b16 v[206:207], v243 offset:21504
    v_mfma_f32_16x16x32_bf16 v[108:111], v[216:219], v[20:23], v[108:111]
    s_nop 0
    v_mfma_f32_16x16x32_bf16 v[108:111], v[220:223], v[28:31], v[108:111]
    v_mfma_f32_16x16x32_bf16 v[104:107], v[220:223], v[24:27], v[104:107]
    ds_read_b64_tr_b16 v[208:209], v242 offset:15424
    ds_read_b64_tr_b16 v[210:211], v242 offset:18496
    v_mfma_f32_16x16x32_bf16 v[104:107], v[216:219], v[16:19], v[104:107]
    s_waitcnt vmcnt(46) lgkmcnt(6)
    ds_read_b64_tr_b16 v[212:213], v242 offset:6208
    s_nop 0
    ds_read_b64_tr_b16 v[214:215], v242 offset:21568
    v_mfma_f32_16x16x32_bf16 v[64:67], v[192:195], v[32:35], v[64:67]
    s_waitcnt vmcnt(42)
    v_mfma_f32_16x16x32_bf16 v[64:67], v[196:199], v[40:43], v[64:67]
    s_waitcnt vmcnt(41)
    v_mfma_f32_16x16x32_bf16 v[68:71], v[196:199], v[44:47], v[68:71]
    s_nop 0
    ds_read_b64_tr_b16 v[216:217], v243 offset:15424
    ds_read_b64_tr_b16 v[218:219], v243 offset:18496
    v_mfma_f32_16x16x32_bf16 v[68:71], v[192:195], v[36:39], v[68:71]
    s_waitcnt lgkmcnt(6)
    ds_read_b64_tr_b16 v[220:221], v243 offset:6208
    ds_read_b64_tr_b16 v[222:223], v243 offset:21568
    v_mfma_f32_16x16x32_bf16 v[76:79], v[200:203], v[36:39], v[76:79]
    v_mfma_f32_16x16x32_bf16 v[76:79], v[204:207], v[44:47], v[76:79]
    v_mfma_f32_16x16x32_bf16 v[72:75], v[204:207], v[40:43], v[72:75]
    ds_read_b64_tr_b16 v[192:193], v242 offset:15488
    ds_read_b64_tr_b16 v[194:195], v242 offset:18560
    v_mfma_f32_16x16x32_bf16 v[72:75], v[200:203], v[32:35], v[72:75]
    s_waitcnt lgkmcnt(6)
    ds_read_b64_tr_b16 v[196:197], v242 offset:6272
    ds_read_b64_tr_b16 v[198:199], v242 offset:21632
    v_mfma_f32_16x16x32_bf16 v[80:83], v[208:211], v[32:35], v[80:83]
    s_nop 0
    ds_read_b64_tr_b16 v[200:201], v243 offset:15488
    ds_read_b64_tr_b16 v[202:203], v243 offset:18560
    v_mfma_f32_16x16x32_bf16 v[80:83], v[212:215], v[40:43], v[80:83]
    ds_read_b64_tr_b16 v[204:205], v243 offset:6272
    ds_read_b64_tr_b16 v[206:207], v243 offset:21632
    v_mfma_f32_16x16x32_bf16 v[84:87], v[212:215], v[44:47], v[84:87]
    s_nop 0
    v_mfma_f32_16x16x32_bf16 v[84:87], v[208:211], v[36:39], v[84:87]
    s_waitcnt lgkmcnt(8)
    v_mfma_f32_16x16x32_bf16 v[92:95], v[216:219], v[36:39], v[92:95]
    v_mfma_f32_16x16x32_bf16 v[92:95], v[220:223], v[44:47], v[92:95]
    v_mfma_f32_16x16x32_bf16 v[88:91], v[220:223], v[40:43], v[88:91]
    v_mfma_f32_16x16x32_bf16 v[88:91], v[216:219], v[32:35], v[88:91]
    s_waitcnt lgkmcnt(0)
    v_mfma_f32_16x16x32_bf16 v[96:99], v[192:195], v[32:35], v[96:99]
    s_waitcnt vmcnt(17)
    s_barrier
    v_mfma_f32_16x16x32_bf16 v[96:99], v[196:199], v[40:43], v[96:99]
    s_nop 0
    ds_read_b64_tr_b16 v[208:209], v242 offset:24576
    ds_read_b64_tr_b16 v[210:211], v242 offset:27648
    v_mfma_f32_16x16x32_bf16 v[100:103], v[196:199], v[44:47], v[100:103]
    ds_read_b64_tr_b16 v[212:213], v242 offset:30720
    ds_read_b64_tr_b16 v[214:215], v242 offset:33792
    v_mfma_f32_16x16x32_bf16 v[100:103], v[192:195], v[36:39], v[100:103]
    ds_read_b64_tr_b16 v[216:217], v243 offset:24576
    ds_read_b64_tr_b16 v[218:219], v243 offset:27648
    v_mfma_f32_16x16x32_bf16 v[108:111], v[200:203], v[36:39], v[108:111]
    s_add_u32 s6, s32, 0
    s_and_b32 s6, s6, 3
    s_mul_i32 s6, s6, 61440
    s_add_u32 s6, s6, s70
    s_add_u32 m0, s34, 0
    ds_read_b64_tr_b16 v[220:221], v243 offset:30720
    ds_read_b64_tr_b16 v[222:223], v243 offset:33792
    v_mfma_f32_16x16x32_bf16 v[108:111], v[204:207], v[44:47], v[108:111]
    buffer_load_dwordx4 v3, s[48:51], s6 offen sc1 lds
    v_mfma_f32_16x16x32_bf16 v[104:107], v[204:207], v[40:43], v[104:107]
    ds_read_b64_tr_b16 v[192:193], v242 offset:24640
    ds_read_b64_tr_b16 v[194:195], v242 offset:27712
    v_mfma_f32_16x16x32_bf16 v[104:107], v[200:203], v[32:35], v[104:107]
    s_waitcnt lgkmcnt(8)
    ds_read_b64_tr_b16 v[196:197], v242 offset:30784
    ds_read_b64_tr_b16 v[198:199], v242 offset:33856
    v_mfma_f32_16x16x32_bf16 v[64:67], v[208:211], a[192:195], v[64:67]
    s_waitcnt lgkmcnt(8)
    s_add_u32 s6, s6, 4096
    s_add_u32 m0, s34, 4096
    v_mfma_f32_16x16x32_bf16 v[64:67], v[212:215], a[200:203], v[64:67]
    buffer_load_dwordx4 v3, s[48:51], s6 offen sc1 lds
    v_mfma_f32_16x16x32_bf16 v[68:71], v[212:215], a[204:207], v[68:71]
    ds_read_b64_tr_b16 v[200:201], v243 offset:24640
    ds_read_b64_tr_b16 v[202:203], v243 offset:27712
    v_mfma_f32_16x16x32_bf16 v[68:71], v[208:211], a[196:199], v[68:71]
    s_waitcnt lgkmcnt(6)
    ds_read_b64_tr_b16 v[204:205], v243 offset:30784
    ds_read_b64_tr_b16 v[206:207], v243 offset:33856
    v_mfma_f32_16x16x32_bf16 v[76:79], v[216:219], a[196:199], v[76:79]
    s_nop 0
    v_mfma_f32_16x16x32_bf16 v[76:79], v[220:223], a[204:207], v[76:79]
    v_mfma_f32_16x16x32_bf16 v[72:75], v[220:223], a[200:203], v[72:75]
    ds_read_b64_tr_b16 v[208:209], v242 offset:24704
    ds_read_b64_tr_b16 v[210:211], v242 offset:27776
    v_mfma_f32_16x16x32_bf16 v[72:75], v[216:219], a[192:195], v[72:75]
    s_waitcnt lgkmcnt(6)
    ds_read_b64_tr_b16 v[212:213], v242 offset:30848
    ds_read_b64_tr_b16 v[214:215], v242 offset:33920
    v_mfma_f32_16x16x32_bf16 v[80:83], v[192:195], a[192:195], v[80:83]
    buffer_store_dwordx4 a[128:131], v2, s[48:51], s66 offen sc1
    v_mfma_f32_16x16x32_bf16 v[80:83], v[196:199], a[200:203], v[80:83]
    v_mfma_f32_16x16x32_bf16 v[84:87], v[196:199], a[204:207], v[84:87]
    ds_read_b64_tr_b16 v[216:217], v243 offset:24704
    ds_read_b64_tr_b16 v[218:219], v243 offset:27776
    v_mfma_f32_16x16x32_bf16 v[84:87], v[192:195], a[196:199], v[84:87]
    s_waitcnt lgkmcnt(6)
    ds_read_b64_tr_b16 v[220:221], v243 offset:30848
    ds_read_b64_tr_b16 v[222:223], v243 offset:33920
    v_mfma_f32_16x16x32_bf16 v[92:95], v[200:203], a[196:199], v[92:95]
    v_mfma_f32_16x16x32_bf16 v[92:95], v[204:207], a[204:207], v[92:95]
    v_mfma_f32_16x16x32_bf16 v[88:91], v[204:207], a[200:203], v[88:91]
    s_nop 0
    ds_read_b64_tr_b16 v[192:193], v242 offset:39936
    ds_read_b64_tr_b16 v[194:195], v242 offset:43008
    v_mfma_f32_16x16x32_bf16 v[88:91], v[200:203], a[192:195], v[88:91]
    s_waitcnt lgkmcnt(6)
    ds_read_b64_tr_b16 v[196:197], v242 offset:46080
    ds_read_b64_tr_b16 v[198:199], v242 offset:49152
    v_mfma_f32_16x16x32_bf16 v[96:99], v[208:211], a[192:195], v[96:99]
    s_add_u32 s6, s6, 4096
    s_add_u32 m0, s34, 8192
    v_mfma_f32_16x16x32_bf16 v[96:99], v[212:215], a[200:203], v[96:99]
    buffer_load_dwordx4 v3, s[48:51], s6 offen sc1 lds
    v_mfma_f32_16x16x32_bf16 v[100:103], v[212:215], a[204:207], v[100:103]
    s_nop 0
    ds_read_b64_tr_b16 v[200:201], v243 offset:39936
    ds_read_b64_tr_b16 v[202:203], v243 offset:43008
    v_mfma_f32_16x16x32_bf16 v[100:103], v[208:211], a[196:199], v[100:103]
    s_waitcnt lgkmcnt(6)
    ds_read_b64_tr_b16 v[204:205], v243 offset:46080
    ds_read_b64_tr_b16 v[206:207], v243 offset:49152
    v_mfma_f32_16x16x32_bf16 v[108:111], v[216:219], a[196:199], v[108:111]
    v_mfma_f32_16x16x32_bf16 v[108:111], v[220:223], a[204:207], v[108:111]
    v_mfma_f32_16x16x32_bf16 v[104:107], v[220:223], a[200:203], v[104:107]
    ds_read_b64_tr_b16 v[208:209], v242 offset:40000
    ds_read_b64_tr_b16 v[210:211], v242 offset:43072
    v_mfma_f32_16x16x32_bf16 v[104:107], v[216:219], a[192:195], v[104:107]
    s_waitcnt lgkmcnt(6)
    ds_read_b64_tr_b16 v[212:213], v242 offset:46144
    ds_read_b64_tr_b16 v[214:215], v242 offset:49216
    s_nop 0
    v_mfma_f32_16x16x32_bf16 v[64:67], v[192:195], a[208:211], v[64:67]
    s_add_u32 s6, s6, 4096
    s_add_u32 m0, s34, 12288
    v_mfma_f32_16x16x32_bf16 v[64:67], v[196:199], a[216:219], v[64:67]
    buffer_load_dwordx4 v3, s[48:51], s6 offen sc1 lds
    v_mfma_f32_16x16x32_bf16 v[68:71], v[196:199], a[220:223], v[68:71]
    ds_read_b64_tr_b16 v[216:217], v243 offset:40000
    ds_read_b64_tr_b16 v[218:219], v243 offset:43072
    v_mfma_f32_16x16x32_bf16 v[68:71], v[192:195], a[212:215], v[68:71]
    s_waitcnt lgkmcnt(6)
    ds_read_b64_tr_b16 v[220:221], v243 offset:46144
    ds_read_b64_tr_b16 v[222:223], v243 offset:49216
    v_mfma_f32_16x16x32_bf16 v[76:79], v[200:203], a[212:215], v[76:79]
    s_nop 0
    v_mfma_f32_16x16x32_bf16 v[76:79], v[204:207], a[220:223], v[76:79]
    buffer_store_dwordx4 a[132:135], v2, s[48:51], s67 offen sc1
    v_mfma_f32_16x16x32_bf16 v[72:75], v[204:207], a[216:219], v[72:75]
    ds_read_b64_tr_b16 v[192:193], v242 offset:40064
    ds_read_b64_tr_b16 v[194:195], v242 offset:43136
    v_mfma_f32_16x16x32_bf16 v[72:75], v[200:203], a[208:211], v[72:75]
    s_waitcnt lgkmcnt(6)
    s_nop 0
    ds_read_b64_tr_b16 v[196:197], v242 offset:46208
    ds_read_b64_tr_b16 v[198:199], v242 offset:49280
    v_mfma_f32_16x16x32_bf16 v[80:83], v[208:211], a[208:211], v[80:83]
    v_mfma_f32_16x16x32_bf16 v[80:83], v[212:215], a[216:219], v[80:83]
    v_mfma_f32_16x16x32_bf16 v[84:87], v[212:215], a[220:223], v[84:87]
    s_nop 0
    ds_read_b64_tr_b16 v[200:201], v243 offset:40064
    ds_read_b64_tr_b16 v[202:203], v243 offset:43136
    v_mfma_f32_16x16x32_bf16 v[84:87], v[208:211], a[212:215], v[84:87]
    s_waitcnt lgkmcnt(6)
    ds_read_b64_tr_b16 v[204:205], v243 offset:46208
    ds_read_b64_tr_b16 v[206:207], v243 offset:49280
    v_mfma_f32_16x16x32_bf16 v[92:95], v[216:219], a[212:215], v[92:95]
    s_add_u32 s6, s6, 4096
    s_add_u32 m0, s34, 16384
    v_mfma_f32_16x16x32_bf16 v[92:95], v[220:223], a[220:223], v[92:95]
    buffer_load_dwordx4 v3, s[48:51], s6 offen sc1 lds
    v_mfma_f32_16x16x32_bf16 v[88:91], v[220:223], a[216:219], v[88:91]
    s_nop 0
    ds_read_b64_tr_b16 v[208:209], v242 offset:36864
    ds_read_b64_tr_b16 v[210:211], v242 offset:52224
    v_mfma_f32_16x16x32_bf16 v[88:91], v[216:219], a[208:211], v[88:91]
    s_waitcnt lgkmcnt(6)
    ds_read_b64_tr_b16 v[212:213], v242 offset:55296
    ds_read_b64_tr_b16 v[214:215], v242 offset:58368
    v_mfma_f32_16x16x32_bf16 v[96:99], v[192:195], a[208:211], v[96:99]
    v_mfma_f32_16x16x32_bf16 v[96:99], v[196:199], a[216:219], v[96:99]
    v_mfma_f32_16x16x32_bf16 v[100:103], v[196:199], a[220:223], v[100:103]
    ds_read_b64_tr_b16 v[216:217], v243 offset:36864
    ds_read_b64_tr_b16 v[218:219], v243 offset:52224
    v_mfma_f32_16x16x32_bf16 v[100:103], v[192:195], a[212:215], v[100:103]
    s_waitcnt lgkmcnt(6)
    ds_read_b64_tr_b16 v[220:221], v243 offset:55296
    ds_read_b64_tr_b16 v[222:223], v243 offset:58368
    s_nop 0
    v_mfma_f32_16x16x32_bf16 v[108:111], v[200:203], a[212:215], v[108:111]
    buffer_store_dwordx4 a[136:139], v2, s[48:51], s68 offen sc1
    v_mfma_f32_16x16x32_bf16 v[108:111], v[204:207], a[220:223], v[108:111]
    v_mfma_f32_16x16x32_bf16 v[104:107], v[204:207], a[216:219], v[104:107]
    ds_read_b64_tr_b16 v[192:193], v242 offset:36928
    ds_read_b64_tr_b16 v[194:195], v242 offset:52288
    v_mfma_f32_16x16x32_bf16 v[104:107], v[200:203], a[208:211], v[104:107]
    s_waitcnt lgkmcnt(6)
    s_nop 0
    ds_read_b64_tr_b16 v[196:197], v242 offset:55360
    ds_read_b64_tr_b16 v[198:199], v242 offset:58432
    v_mfma_f32_16x16x32_bf16 v[64:67], v[208:211], a[224:227], v[64:67]
    v_mfma_f32_16x16x32_bf16 v[64:67], v[212:215], a[232:235], v[64:67]
    v_mfma_f32_16x16x32_bf16 v[68:71], v[212:215], a[236:239], v[68:71]
    s_nop 0
    ds_read_b64_tr_b16 v[200:201], v243 offset:36928
    ds_read_b64_tr_b16 v[202:203], v243 offset:52288
    v_mfma_f32_16x16x32_bf16 v[68:71], v[208:211], a[228:231], v[68:71]
    s_waitcnt lgkmcnt(6)
    ds_read_b64_tr_b16 v[204:205], v243 offset:55360
    ds_read_b64_tr_b16 v[206:207], v243 offset:58432
    v_mfma_f32_16x16x32_bf16 v[76:79], v[216:219], a[228:231], v[76:79]
    s_add_u32 s6, s6, 4096
    s_add_u32 m0, s34, 20480
    v_mfma_f32_16x16x32_bf16 v[76:79], v[220:223], a[236:239], v[76:79]
    buffer_load_dwordx4 v3, s[48:51], s6 offen sc1 lds
    v_mfma_f32_16x16x32_bf16 v[72:75], v[220:223], a[232:235], v[72:75]
    s_nop 0
    ds_read_b64_tr_b16 v[208:209], v242 offset:36992
    ds_read_b64_tr_b16 v[210:211], v242 offset:52352
    v_mfma_f32_16x16x32_bf16 v[72:75], v[216:219], a[224:227], v[72:75]
    s_waitcnt lgkmcnt(6)
    ds_read_b64_tr_b16 v[212:213], v242 offset:55424
    ds_read_b64_tr_b16 v[214:215], v242 offset:58496
    v_mfma_f32_16x16x32_bf16 v[80:83], v[192:195], a[224:227], v[80:83]
    v_mfma_f32_16x16x32_bf16 v[80:83], v[196:199], a[232:235], v[80:83]
    v_mfma_f32_16x16x32_bf16 v[84:87], v[196:199], a[236:239], v[84:87]
    ds_read_b64_tr_b16 v[216:217], v243 offset:36992
    ds_read_b64_tr_b16 v[218:219], v243 offset:52352
    v_mfma_f32_16x16x32_bf16 v[84:87], v[192:195], a[228:231], v[84:87]
    s_waitcnt lgkmcnt(6)
    ds_read_b64_tr_b16 v[220:221], v243 offset:55424
    ds_read_b64_tr_b16 v[222:223], v243 offset:58496
    s_nop 0
    v_mfma_f32_16x16x32_bf16 v[92:95], v[200:203], a[228:231], v[92:95]
    s_add_u32 s6, s6, 4096
    s_add_u32 m0, s34, 24576
    v_mfma_f32_16x16x32_bf16 v[92:95], v[204:207], a[236:239], v[92:95]
    buffer_load_dwordx4 v3, s[48:51], s6 offen sc1 lds
    v_mfma_f32_16x16x32_bf16 v[88:91], v[204:207], a[232:235], v[88:91]
    ds_read_b64_tr_b16 v[192:193], v244 offset:0
    ds_read_b64_tr_b16 v[194:195], v244 offset:3072
    v_mfma_f32_16x16x32_bf16 v[88:91], v[200:203], a[224:227], v[88:91]
    s_waitcnt lgkmcnt(6)
    ds_read_b64_tr_b16 v[196:197], v244 offset:9216
    ds_read_b64_tr_b16 v[198:199], v244 offset:12288
    v_mfma_f32_16x16x32_bf16 v[96:99], v[208:211], a[224:227], v[96:99]
    s_nop 0
    v_mfma_f32_16x16x32_bf16 v[96:99], v[212:215], a[232:235], v[96:99]
    s_nop 0
    v_mfma_f32_16x16x32_bf16 v[100:103], v[212:215], a[236:239], v[100:103]
    s_nop 0
    ds_read_b64_tr_b16 v[200:201], v245 offset:0
    ds_read_b64_tr_b16 v[202:203], v245 offset:3072
    v_mfma_f32_16x16x32_bf16 v[100:103], v[208:211], a[228:231], v[100:103]
    s_waitcnt lgkmcnt(6)
    s_nop 0
    ds_read_b64_tr_b16 v[204:205], v245 offset:9216
    ds_read_b64_tr_b16 v[206:207], v245 offset:12288
    v_mfma_f32_16x16x32_bf16 v[108:111], v[216:219], a[228:231], v[108:111]
    buffer_store_dwordx4 a[140:143], v2, s[48:51], s69 offen sc1
    v_mfma_f32_16x16x32_bf16 v[108:111], v[220:223], a[236:239], v[108:111]
    v_mfma_f32_16x16x32_bf16 v[104:107], v[220:223], a[232:235], v[104:107]
    ds_read_b64_tr_b16 v[208:209], v244 offset:64
    ds_read_b64_tr_b16 v[210:211], v244 offset:3136
    v_mfma_f32_16x16x32_bf16 v[104:107], v[216:219], a[224:227], v[104:107]
    s_waitcnt vmcnt(26) lgkmcnt(6)
    ds_read_b64_tr_b16 v[212:213], v244 offset:9280
    ds_read_b64_tr_b16 v[214:215], v244 offset:12352
    v_mfma_f32_16x16x32_bf16 v[64:67], v[192:195], a[240:243], v[64:67]
    s_waitcnt vmcnt(22)
    v_mfma_f32_16x16x32_bf16 v[64:67], v[196:199], a[248:251], v[64:67]
    s_waitcnt vmcnt(20)
    v_mfma_f32_16x16x32_bf16 v[68:71], v[196:199], a[252:255], v[68:71]
    s_nop 0
    ds_read_b64_tr_b16 v[216:217], v245 offset:64
    ds_read_b64_tr_b16 v[218:219], v245 offset:3136
    v_mfma_f32_16x16x32_bf16 v[68:71], v[192:195], a[244:247], v[68:71]
    s_waitcnt lgkmcnt(6)
    s_nop 0
    ds_read_b64_tr_b16 v[220:221], v245 offset:9280
    ds_read_b64_tr_b16 v[222:223], v245 offset:12352
    v_mfma_f32_16x16x32_bf16 v[76:79], v[200:203], a[244:247], v[76:79]
    s_add_u32 s6, s6, 4096
    s_add_u32 m0, s34, 28672
    v_mfma_f32_16x16x32_bf16 v[76:79], v[204:207], a[252:255], v[76:79]
    buffer_load_dwordx4 v3, s[48:51], s6 offen sc1 lds
    v_mfma_f32_16x16x32_bf16 v[72:75], v[204:207], a[248:251], v[72:75]
    ds_read_b64_tr_b16 v[192:193], v244 offset:128
    ds_read_b64_tr_b16 v[194:195], v244 offset:3200
    v_mfma_f32_16x16x32_bf16 v[72:75], v[200:203], a[240:243], v[72:75]
    s_waitcnt lgkmcnt(6)
    s_nop 0
    ds_read_b64_tr_b16 v[196:197], v244 offset:9344
    ds_read_b64_tr_b16 v[198:199], v244 offset:12416
    v_mfma_f32_16x16x32_bf16 v[80:83], v[208:211], a[240:243], v[80:83]
    v_mfma_f32_16x16x32_bf16 v[80:83], v[212:215], a[248:251], v[80:83]
    v_mfma_f32_16x16x32_bf16 v[84:87], v[212:215], a[252:255], v[84:87]
    s_nop 0
    ds_read_b64_tr_b16 v[200:201], v245 offset:128
    ds_read_b64_tr_b16 v[202:203], v245 offset:3200
    v_mfma_f32_16x16x32_bf16 v[84:87], v[208:211], a[244:247], v[84:87]
    s_waitcnt lgkmcnt(6)
    ds_read_b64_tr_b16 v[204:205], v245 offset:9344
    ds_read_b64_tr_b16 v[206:207], v245 offset:12416
    v_mfma_f32_16x16x32_bf16 v[92:95], v[216:219], a[244:247], v[92:95]
    s_add_u32 s6, s6, 4096
    s_add_u32 m0, s34, 32768
    v_mfma_f32_16x16x32_bf16 v[92:95], v[220:223], a[252:255], v[92:95]
    buffer_load_dwordx4 v3, s[48:51], s6 offen sc1 lds
    v_mfma_f32_16x16x32_bf16 v[88:91], v[220:223], a[248:251], v[88:91]
    s_nop 0
    ds_read_b64_tr_b16 v[208:209], v244 offset:15360
    ds_read_b64_tr_b16 v[210:211], v244 offset:18432
    v_mfma_f32_16x16x32_bf16 v[88:91], v[216:219], a[240:243], v[88:91]
    s_waitcnt lgkmcnt(6)
    ds_read_b64_tr_b16 v[212:213], v244 offset:6144
    ds_read_b64_tr_b16 v[214:215], v244 offset:21504
    v_mfma_f32_16x16x32_bf16 v[96:99], v[192:195], a[240:243], v[96:99]
    v_mfma_f32_16x16x32_bf16 v[96:99], v[196:199], a[248:251], v[96:99]
    buffer_store_dwordx4 a[160:163], v2, s[48:51], s66 offen offset:1024 sc1
    v_mfma_f32_16x16x32_bf16 v[100:103], v[196:199], a[252:255], v[100:103]
    ds_read_b64_tr_b16 v[216:217], v245 offset:15360
    ds_read_b64_tr_b16 v[218:219], v245 offset:18432
    v_mfma_f32_16x16x32_bf16 v[100:103], v[192:195], a[244:247], v[100:103]
    s_waitcnt lgkmcnt(6)
    ds_read_b64_tr_b16 v[220:221], v245 offset:6144
    s_nop 0
    ds_read_b64_tr_b16 v[222:223], v245 offset:21504
    v_mfma_f32_16x16x32_bf16 v[108:111], v[200:203], a[244:247], v[108:111]
    s_nop 0
    v_mfma_f32_16x16x32_bf16 v[108:111], v[204:207], a[252:255], v[108:111]
    s_nop 0
    v_mfma_f32_16x16x32_bf16 v[104:107], v[204:207], a[248:251], v[104:107]
    s_nop 0
    ds_read_b64_tr_b16 v[192:193], v244 offset:15424
    ds_read_b64_tr_b16 v[194:195], v244 offset:18496
    v_mfma_f32_16x16x32_bf16 v[104:107], v[200:203], a[240:243], v[104:107]
    s_waitcnt vmcnt(21) lgkmcnt(6)
    ds_read_b64_tr_b16 v[196:197], v244 offset:6208
    ds_read_b64_tr_b16 v[198:199], v244 offset:21568
    v_mfma_f32_16x16x32_bf16 v[64:67], v[208:211], v[112:115], v[64:67]
    s_waitcnt vmcnt(17)
    s_add_u32 s6, s6, 4096
    s_add_u32 m0, s34, 36864
    v_mfma_f32_16x16x32_bf16 v[64:67], v[212:215], v[120:123], v[64:67]
    s_waitcnt vmcnt(15)
    buffer_load_dwordx4 v3, s[48:51], s6 offen sc1 lds
    v_mfma_f32_16x16x32_bf16 v[68:71], v[212:215], v[124:127], v[68:71]
    ds_read_b64_tr_b16 v[200:201], v245 offset:15424
    ds_read_b64_tr_b16 v[202:203], v245 offset:18496
    v_mfma_f32_16x16x32_bf16 v[68:71], v[208:211], v[116:119], v[68:71]
    s_waitcnt lgkmcnt(6)
    ds_read_b64_tr_b16 v[204:205], v245 offset:6208
    ds_read_b64_tr_b16 v[206:207], v245 offset:21568
    v_mfma_f32_16x16x32_bf16 v[76:79], v[216:219], v[116:119], v[76:79]
    s_nop 0
    v_mfma_f32_16x16x32_bf16 v[76:79], v[220:223], v[124:127], v[76:79]
    v_mfma_f32_16x16x32_bf16 v[72:75], v[220:223], v[120:123], v[72:75]
    ds_read_b64_tr_b16 v[208:209], v244 offset:15488
    ds_read_b64_tr_b16 v[210:211], v244 offset:18560
    v_mfma_f32_16x16x32_bf16 v[72:75], v[216:219], v[112:115], v[72:75]
    s_waitcnt lgkmcnt(6)
    ds_read_b64_tr_b16 v[212:213], v244 offset:6272
    s_nop 0
    ds_read_b64_tr_b16 v[214:215], v244 offset:21632
    v_mfma_f32_16x16x32_bf16 v[80:83], v[192:195], v[112:115], v[80:83]
    buffer_store_dwordx4 a[164:167], v2, s[48:51], s67 offen offset:1024 sc1
    v_mfma_f32_16x16x32_bf16 v[80:83], v[196:199], v[120:123], v[80:83]
    v_mfma_f32_16x16x32_bf16 v[84:87], v[196:199], v[124:127], v[84:87]
    s_nop 0
    ds_read_b64_tr_b16 v[216:217], v245 offset:15488
    ds_read_b64_tr_b16 v[218:219], v245 offset:18560
    v_mfma_f32_16x16x32_bf16 v[84:87], v[192:195], v[116:119], v[84:87]
    s_waitcnt lgkmcnt(6)
    ds_read_b64_tr_b16 v[220:221], v245 offset:6272
    ds_read_b64_tr_b16 v[222:223], v245 offset:21632
    v_mfma_f32_16x16x32_bf16 v[92:95], v[200:203], v[116:119], v[92:95]
    v_mfma_f32_16x16x32_bf16 v[92:95], v[204:207], v[124:127], v[92:95]
    v_mfma_f32_16x16x32_bf16 v[88:91], v[204:207], v[120:123], v[88:91]
    s_nop 0
    v_mfma_f32_16x16x32_bf16 v[88:91], v[200:203], v[112:115], v[88:91]
    s_waitcnt lgkmcnt(4)
    v_mfma_f32_16x16x32_bf16 v[96:99], v[208:211], v[112:115], v[96:99]
    v_mfma_f32_16x16x32_bf16 v[96:99], v[212:215], v[120:123], v[96:99]
    v_mfma_f32_16x16x32_bf16 v[100:103], v[212:215], v[124:127], v[100:103]
    s_nop 0
    v_mfma_f32_16x16x32_bf16 v[100:103], v[208:211], v[116:119], v[100:103]
    s_waitcnt lgkmcnt(0)
    v_mfma_f32_16x16x32_bf16 v[108:111], v[216:219], v[116:119], v[108:111]
    v_mfma_f32_16x16x32_bf16 v[108:111], v[220:223], v[124:127], v[108:111]
    v_mfma_f32_16x16x32_bf16 v[104:107], v[220:223], v[120:123], v[104:107]
    v_mfma_f32_16x16x32_bf16 v[104:107], v[216:219], v[112:115], v[104:107]
    s_mov_b32 s14, 0xbdd2d3e8
    s_mov_b32 s15, 0xbdd2d3e8
    s_mov_b32 s74, 1.0
    s_mov_b32 s75, 1.0
    v_mov_b32 v14, 0xc0135761
    v_mov_b32 v15, v14
    s_mul_i32 s79, s81, 98304
    s_mul_i32 s3, s83, 3072
    s_add_u32 s79, s79, s3
    s_add_u32 s79, s79, 9437184
    s_add_u32 s80, s79, 49152
    buffer_store_dwordx4 a[168:171], v2, s[48:51], s68 offen offset:1024 sc1
    v_pk_mul_f32 v[48:49], v[64:65], v[64:65]
    v_pk_fma_f32 v[48:49], v[48:49], s[14:15], v[14:15]
    v_pk_mul_f32 v[48:49], v[48:49], v[64:65]
    v_pk_mul_f32 v[52:53], v[66:67], v[66:67]
    v_pk_fma_f32 v[52:53], v[52:53], s[14:15], v[14:15]
    v_pk_mul_f32 v[52:53], v[52:53], v[66:67]
    v_exp_f32 v48, v48
    v_exp_f32 v49, v49
    v_exp_f32 v52, v52
    v_exp_f32 v53, v53
    v_pk_add_f32 v[48:49], v[48:49], s[74:75]
    v_pk_add_f32 v[52:53], v[52:53], s[74:75]
    v_rcp_f32 v48, v48
    v_rcp_f32 v49, v49
    v_rcp_f32 v52, v52
    v_rcp_f32 v53, v53
    v_pk_mul_f32 v[48:49], v[48:49], v[64:65]
    v_pk_mul_f32 v[52:53], v[52:53], v[66:67]
    v_cvt_pk_bf16_f32 v224, v48, v49
    v_cvt_pk_bf16_f32 v225, v52, v53
    v_pk_mul_f32 v[48:49], v[72:73], v[72:73]
    v_pk_fma_f32 v[48:49], v[48:49], s[14:15], v[14:15]
    v_pk_mul_f32 v[48:49], v[48:49], v[72:73]
    v_pk_mul_f32 v[52:53], v[74:75], v[74:75]
    v_pk_fma_f32 v[52:53], v[52:53], s[14:15], v[14:15]
    v_pk_mul_f32 v[52:53], v[52:53], v[74:75]
    v_exp_f32 v48, v48
    v_exp_f32 v49, v49
    v_exp_f32 v52, v52
    v_exp_f32 v53, v53
    v_pk_add_f32 v[48:49], v[48:49], s[74:75]
    v_pk_add_f32 v[52:53], v[52:53], s[74:75]
    v_rcp_f32 v48, v48
    v_rcp_f32 v49, v49
    v_rcp_f32 v52, v52
    v_rcp_f32 v53, v53
    v_pk_mul_f32 v[48:49], v[48:49], v[72:73]
    v_pk_mul_f32 v[52:53], v[52:53], v[74:75]
    v_cvt_pk_bf16_f32 v226, v48, v49
    v_cvt_pk_bf16_f32 v227, v52, v53
    v_pk_mul_f32 v[48:49], v[80:81], v[80:81]
    v_pk_fma_f32 v[48:49], v[48:49], s[14:15], v[14:15]
    v_pk_mul_f32 v[48:49], v[48:49], v[80:81]
    v_pk_mul_f32 v[52:53], v[82:83], v[82:83]
    v_pk_fma_f32 v[52:53], v[52:53], s[14:15], v[14:15]
    v_pk_mul_f32 v[52:53], v[52:53], v[82:83]
    v_exp_f32 v48, v48
    v_exp_f32 v49, v49
    v_exp_f32 v52, v52
    v_exp_f32 v53, v53
    v_pk_add_f32 v[48:49], v[48:49], s[74:75]
    v_pk_add_f32 v[52:53], v[52:53], s[74:75]
    v_rcp_f32 v48, v48
    v_rcp_f32 v49, v49
    v_rcp_f32 v52, v52
    v_rcp_f32 v53, v53
    v_pk_mul_f32 v[48:49], v[48:49], v[80:81]
    v_pk_mul_f32 v[52:53], v[52:53], v[82:83]
    v_cvt_pk_bf16_f32 v228, v48, v49
    v_cvt_pk_bf16_f32 v229, v52, v53
    buffer_store_dwordx4 a[172:175], v2, s[48:51], s69 offen offset:1024 sc1
    v_pk_mul_f32 v[48:49], v[88:89], v[88:89]
    v_pk_fma_f32 v[48:49], v[48:49], s[14:15], v[14:15]
    v_pk_mul_f32 v[48:49], v[48:49], v[88:89]
    v_pk_mul_f32 v[52:53], v[90:91], v[90:91]
    v_pk_fma_f32 v[52:53], v[52:53], s[14:15], v[14:15]
    v_pk_mul_f32 v[52:53], v[52:53], v[90:91]
    v_exp_f32 v48, v48
    v_exp_f32 v49, v49
    v_exp_f32 v52, v52
    v_exp_f32 v53, v53
    v_pk_add_f32 v[48:49], v[48:49], s[74:75]
    v_pk_add_f32 v[52:53], v[52:53], s[74:75]
    v_rcp_f32 v48, v48
    v_rcp_f32 v49, v49
    v_rcp_f32 v52, v52
    v_rcp_f32 v53, v53
    v_pk_mul_f32 v[48:49], v[48:49], v[88:89]
    v_pk_mul_f32 v[52:53], v[52:53], v[90:91]
    v_cvt_pk_bf16_f32 v230, v48, v49
    v_cvt_pk_bf16_f32 v231, v52, v53
    v_pk_mul_f32 v[48:49], v[96:97], v[96:97]
    v_pk_fma_f32 v[48:49], v[48:49], s[14:15], v[14:15]
    v_pk_mul_f32 v[48:49], v[48:49], v[96:97]
    v_pk_mul_f32 v[52:53], v[98:99], v[98:99]
    v_pk_fma_f32 v[52:53], v[52:53], s[14:15], v[14:15]
    v_pk_mul_f32 v[52:53], v[52:53], v[98:99]
    v_exp_f32 v48, v48
    v_exp_f32 v49, v49
    v_exp_f32 v52, v52
    v_exp_f32 v53, v53
    v_pk_add_f32 v[48:49], v[48:49], s[74:75]
    v_pk_add_f32 v[52:53], v[52:53], s[74:75]
    v_rcp_f32 v48, v48
    v_rcp_f32 v49, v49
    v_rcp_f32 v52, v52
    v_rcp_f32 v53, v53
    v_pk_mul_f32 v[48:49], v[48:49], v[96:97]
    v_pk_mul_f32 v[52:53], v[52:53], v[98:99]
    v_cvt_pk_bf16_f32 v232, v48, v49
    v_cvt_pk_bf16_f32 v233, v52, v53
    v_pk_mul_f32 v[48:49], v[104:105], v[104:105]
    v_pk_fma_f32 v[48:49], v[48:49], s[14:15], v[14:15]
    v_pk_mul_f32 v[48:49], v[48:49], v[104:105]
    v_pk_mul_f32 v[52:53], v[106:107], v[106:107]
    v_pk_fma_f32 v[52:53], v[52:53], s[14:15], v[14:15]
    v_pk_mul_f32 v[52:53], v[52:53], v[106:107]
    v_exp_f32 v48, v48
    v_exp_f32 v49, v49
    v_exp_f32 v52, v52
    v_exp_f32 v53, v53
    v_pk_add_f32 v[48:49], v[48:49], s[74:75]
    v_pk_add_f32 v[52:53], v[52:53], s[74:75]
    v_rcp_f32 v48, v48
    v_rcp_f32 v49, v49
    v_rcp_f32 v52, v52
    v_rcp_f32 v53, v53
    v_pk_mul_f32 v[48:49], v[48:49], v[104:105]
    v_pk_mul_f32 v[52:53], v[52:53], v[106:107]
    v_cvt_pk_bf16_f32 v234, v48, v49
    v_cvt_pk_bf16_f32 v235, v52, v53
    v_pk_mul_f32 v[48:49], v[68:69], v[68:69]
    v_pk_fma_f32 v[48:49], v[48:49], s[14:15], v[14:15]
    v_pk_mul_f32 v[48:49], v[48:49], v[68:69]
    v_pk_mul_f32 v[52:53], v[70:71], v[70:71]
    v_pk_fma_f32 v[52:53], v[52:53], s[14:15], v[14:15]
    v_pk_mul_f32 v[52:53], v[52:53], v[70:71]
    v_exp_f32 v48, v48
    v_exp_f32 v49, v49
    v_exp_f32 v52, v52
    v_exp_f32 v53, v53
    v_pk_add_f32 v[48:49], v[48:49], s[74:75]
    v_pk_add_f32 v[52:53], v[52:53], s[74:75]
    v_rcp_f32 v48, v48
    v_rcp_f32 v49, v49
    v_rcp_f32 v52, v52
    v_rcp_f32 v53, v53
    v_pk_mul_f32 v[48:49], v[48:49], v[68:69]
    v_pk_mul_f32 v[52:53], v[52:53], v[70:71]
    v_cvt_pk_bf16_f32 v236, v48, v49
    v_cvt_pk_bf16_f32 v237, v52, v53
    v_pk_mul_f32 v[48:49], v[76:77], v[76:77]
    v_pk_fma_f32 v[48:49], v[48:49], s[14:15], v[14:15]
    v_pk_mul_f32 v[48:49], v[48:49], v[76:77]
    v_pk_mul_f32 v[52:53], v[78:79], v[78:79]
    v_pk_fma_f32 v[52:53], v[52:53], s[14:15], v[14:15]
    v_pk_mul_f32 v[52:53], v[52:53], v[78:79]
    v_exp_f32 v48, v48
    v_exp_f32 v49, v49
    v_exp_f32 v52, v52
    v_exp_f32 v53, v53
    v_pk_add_f32 v[48:49], v[48:49], s[74:75]
    v_pk_add_f32 v[52:53], v[52:53], s[74:75]
    v_rcp_f32 v48, v48
    v_rcp_f32 v49, v49
    v_rcp_f32 v52, v52
    v_rcp_f32 v53, v53
    v_pk_mul_f32 v[48:49], v[48:49], v[76:77]
    v_pk_mul_f32 v[52:53], v[52:53], v[78:79]
    v_cvt_pk_bf16_f32 v238, v48, v49
    v_cvt_pk_bf16_f32 v239, v52, v53
    v_pk_mul_f32 v[48:49], v[84:85], v[84:85]
    v_pk_fma_f32 v[48:49], v[48:49], s[14:15], v[14:15]
    v_pk_mul_f32 v[48:49], v[48:49], v[84:85]
    v_pk_mul_f32 v[52:53], v[86:87], v[86:87]
    v_pk_fma_f32 v[52:53], v[52:53], s[14:15], v[14:15]
    v_pk_mul_f32 v[52:53], v[52:53], v[86:87]
    v_exp_f32 v48, v48
    v_exp_f32 v49, v49
    v_exp_f32 v52, v52
    v_exp_f32 v53, v53
    v_pk_add_f32 v[48:49], v[48:49], s[74:75]
    v_pk_add_f32 v[52:53], v[52:53], s[74:75]
    v_rcp_f32 v48, v48
    v_rcp_f32 v49, v49
    v_rcp_f32 v52, v52
    v_rcp_f32 v53, v53
    v_pk_mul_f32 v[48:49], v[48:49], v[84:85]
    v_pk_mul_f32 v[52:53], v[52:53], v[86:87]
    v_cvt_pk_bf16_f32 v240, v48, v49
    v_cvt_pk_bf16_f32 v241, v52, v53
    v_pk_mul_f32 v[48:49], v[92:93], v[92:93]
    v_pk_fma_f32 v[48:49], v[48:49], s[14:15], v[14:15]
    v_pk_mul_f32 v[48:49], v[48:49], v[92:93]
    v_pk_mul_f32 v[52:53], v[94:95], v[94:95]
    v_pk_fma_f32 v[52:53], v[52:53], s[14:15], v[14:15]
    v_pk_mul_f32 v[52:53], v[52:53], v[94:95]
    v_exp_f32 v48, v48
    v_exp_f32 v49, v49
    v_exp_f32 v52, v52
    v_exp_f32 v53, v53
    v_pk_add_f32 v[48:49], v[48:49], s[74:75]
    v_pk_add_f32 v[52:53], v[52:53], s[74:75]
    v_rcp_f32 v48, v48
    v_rcp_f32 v49, v49
    v_rcp_f32 v52, v52
    v_rcp_f32 v53, v53
    v_pk_mul_f32 v[48:49], v[48:49], v[92:93]
    v_pk_mul_f32 v[52:53], v[52:53], v[94:95]
    v_cvt_pk_bf16_f32 v242, v48, v49
    v_cvt_pk_bf16_f32 v243, v52, v53
    v_pk_mul_f32 v[48:49], v[100:101], v[100:101]
    v_pk_fma_f32 v[48:49], v[48:49], s[14:15], v[14:15]
    v_pk_mul_f32 v[48:49], v[48:49], v[100:101]
    v_pk_mul_f32 v[52:53], v[102:103], v[102:103]
    v_pk_fma_f32 v[52:53], v[52:53], s[14:15], v[14:15]
    v_pk_mul_f32 v[52:53], v[52:53], v[102:103]
    v_exp_f32 v48, v48
    v_exp_f32 v49, v49
    v_exp_f32 v52, v52
    v_exp_f32 v53, v53
    v_pk_add_f32 v[48:49], v[48:49], s[74:75]
    v_pk_add_f32 v[52:53], v[52:53], s[74:75]
    v_rcp_f32 v48, v48
    v_rcp_f32 v49, v49
    v_rcp_f32 v52, v52
    v_rcp_f32 v53, v53
    v_pk_mul_f32 v[48:49], v[48:49], v[100:101]
    v_pk_mul_f32 v[52:53], v[52:53], v[102:103]
    v_cvt_pk_bf16_f32 v244, v48, v49
    v_cvt_pk_bf16_f32 v245, v52, v53
    v_pk_mul_f32 v[48:49], v[108:109], v[108:109]
    v_pk_fma_f32 v[48:49], v[48:49], s[14:15], v[14:15]
    v_pk_mul_f32 v[48:49], v[48:49], v[108:109]
    v_pk_mul_f32 v[52:53], v[110:111], v[110:111]
    v_pk_fma_f32 v[52:53], v[52:53], s[14:15], v[14:15]
    v_pk_mul_f32 v[52:53], v[52:53], v[110:111]
    v_exp_f32 v48, v48
    v_exp_f32 v49, v49
    v_exp_f32 v52, v52
    v_exp_f32 v53, v53
    v_pk_add_f32 v[48:49], v[48:49], s[74:75]
    v_pk_add_f32 v[52:53], v[52:53], s[74:75]
    v_rcp_f32 v48, v48
    v_rcp_f32 v49, v49
    v_rcp_f32_e64 v52, v52
    v_rcp_f32_e64 v53, v53
    v_pk_mul_f32 v[48:49], v[48:49], v[108:109]
    v_pk_mul_f32 v[52:53], v[52:53], v[110:111]
    v_cvt_pk_bf16_f32 v246, v48, v49
    v_cvt_pk_bf16_f32 v247, v52, v53
    s_lshl_b32 s77, s31, 8
    s_add_u32 s77, s77, 79695872
    s_waitcnt vmcnt(0)
    s_barrier
    s_cmp_lg_u32 s30, 0
    s_cbranch_scc1 L_sig14
    s_mov_b32 s3, s71
    s_mov_b64 exec, 1
    v_mov_b32 v54, 0
    v_mov_b32 v55, 1
    buffer_atomic_add v55, v54, s[48:51], s3 offen
    s_mov_b64 exec, -1
L_sig14:
    s_bitcmp1_b32 s2, 0
    s_cbranch_scc1 L_vb
L_va:
    ds_read_b64_tr_b16 v[16:17], v8 offset:0
    ds_read_b64_tr_b16 v[18:19], v8 offset:5120
    ds_read_b64_tr_b16 v[20:21], v8 offset:10240
    ds_read_b64_tr_b16 v[22:23], v8 offset:15360
    ds_read_b64_tr_b16 v[24:25], v9 offset:0
    ds_read_b64_tr_b16 v[26:27], v9 offset:5120
    ds_read_b64_tr_b16 v[28:29], v9 offset:10240
    ds_read_b64_tr_b16 v[30:31], v9 offset:15360
    ds_read_b64_tr_b16 v[32:33], v8 offset:64
    ds_read_b64_tr_b16 v[34:35], v8 offset:5184
    ds_read_b64_tr_b16 v[36:37], v8 offset:10304
    ds_read_b64_tr_b16 v[38:39], v8 offset:15424
    s_waitcnt lgkmcnt(10)
    v_mfma_f32_16x16x32_bf16 v[64:67], v[16:19], a[0:3], 0
    s_waitcnt lgkmcnt(8)
    s_add_u32 s6, s6, 4096
    s_add_u32 m0, s34, 40960
    v_mfma_f32_16x16x32_bf16 v[64:67], v[20:23], a[32:35], v[64:67]
    buffer_load_dwordx4 v3, s[48:51], s6 offen sc1 lds
    v_mfma_f32_16x16x32_bf16 v[68:71], v[20:23], a[36:39], 0
    v_mfma_f32_16x16x32_bf16 v[68:71], v[16:19], a[4:7], v[68:71]
    v_mfma_f32_16x16x32_bf16 v[72:75], v[16:19], a[8:11], 0
    ds_read_b64_tr_b16 v[40:41], v9 offset:64
    ds_read_b64_tr_b16 v[42:43], v9 offset:5184
    v_mfma_f32_16x16x32_bf16 v[72:75], v[20:23], a[40:43], v[72:75]
    s_add_u32 s6, s6, 4096
    s_add_u32 m0, s34, 45056
    v_mfma_f32_16x16x32_bf16 v[76:79], v[20:23], a[44:47], 0
    buffer_load_dwordx4 v3, s[48:51], s6 offen sc1 lds
    v_mfma_f32_16x16x32_bf16 v[76:79], v[16:19], a[12:15], v[76:79]
    s_waitcnt lgkmcnt(2)
    ds_read_b64_tr_b16 v[44:45], v9 offset:10304
    ds_read_b64_tr_b16 v[46:47], v9 offset:15424
    v_mfma_f32_16x16x32_bf16 v[92:95], v[24:27], a[12:15], 0
    v_mfma_f32_16x16x32_bf16 v[92:95], v[28:31], a[44:47], v[92:95]
    buffer_store_dwordx4 v[224:227], v1, s[48:51], s79 offen sc1
    v_mfma_f32_16x16x32_bf16 v[88:91], v[28:31], a[40:43], 0
    v_lshrrev_b32 v14, 6, v1
    v_mul_u32_u24 v14, 160, v14
    v_mfma_f32_16x16x32_bf16 v[88:91], v[24:27], a[8:11], v[88:91]
    v_bfe_u32 v15, v1, 4, 2
    v_lshl_add_u32 v48, v15, 3, v14
    v_mfma_f32_16x16x32_bf16 v[84:87], v[24:27], a[4:7], 0
    ds_read_b64_tr_b16 v[16:17], v8 offset:128
    ds_read_b64_tr_b16 v[18:19], v8 offset:5248
    v_mfma_f32_16x16x32_bf16 v[84:87], v[28:31], a[36:39], v[84:87]
    s_add_u32 s6, s6, 4096
    s_add_u32 m0, s34, 49152
    v_mfma_f32_16x16x32_bf16 v[80:83], v[28:31], a[32:35], 0
    buffer_load_dwordx4 v3, s[48:51], s6 offen sc1 lds
    v_mfma_f32_16x16x32_bf16 v[80:83], v[24:27], a[0:3], v[80:83]
    ds_read_b64_tr_b16 v[20:21], v8 offset:10368
    ds_read_b64_tr_b16 v[22:23], v8 offset:15488
    v_mfma_f32_16x16x32_bf16 v[96:99], v[32:35], a[0:3], 0
    v_lshrrev_b32 v14, 9, v1
    v_lshlrev_b32 v14, 8, v14
    v_mfma_f32_16x16x32_bf16 v[96:99], v[36:39], a[32:35], v[96:99]
    s_add_u32 s6, s6, 4096
    s_add_u32 m0, s34, 53248
    v_mfma_f32_16x16x32_bf16 v[100:103], v[36:39], a[36:39], 0
    buffer_load_dwordx4 v3, s[48:51], s6 offen sc1 lds
    v_mfma_f32_16x16x32_bf16 v[100:103], v[32:35], a[4:7], v[100:103]
    v_and_b32 v15, 0xf0, v1
    v_or_b32_e64 v14, v14, v15
    v_mfma_f32_16x16x32_bf16 v[104:107], v[32:35], a[8:11], 0
    ds_read_b64_tr_b16 v[24:25], v9 offset:128
    ds_read_b64_tr_b16 v[26:27], v9 offset:5248
    v_mfma_f32_16x16x32_bf16 v[104:107], v[36:39], a[40:43], v[104:107]
    v_mfma_f32_16x16x32_bf16 v[108:111], v[36:39], a[44:47], 0
    buffer_store_dwordx4 v[228:231], v1, s[48:51], s79 offen offset:1024 sc1
    v_mfma_f32_16x16x32_bf16 v[108:111], v[32:35], a[12:15], v[108:111]
    s_waitcnt lgkmcnt(2)
    ds_read_b64_tr_b16 v[28:29], v9 offset:10368
    ds_read_b64_tr_b16 v[30:31], v9 offset:15488
    v_mfma_f32_16x16x32_bf16 v[124:127], v[40:43], a[12:15], 0
    s_nop 0
    v_bfe_u32 v15, v1, 8, 1
    v_lshl_add_u32 v49, v15, 3, v14
    v_mfma_f32_16x16x32_bf16 v[124:127], v[44:47], a[44:47], v[124:127]
    s_add_u32 s6, s6, 4096
    s_add_u32 m0, s34, 57344
    v_mfma_f32_16x16x32_bf16 v[120:123], v[44:47], a[40:43], 0
    buffer_load_dwordx4 v3, s[48:51], s6 offen sc1 lds
    v_mfma_f32_16x16x32_bf16 v[120:123], v[40:43], a[8:11], v[120:123]
    v_lshl_add_u32 v2, v15, 9, v14
    v_add_u32 v2, 4096, v2
    v_mfma_f32_16x16x32_bf16 v[116:119], v[40:43], a[4:7], 0
    ds_read_b64_tr_b16 v[32:33], v8 offset:192
    ds_read_b64_tr_b16 v[34:35], v8 offset:5312
    v_mfma_f32_16x16x32_bf16 v[116:119], v[44:47], a[36:39], v[116:119]
    v_bfe_u32 v14, v1, 4, 4
    v_mul_u32_u24 v14, 1280, v14
    v_mfma_f32_16x16x32_bf16 v[112:115], v[44:47], a[32:35], 0
    v_lshrrev_b32_e64 v15, 8, v1
    v_lshl_add_u32 v50, v15, 3, v14
    v_mfma_f32_16x16x32_bf16 v[112:115], v[40:43], a[0:3], v[112:115]
    ds_read_b64_tr_b16 v[36:37], v8 offset:10432
    ds_read_b64_tr_b16 v[38:39], v8 offset:15552
    v_mfma_f32_16x16x32_bf16 v[128:131], v[16:19], a[0:3], 0
    buffer_store_dwordx4 v[232:235], v1, s[48:51], s79 offen offset:2048 sc1
    v_mfma_f32_16x16x32_bf16 v[128:131], v[20:23], a[32:35], v[128:131]
    v_bfe_u32 v51, v1, 4, 3
    v_lshlrev_b32 v51, 2, v51
    v_mfma_f32_16x16x32_bf16 v[132:135], v[20:23], a[36:39], 0
    s_cmp_le_u32 s32, 0
    s_cselect_b32 s6, 1, 0
    s_mul_i32 s6, s6, 61440
    s_add_u32 s6, s6, s70
    s_add_u32 m0, s34, 61440
    v_mfma_f32_16x16x32_bf16 v[132:135], v[16:19], a[4:7], v[132:135]
    buffer_load_dwordx4 v3, s[48:51], s6 offen sc1 lds
    v_mfma_f32_16x16x32_bf16 v[136:139], v[16:19], a[8:11], 0
    ds_read_b64_tr_b16 v[40:41], v9 offset:192
    ds_read_b64_tr_b16 v[42:43], v9 offset:5312
    v_mfma_f32_16x16x32_bf16 v[136:139], v[20:23], a[40:43], v[136:139]
    v_mfma_f32_16x16x32_bf16 v[140:143], v[20:23], a[44:47], 0
    s_nop 0
    v_mfma_f32_16x16x32_bf16 v[140:143], v[16:19], a[12:15], v[140:143]
    s_waitcnt lgkmcnt(2)
    ds_read_b64_tr_b16 v[44:45], v9 offset:10432
    ds_read_b64_tr_b16 v[46:47], v9 offset:15552
    v_mfma_f32_16x16x32_bf16 v[156:159], v[24:27], a[12:15], 0
    s_add_u32 s6, s6, 4096
    s_add_u32 m0, s34, 65536
    v_mfma_f32_16x16x32_bf16 v[156:159], v[28:31], a[44:47], v[156:159]
    buffer_load_dwordx4 v3, s[48:51], s6 offen sc1 lds
    v_mfma_f32_16x16x32_bf16 v[152:155], v[28:31], a[40:43], 0
    v_mfma_f32_16x16x32_bf16 v[152:155], v[24:27], a[8:11], v[152:155]
    s_nop 0
    v_mfma_f32_16x16x32_bf16 v[148:151], v[24:27], a[4:7], 0
    s_nop 0
    ds_read_b64_tr_b16 v[16:17], v8 offset:256
    ds_read_b64_tr_b16 v[18:19], v8 offset:5376
    v_mfma_f32_16x16x32_bf16 v[148:151], v[28:31], a[36:39], v[148:151]
    buffer_store_dwordx4 v[236:239], v1, s[48:51], s80 offen sc1
    v_mfma_f32_16x16x32_bf16 v[144:147], v[28:31], a[32:35], 0
    v_mfma_f32_16x16x32_bf16 v[144:147], v[24:27], a[0:3], v[144:147]
    ds_read_b64_tr_b16 v[20:21], v8 offset:10496
    ds_read_b64_tr_b16 v[22:23], v8 offset:15616
    v_mfma_f32_16x16x32_bf16 v[160:163], v[32:35], a[0:3], 0
    s_add_u32 s6, s6, 4096
    s_add_u32 m0, s34, 69632
    v_mfma_f32_16x16x32_bf16 v[160:163], v[36:39], a[32:35], v[160:163]
    buffer_load_dwordx4 v3, s[48:51], s6 offen sc1 lds
    v_mfma_f32_16x16x32_bf16 v[164:167], v[36:39], a[36:39], 0
    s_nop 0
    v_mfma_f32_16x16x32_bf16 v[164:167], v[32:35], a[4:7], v[164:167]
    s_nop 0
    v_mfma_f32_16x16x32_bf16 v[168:171], v[32:35], a[8:11], 0
    ds_read_b64_tr_b16 v[24:25], v9 offset:256
    ds_read_b64_tr_b16 v[26:27], v9 offset:5376
    v_mfma_f32_16x16x32_bf16 v[168:171], v[36:39], a[40:43], v[168:171]
    s_add_u32 s6, s6, 4096
    s_add_u32 m0, s34, 73728
    v_mfma_f32_16x16x32_bf16 v[172:175], v[36:39], a[44:47], 0
    buffer_load_dwordx4 v3, s[48:51], s6 offen sc1 lds
    v_mfma_f32_16x16x32_bf16 v[172:175], v[32:35], a[12:15], v[172:175]
    s_waitcnt lgkmcnt(2)
    ds_read_b64_tr_b16 v[28:29], v9 offset:10496
    ds_read_b64_tr_b16 v[30:31], v9 offset:15616
    v_mfma_f32_16x16x32_bf16 v[188:191], v[40:43], a[12:15], 0
    s_nop 0
    v_mfma_f32_16x16x32_bf16 v[188:191], v[44:47], a[44:47], v[188:191]
    buffer_store_dwordx4 v[240:243], v1, s[48:51], s80 offen offset:1024 sc1
    v_mfma_f32_16x16x32_bf16 v[184:187], v[44:47], a[40:43], 0
    v_mfma_f32_16x16x32_bf16 v[184:187], v[40:43], a[8:11], v[184:187]
    v_mfma_f32_16x16x32_bf16 v[180:183], v[40:43], a[4:7], 0
    ds_read_b64_tr_b16 v[32:33], v8 offset:20480
    ds_read_b64_tr_b16 v[34:35], v8 offset:25600
    v_mfma_f32_16x16x32_bf16 v[180:183], v[44:47], a[36:39], v[180:183]
    s_add_u32 s6, s6, 4096
    s_add_u32 m0, s34, 77824
    v_mfma_f32_16x16x32_bf16 v[176:179], v[44:47], a[32:35], 0
    buffer_load_dwordx4 v3, s[48:51], s6 offen sc1 lds
    v_mfma_f32_16x16x32_bf16 v[176:179], v[40:43], a[0:3], v[176:179]
    ds_read_b64_tr_b16 v[36:37], v8 offset:30720
    ds_read_b64_tr_b16 v[38:39], v8 offset:35840
    v_mfma_f32_16x16x32_bf16 v[192:195], v[16:19], a[0:3], 0
    v_mfma_f32_16x16x32_bf16 v[192:195], v[20:23], a[32:35], v[192:195]
    buffer_store_dwordx4 v[244:247], v1, s[48:51], s80 offen offset:2048 sc1
    v_mfma_f32_16x16x32_bf16 v[196:199], v[20:23], a[36:39], 0
    v_mfma_f32_16x16x32_bf16 v[196:199], v[16:19], a[4:7], v[196:199]
    v_mfma_f32_16x16x32_bf16 v[200:203], v[16:19], a[8:11], 0
    ds_read_b64_tr_b16 v[40:41], v9 offset:20480
    ds_read_b64_tr_b16 v[42:43], v9 offset:25600
    v_mfma_f32_16x16x32_bf16 v[200:203], v[20:23], a[40:43], v[200:203]
    v_mfma_f32_16x16x32_bf16 v[204:207], v[20:23], a[44:47], 0
    s_nop 0
    v_mfma_f32_16x16x32_bf16 v[204:207], v[16:19], a[12:15], v[204:207]
    s_waitcnt lgkmcnt(2)
    ds_read_b64_tr_b16 v[44:45], v9 offset:30720
    ds_read_b64_tr_b16 v[46:47], v9 offset:35840
    v_mfma_f32_16x16x32_bf16 v[220:223], v[24:27], a[12:15], 0
    v_mfma_f32_16x16x32_bf16 v[220:223], v[28:31], a[44:47], v[220:223]
    s_add_u32 s6, s6, 4096
    s_add_u32 m0, s34, 81920
    v_mfma_f32_16x16x32_bf16 v[216:219], v[28:31], a[40:43], 0
    buffer_load_dwordx4 v3, s[48:51], s6 offen sc1 lds
    v_mfma_f32_16x16x32_bf16 v[216:219], v[24:27], a[8:11], v[216:219]
    v_mfma_f32_16x16x32_bf16 v[212:215], v[24:27], a[4:7], 0
    ds_read_b64_tr_b16 v[16:17], v8 offset:20544
    ds_read_b64_tr_b16 v[18:19], v8 offset:25664
    v_mfma_f32_16x16x32_bf16 v[212:215], v[28:31], a[36:39], v[212:215]
    v_mfma_f32_16x16x32_bf16 v[208:211], v[28:31], a[32:35], 0
    v_mfma_f32_16x16x32_bf16 v[208:211], v[24:27], a[0:3], v[208:211]
    ds_read_b64_tr_b16 v[20:21], v8 offset:30784
    ds_read_b64_tr_b16 v[22:23], v8 offset:35904
    v_mfma_f32_16x16x32_bf16 v[64:67], v[32:35], a[64:67], v[64:67]
    s_add_u32 s6, s6, 4096
    s_add_u32 m0, s34, 86016
    v_mfma_f32_16x16x32_bf16 v[64:67], v[36:39], a[96:99], v[64:67]
    buffer_load_dwordx4 v3, s[48:51], s6 offen sc1 lds
    v_mfma_f32_16x16x32_bf16 v[68:71], v[36:39], a[100:103], v[68:71]
    v_mfma_f32_16x16x32_bf16 v[68:71], v[32:35], a[68:71], v[68:71]
    v_mfma_f32_16x16x32_bf16 v[72:75], v[32:35], a[72:75], v[72:75]
    ds_read_b64_tr_b16 v[24:25], v9 offset:20544
    ds_read_b64_tr_b16 v[26:27], v9 offset:25664
    v_mfma_f32_16x16x32_bf16 v[72:75], v[36:39], a[104:107], v[72:75]
    buffer_load_dword v57, v4, s[48:51], s71 offen sc1
    v_mfma_f32_16x16x32_bf16 v[76:79], v[36:39], a[108:111], v[76:79]
    s_nop 0
    v_mfma_f32_16x16x32_bf16 v[76:79], v[32:35], a[76:79], v[76:79]
    s_waitcnt lgkmcnt(2)
    ds_read_b64_tr_b16 v[28:29], v9 offset:30784
    ds_read_b64_tr_b16 v[30:31], v9 offset:35904
    v_mfma_f32_16x16x32_bf16 v[92:95], v[40:43], a[76:79], v[92:95]
    s_add_u32 s6, s6, 4096
    s_add_u32 m0, s34, 90112
    v_mfma_f32_16x16x32_bf16 v[92:95], v[44:47], a[108:111], v[92:95]
    buffer_load_dwordx4 v3, s[48:51], s6 offen sc1 lds
    v_mfma_f32_16x16x32_bf16 v[88:91], v[44:47], a[104:107], v[88:91]
    v_mfma_f32_16x16x32_bf16 v[88:91], v[40:43], a[72:75], v[88:91]
    s_nop 0
    v_mfma_f32_16x16x32_bf16 v[84:87], v[40:43], a[68:71], v[84:87]
    s_nop 0
    ds_read_b64_tr_b16 v[32:33], v8 offset:20608
    ds_read_b64_tr_b16 v[34:35], v8 offset:25728
    v_mfma_f32_16x16x32_bf16 v[84:87], v[44:47], a[100:103], v[84:87]
    s_add_u32 s6, s6, 4096
    s_add_u32 m0, s34, 94208
    v_mfma_f32_16x16x32_bf16 v[80:83], v[44:47], a[96:99], v[80:83]
    buffer_load_dwordx4 v3, s[48:51], s6 offen sc1 lds
    v_mfma_f32_16x16x32_bf16 v[80:83], v[40:43], a[64:67], v[80:83]
    ds_read_b64_tr_b16 v[36:37], v8 offset:30848
    ds_read_b64_tr_b16 v[38:39], v8 offset:35968
    v_mfma_f32_16x16x32_bf16 v[96:99], v[16:19], a[64:67], v[96:99]
    v_mfma_f32_16x16x32_bf16 v[96:99], v[20:23], a[96:99], v[96:99]
    s_add_u32 s6, s6, 4096
    s_add_u32 m0, s34, 98304
    v_mfma_f32_16x16x32_bf16 v[100:103], v[20:23], a[100:103], v[100:103]
    buffer_load_dwordx4 v3, s[48:51], s6 offen sc1 lds
    v_mfma_f32_16x16x32_bf16 v[100:103], v[16:19], a[68:71], v[100:103]
    v_mfma_f32_16x16x32_bf16 v[104:107], v[16:19], a[72:75], v[104:107]
    ds_read_b64_tr_b16 v[40:41], v9 offset:20608
    ds_read_b64_tr_b16 v[42:43], v9 offset:25728
    v_mfma_f32_16x16x32_bf16 v[104:107], v[20:23], a[104:107], v[104:107]
    v_mfma_f32_16x16x32_bf16 v[108:111], v[20:23], a[108:111], v[108:111]
    s_nop 0
    v_mfma_f32_16x16x32_bf16 v[108:111], v[16:19], a[76:79], v[108:111]
    s_waitcnt lgkmcnt(2)
    ds_read_b64_tr_b16 v[44:45], v9 offset:30848
    ds_read_b64_tr_b16 v[46:47], v9 offset:35968
    v_mfma_f32_16x16x32_bf16 v[124:127], v[24:27], a[76:79], v[124:127]
    s_add_u32 s6, s6, 4096
    s_add_u32 m0, s34, 102400
    v_mfma_f32_16x16x32_bf16 v[124:127], v[28:31], a[108:111], v[124:127]
    buffer_load_dwordx4 v3, s[48:51], s6 offen sc1 lds
    v_mfma_f32_16x16x32_bf16 v[120:123], v[28:31], a[104:107], v[120:123]
    v_mfma_f32_16x16x32_bf16 v[120:123], v[24:27], a[72:75], v[120:123]
    v_mfma_f32_16x16x32_bf16 v[116:119], v[24:27], a[68:71], v[116:119]
    ds_read_b64_tr_b16 v[16:17], v8 offset:20672
    ds_read_b64_tr_b16 v[18:19], v8 offset:25792
    v_mfma_f32_16x16x32_bf16 v[116:119], v[28:31], a[100:103], v[116:119]
    v_mfma_f32_16x16x32_bf16 v[112:115], v[28:31], a[96:99], v[112:115]
    v_mfma_f32_16x16x32_bf16 v[112:115], v[24:27], a[64:67], v[112:115]
    ds_read_b64_tr_b16 v[20:21], v8 offset:30912
    ds_read_b64_tr_b16 v[22:23], v8 offset:36032
    v_mfma_f32_16x16x32_bf16 v[128:131], v[32:35], a[64:67], v[128:131]
    s_add_u32 s6, s6, 4096
    s_add_u32 m0, s34, 106496
    v_mfma_f32_16x16x32_bf16 v[128:131], v[36:39], a[96:99], v[128:131]
    buffer_load_dwordx4 v3, s[48:51], s6 offen sc1 lds
    v_mfma_f32_16x16x32_bf16 v[132:135], v[36:39], a[100:103], v[132:135]
    s_nop 0
    v_mfma_f32_16x16x32_bf16 v[132:135], v[32:35], a[68:71], v[132:135]
    s_nop 0
    v_mfma_f32_16x16x32_bf16 v[136:139], v[32:35], a[72:75], v[136:139]
    ds_read_b64_tr_b16 v[24:25], v9 offset:20672
    ds_read_b64_tr_b16 v[26:27], v9 offset:25792
    v_mfma_f32_16x16x32_bf16 v[136:139], v[36:39], a[104:107], v[136:139]
    s_add_u32 s6, s6, 4096
    s_add_u32 m0, s34, 110592
    v_mfma_f32_16x16x32_bf16 v[140:143], v[36:39], a[108:111], v[140:143]
    buffer_load_dwordx4 v3, s[48:51], s6 offen sc1 lds
    v_mfma_f32_16x16x32_bf16 v[140:143], v[32:35], a[76:79], v[140:143]
    s_waitcnt lgkmcnt(2)
    ds_read_b64_tr_b16 v[28:29], v9 offset:30912
    ds_read_b64_tr_b16 v[30:31], v9 offset:36032
    v_mfma_f32_16x16x32_bf16 v[156:159], v[40:43], a[76:79], v[156:159]
    s_nop 0
    v_mfma_f32_16x16x32_bf16 v[156:159], v[44:47], a[108:111], v[156:159]
    v_mfma_f32_16x16x32_bf16 v[152:155], v[44:47], a[104:107], v[152:155]
    s_add_u32 s6, s6, 4096
    s_add_u32 m0, s34, 114688
    v_mfma_f32_16x16x32_bf16 v[152:155], v[40:43], a[72:75], v[152:155]
    buffer_load_dwordx4 v3, s[48:51], s6 offen sc1 lds
    v_mfma_f32_16x16x32_bf16 v[148:151], v[40:43], a[68:71], v[148:151]
    ds_read_b64_tr_b16 v[32:33], v8 offset:20736
    ds_read_b64_tr_b16 v[34:35], v8 offset:25856
    v_mfma_f32_16x16x32_bf16 v[148:151], v[44:47], a[100:103], v[148:151]
    v_mfma_f32_16x16x32_bf16 v[144:147], v[44:47], a[96:99], v[144:147]
    v_mfma_f32_16x16x32_bf16 v[144:147], v[40:43], a[64:67], v[144:147]
    ds_read_b64_tr_b16 v[36:37], v8 offset:30976
    ds_read_b64_tr_b16 v[38:39], v8 offset:36096
    v_mfma_f32_16x16x32_bf16 v[160:163], v[16:19], a[64:67], v[160:163]
    s_add_u32 s6, s6, 4096
    s_add_u32 m0, s34, 118784
    v_mfma_f32_16x16x32_bf16 v[160:163], v[20:23], a[96:99], v[160:163]
    buffer_load_dwordx4 v3, s[48:51], s6 offen sc1 lds
    v_mfma_f32_16x16x32_bf16 v[164:167], v[20:23], a[100:103], v[164:167]
    ds_read_b64_tr_b16 v[40:41], v9 offset:20736
    ds_read_b64_tr_b16 v[42:43], v9 offset:25856
    v_mfma_f32_16x16x32_bf16 v[164:167], v[16:19], a[68:71], v[164:167]
    v_mfma_f32_16x16x32_bf16 v[168:171], v[16:19], a[72:75], v[168:171]
    v_mfma_f32_16x16x32_bf16 v[168:171], v[20:23], a[104:107], v[168:171]
    ds_read_b64_tr_b16 v[44:45], v9 offset:30976
    ds_read_b64_tr_b16 v[46:47], v9 offset:36096
    v_mfma_f32_16x16x32_bf16 v[172:175], v[20:23], a[108:111], v[172:175]
    v_mfma_f32_16x16x32_bf16 v[172:175], v[16:19], a[76:79], v[172:175]
    s_waitcnt lgkmcnt(4)
    v_mfma_f32_16x16x32_bf16 v[188:191], v[24:27], a[76:79], v[188:191]
    s_nop 0
    v_mfma_f32_16x16x32_bf16 v[188:191], v[28:31], a[108:111], v[188:191]
    v_mfma_f32_16x16x32_bf16 v[184:187], v[28:31], a[104:107], v[184:187]
    v_mfma_f32_16x16x32_bf16 v[184:187], v[24:27], a[72:75], v[184:187]
    v_mfma_f32_16x16x32_bf16 v[180:183], v[24:27], a[68:71], v[180:183]
    s_waitcnt vmcnt(11) lgkmcnt(0)
    s_barrier
    s_cmp_lg_u32 s30, 0
    s_cbranch_scc1 L_sig19
    s_lshr_b32 s3, s82, 1
    s_lshl_b32 s3, s3, 8
    s_add_u32 s3, s3, 79695872
    s_mov_b64 exec, 1
    v_mov_b32 v54, 0
    v_mov_b32_e64 v55, 1
    buffer_atomic_add v55, v54, s[48:51], s3 offen
    s_mov_b64 exec, -1
L_sig19:
    s_waitcnt vmcnt(8)
    v_cmp_gt_u32 vcc, 4, v57
    s_cbranch_vccnz L_slow15
L_ok15:
    v_mfma_f32_16x16x32_bf16 v[180:183], v[28:31], a[100:103], v[180:183]
    ds_read_b64_tr_b16 v[16:17], v10 offset:0
    ds_read_b64_tr_b16 v[18:19], v10 offset:5120
    v_mfma_f32_16x16x32_bf16 v[176:179], v[28:31], a[96:99], v[176:179]
    v_mfma_f32_16x16x32_bf16 v[176:179], v[24:27], a[64:67], v[176:179]
    ds_read_b64_tr_b16 v[20:21], v10 offset:10240
    ds_read_b64_tr_b16 v[22:23], v10 offset:15360
    v_mfma_f32_16x16x32_bf16 v[192:195], v[32:35], a[64:67], v[192:195]
    s_cmp_le_u32 s32, 1
    s_cselect_b32 s6, 2, 1
    s_mul_i32 s6, s6, 61440
    s_add_u32 s6, s6, s70
    s_add_u32 m0, s34, 0
    v_mfma_f32_16x16x32_bf16 v[192:195], v[36:39], a[96:99], v[192:195]
    buffer_load_dwordx4 v3, s[48:51], s6 offen sc1 lds
    v_mfma_f32_16x16x32_bf16 v[196:199], v[36:39], a[100:103], v[196:199]
    s_cmp_le_u32 s32, 0
    s_cselect_b32 s7, 1, 0
    s_mul_i32 s7, s7, 6144
    s_add_u32 s7, s7, s72
    v_mfma_f32_16x16x32_bf16 v[196:199], v[32:35], a[68:71], v[196:199]
    buffer_load_dwordx4 a[16:19], v60, s[48:51], s7 offen sc1
    s_nop 0
    v_mfma_f32_16x16x32_bf16 v[200:203], v[32:35], a[72:75], v[200:203]
    s_mul_i32 s8, s33, 245760
    ds_read_b64_tr_b16 v[24:25], v11 offset:0
    ds_read_b64_tr_b16 v[26:27], v11 offset:5120
    v_mfma_f32_16x16x32_bf16 v[200:203], v[36:39], a[104:107], v[200:203]
    buffer_load_dwordx4 a[20:23], v61, s[48:51], s7 offen sc1
    v_mfma_f32_16x16x32_bf16 v[204:207], v[36:39], a[108:111], v[204:207]
    s_add_u32 s8, s8, 85852160
    v_mfma_f32_16x16x32_bf16 v[204:207], v[32:35], a[76:79], v[204:207]
    s_add_u32 s9, s71, 256
    ds_read_b64_tr_b16 v[28:29], v11 offset:10240
    ds_read_b64_tr_b16 v[30:31], v11 offset:15360
    v_mfma_f32_16x16x32_bf16 v[220:223], v[40:43], a[76:79], v[220:223]
    s_lshl_b32 s11, s31, 2
    v_mfma_f32_16x16x32_bf16 v[220:223], v[44:47], a[108:111], v[220:223]
    s_add_u32 s11, s11, s32
    v_mfma_f32_16x16x32_bf16 v[216:219], v[44:47], a[104:107], v[216:219]
    s_lshl_b32 s11, s11, 2
    v_mfma_f32_16x16x32_bf16 v[216:219], v[40:43], a[72:75], v[216:219]
    s_add_u32 s11, s11, s30
    v_mfma_f32_16x16x32_bf16 v[212:215], v[40:43], a[68:71], v[212:215]
    s_mul_i32 s11, s11, 49152
    ds_read_b64_tr_b16 v[32:33], v10 offset:64
    ds_read_b64_tr_b16 v[34:35], v10 offset:5184
    v_mfma_f32_16x16x32_bf16 v[212:215], v[44:47], a[100:103], v[212:215]
    buffer_load_dwordx4 a[24:27], v62, s[48:51], s7 offen sc1
    v_mfma_f32_16x16x32_bf16 v[208:211], v[44:47], a[96:99], v[208:211]
    s_add_u32 s11, s11, 9437184
    v_mfma_f32_16x16x32_bf16 v[208:211], v[40:43], a[64:67], v[208:211]
    s_waitcnt lgkmcnt(2)
    s_nop 0
    s_mul_i32 s35, s31, 2621440
    ds_read_b64_tr_b16 v[36:37], v10 offset:10304
    ds_read_b64_tr_b16 v[38:39], v10 offset:15424
    v_mfma_f32_16x16x32_bf16 v[64:67], v[16:19], a[128:131], v[64:67]
    s_add_u32 s6, s6, 4096
    s_add_u32 m0, s34, 4096
    v_mfma_f32_16x16x32_bf16 v[64:67], v[20:23], a[160:163], v[64:67]
    buffer_load_dwordx4 v3, s[48:51], s6 offen sc1 lds
    v_mfma_f32_16x16x32_bf16 v[68:71], v[20:23], a[164:167], v[68:71]
    s_lshl_b32 s3, s33, 2
    v_mfma_f32_16x16x32_bf16 v[68:71], v[16:19], a[132:135], v[68:71]
    buffer_load_dwordx4 a[28:31], v63, s[48:51], s7 offen sc1
    v_mfma_f32_16x16x32_bf16 v[72:75], v[16:19], a[136:139], v[72:75]
    s_add_u32 s3, s3, s30
    ds_read_b64_tr_b16 v[40:41], v11 offset:64
    ds_read_b64_tr_b16 v[42:43], v11 offset:5184
    v_mfma_f32_16x16x32_bf16 v[72:75], v[20:23], a[168:171], v[72:75]
    s_mul_i32 s3, s3, 81920
    v_mfma_f32_16x16x32_bf16 v[76:79], v[20:23], a[172:175], v[76:79]
    s_add_u32 s35, s35, s3
    v_mfma_f32_16x16x32_bf16 v[76:79], v[16:19], a[140:143], v[76:79]
    s_mul_i32 s3, s32, 5120
    ds_read_b64_tr_b16 v[44:45], v11 offset:10304
    ds_read_b64_tr_b16 v[46:47], v11 offset:15424
    v_mfma_f32_16x16x32_bf16 v[92:95], v[24:27], a[140:143], v[92:95]
    s_add_u32 s35, s35, s3
    v_mfma_f32_16x16x32_bf16 v[92:95], v[28:31], a[172:175], v[92:95]
    s_add_u32 s35, s35, 50331648
    v_mfma_f32_16x16x32_bf16 v[88:91], v[28:31], a[168:171], v[88:91]
    buffer_load_dwordx4 a[48:51], v60, s[48:51], s7 offen offset:1024 sc1
    v_mfma_f32_16x16x32_bf16 v[88:91], v[24:27], a[136:139], v[88:91]
    s_add_u32 s66, s32, 0
    v_mfma_f32_16x16x32_bf16 v[84:87], v[24:27], a[132:135], v[84:87]
    s_and_b32 s66, s66, 3
    ds_read_b64_tr_b16 v[16:17], v10 offset:128
    ds_read_b64_tr_b16 v[18:19], v10 offset:5248
    v_mfma_f32_16x16x32_bf16 v[84:87], v[28:31], a[164:167], v[84:87]
    s_add_u32 s6, s6, 4096
    s_add_u32 m0, s34, 8192
    v_mfma_f32_16x16x32_bf16 v[80:83], v[28:31], a[160:163], v[80:83]
    buffer_load_dwordx4 v3, s[48:51], s6 offen sc1 lds
    v_mfma_f32_16x16x32_bf16 v[80:83], v[24:27], a[128:131], v[80:83]
    s_waitcnt lgkmcnt(2)
    s_mul_i32 s66, s66, 20480
    ds_read_b64_tr_b16 v[20:21], v10 offset:10368
    ds_read_b64_tr_b16 v[22:23], v10 offset:15488
    v_mfma_f32_16x16x32_bf16 v[96:99], v[32:35], a[128:131], v[96:99]
    s_add_u32 s66, s66, s35
    v_mfma_f32_16x16x32_bf16 v[96:99], v[36:39], a[160:163], v[96:99]
    buffer_load_dwordx4 a[52:55], v61, s[48:51], s7 offen offset:1024 sc1
    v_mfma_f32_16x16x32_bf16 v[100:103], v[36:39], a[164:167], v[100:103]
    s_add_u32 s67, s32, 1
    v_mfma_f32_16x16x32_bf16 v[100:103], v[32:35], a[132:135], v[100:103]
    s_and_b32 s67, s67, 3
    v_mfma_f32_16x16x32_bf16 v[104:107], v[32:35], a[136:139], v[104:107]
    s_mul_i32 s67, s67, 20480
    ds_read_b64_tr_b16 v[24:25], v11 offset:128
    ds_read_b64_tr_b16 v[26:27], v11 offset:5248
    v_mfma_f32_16x16x32_bf16 v[104:107], v[36:39], a[168:171], v[104:107]
    s_add_u32 s67, s67, s35
    v_mfma_f32_16x16x32_bf16 v[108:111], v[36:39], a[172:175], v[108:111]
    s_add_u32 s68, s32, 2
    v_mfma_f32_16x16x32_bf16 v[108:111], v[32:35], a[140:143], v[108:111]
    s_and_b32 s68, s68, 3
    ds_read_b64_tr_b16 v[28:29], v11 offset:10368
    ds_read_b64_tr_b16 v[30:31], v11 offset:15488
    v_mfma_f32_16x16x32_bf16 v[124:127], v[40:43], a[140:143], v[124:127]
    buffer_load_dwordx4 a[56:59], v62, s[48:51], s7 offen offset:1024 sc1
    v_mfma_f32_16x16x32_bf16 v[124:127], v[44:47], a[172:175], v[124:127]
    s_mul_i32 s68, s68, 20480
    v_mfma_f32_16x16x32_bf16 v[120:123], v[44:47], a[168:171], v[120:123]
    s_add_u32 s68, s68, s35
    v_mfma_f32_16x16x32_bf16 v[120:123], v[40:43], a[136:139], v[120:123]
    s_add_u32 s69, s32, 3
    v_mfma_f32_16x16x32_bf16 v[116:119], v[40:43], a[132:135], v[116:119]
    s_and_b32 s69, s69, 3
    ds_read_b64_tr_b16 v[32:33], v10 offset:192
    ds_read_b64_tr_b16 v[34:35], v10 offset:5312
    v_mfma_f32_16x16x32_bf16 v[116:119], v[44:47], a[164:167], v[116:119]
    s_add_u32 s6, s6, 4096
    s_add_u32 m0, s34, 12288
    v_mfma_f32_16x16x32_bf16 v[112:115], v[44:47], a[160:163], v[112:115]
    buffer_load_dwordx4 v3, s[48:51], s6 offen sc1 lds
    v_mfma_f32_16x16x32_bf16 v[112:115], v[40:43], a[128:131], v[112:115]
    s_nop 0
    s_waitcnt lgkmcnt(2)
    s_mul_i32 s69, s69, 20480
    ds_read_b64_tr_b16 v[36:37], v10 offset:10432
    ds_read_b64_tr_b16 v[38:39], v10 offset:15552
    v_mfma_f32_16x16x32_bf16 v[128:131], v[16:19], a[128:131], v[128:131]
    buffer_load_dwordx4 a[60:63], v63, s[48:51], s7 offen offset:1024 sc1
    v_mfma_f32_16x16x32_bf16 v[128:131], v[20:23], a[160:163], v[128:131]
    s_add_u32 s69, s69, s35
    v_mfma_f32_16x16x32_bf16 v[132:135], v[20:23], a[164:167], v[132:135]
    s_mov_b32 s40, s24
    v_mfma_f32_16x16x32_bf16 v[132:135], v[16:19], a[132:135], v[132:135]
    s_and_b32 s41, s25, 0xffff
    v_mfma_f32_16x16x32_bf16 v[136:139], v[16:19], a[136:139], v[136:139]
    s_mov_b32 s42, 2621440
    ds_read_b64_tr_b16 v[40:41], v11 offset:192
    ds_read_b64_tr_b16 v[42:43], v11 offset:5312
    v_mfma_f32_16x16x32_bf16 v[136:139], v[20:23], a[168:171], v[136:139]
    s_mov_b32 s43, 0x00020000
    v_mfma_f32_16x16x32_bf16 v[140:143], v[20:23], a[172:175], v[140:143]
    s_lshl_b32 s60, s31, 2
    v_mfma_f32_16x16x32_bf16 v[140:143], v[16:19], a[140:143], v[140:143]
    s_add_u32 s60, s60, s32
    ds_read_b64_tr_b16 v[44:45], v11 offset:10432
    ds_read_b64_tr_b16 v[46:47], v11 offset:15552
    v_mfma_f32_16x16x32_bf16 v[156:159], v[24:27], a[140:143], v[156:159]
    buffer_load_dwordx4 a[80:83], v60, s[48:51], s7 offen offset:2048 sc1
    v_mfma_f32_16x16x32_bf16 v[156:159], v[28:31], a[172:175], v[156:159]
    s_lshl_b32 s60, s60, 2
    v_mfma_f32_16x16x32_bf16 v[152:155], v[28:31], a[168:171], v[152:155]
    s_add_u32 s6, s6, 4096
    s_add_u32 m0, s34, 16384
    v_mfma_f32_16x16x32_bf16 v[152:155], v[24:27], a[136:139], v[152:155]
    buffer_load_dwordx4 v3, s[48:51], s6 offen sc1 lds
    v_mfma_f32_16x16x32_bf16 v[148:151], v[24:27], a[132:135], v[148:151]
    s_add_u32 s60, s60, s30
    ds_read_b64_tr_b16 v[16:17], v10 offset:256
    ds_read_b64_tr_b16 v[18:19], v10 offset:5376
    v_mfma_f32_16x16x32_bf16 v[148:151], v[28:31], a[164:167], v[148:151]
    s_mul_i32 s60, s60, 20480
    v_mfma_f32_16x16x32_bf16 v[144:147], v[28:31], a[160:163], v[144:147]
    s_add_u32 s60, s60, 6291456
    v_mfma_f32_16x16x32_bf16 v[144:147], v[24:27], a[128:131], v[144:147]
    s_waitcnt lgkmcnt(2)
    s_lshr_b32 s3, s33, 1
    ds_read_b64_tr_b16 v[20:21], v10 offset:10496
    ds_read_b64_tr_b16 v[22:23], v10 offset:15616
    v_mfma_f32_16x16x32_bf16 v[160:163], v[32:35], a[128:131], v[160:163]
    buffer_load_dwordx4 a[84:87], v61, s[48:51], s7 offen offset:2048 sc1
    v_mfma_f32_16x16x32_bf16 v[160:163], v[36:39], a[160:163], v[160:163]
    s_mul_i32 s3, s3, 5120
    v_mfma_f32_16x16x32_bf16 v[164:167], v[36:39], a[164:167], v[164:167]
    s_add_u32 s60, s60, s3
    v_mfma_f32_16x16x32_bf16 v[164:167], v[32:35], a[132:135], v[164:167]
    s_and_b32 s3, s33, 1
    v_mfma_f32_16x16x32_bf16 v[168:171], v[32:35], a[136:139], v[168:171]
    s_lshl_b32 s35, s3, 3
    ds_read_b64_tr_b16 v[24:25], v11 offset:256
    ds_read_b64_tr_b16 v[26:27], v11 offset:5376
    v_mfma_f32_16x16x32_bf16 v[168:171], v[36:39], a[168:171], v[168:171]
    s_add_u32 s61, s60, s35
    v_mfma_f32_16x16x32_bf16 v[172:175], v[36:39], a[172:175], v[172:175]
    buffer_load_dwordx4 a[88:91], v62, s[48:51], s7 offen offset:2048 sc1
    v_mfma_f32_16x16x32_bf16 v[172:175], v[32:35], a[140:143], v[172:175]
    s_add_u32 s61, s61, 4096
    ds_read_b64_tr_b16 v[28:29], v11 offset:10496
    ds_read_b64_tr_b16 v[30:31], v11 offset:15616
    v_mfma_f32_16x16x32_bf16 v[188:191], v[40:43], a[140:143], v[188:191]
    s_lshl_b32 s3, s3, 11
    v_mfma_f32_16x16x32_bf16 v[188:191], v[44:47], a[172:175], v[188:191]
    s_add_u32 s60, s60, s3
    v_mfma_f32_16x16x32_bf16 v[184:187], v[44:47], a[168:171], v[184:187]
    s_add_u32 s6, s6, 4096
    s_add_u32 m0, s34, 20480
    v_mfma_f32_16x16x32_bf16 v[184:187], v[40:43], a[136:139], v[184:187]
    buffer_load_dwordx4 v3, s[48:51], s6 offen sc1 lds
    v_mfma_f32_16x16x32_bf16 v[180:183], v[40:43], a[132:135], v[180:183]
    s_lshl_b32 s80, s31, 2
    ds_read_b64_tr_b16 v[32:33], v10 offset:20480
    ds_read_b64_tr_b16 v[34:35], v10 offset:25600
    s_nop 0
    v_mfma_f32_16x16x32_bf16 v[180:183], v[44:47], a[164:167], v[180:183]
    buffer_load_dwordx4 a[92:95], v63, s[48:51], s7 offen offset:2048 sc1
    v_mfma_f32_16x16x32_bf16 v[176:179], v[44:47], a[160:163], v[176:179]
    s_add_u32 s80, s80, s32
    v_mfma_f32_16x16x32_bf16 v[176:179], v[40:43], a[128:131], v[176:179]
    s_waitcnt lgkmcnt(2)
    s_lshl_b32 s80, s80, 2
    ds_read_b64_tr_b16 v[36:37], v10 offset:30720
    ds_read_b64_tr_b16 v[38:39], v10 offset:35840
    v_mfma_f32_16x16x32_bf16 v[192:195], v[16:19], a[128:131], v[192:195]
    s_add_u32 s80, s80, s30
    v_mfma_f32_16x16x32_bf16 v[192:195], v[20:23], a[160:163], v[192:195]
    s_mul_i32 s80, s80, 20480
    v_mfma_f32_16x16x32_bf16 v[196:199], v[20:23], a[164:167], v[196:199]
    s_mul_i32 s3, s33, 160
    v_mfma_f32_16x16x32_bf16 v[196:199], v[16:19], a[132:135], v[196:199]
    s_add_u32 s80, s80, s3
    v_mfma_f32_16x16x32_bf16 v[200:203], v[16:19], a[136:139], v[200:203]
    s_lshr_b32 s81, s33, 1
    ds_read_b64_tr_b16 v[40:41], v11 offset:20480
    ds_read_b64_tr_b16 v[42:43], v11 offset:25600
    v_mfma_f32_16x16x32_bf16 v[200:203], v[20:23], a[168:171], v[200:203]
    buffer_load_dwordx4 a[112:115], v60, s[48:51], s7 offen offset:3072 sc1
    v_mfma_f32_16x16x32_bf16 v[204:207], v[20:23], a[172:175], v[204:207]
    s_lshl_b32 s82, s31, 2
    v_mfma_f32_16x16x32_bf16 v[204:207], v[16:19], a[140:143], v[204:207]
    s_add_u32 s82, s82, s81
    ds_read_b64_tr_b16 v[44:45], v11 offset:30720
    ds_read_b64_tr_b16 v[46:47], v11 offset:35840
    v_mfma_f32_16x16x32_bf16 v[220:223], v[24:27], a[140:143], v[220:223]
    s_lshl_b32 s82, s82, 8
    v_mfma_f32_16x16x32_bf16 v[220:223], v[28:31], a[172:175], v[220:223]
    s_nop 0
    s_add_u32 s6, s6, 4096
    s_add_u32 m0, s34, 24576
    v_mfma_f32_16x16x32_bf16 v[216:219], v[28:31], a[168:171], v[216:219]
    buffer_load_dwordx4 v3, s[48:51], s6 offen sc1 lds
    v_mfma_f32_16x16x32_bf16 v[216:219], v[24:27], a[136:139], v[216:219]
    s_add_u32 s82, s82, 79716352
    v_mfma_f32_16x16x32_bf16 v[212:215], v[24:27], a[132:135], v[212:215]
    s_lshl_b32 s78, s31, 2
    ds_read_b64_tr_b16 v[16:17], v10 offset:20544
    ds_read_b64_tr_b16 v[18:19], v10 offset:25664
    v_mfma_f32_16x16x32_bf16 v[212:215], v[28:31], a[164:167], v[212:215]
    buffer_load_dwordx4 a[116:119], v61, s[48:51], s7 offen offset:3072 sc1
    v_mfma_f32_16x16x32_bf16 v[208:211], v[28:31], a[160:163], v[208:211]
    s_add_u32 s78, s78, s32
    v_mfma_f32_16x16x32_bf16 v[208:211], v[24:27], a[128:131], v[208:211]
    s_waitcnt vmcnt(19) lgkmcnt(2)
    s_lshl_b32 s78, s78, 2
    ds_read_b64_tr_b16 v[20:21], v10 offset:30784
    ds_read_b64_tr_b16 v[22:23], v10 offset:35904
    v_mfma_f32_16x16x32_bf16 v[64:67], v[32:35], a[16:19], v[64:67]
    s_waitcnt vmcnt(14)
    s_add_u32 s78, s78, s30
    v_mfma_f32_16x16x32_bf16 v[64:67], v[36:39], a[48:51], v[64:67]
    s_nop 0
    s_waitcnt vmcnt(12)
    s_mul_i32 s78, s78, 20480
    v_mfma_f32_16x16x32_bf16 v[68:71], v[36:39], a[52:55], v[68:71]
    s_add_u32 s78, s78, 50331648
    v_mfma_f32_16x16x32_bf16 v[68:71], v[32:35], a[20:23], v[68:71]
    buffer_load_dwordx4 a[120:123], v62, s[48:51], s7 offen offset:3072 sc1
    v_mfma_f32_16x16x32_bf16 v[72:75], v[32:35], a[24:27], v[72:75]
    s_waitcnt vmcnt(12)
    s_lshr_b32 s3, s33, 1
    ds_read_b64_tr_b16 v[24:25], v11 offset:20544
    ds_read_b64_tr_b16 v[26:27], v11 offset:25664
    v_mfma_f32_16x16x32_bf16 v[72:75], v[36:39], a[56:59], v[72:75]
    s_waitcnt vmcnt(10)
    s_nop 0
    s_mul_i32 s3, s3, 5120
    v_mfma_f32_16x16x32_bf16 v[76:79], v[36:39], a[60:63], v[76:79]
    s_add_u32 s78, s78, s3
    v_mfma_f32_16x16x32_bf16 v[76:79], v[32:35], a[28:31], v[76:79]
    s_and_b32 s3, s33, 1
    ds_read_b64_tr_b16 v[28:29], v11 offset:30784
    ds_read_b64_tr_b16 v[30:31], v11 offset:35904
    v_mfma_f32_16x16x32_bf16 v[92:95], v[40:43], a[28:31], v[92:95]
    s_add_u32 s6, s6, 4096
    s_add_u32 m0, s34, 28672
    v_mfma_f32_16x16x32_bf16 v[92:95], v[44:47], a[60:63], v[92:95]
    buffer_load_dwordx4 v3, s[48:51], s6 offen sc1 lds
    v_mfma_f32_16x16x32_bf16 v[88:91], v[44:47], a[56:59], v[88:91]
    s_lshl_b32 s35, s3, 3
    v_mfma_f32_16x16x32_bf16 v[88:91], v[40:43], a[24:27], v[88:91]
    buffer_load_dwordx4 a[124:127], v63, s[48:51], s7 offen offset:3072 sc1
    v_mfma_f32_16x16x32_bf16 v[84:87], v[40:43], a[20:23], v[84:87]
    s_add_u32 s79, s78, s35
    ds_read_b64_tr_b16 v[32:33], v10 offset:20608
    ds_read_b64_tr_b16 v[34:35], v10 offset:25728
    v_mfma_f32_16x16x32_bf16 v[84:87], v[44:47], a[52:55], v[84:87]
    s_add_u32 s79, s79, 4096
    v_mfma_f32_16x16x32_bf16 v[80:83], v[44:47], a[48:51], v[80:83]
    s_lshl_b32 s3, s3, 11
    v_mfma_f32_16x16x32_bf16 v[80:83], v[40:43], a[16:19], v[80:83]
    s_waitcnt lgkmcnt(2)
    s_add_u32 s78, s78, s3
    ds_read_b64_tr_b16 v[36:37], v10 offset:30848
    ds_read_b64_tr_b16 v[38:39], v10 offset:35968
    v_mfma_f32_16x16x32_bf16 v[96:99], v[16:19], a[16:19], v[96:99]
    s_and_b32 s3, s33, 1
    v_mfma_f32_16x16x32_bf16 v[96:99], v[20:23], a[48:51], v[96:99]
    s_add_u32 s7, s7, 4096
    v_mfma_f32_16x16x32_bf16 v[100:103], v[20:23], a[52:55], v[100:103]
    buffer_load_dwordx4 a[144:147], v60, s[48:51], s7 offen sc1
    v_mfma_f32_16x16x32_bf16 v[100:103], v[16:19], a[20:23], v[100:103]
    s_mul_i32 s3, s3, 504
    v_mfma_f32_16x16x32_bf16 v[104:107], v[16:19], a[24:27], v[104:107]
    s_add_u32 s79, s79, s3
    ds_read_b64_tr_b16 v[40:41], v11 offset:20608
    ds_read_b64_tr_b16 v[42:43], v11 offset:25728
    v_mfma_f32_16x16x32_bf16 v[104:107], v[20:23], a[56:59], v[104:107]
    s_mov_b32 s83, 0
    v_mfma_f32_16x16x32_bf16 v[108:111], v[20:23], a[60:63], v[108:111]
    s_mov_b32 s14, 0xbfb8aa3b
    v_mfma_f32_16x16x32_bf16 v[108:111], v[16:19], a[28:31], v[108:111]
    s_mov_b32 s15, 0xbfb8aa3b
    ds_read_b64_tr_b16 v[44:45], v11 offset:30848
    ds_read_b64_tr_b16 v[46:47], v11 offset:35968
    v_mfma_f32_16x16x32_bf16 v[124:127], v[24:27], a[28:31], v[124:127]
    s_add_u32 s6, s6, 4096
    s_add_u32 m0, s34, 32768
    v_mfma_f32_16x16x32_bf16 v[124:127], v[28:31], a[60:63], v[124:127]
    buffer_load_dwordx4 v3, s[48:51], s6 offen sc1 lds
    v_mfma_f32_16x16x32_bf16 v[120:123], v[28:31], a[56:59], v[120:123]
    s_mov_b32 s62, 0x00003f80
    v_mfma_f32_16x16x32_bf16 v[120:123], v[24:27], a[24:27], v[120:123]
    buffer_load_dwordx4 a[148:151], v61, s[48:51], s7 offen sc1
    v_mfma_f32_16x16x32_bf16 v[116:119], v[24:27], a[20:23], v[116:119]
    s_mov_b32 s63, 0x3f800000
    ds_read_b64_tr_b16 v[16:17], v10 offset:20672
    ds_read_b64_tr_b16 v[18:19], v10 offset:25792
    v_mfma_f32_16x16x32_bf16 v[116:119], v[28:31], a[52:55], v[116:119]
    s_lshr_b32 s10, s2, 3
    v_mfma_f32_16x16x32_bf16 v[112:115], v[28:31], a[48:51], v[112:115]
    s_lshl_b32 s10, s10, 8
    v_mfma_f32_16x16x32_bf16 v[112:115], v[24:27], a[16:19], v[112:115]
    s_waitcnt lgkmcnt(2)
    s_add_u32 s10, s10, 79716352
    ds_read_b64_tr_b16 v[20:21], v10 offset:30912
    ds_read_b64_tr_b16 v[22:23], v10 offset:36032
    v_mfma_f32_16x16x32_bf16 v[128:131], v[32:35], a[16:19], v[128:131]
    buffer_load_dwordx4 a[152:155], v62, s[48:51], s7 offen sc1
    v_mfma_f32_16x16x32_bf16 v[128:131], v[36:39], a[48:51], v[128:131]
    s_lshl_b32 s35, s31, 2
    v_mfma_f32_16x16x32_bf16 v[132:135], v[36:39], a[52:55], v[132:135]
    s_add_u32 s10, s10, s35
    v_mfma_f32_16x16x32_bf16 v[132:135], v[32:35], a[20:23], v[132:135]
    v_mfma_f32_16x16x32_bf16 v[136:139], v[32:35], a[24:27], v[136:139]
    ds_read_b64_tr_b16 v[24:25], v11 offset:20672
    ds_read_b64_tr_b16 v[26:27], v11 offset:25792
    v_mfma_f32_16x16x32_bf16 v[136:139], v[36:39], a[56:59], v[136:139]
    v_mfma_f32_16x16x32_bf16 v[140:143], v[36:39], a[60:63], v[140:143]
    v_mfma_f32_16x16x32_bf16 v[140:143], v[32:35], a[28:31], v[140:143]
    ds_read_b64_tr_b16 v[28:29], v11 offset:30912
    ds_read_b64_tr_b16 v[30:31], v11 offset:36032
    v_mfma_f32_16x16x32_bf16 v[156:159], v[40:43], a[28:31], v[156:159]
    buffer_load_dwordx4 a[156:159], v63, s[48:51], s7 offen sc1
    v_mfma_f32_16x16x32_bf16 v[156:159], v[44:47], a[60:63], v[156:159]
    s_add_u32 s6, s6, 4096
    s_add_u32 m0, s34, 36864
    v_mfma_f32_16x16x32_bf16 v[152:155], v[44:47], a[56:59], v[152:155]
    buffer_load_dwordx4 v3, s[48:51], s6 offen sc1 lds
    v_mfma_f32_16x16x32_bf16 v[152:155], v[40:43], a[24:27], v[152:155]
    v_mfma_f32_16x16x32_bf16 v[148:151], v[40:43], a[20:23], v[148:151]
    s_add_u32 m0, s34, 122880
    ds_read_b64_tr_b16 v[32:33], v10 offset:20736
    ds_read_b64_tr_b16 v[34:35], v10 offset:25856
    v_mfma_f32_16x16x32_bf16 v[148:151], v[44:47], a[52:55], v[148:151]
    buffer_load_dwordx4 v3, s[48:51], s8 offen sc1 lds
    v_mfma_f32_16x16x32_bf16 v[144:147], v[44:47], a[48:51], v[144:147]
    s_nop 0
    v_mfma_f32_16x16x32_bf16 v[144:147], v[40:43], a[16:19], v[144:147]
    s_waitcnt lgkmcnt(2)
    ds_read_b64_tr_b16 v[36:37], v10 offset:30976
    ds_read_b64_tr_b16 v[38:39], v10 offset:36096
    v_mfma_f32_16x16x32_bf16 v[160:163], v[16:19], a[16:19], v[160:163]
    buffer_load_dwordx4 a[176:179], v60, s[48:51], s7 offen offset:1024 sc1
    v_mfma_f32_16x16x32_bf16 v[160:163], v[20:23], a[48:51], v[160:163]
    v_mfma_f32_16x16x32_bf16 v[164:167], v[20:23], a[52:55], v[164:167]
    ds_read_b64_tr_b16 v[40:41], v11 offset:20736
    ds_read_b64_tr_b16 v[42:43], v11 offset:25856
    v_mfma_f32_16x16x32_bf16 v[164:167], v[16:19], a[20:23], v[164:167]
    v_mfma_f32_16x16x32_bf16 v[168:171], v[16:19], a[24:27], v[168:171]
    v_mfma_f32_16x16x32_bf16 v[168:171], v[20:23], a[56:59], v[168:171]
    ds_read_b64_tr_b16 v[44:45], v11 offset:30976
    ds_read_b64_tr_b16 v[46:47], v11 offset:36096
    v_mfma_f32_16x16x32_bf16 v[172:175], v[20:23], a[60:63], v[172:175]
    buffer_load_dwordx4 a[180:183], v61, s[48:51], s7 offen offset:1024 sc1
    v_mfma_f32_16x16x32_bf16 v[172:175], v[16:19], a[28:31], v[172:175]
    v_mfma_f32_16x16x32_bf16 v[188:191], v[24:27], a[28:31], v[188:191]
    v_mfma_f32_16x16x32_bf16 v[188:191], v[28:31], a[60:63], v[188:191]
    v_mfma_f32_16x16x32_bf16 v[184:187], v[28:31], a[56:59], v[184:187]
    v_mfma_f32_16x16x32_bf16 v[184:187], v[24:27], a[24:27], v[184:187]
    v_mfma_f32_16x16x32_bf16 v[180:183], v[24:27], a[20:23], v[180:183]
    s_waitcnt lgkmcnt(0)
    s_barrier
    v_mfma_f32_16x16x32_bf16 v[180:183], v[28:31], a[52:55], v[180:183]
    ds_read_b64_tr_b16 v[16:17], v12 offset:0
    ds_read_b64_tr_b16 v[18:19], v12 offset:5120
    v_mfma_f32_16x16x32_bf16 v[176:179], v[28:31], a[48:51], v[176:179]
    buffer_load_dwordx4 a[184:187], v62, s[48:51], s7 offen offset:1024 sc1
    v_mfma_f32_16x16x32_bf16 v[176:179], v[24:27], a[16:19], v[176:179]
    ds_read_b64_tr_b16 v[20:21], v12 offset:10240
    ds_read_b64_tr_b16 v[22:23], v12 offset:15360
    v_mfma_f32_16x16x32_bf16 v[192:195], v[32:35], a[16:19], v[192:195]
    s_add_u32 s8, s8, 4096
    s_add_u32 m0, s34, 126976
    v_mfma_f32_16x16x32_bf16 v[192:195], v[36:39], a[48:51], v[192:195]
    buffer_load_dwordx4 v3, s[48:51], s8 offen sc1 lds
    v_mfma_f32_16x16x32_bf16 v[196:199], v[36:39], a[52:55], v[196:199]
    s_add_u32 s6, s6, 4096
    s_add_u32 m0, s34, 40960
    v_mfma_f32_16x16x32_bf16 v[196:199], v[32:35], a[20:23], v[196:199]
    buffer_load_dwordx4 v3, s[48:51], s6 offen sc1 lds
    v_mfma_f32_16x16x32_bf16 v[200:203], v[32:35], a[24:27], v[200:203]
    ds_read_b64_tr_b16 v[24:25], v13 offset:0
    ds_read_b64_tr_b16 v[26:27], v13 offset:5120
    v_mfma_f32_16x16x32_bf16 v[200:203], v[36:39], a[56:59], v[200:203]
    buffer_load_dwordx4 a[188:191], v63, s[48:51], s7 offen offset:1024 sc1
    v_mfma_f32_16x16x32_bf16 v[204:207], v[36:39], a[60:63], v[204:207]
    v_mfma_f32_16x16x32_bf16 v[204:207], v[32:35], a[28:31], v[204:207]
    ds_read_b64_tr_b16 v[28:29], v13 offset:10240
    ds_read_b64_tr_b16 v[30:31], v13 offset:15360
    v_mfma_f32_16x16x32_bf16 v[220:223], v[40:43], a[28:31], v[220:223]
    v_mfma_f32_16x16x32_bf16 v[220:223], v[44:47], a[60:63], v[220:223]
    v_mfma_f32_16x16x32_bf16 v[216:219], v[44:47], a[56:59], v[216:219]
    v_mfma_f32_16x16x32_bf16 v[216:219], v[40:43], a[24:27], v[216:219]
    v_mfma_f32_16x16x32_bf16 v[212:215], v[40:43], a[20:23], v[212:215]
    ds_read_b64_tr_b16 v[32:33], v12 offset:64
    ds_read_b64_tr_b16 v[34:35], v12 offset:5184
    v_mfma_f32_16x16x32_bf16 v[212:215], v[44:47], a[52:55], v[212:215]
    s_add_u32 s6, s6, 4096
    s_add_u32 m0, s34, 45056
    v_mfma_f32_16x16x32_bf16 v[208:211], v[44:47], a[48:51], v[208:211]
    buffer_load_dwordx4 v3, s[48:51], s6 offen sc1 lds
    v_mfma_f32_16x16x32_bf16 v[208:211], v[40:43], a[16:19], v[208:211]
    s_waitcnt vmcnt(25) lgkmcnt(2)
    ds_read_b64_tr_b16 v[36:37], v12 offset:10304
    ds_read_b64_tr_b16 v[38:39], v12 offset:15424
    v_mfma_f32_16x16x32_bf16 v[64:67], v[16:19], a[80:83], v[64:67]
    s_waitcnt vmcnt(19)
    s_add_u32 s8, s8, 4096
    s_add_u32 m0, s34, 131072
    v_mfma_f32_16x16x32_bf16 v[64:67], v[20:23], a[112:115], v[64:67]
    s_nop 0
    s_waitcnt vmcnt(17)
    buffer_load_dwordx4 v3, s[48:51], s8 offen sc1 lds
    v_mfma_f32_16x16x32_bf16 v[68:71], v[20:23], a[116:119], v[68:71]
    s_cmp_le_u32 s32, 1
    s_cselect_b32 s7, 2, 1
    s_mul_i32 s7, s7, 6144
    s_add_u32 s7, s7, s72
    v_mfma_f32_16x16x32_bf16 v[68:71], v[16:19], a[84:87], v[68:71]
    buffer_load_dwordx4 a[16:19], v60, s[48:51], s7 offen sc1
    v_mfma_f32_16x16x32_bf16 v[72:75], v[16:19], a[88:91], v[72:75]
    s_waitcnt vmcnt(18)
    ds_read_b64_tr_b16 v[40:41], v13 offset:64
    ds_read_b64_tr_b16 v[42:43], v13 offset:5184
    v_mfma_f32_16x16x32_bf16 v[72:75], v[20:23], a[120:123], v[72:75]
    s_nop 0
    s_waitcnt vmcnt(16)
    v_mfma_f32_16x16x32_bf16 v[76:79], v[20:23], a[124:127], v[76:79]
    v_mfma_f32_16x16x32_bf16 v[76:79], v[16:19], a[92:95], v[76:79]
    ds_read_b64_tr_b16 v[44:45], v13 offset:10304
    ds_read_b64_tr_b16 v[46:47], v13 offset:15424
    v_mfma_f32_16x16x32_bf16 v[92:95], v[24:27], a[92:95], v[92:95]
    v_mfma_f32_16x16x32_bf16 v[92:95], v[28:31], a[124:127], v[92:95]
    v_mfma_f32_16x16x32_bf16 v[88:91], v[28:31], a[120:123], v[88:91]
    buffer_load_dwordx4 a[20:23], v61, s[48:51], s7 offen sc1
    v_mfma_f32_16x16x32_bf16 v[88:91], v[24:27], a[88:91], v[88:91]
    v_mfma_f32_16x16x32_bf16 v[84:87], v[24:27], a[84:87], v[84:87]
    ds_read_b64_tr_b16 v[16:17], v12 offset:128
    ds_read_b64_tr_b16 v[18:19], v12 offset:5248
    v_mfma_f32_16x16x32_bf16 v[84:87], v[28:31], a[116:119], v[84:87]
    s_add_u32 s6, s6, 4096
    s_add_u32 m0, s34, 49152
    v_mfma_f32_16x16x32_bf16 v[80:83], v[28:31], a[112:115], v[80:83]
    buffer_load_dwordx4 v3, s[48:51], s6 offen sc1 lds
    v_mfma_f32_16x16x32_bf16 v[80:83], v[24:27], a[80:83], v[80:83]
    s_waitcnt lgkmcnt(2)
    s_nop 0
    ds_read_b64_tr_b16 v[20:21], v12 offset:10368
    ds_read_b64_tr_b16 v[22:23], v12 offset:15488
    v_mfma_f32_16x16x32_bf16 v[96:99], v[32:35], a[80:83], v[96:99]
    s_add_u32 s8, s8, 4096
    s_add_u32 m0, s34, 135168
    v_mfma_f32_16x16x32_bf16 v[96:99], v[36:39], a[112:115], v[96:99]
    buffer_load_dwordx4 v3, s[48:51], s8 offen sc1 lds
    v_mfma_f32_16x16x32_bf16 v[100:103], v[36:39], a[116:119], v[100:103]
    v_mfma_f32_16x16x32_bf16 v[100:103], v[32:35], a[84:87], v[100:103]
    v_mfma_f32_16x16x32_bf16 v[104:107], v[32:35], a[88:91], v[104:107]
    ds_read_b64_tr_b16 v[24:25], v13 offset:128
    ds_read_b64_tr_b16 v[26:27], v13 offset:5248
    v_mfma_f32_16x16x32_bf16 v[104:107], v[36:39], a[120:123], v[104:107]
    buffer_load_dwordx4 a[24:27], v62, s[48:51], s7 offen sc1
    v_mfma_f32_16x16x32_bf16 v[108:111], v[36:39], a[124:127], v[108:111]
    v_mfma_f32_16x16x32_bf16 v[108:111], v[32:35], a[92:95], v[108:111]
    ds_read_b64_tr_b16 v[28:29], v13 offset:10368
    ds_read_b64_tr_b16 v[30:31], v13 offset:15488
    v_mfma_f32_16x16x32_bf16 v[124:127], v[40:43], a[92:95], v[124:127]
    v_mfma_f32_16x16x32_bf16 v[124:127], v[44:47], a[124:127], v[124:127]
    v_mfma_f32_16x16x32_bf16 v[120:123], v[44:47], a[120:123], v[120:123]
    v_mfma_f32_16x16x32_bf16 v[120:123], v[40:43], a[88:91], v[120:123]
    v_mfma_f32_16x16x32_bf16 v[116:119], v[40:43], a[84:87], v[116:119]
    ds_read_b64_tr_b16 v[32:33], v12 offset:192
    ds_read_b64_tr_b16 v[34:35], v12 offset:5312
    v_mfma_f32_16x16x32_bf16 v[116:119], v[44:47], a[116:119], v[116:119]
    s_add_u32 s6, s6, 4096
    s_add_u32 m0, s34, 53248
    v_mfma_f32_16x16x32_bf16 v[112:115], v[44:47], a[112:115], v[112:115]
    buffer_load_dwordx4 v3, s[48:51], s6 offen sc1 lds
    v_mfma_f32_16x16x32_bf16 v[112:115], v[40:43], a[80:83], v[112:115]
    s_waitcnt lgkmcnt(2)
    s_nop 0
    ds_read_b64_tr_b16 v[36:37], v12 offset:10432
    ds_read_b64_tr_b16 v[38:39], v12 offset:15552
    v_mfma_f32_16x16x32_bf16 v[128:131], v[16:19], a[80:83], v[128:131]
    buffer_load_dwordx4 a[28:31], v63, s[48:51], s7 offen sc1
    v_mfma_f32_16x16x32_bf16 v[128:131], v[20:23], a[112:115], v[128:131]
    s_add_u32 s8, s8, 4096
    s_add_u32 m0, s34, 139264
    v_mfma_f32_16x16x32_bf16 v[132:135], v[20:23], a[116:119], v[132:135]
    buffer_load_dwordx4 v3, s[48:51], s8 offen sc1 lds
    v_mfma_f32_16x16x32_bf16 v[132:135], v[16:19], a[84:87], v[132:135]
    v_mfma_f32_16x16x32_bf16 v[136:139], v[16:19], a[88:91], v[136:139]
    ds_read_b64_tr_b16 v[40:41], v13 offset:192
    ds_read_b64_tr_b16 v[42:43], v13 offset:5312
    v_mfma_f32_16x16x32_bf16 v[136:139], v[20:23], a[120:123], v[136:139]
    v_mfma_f32_16x16x32_bf16 v[140:143], v[20:23], a[124:127], v[140:143]
    v_mfma_f32_16x16x32_bf16 v[140:143], v[16:19], a[92:95], v[140:143]
    ds_read_b64_tr_b16 v[44:45], v13 offset:10432
    ds_read_b64_tr_b16 v[46:47], v13 offset:15552
    v_mfma_f32_16x16x32_bf16 v[156:159], v[24:27], a[92:95], v[156:159]
    buffer_load_dwordx4 a[48:51], v60, s[48:51], s7 offen offset:1024 sc1
    v_mfma_f32_16x16x32_bf16 v[156:159], v[28:31], a[124:127], v[156:159]
    v_mfma_f32_16x16x32_bf16 v[152:155], v[28:31], a[120:123], v[152:155]
    s_add_u32 s6, s6, 4096
    s_add_u32 m0, s34, 57344
    v_mfma_f32_16x16x32_bf16 v[152:155], v[24:27], a[88:91], v[152:155]
    buffer_load_dwordx4 v3, s[48:51], s6 offen sc1 lds
    v_mfma_f32_16x16x32_bf16 v[148:151], v[24:27], a[84:87], v[148:151]
    ds_read_b64_tr_b16 v[16:17], v12 offset:256
    ds_read_b64_tr_b16 v[18:19], v12 offset:5376
    v_mfma_f32_16x16x32_bf16 v[148:151], v[28:31], a[116:119], v[148:151]
    v_mfma_f32_16x16x32_bf16 v[144:147], v[28:31], a[112:115], v[144:147]
    s_nop 0
    v_mfma_f32_16x16x32_bf16 v[144:147], v[24:27], a[80:83], v[144:147]
    s_waitcnt lgkmcnt(2)
    ds_read_b64_tr_b16 v[20:21], v12 offset:10496
    ds_read_b64_tr_b16 v[22:23], v12 offset:15616
    v_mfma_f32_16x16x32_bf16 v[160:163], v[32:35], a[80:83], v[160:163]
    s_add_u32 s8, s8, 4096
    s_add_u32 m0, s34, 143360
    v_mfma_f32_16x16x32_bf16 v[160:163], v[36:39], a[112:115], v[160:163]
    buffer_load_dwordx4 v3, s[48:51], s8 offen sc1 lds
    v_mfma_f32_16x16x32_bf16 v[164:167], v[36:39], a[116:119], v[164:167]
    v_mfma_f32_16x16x32_bf16 v[164:167], v[32:35], a[84:87], v[164:167]
    buffer_load_dwordx4 a[52:55], v61, s[48:51], s7 offen offset:1024 sc1
    v_mfma_f32_16x16x32_bf16 v[168:171], v[32:35], a[88:91], v[168:171]
    ds_read_b64_tr_b16 v[24:25], v13 offset:256
    ds_read_b64_tr_b16 v[26:27], v13 offset:5376
    v_mfma_f32_16x16x32_bf16 v[168:171], v[36:39], a[120:123], v[168:171]
    v_mfma_f32_16x16x32_bf16 v[172:175], v[36:39], a[124:127], v[172:175]
    v_mfma_f32_16x16x32_bf16 v[172:175], v[32:35], a[92:95], v[172:175]
    ds_read_b64_tr_b16 v[28:29], v13 offset:10496
    ds_read_b64_tr_b16 v[30:31], v13 offset:15616
    v_mfma_f32_16x16x32_bf16 v[188:191], v[40:43], a[92:95], v[188:191]
    v_mfma_f32_16x16x32_bf16 v[188:191], v[44:47], a[124:127], v[188:191]
    s_nop 0
    v_mfma_f32_16x16x32_bf16 v[184:187], v[44:47], a[120:123], v[184:187]
    s_cmp_le_u32 s32, 1
    s_cselect_b32 s6, 2, 1
    s_mul_i32 s6, s6, 61440
    s_add_u32 s6, s6, s70
    s_add_u32 s6, s6, 1024000
    s_add_u32 m0, s34, 61440
    v_mfma_f32_16x16x32_bf16 v[184:187], v[40:43], a[88:91], v[184:187]
    buffer_load_dwordx4 v3, s[48:51], s6 offen sc1 lds
    v_mfma_f32_16x16x32_bf16 v[180:183], v[40:43], a[84:87], v[180:183]
    ds_read_b64_tr_b16 v[32:33], v12 offset:20480
    ds_read_b64_tr_b16 v[34:35], v12 offset:25600
    v_mfma_f32_16x16x32_bf16 v[180:183], v[44:47], a[116:119], v[180:183]
    buffer_load_dwordx4 a[56:59], v62, s[48:51], s7 offen offset:1024 sc1
    v_mfma_f32_16x16x32_bf16 v[176:179], v[44:47], a[112:115], v[176:179]
    s_nop 0
    v_mfma_f32_16x16x32_bf16 v[176:179], v[40:43], a[80:83], v[176:179]
    s_waitcnt lgkmcnt(2)
    ds_read_b64_tr_b16 v[36:37], v12 offset:30720
    ds_read_b64_tr_b16 v[38:39], v12 offset:35840
    v_mfma_f32_16x16x32_bf16 v[192:195], v[16:19], a[80:83], v[192:195]
    buffer_load_dword v7, v4, s[48:51], s77 offen sc1
    v_mfma_f32_16x16x32_bf16 v[192:195], v[20:23], a[112:115], v[192:195]
    s_add_u32 s8, s8, 4096
    s_add_u32 m0, s34, 147456
    v_mfma_f32_16x16x32_bf16 v[196:199], v[20:23], a[116:119], v[196:199]
    buffer_load_dwordx4 v3, s[48:51], s8 offen sc1 lds
    v_mfma_f32_16x16x32_bf16 v[196:199], v[16:19], a[84:87], v[196:199]
    v_mfma_f32_16x16x32_bf16 v[200:203], v[16:19], a[88:91], v[200:203]
    ds_read_b64_tr_b16 v[40:41], v13 offset:20480
    ds_read_b64_tr_b16 v[42:43], v13 offset:25600
    v_mfma_f32_16x16x32_bf16 v[200:203], v[20:23], a[120:123], v[200:203]
    buffer_load_dwordx4 a[60:63], v63, s[48:51], s7 offen offset:1024 sc1
    v_mfma_f32_16x16x32_bf16 v[204:207], v[20:23], a[124:127], v[204:207]
    v_mfma_f32_16x16x32_bf16 v[204:207], v[16:19], a[92:95], v[204:207]
    ds_read_b64_tr_b16 v[44:45], v13 offset:30720
    ds_read_b64_tr_b16 v[46:47], v13 offset:35840
    v_mfma_f32_16x16x32_bf16 v[220:223], v[24:27], a[92:95], v[220:223]
    v_mfma_f32_16x16x32_bf16 v[220:223], v[28:31], a[124:127], v[220:223]
    s_add_u32 s6, s6, 4096
    s_add_u32 m0, s34, 65536
    v_mfma_f32_16x16x32_bf16 v[216:219], v[28:31], a[120:123], v[216:219]
    buffer_load_dwordx4 v3, s[48:51], s6 offen sc1 lds
    v_mfma_f32_16x16x32_bf16 v[216:219], v[24:27], a[88:91], v[216:219]
    v_mfma_f32_16x16x32_bf16 v[212:215], v[24:27], a[84:87], v[212:215]
    ds_read_b64_tr_b16 v[16:17], v12 offset:20544
    ds_read_b64_tr_b16 v[18:19], v12 offset:25664
    v_mfma_f32_16x16x32_bf16 v[212:215], v[28:31], a[116:119], v[212:215]
    v_mfma_f32_16x16x32_bf16 v[208:211], v[28:31], a[112:115], v[208:211]
    v_mfma_f32_16x16x32_bf16 v[208:211], v[24:27], a[80:83], v[208:211]
    s_waitcnt vmcnt(32) lgkmcnt(2)
    ds_read_b64_tr_b16 v[20:21], v12 offset:30784
    ds_read_b64_tr_b16 v[22:23], v12 offset:35904
    v_mfma_f32_16x16x32_bf16 v[64:67], v[32:35], a[144:147], v[64:67]
    s_waitcnt vmcnt(25)
    s_add_u32 s8, s8, 4096
    s_add_u32 m0, s34, 151552
    v_mfma_f32_16x16x32_bf16 v[64:67], v[36:39], a[176:179], v[64:67]
    s_nop 0
    s_waitcnt vmcnt(24)
    buffer_load_dwordx4 v3, s[48:51], s8 offen sc1 lds
    v_mfma_f32_16x16x32_bf16 v[68:71], v[36:39], a[180:183], v[68:71]
    v_mfma_f32_16x16x32_bf16 v[68:71], v[32:35], a[148:151], v[68:71]
    buffer_load_dwordx4 a[80:83], v60, s[48:51], s7 offen offset:2048 sc1
    v_mfma_f32_16x16x32_bf16 v[72:75], v[32:35], a[152:155], v[72:75]
    s_waitcnt vmcnt(25)
    ds_read_b64_tr_b16 v[24:25], v13 offset:20544
    ds_read_b64_tr_b16 v[26:27], v13 offset:25664
    v_mfma_f32_16x16x32_bf16 v[72:75], v[36:39], a[184:187], v[72:75]
    s_waitcnt vmcnt(22)
    v_mfma_f32_16x16x32_bf16 v[76:79], v[36:39], a[188:191], v[76:79]
    v_mfma_f32_16x16x32_bf16 v[76:79], v[32:35], a[156:159], v[76:79]
    ds_read_b64_tr_b16 v[28:29], v13 offset:30784
    ds_read_b64_tr_b16 v[30:31], v13 offset:35904
    v_mfma_f32_16x16x32_bf16 v[92:95], v[40:43], a[156:159], v[92:95]
    s_add_u32 s6, s6, 4096
    s_add_u32 m0, s34, 69632
    v_mfma_f32_16x16x32_bf16 v[92:95], v[44:47], a[188:191], v[92:95]
    buffer_load_dwordx4 v3, s[48:51], s6 offen sc1 lds
    v_mfma_f32_16x16x32_bf16 v[88:91], v[44:47], a[184:187], v[88:91]
    v_mfma_f32_16x16x32_bf16 v[88:91], v[40:43], a[152:155], v[88:91]
    buffer_load_dwordx4 a[84:87], v61, s[48:51], s7 offen offset:2048 sc1
    v_mfma_f32_16x16x32_bf16 v[84:87], v[40:43], a[148:151], v[84:87]
    ds_read_b64_tr_b16 v[32:33], v12 offset:20608
    ds_read_b64_tr_b16 v[34:35], v12 offset:25728
    v_mfma_f32_16x16x32_bf16 v[84:87], v[44:47], a[180:183], v[84:87]
    v_mfma_f32_16x16x32_bf16 v[80:83], v[44:47], a[176:179], v[80:83]
    s_nop 0
    v_mfma_f32_16x16x32_bf16 v[80:83], v[40:43], a[144:147], v[80:83]
    s_waitcnt lgkmcnt(2)
    ds_read_b64_tr_b16 v[36:37], v12 offset:30848
    ds_read_b64_tr_b16 v[38:39], v12 offset:35968
    v_mfma_f32_16x16x32_bf16 v[96:99], v[16:19], a[144:147], v[96:99]
    s_add_u32 s8, s8, 4096
    s_add_u32 m0, s34, 155648
    v_mfma_f32_16x16x32_bf16 v[96:99], v[20:23], a[176:179], v[96:99]
    buffer_load_dwordx4 v3, s[48:51], s8 offen sc1 lds
    v_mfma_f32_16x16x32_bf16 v[100:103], v[20:23], a[180:183], v[100:103]
    v_mfma_f32_16x16x32_bf16 v[100:103], v[16:19], a[148:151], v[100:103]
    buffer_load_dwordx4 a[88:91], v62, s[48:51], s7 offen offset:2048 sc1
    v_mfma_f32_16x16x32_bf16 v[104:107], v[16:19], a[152:155], v[104:107]
    ds_read_b64_tr_b16 v[40:41], v13 offset:20608
    ds_read_b64_tr_b16 v[42:43], v13 offset:25728
    v_mfma_f32_16x16x32_bf16 v[104:107], v[20:23], a[184:187], v[104:107]
    v_mfma_f32_16x16x32_bf16 v[108:111], v[20:23], a[188:191], v[108:111]
    v_mfma_f32_16x16x32_bf16 v[108:111], v[16:19], a[156:159], v[108:111]
    ds_read_b64_tr_b16 v[44:45], v13 offset:30848
    ds_read_b64_tr_b16 v[46:47], v13 offset:35968
    v_mfma_f32_16x16x32_bf16 v[124:127], v[24:27], a[156:159], v[124:127]
    s_add_u32 s6, s6, 4096
    s_add_u32 m0, s34, 73728
    v_mfma_f32_16x16x32_bf16 v[124:127], v[28:31], a[188:191], v[124:127]
    buffer_load_dwordx4 v3, s[48:51], s6 offen sc1 lds
    v_mfma_f32_16x16x32_bf16 v[120:123], v[28:31], a[184:187], v[120:123]
    v_mfma_f32_16x16x32_bf16 v[120:123], v[24:27], a[152:155], v[120:123]
    s_nop 0
    v_mfma_f32_16x16x32_bf16 v[116:119], v[24:27], a[148:151], v[116:119]
    s_nop 0
    ds_read_b64_tr_b16 v[16:17], v12 offset:20672
    ds_read_b64_tr_b16 v[18:19], v12 offset:25792
    v_mfma_f32_16x16x32_bf16 v[116:119], v[28:31], a[180:183], v[116:119]
    buffer_load_dwordx4 a[92:95], v63, s[48:51], s7 offen offset:2048 sc1
    v_mfma_f32_16x16x32_bf16 v[112:115], v[28:31], a[176:179], v[112:115]
    s_nop 0
    v_mfma_f32_16x16x32_bf16 v[112:115], v[24:27], a[144:147], v[112:115]
    s_waitcnt lgkmcnt(2)
    ds_read_b64_tr_b16 v[20:21], v12 offset:30912
    ds_read_b64_tr_b16 v[22:23], v12 offset:36032
    v_mfma_f32_16x16x32_bf16 v[128:131], v[32:35], a[144:147], v[128:131]
    s_add_u32 s8, s8, 4096
    s_add_u32 m0, s34, 159744
    v_mfma_f32_16x16x32_bf16 v[128:131], v[36:39], a[176:179], v[128:131]
    buffer_load_dwordx4 v3, s[48:51], s8 offen sc1 lds
    v_mfma_f32_16x16x32_bf16 v[132:135], v[36:39], a[180:183], v[132:135]
    v_mfma_f32_16x16x32_bf16 v[132:135], v[32:35], a[148:151], v[132:135]
    v_mfma_f32_16x16x32_bf16 v[136:139], v[32:35], a[152:155], v[136:139]
    ds_read_b64_tr_b16 v[24:25], v13 offset:20672
    ds_read_b64_tr_b16 v[26:27], v13 offset:25792
    v_mfma_f32_16x16x32_bf16 v[136:139], v[36:39], a[184:187], v[136:139]
    v_mfma_f32_16x16x32_bf16 v[140:143], v[36:39], a[188:191], v[140:143]
    buffer_load_dwordx4 a[112:115], v60, s[48:51], s7 offen offset:3072 sc1
    v_mfma_f32_16x16x32_bf16 v[140:143], v[32:35], a[156:159], v[140:143]
    ds_read_b64_tr_b16 v[28:29], v13 offset:30912
    ds_read_b64_tr_b16 v[30:31], v13 offset:36032
    v_mfma_f32_16x16x32_bf16 v[156:159], v[40:43], a[156:159], v[156:159]
    s_add_u32 s6, s6, 4096
    s_add_u32 m0, s34, 77824
    v_mfma_f32_16x16x32_bf16 v[156:159], v[44:47], a[188:191], v[156:159]
    buffer_load_dwordx4 v3, s[48:51], s6 offen sc1 lds
    v_mfma_f32_16x16x32_bf16 v[152:155], v[44:47], a[184:187], v[152:155]
    v_mfma_f32_16x16x32_bf16 v[152:155], v[40:43], a[152:155], v[152:155]
    v_mfma_f32_16x16x32_bf16 v[148:151], v[40:43], a[148:151], v[148:151]
    ds_read_b64_tr_b16 v[32:33], v12 offset:20736
    ds_read_b64_tr_b16 v[34:35], v12 offset:25856
    v_mfma_f32_16x16x32_bf16 v[148:151], v[44:47], a[180:183], v[148:151]
    v_mfma_f32_16x16x32_bf16 v[144:147], v[44:47], a[176:179], v[144:147]
    s_nop 0
    v_mfma_f32_16x16x32_bf16 v[144:147], v[40:43], a[144:147], v[144:147]
    s_waitcnt lgkmcnt(2)
    ds_read_b64_tr_b16 v[36:37], v12 offset:30976
    ds_read_b64_tr_b16 v[38:39], v12 offset:36096
    v_mfma_f32_16x16x32_bf16 v[160:163], v[16:19], a[144:147], v[160:163]
    buffer_load_dwordx4 a[116:119], v61, s[48:51], s7 offen offset:3072 sc1
    v_mfma_f32_16x16x32_bf16 v[160:163], v[20:23], a[176:179], v[160:163]
    v_mfma_f32_16x16x32_bf16 v[164:167], v[20:23], a[180:183], v[164:167]
    ds_read_b64_tr_b16 v[40:41], v13 offset:20736
    ds_read_b64_tr_b16 v[42:43], v13 offset:25856
    v_mfma_f32_16x16x32_bf16 v[164:167], v[16:19], a[148:151], v[164:167]
    v_mfma_f32_16x16x32_bf16 v[168:171], v[16:19], a[152:155], v[168:171]
    v_mfma_f32_16x16x32_bf16 v[168:171], v[20:23], a[184:187], v[168:171]
    ds_read_b64_tr_b16 v[44:45], v13 offset:30976
    ds_read_b64_tr_b16 v[46:47], v13 offset:36096
    v_mfma_f32_16x16x32_bf16 v[172:175], v[20:23], a[188:191], v[172:175]
    v_mfma_f32_16x16x32_bf16 v[172:175], v[16:19], a[156:159], v[172:175]
    v_mfma_f32_16x16x32_bf16 v[188:191], v[24:27], a[156:159], v[188:191]
    v_mfma_f32_16x16x32_bf16 v[188:191], v[28:31], a[188:191], v[188:191]
    v_mfma_f32_16x16x32_bf16 v[184:187], v[28:31], a[184:187], v[184:187]
    buffer_load_dwordx4 a[120:123], v62, s[48:51], s7 offen offset:3072 sc1
    v_mfma_f32_16x16x32_bf16 v[184:187], v[24:27], a[152:155], v[184:187]
    v_mfma_f32_16x16x32_bf16 v[180:183], v[24:27], a[148:151], v[180:183]
    s_waitcnt lgkmcnt(0)
    s_barrier
    s_waitcnt vmcnt(16)
    v_cmp_gt_u32 vcc, 32, v7
    s_cbranch_vccnz L_slow17
L_ok17:
    v_mfma_f32_16x16x32_bf16 v[180:183], v[28:31], a[180:183], v[180:183]
    s_nop 0
    ds_read_b64_tr_b16 v[16:17], v8 offset:0
    ds_read_b64_tr_b16 v[18:19], v8 offset:5120
    v_mfma_f32_16x16x32_bf16 v[176:179], v[28:31], a[176:179], v[176:179]
    v_mfma_f32_16x16x32_bf16 v[176:179], v[24:27], a[144:147], v[176:179]
    ds_read_b64_tr_b16 v[20:21], v8 offset:10240
    ds_read_b64_tr_b16 v[22:23], v8 offset:15360
    v_mfma_f32_16x16x32_bf16 v[192:195], v[32:35], a[144:147], v[192:195]
    s_cmp_le_u32 s32, 2
    s_cselect_b32 s6, 3, 2
    s_mul_i32 s6, s6, 61440
    s_add_u32 s6, s6, s70
    s_add_u32 m0, s34, 81920
    v_mfma_f32_16x16x32_bf16 v[192:195], v[36:39], a[176:179], v[192:195]
    s_nop 0
    buffer_load_dwordx4 v3, s[48:51], s6 offen sc1 lds
    v_mfma_f32_16x16x32_bf16 v[196:199], v[36:39], a[180:183], v[196:199]
    v_mfma_f32_16x16x32_bf16 v[196:199], v[32:35], a[148:151], v[196:199]
    buffer_load_dwordx4 a[124:127], v63, s[48:51], s7 offen offset:3072 sc1
    v_mfma_f32_16x16x32_bf16 v[200:203], v[32:35], a[152:155], v[200:203]
    ds_read_b64_tr_b16 v[24:25], v9 offset:0
    ds_read_b64_tr_b16 v[26:27], v9 offset:5120
    v_mfma_f32_16x16x32_bf16 v[200:203], v[36:39], a[184:187], v[200:203]
    v_mfma_f32_16x16x32_bf16 v[204:207], v[36:39], a[188:191], v[204:207]
    v_mfma_f32_16x16x32_bf16 v[204:207], v[32:35], a[156:159], v[204:207]
    ds_read_b64_tr_b16 v[28:29], v9 offset:10240
    ds_read_b64_tr_b16 v[30:31], v9 offset:15360
    v_mfma_f32_16x16x32_bf16 v[220:223], v[40:43], a[156:159], v[220:223]
    v_mfma_f32_16x16x32_bf16 v[220:223], v[44:47], a[188:191], v[220:223]
    v_mfma_f32_16x16x32_bf16 v[216:219], v[44:47], a[184:187], v[216:219]
    v_mfma_f32_16x16x32_bf16 v[216:219], v[40:43], a[152:155], v[216:219]
    v_mfma_f32_16x16x32_bf16 v[212:215], v[40:43], a[148:151], v[212:215]
    ds_read_b64_tr_b16 v[32:33], v8 offset:64
    ds_read_b64_tr_b16 v[34:35], v8 offset:5184
    v_mfma_f32_16x16x32_bf16 v[212:215], v[44:47], a[180:183], v[212:215]
    s_add_u32 s6, s6, 4096
    s_add_u32 m0, s34, 86016
    v_mfma_f32_16x16x32_bf16 v[208:211], v[44:47], a[176:179], v[208:211]
    buffer_load_dwordx4 v3, s[48:51], s6 offen sc1 lds
    v_mfma_f32_16x16x32_bf16 v[208:211], v[40:43], a[144:147], v[208:211]
    s_waitcnt lgkmcnt(2)
    ds_read_b64_tr_b16 v[36:37], v8 offset:10304
    ds_read_b64_tr_b16 v[38:39], v8 offset:15424
    s_nop 0
    v_mfma_f32_16x16x32_bf16 v[64:67], v[16:19], a[16:19], v[64:67]
    s_add_u32 s7, s7, 4096
    v_mfma_f32_16x16x32_bf16 v[64:67], v[20:23], a[48:51], v[64:67]
    buffer_load_dwordx4 a[144:147], v60, s[48:51], s7 offen sc1
    v_mfma_f32_16x16x32_bf16 v[68:71], v[20:23], a[52:55], v[68:71]
    v_mfma_f32_16x16x32_bf16 v[68:71], v[16:19], a[20:23], v[68:71]
    v_mfma_f32_16x16x32_bf16 v[72:75], v[16:19], a[24:27], v[72:75]
    ds_read_b64_tr_b16 v[40:41], v9 offset:64
    ds_read_b64_tr_b16 v[42:43], v9 offset:5184
    v_mfma_f32_16x16x32_bf16 v[72:75], v[20:23], a[56:59], v[72:75]
    s_waitcnt vmcnt(18)
    v_mfma_f32_16x16x32_bf16 v[76:79], v[20:23], a[60:63], v[76:79]
    s_nop 0
    v_mfma_f32_16x16x32_bf16 v[76:79], v[16:19], a[28:31], v[76:79]
    ds_read_b64_tr_b16 v[44:45], v9 offset:10304
    ds_read_b64_tr_b16 v[46:47], v9 offset:15424
    v_mfma_f32_16x16x32_bf16 v[92:95], v[24:27], a[28:31], v[92:95]
    buffer_load_dwordx4 a[148:151], v61, s[48:51], s7 offen sc1
    v_mfma_f32_16x16x32_bf16 v[92:95], v[28:31], a[60:63], v[92:95]
    v_mfma_f32_16x16x32_bf16 v[88:91], v[28:31], a[56:59], v[88:91]
    v_mfma_f32_16x16x32_bf16 v[88:91], v[24:27], a[24:27], v[88:91]
    v_mfma_f32_16x16x32_bf16 v[84:87], v[24:27], a[20:23], v[84:87]
    ds_read_b64_tr_b16 v[16:17], v8 offset:128
    ds_read_b64_tr_b16 v[18:19], v8 offset:5248
    v_mfma_f32_16x16x32_bf16 v[84:87], v[28:31], a[52:55], v[84:87]
    s_add_u32 s6, s6, 4096
    s_add_u32 m0, s34, 90112
    v_mfma_f32_16x16x32_bf16 v[80:83], v[28:31], a[48:51], v[80:83]
    buffer_load_dwordx4 v3, s[48:51], s6 offen sc1 lds
    v_mfma_f32_16x16x32_bf16 v[80:83], v[24:27], a[16:19], v[80:83]
    s_waitcnt lgkmcnt(2)
    ds_read_b64_tr_b16 v[20:21], v8 offset:10368
    ds_read_b64_tr_b16 v[22:23], v8 offset:15488
    v_mfma_f32_16x16x32_bf16 v[96:99], v[32:35], a[16:19], v[96:99]
    s_nop 0
    v_mfma_f32_16x16x32_bf16 v[96:99], v[36:39], a[48:51], v[96:99]
    buffer_load_dwordx4 a[152:155], v62, s[48:51], s7 offen sc1
    v_mfma_f32_16x16x32_bf16 v[100:103], v[36:39], a[52:55], v[100:103]
    v_mfma_f32_16x16x32_bf16 v[100:103], v[32:35], a[20:23], v[100:103]
    v_mfma_f32_16x16x32_bf16 v[104:107], v[32:35], a[24:27], v[104:107]
    ds_read_b64_tr_b16 v[24:25], v9 offset:128
    ds_read_b64_tr_b16 v[26:27], v9 offset:5248
    v_mfma_f32_16x16x32_bf16 v[104:107], v[36:39], a[56:59], v[104:107]
    v_mfma_f32_16x16x32_bf16 v[108:111], v[36:39], a[60:63], v[108:111]
    v_mfma_f32_16x16x32_bf16 v[108:111], v[32:35], a[28:31], v[108:111]
    ds_read_b64_tr_b16 v[28:29], v9 offset:10368
    ds_read_b64_tr_b16 v[30:31], v9 offset:15488
    v_mfma_f32_16x16x32_bf16 v[124:127], v[40:43], a[28:31], v[124:127]
    v_mfma_f32_16x16x32_bf16 v[124:127], v[44:47], a[60:63], v[124:127]
    v_mfma_f32_16x16x32_bf16 v[120:123], v[44:47], a[56:59], v[120:123]
    v_mfma_f32_16x16x32_bf16 v[120:123], v[40:43], a[24:27], v[120:123]
    buffer_load_dwordx4 a[156:159], v63, s[48:51], s7 offen sc1
    v_mfma_f32_16x16x32_bf16 v[116:119], v[40:43], a[20:23], v[116:119]
    ds_read_b64_tr_b16 v[32:33], v8 offset:192
    ds_read_b64_tr_b16 v[34:35], v8 offset:5312
    v_mfma_f32_16x16x32_bf16 v[116:119], v[44:47], a[52:55], v[116:119]
    s_add_u32 s6, s6, 4096
    s_add_u32 m0, s34, 94208
    v_mfma_f32_16x16x32_bf16 v[112:115], v[44:47], a[48:51], v[112:115]
    buffer_load_dwordx4 v3, s[48:51], s6 offen sc1 lds
    v_mfma_f32_16x16x32_bf16 v[112:115], v[40:43], a[16:19], v[112:115]
    s_waitcnt lgkmcnt(2)
    s_nop 0
    ds_read_b64_tr_b16 v[36:37], v8 offset:10432
    ds_read_b64_tr_b16 v[38:39], v8 offset:15552
    v_mfma_f32_16x16x32_bf16 v[128:131], v[16:19], a[16:19], v[128:131]
    v_mfma_f32_16x16x32_bf16 v[128:131], v[20:23], a[48:51], v[128:131]
    v_mfma_f32_16x16x32_bf16 v[132:135], v[20:23], a[52:55], v[132:135]
    v_mfma_f32_16x16x32_bf16 v[132:135], v[16:19], a[20:23], v[132:135]
    v_mfma_f32_16x16x32_bf16 v[136:139], v[16:19], a[24:27], v[136:139]
    ds_read_b64_tr_b16 v[40:41], v9 offset:192
    ds_read_b64_tr_b16 v[42:43], v9 offset:5312
    v_mfma_f32_16x16x32_bf16 v[136:139], v[20:23], a[56:59], v[136:139]
    buffer_load_dwordx4 a[176:179], v60, s[48:51], s7 offen offset:1024 sc1
    v_mfma_f32_16x16x32_bf16 v[140:143], v[20:23], a[60:63], v[140:143]
    v_mfma_f32_16x16x32_bf16 v[140:143], v[16:19], a[28:31], v[140:143]
    ds_read_b64_tr_b16 v[44:45], v9 offset:10432
    ds_read_b64_tr_b16 v[46:47], v9 offset:15552
    v_mfma_f32_16x16x32_bf16 v[156:159], v[24:27], a[28:31], v[156:159]
    v_mfma_f32_16x16x32_bf16 v[156:159], v[28:31], a[60:63], v[156:159]
    v_mfma_f32_16x16x32_bf16 v[152:155], v[28:31], a[56:59], v[152:155]
    s_add_u32 s6, s6, 4096
    s_add_u32 m0, s34, 98304
    v_mfma_f32_16x16x32_bf16 v[152:155], v[24:27], a[24:27], v[152:155]
    buffer_load_dwordx4 v3, s[48:51], s6 offen sc1 lds
    v_mfma_f32_16x16x32_bf16 v[148:151], v[24:27], a[20:23], v[148:151]
    ds_read_b64_tr_b16 v[16:17], v8 offset:256
    ds_read_b64_tr_b16 v[18:19], v8 offset:5376
    v_mfma_f32_16x16x32_bf16 v[148:151], v[28:31], a[52:55], v[148:151]
    v_mfma_f32_16x16x32_bf16 v[144:147], v[28:31], a[48:51], v[144:147]
    buffer_load_dwordx4 a[180:183], v61, s[48:51], s7 offen offset:1024 sc1
    v_mfma_f32_16x16x32_bf16 v[144:147], v[24:27], a[16:19], v[144:147]
    s_waitcnt lgkmcnt(2)
    ds_read_b64_tr_b16 v[20:21], v8 offset:10496
    ds_read_b64_tr_b16 v[22:23], v8 offset:15616
    v_mfma_f32_16x16x32_bf16 v[160:163], v[32:35], a[16:19], v[160:163]
    s_nop 0
    v_mfma_f32_16x16x32_bf16 v[160:163], v[36:39], a[48:51], v[160:163]
    v_mfma_f32_16x16x32_bf16 v[164:167], v[36:39], a[52:55], v[164:167]
    v_mfma_f32_16x16x32_bf16 v[164:167], v[32:35], a[20:23], v[164:167]
    v_mfma_f32_16x16x32_bf16 v[168:171], v[32:35], a[24:27], v[168:171]
    ds_read_b64_tr_b16 v[24:25], v9 offset:256
    ds_read_b64_tr_b16 v[26:27], v9 offset:5376
    v_mfma_f32_16x16x32_bf16 v[168:171], v[36:39], a[56:59], v[168:171]
    v_mfma_f32_16x16x32_bf16 v[172:175], v[36:39], a[60:63], v[172:175]
    v_mfma_f32_16x16x32_bf16 v[172:175], v[32:35], a[28:31], v[172:175]
    ds_read_b64_tr_b16 v[28:29], v9 offset:10496
    ds_read_b64_tr_b16 v[30:31], v9 offset:15616
    v_mfma_f32_16x16x32_bf16 v[188:191], v[40:43], a[28:31], v[188:191]
    buffer_load_dwordx4 a[184:187], v62, s[48:51], s7 offen offset:1024 sc1
    v_mfma_f32_16x16x32_bf16 v[188:191], v[44:47], a[60:63], v[188:191]
    v_mfma_f32_16x16x32_bf16 v[184:187], v[44:47], a[56:59], v[184:187]
    s_add_u32 s6, s6, 4096
    s_add_u32 m0, s34, 102400
    v_mfma_f32_16x16x32_bf16 v[184:187], v[40:43], a[24:27], v[184:187]
    buffer_load_dwordx4 v3, s[48:51], s6 offen sc1 lds
    v_mfma_f32_16x16x32_bf16 v[180:183], v[40:43], a[20:23], v[180:183]
    ds_read_b64_tr_b16 v[32:33], v8 offset:20480
    ds_read_b64_tr_b16 v[34:35], v8 offset:25600
    v_mfma_f32_16x16x32_bf16 v[180:183], v[44:47], a[52:55], v[180:183]
    buffer_load_dwordx4 a[192:195], v1, s[48:51], s11 offen sc1
    v_mfma_f32_16x16x32_bf16 v[176:179], v[44:47], a[48:51], v[176:179]
    s_nop 0
    v_mfma_f32_16x16x32_bf16 v[176:179], v[40:43], a[16:19], v[176:179]
    s_waitcnt lgkmcnt(2)
    ds_read_b64_tr_b16 v[36:37], v8 offset:30720
    ds_read_b64_tr_b16 v[38:39], v8 offset:35840
    v_mfma_f32_16x16x32_bf16 v[192:195], v[16:19], a[16:19], v[192:195]
    v_mfma_f32_16x16x32_bf16 v[192:195], v[20:23], a[48:51], v[192:195]
    v_mfma_f32_16x16x32_bf16 v[196:199], v[20:23], a[52:55], v[196:199]
    buffer_load_dwordx4 a[188:191], v63, s[48:51], s7 offen offset:1024 sc1
    v_mfma_f32_16x16x32_bf16 v[196:199], v[16:19], a[20:23], v[196:199]
    v_mfma_f32_16x16x32_bf16 v[200:203], v[16:19], a[24:27], v[200:203]
    ds_read_b64_tr_b16 v[40:41], v9 offset:20480
    ds_read_b64_tr_b16 v[42:43], v9 offset:25600
    v_mfma_f32_16x16x32_bf16 v[200:203], v[20:23], a[56:59], v[200:203]
    s_cmp_le_u32 s32, 2
    s_cselect_b32 s17, 3, 2
    s_mul_i32 s17, s17, 6144
    s_add_u32 s17, s17, s72
    v_mfma_f32_16x16x32_bf16 v[204:207], v[20:23], a[60:63], v[204:207]
    buffer_load_dwordx4 a[0:3], v60, s[48:51], s17 offen sc1
    v_mfma_f32_16x16x32_bf16 v[204:207], v[16:19], a[28:31], v[204:207]
    s_nop 0
    ds_read_b64_tr_b16 v[44:45], v9 offset:30720
    ds_read_b64_tr_b16 v[46:47], v9 offset:35840
    v_mfma_f32_16x16x32_bf16 v[220:223], v[24:27], a[28:31], v[220:223]
    v_mfma_f32_16x16x32_bf16 v[220:223], v[28:31], a[60:63], v[220:223]
    buffer_load_dwordx4 a[196:199], v1, s[48:51], s11 offen offset:1024 sc1
    v_mfma_f32_16x16x32_bf16 v[216:219], v[28:31], a[56:59], v[216:219]
    s_add_u32 s6, s6, 4096
    s_add_u32 m0, s34, 106496
    v_mfma_f32_16x16x32_bf16 v[216:219], v[24:27], a[24:27], v[216:219]
    buffer_load_dwordx4 v3, s[48:51], s6 offen sc1 lds
    v_mfma_f32_16x16x32_bf16 v[212:215], v[24:27], a[20:23], v[212:215]
    ds_read_b64_tr_b16 v[16:17], v8 offset:20544
    ds_read_b64_tr_b16 v[18:19], v8 offset:25664
    v_mfma_f32_16x16x32_bf16 v[212:215], v[28:31], a[52:55], v[212:215]
    v_mfma_f32_16x16x32_bf16 v[208:211], v[28:31], a[48:51], v[208:211]
    v_mfma_f32_16x16x32_bf16 v[208:211], v[24:27], a[16:19], v[208:211]
    s_waitcnt vmcnt(30) lgkmcnt(2)
    ds_read_b64_tr_b16 v[20:21], v8 offset:30784
    ds_read_b64_tr_b16 v[22:23], v8 offset:35904
    v_mfma_f32_16x16x32_bf16 v[64:67], v[32:35], a[80:83], v[64:67]
    s_waitcnt vmcnt(22)
    buffer_load_dwordx4 a[4:7], v61, s[48:51], s17 offen sc1
    v_mfma_f32_16x16x32_bf16 v[64:67], v[36:39], a[112:115], v[64:67]
    s_waitcnt vmcnt(21)
    v_mfma_f32_16x16x32_bf16 v[68:71], v[36:39], a[116:119], v[68:71]
    s_nop 0
    v_mfma_f32_16x16x32_bf16 v[68:71], v[32:35], a[84:87], v[68:71]
    v_mfma_f32_16x16x32_bf16 v[72:75], v[32:35], a[88:91], v[72:75]
    s_waitcnt vmcnt(20)
    ds_read_b64_tr_b16 v[24:25], v9 offset:20544
    ds_read_b64_tr_b16 v[26:27], v9 offset:25664
    v_mfma_f32_16x16x32_bf16 v[72:75], v[36:39], a[120:123], v[72:75]
    s_waitcnt vmcnt(18)
    v_mfma_f32_16x16x32_bf16 v[76:79], v[36:39], a[124:127], v[76:79]
    buffer_load_dwordx4 a[200:203], v1, s[48:51], s11 offen offset:2048 sc1
    v_mfma_f32_16x16x32_bf16 v[76:79], v[32:35], a[92:95], v[76:79]
    ds_read_b64_tr_b16 v[28:29], v9 offset:30784
    ds_read_b64_tr_b16 v[30:31], v9 offset:35904
    v_mfma_f32_16x16x32_bf16 v[92:95], v[40:43], a[92:95], v[92:95]
    buffer_load_dwordx4 a[8:11], v62, s[48:51], s17 offen sc1
    v_mfma_f32_16x16x32_bf16 v[92:95], v[44:47], a[124:127], v[92:95]
    s_add_u32 s6, s6, 4096
    s_add_u32 m0, s34, 110592
    v_mfma_f32_16x16x32_bf16 v[88:91], v[44:47], a[120:123], v[88:91]
    buffer_load_dwordx4 v3, s[48:51], s6 offen sc1 lds
    v_mfma_f32_16x16x32_bf16 v[88:91], v[40:43], a[88:91], v[88:91]
    v_mfma_f32_16x16x32_bf16 v[84:87], v[40:43], a[84:87], v[84:87]
    ds_read_b64_tr_b16 v[32:33], v8 offset:20608
    ds_read_b64_tr_b16 v[34:35], v8 offset:25728
    v_mfma_f32_16x16x32_bf16 v[84:87], v[44:47], a[116:119], v[84:87]
    buffer_load_dword v57, v4, s[48:51], s9 offen sc1
    v_mfma_f32_16x16x32_bf16 v[80:83], v[44:47], a[112:115], v[80:83]
    s_nop 0
    v_mfma_f32_16x16x32_bf16 v[80:83], v[40:43], a[80:83], v[80:83]
    s_waitcnt lgkmcnt(2)
    ds_read_b64_tr_b16 v[36:37], v8 offset:30848
    ds_read_b64_tr_b16 v[38:39], v8 offset:35968
    v_mfma_f32_16x16x32_bf16 v[96:99], v[16:19], a[80:83], v[96:99]
    v_mfma_f32_16x16x32_bf16 v[96:99], v[20:23], a[112:115], v[96:99]
    v_mfma_f32_16x16x32_bf16 v[100:103], v[20:23], a[116:119], v[100:103]
    buffer_load_dwordx4 a[12:15], v63, s[48:51], s17 offen sc1
    v_mfma_f32_16x16x32_bf16 v[100:103], v[16:19], a[84:87], v[100:103]
    v_mfma_f32_16x16x32_bf16 v[104:107], v[16:19], a[88:91], v[104:107]
    ds_read_b64_tr_b16 v[40:41], v9 offset:20608
    ds_read_b64_tr_b16 v[42:43], v9 offset:25728
    v_mfma_f32_16x16x32_bf16 v[104:107], v[20:23], a[120:123], v[104:107]
    buffer_load_dwordx4 a[204:207], v1, s[48:51], s11 offen offset:3072 sc1
    v_mfma_f32_16x16x32_bf16 v[108:111], v[20:23], a[124:127], v[108:111]
    v_mfma_f32_16x16x32_bf16 v[108:111], v[16:19], a[92:95], v[108:111]
    ds_read_b64_tr_b16 v[44:45], v9 offset:30848
    ds_read_b64_tr_b16 v[46:47], v9 offset:35968
    v_mfma_f32_16x16x32_bf16 v[124:127], v[24:27], a[92:95], v[124:127]
    s_add_u32 s6, s6, 4096
    s_add_u32 m0, s34, 114688
    v_mfma_f32_16x16x32_bf16 v[124:127], v[28:31], a[124:127], v[124:127]
    buffer_load_dwordx4 v3, s[48:51], s6 offen sc1 lds
    v_mfma_f32_16x16x32_bf16 v[120:123], v[28:31], a[120:123], v[120:123]
    v_mfma_f32_16x16x32_bf16 v[120:123], v[24:27], a[88:91], v[120:123]
    buffer_load_dwordx4 a[32:35], v60, s[48:51], s17 offen offset:1024 sc1
    v_mfma_f32_16x16x32_bf16 v[116:119], v[24:27], a[84:87], v[116:119]
    ds_read_b64_tr_b16 v[16:17], v8 offset:20672
    ds_read_b64_tr_b16 v[18:19], v8 offset:25792
    v_mfma_f32_16x16x32_bf16 v[116:119], v[28:31], a[116:119], v[116:119]
    v_mfma_f32_16x16x32_bf16 v[112:115], v[28:31], a[112:115], v[112:115]
    s_nop 0
    v_mfma_f32_16x16x32_bf16 v[112:115], v[24:27], a[80:83], v[112:115]
    s_waitcnt lgkmcnt(2)
    s_add_u32 s11, s11, 4096
    ds_read_b64_tr_b16 v[20:21], v8 offset:30912
    ds_read_b64_tr_b16 v[22:23], v8 offset:36032
    v_mfma_f32_16x16x32_bf16 v[128:131], v[32:35], a[80:83], v[128:131]
    buffer_load_dwordx4 a[208:211], v1, s[48:51], s11 offen sc1
    v_mfma_f32_16x16x32_bf16 v[128:131], v[36:39], a[112:115], v[128:131]
    v_mfma_f32_16x16x32_bf16 v[132:135], v[36:39], a[116:119], v[132:135]
    v_mfma_f32_16x16x32_bf16 v[132:135], v[32:35], a[84:87], v[132:135]
    v_mfma_f32_16x16x32_bf16 v[136:139], v[32:35], a[88:91], v[136:139]
    ds_read_b64_tr_b16 v[24:25], v9 offset:20672
    ds_read_b64_tr_b16 v[26:27], v9 offset:25792
    v_mfma_f32_16x16x32_bf16 v[136:139], v[36:39], a[120:123], v[136:139]
    buffer_load_dwordx4 a[36:39], v61, s[48:51], s17 offen offset:1024 sc1
    v_mfma_f32_16x16x32_bf16 v[140:143], v[36:39], a[124:127], v[140:143]
    v_mfma_f32_16x16x32_bf16 v[140:143], v[32:35], a[92:95], v[140:143]
    ds_read_b64_tr_b16 v[28:29], v9 offset:30912
    ds_read_b64_tr_b16 v[30:31], v9 offset:36032
    v_mfma_f32_16x16x32_bf16 v[156:159], v[40:43], a[92:95], v[156:159]
    s_add_u32 s6, s6, 4096
    s_add_u32 m0, s34, 118784
    v_mfma_f32_16x16x32_bf16 v[156:159], v[44:47], a[124:127], v[156:159]
    buffer_load_dwordx4 v3, s[48:51], s6 offen sc1 lds
    v_mfma_f32_16x16x32_bf16 v[152:155], v[44:47], a[120:123], v[152:155]
    v_mfma_f32_16x16x32_bf16 v[152:155], v[40:43], a[88:91], v[152:155]
    v_mfma_f32_16x16x32_bf16 v[148:151], v[40:43], a[84:87], v[148:151]
    ds_read_b64_tr_b16 v[32:33], v8 offset:20736
    ds_read_b64_tr_b16 v[34:35], v8 offset:25856
    v_mfma_f32_16x16x32_bf16 v[148:151], v[44:47], a[116:119], v[148:151]
    buffer_load_dwordx4 a[212:215], v1, s[48:51], s11 offen offset:1024 sc1
    v_mfma_f32_16x16x32_bf16 v[144:147], v[44:47], a[112:115], v[144:147]
    s_nop 0
    v_mfma_f32_16x16x32_bf16 v[144:147], v[40:43], a[80:83], v[144:147]
    s_waitcnt lgkmcnt(2)
    ds_read_b64_tr_b16 v[36:37], v8 offset:30976
    ds_read_b64_tr_b16 v[38:39], v8 offset:36096
    v_mfma_f32_16x16x32_bf16 v[160:163], v[16:19], a[80:83], v[160:163]
    buffer_load_dwordx4 a[40:43], v62, s[48:51], s17 offen offset:1024 sc1
    v_mfma_f32_16x16x32_bf16 v[160:163], v[20:23], a[112:115], v[160:163]
    v_mfma_f32_16x16x32_bf16 v[164:167], v[20:23], a[116:119], v[164:167]
    ds_read_b64_tr_b16 v[40:41], v9 offset:20736
    ds_read_b64_tr_b16 v[42:43], v9 offset:25856
    v_mfma_f32_16x16x32_bf16 v[164:167], v[16:19], a[84:87], v[164:167]
    v_mfma_f32_16x16x32_bf16 v[168:171], v[16:19], a[88:91], v[168:171]
    v_mfma_f32_16x16x32_bf16 v[168:171], v[20:23], a[120:123], v[168:171]
    ds_read_b64_tr_b16 v[44:45], v9 offset:30976
    ds_read_b64_tr_b16 v[46:47], v9 offset:36096
    v_mfma_f32_16x16x32_bf16 v[172:175], v[20:23], a[124:127], v[172:175]
    v_mfma_f32_16x16x32_bf16 v[172:175], v[16:19], a[92:95], v[172:175]
    buffer_load_dwordx4 a[44:47], v63, s[48:51], s17 offen offset:1024 sc1
    v_mfma_f32_16x16x32_bf16 v[188:191], v[24:27], a[92:95], v[188:191]
    v_mfma_f32_16x16x32_bf16 v[188:191], v[28:31], a[124:127], v[188:191]
    v_mfma_f32_16x16x32_bf16 v[184:187], v[28:31], a[120:123], v[184:187]
    buffer_load_dwordx4 a[216:219], v1, s[48:51], s11 offen offset:2048 sc1
    v_mfma_f32_16x16x32_bf16 v[184:187], v[24:27], a[88:91], v[184:187]
    v_mfma_f32_16x16x32_bf16 v[180:183], v[24:27], a[84:87], v[180:183]
    s_waitcnt lgkmcnt(0)
    s_barrier
    s_waitcnt vmcnt(11)
    v_cmp_gt_u32 vcc, 4, v57
    s_cbranch_vccnz L_slow16
L_ok16:
    v_mfma_f32_16x16x32_bf16 v[180:183], v[28:31], a[116:119], v[180:183]
    s_nop 0
    ds_read_b64_tr_b16 v[16:17], v10 offset:0
    ds_read_b64_tr_b16 v[18:19], v10 offset:5120
    v_mfma_f32_16x16x32_bf16 v[176:179], v[28:31], a[112:115], v[176:179]
    v_mfma_f32_16x16x32_bf16 v[176:179], v[24:27], a[80:83], v[176:179]
    ds_read_b64_tr_b16 v[20:21], v10 offset:10240
    ds_read_b64_tr_b16 v[22:23], v10 offset:15360
    v_mfma_f32_16x16x32_bf16 v[192:195], v[32:35], a[80:83], v[192:195]
    s_add_u32 s6, s6, 4096
    s_add_u32 m0, s34, 0
    v_mfma_f32_16x16x32_bf16 v[192:195], v[36:39], a[112:115], v[192:195]
    buffer_load_dwordx4 v3, s[48:51], s6 offen sc1 lds
    v_mfma_f32_16x16x32_bf16 v[196:199], v[36:39], a[116:119], v[196:199]
    s_cmp_le_u32 s32, 1
    s_cselect_b32 s7, 2, 1
    s_mul_i32 s7, s7, 6144
    s_add_u32 s7, s7, s72
    s_add_u32 s7, s7, 28672
    v_mfma_f32_16x16x32_bf16 v[196:199], v[32:35], a[84:87], v[196:199]
    buffer_load_dwordx4 a[16:19], v60, s[48:51], s7 offen sc1
    v_mfma_f32_16x16x32_bf16 v[200:203], v[32:35], a[88:91], v[200:203]
    ds_read_b64_tr_b16 v[24:25], v11 offset:0
    ds_read_b64_tr_b16 v[26:27], v11 offset:5120
    v_mfma_f32_16x16x32_bf16 v[200:203], v[36:39], a[120:123], v[200:203]
    buffer_load_dwordx4 a[64:67], v60, s[48:51], s17 offen offset:2048 sc1
    v_mfma_f32_16x16x32_bf16 v[204:207], v[36:39], a[124:127], v[204:207]
    v_mfma_f32_16x16x32_bf16 v[204:207], v[32:35], a[92:95], v[204:207]
    ds_read_b64_tr_b16 v[28:29], v11 offset:10240
    ds_read_b64_tr_b16 v[30:31], v11 offset:15360
    v_mfma_f32_16x16x32_bf16 v[220:223], v[40:43], a[92:95], v[220:223]
    buffer_load_dwordx4 a[20:23], v61, s[48:51], s7 offen sc1
    v_mfma_f32_16x16x32_bf16 v[220:223], v[44:47], a[124:127], v[220:223]
    v_mfma_f32_16x16x32_bf16 v[216:219], v[44:47], a[120:123], v[216:219]
    buffer_load_dwordx4 a[220:223], v1, s[48:51], s11 offen offset:3072 sc1
    v_mfma_f32_16x16x32_bf16 v[216:219], v[40:43], a[88:91], v[216:219]
    v_mfma_f32_16x16x32_bf16 v[212:215], v[40:43], a[84:87], v[212:215]
    ds_read_b64_tr_b16 v[32:33], v10 offset:64
    ds_read_b64_tr_b16 v[34:35], v10 offset:5184
    v_mfma_f32_16x16x32_bf16 v[212:215], v[44:47], a[116:119], v[212:215]
    buffer_load_dwordx4 a[24:27], v62, s[48:51], s7 offen sc1
    v_mfma_f32_16x16x32_bf16 v[208:211], v[44:47], a[112:115], v[208:211]
    s_nop 0
    v_mfma_f32_16x16x32_bf16 v[208:211], v[40:43], a[80:83], v[208:211]
    s_waitcnt lgkmcnt(2)
    ds_read_b64_tr_b16 v[36:37], v10 offset:10304
    ds_read_b64_tr_b16 v[38:39], v10 offset:15424
    v_mfma_f32_16x16x32_bf16 v[64:67], v[16:19], a[144:147], v[64:67]
    buffer_load_dwordx4 a[68:71], v61, s[48:51], s17 offen offset:2048 sc1
    v_mfma_f32_16x16x32_bf16 v[64:67], v[20:23], a[176:179], v[64:67]
    v_mfma_f32_16x16x32_bf16 v[68:71], v[20:23], a[180:183], v[68:71]
    buffer_load_dwordx4 a[28:31], v63, s[48:51], s7 offen sc1
    v_mfma_f32_16x16x32_bf16 v[68:71], v[16:19], a[148:151], v[68:71]
    v_mfma_f32_16x16x32_bf16 v[72:75], v[16:19], a[152:155], v[72:75]
    ds_read_b64_tr_b16 v[40:41], v11 offset:64
    ds_read_b64_tr_b16 v[42:43], v11 offset:5184
    v_mfma_f32_16x16x32_bf16 v[72:75], v[20:23], a[184:187], v[72:75]
    s_add_u32 s6, s6, 4096
    s_add_u32 m0, s34, 4096
    v_mfma_f32_16x16x32_bf16 v[76:79], v[20:23], a[188:191], v[76:79]
    buffer_load_dwordx4 v3, s[48:51], s6 offen sc1 lds
    v_mfma_f32_16x16x32_bf16 v[76:79], v[16:19], a[156:159], v[76:79]
    ds_read_b64_tr_b16 v[44:45], v11 offset:10304
    ds_read_b64_tr_b16 v[46:47], v11 offset:15424
    v_mfma_f32_16x16x32_bf16 v[92:95], v[24:27], a[156:159], v[92:95]
    buffer_load_dwordx4 a[48:51], v60, s[48:51], s7 offen offset:1024 sc1
    v_mfma_f32_16x16x32_bf16 v[92:95], v[28:31], a[188:191], v[92:95]
    v_mfma_f32_16x16x32_bf16 v[88:91], v[28:31], a[184:187], v[88:91]
    buffer_load_dwordx4 a[72:75], v62, s[48:51], s17 offen offset:2048 sc1
    v_mfma_f32_16x16x32_bf16 v[88:91], v[24:27], a[152:155], v[88:91]
    v_mfma_f32_16x16x32_bf16 v[84:87], v[24:27], a[148:151], v[84:87]
    s_add_u32 s11, s11, 4096
    ds_read_b64_tr_b16 v[16:17], v10 offset:128
    ds_read_b64_tr_b16 v[18:19], v10 offset:5248
    v_mfma_f32_16x16x32_bf16 v[84:87], v[28:31], a[180:183], v[84:87]
    buffer_load_dwordx4 a[224:227], v1, s[48:51], s11 offen sc1
    v_mfma_f32_16x16x32_bf16 v[80:83], v[28:31], a[176:179], v[80:83]
    s_nop 0
    v_mfma_f32_16x16x32_bf16 v[80:83], v[24:27], a[144:147], v[80:83]
    s_waitcnt lgkmcnt(2)
    ds_read_b64_tr_b16 v[20:21], v10 offset:10368
    ds_read_b64_tr_b16 v[22:23], v10 offset:15488
    v_mfma_f32_16x16x32_bf16 v[96:99], v[32:35], a[144:147], v[96:99]
    buffer_load_dwordx4 a[52:55], v61, s[48:51], s7 offen offset:1024 sc1
    v_mfma_f32_16x16x32_bf16 v[96:99], v[36:39], a[176:179], v[96:99]
    v_mfma_f32_16x16x32_bf16 v[100:103], v[36:39], a[180:183], v[100:103]
    buffer_load_dwordx4 a[56:59], v62, s[48:51], s7 offen offset:1024 sc1
    v_mfma_f32_16x16x32_bf16 v[100:103], v[32:35], a[148:151], v[100:103]
    v_mfma_f32_16x16x32_bf16 v[104:107], v[32:35], a[152:155], v[104:107]
    ds_read_b64_tr_b16 v[24:25], v11 offset:128
    ds_read_b64_tr_b16 v[26:27], v11 offset:5248
    v_mfma_f32_16x16x32_bf16 v[104:107], v[36:39], a[184:187], v[104:107]
    buffer_load_dwordx4 a[76:79], v63, s[48:51], s17 offen offset:2048 sc1
    v_mfma_f32_16x16x32_bf16 v[108:111], v[36:39], a[188:191], v[108:111]
    v_mfma_f32_16x16x32_bf16 v[108:111], v[32:35], a[156:159], v[108:111]
    ds_read_b64_tr_b16 v[28:29], v11 offset:10368
    ds_read_b64_tr_b16 v[30:31], v11 offset:15488
    v_mfma_f32_16x16x32_bf16 v[124:127], v[40:43], a[156:159], v[124:127]
    s_add_u32 s6, s6, 4096
    s_add_u32 m0, s34, 8192
    v_mfma_f32_16x16x32_bf16 v[124:127], v[44:47], a[188:191], v[124:127]
    buffer_load_dwordx4 v3, s[48:51], s6 offen sc1 lds
    v_mfma_f32_16x16x32_bf16 v[120:123], v[44:47], a[184:187], v[120:123]
    v_mfma_f32_16x16x32_bf16 v[120:123], v[40:43], a[152:155], v[120:123]
    buffer_load_dwordx4 a[228:231], v1, s[48:51], s11 offen offset:1024 sc1
    v_mfma_f32_16x16x32_bf16 v[116:119], v[40:43], a[148:151], v[116:119]
    ds_read_b64_tr_b16 v[32:33], v10 offset:192
    ds_read_b64_tr_b16 v[34:35], v10 offset:5312
    v_mfma_f32_16x16x32_bf16 v[116:119], v[44:47], a[180:183], v[116:119]
    buffer_load_dwordx4 a[60:63], v63, s[48:51], s7 offen offset:1024 sc1
    v_mfma_f32_16x16x32_bf16 v[112:115], v[44:47], a[176:179], v[112:115]
    s_nop 0
    v_mfma_f32_16x16x32_bf16 v[112:115], v[40:43], a[144:147], v[112:115]
    s_waitcnt lgkmcnt(2)
    ds_read_b64_tr_b16 v[36:37], v10 offset:10432
    ds_read_b64_tr_b16 v[38:39], v10 offset:15552
    v_mfma_f32_16x16x32_bf16 v[128:131], v[16:19], a[144:147], v[128:131]
    buffer_load_dwordx4 a[96:99], v60, s[48:51], s17 offen offset:3072 sc1
    v_mfma_f32_16x16x32_bf16 v[128:131], v[20:23], a[176:179], v[128:131]
    v_mfma_f32_16x16x32_bf16 v[132:135], v[20:23], a[180:183], v[132:135]
    buffer_load_dwordx4 a[232:235], v1, s[48:51], s11 offen offset:2048 sc1
    v_mfma_f32_16x16x32_bf16 v[132:135], v[16:19], a[148:151], v[132:135]
    v_mfma_f32_16x16x32_bf16 v[136:139], v[16:19], a[152:155], v[136:139]
    ds_read_b64_tr_b16 v[40:41], v11 offset:192
    ds_read_b64_tr_b16 v[42:43], v11 offset:5312
    v_mfma_f32_16x16x32_bf16 v[136:139], v[20:23], a[184:187], v[136:139]
    buffer_load_dwordx4 a[100:103], v61, s[48:51], s17 offen offset:3072 sc1
    v_mfma_f32_16x16x32_bf16 v[140:143], v[20:23], a[188:191], v[140:143]
    v_mfma_f32_16x16x32_bf16 v[140:143], v[16:19], a[156:159], v[140:143]
    ds_read_b64_tr_b16 v[44:45], v11 offset:10432
    ds_read_b64_tr_b16 v[46:47], v11 offset:15552
    v_mfma_f32_16x16x32_bf16 v[156:159], v[24:27], a[156:159], v[156:159]
    s_add_u32 s6, s6, 4096
    s_add_u32 m0, s34, 12288
    v_mfma_f32_16x16x32_bf16 v[156:159], v[28:31], a[188:191], v[156:159]
    buffer_load_dwordx4 v3, s[48:51], s6 offen sc1 lds
    v_mfma_f32_16x16x32_bf16 v[152:155], v[28:31], a[184:187], v[152:155]
    v_mfma_f32_16x16x32_bf16 v[152:155], v[24:27], a[152:155], v[152:155]
    buffer_load_dwordx4 a[104:107], v62, s[48:51], s17 offen offset:3072 sc1
    v_mfma_f32_16x16x32_bf16 v[148:151], v[24:27], a[148:151], v[148:151]
    ds_read_b64_tr_b16 v[16:17], v10 offset:256
    ds_read_b64_tr_b16 v[18:19], v10 offset:5376
    v_mfma_f32_16x16x32_bf16 v[148:151], v[28:31], a[180:183], v[148:151]
    buffer_load_dwordx4 a[236:239], v1, s[48:51], s11 offen offset:3072 sc1
    v_mfma_f32_16x16x32_bf16 v[144:147], v[28:31], a[176:179], v[144:147]
    s_nop 0
    v_mfma_f32_16x16x32_bf16 v[144:147], v[24:27], a[144:147], v[144:147]
    s_waitcnt lgkmcnt(2)
    ds_read_b64_tr_b16 v[20:21], v10 offset:10496
    ds_read_b64_tr_b16 v[22:23], v10 offset:15616
    v_mfma_f32_16x16x32_bf16 v[160:163], v[32:35], a[144:147], v[160:163]
    v_mfma_f32_16x16x32_bf16 v[160:163], v[36:39], a[176:179], v[160:163]
    v_mfma_f32_16x16x32_bf16 v[164:167], v[36:39], a[180:183], v[164:167]
    v_mfma_f32_16x16x32_bf16 v[164:167], v[32:35], a[148:151], v[164:167]
    buffer_load_dwordx4 a[108:111], v63, s[48:51], s17 offen offset:3072 sc1
    v_mfma_f32_16x16x32_bf16 v[168:171], v[32:35], a[152:155], v[168:171]
    ds_read_b64_tr_b16 v[24:25], v11 offset:256
    ds_read_b64_tr_b16 v[26:27], v11 offset:5376
    v_mfma_f32_16x16x32_bf16 v[168:171], v[36:39], a[184:187], v[168:171]
    s_add_u32 s6, s6, 4096
    s_add_u32 m0, s34, 16384
    v_mfma_f32_16x16x32_bf16 v[172:175], v[36:39], a[188:191], v[172:175]
    buffer_load_dwordx4 v3, s[48:51], s6 offen sc1 lds
    v_mfma_f32_16x16x32_bf16 v[172:175], v[32:35], a[156:159], v[172:175]
    s_add_u32 s11, s11, 4096
    ds_read_b64_tr_b16 v[28:29], v11 offset:10496
    ds_read_b64_tr_b16 v[30:31], v11 offset:15616
    v_mfma_f32_16x16x32_bf16 v[188:191], v[40:43], a[156:159], v[188:191]
    buffer_load_dwordx4 a[240:243], v1, s[48:51], s11 offen sc1
    v_mfma_f32_16x16x32_bf16 v[188:191], v[44:47], a[188:191], v[188:191]
    v_mfma_f32_16x16x32_bf16 v[184:187], v[44:47], a[184:187], v[184:187]
    v_mfma_f32_16x16x32_bf16 v[184:187], v[40:43], a[152:155], v[184:187]
    v_mfma_f32_16x16x32_bf16 v[180:183], v[40:43], a[148:151], v[180:183]
    s_add_u32 s17, s17, 4096
    ds_read_b64_tr_b16 v[32:33], v10 offset:20480
    ds_read_b64_tr_b16 v[34:35], v10 offset:25600
    v_mfma_f32_16x16x32_bf16 v[180:183], v[44:47], a[180:183], v[180:183]
    buffer_load_dwordx4 a[128:131], v60, s[48:51], s17 offen sc1
    v_mfma_f32_16x16x32_bf16 v[176:179], v[44:47], a[176:179], v[176:179]
    v_mfma_f32_16x16x32_bf16 v[176:179], v[40:43], a[144:147], v[176:179]
    s_waitcnt lgkmcnt(2)
    ds_read_b64_tr_b16 v[36:37], v10 offset:30720
    ds_read_b64_tr_b16 v[38:39], v10 offset:35840
    v_mfma_f32_16x16x32_bf16 v[192:195], v[16:19], a[144:147], v[192:195]
    s_nop 0
    v_mfma_f32_16x16x32_bf16 v[192:195], v[20:23], a[176:179], v[192:195]
    v_mfma_f32_16x16x32_bf16 v[196:199], v[20:23], a[180:183], v[196:199]
    v_mfma_f32_16x16x32_bf16 v[196:199], v[16:19], a[148:151], v[196:199]
    v_mfma_f32_16x16x32_bf16 v[200:203], v[16:19], a[152:155], v[200:203]
    ds_read_b64_tr_b16 v[40:41], v11 offset:20480
    ds_read_b64_tr_b16 v[42:43], v11 offset:25600
    v_mfma_f32_16x16x32_bf16 v[200:203], v[20:23], a[184:187], v[200:203]
    buffer_load_dwordx4 a[244:247], v1, s[48:51], s11 offen offset:1024 sc1
    v_mfma_f32_16x16x32_bf16 v[204:207], v[20:23], a[188:191], v[204:207]
    s_nop 0
    v_mfma_f32_16x16x32_bf16 v[204:207], v[16:19], a[156:159], v[204:207]
    s_nop 0
    ds_read_b64_tr_b16 v[44:45], v11 offset:30720
    ds_read_b64_tr_b16 v[46:47], v11 offset:35840
    v_mfma_f32_16x16x32_bf16 v[220:223], v[24:27], a[156:159], v[220:223]
    buffer_load_dwordx4 a[132:135], v61, s[48:51], s17 offen sc1
    v_mfma_f32_16x16x32_bf16 v[220:223], v[28:31], a[188:191], v[220:223]
    v_mfma_f32_16x16x32_bf16 v[216:219], v[28:31], a[184:187], v[216:219]
    s_nop 0
    v_mfma_f32_16x16x32_bf16 v[216:219], v[24:27], a[152:155], v[216:219]
    s_nop 0
    v_mfma_f32_16x16x32_bf16 v[212:215], v[24:27], a[148:151], v[212:215]
    ds_read_b64_tr_b16 v[16:17], v10 offset:20544
    ds_read_b64_tr_b16 v[18:19], v10 offset:25664
    v_mfma_f32_16x16x32_bf16 v[212:215], v[28:31], a[180:183], v[212:215]
    v_mfma_f32_16x16x32_bf16 v[208:211], v[28:31], a[176:179], v[208:211]
    s_nop 0
    v_mfma_f32_16x16x32_bf16 v[208:211], v[24:27], a[144:147], v[208:211]
    s_waitcnt vmcnt(28) lgkmcnt(2)
    ds_read_b64_tr_b16 v[20:21], v10 offset:30784
    ds_read_b64_tr_b16 v[22:23], v10 offset:35904
    v_mfma_f32_16x16x32_bf16 v[64:67], v[32:35], a[16:19], v[64:67]
    s_waitcnt vmcnt(20)
    buffer_load_dwordx4 a[136:139], v62, s[48:51], s17 offen sc1
    v_mfma_f32_16x16x32_bf16 v[64:67], v[36:39], a[48:51], v[64:67]
    s_waitcnt vmcnt(18)
    v_mfma_f32_16x16x32_bf16 v[68:71], v[36:39], a[52:55], v[68:71]
    buffer_load_dwordx4 a[248:251], v1, s[48:51], s11 offen offset:2048 sc1
    v_mfma_f32_16x16x32_bf16 v[68:71], v[32:35], a[20:23], v[68:71]
    v_mfma_f32_16x16x32_bf16 v[72:75], v[32:35], a[24:27], v[72:75]
    s_waitcnt vmcnt(18)
    ds_read_b64_tr_b16 v[24:25], v11 offset:20544
    ds_read_b64_tr_b16 v[26:27], v11 offset:25664
    v_mfma_f32_16x16x32_bf16 v[72:75], v[36:39], a[56:59], v[72:75]
    s_waitcnt vmcnt(14)
    v_mfma_f32_16x16x32_bf16 v[76:79], v[36:39], a[60:63], v[76:79]
    v_mfma_f32_16x16x32_bf16 v[76:79], v[32:35], a[28:31], v[76:79]
    ds_read_b64_tr_b16 v[28:29], v11 offset:30784
    ds_read_b64_tr_b16 v[30:31], v11 offset:35904
    v_mfma_f32_16x16x32_bf16 v[92:95], v[40:43], a[28:31], v[92:95]
    buffer_load_dwordx4 a[140:143], v63, s[48:51], s17 offen sc1
    v_mfma_f32_16x16x32_bf16 v[92:95], v[44:47], a[60:63], v[92:95]
    v_mfma_f32_16x16x32_bf16 v[88:91], v[44:47], a[56:59], v[88:91]
    v_mfma_f32_16x16x32_bf16 v[88:91], v[40:43], a[24:27], v[88:91]
    v_mfma_f32_16x16x32_bf16 v[84:87], v[40:43], a[20:23], v[84:87]
    ds_read_b64_tr_b16 v[32:33], v10 offset:20608
    ds_read_b64_tr_b16 v[34:35], v10 offset:25728
    v_mfma_f32_16x16x32_bf16 v[84:87], v[44:47], a[52:55], v[84:87]
    v_mfma_f32_16x16x32_bf16 v[80:83], v[44:47], a[48:51], v[80:83]
    s_nop 0
    v_mfma_f32_16x16x32_bf16 v[80:83], v[40:43], a[16:19], v[80:83]
    s_waitcnt lgkmcnt(2)
    ds_read_b64_tr_b16 v[36:37], v10 offset:30848
    ds_read_b64_tr_b16 v[38:39], v10 offset:35968
    v_mfma_f32_16x16x32_bf16 v[96:99], v[16:19], a[16:19], v[96:99]
    buffer_load_dwordx4 a[252:255], v1, s[48:51], s11 offen offset:3072 sc1
    v_mfma_f32_16x16x32_bf16 v[96:99], v[20:23], a[48:51], v[96:99]
    v_mfma_f32_16x16x32_bf16 v[100:103], v[20:23], a[52:55], v[100:103]
    buffer_load_dwordx4 a[160:163], v60, s[48:51], s17 offen offset:1024 sc1
    v_mfma_f32_16x16x32_bf16 v[100:103], v[16:19], a[20:23], v[100:103]
    v_mfma_f32_16x16x32_bf16 v[104:107], v[16:19], a[24:27], v[104:107]
    ds_read_b64_tr_b16 v[40:41], v11 offset:20608
    ds_read_b64_tr_b16 v[42:43], v11 offset:25728
    v_mfma_f32_16x16x32_bf16 v[104:107], v[20:23], a[56:59], v[104:107]
    v_mfma_f32_16x16x32_bf16 v[108:111], v[20:23], a[60:63], v[108:111]
    v_mfma_f32_16x16x32_bf16 v[108:111], v[16:19], a[28:31], v[108:111]
    ds_read_b64_tr_b16 v[44:45], v11 offset:30848
    ds_read_b64_tr_b16 v[46:47], v11 offset:35968
    v_mfma_f32_16x16x32_bf16 v[124:127], v[24:27], a[28:31], v[124:127]
    v_mfma_f32_16x16x32_bf16 v[124:127], v[28:31], a[60:63], v[124:127]
    v_mfma_f32_16x16x32_bf16 v[120:123], v[28:31], a[56:59], v[120:123]
    v_mfma_f32_16x16x32_bf16 v[120:123], v[24:27], a[24:27], v[120:123]
    buffer_load_dwordx4 a[164:167], v61, s[48:51], s17 offen offset:1024 sc1
    v_mfma_f32_16x16x32_bf16 v[116:119], v[24:27], a[20:23], v[116:119]
    s_add_u32 s11, s11, 4096
    ds_read_b64_tr_b16 v[16:17], v10 offset:20672
    ds_read_b64_tr_b16 v[18:19], v10 offset:25792
    v_mfma_f32_16x16x32_bf16 v[116:119], v[28:31], a[52:55], v[116:119]
    buffer_load_dwordx4 v[224:227], v1, s[48:51], s11 offen sc1
    v_mfma_f32_16x16x32_bf16 v[112:115], v[28:31], a[48:51], v[112:115]
    s_nop 0
    v_mfma_f32_16x16x32_bf16 v[112:115], v[24:27], a[16:19], v[112:115]
    s_waitcnt lgkmcnt(2)
    ds_read_b64_tr_b16 v[20:21], v10 offset:30912
    ds_read_b64_tr_b16 v[22:23], v10 offset:36032
    v_mfma_f32_16x16x32_bf16 v[128:131], v[32:35], a[16:19], v[128:131]
    v_mfma_f32_16x16x32_bf16 v[128:131], v[36:39], a[48:51], v[128:131]
    v_mfma_f32_16x16x32_bf16 v[132:135], v[36:39], a[52:55], v[132:135]
    v_mfma_f32_16x16x32_bf16 v[132:135], v[32:35], a[20:23], v[132:135]
    v_mfma_f32_16x16x32_bf16 v[136:139], v[32:35], a[24:27], v[136:139]
    ds_read_b64_tr_b16 v[24:25], v11 offset:20672
    ds_read_b64_tr_b16 v[26:27], v11 offset:25792
    v_mfma_f32_16x16x32_bf16 v[136:139], v[36:39], a[56:59], v[136:139]
    buffer_load_dwordx4 a[168:171], v62, s[48:51], s17 offen offset:1024 sc1
    v_mfma_f32_16x16x32_bf16 v[140:143], v[36:39], a[60:63], v[140:143]
    v_mfma_f32_16x16x32_bf16 v[140:143], v[32:35], a[28:31], v[140:143]
    ds_read_b64_tr_b16 v[28:29], v11 offset:30912
    ds_read_b64_tr_b16 v[30:31], v11 offset:36032
    v_mfma_f32_16x16x32_bf16 v[156:159], v[40:43], a[28:31], v[156:159]
    v_mfma_f32_16x16x32_bf16 v[156:159], v[44:47], a[60:63], v[156:159]
    buffer_load_dwordx4 v[228:231], v1, s[48:51], s11 offen offset:1024 sc1
    v_mfma_f32_16x16x32_bf16 v[152:155], v[44:47], a[56:59], v[152:155]
    v_mfma_f32_16x16x32_bf16 v[152:155], v[40:43], a[24:27], v[152:155]
    v_mfma_f32_16x16x32_bf16 v[148:151], v[40:43], a[20:23], v[148:151]
    ds_read_b64_tr_b16 v[32:33], v10 offset:20736
    ds_read_b64_tr_b16 v[34:35], v10 offset:25856
    v_mfma_f32_16x16x32_bf16 v[148:151], v[44:47], a[52:55], v[148:151]
    v_mfma_f32_16x16x32_bf16 v[144:147], v[44:47], a[48:51], v[144:147]
    buffer_load_dwordx4 a[172:175], v63, s[48:51], s17 offen offset:1024 sc1
    v_mfma_f32_16x16x32_bf16 v[144:147], v[40:43], a[16:19], v[144:147]
    s_waitcnt lgkmcnt(2)
    ds_read_b64_tr_b16 v[36:37], v10 offset:30976
    s_nop 0
    ds_read_b64_tr_b16 v[38:39], v10 offset:36096
    v_mfma_f32_16x16x32_bf16 v[160:163], v[16:19], a[16:19], v[160:163]
    v_mfma_f32_16x16x32_bf16 v[160:163], v[20:23], a[48:51], v[160:163]
    v_mfma_f32_16x16x32_bf16 v[164:167], v[20:23], a[52:55], v[164:167]
    ds_read_b64_tr_b16 v[40:41], v11 offset:20736
    ds_read_b64_tr_b16 v[42:43], v11 offset:25856
    v_mfma_f32_16x16x32_bf16 v[164:167], v[16:19], a[20:23], v[164:167]
    v_mfma_f32_16x16x32_bf16 v[168:171], v[16:19], a[24:27], v[168:171]
    v_mfma_f32_16x16x32_bf16 v[168:171], v[20:23], a[56:59], v[168:171]
    ds_read_b64_tr_b16 v[44:45], v11 offset:30976
    ds_read_b64_tr_b16 v[46:47], v11 offset:36096
    v_mfma_f32_16x16x32_bf16 v[172:175], v[20:23], a[60:63], v[172:175]
    v_mfma_f32_16x16x32_bf16 v[172:175], v[16:19], a[28:31], v[172:175]
    buffer_load_dwordx4 v[232:235], v1, s[48:51], s11 offen offset:2048 sc1
    v_mfma_f32_16x16x32_bf16 v[188:191], v[24:27], a[28:31], v[188:191]
    v_mfma_f32_16x16x32_bf16 v[188:191], v[28:31], a[60:63], v[188:191]
    v_mfma_f32_16x16x32_bf16 v[184:187], v[28:31], a[56:59], v[184:187]
    v_mfma_f32_16x16x32_bf16 v[184:187], v[24:27], a[24:27], v[184:187]
    v_mfma_f32_16x16x32_bf16 v[180:183], v[24:27], a[20:23], v[180:183]
    s_waitcnt vmcnt(15) lgkmcnt(0)
    s_barrier
    v_mfma_f32_16x16x32_bf16 v[180:183], v[28:31], a[52:55], v[180:183]
    ds_read_b64_tr_b16 v[16:17], v12 offset:0
    ds_read_b64_tr_b16 v[18:19], v12 offset:5120
    v_mfma_f32_16x16x32_bf16 v[176:179], v[28:31], a[48:51], v[176:179]
    v_mfma_f32_16x16x32_bf16 v[176:179], v[24:27], a[16:19], v[176:179]
    ds_read_b64_tr_b16 v[20:21], v12 offset:10240
    ds_read_b64_tr_b16 v[22:23], v12 offset:15360
    v_mfma_f32_16x16x32_bf16 v[192:195], v[32:35], a[16:19], v[192:195]
    s_add_u32 s8, s8, 4096
    s_add_u32 m0, s34, 40960
    v_mfma_f32_16x16x32_bf16 v[192:195], v[36:39], a[48:51], v[192:195]
    buffer_load_dwordx4 v3, s[48:51], s8 offen sc1 lds
    v_mfma_f32_16x16x32_bf16 v[196:199], v[36:39], a[52:55], v[196:199]
    v_mfma_f32_16x16x32_bf16 v[196:199], v[32:35], a[20:23], v[196:199]
    v_mfma_f32_16x16x32_bf16 v[200:203], v[32:35], a[24:27], v[200:203]
    ds_read_b64_tr_b16 v[24:25], v13 offset:0
    ds_read_b64_tr_b16 v[26:27], v13 offset:5120
    v_mfma_f32_16x16x32_bf16 v[200:203], v[36:39], a[56:59], v[200:203]
    buffer_load_dwordx4 v[236:239], v1, s[48:51], s11 offen offset:3072 sc1
    v_mfma_f32_16x16x32_bf16 v[204:207], v[36:39], a[60:63], v[204:207]
    v_mfma_f32_16x16x32_bf16 v[204:207], v[32:35], a[28:31], v[204:207]
    ds_read_b64_tr_b16 v[28:29], v13 offset:10240
    ds_read_b64_tr_b16 v[30:31], v13 offset:15360
    v_mfma_f32_16x16x32_bf16 v[220:223], v[40:43], a[28:31], v[220:223]
    v_mfma_f32_16x16x32_bf16 v[220:223], v[44:47], a[60:63], v[220:223]
    s_add_u32 s8, s8, 4096
    s_add_u32 m0, s34, 45056
    v_mfma_f32_16x16x32_bf16 v[216:219], v[44:47], a[56:59], v[216:219]
    buffer_load_dwordx4 v3, s[48:51], s8 offen sc1 lds
    v_mfma_f32_16x16x32_bf16 v[216:219], v[40:43], a[24:27], v[216:219]
    v_mfma_f32_16x16x32_bf16 v[212:215], v[40:43], a[20:23], v[212:215]
    ds_read_b64_tr_b16 v[32:33], v12 offset:20480
    ds_read_b64_tr_b16 v[34:35], v12 offset:25600
    v_mfma_f32_16x16x32_bf16 v[212:215], v[44:47], a[52:55], v[212:215]
    v_mfma_f32_16x16x32_bf16 v[208:211], v[44:47], a[48:51], v[208:211]
    s_nop 0
    v_mfma_f32_16x16x32_bf16 v[208:211], v[40:43], a[16:19], v[208:211]
    s_waitcnt lgkmcnt(2)
    ds_read_b64_tr_b16 v[36:37], v12 offset:30720
    ds_read_b64_tr_b16 v[38:39], v12 offset:35840
    v_mfma_f32_16x16x32_bf16 v[64:67], v[16:19], a[0:3], v[64:67]
    s_add_u32 s11, s11, 4096
    v_mfma_f32_16x16x32_bf16 v[64:67], v[20:23], a[32:35], v[64:67]
    buffer_load_dwordx4 a[80:83], v1, s[48:51], s11 offen sc1
    v_mfma_f32_16x16x32_bf16 v[68:71], v[20:23], a[36:39], v[68:71]
    v_mfma_f32_16x16x32_bf16 v[68:71], v[16:19], a[4:7], v[68:71]
    v_mfma_f32_16x16x32_bf16 v[72:75], v[16:19], a[8:11], v[72:75]
    ds_read_b64_tr_b16 v[40:41], v13 offset:20480
    ds_read_b64_tr_b16 v[42:43], v13 offset:25600
    v_mfma_f32_16x16x32_bf16 v[72:75], v[20:23], a[40:43], v[72:75]
    s_add_u32 s8, s8, 4096
    s_add_u32 m0, s34, 49152
    v_mfma_f32_16x16x32_bf16 v[76:79], v[20:23], a[44:47], v[76:79]
    buffer_load_dwordx4 v3, s[48:51], s8 offen sc1 lds
    v_mfma_f32_16x16x32_bf16 v[76:79], v[16:19], a[12:15], v[76:79]
    ds_read_b64_tr_b16 v[44:45], v13 offset:30720
    ds_read_b64_tr_b16 v[46:47], v13 offset:35840
    v_mfma_f32_16x16x32_bf16 v[92:95], v[24:27], a[12:15], v[92:95]
    v_mfma_f32_16x16x32_bf16 v[92:95], v[28:31], a[44:47], v[92:95]
    v_mfma_f32_16x16x32_bf16 v[88:91], v[28:31], a[40:43], v[88:91]
    v_mfma_f32_16x16x32_bf16 v[88:91], v[24:27], a[8:11], v[88:91]
    v_mfma_f32_16x16x32_bf16 v[84:87], v[24:27], a[4:7], v[84:87]
    ds_read_b64_tr_b16 v[16:17], v8 offset:0
    ds_read_b64_tr_b16 v[18:19], v8 offset:5120
    v_mfma_f32_16x16x32_bf16 v[84:87], v[28:31], a[36:39], v[84:87]
    v_mfma_f32_16x16x32_bf16 v[80:83], v[28:31], a[32:35], v[80:83]
    buffer_load_dwordx4 a[84:87], v1, s[48:51], s11 offen offset:1024 sc1
    v_mfma_f32_16x16x32_bf16 v[80:83], v[24:27], a[0:3], v[80:83]
    s_waitcnt lgkmcnt(2)
    s_nop 0
    ds_read_b64_tr_b16 v[20:21], v8 offset:10240
    ds_read_b64_tr_b16 v[22:23], v8 offset:15360
    v_mfma_f32_16x16x32_bf16 v[64:67], v[32:35], a[64:67], v[64:67]
    s_add_u32 s8, s8, 4096
    s_add_u32 m0, s34, 53248
    v_mfma_f32_16x16x32_bf16 v[64:67], v[36:39], a[96:99], v[64:67]
    buffer_load_dwordx4 v3, s[48:51], s8 offen sc1 lds
    v_mfma_f32_16x16x32_bf16 v[68:71], v[36:39], a[100:103], v[68:71]
    v_mfma_f32_16x16x32_bf16 v[68:71], v[32:35], a[68:71], v[68:71]
    v_mfma_f32_16x16x32_bf16 v[72:75], v[32:35], a[72:75], v[72:75]
    ds_read_b64_tr_b16 v[24:25], v9 offset:0
    ds_read_b64_tr_b16 v[26:27], v9 offset:5120
    v_mfma_f32_16x16x32_bf16 v[72:75], v[36:39], a[104:107], v[72:75]
    v_mfma_f32_16x16x32_bf16 v[76:79], v[36:39], a[108:111], v[76:79]
    v_mfma_f32_16x16x32_bf16 v[76:79], v[32:35], a[76:79], v[76:79]
    ds_read_b64_tr_b16 v[28:29], v9 offset:10240
    ds_read_b64_tr_b16 v[30:31], v9 offset:15360
    v_mfma_f32_16x16x32_bf16 v[92:95], v[40:43], a[76:79], v[92:95]
    v_mfma_f32_16x16x32_bf16 v[92:95], v[44:47], a[108:111], v[92:95]
    s_add_u32 s8, s8, 4096
    s_add_u32 m0, s34, 57344
    v_mfma_f32_16x16x32_bf16 v[88:91], v[44:47], a[104:107], v[88:91]
    buffer_load_dwordx4 v3, s[48:51], s8 offen sc1 lds
    v_mfma_f32_16x16x32_bf16 v[88:91], v[40:43], a[72:75], v[88:91]
    v_mfma_f32_16x16x32_bf16 v[84:87], v[40:43], a[68:71], v[84:87]
    ds_read_b64_tr_b16 v[32:33], v12 offset:64
    ds_read_b64_tr_b16 v[34:35], v12 offset:5184
    v_mfma_f32_16x16x32_bf16 v[84:87], v[44:47], a[100:103], v[84:87]
    buffer_load_dwordx4 a[88:91], v1, s[48:51], s11 offen offset:2048 sc1
    v_mfma_f32_16x16x32_bf16 v[80:83], v[44:47], a[96:99], v[80:83]
    s_nop 0
    v_mfma_f32_16x16x32_bf16 v[80:83], v[40:43], a[64:67], v[80:83]
    s_waitcnt vmcnt(22) lgkmcnt(2)
    ds_read_b64_tr_b16 v[36:37], v12 offset:10304
    ds_read_b64_tr_b16 v[38:39], v12 offset:15424
    v_mfma_f32_16x16x32_bf16 v[64:67], v[16:19], a[128:131], v[64:67]
    s_waitcnt vmcnt(15)
    v_mfma_f32_16x16x32_bf16 v[64:67], v[20:23], a[160:163], v[64:67]
    s_waitcnt vmcnt(14)
    v_mfma_f32_16x16x32_bf16 v[68:71], v[20:23], a[164:167], v[68:71]
    s_nop 0
    v_mfma_f32_16x16x32_bf16 v[68:71], v[16:19], a[132:135], v[68:71]
    s_nop 0
    v_mfma_f32_16x16x32_bf16 v[72:75], v[16:19], a[136:139], v[72:75]
    s_waitcnt vmcnt(12)
    ds_read_b64_tr_b16 v[40:41], v13 offset:64
    ds_read_b64_tr_b16 v[42:43], v13 offset:5184
    v_mfma_f32_16x16x32_bf16 v[72:75], v[20:23], a[168:171], v[72:75]
    s_waitcnt vmcnt(10)
    s_add_u32 s8, s8, 4096
    s_add_u32 m0, s34, 61440
    v_mfma_f32_16x16x32_bf16 v[76:79], v[20:23], a[172:175], v[76:79]
    buffer_load_dwordx4 v3, s[48:51], s8 offen sc1 lds
    v_mfma_f32_16x16x32_bf16 v[76:79], v[16:19], a[140:143], v[76:79]
    ds_read_b64_tr_b16 v[44:45], v13 offset:10304
    ds_read_b64_tr_b16 v[46:47], v13 offset:15424
    v_mfma_f32_16x16x32_bf16 v[92:95], v[24:27], a[140:143], v[92:95]
    buffer_load_dwordx4 a[92:95], v1, s[48:51], s11 offen offset:3072 sc1
    v_mfma_f32_16x16x32_bf16 v[92:95], v[28:31], a[172:175], v[92:95]
    v_mfma_f32_16x16x32_bf16 v[88:91], v[28:31], a[168:171], v[88:91]
    v_mfma_f32_16x16x32_bf16 v[88:91], v[24:27], a[136:139], v[88:91]
    v_mfma_f32_16x16x32_bf16 v[84:87], v[24:27], a[132:135], v[84:87]
    ds_read_b64_tr_b16 v[16:17], v12 offset:20544
    ds_read_b64_tr_b16 v[18:19], v12 offset:25664
    v_mfma_f32_16x16x32_bf16 v[84:87], v[28:31], a[164:167], v[84:87]
    v_mfma_f32_16x16x32_bf16 v[80:83], v[28:31], a[160:163], v[80:83]
    s_nop 0
    v_mfma_f32_16x16x32_bf16 v[80:83], v[24:27], a[128:131], v[80:83]
    s_waitcnt lgkmcnt(2)
    ds_read_b64_tr_b16 v[20:21], v12 offset:30784
    ds_read_b64_tr_b16 v[22:23], v12 offset:35904
    v_mfma_f32_16x16x32_bf16 v[96:99], v[32:35], a[0:3], v[96:99]
    s_add_u32 s8, s8, 4096
    s_add_u32 m0, s34, 65536
    v_mfma_f32_16x16x32_bf16 v[96:99], v[36:39], a[32:35], v[96:99]
    buffer_load_dwordx4 v3, s[48:51], s8 offen sc1 lds
    v_mfma_f32_16x16x32_bf16 v[100:103], v[36:39], a[36:39], v[100:103]
    v_mfma_f32_16x16x32_bf16 v[100:103], v[32:35], a[4:7], v[100:103]
    v_cvt_pk_bf16_f32 v64, v64, v65
    v_cvt_pk_bf16_f32 v65, v66, v67
    v_mfma_f32_16x16x32_bf16 v[104:107], v[32:35], a[8:11], v[104:107]
    s_add_u32 s11, s11, 4096
    ds_read_b64_tr_b16 v[24:25], v13 offset:20544
    ds_read_b64_tr_b16 v[26:27], v13 offset:25664
    v_mfma_f32_16x16x32_bf16 v[104:107], v[36:39], a[40:43], v[104:107]
    buffer_load_dwordx4 a[112:115], v1, s[48:51], s11 offen sc1
    v_mfma_f32_16x16x32_bf16 v[108:111], v[36:39], a[44:47], v[108:111]
    v_cvt_pk_bf16_f32 v66, v80, v81
    v_cvt_pk_bf16_f32 v67, v82, v83
    v_mfma_f32_16x16x32_bf16 v[108:111], v[32:35], a[12:15], v[108:111]
    ds_read_b64_tr_b16 v[28:29], v13 offset:30784
    ds_read_b64_tr_b16 v[30:31], v13 offset:35904
    v_mfma_f32_16x16x32_bf16 v[124:127], v[40:43], a[12:15], v[124:127]
    v_cvt_pk_bf16_f32 v68, v68, v69
    v_cvt_pk_bf16_f32 v69, v70, v71
    v_mfma_f32_16x16x32_bf16 v[124:127], v[44:47], a[44:47], v[124:127]
    s_add_u32 s8, s8, 4096
    s_add_u32 m0, s34, 69632
    v_mfma_f32_16x16x32_bf16 v[120:123], v[44:47], a[40:43], v[120:123]
    buffer_load_dwordx4 v3, s[48:51], s8 offen sc1 lds
    v_mfma_f32_16x16x32_bf16 v[120:123], v[40:43], a[8:11], v[120:123]
    v_cvt_pk_bf16_f32 v70, v84, v85
    v_cvt_pk_bf16_f32 v71, v86, v87
    v_mfma_f32_16x16x32_bf16 v[116:119], v[40:43], a[4:7], v[116:119]
    ds_read_b64_tr_b16 v[32:33], v8 offset:64
    ds_read_b64_tr_b16 v[34:35], v8 offset:5184
    v_mfma_f32_16x16x32_bf16 v[116:119], v[44:47], a[36:39], v[116:119]
    v_mfma_f32_16x16x32_bf16 v[112:115], v[44:47], a[32:35], v[112:115]
    buffer_store_dwordx4 v[64:67], v1, s[48:51], s66 offen sc1
    v_mfma_f32_16x16x32_bf16 v[112:115], v[40:43], a[0:3], v[112:115]
    s_waitcnt lgkmcnt(2)
    ds_read_b64_tr_b16 v[36:37], v8 offset:10304
    ds_read_b64_tr_b16 v[38:39], v8 offset:15424
    v_mfma_f32_16x16x32_bf16 v[96:99], v[16:19], a[64:67], v[96:99]
    s_nop 0
    v_cvt_pk_bf16_f32 v72, v72, v73
    v_cvt_pk_bf16_f32 v73, v74, v75
    v_mfma_f32_16x16x32_bf16 v[96:99], v[20:23], a[96:99], v[96:99]
    v_mfma_f32_16x16x32_bf16 v[100:103], v[20:23], a[100:103], v[100:103]
    buffer_load_dwordx4 a[116:119], v1, s[48:51], s11 offen offset:1024 sc1
    v_mfma_f32_16x16x32_bf16 v[100:103], v[16:19], a[68:71], v[100:103]
    v_cvt_pk_bf16_f32 v74, v88, v89
    v_cvt_pk_bf16_f32 v75, v90, v91
    v_mfma_f32_16x16x32_bf16 v[104:107], v[16:19], a[72:75], v[104:107]
    ds_read_b64_tr_b16 v[40:41], v9 offset:64
    ds_read_b64_tr_b16 v[42:43], v9 offset:5184
    v_mfma_f32_16x16x32_bf16 v[104:107], v[20:23], a[104:107], v[104:107]
    s_add_u32 s8, s8, 4096
    s_add_u32 m0, s34, 73728
    v_mfma_f32_16x16x32_bf16 v[108:111], v[20:23], a[108:111], v[108:111]
    buffer_load_dwordx4 v3, s[48:51], s8 offen sc1 lds
    v_mfma_f32_16x16x32_bf16 v[108:111], v[16:19], a[76:79], v[108:111]
    ds_read_b64_tr_b16 v[44:45], v9 offset:10304
    ds_read_b64_tr_b16 v[46:47], v9 offset:15424
    v_mfma_f32_16x16x32_bf16 v[124:127], v[24:27], a[76:79], v[124:127]
    buffer_store_dwordx4 v[68:71], v1, s[48:51], s67 offen sc1
    v_mfma_f32_16x16x32_bf16 v[124:127], v[28:31], a[108:111], v[124:127]
    v_cvt_pk_bf16_f32 v76, v76, v77
    v_cvt_pk_bf16_f32 v77, v78, v79
    v_mfma_f32_16x16x32_bf16 v[120:123], v[28:31], a[104:107], v[120:123]
    v_cvt_pk_bf16_f32 v78, v92, v93
    v_cvt_pk_bf16_f32 v79, v94, v95
    v_mfma_f32_16x16x32_bf16 v[120:123], v[24:27], a[72:75], v[120:123]
    v_mfma_f32_16x16x32_bf16 v[116:119], v[24:27], a[68:71], v[116:119]
    ds_read_b64_tr_b16 v[16:17], v13 offset:128
    ds_read_b64_tr_b16 v[18:19], v13 offset:5248
    v_mfma_f32_16x16x32_bf16 v[116:119], v[28:31], a[100:103], v[116:119]
    s_nop 0
    v_mfma_f32_16x16x32_bf16 v[112:115], v[28:31], a[96:99], v[112:115]
    buffer_store_dwordx4 v[72:75], v1, s[48:51], s68 offen sc1
    v_mfma_f32_16x16x32_bf16 v[112:115], v[24:27], a[64:67], v[112:115]
    s_waitcnt lgkmcnt(2)
    ds_read_b64_tr_b16 v[20:21], v13 offset:10368
    ds_read_b64_tr_b16 v[22:23], v13 offset:15488
    v_mfma_f32_16x16x32_bf16 v[96:99], v[32:35], a[128:131], v[96:99]
    s_add_u32 s8, s8, 4096
    s_add_u32 m0, s34, 77824
    v_mfma_f32_16x16x32_bf16 v[96:99], v[36:39], a[160:163], v[96:99]
    buffer_load_dwordx4 v3, s[48:51], s8 offen sc1 lds
    v_mfma_f32_16x16x32_bf16 v[100:103], v[36:39], a[164:167], v[100:103]
    v_mfma_f32_16x16x32_bf16 v[100:103], v[32:35], a[132:135], v[100:103]
    buffer_load_dwordx4 a[120:123], v1, s[48:51], s11 offen offset:2048 sc1
    v_mfma_f32_16x16x32_bf16 v[104:107], v[32:35], a[136:139], v[104:107]
    ds_read_b64_tr_b16 v[24:25], v12 offset:192
    ds_read_b64_tr_b16 v[26:27], v12 offset:5312
    v_mfma_f32_16x16x32_bf16 v[104:107], v[36:39], a[168:171], v[104:107]
    v_mfma_f32_16x16x32_bf16 v[108:111], v[36:39], a[172:175], v[108:111]
    buffer_store_dwordx4 v[76:79], v1, s[48:51], s69 offen sc1
    v_mfma_f32_16x16x32_bf16 v[108:111], v[32:35], a[140:143], v[108:111]
    ds_read_b64_tr_b16 v[28:29], v12 offset:10432
    ds_read_b64_tr_b16 v[30:31], v12 offset:15552
    v_mfma_f32_16x16x32_bf16 v[124:127], v[40:43], a[140:143], v[124:127]
    v_mfma_f32_16x16x32_bf16 v[124:127], v[44:47], a[172:175], v[124:127]
    v_mfma_f32_16x16x32_bf16 v[120:123], v[44:47], a[168:171], v[120:123]
    v_mfma_f32_16x16x32_bf16 v[120:123], v[40:43], a[136:139], v[120:123]
    v_mfma_f32_16x16x32_bf16 v[116:119], v[40:43], a[132:135], v[116:119]
    ds_read_b64_tr_b16 v[32:33], v13 offset:20608
    ds_read_b64_tr_b16 v[34:35], v13 offset:25728
    v_mfma_f32_16x16x32_bf16 v[116:119], v[44:47], a[164:167], v[116:119]
    buffer_load_dwordx4 a[124:127], v1, s[48:51], s11 offen offset:3072 sc1
    v_mfma_f32_16x16x32_bf16 v[112:115], v[44:47], a[160:163], v[112:115]
    s_nop 0
    v_mfma_f32_16x16x32_bf16 v[112:115], v[40:43], a[128:131], v[112:115]
    s_waitcnt lgkmcnt(2)
    ds_read_b64_tr_b16 v[36:37], v13 offset:30848
    ds_read_b64_tr_b16 v[38:39], v13 offset:35968
    v_mfma_f32_16x16x32_bf16 v[144:147], v[16:19], a[0:3], v[144:147]
    v_mfma_f32_16x16x32_bf16 v[144:147], v[20:23], a[32:35], v[144:147]
    v_mfma_f32_16x16x32_bf16 v[148:151], v[20:23], a[36:39], v[148:151]
    v_mfma_f32_16x16x32_bf16 v[148:151], v[16:19], a[4:7], v[148:151]
    v_cvt_pk_bf16_f32 v96, v96, v97
    v_cvt_pk_bf16_f32 v97, v98, v99
    v_mfma_f32_16x16x32_bf16 v[152:155], v[16:19], a[8:11], v[152:155]
    ds_read_b64_tr_b16 v[40:41], v12 offset:20672
    ds_read_b64_tr_b16 v[42:43], v12 offset:25792
    v_mfma_f32_16x16x32_bf16 v[152:155], v[20:23], a[40:43], v[152:155]
    v_cvt_pk_bf16_f32 v98, v112, v113
    v_cvt_pk_bf16_f32 v99, v114, v115
    v_mfma_f32_16x16x32_bf16 v[156:159], v[20:23], a[44:47], v[156:159]
    v_cvt_pk_bf16_f32 v100, v100, v101
    v_cvt_pk_bf16_f32 v101, v102, v103
    v_mfma_f32_16x16x32_bf16 v[156:159], v[16:19], a[12:15], v[156:159]
    ds_read_b64_tr_b16 v[44:45], v12 offset:30912
    ds_read_b64_tr_b16 v[46:47], v12 offset:36032
    v_mfma_f32_16x16x32_bf16 v[172:175], v[24:27], a[12:15], v[172:175]
    s_add_u32 s11, s11, 4096
    v_mfma_f32_16x16x32_bf16 v[172:175], v[28:31], a[44:47], v[172:175]
    buffer_load_dwordx4 a[144:147], v1, s[48:51], s11 offen sc1
    v_mfma_f32_16x16x32_bf16 v[168:171], v[28:31], a[40:43], v[168:171]
    v_cvt_pk_bf16_f32 v102, v116, v117
    v_cvt_pk_bf16_f32 v103, v118, v119
    v_mfma_f32_16x16x32_bf16 v[168:171], v[24:27], a[8:11], v[168:171]
    v_cvt_pk_bf16_f32 v104, v104, v105
    v_cvt_pk_bf16_f32 v105, v106, v107
    v_mfma_f32_16x16x32_bf16 v[164:167], v[24:27], a[4:7], v[164:167]
    ds_read_b64_tr_b16 v[16:17], v9 offset:128
    ds_read_b64_tr_b16 v[18:19], v9 offset:5248
    v_mfma_f32_16x16x32_bf16 v[164:167], v[28:31], a[36:39], v[164:167]
    v_mfma_f32_16x16x32_bf16 v[160:163], v[28:31], a[32:35], v[160:163]
    buffer_store_dwordx4 v[96:99], v1, s[48:51], s66 offen offset:1024 sc1
    v_mfma_f32_16x16x32_bf16 v[160:163], v[24:27], a[0:3], v[160:163]
    s_waitcnt lgkmcnt(2)
    ds_read_b64_tr_b16 v[20:21], v9 offset:10368
    ds_read_b64_tr_b16 v[22:23], v9 offset:15488
    v_mfma_f32_16x16x32_bf16 v[144:147], v[32:35], a[64:67], v[144:147]
    s_nop 0
    v_cvt_pk_bf16_f32 v106, v120, v121
    v_cvt_pk_bf16_f32 v107, v122, v123
    v_mfma_f32_16x16x32_bf16 v[144:147], v[36:39], a[96:99], v[144:147]
    v_cvt_pk_bf16_f32 v108, v108, v109
    v_cvt_pk_bf16_f32 v109, v110, v111
    v_mfma_f32_16x16x32_bf16 v[148:151], v[36:39], a[100:103], v[148:151]
    v_cvt_pk_bf16_f32 v110, v124, v125
    v_cvt_pk_bf16_f32 v111, v126, v127
    v_mfma_f32_16x16x32_bf16 v[148:151], v[32:35], a[68:71], v[148:151]
    v_mfma_f32_16x16x32_bf16 v[152:155], v[32:35], a[72:75], v[152:155]
    ds_read_b64_tr_b16 v[24:25], v8 offset:192
    ds_read_b64_tr_b16 v[26:27], v8 offset:5312
    v_mfma_f32_16x16x32_bf16 v[152:155], v[36:39], a[104:107], v[152:155]
    v_mfma_f32_16x16x32_bf16 v[156:159], v[36:39], a[108:111], v[156:159]
    buffer_load_dwordx4 a[148:151], v1, s[48:51], s11 offen offset:1024 sc1
    v_mfma_f32_16x16x32_bf16 v[156:159], v[32:35], a[76:79], v[156:159]
    ds_read_b64_tr_b16 v[28:29], v8 offset:10432
    ds_read_b64_tr_b16 v[30:31], v8 offset:15552
    v_mfma_f32_16x16x32_bf16 v[172:175], v[40:43], a[76:79], v[172:175]
    buffer_store_dwordx4 v[100:103], v1, s[48:51], s67 offen offset:1024 sc1
    v_mfma_f32_16x16x32_bf16 v[172:175], v[44:47], a[108:111], v[172:175]
    s_nop 0
    v_mfma_f32_16x16x32_bf16 v[168:171], v[44:47], a[104:107], v[168:171]
    s_nop 0
    v_mfma_f32_16x16x32_bf16 v[168:171], v[40:43], a[72:75], v[168:171]
    v_mfma_f32_16x16x32_bf16 v[164:167], v[40:43], a[68:71], v[164:167]
    ds_read_b64_tr_b16 v[32:33], v13 offset:192
    ds_read_b64_tr_b16 v[34:35], v13 offset:5312
    v_mfma_f32_16x16x32_bf16 v[164:167], v[44:47], a[100:103], v[164:167]
    s_nop 0
    v_mfma_f32_16x16x32_bf16 v[160:163], v[44:47], a[96:99], v[160:163]
    buffer_store_dwordx4 v[104:107], v1, s[48:51], s68 offen offset:1024 sc1
    v_mfma_f32_16x16x32_bf16 v[160:163], v[40:43], a[64:67], v[160:163]
    s_waitcnt lgkmcnt(2)
    ds_read_b64_tr_b16 v[36:37], v13 offset:10432
    ds_read_b64_tr_b16 v[38:39], v13 offset:15552
    v_mfma_f32_16x16x32_bf16 v[144:147], v[16:19], a[128:131], v[144:147]
    v_mfma_f32_16x16x32_bf16 v[144:147], v[20:23], a[160:163], v[144:147]
    v_mfma_f32_16x16x32_bf16 v[148:151], v[20:23], a[164:167], v[148:151]
    v_mfma_f32_16x16x32_bf16 v[148:151], v[16:19], a[132:135], v[148:151]
    buffer_load_dwordx4 a[152:155], v1, s[48:51], s11 offen offset:2048 sc1
    v_mfma_f32_16x16x32_bf16 v[152:155], v[16:19], a[136:139], v[152:155]
    ds_read_b64_tr_b16 v[40:41], v12 offset:256
    ds_read_b64_tr_b16 v[42:43], v12 offset:5376
    v_mfma_f32_16x16x32_bf16 v[152:155], v[20:23], a[168:171], v[152:155]
    v_mfma_f32_16x16x32_bf16 v[156:159], v[20:23], a[172:175], v[156:159]
    buffer_store_dwordx4 v[108:111], v1, s[48:51], s69 offen offset:1024 sc1
    v_mfma_f32_16x16x32_bf16 v[156:159], v[16:19], a[140:143], v[156:159]
    ds_read_b64_tr_b16 v[44:45], v12 offset:10496
    ds_read_b64_tr_b16 v[46:47], v12 offset:15616
    v_mfma_f32_16x16x32_bf16 v[172:175], v[24:27], a[140:143], v[172:175]
    v_mfma_f32_16x16x32_bf16 v[172:175], v[28:31], a[172:175], v[172:175]
    v_mfma_f32_16x16x32_bf16 v[168:171], v[28:31], a[168:171], v[168:171]
    v_mfma_f32_16x16x32_bf16 v[168:171], v[24:27], a[136:139], v[168:171]
    v_mfma_f32_16x16x32_bf16 v[164:167], v[24:27], a[132:135], v[164:167]
    ds_read_b64_tr_b16 v[16:17], v13 offset:20672
    ds_read_b64_tr_b16 v[18:19], v13 offset:25792
    v_mfma_f32_16x16x32_bf16 v[164:167], v[28:31], a[164:167], v[164:167]
    v_mfma_f32_16x16x32_bf16 v[160:163], v[28:31], a[160:163], v[160:163]
    s_nop 0
    v_mfma_f32_16x16x32_bf16 v[160:163], v[24:27], a[128:131], v[160:163]
    s_waitcnt lgkmcnt(2)
    ds_read_b64_tr_b16 v[20:21], v13 offset:30912
    ds_read_b64_tr_b16 v[22:23], v13 offset:36032
    v_mfma_f32_16x16x32_bf16 v[176:179], v[32:35], a[0:3], v[176:179]
    buffer_load_dwordx4 a[156:159], v1, s[48:51], s11 offen offset:3072 sc1
    v_mfma_f32_16x16x32_bf16 v[176:179], v[36:39], a[32:35], v[176:179]
    v_mfma_f32_16x16x32_bf16 v[180:183], v[36:39], a[36:39], v[180:183]
    s_nop 0
    v_mfma_f32_16x16x32_bf16 v[180:183], v[32:35], a[4:7], v[180:183]
    s_nop 0
    v_cvt_pk_bf16_f32 v144, v144, v145
    v_cvt_pk_bf16_f32 v145, v146, v147
    v_mfma_f32_16x16x32_bf16 v[184:187], v[32:35], a[8:11], v[184:187]
    ds_read_b64_tr_b16 v[24:25], v12 offset:20736
    ds_read_b64_tr_b16 v[26:27], v12 offset:25856
    v_mfma_f32_16x16x32_bf16 v[184:187], v[36:39], a[40:43], v[184:187]
    v_cvt_pk_bf16_f32 v146, v160, v161
    v_cvt_pk_bf16_f32 v147, v162, v163
    v_mfma_f32_16x16x32_bf16 v[188:191], v[36:39], a[44:47], v[188:191]
    v_cvt_pk_bf16_f32 v148, v148, v149
    v_cvt_pk_bf16_f32 v149, v150, v151
    v_mfma_f32_16x16x32_bf16 v[188:191], v[32:35], a[12:15], v[188:191]
    ds_read_b64_tr_b16 v[28:29], v12 offset:30976
    ds_read_b64_tr_b16 v[30:31], v12 offset:36096
    v_mfma_f32_16x16x32_bf16 v[204:207], v[40:43], a[12:15], v[204:207]
    v_cvt_pk_bf16_f32 v150, v164, v165
    v_cvt_pk_bf16_f32 v151, v166, v167
    v_mfma_f32_16x16x32_bf16 v[204:207], v[44:47], a[44:47], v[204:207]
    v_cvt_pk_bf16_f32 v152, v152, v153
    v_cvt_pk_bf16_f32 v153, v154, v155
    v_mfma_f32_16x16x32_bf16 v[200:203], v[44:47], a[40:43], v[200:203]
    v_cvt_pk_bf16_f32 v154, v168, v169
    v_cvt_pk_bf16_f32 v155, v170, v171
    v_mfma_f32_16x16x32_bf16 v[200:203], v[40:43], a[8:11], v[200:203]
    v_cvt_pk_bf16_f32 v156, v156, v157
    v_cvt_pk_bf16_f32 v157, v158, v159
    v_mfma_f32_16x16x32_bf16 v[196:199], v[40:43], a[4:7], v[196:199]
    s_add_u32 s11, s11, 4096
    ds_read_b64_tr_b16 v[32:33], v9 offset:192
    ds_read_b64_tr_b16 v[34:35], v9 offset:5312
    v_mfma_f32_16x16x32_bf16 v[196:199], v[44:47], a[36:39], v[196:199]
    buffer_load_dwordx4 a[176:179], v1, s[48:51], s11 offen sc1
    v_mfma_f32_16x16x32_bf16 v[192:195], v[44:47], a[32:35], v[192:195]
    s_nop 0
    v_cvt_pk_bf16_f32 v158, v172, v173
    v_cvt_pk_bf16_f32 v159, v174, v175
    v_mfma_f32_16x16x32_bf16 v[192:195], v[40:43], a[0:3], v[192:195]
    s_waitcnt lgkmcnt(2)
    ds_read_b64_tr_b16 v[36:37], v9 offset:10432
    ds_read_b64_tr_b16 v[38:39], v9 offset:15552
    v_mfma_f32_16x16x32_bf16 v[176:179], v[16:19], a[64:67], v[176:179]
    buffer_store_dwordx4 v[144:147], v1, s[48:51], s66 offen offset:2048 sc1
    v_mfma_f32_16x16x32_bf16 v[176:179], v[20:23], a[96:99], v[176:179]
    v_mfma_f32_16x16x32_bf16 v[180:183], v[20:23], a[100:103], v[180:183]
    v_mfma_f32_16x16x32_bf16 v[180:183], v[16:19], a[68:71], v[180:183]
    v_mfma_f32_16x16x32_bf16 v[184:187], v[16:19], a[72:75], v[184:187]
    ds_read_b64_tr_b16 v[40:41], v8 offset:256
    ds_read_b64_tr_b16 v[42:43], v8 offset:5376
    v_mfma_f32_16x16x32_bf16 v[184:187], v[20:23], a[104:107], v[184:187]
    v_mfma_f32_16x16x32_bf16 v[188:191], v[20:23], a[108:111], v[188:191]
    buffer_store_dwordx4 v[148:151], v1, s[48:51], s67 offen offset:2048 sc1
    v_mfma_f32_16x16x32_bf16 v[188:191], v[16:19], a[76:79], v[188:191]
    ds_read_b64_tr_b16 v[44:45], v8 offset:10496
    ds_read_b64_tr_b16 v[46:47], v8 offset:15616
    v_mfma_f32_16x16x32_bf16 v[204:207], v[24:27], a[76:79], v[204:207]
    v_mfma_f32_16x16x32_bf16 v[204:207], v[28:31], a[108:111], v[204:207]
    v_mfma_f32_16x16x32_bf16 v[200:203], v[28:31], a[104:107], v[200:203]
    buffer_load_dwordx4 a[180:183], v1, s[48:51], s11 offen offset:1024 sc1
    v_mfma_f32_16x16x32_bf16 v[200:203], v[24:27], a[72:75], v[200:203]
    v_mfma_f32_16x16x32_bf16 v[196:199], v[24:27], a[68:71], v[196:199]
    ds_read_b64_tr_b16 v[16:17], v12 offset:128
    ds_read_b64_tr_b16 v[18:19], v12 offset:5248
    v_mfma_f32_16x16x32_bf16 v[196:199], v[28:31], a[100:103], v[196:199]
    v_mfma_f32_16x16x32_bf16 v[192:195], v[28:31], a[96:99], v[192:195]
    buffer_store_dwordx4 v[152:155], v1, s[48:51], s68 offen offset:2048 sc1
    v_mfma_f32_16x16x32_bf16 v[192:195], v[24:27], a[64:67], v[192:195]
    s_waitcnt lgkmcnt(2)
    ds_read_b64_tr_b16 v[20:21], v12 offset:10368
    ds_read_b64_tr_b16 v[22:23], v12 offset:15488
    v_mfma_f32_16x16x32_bf16 v[176:179], v[32:35], a[128:131], v[176:179]
    s_nop 0
    v_mfma_f32_16x16x32_bf16 v[176:179], v[36:39], a[160:163], v[176:179]
    v_mfma_f32_16x16x32_bf16 v[180:183], v[36:39], a[164:167], v[180:183]
    v_mfma_f32_16x16x32_bf16 v[180:183], v[32:35], a[132:135], v[180:183]
    v_mfma_f32_16x16x32_bf16 v[184:187], v[32:35], a[136:139], v[184:187]
    ds_read_b64_tr_b16 v[24:25], v13 offset:256
    ds_read_b64_tr_b16 v[26:27], v13 offset:5376
    v_mfma_f32_16x16x32_bf16 v[184:187], v[36:39], a[168:171], v[184:187]
    v_mfma_f32_16x16x32_bf16 v[188:191], v[36:39], a[172:175], v[188:191]
    buffer_store_dwordx4 v[156:159], v1, s[48:51], s69 offen offset:2048 sc1
    v_mfma_f32_16x16x32_bf16 v[188:191], v[32:35], a[140:143], v[188:191]
    ds_read_b64_tr_b16 v[28:29], v13 offset:10496
    ds_read_b64_tr_b16 v[30:31], v13 offset:15616
    v_mfma_f32_16x16x32_bf16 v[204:207], v[40:43], a[140:143], v[204:207]
    buffer_load_dwordx4 a[184:187], v1, s[48:51], s11 offen offset:2048 sc1
    v_mfma_f32_16x16x32_bf16 v[204:207], v[44:47], a[172:175], v[204:207]
    v_mfma_f32_16x16x32_bf16 v[200:203], v[44:47], a[168:171], v[200:203]
    v_mfma_f32_16x16x32_bf16 v[200:203], v[40:43], a[136:139], v[200:203]
    v_mfma_f32_16x16x32_bf16 v[196:199], v[40:43], a[132:135], v[196:199]
    ds_read_b64_tr_b16 v[32:33], v12 offset:20608
    ds_read_b64_tr_b16 v[34:35], v12 offset:25728
    v_mfma_f32_16x16x32_bf16 v[196:199], v[44:47], a[164:167], v[196:199]
    v_mfma_f32_16x16x32_bf16 v[192:195], v[44:47], a[160:163], v[192:195]
    s_nop 0
    v_mfma_f32_16x16x32_bf16 v[192:195], v[40:43], a[128:131], v[192:195]
    s_waitcnt lgkmcnt(2)
    ds_read_b64_tr_b16 v[36:37], v12 offset:30848
    ds_read_b64_tr_b16 v[38:39], v12 offset:35968
    v_mfma_f32_16x16x32_bf16 v[128:131], v[16:19], a[0:3], v[128:131]
    v_mfma_f32_16x16x32_bf16 v[128:131], v[20:23], a[32:35], v[128:131]
    v_mfma_f32_16x16x32_bf16 v[132:135], v[20:23], a[36:39], v[132:135]
    v_mfma_f32_16x16x32_bf16 v[132:135], v[16:19], a[4:7], v[132:135]
    v_cvt_pk_bf16_f32 v176, v176, v177
    v_cvt_pk_bf16_f32 v177, v178, v179
    v_mfma_f32_16x16x32_bf16 v[136:139], v[16:19], a[8:11], v[136:139]
    ds_read_b64_tr_b16 v[40:41], v13 offset:20736
    ds_read_b64_tr_b16 v[42:43], v13 offset:25856
    v_mfma_f32_16x16x32_bf16 v[136:139], v[20:23], a[40:43], v[136:139]
    buffer_load_dwordx4 a[188:191], v1, s[48:51], s11 offen offset:3072 sc1
    v_mfma_f32_16x16x32_bf16 v[140:143], v[20:23], a[44:47], v[140:143]
    v_cvt_pk_bf16_f32 v178, v192, v193
    v_cvt_pk_bf16_f32 v179, v194, v195
    v_mfma_f32_16x16x32_bf16 v[140:143], v[16:19], a[12:15], v[140:143]
    ds_read_b64_tr_b16 v[44:45], v13 offset:30976
    ds_read_b64_tr_b16 v[46:47], v13 offset:36096
    v_mfma_f32_16x16x32_bf16 v[220:223], v[24:27], a[12:15], v[220:223]
    v_cvt_pk_bf16_f32 v180, v180, v181
    v_cvt_pk_bf16_f32 v181, v182, v183
    v_mfma_f32_16x16x32_bf16 v[220:223], v[28:31], a[44:47], v[220:223]
    v_cvt_pk_bf16_f32 v182, v196, v197
    v_cvt_pk_bf16_f32 v183, v198, v199
    v_mfma_f32_16x16x32_bf16 v[216:219], v[28:31], a[40:43], v[216:219]
    v_cvt_pk_bf16_f32 v184, v184, v185
    v_cvt_pk_bf16_f32 v185, v186, v187
    v_mfma_f32_16x16x32_bf16 v[216:219], v[24:27], a[8:11], v[216:219]
    v_cvt_pk_bf16_f32 v186, v200, v201
    v_cvt_pk_bf16_f32 v187, v202, v203
    v_mfma_f32_16x16x32_bf16 v[212:215], v[24:27], a[4:7], v[212:215]
    ds_read_b64_tr_b16 v[16:17], v8 offset:128
    ds_read_b64_tr_b16 v[18:19], v8 offset:5248
    v_mfma_f32_16x16x32_bf16 v[212:215], v[28:31], a[36:39], v[212:215]
    buffer_store_dwordx4 v[176:179], v1, s[48:51], s66 offen offset:3072 sc1
    v_mfma_f32_16x16x32_bf16 v[208:211], v[28:31], a[32:35], v[208:211]
    v_cvt_pk_bf16_f32 v188, v188, v189
    v_cvt_pk_bf16_f32 v189, v190, v191
    v_mfma_f32_16x16x32_bf16 v[208:211], v[24:27], a[0:3], v[208:211]
    s_waitcnt lgkmcnt(2)
    ds_read_b64_tr_b16 v[20:21], v8 offset:10368
    ds_read_b64_tr_b16 v[22:23], v8 offset:15488
    v_mfma_f32_16x16x32_bf16 v[128:131], v[32:35], a[64:67], v[128:131]
    s_nop 0
    v_mfma_f32_16x16x32_bf16 v[128:131], v[36:39], a[96:99], v[128:131]
    buffer_store_dwordx4 v[180:183], v1, s[48:51], s67 offen offset:3072 sc1
    v_mfma_f32_16x16x32_bf16 v[132:135], v[36:39], a[100:103], v[132:135]
    v_cvt_pk_bf16_f32 v190, v204, v205
    v_cvt_pk_bf16_f32 v191, v206, v207
    v_mfma_f32_16x16x32_bf16 v[132:135], v[32:35], a[68:71], v[132:135]
    v_mfma_f32_16x16x32_bf16 v[136:139], v[32:35], a[72:75], v[136:139]
    ds_read_b64_tr_b16 v[24:25], v9 offset:256
    ds_read_b64_tr_b16 v[26:27], v9 offset:5376
    v_mfma_f32_16x16x32_bf16 v[136:139], v[36:39], a[104:107], v[136:139]
    v_mfma_f32_16x16x32_bf16 v[140:143], v[36:39], a[108:111], v[140:143]
    buffer_store_dwordx4 v[184:187], v1, s[48:51], s68 offen offset:3072 sc1
    v_mfma_f32_16x16x32_bf16 v[140:143], v[32:35], a[76:79], v[140:143]
    ds_read_b64_tr_b16 v[28:29], v9 offset:10496
    ds_read_b64_tr_b16 v[30:31], v9 offset:15616
    v_mfma_f32_16x16x32_bf16 v[220:223], v[40:43], a[76:79], v[220:223]
    v_mfma_f32_16x16x32_bf16 v[220:223], v[44:47], a[108:111], v[220:223]
    v_mfma_f32_16x16x32_bf16 v[216:219], v[44:47], a[104:107], v[216:219]
    buffer_store_dwordx4 v[188:191], v1, s[48:51], s69 offen offset:3072 sc1
    v_mfma_f32_16x16x32_bf16 v[216:219], v[40:43], a[72:75], v[216:219]
    v_mfma_f32_16x16x32_bf16 v[212:215], v[40:43], a[68:71], v[212:215]
    s_waitcnt lgkmcnt(0)
    s_barrier
    v_mfma_f32_16x16x32_bf16 v[212:215], v[44:47], a[100:103], v[212:215]
    v_mfma_f32_16x16x32_bf16 v[208:211], v[44:47], a[96:99], v[208:211]
    s_add_u32 s8, s8, 4096
    s_add_u32 m0, s34, 0
    s_nop 0
    buffer_load_dwordx4 v3, s[48:51], s8 offen sc1 lds
    v_mfma_f32_16x16x32_bf16 v[208:211], v[40:43], a[64:67], v[208:211]
    s_nop 0
    v_mfma_f32_16x16x32_bf16 v[128:131], v[16:19], a[128:131], v[128:131]
    s_add_u32 s8, s8, 4096
    s_add_u32 m0, s34, 4096
    s_nop 0
    buffer_load_dwordx4 v3, s[48:51], s8 offen sc1 lds
    v_mfma_f32_16x16x32_bf16 v[128:131], v[20:23], a[160:163], v[128:131]
    v_mfma_f32_16x16x32_bf16 v[132:135], v[20:23], a[164:167], v[132:135]
    s_add_u32 s8, s8, 4096
    s_add_u32 m0, s34, 8192
    s_nop 0
    buffer_load_dwordx4 v3, s[48:51], s8 offen sc1 lds
    v_mfma_f32_16x16x32_bf16 v[132:135], v[16:19], a[132:135], v[132:135]
    v_mfma_f32_16x16x32_bf16 v[136:139], v[16:19], a[136:139], v[136:139]
    s_add_u32 s8, s8, 4096
    s_add_u32 m0, s34, 12288
    s_nop 0
    buffer_load_dwordx4 v3, s[48:51], s8 offen sc1 lds
    v_mfma_f32_16x16x32_bf16 v[136:139], v[20:23], a[168:171], v[136:139]
    v_mfma_f32_16x16x32_bf16 v[140:143], v[20:23], a[172:175], v[140:143]
    s_add_u32 s8, s8, 4096
    s_add_u32 m0, s34, 16384
    s_nop 0
    buffer_load_dwordx4 v3, s[48:51], s8 offen sc1 lds
    v_mfma_f32_16x16x32_bf16 v[140:143], v[16:19], a[140:143], v[140:143]
    v_mfma_f32_16x16x32_bf16 v[220:223], v[24:27], a[140:143], v[220:223]
    s_add_u32 s8, s8, 4096
    s_add_u32 m0, s34, 20480
    s_nop 0
    buffer_load_dwordx4 v3, s[48:51], s8 offen sc1 lds
    v_mfma_f32_16x16x32_bf16 v[220:223], v[28:31], a[172:175], v[220:223]
    s_nop 0
    v_mfma_f32_16x16x32_bf16 v[216:219], v[28:31], a[168:171], v[216:219]
    s_add_u32 s8, s8, 4096
    s_add_u32 m0, s34, 24576
    s_nop 0
    buffer_load_dwordx4 v3, s[48:51], s8 offen sc1 lds
    v_mfma_f32_16x16x32_bf16 v[216:219], v[24:27], a[136:139], v[216:219]
    v_mfma_f32_16x16x32_bf16 v[212:215], v[24:27], a[132:135], v[212:215]
    s_add_u32 s8, s8, 4096
    s_add_u32 m0, s34, 28672
    s_nop 0
    buffer_load_dwordx4 v3, s[48:51], s8 offen sc1 lds
    v_mfma_f32_16x16x32_bf16 v[212:215], v[28:31], a[164:167], v[212:215]
    s_nop 0
    v_mfma_f32_16x16x32_bf16 v[208:211], v[28:31], a[160:163], v[208:211]
    v_mfma_f32_16x16x32_bf16 v[208:211], v[24:27], a[128:131], v[208:211]
    v_add_u32 v8, 61440, v48
    v_add_u32 v9, 122880, v48
    ds_read_b64_tr_b16 a[32:33], v9 offset:0
    ds_read_b64_tr_b16 a[34:35], v9 offset:2560
    ds_read_b64_tr_b16 a[36:37], v9 offset:5120
    ds_read_b64_tr_b16 a[38:39], v9 offset:7680
    ds_read_b64_tr_b16 a[40:41], v9 offset:10240
    ds_read_b64_tr_b16 a[42:43], v9 offset:12800
    ds_read_b64_tr_b16 a[44:45], v9 offset:15360
    ds_read_b64_tr_b16 a[46:47], v9 offset:17920
    ds_read_b64_tr_b16 a[64:65], v9 offset:15392
    ds_read_b64_tr_b16 a[66:67], v9 offset:17952
    ds_read_b64_tr_b16 a[68:69], v9 offset:10272
    ds_read_b64_tr_b16 a[70:71], v9 offset:12832
    ds_read_b64_tr_b16 a[72:73], v9 offset:5152
    ds_read_b64_tr_b16 a[74:75], v9 offset:7712
    ds_read_b64_tr_b16 a[76:77], v9 offset:32
    ds_read_b64_tr_b16 a[78:79], v9 offset:2592
    ds_read_b64_tr_b16 a[96:97], v9 offset:64
    ds_read_b64_tr_b16 a[98:99], v9 offset:2624
    ds_read_b64_tr_b16 a[100:101], v9 offset:5184
    ds_read_b64_tr_b16 a[102:103], v9 offset:7744
    ds_read_b64_tr_b16 a[104:105], v9 offset:10304
    ds_read_b64_tr_b16 a[106:107], v9 offset:12864
    ds_read_b64_tr_b16 a[108:109], v9 offset:15424
    ds_read_b64_tr_b16 a[110:111], v9 offset:17984
    v_cvt_pk_bf16_f32 v128, v128, v129
    v_cvt_pk_bf16_f32 v129, v130, v131
    v_cvt_pk_bf16_f32 v130, v208, v209
    v_cvt_pk_bf16_f32 v131, v210, v211
    v_cvt_pk_bf16_f32 v132, v132, v133
    v_cvt_pk_bf16_f32 v133, v134, v135
    v_cvt_pk_bf16_f32 v134, v212, v213
    v_cvt_pk_bf16_f32 v135, v214, v215
    v_cvt_pk_bf16_f32 v136, v136, v137
    v_cvt_pk_bf16_f32 v137, v138, v139
    v_cvt_pk_bf16_f32 v138, v216, v217
    v_cvt_pk_bf16_f32 v139, v218, v219
    v_cvt_pk_bf16_f32 v140, v140, v141
    v_cvt_pk_bf16_f32 v141, v142, v143
    v_cvt_pk_bf16_f32 v142, v220, v221
    v_cvt_pk_bf16_f32 v143, v222, v223
    v_permlane16_swap_b32 v128, v130
    v_permlane16_swap_b32 v129, v131
    v_permlane16_swap_b32 v132, v134
    v_permlane16_swap_b32 v133, v135
    v_permlane16_swap_b32 v136, v138
    v_permlane16_swap_b32 v137, v139
    v_permlane16_swap_b32 v140, v142
    v_permlane16_swap_b32 v141, v143
    buffer_store_dwordx4 v[128:131], v2, s[48:51], s66 offen sc1
    buffer_store_dwordx4 v[132:135], v2, s[48:51], s67 offen sc1
    s_waitcnt lgkmcnt(15)
    s_nop 0
    v_mfma_f32_16x16x32_bf16 v[16:19], a[32:35], a[192:195], 0
    s_add_u32 s8, s8, 4096
    s_add_u32 m0, s34, 32768
    ds_read_b64_tr_b16 a[128:129], v9 offset:15456
    ds_read_b64_tr_b16 a[130:131], v9 offset:18016
    buffer_load_dwordx4 v3, s[48:51], s8 offen sc1 lds
    v_mfma_f32_16x16x32_bf16 v[16:19], a[36:39], a[196:199], v[16:19]
    ds_read_b64_tr_b16 a[132:133], v9 offset:10336
    ds_read_b64_tr_b16 a[134:135], v9 offset:12896
    buffer_store_dwordx4 v[136:139], v2, s[48:51], s68 offen sc1
    v_mfma_f32_16x16x32_bf16 v[16:19], a[40:43], a[200:203], v[16:19]
    s_add_u32 s11, s11, 4096
    ds_read_b64_tr_b16 a[136:137], v9 offset:5216
    ds_read_b64_tr_b16 a[138:139], v9 offset:7776
    buffer_load_dwordx4 a[16:19], v1, s[48:51], s11 offen sc1
    v_mfma_f32_16x16x32_bf16 v[16:19], a[44:47], a[204:207], v[16:19]
    s_nop 0
    s_waitcnt lgkmcnt(15)
    s_add_u32 s8, s8, 4096
    ds_read_b64_tr_b16 a[140:141], v9 offset:96
    ds_read_b64_tr_b16 a[142:143], v9 offset:2656
    v_mfma_f32_16x16x32_bf16 v[20:23], a[64:67], a[204:207], 0
    s_add_u32 m0, s34, 36864
    ds_read_b64_tr_b16 a[32:33], v9 offset:128
    ds_read_b64_tr_b16 a[34:35], v9 offset:2688
    buffer_load_dwordx4 v3, s[48:51], s8 offen sc1 lds
    v_mfma_f32_16x16x32_bf16 v[20:23], a[68:71], a[200:203], v[20:23]
    ds_read_b64_tr_b16 a[36:37], v9 offset:5248
    ds_read_b64_tr_b16 a[38:39], v9 offset:7808
    v_mfma_f32_16x16x32_bf16 v[20:23], a[72:75], a[196:199], v[20:23]
    ds_read_b64_tr_b16 a[40:41], v9 offset:10368
    ds_read_b64_tr_b16 a[42:43], v9 offset:12928
    s_waitcnt vmcnt(40)
    buffer_load_dwordx4 a[20:23], v1, s[48:51], s11 offen offset:1024 sc1
    s_waitcnt lgkmcnt(12)
    v_mfma_f32_16x16x32_bf16 v[20:23], a[76:79], a[192:195], v[20:23]
    ds_read_b64_tr_b16 a[44:45], v9 offset:15488
    ds_read_b64_tr_b16 a[46:47], v9 offset:18048
    v_mfma_f32_16x16x32_bf16 v[24:27], a[96:99], a[192:195], 0
    s_add_u32 s8, s8, 4096
    ds_read_b64_tr_b16 a[64:65], v9 offset:20480
    ds_read_b64_tr_b16 a[66:67], v9 offset:23040
    v_mfma_f32_16x16x32_bf16 v[24:27], a[100:103], a[196:199], v[24:27]
    s_add_u32 m0, s34, 81920
    ds_read_b64_tr_b16 a[68:69], v9 offset:25600
    ds_read_b64_tr_b16 a[70:71], v9 offset:28160
    buffer_load_dwordx4 v3, s[48:51], s8 offen sc1 lds
    v_mfma_f32_16x16x32_bf16 v[24:27], a[104:107], a[200:203], v[24:27]
    ds_read_b64_tr_b16 a[72:73], v9 offset:30720
    ds_read_b64_tr_b16 a[74:75], v9 offset:33280
    buffer_store_dwordx4 v[140:143], v2, s[48:51], s69 offen sc1
    v_mfma_f32_16x16x32_bf16 v[24:27], a[108:111], a[204:207], v[24:27]
    ds_read_b64_tr_b16 a[76:77], v9 offset:35840
    ds_read_b64_tr_b16 a[78:79], v9 offset:38400
    buffer_load_dwordx4 a[24:27], v1, s[48:51], s11 offen offset:2048 sc1
    v_mfma_f32_16x16x32_bf16 v[28:31], a[128:131], a[204:207], 0
    s_waitcnt lgkmcnt(10)
    s_add_u32 s8, s8, 4096
    s_nop 0
    ds_read_b64_tr_b16 a[96:97], v9 offset:35872
    ds_read_b64_tr_b16 a[98:99], v9 offset:38432
    v_mfma_f32_16x16x32_bf16 v[28:31], a[132:135], a[200:203], v[28:31]
    s_add_u32 m0, s34, 86016
    ds_read_b64_tr_b16 a[100:101], v9 offset:30752
    ds_read_b64_tr_b16 a[102:103], v9 offset:33312
    buffer_load_dwordx4 v3, s[48:51], s8 offen sc1 lds
    v_mfma_f32_16x16x32_bf16 v[28:31], a[136:139], a[196:199], v[28:31]
    ds_read_b64_tr_b16 a[104:105], v9 offset:25632
    ds_read_b64_tr_b16 a[106:107], v9 offset:28192
    v_mfma_f32_16x16x32_bf16 v[28:31], a[140:143], a[192:195], v[28:31]
    ds_read_b64_tr_b16 a[108:109], v9 offset:20512
    ds_read_b64_tr_b16 a[110:111], v9 offset:23072
    buffer_load_dwordx4 a[28:31], v1, s[48:51], s11 offen offset:3072 sc1
    v_mfma_f32_16x16x32_bf16 v[32:35], a[32:35], a[192:195], 0
    ds_read_b64_tr_b16 a[128:129], v9 offset:20544
    ds_read_b64_tr_b16 a[130:131], v9 offset:23104
    v_mfma_f32_16x16x32_bf16 v[32:35], a[36:39], a[196:199], v[32:35]
    s_add_u32 s8, s8, 4096
    ds_read_b64_tr_b16 a[132:133], v9 offset:25664
    ds_read_b64_tr_b16 a[134:135], v9 offset:28224
    v_mfma_f32_16x16x32_bf16 v[32:35], a[40:43], a[200:203], v[32:35]
    s_waitcnt lgkmcnt(10)
    s_add_u32 m0, s34, 90112
    s_nop 0
    ds_read_b64_tr_b16 a[136:137], v9 offset:30784
    ds_read_b64_tr_b16 a[138:139], v9 offset:33344
    buffer_load_dwordx4 v3, s[48:51], s8 offen sc1 lds
    v_mfma_f32_16x16x32_bf16 v[32:35], a[44:47], a[204:207], v[32:35]
    ds_read_b64_tr_b16 a[140:141], v9 offset:35904
    ds_read_b64_tr_b16 a[142:143], v9 offset:38464
    v_mfma_f32_16x16x32_bf16 v[16:19], a[64:67], a[208:211], v[16:19]
    s_add_u32 s11, s11, 4096
    ds_read_b64_tr_b16 a[32:33], v9 offset:35936
    ds_read_b64_tr_b16 a[34:35], v9 offset:38496
    buffer_load_dwordx4 a[48:51], v1, s[48:51], s11 offen sc1
    v_mfma_f32_16x16x32_bf16 v[16:19], a[68:71], a[212:215], v[16:19]
    s_add_u32 s8, s8, 4096
    ds_read_b64_tr_b16 a[36:37], v9 offset:30816
    ds_read_b64_tr_b16 a[38:39], v9 offset:33376
    v_mfma_f32_16x16x32_bf16 v[16:19], a[72:75], a[216:219], v[16:19]
    s_add_u32 m0, s34, 94208
    ds_read_b64_tr_b16 a[40:41], v9 offset:25696
    ds_read_b64_tr_b16 a[42:43], v9 offset:28256
    buffer_load_dwordx4 v3, s[48:51], s8 offen sc1 lds
    v_mfma_f32_16x16x32_bf16 v[16:19], a[76:79], a[220:223], v[16:19]
    s_nop 0
    ds_read_b64_tr_b16 a[44:45], v9 offset:20576
    ds_read_b64_tr_b16 a[46:47], v9 offset:23136
    v_mfma_f32_16x16x32_bf16 v[20:23], a[96:99], a[220:223], v[20:23]
    s_waitcnt lgkmcnt(10)
    ds_read_b64_tr_b16 a[64:65], v9 offset:20608
    ds_read_b64_tr_b16 a[66:67], v9 offset:23168
    buffer_load_dwordx4 a[52:55], v1, s[48:51], s11 offen offset:1024 sc1
    v_mfma_f32_16x16x32_bf16 v[20:23], a[100:103], a[216:219], v[20:23]
    ds_read_b64_tr_b16 a[68:69], v9 offset:25728
    ds_read_b64_tr_b16 a[70:71], v9 offset:28288
    v_mfma_f32_16x16x32_bf16 v[20:23], a[104:107], a[212:215], v[20:23]
    ds_read_b64_tr_b16 a[72:73], v9 offset:30848
    ds_read_b64_tr_b16 a[74:75], v9 offset:33408
    v_mfma_f32_16x16x32_bf16 v[20:23], a[108:111], a[208:211], v[20:23]
    s_waitcnt vmcnt(47)
    s_barrier
    v_mfma_f32_16x16x32_bf16 v[24:27], a[128:131], a[208:211], v[24:27]
    s_add_u32 s8, s8, 4096
    s_add_u32 m0, s34, 98304
    ds_read_b64_tr_b16 a[76:77], v9 offset:35968
    ds_read_b64_tr_b16 a[78:79], v9 offset:38528
    buffer_load_dwordx4 v3, s[48:51], s8 offen sc1 lds
    v_mfma_f32_16x16x32_bf16 v[24:27], a[132:135], a[212:215], v[24:27]
    ds_read_b64_tr_b16 a[96:97], v48 offset:40960
    ds_read_b64_tr_b16 a[98:99], v48 offset:43520
    buffer_load_dwordx4 a[56:59], v1, s[48:51], s11 offen offset:2048 sc1
    v_mfma_f32_16x16x32_bf16 v[24:27], a[136:139], a[216:219], v[24:27]
    s_waitcnt lgkmcnt(8)
    s_nop 0
    s_add_u32 s8, s8, 4096
    ds_read_b64_tr_b16 a[100:101], v48 offset:46080
    ds_read_b64_tr_b16 a[102:103], v48 offset:48640
    v_mfma_f32_16x16x32_bf16 v[24:27], a[140:143], a[220:223], v[24:27]
    s_add_u32 m0, s34, 102400
    ds_read_b64_tr_b16 a[104:105], v48 offset:51200
    ds_read_b64_tr_b16 a[106:107], v48 offset:53760
    buffer_load_dwordx4 v3, s[48:51], s8 offen sc1 lds
    v_mfma_f32_16x16x32_bf16 v[28:31], a[32:35], a[220:223], v[28:31]
    ds_read_b64_tr_b16 a[108:109], v48 offset:56320
    ds_read_b64_tr_b16 a[110:111], v48 offset:58880
    v_mfma_f32_16x16x32_bf16 v[28:31], a[36:39], a[216:219], v[28:31]
    ds_read_b64_tr_b16 a[128:129], v48 offset:56352
    ds_read_b64_tr_b16 a[130:131], v48 offset:58912
    buffer_load_dwordx4 a[60:63], v1, s[48:51], s11 offen offset:3072 sc1
    v_mfma_f32_16x16x32_bf16 v[28:31], a[40:43], a[212:215], v[28:31]
    ds_read_b64_tr_b16 a[132:133], v48 offset:51232
    ds_read_b64_tr_b16 a[134:135], v48 offset:53792
    v_mfma_f32_16x16x32_bf16 v[28:31], a[44:47], a[208:211], v[28:31]
    s_add_u32 s8, s8, 4096
    ds_read_b64_tr_b16 a[136:137], v48 offset:46112
    ds_read_b64_tr_b16 a[138:139], v48 offset:48672
    v_mfma_f32_16x16x32_bf16 v[32:35], a[64:67], a[208:211], v[32:35]
    s_waitcnt lgkmcnt(10)
    s_nop 0
    s_add_u32 m0, s34, 106496
    ds_read_b64_tr_b16 a[140:141], v48 offset:40992
    ds_read_b64_tr_b16 a[142:143], v48 offset:43552
    buffer_load_dwordx4 v3, s[48:51], s8 offen sc1 lds
    v_mfma_f32_16x16x32_bf16 v[32:35], a[68:71], a[212:215], v[32:35]
    ds_read_b64_tr_b16 a[32:33], v48 offset:41024
    ds_read_b64_tr_b16 a[34:35], v48 offset:43584
    v_mfma_f32_16x16x32_bf16 v[32:35], a[72:75], a[216:219], v[32:35]
    s_add_u32 s11, s11, 4096
    ds_read_b64_tr_b16 a[36:37], v48 offset:46144
    ds_read_b64_tr_b16 a[38:39], v48 offset:48704
    buffer_load_dwordx4 a[0:3], v1, s[48:51], s11 offen sc1
    v_mfma_f32_16x16x32_bf16 v[32:35], a[76:79], a[220:223], v[32:35]
    s_add_u32 s8, s8, 4096
    ds_read_b64_tr_b16 a[40:41], v48 offset:51264
    ds_read_b64_tr_b16 a[42:43], v48 offset:53824
    v_mfma_f32_16x16x32_bf16 v[16:19], a[96:99], a[224:227], v[16:19]
    s_add_u32 m0, s34, 110592
    ds_read_b64_tr_b16 a[44:45], v48 offset:56384
    ds_read_b64_tr_b16 a[46:47], v48 offset:58944
    buffer_load_dwordx4 v3, s[48:51], s8 offen sc1 lds
    v_mfma_f32_16x16x32_bf16 v[16:19], a[100:103], a[228:231], v[16:19]
    s_waitcnt lgkmcnt(10)
    ds_read_b64_tr_b16 a[64:65], v48 offset:56416
    s_nop 0
    ds_read_b64_tr_b16 a[66:67], v48 offset:58976
    v_mfma_f32_16x16x32_bf16 v[16:19], a[104:107], a[232:235], v[16:19]
    ds_read_b64_tr_b16 a[68:69], v48 offset:51296
    ds_read_b64_tr_b16 a[70:71], v48 offset:53856
    buffer_load_dwordx4 a[4:7], v1, s[48:51], s11 offen offset:1024 sc1
    v_mfma_f32_16x16x32_bf16 v[16:19], a[108:111], a[236:239], v[16:19]
    ds_read_b64_tr_b16 a[72:73], v48 offset:46176
    ds_read_b64_tr_b16 a[74:75], v48 offset:48736
    v_mfma_f32_16x16x32_bf16 v[20:23], a[128:131], a[236:239], v[20:23]
    s_add_u32 s8, s8, 4096
    ds_read_b64_tr_b16 a[76:77], v48 offset:41056
    ds_read_b64_tr_b16 a[78:79], v48 offset:43616
    v_mfma_f32_16x16x32_bf16 v[20:23], a[132:135], a[232:235], v[20:23]
    s_add_u32 m0, s34, 114688
    ds_read_b64_tr_b16 a[96:97], v48 offset:41088
    ds_read_b64_tr_b16 a[98:99], v48 offset:43648
    buffer_load_dwordx4 v3, s[48:51], s8 offen sc1 lds
    v_mfma_f32_16x16x32_bf16 v[20:23], a[136:139], a[228:231], v[20:23]
    s_waitcnt lgkmcnt(10)
    ds_read_b64_tr_b16 a[100:101], v48 offset:46208
    s_nop 0
    ds_read_b64_tr_b16 a[102:103], v48 offset:48768
    v_mfma_f32_16x16x32_bf16 v[20:23], a[140:143], a[224:227], v[20:23]
    ds_read_b64_tr_b16 a[104:105], v48 offset:51328
    ds_read_b64_tr_b16 a[106:107], v48 offset:53888
    buffer_load_dwordx4 a[8:11], v1, s[48:51], s11 offen offset:2048 sc1
    v_mfma_f32_16x16x32_bf16 v[24:27], a[32:35], a[224:227], v[24:27]
    s_add_u32 s8, s8, 4096
    ds_read_b64_tr_b16 a[108:109], v48 offset:56448
    ds_read_b64_tr_b16 a[110:111], v48 offset:59008
    v_mfma_f32_16x16x32_bf16 v[24:27], a[36:39], a[228:231], v[24:27]
    s_add_u32 m0, s34, 118784
    ds_read_b64_tr_b16 a[128:129], v8 offset:0
    ds_read_b64_tr_b16 a[130:131], v8 offset:2560
    buffer_load_dwordx4 v3, s[48:51], s8 offen sc1 lds
    v_mfma_f32_16x16x32_bf16 v[24:27], a[40:43], a[232:235], v[24:27]
    ds_read_b64_tr_b16 a[132:133], v8 offset:5120
    ds_read_b64_tr_b16 a[134:135], v8 offset:7680
    v_mfma_f32_16x16x32_bf16 v[24:27], a[44:47], a[236:239], v[24:27]
    s_nop 0
    ds_read_b64_tr_b16 a[136:137], v8 offset:10240
    ds_read_b64_tr_b16 a[138:139], v8 offset:12800
    s_waitcnt vmcnt(40)
    buffer_load_dwordx4 a[12:15], v1, s[48:51], s11 offen offset:3072 sc1
    s_waitcnt lgkmcnt(12)
    v_mfma_f32_16x16x32_bf16 v[28:31], a[64:67], a[236:239], v[28:31]
    s_nop 0
    ds_read_b64_tr_b16 a[140:141], v8 offset:15360
    ds_read_b64_tr_b16 a[142:143], v8 offset:17920
    v_mfma_f32_16x16x32_bf16 v[28:31], a[68:71], a[232:235], v[28:31]
    ds_read_b64_tr_b16 a[32:33], v8 offset:15392
    ds_read_b64_tr_b16 a[34:35], v8 offset:17952
    v_mfma_f32_16x16x32_bf16 v[28:31], a[72:75], a[228:231], v[28:31]
    ds_read_b64_tr_b16 a[36:37], v8 offset:10272
    ds_read_b64_tr_b16 a[38:39], v8 offset:12832
    v_mfma_f32_16x16x32_bf16 v[28:31], a[76:79], a[224:227], v[28:31]
    s_nop 0
    ds_read_b64_tr_b16 a[40:41], v8 offset:5152
    ds_read_b64_tr_b16 a[42:43], v8 offset:7712
    v_mfma_f32_16x16x32_bf16 v[32:35], a[96:99], a[224:227], v[32:35]
    s_waitcnt lgkmcnt(10)
    ds_read_b64_tr_b16 a[44:45], v8 offset:32
    ds_read_b64_tr_b16 a[46:47], v8 offset:2592
    v_mfma_f32_16x16x32_bf16 v[32:35], a[100:103], a[228:231], v[32:35]
    ds_read_b64_tr_b16 a[64:65], v8 offset:64
    ds_read_b64_tr_b16 a[66:67], v8 offset:2624
    v_mfma_f32_16x16x32_bf16 v[32:35], a[104:107], a[232:235], v[32:35]
    ds_read_b64_tr_b16 a[68:69], v8 offset:5184
    ds_read_b64_tr_b16 a[70:71], v8 offset:7744
    v_mfma_f32_16x16x32_bf16 v[32:35], a[108:111], a[236:239], v[32:35]
    ds_read_b64_tr_b16 a[72:73], v8 offset:10304
    ds_read_b64_tr_b16 a[74:75], v8 offset:12864
    v_mfma_f32_16x16x32_bf16 v[16:19], a[128:131], a[240:243], v[16:19]
    s_nop 0
    ds_read_b64_tr_b16 a[76:77], v8 offset:15424
    ds_read_b64_tr_b16 a[78:79], v8 offset:17984
    v_mfma_f32_16x16x32_bf16 v[16:19], a[132:135], a[244:247], v[16:19]
    s_waitcnt lgkmcnt(10)
    ds_read_b64_tr_b16 a[96:97], v8 offset:15456
    ds_read_b64_tr_b16 a[98:99], v8 offset:18016
    v_mfma_f32_16x16x32_bf16 v[16:19], a[136:139], a[248:251], v[16:19]
    ds_read_b64_tr_b16 a[100:101], v8 offset:10336
    ds_read_b64_tr_b16 a[102:103], v8 offset:12896
    v_mfma_f32_16x16x32_bf16 v[16:19], a[140:143], a[252:255], v[16:19]
    ds_read_b64_tr_b16 a[104:105], v8 offset:5216
    ds_read_b64_tr_b16 a[106:107], v8 offset:7776
    v_mfma_f32_16x16x32_bf16 v[20:23], a[32:35], a[252:255], v[20:23]
    ds_read_b64_tr_b16 a[108:109], v8 offset:96
    ds_read_b64_tr_b16 a[110:111], v8 offset:2656
    v_mfma_f32_16x16x32_bf16 v[20:23], a[36:39], a[248:251], v[20:23]
    ds_read_b64_tr_b16 a[128:129], v8 offset:128
    ds_read_b64_tr_b16 a[130:131], v8 offset:2688
    v_mfma_f32_16x16x32_bf16 v[20:23], a[40:43], a[244:247], v[20:23]
    s_waitcnt lgkmcnt(10)
    ds_read_b64_tr_b16 a[132:133], v8 offset:5248
    ds_read_b64_tr_b16 a[134:135], v8 offset:7808
    v_mfma_f32_16x16x32_bf16 v[20:23], a[44:47], a[240:243], v[20:23]
    s_waitcnt vmcnt(19)
    s_barrier
    s_cmp_lg_u32 s30, 0
    s_cbranch_scc1 L_sig20
    s_mov_b32 s3, s10
    s_mov_b64 exec, 1
    v_mov_b32 v6, 0
    v_mov_b32 v7, 1
    buffer_atomic_add v7, v6, s[48:51], s3 offen
    s_mov_b64 exec, -1
L_sig20:
    v_mfma_f32_16x16x32_bf16 v[24:27], a[64:67], a[240:243], v[24:27]
    s_add_u32 s8, s8, 4096
    s_add_u32 m0, s34, 122880
    ds_read_b64_tr_b16 a[136:137], v8 offset:10368
    ds_read_b64_tr_b16 a[138:139], v8 offset:12928
    buffer_load_dwordx4 v3, s[48:51], s8 offen sc1 lds
    v_mfma_f32_16x16x32_bf16 v[24:27], a[68:71], a[244:247], v[24:27]
    ds_read_b64_tr_b16 a[140:141], v8 offset:15488
    ds_read_b64_tr_b16 a[142:143], v8 offset:18048
    v_mfma_f32_16x16x32_bf16 v[24:27], a[72:75], a[248:251], v[24:27]
    s_add_u32 s8, s8, 4096
    ds_read_b64_tr_b16 a[32:33], v48 offset:0
    ds_read_b64_tr_b16 a[34:35], v48 offset:2560
    v_mfma_f32_16x16x32_bf16 v[24:27], a[76:79], a[252:255], v[24:27]
    s_waitcnt lgkmcnt(8)
    s_nop 0
    s_add_u32 m0, s34, 126976
    ds_read_b64_tr_b16 a[36:37], v48 offset:5120
    ds_read_b64_tr_b16 a[38:39], v48 offset:7680
    buffer_load_dwordx4 v3, s[48:51], s8 offen sc1 lds
    v_mfma_f32_16x16x32_bf16 v[28:31], a[96:99], a[252:255], v[28:31]
    ds_read_b64_tr_b16 a[40:41], v48 offset:10240
    ds_read_b64_tr_b16 a[42:43], v48 offset:12800
    v_mfma_f32_16x16x32_bf16 v[28:31], a[100:103], a[248:251], v[28:31]
    ds_read_b64_tr_b16 a[44:45], v48 offset:15360
    ds_read_b64_tr_b16 a[46:47], v48 offset:17920
    v_mfma_f32_16x16x32_bf16 v[28:31], a[104:107], a[244:247], v[28:31]
    s_add_u32 s8, s8, 4096
    ds_read_b64_tr_b16 a[64:65], v48 offset:15392
    ds_read_b64_tr_b16 a[66:67], v48 offset:17952
    v_mfma_f32_16x16x32_bf16 v[28:31], a[108:111], a[240:243], v[28:31]
    s_add_u32 m0, s34, 131072
    ds_read_b64_tr_b16 a[68:69], v48 offset:10272
    ds_read_b64_tr_b16 a[70:71], v48 offset:12832
    buffer_load_dwordx4 v3, s[48:51], s8 offen sc1 lds
    v_mfma_f32_16x16x32_bf16 v[32:35], a[128:131], a[240:243], v[32:35]
    s_nop 0
    s_waitcnt lgkmcnt(10)
    ds_read_b64_tr_b16 a[72:73], v48 offset:5152
    ds_read_b64_tr_b16 a[74:75], v48 offset:7712
    v_mfma_f32_16x16x32_bf16 v[32:35], a[132:135], a[244:247], v[32:35]
    s_add_u32 s8, s8, 4096
    ds_read_b64_tr_b16 a[76:77], v48 offset:32
    ds_read_b64_tr_b16 a[78:79], v48 offset:2592
    v_mfma_f32_16x16x32_bf16 v[32:35], a[136:139], a[248:251], v[32:35]
    s_add_u32 m0, s34, 135168
    ds_read_b64_tr_b16 a[96:97], v48 offset:64
    ds_read_b64_tr_b16 a[98:99], v48 offset:2624
    buffer_load_dwordx4 v3, s[48:51], s8 offen sc1 lds
    v_mfma_f32_16x16x32_bf16 v[32:35], a[140:143], a[252:255], v[32:35]
    s_nop 0
    ds_read_b64_tr_b16 a[100:101], v48 offset:5184
    ds_read_b64_tr_b16 a[102:103], v48 offset:7744
    v_mfma_f32_16x16x32_bf16 v[16:19], a[32:35], v[224:227], v[16:19]
    s_waitcnt lgkmcnt(10)
    ds_read_b64_tr_b16 a[104:105], v48 offset:10304
    ds_read_b64_tr_b16 a[106:107], v48 offset:12864
    v_mfma_f32_16x16x32_bf16 v[16:19], a[36:39], v[228:231], v[16:19]
    s_add_u32 s8, s8, 4096
    ds_read_b64_tr_b16 a[108:109], v48 offset:15424
    ds_read_b64_tr_b16 a[110:111], v48 offset:17984
    v_mfma_f32_16x16x32_bf16 v[16:19], a[40:43], v[232:235], v[16:19]
    s_add_u32 m0, s34, 139264
    ds_read_b64_tr_b16 a[128:129], v48 offset:15456
    ds_read_b64_tr_b16 a[130:131], v48 offset:18016
    buffer_load_dwordx4 v3, s[48:51], s8 offen sc1 lds
    v_mfma_f32_16x16x32_bf16 v[16:19], a[44:47], v[236:239], v[16:19]
    s_nop 0
    ds_read_b64_tr_b16 a[132:133], v48 offset:10336
    ds_read_b64_tr_b16 a[134:135], v48 offset:12896
    v_mfma_f32_16x16x32_bf16 v[20:23], a[64:67], v[236:239], v[20:23]
    s_waitcnt lgkmcnt(10)
    ds_read_b64_tr_b16 a[136:137], v48 offset:5216
    ds_read_b64_tr_b16 a[138:139], v48 offset:7776
    v_mfma_f32_16x16x32_bf16 v[20:23], a[68:71], v[232:235], v[20:23]
    s_add_u32 s8, s8, 4096
    ds_read_b64_tr_b16 a[140:141], v48 offset:96
    ds_read_b64_tr_b16 a[142:143], v48 offset:2656
    v_mfma_f32_16x16x32_bf16 v[20:23], a[72:75], v[228:231], v[20:23]
    s_add_u32 m0, s34, 143360
    ds_read_b64_tr_b16 a[32:33], v48 offset:128
    ds_read_b64_tr_b16 a[34:35], v48 offset:2688
    buffer_load_dwordx4 v3, s[48:51], s8 offen sc1 lds
    v_mfma_f32_16x16x32_bf16 v[20:23], a[76:79], v[224:227], v[20:23]
    s_nop 0
    ds_read_b64_tr_b16 a[36:37], v48 offset:5248
    ds_read_b64_tr_b16 a[38:39], v48 offset:7808
    v_mfma_f32_16x16x32_bf16 v[24:27], a[96:99], v[224:227], v[24:27]
    s_waitcnt lgkmcnt(10)
    s_add_u32 s8, s8, 4096
    ds_read_b64_tr_b16 a[40:41], v48 offset:10368
    ds_read_b64_tr_b16 a[42:43], v48 offset:12928
    v_mfma_f32_16x16x32_bf16 v[24:27], a[100:103], v[228:231], v[24:27]
    s_add_u32 m0, s34, 147456
    ds_read_b64_tr_b16 a[44:45], v48 offset:15488
    ds_read_b64_tr_b16 a[46:47], v48 offset:18048
    buffer_load_dwordx4 v3, s[48:51], s8 offen sc1 lds
    v_mfma_f32_16x16x32_bf16 v[24:27], a[104:107], v[232:235], v[24:27]
    ds_read_b64_tr_b16 a[64:65], v48 offset:20480
    ds_read_b64_tr_b16 a[66:67], v48 offset:23040
    v_mfma_f32_16x16x32_bf16 v[24:27], a[108:111], v[236:239], v[24:27]
    s_nop 0
    ds_read_b64_tr_b16 a[68:69], v48 offset:25600
    ds_read_b64_tr_b16 a[70:71], v48 offset:28160
    v_mfma_f32_16x16x32_bf16 v[28:31], a[128:131], v[236:239], v[28:31]
    s_waitcnt lgkmcnt(10)
    s_add_u32 s8, s8, 4096
    ds_read_b64_tr_b16 a[72:73], v48 offset:30720
    ds_read_b64_tr_b16 a[74:75], v48 offset:33280
    v_mfma_f32_16x16x32_bf16 v[28:31], a[132:135], v[232:235], v[28:31]
    s_add_u32 m0, s34, 151552
    ds_read_b64_tr_b16 a[76:77], v48 offset:35840
    ds_read_b64_tr_b16 a[78:79], v48 offset:38400
    buffer_load_dwordx4 v3, s[48:51], s8 offen sc1 lds
    v_mfma_f32_16x16x32_bf16 v[28:31], a[136:139], v[228:231], v[28:31]
    ds_read_b64_tr_b16 a[96:97], v48 offset:35872
    ds_read_b64_tr_b16 a[98:99], v48 offset:38432
    v_mfma_f32_16x16x32_bf16 v[28:31], a[140:143], v[224:227], v[28:31]
    s_add_u32 s8, s8, 4096
    ds_read_b64_tr_b16 a[100:101], v48 offset:30752
    ds_read_b64_tr_b16 a[102:103], v48 offset:33312
    v_mfma_f32_16x16x32_bf16 v[32:35], a[32:35], v[224:227], v[32:35]
    s_waitcnt lgkmcnt(10)
    s_add_u32 m0, s34, 155648
    ds_read_b64_tr_b16 a[104:105], v48 offset:25632
    s_nop 0
    ds_read_b64_tr_b16 a[106:107], v48 offset:28192
    buffer_load_dwordx4 v3, s[48:51], s8 offen sc1 lds
    v_mfma_f32_16x16x32_bf16 v[32:35], a[36:39], v[228:231], v[32:35]
    ds_read_b64_tr_b16 a[108:109], v48 offset:20512
    ds_read_b64_tr_b16 a[110:111], v48 offset:23072
    v_mfma_f32_16x16x32_bf16 v[32:35], a[40:43], v[232:235], v[32:35]
    ds_read_b64_tr_b16 a[128:129], v48 offset:20544
    ds_read_b64_tr_b16 a[130:131], v48 offset:23104
    v_mfma_f32_16x16x32_bf16 v[32:35], a[44:47], v[236:239], v[32:35]
    s_add_u32 s8, s8, 4096
    ds_read_b64_tr_b16 a[132:133], v48 offset:25664
    ds_read_b64_tr_b16 a[134:135], v48 offset:28224
    v_mfma_f32_16x16x32_bf16 v[16:19], a[64:67], a[80:83], v[16:19]
    s_waitcnt lgkmcnt(10)
    s_add_u32 m0, s34, 159744
    ds_read_b64_tr_b16 a[136:137], v48 offset:30784
    s_nop 0
    ds_read_b64_tr_b16 a[138:139], v48 offset:33344
    buffer_load_dwordx4 v3, s[48:51], s8 offen sc1 lds
    v_mfma_f32_16x16x32_bf16 v[16:19], a[68:71], a[84:87], v[16:19]
    ds_read_b64_tr_b16 a[140:141], v48 offset:35904
    ds_read_b64_tr_b16 a[142:143], v48 offset:38464
    v_mfma_f32_16x16x32_bf16 v[16:19], a[72:75], a[88:91], v[16:19]
    ds_read_b64_tr_b16 a[32:33], v48 offset:35936
    ds_read_b64_tr_b16 a[34:35], v48 offset:38496
    v_mfma_f32_16x16x32_bf16 v[16:19], a[76:79], a[92:95], v[16:19]
    s_nop 0
    ds_read_b64_tr_b16 a[36:37], v48 offset:30816
    ds_read_b64_tr_b16 a[38:39], v48 offset:33376
    v_mfma_f32_16x16x32_bf16 v[20:23], a[96:99], a[92:95], v[20:23]
    s_waitcnt lgkmcnt(10)
    ds_read_b64_tr_b16 a[40:41], v48 offset:25696
    ds_read_b64_tr_b16 a[42:43], v48 offset:28256
    v_mfma_f32_16x16x32_bf16 v[20:23], a[100:103], a[88:91], v[20:23]
    ds_read_b64_tr_b16 a[44:45], v48 offset:20576
    ds_read_b64_tr_b16 a[46:47], v48 offset:23136
    v_mfma_f32_16x16x32_bf16 v[20:23], a[104:107], a[84:87], v[20:23]
    ds_read_b64_tr_b16 a[64:65], v48 offset:20608
    ds_read_b64_tr_b16 a[66:67], v48 offset:23168
    v_mfma_f32_16x16x32_bf16 v[20:23], a[108:111], a[80:83], v[20:23]
    s_waitcnt vmcnt(11)
    s_barrier
    v_mfma_f32_16x16x32_bf16 v[24:27], a[128:131], a[80:83], v[24:27]
    s_nop 0
    s_waitcnt lgkmcnt(8)
    s_add_u32 s8, s8, 4096
    s_add_u32 m0, s34, 40960
    ds_read_b64_tr_b16 a[68:69], v48 offset:25728
    ds_read_b64_tr_b16 a[70:71], v48 offset:28288
    buffer_load_dwordx4 v3, s[48:51], s8 offen sc1 lds
    v_mfma_f32_16x16x32_bf16 v[24:27], a[132:135], a[84:87], v[24:27]
    ds_read_b64_tr_b16 a[72:73], v48 offset:30848
    ds_read_b64_tr_b16 a[74:75], v48 offset:33408
    v_mfma_f32_16x16x32_bf16 v[24:27], a[136:139], a[88:91], v[24:27]
    s_add_u32 s8, s8, 4096
    ds_read_b64_tr_b16 a[76:77], v48 offset:35968
    ds_read_b64_tr_b16 a[78:79], v48 offset:38528
    v_mfma_f32_16x16x32_bf16 v[24:27], a[140:143], a[92:95], v[24:27]
    s_add_u32 m0, s34, 45056
    ds_read_b64_tr_b16 a[96:97], v8 offset:20480
    ds_read_b64_tr_b16 a[98:99], v8 offset:23040
    buffer_load_dwordx4 v3, s[48:51], s8 offen sc1 lds
    v_mfma_f32_16x16x32_bf16 v[28:31], a[32:35], a[92:95], v[28:31]
    s_waitcnt lgkmcnt(8)
    s_nop 0
    ds_read_b64_tr_b16 a[100:101], v8 offset:25600
    ds_read_b64_tr_b16 a[102:103], v8 offset:28160
    v_mfma_f32_16x16x32_bf16 v[28:31], a[36:39], a[88:91], v[28:31]
    s_add_u32 s8, s8, 4096
    ds_read_b64_tr_b16 a[104:105], v8 offset:30720
    ds_read_b64_tr_b16 a[106:107], v8 offset:33280
    v_mfma_f32_16x16x32_bf16 v[28:31], a[40:43], a[84:87], v[28:31]
    s_add_u32 m0, s34, 49152
    ds_read_b64_tr_b16 a[108:109], v8 offset:35840
    ds_read_b64_tr_b16 a[110:111], v8 offset:38400
    buffer_load_dwordx4 v3, s[48:51], s8 offen sc1 lds
    v_mfma_f32_16x16x32_bf16 v[28:31], a[44:47], a[80:83], v[28:31]
    ds_read_b64_tr_b16 a[128:129], v8 offset:35872
    ds_read_b64_tr_b16 a[130:131], v8 offset:38432
    v_mfma_f32_16x16x32_bf16 v[32:35], a[64:67], a[80:83], v[32:35]
    s_waitcnt lgkmcnt(10)
    s_nop 0
    s_add_u32 s8, s8, 4096
    ds_read_b64_tr_b16 a[132:133], v8 offset:30752
    ds_read_b64_tr_b16 a[134:135], v8 offset:33312
    v_mfma_f32_16x16x32_bf16 v[32:35], a[68:71], a[84:87], v[32:35]
    s_add_u32 m0, s34, 53248
    ds_read_b64_tr_b16 a[136:137], v8 offset:25632
    ds_read_b64_tr_b16 a[138:139], v8 offset:28192
    buffer_load_dwordx4 v3, s[48:51], s8 offen sc1 lds
    v_mfma_f32_16x16x32_bf16 v[32:35], a[72:75], a[88:91], v[32:35]
    s_nop 0
    ds_read_b64_tr_b16 a[140:141], v8 offset:20512
    ds_read_b64_tr_b16 a[142:143], v8 offset:23072
    v_mfma_f32_16x16x32_bf16 v[32:35], a[76:79], a[92:95], v[32:35]
    s_waitcnt lgkmcnt(10)
    s_add_u32 s8, s8, 4096
    ds_read_b64_tr_b16 a[32:33], v8 offset:20544
    ds_read_b64_tr_b16 a[34:35], v8 offset:23104
    v_mfma_f32_16x16x32_bf16 v[16:19], a[96:99], a[112:115], v[16:19]
    s_add_u32 m0, s34, 57344
    ds_read_b64_tr_b16 a[36:37], v8 offset:25664
    ds_read_b64_tr_b16 a[38:39], v8 offset:28224
    buffer_load_dwordx4 v3, s[48:51], s8 offen sc1 lds
    v_mfma_f32_16x16x32_bf16 v[16:19], a[100:103], a[116:119], v[16:19]
    ds_read_b64_tr_b16 a[40:41], v8 offset:30784
    ds_read_b64_tr_b16 a[42:43], v8 offset:33344
    v_mfma_f32_16x16x32_bf16 v[16:19], a[104:107], a[120:123], v[16:19]
    s_waitcnt lgkmcnt(10)
    ds_read_b64_tr_b16 a[44:45], v8 offset:35904
    ds_read_b64_tr_b16 a[46:47], v8 offset:38464
    s_nop 0
    v_mfma_f32_16x16x32_bf16 v[16:19], a[108:111], a[124:127], v[16:19]
    s_add_u32 s8, s8, 4096
    ds_read_b64_tr_b16 a[64:65], v8 offset:35936
    ds_read_b64_tr_b16 a[66:67], v8 offset:38496
    v_mfma_f32_16x16x32_bf16 v[20:23], a[128:131], a[124:127], v[20:23]
    s_add_u32 m0, s34, 61440
    ds_read_b64_tr_b16 a[68:69], v8 offset:30816
    ds_read_b64_tr_b16 a[70:71], v8 offset:33376
    buffer_load_dwordx4 v3, s[48:51], s8 offen sc1 lds
    v_mfma_f32_16x16x32_bf16 v[20:23], a[132:135], a[120:123], v[20:23]
    s_waitcnt lgkmcnt(10)
    ds_read_b64_tr_b16 a[72:73], v8 offset:25696
    s_nop 0
    ds_read_b64_tr_b16 a[74:75], v8 offset:28256
    v_mfma_f32_16x16x32_bf16 v[20:23], a[136:139], a[116:119], v[20:23]
    s_add_u32 s8, s8, 4096
    ds_read_b64_tr_b16 a[76:77], v8 offset:20576
    ds_read_b64_tr_b16 a[78:79], v8 offset:23136
    v_mfma_f32_16x16x32_bf16 v[20:23], a[140:143], a[112:115], v[20:23]
    s_add_u32 m0, s34, 65536
    ds_read_b64_tr_b16 a[96:97], v8 offset:20608
    ds_read_b64_tr_b16 a[98:99], v8 offset:23168
    buffer_load_dwordx4 v3, s[48:51], s8 offen sc1 lds
    v_mfma_f32_16x16x32_bf16 v[24:27], a[32:35], a[112:115], v[24:27]
    s_waitcnt lgkmcnt(10)
    s_nop 0
    ds_read_b64_tr_b16 a[100:101], v8 offset:25728
    ds_read_b64_tr_b16 a[102:103], v8 offset:28288
    v_mfma_f32_16x16x32_bf16 v[24:27], a[36:39], a[116:119], v[24:27]
    s_add_u32 s8, s8, 4096
    ds_read_b64_tr_b16 a[104:105], v8 offset:30848
    ds_read_b64_tr_b16 a[106:107], v8 offset:33408
    v_mfma_f32_16x16x32_bf16 v[24:27], a[40:43], a[120:123], v[24:27]
    s_add_u32 m0, s34, 69632
    ds_read_b64_tr_b16 a[108:109], v8 offset:35968
    ds_read_b64_tr_b16 a[110:111], v8 offset:38528
    buffer_load_dwordx4 v3, s[48:51], s8 offen sc1 lds
    v_mfma_f32_16x16x32_bf16 v[24:27], a[44:47], a[124:127], v[24:27]
    s_nop 0
    s_waitcnt lgkmcnt(10)
    ds_read_b64_tr_b16 a[128:129], v8 offset:40960
    ds_read_b64_tr_b16 a[130:131], v8 offset:43520
    v_mfma_f32_16x16x32_bf16 v[28:31], a[64:67], a[124:127], v[28:31]
    ds_read_b64_tr_b16 a[132:133], v8 offset:46080
    ds_read_b64_tr_b16 a[134:135], v8 offset:48640
    buffer_load_dword v5, v51, s[48:51], s82 offen sc1
    v_mfma_f32_16x16x32_bf16 v[28:31], a[68:71], a[120:123], v[28:31]
    s_add_u32 s8, s8, 4096
    s_add_u32 m0, s34, 73728
    ds_read_b64_tr_b16 a[136:137], v8 offset:51200
    ds_read_b64_tr_b16 a[138:139], v8 offset:53760
    buffer_load_dwordx4 v3, s[48:51], s8 offen sc1 lds
    v_mfma_f32_16x16x32_bf16 v[28:31], a[72:75], a[116:119], v[28:31]
    s_waitcnt lgkmcnt(10)
    ds_read_b64_tr_b16 a[140:141], v8 offset:56320
    s_nop 0
    ds_read_b64_tr_b16 a[142:143], v8 offset:58880
    v_mfma_f32_16x16x32_bf16 v[28:31], a[76:79], a[112:115], v[28:31]
    s_add_u32 s8, s8, 4096
    ds_read_b64_tr_b16 a[32:33], v8 offset:56352
    ds_read_b64_tr_b16 a[34:35], v8 offset:58912
    v_mfma_f32_16x16x32_bf16 v[32:35], a[96:99], a[112:115], v[32:35]
    s_add_u32 m0, s34, 77824
    ds_read_b64_tr_b16 a[36:37], v8 offset:51232
    ds_read_b64_tr_b16 a[38:39], v8 offset:53792
    buffer_load_dwordx4 v3, s[48:51], s8 offen sc1 lds
    v_mfma_f32_16x16x32_bf16 v[32:35], a[100:103], a[116:119], v[32:35]
    s_waitcnt lgkmcnt(10)
    s_nop 0
    ds_read_b64_tr_b16 a[40:41], v8 offset:46112
    ds_read_b64_tr_b16 a[42:43], v8 offset:48672
    v_mfma_f32_16x16x32_bf16 v[32:35], a[104:107], a[120:123], v[32:35]
    ds_read_b64_tr_b16 a[44:45], v8 offset:40992
    ds_read_b64_tr_b16 a[46:47], v8 offset:43552
    v_mfma_f32_16x16x32_bf16 v[32:35], a[108:111], a[124:127], v[32:35]
    ds_read_b64_tr_b16 a[64:65], v8 offset:41024
    ds_read_b64_tr_b16 a[66:67], v8 offset:43584
    v_mfma_f32_16x16x32_bf16 v[16:19], a[128:131], a[144:147], v[16:19]
    s_waitcnt lgkmcnt(10)
    ds_read_b64_tr_b16 a[68:69], v8 offset:46144
    ds_read_b64_tr_b16 a[70:71], v8 offset:48704
    v_mfma_f32_16x16x32_bf16 v[16:19], a[132:135], a[148:151], v[16:19]
    s_nop 0
    ds_read_b64_tr_b16 a[72:73], v8 offset:51264
    ds_read_b64_tr_b16 a[74:75], v8 offset:53824
    buffer_load_dwordx4 v[36:39], v1, s[48:51], s60 offen sc1
    v_mfma_f32_16x16x32_bf16 v[16:19], a[136:139], a[152:155], v[16:19]
    ds_read_b64_tr_b16 a[76:77], v8 offset:56384
    ds_read_b64_tr_b16 a[78:79], v8 offset:58944
    buffer_load_dwordx4 v[40:43], v1, s[48:51], s60 offen offset:1024 sc1
    v_mfma_f32_16x16x32_bf16 v[16:19], a[140:143], a[156:159], v[16:19]
    s_waitcnt lgkmcnt(10)
    ds_read_b64_tr_b16 a[96:97], v8 offset:56416
    ds_read_b64_tr_b16 a[98:99], v8 offset:58976
    s_nop 0
    buffer_load_dwordx2 v[44:45], v1, s[48:51], s61 offen sc1
    v_mfma_f32_16x16x32_bf16 v[20:23], a[32:35], a[156:159], v[20:23]
    ds_read_b64_tr_b16 a[100:101], v8 offset:51296
    ds_read_b64_tr_b16 a[102:103], v8 offset:53856
    v_mfma_f32_16x16x32_bf16 v[20:23], a[36:39], a[152:155], v[20:23]
    s_nop 0
    ds_read_b64_tr_b16 a[104:105], v8 offset:46176
    ds_read_b64_tr_b16 a[106:107], v8 offset:48736
    v_mfma_f32_16x16x32_bf16 v[20:23], a[40:43], a[148:151], v[20:23]
    s_waitcnt lgkmcnt(10)
    ds_read_b64_tr_b16 a[108:109], v8 offset:41056
    ds_read_b64_tr_b16 a[110:111], v8 offset:43616
    v_mfma_f32_16x16x32_bf16 v[20:23], a[44:47], a[144:147], v[20:23]
    s_waitcnt vmcnt(14)
    s_barrier
    v_mfma_f32_16x16x32_bf16 v[24:27], a[64:67], a[144:147], v[24:27]
    ds_read_b64_tr_b16 a[128:129], v8 offset:41088
    ds_read_b64_tr_b16 a[130:131], v8 offset:43648
    v_mfma_f32_16x16x32_bf16 v[24:27], a[68:71], a[148:151], v[24:27]
    s_waitcnt lgkmcnt(8)
    ds_read_b64_tr_b16 a[132:133], v8 offset:46208
    ds_read_b64_tr_b16 a[134:135], v8 offset:48768
    v_mfma_f32_16x16x32_bf16 v[24:27], a[72:75], a[152:155], v[24:27]
    s_nop 0
    ds_read_b64_tr_b16 a[136:137], v8 offset:51328
    ds_read_b64_tr_b16 a[138:139], v8 offset:53888
    v_lshlrev_b32_e64 v176, 16, v58
    v_mfma_f32_16x16x32_bf16 v[24:27], a[76:79], a[156:159], v[24:27]
    ds_read_b64_tr_b16 a[140:141], v8 offset:56448
    ds_read_b64_tr_b16 a[142:143], v8 offset:59008
    v_and_b32 v177, s76, v58
    v_mfma_f32_16x16x32_bf16 v[28:31], a[96:99], a[156:159], v[28:31]
    s_waitcnt lgkmcnt(8)
    ds_read_b64_tr_b16 a[32:33], v9 offset:0
    ds_read_b64_tr_b16 a[34:35], v9 offset:2560
    v_mov_b32_e64 v128, 0
    v_mfma_f32_16x16x32_bf16 v[28:31], a[100:103], a[152:155], v[28:31]
    ds_read_b64_tr_b16 a[36:37], v9 offset:5120
    ds_read_b64_tr_b16 a[38:39], v9 offset:7680
    v_mov_b32_e64 v129, 0
    v_mfma_f32_16x16x32_bf16 v[28:31], a[104:107], a[148:151], v[28:31]
    ds_read_b64_tr_b16 a[40:41], v9 offset:10240
    ds_read_b64_tr_b16 a[42:43], v9 offset:12800
    v_lshlrev_b32 v178, 16, v59
    v_mfma_f32_16x16x32_bf16 v[28:31], a[108:111], a[144:147], v[28:31]
    s_waitcnt lgkmcnt(10)
    ds_read_b64_tr_b16 a[44:45], v9 offset:15360
    ds_read_b64_tr_b16 a[46:47], v9 offset:17920
    v_and_b32_e64 v179, s76, v59
    v_mfma_f32_16x16x32_bf16 v[32:35], a[128:131], a[144:147], v[32:35]
    ds_read_b64_tr_b16 a[64:65], v9 offset:15392
    ds_read_b64_tr_b16 a[66:67], v9 offset:17952
    v_mov_b32 v130, 0
    v_mfma_f32_16x16x32_bf16 v[32:35], a[132:135], a[148:151], v[32:35]
    s_waitcnt lgkmcnt(10)
    ds_read_b64_tr_b16 a[68:69], v9 offset:10272
    ds_read_b64_tr_b16 a[70:71], v9 offset:12832
    v_mov_b32_e64 v131, 0
    v_mfma_f32_16x16x32_bf16 v[32:35], a[136:139], a[152:155], v[32:35]
    ds_read_b64_tr_b16 a[72:73], v9 offset:5152
    ds_read_b64_tr_b16 a[74:75], v9 offset:7712
    v_lshlrev_b32 v180, 16, v248
    v_mfma_f32_16x16x32_bf16 v[32:35], a[140:143], a[156:159], v[32:35]
    s_waitcnt lgkmcnt(10)
    ds_read_b64_tr_b16 a[76:77], v9 offset:32
    ds_read_b64_tr_b16 a[78:79], v9 offset:2592
    v_and_b32_e64 v181, s76, v248
    v_mfma_f32_16x16x32_bf16 v[16:19], a[32:35], a[176:179], v[16:19]
    s_waitcnt vmcnt(0)
    s_barrier
    v_cmp_lt_u32 vcc, 0, v5
    s_nop 1
    s_and_b32 s81, vcc_lo, 0xff
    s_andn2_b32 s81, s81, s83
    s_or_b32 s83, s83, s81
    v_mfma_f32_16x16x32_bf16 v[16:19], a[36:39], a[180:183], v[16:19]
    ds_read_b64_tr_b16 a[96:97], v9 offset:64
    ds_read_b64_tr_b16 a[98:99], v9 offset:2624
    s_bitcmp1_b32 s81, 0
    s_cbranch_scc0 L_f0_0a
    s_add_u32 s3, s78, 0
    s_add_u32 s35, s79, 0
    buffer_load_dwordx4 v[80:83], v1, s[48:51], s3 offen sc1
    buffer_load_dwordx4 v[84:87], v1, s[48:51], s3 offen offset:1024 sc1
    buffer_load_dwordx2 v[240:241], v49, s[48:51], s35 offen sc1
L_f0_0a:
    s_waitcnt lgkmcnt(10)
    v_mfma_f32_16x16x32_bf16 v[16:19], a[40:43], a[184:187], v[16:19]
    s_nop 0
    ds_read_b64_tr_b16 a[100:101], v9 offset:5184
    ds_read_b64_tr_b16 a[102:103], v9 offset:7744
    v_mov_b32 v132, 0
    v_mfma_f32_16x16x32_bf16 v[16:19], a[44:47], a[188:191], v[16:19]
    s_waitcnt lgkmcnt(8)
    ds_read_b64_tr_b16 a[104:105], v9 offset:10304
    ds_read_b64_tr_b16 a[106:107], v9 offset:12864
    v_mov_b32_e64 v133, 0
    v_mfma_f32_16x16x32_bf16 v[20:23], a[64:67], a[188:191], v[20:23]
    ds_read_b64_tr_b16 a[108:109], v9 offset:15424
    ds_read_b64_tr_b16 a[110:111], v9 offset:17984
    v_lshlrev_b32 v182, 16, v249
    v_mfma_f32_16x16x32_bf16 v[20:23], a[68:71], a[184:187], v[20:23]
    s_waitcnt lgkmcnt(8)
    ds_read_b64_tr_b16 a[128:129], v9 offset:15456
    ds_read_b64_tr_b16 a[130:131], v9 offset:18016
    v_and_b32_e64 v183, s76, v249
    v_mfma_f32_16x16x32_bf16 v[20:23], a[72:75], a[180:183], v[20:23]
    ds_read_b64_tr_b16 a[132:133], v9 offset:10336
    ds_read_b64_tr_b16 a[134:135], v9 offset:12896
    v_mov_b32 v134, 0
    v_mfma_f32_16x16x32_bf16 v[20:23], a[76:79], a[176:179], v[20:23]
    s_waitcnt lgkmcnt(10)
    ds_read_b64_tr_b16 a[136:137], v9 offset:5216
    ds_read_b64_tr_b16 a[138:139], v9 offset:7776
    v_mov_b32 v135, 0
    v_mfma_f32_16x16x32_bf16 v[24:27], a[96:99], a[176:179], v[24:27]
    s_waitcnt lgkmcnt(10)
    ds_read_b64_tr_b16 a[140:141], v9 offset:96
    ds_read_b64_tr_b16 a[142:143], v9 offset:2656
    v_lshlrev_b32 v184, 16, v250
    v_mfma_f32_16x16x32_bf16 v[24:27], a[100:103], a[180:183], v[24:27]
    s_waitcnt lgkmcnt(10)
    ds_read_b64_tr_b16 a[32:33], v9 offset:128
    ds_read_b64_tr_b16 a[34:35], v9 offset:2688
    v_and_b32 v185, s76, v250
    v_mfma_f32_16x16x32_bf16 v[24:27], a[104:107], a[184:187], v[24:27]
    s_waitcnt lgkmcnt(10)
    ds_read_b64_tr_b16 a[36:37], v9 offset:5248
    ds_read_b64_tr_b16 a[38:39], v9 offset:7808
    v_mov_b32 v136, 0
    v_mfma_f32_16x16x32_bf16 v[24:27], a[108:111], a[188:191], v[24:27]
    s_waitcnt lgkmcnt(10)
    ds_read_b64_tr_b16 a[40:41], v9 offset:10368
    ds_read_b64_tr_b16 a[42:43], v9 offset:12928
    v_mov_b32 v137, 0
    v_mfma_f32_16x16x32_bf16 v[28:31], a[128:131], a[188:191], v[28:31]
    s_waitcnt lgkmcnt(10)
    ds_read_b64_tr_b16 a[44:45], v9 offset:15488
    ds_read_b64_tr_b16 a[46:47], v9 offset:18048
    v_lshlrev_b32 v186, 16, v251
    v_mfma_f32_16x16x32_bf16 v[28:31], a[132:135], a[184:187], v[28:31]
    s_waitcnt lgkmcnt(10)
    ds_read_b64_tr_b16 a[64:65], v9 offset:20480
    ds_read_b64_tr_b16 a[66:67], v9 offset:23040
    v_mfma_f32_16x16x32_bf16 v[28:31], a[136:139], a[180:183], v[28:31]
    ds_read_b64_tr_b16 a[68:69], v9 offset:25600
    ds_read_b64_tr_b16 a[70:71], v9 offset:28160
    s_bitcmp1_b32 s81, 1
    s_cbranch_scc0 L_f0_1a
    s_add_u32 s3, s78, 2621440
    s_add_u32 s35, s79, 2621440
    buffer_load_dwordx4 v[88:91], v1, s[48:51], s3 offen sc1
    buffer_load_dwordx4 v[92:95], v1, s[48:51], s3 offen offset:1024 sc1
    buffer_load_dwordx2 v[242:243], v49, s[48:51], s35 offen sc1
L_f0_1a:
    s_waitcnt lgkmcnt(12)
    v_mfma_f32_16x16x32_bf16 v[28:31], a[140:143], a[176:179], v[28:31]
    s_waitcnt lgkmcnt(10)
    ds_read_b64_tr_b16 a[72:73], v9 offset:30720
    ds_read_b64_tr_b16 a[74:75], v9 offset:33280
    v_and_b32 v187, s76, v251
    v_mfma_f32_16x16x32_bf16 v[32:35], a[32:35], a[176:179], v[32:35]
    s_waitcnt lgkmcnt(10)
    ds_read_b64_tr_b16 a[76:77], v9 offset:35840
    ds_read_b64_tr_b16 a[78:79], v9 offset:38400
    v_mov_b32 v138, 0
    v_mfma_f32_16x16x32_bf16 v[32:35], a[36:39], a[180:183], v[32:35]
    s_waitcnt lgkmcnt(10)
    ds_read_b64_tr_b16 a[96:97], v9 offset:35872
    ds_read_b64_tr_b16 a[98:99], v9 offset:38432
    v_mov_b32 v139, 0
    v_mfma_f32_16x16x32_bf16 v[32:35], a[40:43], a[184:187], v[32:35]
    s_waitcnt lgkmcnt(10)
    ds_read_b64_tr_b16 a[100:101], v9 offset:30752
    ds_read_b64_tr_b16 a[102:103], v9 offset:33312
    v_lshlrev_b32 v188, 16, v252
    v_mfma_f32_16x16x32_bf16 v[32:35], a[44:47], a[188:191], v[32:35]
    s_waitcnt lgkmcnt(10)
    ds_read_b64_tr_b16 a[104:105], v9 offset:25632
    ds_read_b64_tr_b16 a[106:107], v9 offset:28192
    v_and_b32 v189, s76, v252
    v_mfma_f32_16x16x32_bf16 v[16:19], a[64:67], a[16:19], v[16:19]
    s_waitcnt lgkmcnt(10)
    ds_read_b64_tr_b16 a[108:109], v9 offset:20512
    ds_read_b64_tr_b16 a[110:111], v9 offset:23072
    v_mov_b32 v140, 0
    v_mfma_f32_16x16x32_bf16 v[16:19], a[68:71], a[20:23], v[16:19]
    s_waitcnt lgkmcnt(10)
    ds_read_b64_tr_b16 a[128:129], v9 offset:20544
    ds_read_b64_tr_b16 a[130:131], v9 offset:23104
    v_mov_b32 v141, 0
    v_mfma_f32_16x16x32_bf16 v[16:19], a[72:75], a[24:27], v[16:19]
    s_waitcnt lgkmcnt(10)
    ds_read_b64_tr_b16 a[132:133], v9 offset:25664
    ds_read_b64_tr_b16 a[134:135], v9 offset:28224
    v_lshlrev_b32 v190, 16, v253
    v_mfma_f32_16x16x32_bf16 v[16:19], a[76:79], a[28:31], v[16:19]
    s_waitcnt lgkmcnt(10)
    ds_read_b64_tr_b16 a[136:137], v9 offset:30784
    ds_read_b64_tr_b16 a[138:139], v9 offset:33344
    v_and_b32_e64 v191, s76, v253
    v_mfma_f32_16x16x32_bf16 v[20:23], a[96:99], a[28:31], v[20:23]
    s_waitcnt lgkmcnt(10)
    ds_read_b64_tr_b16 a[140:141], v9 offset:35904
    ds_read_b64_tr_b16 a[142:143], v9 offset:38464
    v_mov_b32_e64 v142, 0
    v_mfma_f32_16x16x32_bf16 v[20:23], a[100:103], a[24:27], v[20:23]
    s_waitcnt lgkmcnt(10)
    ds_read_b64_tr_b16 a[32:33], v9 offset:35936
    ds_read_b64_tr_b16 a[34:35], v9 offset:38496
    v_mov_b32_e64 v143, 0
    v_mfma_f32_16x16x32_bf16 v[20:23], a[104:107], a[20:23], v[20:23]
    s_waitcnt lgkmcnt(10)
    ds_read_b64_tr_b16 a[36:37], v9 offset:30816
    ds_read_b64_tr_b16 a[38:39], v9 offset:33376
    v_mfma_f32_16x16x32_bf16 v[20:23], a[108:111], a[16:19], v[20:23]
    s_nop 0
    ds_read_b64_tr_b16 a[40:41], v9 offset:25696
    ds_read_b64_tr_b16 a[42:43], v9 offset:28256
    s_bitcmp1_b32 s81, 2
    s_cbranch_scc0 L_f0_2a
    s_add_u32 s3, s78, 5242880
    s_add_u32 s35, s79, 5242880
    buffer_load_dwordx4 v[112:115], v1, s[48:51], s3 offen sc1
    buffer_load_dwordx4 v[116:119], v1, s[48:51], s3 offen offset:1024 sc1
    buffer_load_dwordx2 v[244:245], v49, s[48:51], s35 offen sc1
L_f0_2a:
    s_waitcnt lgkmcnt(12)
    v_mfma_f32_16x16x32_bf16 v[24:27], a[128:131], a[16:19], v[24:27]
    s_waitcnt lgkmcnt(10)
    ds_read_b64_tr_b16 a[44:45], v9 offset:20576
    ds_read_b64_tr_b16 a[46:47], v9 offset:23136
    v_lshlrev_b32 v192, 16, v254
    v_mfma_f32_16x16x32_bf16 v[24:27], a[132:135], a[20:23], v[24:27]
    s_waitcnt lgkmcnt(10)
    ds_read_b64_tr_b16 a[64:65], v9 offset:20608
    ds_read_b64_tr_b16 a[66:67], v9 offset:23168
    v_and_b32 v193, s76, v254
    v_mfma_f32_16x16x32_bf16 v[24:27], a[136:139], a[24:27], v[24:27]
    s_waitcnt lgkmcnt(10)
    ds_read_b64_tr_b16 a[68:69], v9 offset:25728
    ds_read_b64_tr_b16 a[70:71], v9 offset:28288
    v_mov_b32 v144, 0
    v_mfma_f32_16x16x32_bf16 v[24:27], a[140:143], a[28:31], v[24:27]
    s_waitcnt lgkmcnt(10)
    ds_read_b64_tr_b16 a[72:73], v9 offset:30848
    ds_read_b64_tr_b16 a[74:75], v9 offset:33408
    v_mov_b32 v145, 0
    v_mfma_f32_16x16x32_bf16 v[28:31], a[32:35], a[28:31], v[28:31]
    s_waitcnt lgkmcnt(10)
    ds_read_b64_tr_b16 a[76:77], v9 offset:35968
    ds_read_b64_tr_b16 a[78:79], v9 offset:38528
    v_lshlrev_b32 v194, 16, v255
    v_mfma_f32_16x16x32_bf16 v[28:31], a[36:39], a[24:27], v[28:31]
    s_waitcnt lgkmcnt(10)
    ds_read_b64_tr_b16 a[96:97], v48 offset:40960
    ds_read_b64_tr_b16 a[98:99], v48 offset:43520
    v_and_b32 v195, s76, v255
    v_mfma_f32_16x16x32_bf16 v[28:31], a[40:43], a[20:23], v[28:31]
    s_waitcnt lgkmcnt(10)
    ds_read_b64_tr_b16 a[100:101], v48 offset:46080
    ds_read_b64_tr_b16 a[102:103], v48 offset:48640
    v_mov_b32 v146, 0
    v_mfma_f32_16x16x32_bf16 v[28:31], a[44:47], a[16:19], v[28:31]
    s_waitcnt lgkmcnt(10)
    ds_read_b64_tr_b16 a[104:105], v48 offset:51200
    ds_read_b64_tr_b16 a[106:107], v48 offset:53760
    v_mov_b32 v147, 0
    v_mfma_f32_16x16x32_bf16 v[32:35], a[64:67], a[16:19], v[32:35]
    s_waitcnt lgkmcnt(10)
    ds_read_b64_tr_b16 a[108:109], v48 offset:56320
    ds_read_b64_tr_b16 a[110:111], v48 offset:58880
    v_mfma_f32_16x16x32_bf16 v[32:35], a[68:71], a[20:23], v[32:35]
    s_waitcnt lgkmcnt(10)
    ds_read_b64_tr_b16 a[128:129], v48 offset:56352
    ds_read_b64_tr_b16 a[130:131], v48 offset:58912
    v_mfma_f32_16x16x32_bf16 v[32:35], a[72:75], a[24:27], v[32:35]
    s_waitcnt lgkmcnt(10)
    ds_read_b64_tr_b16 a[132:133], v48 offset:51232
    ds_read_b64_tr_b16 a[134:135], v48 offset:53792
    v_mfma_f32_16x16x32_bf16 v[32:35], a[76:79], a[28:31], v[32:35]
    s_waitcnt lgkmcnt(10)
    ds_read_b64_tr_b16 a[136:137], v48 offset:46112
    ds_read_b64_tr_b16 a[138:139], v48 offset:48672
    v_mfma_f32_16x16x32_bf16 v[16:19], a[96:99], a[48:51], v[16:19]
    s_nop 0
    ds_read_b64_tr_b16 a[140:141], v48 offset:40992
    ds_read_b64_tr_b16 a[142:143], v48 offset:43552
    s_bitcmp1_b32 s81, 3
    s_cbranch_scc0 L_f0_3a
    s_add_u32 s3, s78, 7864320
    s_add_u32 s35, s79, 7864320
    buffer_load_dwordx4 v[120:123], v1, s[48:51], s3 offen sc1
    buffer_load_dwordx4 v[124:127], v1, s[48:51], s3 offen offset:1024 sc1
    buffer_load_dwordx2 v[246:247], v49, s[48:51], s35 offen sc1
L_f0_3a:
    s_waitcnt lgkmcnt(12)
    v_mfma_f32_16x16x32_bf16 v[16:19], a[100:103], a[52:55], v[16:19]
    s_waitcnt lgkmcnt(10)
    ds_read_b64_tr_b16 a[32:33], v48 offset:41024
    ds_read_b64_tr_b16 a[34:35], v48 offset:43584
    v_mfma_f32_16x16x32_bf16 v[16:19], a[104:107], a[56:59], v[16:19]
    s_waitcnt lgkmcnt(10)
    ds_read_b64_tr_b16 a[36:37], v48 offset:46144
    ds_read_b64_tr_b16 a[38:39], v48 offset:48704
    v_mfma_f32_16x16x32_bf16 v[16:19], a[108:111], a[60:63], v[16:19]
    s_waitcnt lgkmcnt(10)
    ds_read_b64_tr_b16 a[40:41], v48 offset:51264
    ds_read_b64_tr_b16 a[42:43], v48 offset:53824
    v_mfma_f32_16x16x32_bf16 v[20:23], a[128:131], a[60:63], v[20:23]
    s_waitcnt lgkmcnt(10)
    ds_read_b64_tr_b16 a[44:45], v48 offset:56384
    ds_read_b64_tr_b16 a[46:47], v48 offset:58944
    v_mfma_f32_16x16x32_bf16 v[20:23], a[132:135], a[56:59], v[20:23]
    s_waitcnt lgkmcnt(10)
    ds_read_b64_tr_b16 a[64:65], v48 offset:56416
    ds_read_b64_tr_b16 a[66:67], v48 offset:58976
    v_mfma_f32_16x16x32_bf16 v[20:23], a[136:139], a[52:55], v[20:23]
    s_waitcnt lgkmcnt(10)
    ds_read_b64_tr_b16 a[68:69], v48 offset:51296
    ds_read_b64_tr_b16 a[70:71], v48 offset:53856
    v_mfma_f32_16x16x32_bf16 v[20:23], a[140:143], a[48:51], v[20:23]
    s_waitcnt lgkmcnt(10)
    ds_read_b64_tr_b16 a[72:73], v48 offset:46176
    ds_read_b64_tr_b16 a[74:75], v48 offset:48736
    v_mfma_f32_16x16x32_bf16 v[24:27], a[32:35], a[48:51], v[24:27]
    s_waitcnt lgkmcnt(10)
    ds_read_b64_tr_b16 a[76:77], v48 offset:41056
    ds_read_b64_tr_b16 a[78:79], v48 offset:43616
    v_mfma_f32_16x16x32_bf16 v[24:27], a[36:39], a[52:55], v[24:27]
    s_waitcnt lgkmcnt(10)
    ds_read_b64_tr_b16 a[96:97], v48 offset:41088
    ds_read_b64_tr_b16 a[98:99], v48 offset:43648
    v_mfma_f32_16x16x32_bf16 v[24:27], a[40:43], a[56:59], v[24:27]
    s_waitcnt lgkmcnt(10)
    ds_read_b64_tr_b16 a[100:101], v48 offset:46208
    ds_read_b64_tr_b16 a[102:103], v48 offset:48768
    v_mfma_f32_16x16x32_bf16 v[24:27], a[44:47], a[60:63], v[24:27]
    s_waitcnt lgkmcnt(10)
    ds_read_b64_tr_b16 a[104:105], v48 offset:51328
    ds_read_b64_tr_b16 a[106:107], v48 offset:53888
    v_mfma_f32_16x16x32_bf16 v[28:31], a[64:67], a[60:63], v[28:31]
    s_waitcnt lgkmcnt(10)
    ds_read_b64_tr_b16 a[108:109], v48 offset:56448
    ds_read_b64_tr_b16 a[110:111], v48 offset:59008
    v_mfma_f32_16x16x32_bf16 v[28:31], a[68:71], a[56:59], v[28:31]
    s_nop 0
    ds_read_b64_tr_b16 a[128:129], v8 offset:0
    ds_read_b64_tr_b16 a[130:131], v8 offset:2560
    s_bitcmp1_b32 s81, 4
    s_cbranch_scc0 L_f0_4a
    s_add_u32 s3, s78, 10485760
    s_add_u32 s35, s79, 10485760
    buffer_load_dwordx4 v[160:163], v1, s[48:51], s3 offen sc1
    buffer_load_dwordx4 v[164:167], v1, s[48:51], s3 offen offset:1024 sc1
    buffer_load_dwordx2 v[52:53], v49, s[48:51], s35 offen sc1
L_f0_4a:
    s_waitcnt lgkmcnt(12)
    v_mfma_f32_16x16x32_bf16 v[28:31], a[72:75], a[52:55], v[28:31]
    s_waitcnt lgkmcnt(10)
    ds_read_b64_tr_b16 a[132:133], v8 offset:5120
    ds_read_b64_tr_b16 a[134:135], v8 offset:7680
    v_mfma_f32_16x16x32_bf16 v[28:31], a[76:79], a[48:51], v[28:31]
    s_waitcnt lgkmcnt(10)
    ds_read_b64_tr_b16 a[136:137], v8 offset:10240
    ds_read_b64_tr_b16 a[138:139], v8 offset:12800
    v_mfma_f32_16x16x32_bf16 v[32:35], a[96:99], a[48:51], v[32:35]
    s_waitcnt lgkmcnt(10)
    ds_read_b64_tr_b16 a[140:141], v8 offset:15360
    ds_read_b64_tr_b16 a[142:143], v8 offset:17920
    v_mfma_f32_16x16x32_bf16 v[32:35], a[100:103], a[52:55], v[32:35]
    s_waitcnt lgkmcnt(10)
    ds_read_b64_tr_b16 a[32:33], v8 offset:15392
    ds_read_b64_tr_b16 a[34:35], v8 offset:17952
    v_mfma_f32_16x16x32_bf16 v[32:35], a[104:107], a[56:59], v[32:35]
    s_waitcnt lgkmcnt(10)
    ds_read_b64_tr_b16 a[36:37], v8 offset:10272
    ds_read_b64_tr_b16 a[38:39], v8 offset:12832
    v_mfma_f32_16x16x32_bf16 v[32:35], a[108:111], a[60:63], v[32:35]
    s_waitcnt lgkmcnt(10)
    ds_read_b64_tr_b16 a[40:41], v8 offset:5152
    ds_read_b64_tr_b16 a[42:43], v8 offset:7712
    v_mfma_f32_16x16x32_bf16 v[16:19], a[128:131], a[0:3], v[16:19]
    s_waitcnt lgkmcnt(10)
    ds_read_b64_tr_b16 a[44:45], v8 offset:32
    ds_read_b64_tr_b16 a[46:47], v8 offset:2592
    v_mfma_f32_16x16x32_bf16 v[16:19], a[132:135], a[4:7], v[16:19]
    s_waitcnt lgkmcnt(10)
    ds_read_b64_tr_b16 a[64:65], v8 offset:64
    ds_read_b64_tr_b16 a[66:67], v8 offset:2624
    v_mfma_f32_16x16x32_bf16 v[16:19], a[136:139], a[8:11], v[16:19]
    s_waitcnt lgkmcnt(10)
    ds_read_b64_tr_b16 a[68:69], v8 offset:5184
    ds_read_b64_tr_b16 a[70:71], v8 offset:7744
    v_mfma_f32_16x16x32_bf16 v[16:19], a[140:143], a[12:15], v[16:19]
    s_waitcnt lgkmcnt(10)
    ds_read_b64_tr_b16 a[72:73], v8 offset:10304
    ds_read_b64_tr_b16 a[74:75], v8 offset:12864
    v_mfma_f32_16x16x32_bf16 v[20:23], a[32:35], a[12:15], v[20:23]
    s_waitcnt lgkmcnt(10)
    ds_read_b64_tr_b16 a[76:77], v8 offset:15424
    ds_read_b64_tr_b16 a[78:79], v8 offset:17984
    v_mfma_f32_16x16x32_bf16 v[20:23], a[36:39], a[8:11], v[20:23]
    s_waitcnt lgkmcnt(10)
    ds_read_b64_tr_b16 a[96:97], v8 offset:15456
    ds_read_b64_tr_b16 a[98:99], v8 offset:18016
    v_mfma_f32_16x16x32_bf16 v[20:23], a[40:43], a[4:7], v[20:23]
    s_nop 0
    ds_read_b64_tr_b16 a[100:101], v8 offset:10336
    ds_read_b64_tr_b16 a[102:103], v8 offset:12896
    s_bitcmp1_b32 s81, 5
    s_cbranch_scc0 L_f0_5a
    s_add_u32 s3, s78, 13107200
    s_add_u32 s35, s79, 13107200
    buffer_load_dwordx4 v[168:171], v1, s[48:51], s3 offen sc1
    buffer_load_dwordx4 v[172:175], v1, s[48:51], s3 offen offset:1024 sc1
    buffer_load_dwordx2 v[54:55], v49, s[48:51], s35 offen sc1
L_f0_5a:
    s_waitcnt lgkmcnt(12)
    v_mfma_f32_16x16x32_bf16 v[20:23], a[44:47], a[0:3], v[20:23]
    s_waitcnt lgkmcnt(10)
    ds_read_b64_tr_b16 a[104:105], v8 offset:5216
    ds_read_b64_tr_b16 a[106:107], v8 offset:7776
    v_mfma_f32_16x16x32_bf16 v[24:27], a[64:67], a[0:3], v[24:27]
    s_waitcnt lgkmcnt(10)
    ds_read_b64_tr_b16 a[108:109], v8 offset:96
    ds_read_b64_tr_b16 a[110:111], v8 offset:2656
    v_mfma_f32_16x16x32_bf16 v[24:27], a[68:71], a[4:7], v[24:27]
    s_waitcnt lgkmcnt(10)
    ds_read_b64_tr_b16 a[128:129], v8 offset:128
    ds_read_b64_tr_b16 a[130:131], v8 offset:2688
    v_mfma_f32_16x16x32_bf16 v[24:27], a[72:75], a[8:11], v[24:27]
    s_waitcnt lgkmcnt(10)
    ds_read_b64_tr_b16 a[132:133], v8 offset:5248
    ds_read_b64_tr_b16 a[134:135], v8 offset:7808
    v_mfma_f32_16x16x32_bf16 v[24:27], a[76:79], a[12:15], v[24:27]
    s_waitcnt lgkmcnt(10)
    ds_read_b64_tr_b16 a[136:137], v8 offset:10368
    ds_read_b64_tr_b16 a[138:139], v8 offset:12928
    v_mfma_f32_16x16x32_bf16 v[28:31], a[96:99], a[12:15], v[28:31]
    s_waitcnt lgkmcnt(10)
    ds_read_b64_tr_b16 a[140:141], v8 offset:15488
    ds_read_b64_tr_b16 a[142:143], v8 offset:18048
    v_mfma_f32_16x16x32_bf16 v[28:31], a[100:103], a[8:11], v[28:31]
    s_waitcnt lgkmcnt(10)
    v_mfma_f32_16x16x32_bf16 v[28:31], a[104:107], a[4:7], v[28:31]
    s_waitcnt lgkmcnt(8)
    v_mfma_f32_16x16x32_bf16 v[28:31], a[108:111], a[0:3], v[28:31]
    s_waitcnt lgkmcnt(6)
    v_mfma_f32_16x16x32_bf16 v[32:35], a[128:131], a[0:3], v[32:35]
    s_waitcnt lgkmcnt(4)
    v_mfma_f32_16x16x32_bf16 v[32:35], a[132:135], a[4:7], v[32:35]
    s_waitcnt lgkmcnt(2)
    v_mfma_f32_16x16x32_bf16 v[32:35], a[136:139], a[8:11], v[32:35]
    s_waitcnt lgkmcnt(0)
    v_mfma_f32_16x16x32_bf16 v[32:35], a[140:143], a[12:15], v[32:35]
    s_nop 7
    s_bitcmp1_b32 s81, 6
    s_cbranch_scc0 L_f0_6a
    s_add_u32 s3, s78, 15728640
    s_add_u32 s35, s79, 15728640
    buffer_load_dwordx4 v[208:211], v1, s[48:51], s3 offen sc1
    buffer_load_dwordx4 v[212:215], v1, s[48:51], s3 offen offset:1024 sc1
    buffer_load_dwordx2 v[56:57], v49, s[48:51], s35 offen sc1
L_f0_6a:
    v_lshlrev_b32 v10, 16, v36
    v_and_b32 v11, s76, v36
    v_lshlrev_b32 v12, 16, v37
    v_and_b32 v13, s76, v37
    v_pk_add_f32 v[16:17], v[16:17], v[10:11]
    v_pk_add_f32 v[18:19], v[18:19], v[12:13]
    v_pk_mul_f32 v[10:11], v[16:17], s[14:15]
    v_pk_mul_f32 v[12:13], v[18:19], s[14:15]
    v_exp_f32 v10, v10
    v_exp_f32 v11, v11
    v_exp_f32 v12, v12
    v_exp_f32 v13, v13
    v_pk_add_f32 v[10:11], v[10:11], s[74:75]
    v_pk_add_f32 v[12:13], v[12:13], s[74:75]
    v_rcp_f32 v10, v10
    v_rcp_f32 v11, v11
    v_rcp_f32 v12, v12
    v_rcp_f32 v13, v13
    v_pk_mul_f32 v[16:17], v[10:11], v[16:17]
    v_pk_mul_f32 v[18:19], v[12:13], v[18:19]
    v_lshlrev_b32 v10, 16, v38
    v_and_b32 v11, s76, v38
    v_lshlrev_b32 v12, 16, v39
    v_and_b32 v13, s76, v39
    v_pk_add_f32 v[20:21], v[20:21], v[10:11]
    v_pk_add_f32 v[22:23], v[22:23], v[12:13]
    v_pk_mul_f32 v[10:11], v[20:21], s[14:15]
    v_pk_mul_f32 v[12:13], v[22:23], s[14:15]
    v_exp_f32 v10, v10
    v_exp_f32 v11, v11
    v_exp_f32 v12, v12
    v_exp_f32 v13, v13
    v_pk_add_f32 v[10:11], v[10:11], s[74:75]
    v_pk_add_f32 v[12:13], v[12:13], s[74:75]
    v_rcp_f32 v10, v10
    v_rcp_f32 v11, v11
    v_rcp_f32 v12, v12
    v_rcp_f32 v13, v13
    v_pk_mul_f32 v[20:21], v[10:11], v[20:21]
    v_pk_mul_f32 v[22:23], v[12:13], v[22:23]
    v_lshlrev_b32 v10, 16, v40
    v_and_b32 v11, s76, v40
    v_lshlrev_b32 v12, 16, v41
    v_and_b32 v13, s76, v41
    s_bitcmp1_b32 s81, 7
    s_cbranch_scc0 L_f0_7a
    s_add_u32 s3, s78, 18350080
    s_add_u32 s35, s79, 18350080
    buffer_load_dwordx4 v[216:219], v1, s[48:51], s3 offen sc1
    buffer_load_dwordx4 v[220:223], v1, s[48:51], s3 offen offset:1024 sc1
    buffer_load_dwordx2 v[46:47], v49, s[48:51], s35 offen sc1
L_f0_7a:
    v_pk_add_f32 v[24:25], v[24:25], v[10:11]
    v_pk_add_f32 v[26:27], v[26:27], v[12:13]
    v_pk_mul_f32 v[10:11], v[24:25], s[14:15]
    v_pk_mul_f32 v[12:13], v[26:27], s[14:15]
    v_exp_f32 v10, v10
    v_exp_f32 v11, v11
    v_exp_f32 v12, v12
    v_exp_f32 v13, v13
    v_pk_add_f32 v[10:11], v[10:11], s[74:75]
    v_pk_add_f32 v[12:13], v[12:13], s[74:75]
    v_rcp_f32 v10, v10
    v_rcp_f32 v11, v11
    v_rcp_f32 v12, v12
    v_rcp_f32 v13, v13
    v_pk_mul_f32 v[24:25], v[10:11], v[24:25]
    v_pk_mul_f32 v[26:27], v[12:13], v[26:27]
    v_lshlrev_b32 v10, 16, v42
    v_and_b32 v11, s76, v42
    v_lshlrev_b32 v12, 16, v43
    v_and_b32 v13, s76, v43
    v_pk_add_f32 v[28:29], v[28:29], v[10:11]
    v_pk_add_f32 v[30:31], v[30:31], v[12:13]
    v_pk_mul_f32 v[10:11], v[28:29], s[14:15]
    v_pk_mul_f32 v[12:13], v[30:31], s[14:15]
    v_exp_f32 v10, v10
    v_exp_f32 v11, v11
    v_exp_f32 v12, v12
    v_exp_f32 v13, v13
    v_pk_add_f32 v[10:11], v[10:11], s[74:75]
    v_pk_add_f32 v[12:13], v[12:13], s[74:75]
    v_rcp_f32 v10, v10
    v_rcp_f32 v11, v11
    v_rcp_f32 v12, v12
    v_rcp_f32 v13, v13
    v_pk_mul_f32 v[28:29], v[10:11], v[28:29]
    v_pk_mul_f32 v[30:31], v[12:13], v[30:31]
    v_lshlrev_b32 v10, 16, v44
    v_and_b32 v11, s76, v44
    v_lshlrev_b32 v12, 16, v45
    v_and_b32 v13, s76, v45
    v_pk_add_f32 v[32:33], v[32:33], v[10:11]
    v_pk_add_f32 v[34:35], v[34:35], v[12:13]
    v_pk_mul_f32 v[10:11], v[32:33], s[14:15]
    v_pk_mul_f32 v[12:13], v[34:35], s[14:15]
    v_exp_f32 v10, v10
    v_exp_f32 v11, v11
    v_exp_f32 v12, v12
    v_exp_f32 v13, v13
    v_pk_add_f32 v[10:11], v[10:11], s[74:75]
    v_pk_add_f32 v[12:13], v[12:13], s[74:75]
    v_rcp_f32 v10, v10
    v_rcp_f32 v11, v11
    v_rcp_f32_e64 v12, v12
    v_rcp_f32_e64 v13, v13
    v_pk_mul_f32 v[32:33], v[10:11], v[32:33]
    v_pk_mul_f32 v[34:35], v[12:13], v[34:35]
    s_cmp_eq_u32 s83, 0xff
    s_cbranch_scc1 L_fin3a
    buffer_load_dword v5, v51, s[48:51], s82 offen sc1
    s_mov_b32 s65, 60000
L_fina:
    s_waitcnt vmcnt(0)
    v_cmp_lt_u32 vcc, 0, v5
    s_nop 1
    s_and_b32 s81, vcc_lo, 0xff
    s_andn2_b32 s81, s81, s83
    s_or_b32 s83, s83, s81
    s_bitcmp1_b32 s81, 0
    s_cbranch_scc0 L_f1_0a
    s_add_u32 s3, s78, 0
    s_add_u32 s35, s79, 0
    buffer_load_dwordx4 v[80:83], v1, s[48:51], s3 offen sc1
    buffer_load_dwordx4 v[84:87], v1, s[48:51], s3 offen offset:1024 sc1
    buffer_load_dwordx2 v[240:241], v49, s[48:51], s35 offen sc1
L_f1_0a:
    s_bitcmp1_b32 s81, 1
    s_cbranch_scc0 L_f1_1a
    s_add_u32 s3, s78, 2621440
    s_add_u32 s35, s79, 2621440
    buffer_load_dwordx4 v[88:91], v1, s[48:51], s3 offen sc1
    buffer_load_dwordx4 v[92:95], v1, s[48:51], s3 offen offset:1024 sc1
    buffer_load_dwordx2 v[242:243], v49, s[48:51], s35 offen sc1
L_f1_1a:
    s_bitcmp1_b32 s81, 2
    s_cbranch_scc0 L_f1_2a
    s_add_u32 s3, s78, 5242880
    s_add_u32 s35, s79, 5242880
    buffer_load_dwordx4 v[112:115], v1, s[48:51], s3 offen sc1
    buffer_load_dwordx4 v[116:119], v1, s[48:51], s3 offen offset:1024 sc1
    buffer_load_dwordx2 v[244:245], v49, s[48:51], s35 offen sc1
L_f1_2a:
    s_bitcmp1_b32 s81, 3
    s_cbranch_scc0 L_f1_3a
    s_add_u32 s3, s78, 7864320
    s_add_u32 s35, s79, 7864320
    buffer_load_dwordx4 v[120:123], v1, s[48:51], s3 offen sc1
    buffer_load_dwordx4 v[124:127], v1, s[48:51], s3 offen offset:1024 sc1
    buffer_load_dwordx2 v[246:247], v49, s[48:51], s35 offen sc1
L_f1_3a:
    s_bitcmp1_b32 s81, 4
    s_cbranch_scc0 L_f1_4a
    s_add_u32 s3, s78, 10485760
    s_add_u32 s35, s79, 10485760
    buffer_load_dwordx4 v[160:163], v1, s[48:51], s3 offen sc1
    buffer_load_dwordx4 v[164:167], v1, s[48:51], s3 offen offset:1024 sc1
    buffer_load_dwordx2 v[52:53], v49, s[48:51], s35 offen sc1
L_f1_4a:
    s_bitcmp1_b32 s81, 5
    s_cbranch_scc0 L_f1_5a
    s_add_u32 s3, s78, 13107200
    s_add_u32 s35, s79, 13107200
    buffer_load_dwordx4 v[168:171], v1, s[48:51], s3 offen sc1
    buffer_load_dwordx4 v[172:175], v1, s[48:51], s3 offen offset:1024 sc1
    buffer_load_dwordx2 v[54:55], v49, s[48:51], s35 offen sc1
L_f1_5a:
    s_bitcmp1_b32 s81, 6
    s_cbranch_scc0 L_f1_6a
    s_add_u32 s3, s78, 15728640
    s_add_u32 s35, s79, 15728640
    buffer_load_dwordx4 v[208:211], v1, s[48:51], s3 offen sc1
    buffer_load_dwordx4 v[212:215], v1, s[48:51], s3 offen offset:1024 sc1
    buffer_load_dwordx2 v[56:57], v49, s[48:51], s35 offen sc1
L_f1_6a:
    s_bitcmp1_b32 s81, 7
    s_cbranch_scc0 L_f1_7a
    s_add_u32 s3, s78, 18350080
    s_add_u32 s35, s79, 18350080
    buffer_load_dwordx4 v[216:219], v1, s[48:51], s3 offen sc1
    buffer_load_dwordx4 v[220:223], v1, s[48:51], s3 offen offset:1024 sc1
    buffer_load_dwordx2 v[46:47], v49, s[48:51], s35 offen sc1
L_f1_7a:
    s_cmp_eq_u32 s83, 0xff
    s_cbranch_scc1 L_fin2a
    s_sleep 12
    buffer_load_dword v5, v51, s[48:51], s82 offen sc1
    s_sub_u32 s65, s65, 1
    s_cbranch_scc0 L_fina
L_fin2a:
    s_waitcnt vmcnt(0)
L_fin3a:
    s_waitcnt vmcnt(21)
    v_dot2c_f32_bf16 v128, s62, v80
    v_dot2c_f32_bf16 v129, s63, v80
    v_dot2c_f32_bf16 v130, s62, v81
    v_dot2c_f32_bf16 v131, s63, v81
    v_dot2c_f32_bf16 v132, s62, v82
    v_dot2c_f32_bf16 v133, s63, v82
    v_dot2c_f32_bf16 v134, s62, v83
    v_dot2c_f32_bf16 v135, s63, v83
    v_dot2c_f32_bf16 v136, s62, v84
    v_dot2c_f32_bf16 v137, s63, v84
    v_dot2c_f32_bf16 v138, s62, v85
    v_dot2c_f32_bf16 v139, s63, v85
    v_dot2c_f32_bf16 v140, s62, v86
    v_dot2c_f32_bf16 v141, s63, v86
    v_dot2c_f32_bf16 v142, s62, v87
    v_dot2c_f32_bf16 v143, s63, v87
    v_dot2c_f32_bf16 v144, s62, v240
    v_dot2c_f32_bf16 v145, s63, v240
    v_dot2c_f32_bf16 v146, s62, v241
    v_dot2c_f32_bf16 v147, s63, v241
    s_waitcnt vmcnt(18)
    v_dot2c_f32_bf16 v128, s62, v88
    v_dot2c_f32_bf16 v129, s63, v88
    v_dot2c_f32_bf16 v130, s62, v89
    v_dot2c_f32_bf16 v131, s63, v89
    v_dot2c_f32_bf16 v132, s62, v90
    v_dot2c_f32_bf16 v133, s63, v90
    v_dot2c_f32_bf16 v134, s62, v91
    v_dot2c_f32_bf16 v135, s63, v91
    v_dot2c_f32_bf16 v136, s62, v92
    v_dot2c_f32_bf16 v137, s63, v92
    v_dot2c_f32_bf16 v138, s62, v93
    v_dot2c_f32_bf16 v139, s63, v93
    v_dot2c_f32_bf16 v140, s62, v94
    v_dot2c_f32_bf16 v141, s63, v94
    v_dot2c_f32_bf16 v142, s62, v95
    v_dot2c_f32_bf16 v143, s63, v95
    v_dot2c_f32_bf16 v144, s62, v242
    v_dot2c_f32_bf16 v145, s63, v242
    v_dot2c_f32_bf16 v146, s62, v243
    v_dot2c_f32_bf16 v147, s63, v243
    s_waitcnt vmcnt(15)
    v_dot2c_f32_bf16 v128, s62, v112
    v_dot2c_f32_bf16 v129, s63, v112
    v_dot2c_f32_bf16 v130, s62, v113
    v_dot2c_f32_bf16 v131, s63, v113
    v_dot2c_f32_bf16 v132, s62, v114
    v_dot2c_f32_bf16 v133, s63, v114
    v_dot2c_f32_bf16 v134, s62, v115
    v_dot2c_f32_bf16 v135, s63, v115
    v_dot2c_f32_bf16 v136, s62, v116
    v_dot2c_f32_bf16 v137, s63, v116
    v_dot2c_f32_bf16 v138, s62, v117
    v_dot2c_f32_bf16 v139, s63, v117
    v_dot2c_f32_bf16 v140, s62, v118
    v_dot2c_f32_bf16 v141, s63, v118
    v_dot2c_f32_bf16 v142, s62, v119
    v_dot2c_f32_bf16 v143, s63, v119
    v_dot2c_f32_bf16 v144, s62, v244
    v_dot2c_f32_bf16 v145, s63, v244
    v_dot2c_f32_bf16 v146, s62, v245
    v_dot2c_f32_bf16 v147, s63, v245
    s_waitcnt vmcnt(12)
    v_dot2c_f32_bf16 v128, s62, v120
    v_dot2c_f32_bf16 v129, s63, v120
    v_dot2c_f32_bf16 v130, s62, v121
    v_dot2c_f32_bf16 v131, s63, v121
    v_dot2c_f32_bf16 v132, s62, v122
    v_dot2c_f32_bf16 v133, s63, v122
    v_dot2c_f32_bf16 v134, s62, v123
    v_dot2c_f32_bf16 v135, s63, v123
    v_dot2c_f32_bf16 v136, s62, v124
    v_dot2c_f32_bf16 v137, s63, v124
    v_dot2c_f32_bf16 v138, s62, v125
    v_dot2c_f32_bf16 v139, s63, v125
    v_dot2c_f32_bf16 v140, s62, v126
    v_dot2c_f32_bf16 v141, s63, v126
    v_dot2c_f32_bf16 v142, s62, v127
    v_dot2c_f32_bf16 v143, s63, v127
    v_dot2c_f32_bf16 v144, s62, v246
    v_dot2c_f32_bf16 v145, s63, v246
    v_dot2c_f32_bf16 v146, s62, v247
    v_dot2c_f32_bf16 v147, s63, v247
    s_waitcnt vmcnt(9)
    v_dot2c_f32_bf16 v128, s62, v160
    v_dot2c_f32_bf16 v129, s63, v160
    v_dot2c_f32_bf16 v130, s62, v161
    v_dot2c_f32_bf16 v131, s63, v161
    v_dot2c_f32_bf16 v132, s62, v162
    v_dot2c_f32_bf16 v133, s63, v162
    v_dot2c_f32_bf16 v134, s62, v163
    v_dot2c_f32_bf16 v135, s63, v163
    v_dot2c_f32_bf16 v136, s62, v164
    v_dot2c_f32_bf16 v137, s63, v164
    v_dot2c_f32_bf16 v138, s62, v165
    v_dot2c_f32_bf16 v139, s63, v165
    v_dot2c_f32_bf16 v140, s62, v166
    v_dot2c_f32_bf16 v141, s63, v166
    v_dot2c_f32_bf16 v142, s62, v167
    v_dot2c_f32_bf16 v143, s63, v167
    v_dot2c_f32_bf16 v144, s62, v52
    v_dot2c_f32_bf16 v145, s63, v52
    v_dot2c_f32_bf16 v146, s62, v53
    v_dot2c_f32_bf16 v147, s63, v53
    s_waitcnt vmcnt(6)
    v_dot2c_f32_bf16 v128, s62, v168
    v_dot2c_f32_bf16 v129, s63, v168
    v_dot2c_f32_bf16 v130, s62, v169
    v_dot2c_f32_bf16 v131, s63, v169
    v_dot2c_f32_bf16 v132, s62, v170
    v_dot2c_f32_bf16 v133, s63, v170
    v_dot2c_f32_bf16 v134, s62, v171
    v_dot2c_f32_bf16 v135, s63, v171
    v_dot2c_f32_bf16 v136, s62, v172
    v_dot2c_f32_bf16 v137, s63, v172
    v_dot2c_f32_bf16 v138, s62, v173
    v_dot2c_f32_bf16 v139, s63, v173
    v_dot2c_f32_bf16 v140, s62, v174
    v_dot2c_f32_bf16 v141, s63, v174
    v_dot2c_f32_bf16 v142, s62, v175
    v_dot2c_f32_bf16 v143, s63, v175
    v_dot2c_f32_bf16 v144, s62, v54
    v_dot2c_f32_bf16 v145, s63, v54
    v_dot2c_f32_bf16 v146, s62, v55
    v_dot2c_f32_bf16 v147, s63, v55
    s_waitcnt vmcnt(3)
    v_dot2c_f32_bf16 v128, s62, v208
    v_dot2c_f32_bf16 v129, s63, v208
    v_dot2c_f32_bf16 v130, s62, v209
    v_dot2c_f32_bf16 v131, s63, v209
    v_dot2c_f32_bf16 v132, s62, v210
    v_dot2c_f32_bf16 v133, s63, v210
    v_dot2c_f32_bf16 v134, s62, v211
    v_dot2c_f32_bf16 v135, s63, v211
    v_dot2c_f32_bf16 v136, s62, v212
    v_dot2c_f32_bf16 v137, s63, v212
    v_dot2c_f32_bf16 v138, s62, v213
    v_dot2c_f32_bf16 v139, s63, v213
    v_dot2c_f32_bf16 v140, s62, v214
    v_dot2c_f32_bf16 v141, s63, v214
    v_dot2c_f32_bf16 v142, s62, v215
    v_dot2c_f32_bf16 v143, s63, v215
    v_dot2c_f32_bf16 v144, s62, v56
    v_dot2c_f32_bf16 v145, s63, v56
    v_dot2c_f32_bf16 v146, s62, v57
    v_dot2c_f32_bf16 v147, s63, v57
    s_waitcnt vmcnt(0)
    v_dot2c_f32_bf16 v128, s62, v216
    v_dot2c_f32_bf16 v129, s63, v216
    v_dot2c_f32_bf16 v130, s62, v217
    v_dot2c_f32_bf16 v131, s63, v217
    v_dot2c_f32_bf16 v132, s62, v218
    v_dot2c_f32_bf16 v133, s63, v218
    v_dot2c_f32_bf16 v134, s62, v219
    v_dot2c_f32_bf16 v135, s63, v219
    v_dot2c_f32_bf16 v136, s62, v220
    v_dot2c_f32_bf16 v137, s63, v220
    v_dot2c_f32_bf16 v138, s62, v221
    v_dot2c_f32_bf16 v139, s63, v221
    v_dot2c_f32_bf16 v140, s62, v222
    v_dot2c_f32_bf16 v141, s63, v222
    v_dot2c_f32_bf16 v142, s62, v223
    v_dot2c_f32_bf16 v143, s63, v223
    v_dot2c_f32_bf16 v144, s62, v46
    v_dot2c_f32_bf16 v145, s63, v46
    v_dot2c_f32_bf16 v146, s62, v47
    v_dot2c_f32_bf16 v147, s63, v47
    v_pk_fma_f32 v[16:17], v[16:17], v[128:129], v[176:177]
    s_nop 0
    v_cvt_pk_bf16_f32 v36, v16, v17
    v_pk_fma_f32 v[18:19], v[18:19], v[130:131], v[178:179]
    v_cvt_pk_bf16_f32 v37, v18, v19
    buffer_store_dwordx2 v[36:37], v50, s[40:43], s80 offen offset:0
    v_pk_fma_f32 v[20:21], v[20:21], v[132:133], v[180:181]
    v_cvt_pk_bf16_f32 v38, v20, v21
    v_pk_fma_f32 v[22:23], v[22:23], v[134:135], v[182:183]
    v_cvt_pk_bf16_f32 v39, v22, v23
    buffer_store_dwordx2 v[38:39], v50, s[40:43], s80 offen offset:32
    v_pk_fma_f32 v[24:25], v[24:25], v[136:137], v[184:185]
    v_cvt_pk_bf16_f32 v40, v24, v25
    v_pk_fma_f32 v[26:27], v[26:27], v[138:139], v[186:187]
    v_cvt_pk_bf16_f32 v41, v26, v27
    buffer_store_dwordx2 v[40:41], v50, s[40:43], s80 offen offset:64
    v_pk_fma_f32 v[28:29], v[28:29], v[140:141], v[188:189]
    v_cvt_pk_bf16_f32 v42, v28, v29
    v_pk_fma_f32 v[30:31], v[30:31], v[142:143], v[190:191]
    v_cvt_pk_bf16_f32 v43, v30, v31
    buffer_store_dwordx2 v[42:43], v50, s[40:43], s80 offen offset:96
    v_pk_fma_f32 v[32:33], v[32:33], v[144:145], v[192:193]
    v_cvt_pk_bf16_f32 v44, v32, v33
    v_pk_fma_f32 v[34:35], v[34:35], v[146:147], v[194:195]
    v_cvt_pk_bf16_f32 v45, v34, v35
    buffer_store_dwordx2 v[44:45], v50, s[40:43], s80 offen offset:128
    s_nop 0
    s_endpgm
L_vb:
    ds_read_b64_tr_b16 v[16:17], v8 offset:0
    ds_read_b64_tr_b16 v[18:19], v8 offset:5120
    ds_read_b64_tr_b16 v[20:21], v8 offset:10240
    ds_read_b64_tr_b16 v[22:23], v8 offset:15360
    ds_read_b64_tr_b16 v[24:25], v9 offset:0
    ds_read_b64_tr_b16 v[26:27], v9 offset:5120
    ds_read_b64_tr_b16 v[28:29], v9 offset:10240
    ds_read_b64_tr_b16 v[30:31], v9 offset:15360
    ds_read_b64_tr_b16 v[32:33], v8 offset:64
    ds_read_b64_tr_b16 v[34:35], v8 offset:5184
    ds_read_b64_tr_b16 v[36:37], v8 offset:10304
    ds_read_b64_tr_b16 v[38:39], v8 offset:15424
    s_waitcnt lgkmcnt(10)
    v_mfma_f32_16x16x32_bf16 v[64:67], v[16:19], a[0:3], 0
    s_waitcnt lgkmcnt(8)
    s_add_u32 s6, s6, 4096
    s_add_u32 m0, s34, 40960
    v_mfma_f32_16x16x32_bf16 v[64:67], v[20:23], a[32:35], v[64:67]
    buffer_load_dwordx4 v3, s[48:51], s6 offen sc1 lds
    v_mfma_f32_16x16x32_bf16 v[68:71], v[20:23], a[36:39], 0
    v_mfma_f32_16x16x32_bf16 v[68:71], v[16:19], a[4:7], v[68:71]
    v_mfma_f32_16x16x32_bf16 v[72:75], v[16:19], a[8:11], 0
    ds_read_b64_tr_b16 v[40:41], v9 offset:64
    ds_read_b64_tr_b16 v[42:43], v9 offset:5184
    v_mfma_f32_16x16x32_bf16 v[72:75], v[20:23], a[40:43], v[72:75]
    s_add_u32 s6, s6, 4096
    s_add_u32 m0, s34, 45056
    v_mfma_f32_16x16x32_bf16 v[76:79], v[20:23], a[44:47], 0
    buffer_load_dwordx4 v3, s[48:51], s6 offen sc1 lds
    v_mfma_f32_16x16x32_bf16 v[76:79], v[16:19], a[12:15], v[76:79]
    s_waitcnt lgkmcnt(2)
    ds_read_b64_tr_b16 v[44:45], v9 offset:10304
    ds_read_b64_tr_b16 v[46:47], v9 offset:15424
    v_mfma_f32_16x16x32_bf16 v[92:95], v[24:27], a[12:15], 0
    v_mfma_f32_16x16x32_bf16 v[92:95], v[28:31], a[44:47], v[92:95]
    buffer_store_dwordx4 v[224:227], v1, s[48:51], s79 offen sc1
    v_mfma_f32_16x16x32_bf16 v[88:91], v[28:31], a[40:43], 0
    v_lshrrev_b32 v14, 6, v1
    v_mul_u32_u24 v14, 160, v14
    v_mfma_f32_16x16x32_bf16 v[88:91], v[24:27], a[8:11], v[88:91]
    v_bfe_u32 v15, v1, 4, 2
    v_lshl_add_u32 v48, v15, 3, v14
    v_mfma_f32_16x16x32_bf16 v[84:87], v[24:27], a[4:7], 0
    ds_read_b64_tr_b16 v[16:17], v8 offset:128
    ds_read_b64_tr_b16 v[18:19], v8 offset:5248
    v_mfma_f32_16x16x32_bf16 v[84:87], v[28:31], a[36:39], v[84:87]
    s_add_u32 s6, s6, 4096
    s_add_u32 m0, s34, 49152
    v_mfma_f32_16x16x32_bf16 v[80:83], v[28:31], a[32:35], 0
    buffer_load_dwordx4 v3, s[48:51], s6 offen sc1 lds
    v_mfma_f32_16x16x32_bf16 v[80:83], v[24:27], a[0:3], v[80:83]
    ds_read_b64_tr_b16 v[20:21], v8 offset:10368
    ds_read_b64_tr_b16 v[22:23], v8 offset:15488
    v_mfma_f32_16x16x32_bf16 v[96:99], v[32:35], a[0:3], 0
    v_lshrrev_b32 v14, 9, v1
    v_lshlrev_b32 v14, 8, v14
    v_mfma_f32_16x16x32_bf16 v[96:99], v[36:39], a[32:35], v[96:99]
    s_add_u32 s6, s6, 4096
    s_add_u32 m0, s34, 53248
    v_mfma_f32_16x16x32_bf16 v[100:103], v[36:39], a[36:39], 0
    buffer_load_dwordx4 v3, s[48:51], s6 offen sc1 lds
    v_mfma_f32_16x16x32_bf16 v[100:103], v[32:35], a[4:7], v[100:103]
    v_and_b32 v15, 0xf0, v1
    v_or_b32_e64 v14, v14, v15
    v_mfma_f32_16x16x32_bf16 v[104:107], v[32:35], a[8:11], 0
    ds_read_b64_tr_b16 v[24:25], v9 offset:128
    ds_read_b64_tr_b16 v[26:27], v9 offset:5248
    v_mfma_f32_16x16x32_bf16 v[104:107], v[36:39], a[40:43], v[104:107]
    v_mfma_f32_16x16x32_bf16 v[108:111], v[36:39], a[44:47], 0
    buffer_store_dwordx4 v[228:231], v1, s[48:51], s79 offen offset:1024 sc1
    v_mfma_f32_16x16x32_bf16 v[108:111], v[32:35], a[12:15], v[108:111]
    s_waitcnt lgkmcnt(2)
    ds_read_b64_tr_b16 v[28:29], v9 offset:10368
    ds_read_b64_tr_b16 v[30:31], v9 offset:15488
    v_mfma_f32_16x16x32_bf16 v[124:127], v[40:43], a[12:15], 0
    s_nop 0
    v_bfe_u32 v15, v1, 8, 1
    v_lshl_add_u32 v49, v15, 3, v14
    v_mfma_f32_16x16x32_bf16 v[124:127], v[44:47], a[44:47], v[124:127]
    s_add_u32 s6, s6, 4096
    s_add_u32 m0, s34, 57344
    v_mfma_f32_16x16x32_bf16 v[120:123], v[44:47], a[40:43], 0
    buffer_load_dwordx4 v3, s[48:51], s6 offen sc1 lds
    v_mfma_f32_16x16x32_bf16 v[120:123], v[40:43], a[8:11], v[120:123]
    v_lshl_add_u32 v2, v15, 9, v14
    v_add_u32 v2, 4096, v2
    v_mfma_f32_16x16x32_bf16 v[116:119], v[40:43], a[4:7], 0
    ds_read_b64_tr_b16 v[32:33], v8 offset:192
    ds_read_b64_tr_b16 v[34:35], v8 offset:5312
    v_mfma_f32_16x16x32_bf16 v[116:119], v[44:47], a[36:39], v[116:119]
    v_bfe_u32 v14, v1, 4, 4
    v_mul_u32_u24 v14, 1280, v14
    v_mfma_f32_16x16x32_bf16 v[112:115], v[44:47], a[32:35], 0
    v_lshrrev_b32_e64 v15, 8, v1
    v_lshl_add_u32 v50, v15, 3, v14
    v_mfma_f32_16x16x32_bf16 v[112:115], v[40:43], a[0:3], v[112:115]
    ds_read_b64_tr_b16 v[36:37], v8 offset:10432
    ds_read_b64_tr_b16 v[38:39], v8 offset:15552
    v_mfma_f32_16x16x32_bf16 v[128:131], v[16:19], a[0:3], 0
    buffer_store_dwordx4 v[232:235], v1, s[48:51], s79 offen offset:2048 sc1
    v_mfma_f32_16x16x32_bf16 v[128:131], v[20:23], a[32:35], v[128:131]
    v_bfe_u32 v51, v1, 4, 3
    v_lshlrev_b32 v51, 2, v51
    v_mfma_f32_16x16x32_bf16 v[132:135], v[20:23], a[36:39], 0
    s_cmp_le_u32 s32, 0
    s_cselect_b32 s6, 1, 0
    s_mul_i32 s6, s6, 61440
    s_add_u32 s6, s6, s70
    s_add_u32 m0, s34, 61440
    v_mfma_f32_16x16x32_bf16 v[132:135], v[16:19], a[4:7], v[132:135]
    buffer_load_dwordx4 v3, s[48:51], s6 offen sc1 lds
    v_mfma_f32_16x16x32_bf16 v[136:139], v[16:19], a[8:11], 0
    ds_read_b64_tr_b16 v[40:41], v9 offset:192
    ds_read_b64_tr_b16 v[42:43], v9 offset:5312
    v_mfma_f32_16x16x32_bf16 v[136:139], v[20:23], a[40:43], v[136:139]
    v_mfma_f32_16x16x32_bf16 v[140:143], v[20:23], a[44:47], 0
    s_nop 0
    v_mfma_f32_16x16x32_bf16 v[140:143], v[16:19], a[12:15], v[140:143]
    s_waitcnt lgkmcnt(2)
    ds_read_b64_tr_b16 v[44:45], v9 offset:10432
    ds_read_b64_tr_b16 v[46:47], v9 offset:15552
    v_mfma_f32_16x16x32_bf16 v[156:159], v[24:27], a[12:15], 0
    s_add_u32 s6, s6, 4096
    s_add_u32 m0, s34, 65536
    v_mfma_f32_16x16x32_bf16 v[156:159], v[28:31], a[44:47], v[156:159]
    buffer_load_dwordx4 v3, s[48:51], s6 offen sc1 lds
    v_mfma_f32_16x16x32_bf16 v[152:155], v[28:31], a[40:43], 0
    v_mfma_f32_16x16x32_bf16 v[152:155], v[24:27], a[8:11], v[152:155]
    s_nop 0
    v_mfma_f32_16x16x32_bf16 v[148:151], v[24:27], a[4:7], 0
    s_nop 0
    ds_read_b64_tr_b16 v[16:17], v8 offset:256
    ds_read_b64_tr_b16 v[18:19], v8 offset:5376
    v_mfma_f32_16x16x32_bf16 v[148:151], v[28:31], a[36:39], v[148:151]
    buffer_store_dwordx4 v[236:239], v1, s[48:51], s80 offen sc1
    v_mfma_f32_16x16x32_bf16 v[144:147], v[28:31], a[32:35], 0
    v_mfma_f32_16x16x32_bf16 v[144:147], v[24:27], a[0:3], v[144:147]
    ds_read_b64_tr_b16 v[20:21], v8 offset:10496
    ds_read_b64_tr_b16 v[22:23], v8 offset:15616
    v_mfma_f32_16x16x32_bf16 v[160:163], v[32:35], a[0:3], 0
    s_add_u32 s6, s6, 4096
    s_add_u32 m0, s34, 69632
    v_mfma_f32_16x16x32_bf16 v[160:163], v[36:39], a[32:35], v[160:163]
    buffer_load_dwordx4 v3, s[48:51], s6 offen sc1 lds
    v_mfma_f32_16x16x32_bf16 v[164:167], v[36:39], a[36:39], 0
    s_nop 0
    v_mfma_f32_16x16x32_bf16 v[164:167], v[32:35], a[4:7], v[164:167]
    s_nop 0
    v_mfma_f32_16x16x32_bf16 v[168:171], v[32:35], a[8:11], 0
    ds_read_b64_tr_b16 v[24:25], v9 offset:256
    ds_read_b64_tr_b16 v[26:27], v9 offset:5376
    v_mfma_f32_16x16x32_bf16 v[168:171], v[36:39], a[40:43], v[168:171]
    s_add_u32 s6, s6, 4096
    s_add_u32 m0, s34, 73728
    v_mfma_f32_16x16x32_bf16 v[172:175], v[36:39], a[44:47], 0
    buffer_load_dwordx4 v3, s[48:51], s6 offen sc1 lds
    v_mfma_f32_16x16x32_bf16 v[172:175], v[32:35], a[12:15], v[172:175]
    s_waitcnt lgkmcnt(2)
    ds_read_b64_tr_b16 v[28:29], v9 offset:10496
    ds_read_b64_tr_b16 v[30:31], v9 offset:15616
    v_mfma_f32_16x16x32_bf16 v[188:191], v[40:43], a[12:15], 0
    s_nop 0
    v_mfma_f32_16x16x32_bf16 v[188:191], v[44:47], a[44:47], v[188:191]
    buffer_store_dwordx4 v[240:243], v1, s[48:51], s80 offen offset:1024 sc1
    v_mfma_f32_16x16x32_bf16 v[184:187], v[44:47], a[40:43], 0
    v_mfma_f32_16x16x32_bf16 v[184:187], v[40:43], a[8:11], v[184:187]
    v_mfma_f32_16x16x32_bf16 v[180:183], v[40:43], a[4:7], 0
    ds_read_b64_tr_b16 v[32:33], v8 offset:20480
    ds_read_b64_tr_b16 v[34:35], v8 offset:25600
    v_mfma_f32_16x16x32_bf16 v[180:183], v[44:47], a[36:39], v[180:183]
    s_add_u32 s6, s6, 4096
    s_add_u32 m0, s34, 77824
    v_mfma_f32_16x16x32_bf16 v[176:179], v[44:47], a[32:35], 0
    buffer_load_dwordx4 v3, s[48:51], s6 offen sc1 lds
    v_mfma_f32_16x16x32_bf16 v[176:179], v[40:43], a[0:3], v[176:179]
    ds_read_b64_tr_b16 v[36:37], v8 offset:30720
    ds_read_b64_tr_b16 v[38:39], v8 offset:35840
    v_mfma_f32_16x16x32_bf16 v[192:195], v[16:19], a[0:3], 0
    v_mfma_f32_16x16x32_bf16 v[192:195], v[20:23], a[32:35], v[192:195]
    buffer_store_dwordx4 v[244:247], v1, s[48:51], s80 offen offset:2048 sc1
    v_mfma_f32_16x16x32_bf16 v[196:199], v[20:23], a[36:39], 0
    v_mfma_f32_16x16x32_bf16 v[196:199], v[16:19], a[4:7], v[196:199]
    v_mfma_f32_16x16x32_bf16 v[200:203], v[16:19], a[8:11], 0
    ds_read_b64_tr_b16 v[40:41], v9 offset:20480
    ds_read_b64_tr_b16 v[42:43], v9 offset:25600
    v_mfma_f32_16x16x32_bf16 v[200:203], v[20:23], a[40:43], v[200:203]
    v_mfma_f32_16x16x32_bf16 v[204:207], v[20:23], a[44:47], 0
    s_nop 0
    v_mfma_f32_16x16x32_bf16 v[204:207], v[16:19], a[12:15], v[204:207]
    s_waitcnt lgkmcnt(2)
    ds_read_b64_tr_b16 v[44:45], v9 offset:30720
    ds_read_b64_tr_b16 v[46:47], v9 offset:35840
    v_mfma_f32_16x16x32_bf16 v[220:223], v[24:27], a[12:15], 0
    v_mfma_f32_16x16x32_bf16 v[220:223], v[28:31], a[44:47], v[220:223]
    s_add_u32 s6, s6, 4096
    s_add_u32 m0, s34, 81920
    v_mfma_f32_16x16x32_bf16 v[216:219], v[28:31], a[40:43], 0
    buffer_load_dwordx4 v3, s[48:51], s6 offen sc1 lds
    v_mfma_f32_16x16x32_bf16 v[216:219], v[24:27], a[8:11], v[216:219]
    v_mfma_f32_16x16x32_bf16 v[212:215], v[24:27], a[4:7], 0
    ds_read_b64_tr_b16 v[16:17], v8 offset:20544
    ds_read_b64_tr_b16 v[18:19], v8 offset:25664
    v_mfma_f32_16x16x32_bf16 v[212:215], v[28:31], a[36:39], v[212:215]
    v_mfma_f32_16x16x32_bf16 v[208:211], v[28:31], a[32:35], 0
    v_mfma_f32_16x16x32_bf16 v[208:211], v[24:27], a[0:3], v[208:211]
    ds_read_b64_tr_b16 v[20:21], v8 offset:30784
    ds_read_b64_tr_b16 v[22:23], v8 offset:35904
    v_mfma_f32_16x16x32_bf16 v[64:67], v[32:35], a[64:67], v[64:67]
    s_add_u32 s6, s6, 4096
    s_add_u32 m0, s34, 86016
    v_mfma_f32_16x16x32_bf16 v[64:67], v[36:39], a[96:99], v[64:67]
    buffer_load_dwordx4 v3, s[48:51], s6 offen sc1 lds
    v_mfma_f32_16x16x32_bf16 v[68:71], v[36:39], a[100:103], v[68:71]
    v_mfma_f32_16x16x32_bf16 v[68:71], v[32:35], a[68:71], v[68:71]
    v_mfma_f32_16x16x32_bf16 v[72:75], v[32:35], a[72:75], v[72:75]
    ds_read_b64_tr_b16 v[24:25], v9 offset:20544
    ds_read_b64_tr_b16 v[26:27], v9 offset:25664
    v_mfma_f32_16x16x32_bf16 v[72:75], v[36:39], a[104:107], v[72:75]
    buffer_load_dword v57, v4, s[48:51], s71 offen sc1
    v_mfma_f32_16x16x32_bf16 v[76:79], v[36:39], a[108:111], v[76:79]
    s_nop 0
    v_mfma_f32_16x16x32_bf16 v[76:79], v[32:35], a[76:79], v[76:79]
    s_waitcnt lgkmcnt(2)
    ds_read_b64_tr_b16 v[28:29], v9 offset:30784
    ds_read_b64_tr_b16 v[30:31], v9 offset:35904
    v_mfma_f32_16x16x32_bf16 v[92:95], v[40:43], a[76:79], v[92:95]
    s_add_u32 s6, s6, 4096
    s_add_u32 m0, s34, 90112
    v_mfma_f32_16x16x32_bf16 v[92:95], v[44:47], a[108:111], v[92:95]
    buffer_load_dwordx4 v3, s[48:51], s6 offen sc1 lds
    v_mfma_f32_16x16x32_bf16 v[88:91], v[44:47], a[104:107], v[88:91]
    v_mfma_f32_16x16x32_bf16 v[88:91], v[40:43], a[72:75], v[88:91]
    s_nop 0
    v_mfma_f32_16x16x32_bf16 v[84:87], v[40:43], a[68:71], v[84:87]
    s_nop 0
    ds_read_b64_tr_b16 v[32:33], v8 offset:20608
    ds_read_b64_tr_b16 v[34:35], v8 offset:25728
    v_mfma_f32_16x16x32_bf16 v[84:87], v[44:47], a[100:103], v[84:87]
    s_add_u32 s6, s6, 4096
    s_add_u32 m0, s34, 94208
    v_mfma_f32_16x16x32_bf16 v[80:83], v[44:47], a[96:99], v[80:83]
    buffer_load_dwordx4 v3, s[48:51], s6 offen sc1 lds
    v_mfma_f32_16x16x32_bf16 v[80:83], v[40:43], a[64:67], v[80:83]
    ds_read_b64_tr_b16 v[36:37], v8 offset:30848
    ds_read_b64_tr_b16 v[38:39], v8 offset:35968
    v_mfma_f32_16x16x32_bf16 v[96:99], v[16:19], a[64:67], v[96:99]
    v_mfma_f32_16x16x32_bf16 v[96:99], v[20:23], a[96:99], v[96:99]
    s_add_u32 s6, s6, 4096
    s_add_u32 m0, s34, 98304
    v_mfma_f32_16x16x32_bf16 v[100:103], v[20:23], a[100:103], v[100:103]
    buffer_load_dwordx4 v3, s[48:51], s6 offen sc1 lds
    v_mfma_f32_16x16x32_bf16 v[100:103], v[16:19], a[68:71], v[100:103]
    v_mfma_f32_16x16x32_bf16 v[104:107], v[16:19], a[72:75], v[104:107]
    ds_read_b64_tr_b16 v[40:41], v9 offset:20608
    ds_read_b64_tr_b16 v[42:43], v9 offset:25728
    v_mfma_f32_16x16x32_bf16 v[104:107], v[20:23], a[104:107], v[104:107]
    v_mfma_f32_16x16x32_bf16 v[108:111], v[20:23], a[108:111], v[108:111]
    s_nop 0
    v_mfma_f32_16x16x32_bf16 v[108:111], v[16:19], a[76:79], v[108:111]
    s_waitcnt lgkmcnt(2)
    ds_read_b64_tr_b16 v[44:45], v9 offset:30848
    ds_read_b64_tr_b16 v[46:47], v9 offset:35968
    v_mfma_f32_16x16x32_bf16 v[124:127], v[24:27], a[76:79], v[124:127]
    s_add_u32 s6, s6, 4096
    s_add_u32 m0, s34, 102400
    v_mfma_f32_16x16x32_bf16 v[124:127], v[28:31], a[108:111], v[124:127]
    buffer_load_dwordx4 v3, s[48:51], s6 offen sc1 lds
    v_mfma_f32_16x16x32_bf16 v[120:123], v[28:31], a[104:107], v[120:123]
    v_mfma_f32_16x16x32_bf16 v[120:123], v[24:27], a[72:75], v[120:123]
    v_mfma_f32_16x16x32_bf16 v[116:119], v[24:27], a[68:71], v[116:119]
    ds_read_b64_tr_b16 v[16:17], v8 offset:20672
    ds_read_b64_tr_b16 v[18:19], v8 offset:25792
    v_mfma_f32_16x16x32_bf16 v[116:119], v[28:31], a[100:103], v[116:119]
    v_mfma_f32_16x16x32_bf16 v[112:115], v[28:31], a[96:99], v[112:115]
    v_mfma_f32_16x16x32_bf16 v[112:115], v[24:27], a[64:67], v[112:115]
    ds_read_b64_tr_b16 v[20:21], v8 offset:30912
    ds_read_b64_tr_b16 v[22:23], v8 offset:36032
    v_mfma_f32_16x16x32_bf16 v[128:131], v[32:35], a[64:67], v[128:131]
    s_add_u32 s6, s6, 4096
    s_add_u32 m0, s34, 106496
    v_mfma_f32_16x16x32_bf16 v[128:131], v[36:39], a[96:99], v[128:131]
    buffer_load_dwordx4 v3, s[48:51], s6 offen sc1 lds
    v_mfma_f32_16x16x32_bf16 v[132:135], v[36:39], a[100:103], v[132:135]
    s_nop 0
    v_mfma_f32_16x16x32_bf16 v[132:135], v[32:35], a[68:71], v[132:135]
    s_nop 0
    v_mfma_f32_16x16x32_bf16 v[136:139], v[32:35], a[72:75], v[136:139]
    ds_read_b64_tr_b16 v[24:25], v9 offset:20672
    ds_read_b64_tr_b16 v[26:27], v9 offset:25792
    v_mfma_f32_16x16x32_bf16 v[136:139], v[36:39], a[104:107], v[136:139]
    s_add_u32 s6, s6, 4096
    s_add_u32 m0, s34, 110592
    v_mfma_f32_16x16x32_bf16 v[140:143], v[36:39], a[108:111], v[140:143]
    buffer_load_dwordx4 v3, s[48:51], s6 offen sc1 lds
    v_mfma_f32_16x16x32_bf16 v[140:143], v[32:35], a[76:79], v[140:143]
    s_waitcnt lgkmcnt(2)
    ds_read_b64_tr_b16 v[28:29], v9 offset:30912
    ds_read_b64_tr_b16 v[30:31], v9 offset:36032
    v_mfma_f32_16x16x32_bf16 v[156:159], v[40:43], a[76:79], v[156:159]
    s_nop 0
    v_mfma_f32_16x16x32_bf16 v[156:159], v[44:47], a[108:111], v[156:159]
    v_mfma_f32_16x16x32_bf16 v[152:155], v[44:47], a[104:107], v[152:155]
    s_add_u32 s6, s6, 4096
    s_add_u32 m0, s34, 114688
    v_mfma_f32_16x16x32_bf16 v[152:155], v[40:43], a[72:75], v[152:155]
    buffer_load_dwordx4 v3, s[48:51], s6 offen sc1 lds
    v_mfma_f32_16x16x32_bf16 v[148:151], v[40:43], a[68:71], v[148:151]
    ds_read_b64_tr_b16 v[32:33], v8 offset:20736
    ds_read_b64_tr_b16 v[34:35], v8 offset:25856
    v_mfma_f32_16x16x32_bf16 v[148:151], v[44:47], a[100:103], v[148:151]
    v_mfma_f32_16x16x32_bf16 v[144:147], v[44:47], a[96:99], v[144:147]
    v_mfma_f32_16x16x32_bf16 v[144:147], v[40:43], a[64:67], v[144:147]
    ds_read_b64_tr_b16 v[36:37], v8 offset:30976
    ds_read_b64_tr_b16 v[38:39], v8 offset:36096
    v_mfma_f32_16x16x32_bf16 v[160:163], v[16:19], a[64:67], v[160:163]
    s_add_u32 s6, s6, 4096
    s_add_u32 m0, s34, 118784
    v_mfma_f32_16x16x32_bf16 v[160:163], v[20:23], a[96:99], v[160:163]
    buffer_load_dwordx4 v3, s[48:51], s6 offen sc1 lds
    v_mfma_f32_16x16x32_bf16 v[164:167], v[20:23], a[100:103], v[164:167]
    ds_read_b64_tr_b16 v[40:41], v9 offset:20736
    ds_read_b64_tr_b16 v[42:43], v9 offset:25856
    v_mfma_f32_16x16x32_bf16 v[164:167], v[16:19], a[68:71], v[164:167]
    v_mfma_f32_16x16x32_bf16 v[168:171], v[16:19], a[72:75], v[168:171]
    v_mfma_f32_16x16x32_bf16 v[168:171], v[20:23], a[104:107], v[168:171]
    ds_read_b64_tr_b16 v[44:45], v9 offset:30976
    ds_read_b64_tr_b16 v[46:47], v9 offset:36096
    v_mfma_f32_16x16x32_bf16 v[172:175], v[20:23], a[108:111], v[172:175]
    v_mfma_f32_16x16x32_bf16 v[172:175], v[16:19], a[76:79], v[172:175]
    s_waitcnt lgkmcnt(4)
    v_mfma_f32_16x16x32_bf16 v[188:191], v[24:27], a[76:79], v[188:191]
    s_nop 0
    v_mfma_f32_16x16x32_bf16 v[188:191], v[28:31], a[108:111], v[188:191]
    v_mfma_f32_16x16x32_bf16 v[184:187], v[28:31], a[104:107], v[184:187]
    v_mfma_f32_16x16x32_bf16 v[184:187], v[24:27], a[72:75], v[184:187]
    v_mfma_f32_16x16x32_bf16 v[180:183], v[24:27], a[68:71], v[180:183]
    s_waitcnt vmcnt(11) lgkmcnt(0)
    s_barrier
    s_cmp_lg_u32 s30, 0
    s_cbranch_scc1 L_sig25
    s_lshr_b32 s3, s82, 1
    s_lshl_b32 s3, s3, 8
    s_add_u32 s3, s3, 79695872
    s_mov_b64 exec, 1
    v_mov_b32 v54, 0
    v_mov_b32_e64 v55, 1
    buffer_atomic_add v55, v54, s[48:51], s3 offen
    s_mov_b64 exec, -1
L_sig25:
    s_waitcnt vmcnt(8)
    v_cmp_gt_u32 vcc, 4, v57
    s_cbranch_vccnz L_slow21
L_ok21:
    v_mfma_f32_16x16x32_bf16 v[180:183], v[28:31], a[100:103], v[180:183]
    ds_read_b64_tr_b16 v[16:17], v10 offset:0
    ds_read_b64_tr_b16 v[18:19], v10 offset:5120
    v_mfma_f32_16x16x32_bf16 v[176:179], v[28:31], a[96:99], v[176:179]
    v_mfma_f32_16x16x32_bf16 v[176:179], v[24:27], a[64:67], v[176:179]
    ds_read_b64_tr_b16 v[20:21], v10 offset:10240
    ds_read_b64_tr_b16 v[22:23], v10 offset:15360
    v_mfma_f32_16x16x32_bf16 v[192:195], v[32:35], a[64:67], v[192:195]
    s_cmp_le_u32 s32, 1
    s_cselect_b32 s6, 2, 1
    s_mul_i32 s6, s6, 61440
    s_add_u32 s6, s6, s70
    s_add_u32 m0, s34, 0
    v_mfma_f32_16x16x32_bf16 v[192:195], v[36:39], a[96:99], v[192:195]
    buffer_load_dwordx4 v3, s[48:51], s6 offen sc1 lds
    v_mfma_f32_16x16x32_bf16 v[196:199], v[36:39], a[100:103], v[196:199]
    s_cmp_le_u32 s32, 0
    s_cselect_b32 s7, 1, 0
    s_mul_i32 s7, s7, 6144
    s_add_u32 s7, s7, s72
    v_mfma_f32_16x16x32_bf16 v[196:199], v[32:35], a[68:71], v[196:199]
    buffer_load_dwordx4 a[16:19], v60, s[48:51], s7 offen sc1
    s_nop 0
    v_mfma_f32_16x16x32_bf16 v[200:203], v[32:35], a[72:75], v[200:203]
    s_mul_i32 s8, s33, 245760
    ds_read_b64_tr_b16 v[24:25], v11 offset:0
    ds_read_b64_tr_b16 v[26:27], v11 offset:5120
    v_mfma_f32_16x16x32_bf16 v[200:203], v[36:39], a[104:107], v[200:203]
    buffer_load_dwordx4 a[20:23], v61, s[48:51], s7 offen sc1
    v_mfma_f32_16x16x32_bf16 v[204:207], v[36:39], a[108:111], v[204:207]
    s_add_u32 s8, s8, 85852160
    v_mfma_f32_16x16x32_bf16 v[204:207], v[32:35], a[76:79], v[204:207]
    s_add_u32 s9, s71, 256
    ds_read_b64_tr_b16 v[28:29], v11 offset:10240
    ds_read_b64_tr_b16 v[30:31], v11 offset:15360
    v_mfma_f32_16x16x32_bf16 v[220:223], v[40:43], a[76:79], v[220:223]
    s_lshl_b32 s11, s31, 2
    v_mfma_f32_16x16x32_bf16 v[220:223], v[44:47], a[108:111], v[220:223]
    s_add_u32 s11, s11, s32
    v_mfma_f32_16x16x32_bf16 v[216:219], v[44:47], a[104:107], v[216:219]
    s_lshl_b32 s11, s11, 2
    v_mfma_f32_16x16x32_bf16 v[216:219], v[40:43], a[72:75], v[216:219]
    s_add_u32 s11, s11, s30
    v_mfma_f32_16x16x32_bf16 v[212:215], v[40:43], a[68:71], v[212:215]
    s_mul_i32 s11, s11, 49152
    ds_read_b64_tr_b16 v[32:33], v10 offset:64
    ds_read_b64_tr_b16 v[34:35], v10 offset:5184
    v_mfma_f32_16x16x32_bf16 v[212:215], v[44:47], a[100:103], v[212:215]
    buffer_load_dwordx4 a[24:27], v62, s[48:51], s7 offen sc1
    v_mfma_f32_16x16x32_bf16 v[208:211], v[44:47], a[96:99], v[208:211]
    s_add_u32 s11, s11, 9437184
    v_mfma_f32_16x16x32_bf16 v[208:211], v[40:43], a[64:67], v[208:211]
    s_waitcnt lgkmcnt(2)
    s_nop 0
    s_mul_i32 s35, s31, 2621440
    ds_read_b64_tr_b16 v[36:37], v10 offset:10304
    ds_read_b64_tr_b16 v[38:39], v10 offset:15424
    v_mfma_f32_16x16x32_bf16 v[64:67], v[16:19], a[128:131], v[64:67]
    s_add_u32 s6, s6, 4096
    s_add_u32 m0, s34, 4096
    v_mfma_f32_16x16x32_bf16 v[64:67], v[20:23], a[160:163], v[64:67]
    buffer_load_dwordx4 v3, s[48:51], s6 offen sc1 lds
    v_mfma_f32_16x16x32_bf16 v[68:71], v[20:23], a[164:167], v[68:71]
    s_lshl_b32 s3, s33, 2
    v_mfma_f32_16x16x32_bf16 v[68:71], v[16:19], a[132:135], v[68:71]
    buffer_load_dwordx4 a[28:31], v63, s[48:51], s7 offen sc1
    v_mfma_f32_16x16x32_bf16 v[72:75], v[16:19], a[136:139], v[72:75]
    s_add_u32 s3, s3, s30
    ds_read_b64_tr_b16 v[40:41], v11 offset:64
    ds_read_b64_tr_b16 v[42:43], v11 offset:5184
    v_mfma_f32_16x16x32_bf16 v[72:75], v[20:23], a[168:171], v[72:75]
    s_mul_i32 s3, s3, 81920
    v_mfma_f32_16x16x32_bf16 v[76:79], v[20:23], a[172:175], v[76:79]
    s_add_u32 s35, s35, s3
    v_mfma_f32_16x16x32_bf16 v[76:79], v[16:19], a[140:143], v[76:79]
    s_mul_i32 s3, s32, 5120
    ds_read_b64_tr_b16 v[44:45], v11 offset:10304
    ds_read_b64_tr_b16 v[46:47], v11 offset:15424
    v_mfma_f32_16x16x32_bf16 v[92:95], v[24:27], a[140:143], v[92:95]
    s_add_u32 s35, s35, s3
    v_mfma_f32_16x16x32_bf16 v[92:95], v[28:31], a[172:175], v[92:95]
    s_add_u32 s35, s35, 50331648
    v_mfma_f32_16x16x32_bf16 v[88:91], v[28:31], a[168:171], v[88:91]
    buffer_load_dwordx4 a[48:51], v60, s[48:51], s7 offen offset:1024 sc1
    v_mfma_f32_16x16x32_bf16 v[88:91], v[24:27], a[136:139], v[88:91]
    s_add_u32 s66, s32, 0
    v_mfma_f32_16x16x32_bf16 v[84:87], v[24:27], a[132:135], v[84:87]
    s_and_b32 s66, s66, 3
    ds_read_b64_tr_b16 v[16:17], v10 offset:128
    ds_read_b64_tr_b16 v[18:19], v10 offset:5248
    v_mfma_f32_16x16x32_bf16 v[84:87], v[28:31], a[164:167], v[84:87]
    s_add_u32 s6, s6, 4096
    s_add_u32 m0, s34, 8192
    v_mfma_f32_16x16x32_bf16 v[80:83], v[28:31], a[160:163], v[80:83]
    buffer_load_dwordx4 v3, s[48:51], s6 offen sc1 lds
    v_mfma_f32_16x16x32_bf16 v[80:83], v[24:27], a[128:131], v[80:83]
    s_waitcnt lgkmcnt(2)
    s_mul_i32 s66, s66, 20480
    ds_read_b64_tr_b16 v[20:21], v10 offset:10368
    ds_read_b64_tr_b16 v[22:23], v10 offset:15488
    v_mfma_f32_16x16x32_bf16 v[96:99], v[32:35], a[128:131], v[96:99]
    s_add_u32 s66, s66, s35
    v_mfma_f32_16x16x32_bf16 v[96:99], v[36:39], a[160:163], v[96:99]
    buffer_load_dwordx4 a[52:55], v61, s[48:51], s7 offen offset:1024 sc1
    v_mfma_f32_16x16x32_bf16 v[100:103], v[36:39], a[164:167], v[100:103]
    s_add_u32 s67, s32, 1
    v_mfma_f32_16x16x32_bf16 v[100:103], v[32:35], a[132:135], v[100:103]
    s_and_b32 s67, s67, 3
    v_mfma_f32_16x16x32_bf16 v[104:107], v[32:35], a[136:139], v[104:107]
    s_mul_i32 s67, s67, 20480
    ds_read_b64_tr_b16 v[24:25], v11 offset:128
    ds_read_b64_tr_b16 v[26:27], v11 offset:5248
    v_mfma_f32_16x16x32_bf16 v[104:107], v[36:39], a[168:171], v[104:107]
    s_add_u32 s67, s67, s35
    v_mfma_f32_16x16x32_bf16 v[108:111], v[36:39], a[172:175], v[108:111]
    s_add_u32 s68, s32, 2
    v_mfma_f32_16x16x32_bf16 v[108:111], v[32:35], a[140:143], v[108:111]
    s_and_b32 s68, s68, 3
    ds_read_b64_tr_b16 v[28:29], v11 offset:10368
    ds_read_b64_tr_b16 v[30:31], v11 offset:15488
    v_mfma_f32_16x16x32_bf16 v[124:127], v[40:43], a[140:143], v[124:127]
    buffer_load_dwordx4 a[56:59], v62, s[48:51], s7 offen offset:1024 sc1
    v_mfma_f32_16x16x32_bf16 v[124:127], v[44:47], a[172:175], v[124:127]
    s_mul_i32 s68, s68, 20480
    v_mfma_f32_16x16x32_bf16 v[120:123], v[44:47], a[168:171], v[120:123]
    s_add_u32 s68, s68, s35
    v_mfma_f32_16x16x32_bf16 v[120:123], v[40:43], a[136:139], v[120:123]
    s_add_u32 s69, s32, 3
    v_mfma_f32_16x16x32_bf16 v[116:119], v[40:43], a[132:135], v[116:119]
    s_and_b32 s69, s69, 3
    ds_read_b64_tr_b16 v[32:33], v10 offset:192
    ds_read_b64_tr_b16 v[34:35], v10 offset:5312
    v_mfma_f32_16x16x32_bf16 v[116:119], v[44:47], a[164:167], v[116:119]
    s_add_u32 s6, s6, 4096
    s_add_u32 m0, s34, 12288
    v_mfma_f32_16x16x32_bf16 v[112:115], v[44:47], a[160:163], v[112:115]
    buffer_load_dwordx4 v3, s[48:51], s6 offen sc1 lds
    v_mfma_f32_16x16x32_bf16 v[112:115], v[40:43], a[128:131], v[112:115]
    s_nop 0
    s_waitcnt lgkmcnt(2)
    s_mul_i32 s69, s69, 20480
    ds_read_b64_tr_b16 v[36:37], v10 offset:10432
    ds_read_b64_tr_b16 v[38:39], v10 offset:15552
    v_mfma_f32_16x16x32_bf16 v[128:131], v[16:19], a[128:131], v[128:131]
    buffer_load_dwordx4 a[60:63], v63, s[48:51], s7 offen offset:1024 sc1
    v_mfma_f32_16x16x32_bf16 v[128:131], v[20:23], a[160:163], v[128:131]
    s_add_u32 s69, s69, s35
    v_mfma_f32_16x16x32_bf16 v[132:135], v[20:23], a[164:167], v[132:135]
    s_mov_b32 s40, s24
    v_mfma_f32_16x16x32_bf16 v[132:135], v[16:19], a[132:135], v[132:135]
    s_and_b32 s41, s25, 0xffff
    v_mfma_f32_16x16x32_bf16 v[136:139], v[16:19], a[136:139], v[136:139]
    s_mov_b32 s42, 2621440
    ds_read_b64_tr_b16 v[40:41], v11 offset:192
    ds_read_b64_tr_b16 v[42:43], v11 offset:5312
    v_mfma_f32_16x16x32_bf16 v[136:139], v[20:23], a[168:171], v[136:139]
    s_mov_b32 s43, 0x00020000
    v_mfma_f32_16x16x32_bf16 v[140:143], v[20:23], a[172:175], v[140:143]
    s_lshl_b32 s60, s31, 2
    v_mfma_f32_16x16x32_bf16 v[140:143], v[16:19], a[140:143], v[140:143]
    s_add_u32 s60, s60, s32
    ds_read_b64_tr_b16 v[44:45], v11 offset:10432
    ds_read_b64_tr_b16 v[46:47], v11 offset:15552
    v_mfma_f32_16x16x32_bf16 v[156:159], v[24:27], a[140:143], v[156:159]
    buffer_load_dwordx4 a[80:83], v60, s[48:51], s7 offen offset:2048 sc1
    v_mfma_f32_16x16x32_bf16 v[156:159], v[28:31], a[172:175], v[156:159]
    s_lshl_b32 s60, s60, 2
    v_mfma_f32_16x16x32_bf16 v[152:155], v[28:31], a[168:171], v[152:155]
    s_add_u32 s6, s6, 4096
    s_add_u32 m0, s34, 16384
    v_mfma_f32_16x16x32_bf16 v[152:155], v[24:27], a[136:139], v[152:155]
    buffer_load_dwordx4 v3, s[48:51], s6 offen sc1 lds
    v_mfma_f32_16x16x32_bf16 v[148:151], v[24:27], a[132:135], v[148:151]
    s_add_u32 s60, s60, s30
    ds_read_b64_tr_b16 v[16:17], v10 offset:256
    ds_read_b64_tr_b16 v[18:19], v10 offset:5376
    v_mfma_f32_16x16x32_bf16 v[148:151], v[28:31], a[164:167], v[148:151]
    s_mul_i32 s60, s60, 20480
    v_mfma_f32_16x16x32_bf16 v[144:147], v[28:31], a[160:163], v[144:147]
    s_add_u32 s60, s60, 6291456
    v_mfma_f32_16x16x32_bf16 v[144:147], v[24:27], a[128:131], v[144:147]
    s_waitcnt lgkmcnt(2)
    s_lshr_b32 s3, s33, 1
    ds_read_b64_tr_b16 v[20:21], v10 offset:10496
    ds_read_b64_tr_b16 v[22:23], v10 offset:15616
    v_mfma_f32_16x16x32_bf16 v[160:163], v[32:35], a[128:131], v[160:163]
    buffer_load_dwordx4 a[84:87], v61, s[48:51], s7 offen offset:2048 sc1
    v_mfma_f32_16x16x32_bf16 v[160:163], v[36:39], a[160:163], v[160:163]
    s_mul_i32 s3, s3, 5120
    v_mfma_f32_16x16x32_bf16 v[164:167], v[36:39], a[164:167], v[164:167]
    s_add_u32 s60, s60, s3
    v_mfma_f32_16x16x32_bf16 v[164:167], v[32:35], a[132:135], v[164:167]
    s_and_b32 s3, s33, 1
    v_mfma_f32_16x16x32_bf16 v[168:171], v[32:35], a[136:139], v[168:171]
    s_lshl_b32 s35, s3, 3
    ds_read_b64_tr_b16 v[24:25], v11 offset:256
    ds_read_b64_tr_b16 v[26:27], v11 offset:5376
    v_mfma_f32_16x16x32_bf16 v[168:171], v[36:39], a[168:171], v[168:171]
    s_add_u32 s61, s60, s35
    v_mfma_f32_16x16x32_bf16 v[172:175], v[36:39], a[172:175], v[172:175]
    buffer_load_dwordx4 a[88:91], v62, s[48:51], s7 offen offset:2048 sc1
    v_mfma_f32_16x16x32_bf16 v[172:175], v[32:35], a[140:143], v[172:175]
    s_add_u32 s61, s61, 4096
    ds_read_b64_tr_b16 v[28:29], v11 offset:10496
    ds_read_b64_tr_b16 v[30:31], v11 offset:15616
    v_mfma_f32_16x16x32_bf16 v[188:191], v[40:43], a[140:143], v[188:191]
    s_lshl_b32 s3, s3, 11
    v_mfma_f32_16x16x32_bf16 v[188:191], v[44:47], a[172:175], v[188:191]
    s_add_u32 s60, s60, s3
    v_mfma_f32_16x16x32_bf16 v[184:187], v[44:47], a[168:171], v[184:187]
    s_add_u32 s6, s6, 4096
    s_add_u32 m0, s34, 20480
    v_mfma_f32_16x16x32_bf16 v[184:187], v[40:43], a[136:139], v[184:187]
    buffer_load_dwordx4 v3, s[48:51], s6 offen sc1 lds
    v_mfma_f32_16x16x32_bf16 v[180:183], v[40:43], a[132:135], v[180:183]
    s_lshl_b32 s80, s31, 2
    ds_read_b64_tr_b16 v[32:33], v10 offset:20480
    ds_read_b64_tr_b16 v[34:35], v10 offset:25600
    s_nop 0
    v_mfma_f32_16x16x32_bf16 v[180:183], v[44:47], a[164:167], v[180:183]
    buffer_load_dwordx4 a[92:95], v63, s[48:51], s7 offen offset:2048 sc1
    v_mfma_f32_16x16x32_bf16 v[176:179], v[44:47], a[160:163], v[176:179]
    s_add_u32 s80, s80, s32
    v_mfma_f32_16x16x32_bf16 v[176:179], v[40:43], a[128:131], v[176:179]
    s_waitcnt lgkmcnt(2)
    s_lshl_b32 s80, s80, 2
    ds_read_b64_tr_b16 v[36:37], v10 offset:30720
    ds_read_b64_tr_b16 v[38:39], v10 offset:35840
    v_mfma_f32_16x16x32_bf16 v[192:195], v[16:19], a[128:131], v[192:195]
    s_add_u32 s80, s80, s30
    v_mfma_f32_16x16x32_bf16 v[192:195], v[20:23], a[160:163], v[192:195]
    s_mul_i32 s80, s80, 20480
    v_mfma_f32_16x16x32_bf16 v[196:199], v[20:23], a[164:167], v[196:199]
    s_mul_i32 s3, s33, 160
    v_mfma_f32_16x16x32_bf16 v[196:199], v[16:19], a[132:135], v[196:199]
    s_add_u32 s80, s80, s3
    v_mfma_f32_16x16x32_bf16 v[200:203], v[16:19], a[136:139], v[200:203]
    s_lshr_b32 s81, s33, 1
    ds_read_b64_tr_b16 v[40:41], v11 offset:20480
    ds_read_b64_tr_b16 v[42:43], v11 offset:25600
    v_mfma_f32_16x16x32_bf16 v[200:203], v[20:23], a[168:171], v[200:203]
    buffer_load_dwordx4 a[112:115], v60, s[48:51], s7 offen offset:3072 sc1
    v_mfma_f32_16x16x32_bf16 v[204:207], v[20:23], a[172:175], v[204:207]
    s_lshl_b32 s82, s31, 2
    v_mfma_f32_16x16x32_bf16 v[204:207], v[16:19], a[140:143], v[204:207]
    s_add_u32 s82, s82, s81
    ds_read_b64_tr_b16 v[44:45], v11 offset:30720
    ds_read_b64_tr_b16 v[46:47], v11 offset:35840
    v_mfma_f32_16x16x32_bf16 v[220:223], v[24:27], a[140:143], v[220:223]
    s_lshl_b32 s82, s82, 8
    v_mfma_f32_16x16x32_bf16 v[220:223], v[28:31], a[172:175], v[220:223]
    s_nop 0
    s_add_u32 s6, s6, 4096
    s_add_u32 m0, s34, 24576
    v_mfma_f32_16x16x32_bf16 v[216:219], v[28:31], a[168:171], v[216:219]
    buffer_load_dwordx4 v3, s[48:51], s6 offen sc1 lds
    v_mfma_f32_16x16x32_bf16 v[216:219], v[24:27], a[136:139], v[216:219]
    s_add_u32 s82, s82, 79716352
    v_mfma_f32_16x16x32_bf16 v[212:215], v[24:27], a[132:135], v[212:215]
    s_lshl_b32 s78, s31, 2
    ds_read_b64_tr_b16 v[16:17], v10 offset:20544
    ds_read_b64_tr_b16 v[18:19], v10 offset:25664
    v_mfma_f32_16x16x32_bf16 v[212:215], v[28:31], a[164:167], v[212:215]
    buffer_load_dwordx4 a[116:119], v61, s[48:51], s7 offen offset:3072 sc1
    v_mfma_f32_16x16x32_bf16 v[208:211], v[28:31], a[160:163], v[208:211]
    s_add_u32 s78, s78, s32
    v_mfma_f32_16x16x32_bf16 v[208:211], v[24:27], a[128:131], v[208:211]
    s_waitcnt vmcnt(19) lgkmcnt(2)
    s_lshl_b32 s78, s78, 2
    ds_read_b64_tr_b16 v[20:21], v10 offset:30784
    ds_read_b64_tr_b16 v[22:23], v10 offset:35904
    v_mfma_f32_16x16x32_bf16 v[64:67], v[32:35], a[16:19], v[64:67]
    s_waitcnt vmcnt(14)
    s_add_u32 s78, s78, s30
    v_mfma_f32_16x16x32_bf16 v[64:67], v[36:39], a[48:51], v[64:67]
    s_nop 0
    s_waitcnt vmcnt(12)
    s_mul_i32 s78, s78, 20480
    v_mfma_f32_16x16x32_bf16 v[68:71], v[36:39], a[52:55], v[68:71]
    s_add_u32 s78, s78, 50331648
    v_mfma_f32_16x16x32_bf16 v[68:71], v[32:35], a[20:23], v[68:71]
    buffer_load_dwordx4 a[120:123], v62, s[48:51], s7 offen offset:3072 sc1
    v_mfma_f32_16x16x32_bf16 v[72:75], v[32:35], a[24:27], v[72:75]
    s_waitcnt vmcnt(12)
    s_lshr_b32 s3, s33, 1
    ds_read_b64_tr_b16 v[24:25], v11 offset:20544
    ds_read_b64_tr_b16 v[26:27], v11 offset:25664
    v_mfma_f32_16x16x32_bf16 v[72:75], v[36:39], a[56:59], v[72:75]
    s_waitcnt vmcnt(10)
    s_nop 0
    s_mul_i32 s3, s3, 5120
    v_mfma_f32_16x16x32_bf16 v[76:79], v[36:39], a[60:63], v[76:79]
    s_add_u32 s78, s78, s3
    v_mfma_f32_16x16x32_bf16 v[76:79], v[32:35], a[28:31], v[76:79]
    s_and_b32 s3, s33, 1
    ds_read_b64_tr_b16 v[28:29], v11 offset:30784
    ds_read_b64_tr_b16 v[30:31], v11 offset:35904
    v_mfma_f32_16x16x32_bf16 v[92:95], v[40:43], a[28:31], v[92:95]
    s_add_u32 s6, s6, 4096
    s_add_u32 m0, s34, 28672
    v_mfma_f32_16x16x32_bf16 v[92:95], v[44:47], a[60:63], v[92:95]
    buffer_load_dwordx4 v3, s[48:51], s6 offen sc1 lds
    v_mfma_f32_16x16x32_bf16 v[88:91], v[44:47], a[56:59], v[88:91]
    s_lshl_b32 s35, s3, 3
    v_mfma_f32_16x16x32_bf16 v[88:91], v[40:43], a[24:27], v[88:91]
    buffer_load_dwordx4 a[124:127], v63, s[48:51], s7 offen offset:3072 sc1
    v_mfma_f32_16x16x32_bf16 v[84:87], v[40:43], a[20:23], v[84:87]
    s_add_u32 s79, s78, s35
    ds_read_b64_tr_b16 v[32:33], v10 offset:20608
    ds_read_b64_tr_b16 v[34:35], v10 offset:25728
    v_mfma_f32_16x16x32_bf16 v[84:87], v[44:47], a[52:55], v[84:87]
    s_add_u32 s79, s79, 4096
    v_mfma_f32_16x16x32_bf16 v[80:83], v[44:47], a[48:51], v[80:83]
    s_lshl_b32 s3, s3, 11
    v_mfma_f32_16x16x32_bf16 v[80:83], v[40:43], a[16:19], v[80:83]
    s_waitcnt lgkmcnt(2)
    s_add_u32 s78, s78, s3
    ds_read_b64_tr_b16 v[36:37], v10 offset:30848
    ds_read_b64_tr_b16 v[38:39], v10 offset:35968
    v_mfma_f32_16x16x32_bf16 v[96:99], v[16:19], a[16:19], v[96:99]
    s_and_b32 s3, s33, 1
    v_mfma_f32_16x16x32_bf16 v[96:99], v[20:23], a[48:51], v[96:99]
    s_add_u32 s7, s7, 4096
    v_mfma_f32_16x16x32_bf16 v[100:103], v[20:23], a[52:55], v[100:103]
    buffer_load_dwordx4 a[144:147], v60, s[48:51], s7 offen sc1
    v_mfma_f32_16x16x32_bf16 v[100:103], v[16:19], a[20:23], v[100:103]
    s_mul_i32 s3, s3, 504
    v_mfma_f32_16x16x32_bf16 v[104:107], v[16:19], a[24:27], v[104:107]
    s_add_u32 s79, s79, s3
    ds_read_b64_tr_b16 v[40:41], v11 offset:20608
    ds_read_b64_tr_b16 v[42:43], v11 offset:25728
    v_mfma_f32_16x16x32_bf16 v[104:107], v[20:23], a[56:59], v[104:107]
    s_mov_b32 s83, 0
    v_mfma_f32_16x16x32_bf16 v[108:111], v[20:23], a[60:63], v[108:111]
    s_mov_b32 s14, 0xbfb8aa3b
    v_mfma_f32_16x16x32_bf16 v[108:111], v[16:19], a[28:31], v[108:111]
    s_mov_b32 s15, 0xbfb8aa3b
    ds_read_b64_tr_b16 v[44:45], v11 offset:30848
    ds_read_b64_tr_b16 v[46:47], v11 offset:35968
    v_mfma_f32_16x16x32_bf16 v[124:127], v[24:27], a[28:31], v[124:127]
    s_add_u32 s6, s6, 4096
    s_add_u32 m0, s34, 32768
    v_mfma_f32_16x16x32_bf16 v[124:127], v[28:31], a[60:63], v[124:127]
    buffer_load_dwordx4 v3, s[48:51], s6 offen sc1 lds
    v_mfma_f32_16x16x32_bf16 v[120:123], v[28:31], a[56:59], v[120:123]
    s_mov_b32 s62, 0x00003f80
    v_mfma_f32_16x16x32_bf16 v[120:123], v[24:27], a[24:27], v[120:123]
    buffer_load_dwordx4 a[148:151], v61, s[48:51], s7 offen sc1
    v_mfma_f32_16x16x32_bf16 v[116:119], v[24:27], a[20:23], v[116:119]
    s_mov_b32 s63, 0x3f800000
    ds_read_b64_tr_b16 v[16:17], v10 offset:20672
    ds_read_b64_tr_b16 v[18:19], v10 offset:25792
    v_mfma_f32_16x16x32_bf16 v[116:119], v[28:31], a[52:55], v[116:119]
    s_lshr_b32 s10, s2, 3
    v_mfma_f32_16x16x32_bf16 v[112:115], v[28:31], a[48:51], v[112:115]
    s_lshl_b32 s10, s10, 8
    v_mfma_f32_16x16x32_bf16 v[112:115], v[24:27], a[16:19], v[112:115]
    s_waitcnt lgkmcnt(2)
    s_add_u32 s10, s10, 79716352
    ds_read_b64_tr_b16 v[20:21], v10 offset:30912
    ds_read_b64_tr_b16 v[22:23], v10 offset:36032
    v_mfma_f32_16x16x32_bf16 v[128:131], v[32:35], a[16:19], v[128:131]
    buffer_load_dwordx4 a[152:155], v62, s[48:51], s7 offen sc1
    v_mfma_f32_16x16x32_bf16 v[128:131], v[36:39], a[48:51], v[128:131]
    s_lshl_b32 s35, s31, 2
    v_mfma_f32_16x16x32_bf16 v[132:135], v[36:39], a[52:55], v[132:135]
    s_add_u32 s10, s10, s35
    v_mfma_f32_16x16x32_bf16 v[132:135], v[32:35], a[20:23], v[132:135]
    v_mfma_f32_16x16x32_bf16 v[136:139], v[32:35], a[24:27], v[136:139]
    ds_read_b64_tr_b16 v[24:25], v11 offset:20672
    ds_read_b64_tr_b16 v[26:27], v11 offset:25792
    v_mfma_f32_16x16x32_bf16 v[136:139], v[36:39], a[56:59], v[136:139]
    v_mfma_f32_16x16x32_bf16 v[140:143], v[36:39], a[60:63], v[140:143]
    v_mfma_f32_16x16x32_bf16 v[140:143], v[32:35], a[28:31], v[140:143]
    ds_read_b64_tr_b16 v[28:29], v11 offset:30912
    ds_read_b64_tr_b16 v[30:31], v11 offset:36032
    v_mfma_f32_16x16x32_bf16 v[156:159], v[40:43], a[28:31], v[156:159]
    buffer_load_dwordx4 a[156:159], v63, s[48:51], s7 offen sc1
    v_mfma_f32_16x16x32_bf16 v[156:159], v[44:47], a[60:63], v[156:159]
    s_add_u32 s6, s6, 4096
    s_add_u32 m0, s34, 36864
    v_mfma_f32_16x16x32_bf16 v[152:155], v[44:47], a[56:59], v[152:155]
    buffer_load_dwordx4 v3, s[48:51], s6 offen sc1 lds
    v_mfma_f32_16x16x32_bf16 v[152:155], v[40:43], a[24:27], v[152:155]
    v_mfma_f32_16x16x32_bf16 v[148:151], v[40:43], a[20:23], v[148:151]
    s_add_u32 m0, s34, 122880
    ds_read_b64_tr_b16 v[32:33], v10 offset:20736
    ds_read_b64_tr_b16 v[34:35], v10 offset:25856
    v_mfma_f32_16x16x32_bf16 v[148:151], v[44:47], a[52:55], v[148:151]
    buffer_load_dwordx4 v3, s[48:51], s8 offen sc1 lds
    v_mfma_f32_16x16x32_bf16 v[144:147], v[44:47], a[48:51], v[144:147]
    s_nop 0
    v_mfma_f32_16x16x32_bf16 v[144:147], v[40:43], a[16:19], v[144:147]
    s_waitcnt lgkmcnt(2)
    ds_read_b64_tr_b16 v[36:37], v10 offset:30976
    ds_read_b64_tr_b16 v[38:39], v10 offset:36096
    v_mfma_f32_16x16x32_bf16 v[160:163], v[16:19], a[16:19], v[160:163]
    buffer_load_dwordx4 a[176:179], v60, s[48:51], s7 offen offset:1024 sc1
    v_mfma_f32_16x16x32_bf16 v[160:163], v[20:23], a[48:51], v[160:163]
    v_mfma_f32_16x16x32_bf16 v[164:167], v[20:23], a[52:55], v[164:167]
    ds_read_b64_tr_b16 v[40:41], v11 offset:20736
    ds_read_b64_tr_b16 v[42:43], v11 offset:25856
    v_mfma_f32_16x16x32_bf16 v[164:167], v[16:19], a[20:23], v[164:167]
    v_mfma_f32_16x16x32_bf16 v[168:171], v[16:19], a[24:27], v[168:171]
    v_mfma_f32_16x16x32_bf16 v[168:171], v[20:23], a[56:59], v[168:171]
    ds_read_b64_tr_b16 v[44:45], v11 offset:30976
    ds_read_b64_tr_b16 v[46:47], v11 offset:36096
    v_mfma_f32_16x16x32_bf16 v[172:175], v[20:23], a[60:63], v[172:175]
    buffer_load_dwordx4 a[180:183], v61, s[48:51], s7 offen offset:1024 sc1
    v_mfma_f32_16x16x32_bf16 v[172:175], v[16:19], a[28:31], v[172:175]
    v_mfma_f32_16x16x32_bf16 v[188:191], v[24:27], a[28:31], v[188:191]
    v_mfma_f32_16x16x32_bf16 v[188:191], v[28:31], a[60:63], v[188:191]
    v_mfma_f32_16x16x32_bf16 v[184:187], v[28:31], a[56:59], v[184:187]
    v_mfma_f32_16x16x32_bf16 v[184:187], v[24:27], a[24:27], v[184:187]
    v_mfma_f32_16x16x32_bf16 v[180:183], v[24:27], a[20:23], v[180:183]
    s_waitcnt lgkmcnt(0)
    s_barrier
    v_mfma_f32_16x16x32_bf16 v[180:183], v[28:31], a[52:55], v[180:183]
    ds_read_b64_tr_b16 v[16:17], v12 offset:0
    ds_read_b64_tr_b16 v[18:19], v12 offset:5120
    v_mfma_f32_16x16x32_bf16 v[176:179], v[28:31], a[48:51], v[176:179]
    buffer_load_dwordx4 a[184:187], v62, s[48:51], s7 offen offset:1024 sc1
    v_mfma_f32_16x16x32_bf16 v[176:179], v[24:27], a[16:19], v[176:179]
    ds_read_b64_tr_b16 v[20:21], v12 offset:10240
    ds_read_b64_tr_b16 v[22:23], v12 offset:15360
    v_mfma_f32_16x16x32_bf16 v[192:195], v[32:35], a[16:19], v[192:195]
    s_add_u32 s8, s8, 4096
    s_add_u32 m0, s34, 126976
    v_mfma_f32_16x16x32_bf16 v[192:195], v[36:39], a[48:51], v[192:195]
    buffer_load_dwordx4 v3, s[48:51], s8 offen sc1 lds
    v_mfma_f32_16x16x32_bf16 v[196:199], v[36:39], a[52:55], v[196:199]
    s_cmp_le_u32 s32, 2
    s_cselect_b32 s6, 3, 2
    s_mul_i32 s6, s6, 61440
    s_add_u32 s6, s6, s70
    s_add_u32 m0, s34, 40960
    v_mfma_f32_16x16x32_bf16 v[196:199], v[32:35], a[20:23], v[196:199]
    s_nop 0
    buffer_load_dwordx4 v3, s[48:51], s6 offen sc1 lds
    v_mfma_f32_16x16x32_bf16 v[200:203], v[32:35], a[24:27], v[200:203]
    ds_read_b64_tr_b16 v[24:25], v13 offset:0
    ds_read_b64_tr_b16 v[26:27], v13 offset:5120
    v_mfma_f32_16x16x32_bf16 v[200:203], v[36:39], a[56:59], v[200:203]
    buffer_load_dwordx4 a[188:191], v63, s[48:51], s7 offen offset:1024 sc1
    v_mfma_f32_16x16x32_bf16 v[204:207], v[36:39], a[60:63], v[204:207]
    v_mfma_f32_16x16x32_bf16 v[204:207], v[32:35], a[28:31], v[204:207]
    ds_read_b64_tr_b16 v[28:29], v13 offset:10240
    ds_read_b64_tr_b16 v[30:31], v13 offset:15360
    v_mfma_f32_16x16x32_bf16 v[220:223], v[40:43], a[28:31], v[220:223]
    v_mfma_f32_16x16x32_bf16 v[220:223], v[44:47], a[60:63], v[220:223]
    v_mfma_f32_16x16x32_bf16 v[216:219], v[44:47], a[56:59], v[216:219]
    v_mfma_f32_16x16x32_bf16 v[216:219], v[40:43], a[24:27], v[216:219]
    v_mfma_f32_16x16x32_bf16 v[212:215], v[40:43], a[20:23], v[212:215]
    ds_read_b64_tr_b16 v[32:33], v12 offset:64
    ds_read_b64_tr_b16 v[34:35], v12 offset:5184
    v_mfma_f32_16x16x32_bf16 v[212:215], v[44:47], a[52:55], v[212:215]
    s_add_u32 s6, s6, 4096
    s_add_u32 m0, s34, 45056
    v_mfma_f32_16x16x32_bf16 v[208:211], v[44:47], a[48:51], v[208:211]
    buffer_load_dwordx4 v3, s[48:51], s6 offen sc1 lds
    v_mfma_f32_16x16x32_bf16 v[208:211], v[40:43], a[16:19], v[208:211]
    s_waitcnt vmcnt(25) lgkmcnt(2)
    ds_read_b64_tr_b16 v[36:37], v12 offset:10304
    ds_read_b64_tr_b16 v[38:39], v12 offset:15424
    v_mfma_f32_16x16x32_bf16 v[64:67], v[16:19], a[80:83], v[64:67]
    s_waitcnt vmcnt(19)
    s_add_u32 s8, s8, 4096
    s_add_u32 m0, s34, 131072
    v_mfma_f32_16x16x32_bf16 v[64:67], v[20:23], a[112:115], v[64:67]
    s_waitcnt vmcnt(17)
    buffer_load_dwordx4 v3, s[48:51], s8 offen sc1 lds
    v_mfma_f32_16x16x32_bf16 v[68:71], v[20:23], a[116:119], v[68:71]
    s_cmp_le_u32 s32, 1
    s_cselect_b32 s7, 2, 1
    s_mul_i32 s7, s7, 6144
    s_add_u32 s7, s7, s72
    v_mfma_f32_16x16x32_bf16 v[68:71], v[16:19], a[84:87], v[68:71]
    buffer_load_dwordx4 a[16:19], v60, s[48:51], s7 offen sc1
    v_mfma_f32_16x16x32_bf16 v[72:75], v[16:19], a[88:91], v[72:75]
    s_waitcnt vmcnt(18)
    ds_read_b64_tr_b16 v[40:41], v13 offset:64
    s_nop 0
    ds_read_b64_tr_b16 v[42:43], v13 offset:5184
    v_mfma_f32_16x16x32_bf16 v[72:75], v[20:23], a[120:123], v[72:75]
    s_waitcnt vmcnt(16)
    v_mfma_f32_16x16x32_bf16 v[76:79], v[20:23], a[124:127], v[76:79]
    s_nop 0
    v_mfma_f32_16x16x32_bf16 v[76:79], v[16:19], a[92:95], v[76:79]
    ds_read_b64_tr_b16 v[44:45], v13 offset:10304
    ds_read_b64_tr_b16 v[46:47], v13 offset:15424
    v_mfma_f32_16x16x32_bf16 v[92:95], v[24:27], a[92:95], v[92:95]
    v_mfma_f32_16x16x32_bf16 v[92:95], v[28:31], a[124:127], v[92:95]
    v_mfma_f32_16x16x32_bf16 v[88:91], v[28:31], a[120:123], v[88:91]
    buffer_load_dwordx4 a[20:23], v61, s[48:51], s7 offen sc1
    v_mfma_f32_16x16x32_bf16 v[88:91], v[24:27], a[88:91], v[88:91]
    v_mfma_f32_16x16x32_bf16 v[84:87], v[24:27], a[84:87], v[84:87]
    ds_read_b64_tr_b16 v[16:17], v12 offset:128
    ds_read_b64_tr_b16 v[18:19], v12 offset:5248
    v_mfma_f32_16x16x32_bf16 v[84:87], v[28:31], a[116:119], v[84:87]
    s_add_u32 s6, s6, 4096
    s_add_u32 m0, s34, 49152
    v_mfma_f32_16x16x32_bf16 v[80:83], v[28:31], a[112:115], v[80:83]
    buffer_load_dwordx4 v3, s[48:51], s6 offen sc1 lds
    v_mfma_f32_16x16x32_bf16 v[80:83], v[24:27], a[80:83], v[80:83]
    s_waitcnt lgkmcnt(2)
    ds_read_b64_tr_b16 v[20:21], v12 offset:10368
    ds_read_b64_tr_b16 v[22:23], v12 offset:15488
    s_nop 0
    v_mfma_f32_16x16x32_bf16 v[96:99], v[32:35], a[80:83], v[96:99]
    s_add_u32 s8, s8, 4096
    s_add_u32 m0, s34, 135168
    v_mfma_f32_16x16x32_bf16 v[96:99], v[36:39], a[112:115], v[96:99]
    buffer_load_dwordx4 v3, s[48:51], s8 offen sc1 lds
    v_mfma_f32_16x16x32_bf16 v[100:103], v[36:39], a[116:119], v[100:103]
    v_mfma_f32_16x16x32_bf16 v[100:103], v[32:35], a[84:87], v[100:103]
    v_mfma_f32_16x16x32_bf16 v[104:107], v[32:35], a[88:91], v[104:107]
    ds_read_b64_tr_b16 v[24:25], v13 offset:128
    ds_read_b64_tr_b16 v[26:27], v13 offset:5248
    v_mfma_f32_16x16x32_bf16 v[104:107], v[36:39], a[120:123], v[104:107]
    buffer_load_dwordx4 a[24:27], v62, s[48:51], s7 offen sc1
    v_mfma_f32_16x16x32_bf16 v[108:111], v[36:39], a[124:127], v[108:111]
    v_mfma_f32_16x16x32_bf16 v[108:111], v[32:35], a[92:95], v[108:111]
    ds_read_b64_tr_b16 v[28:29], v13 offset:10368
    ds_read_b64_tr_b16 v[30:31], v13 offset:15488
    v_mfma_f32_16x16x32_bf16 v[124:127], v[40:43], a[92:95], v[124:127]
    v_mfma_f32_16x16x32_bf16 v[124:127], v[44:47], a[124:127], v[124:127]
    v_mfma_f32_16x16x32_bf16 v[120:123], v[44:47], a[120:123], v[120:123]
    v_mfma_f32_16x16x32_bf16 v[120:123], v[40:43], a[88:91], v[120:123]
    v_mfma_f32_16x16x32_bf16 v[116:119], v[40:43], a[84:87], v[116:119]
    ds_read_b64_tr_b16 v[32:33], v12 offset:192
    ds_read_b64_tr_b16 v[34:35], v12 offset:5312
    v_mfma_f32_16x16x32_bf16 v[116:119], v[44:47], a[116:119], v[116:119]
    s_add_u32 s6, s6, 4096
    s_add_u32 m0, s34, 53248
    v_mfma_f32_16x16x32_bf16 v[112:115], v[44:47], a[112:115], v[112:115]
    buffer_load_dwordx4 v3, s[48:51], s6 offen sc1 lds
    v_mfma_f32_16x16x32_bf16 v[112:115], v[40:43], a[80:83], v[112:115]
    s_waitcnt lgkmcnt(2)
    ds_read_b64_tr_b16 v[36:37], v12 offset:10432
    ds_read_b64_tr_b16 v[38:39], v12 offset:15552
    s_nop 0
    v_mfma_f32_16x16x32_bf16 v[128:131], v[16:19], a[80:83], v[128:131]
    buffer_load_dwordx4 a[28:31], v63, s[48:51], s7 offen sc1
    v_mfma_f32_16x16x32_bf16 v[128:131], v[20:23], a[112:115], v[128:131]
    s_add_u32 s8, s8, 4096
    s_add_u32 m0, s34, 139264
    v_mfma_f32_16x16x32_bf16 v[132:135], v[20:23], a[116:119], v[132:135]
    buffer_load_dwordx4 v3, s[48:51], s8 offen sc1 lds
    v_mfma_f32_16x16x32_bf16 v[132:135], v[16:19], a[84:87], v[132:135]
    v_mfma_f32_16x16x32_bf16 v[136:139], v[16:19], a[88:91], v[136:139]
    ds_read_b64_tr_b16 v[40:41], v13 offset:192
    ds_read_b64_tr_b16 v[42:43], v13 offset:5312
    v_mfma_f32_16x16x32_bf16 v[136:139], v[20:23], a[120:123], v[136:139]
    v_mfma_f32_16x16x32_bf16 v[140:143], v[20:23], a[124:127], v[140:143]
    v_mfma_f32_16x16x32_bf16 v[140:143], v[16:19], a[92:95], v[140:143]
    ds_read_b64_tr_b16 v[44:45], v13 offset:10432
    ds_read_b64_tr_b16 v[46:47], v13 offset:15552
    v_mfma_f32_16x16x32_bf16 v[156:159], v[24:27], a[92:95], v[156:159]
    buffer_load_dwordx4 a[48:51], v60, s[48:51], s7 offen offset:1024 sc1
    v_mfma_f32_16x16x32_bf16 v[156:159], v[28:31], a[124:127], v[156:159]
    v_mfma_f32_16x16x32_bf16 v[152:155], v[28:31], a[120:123], v[152:155]
    s_add_u32 s6, s6, 4096
    s_add_u32 m0, s34, 57344
    v_mfma_f32_16x16x32_bf16 v[152:155], v[24:27], a[88:91], v[152:155]
    buffer_load_dwordx4 v3, s[48:51], s6 offen sc1 lds
    v_mfma_f32_16x16x32_bf16 v[148:151], v[24:27], a[84:87], v[148:151]
    ds_read_b64_tr_b16 v[16:17], v12 offset:256
    ds_read_b64_tr_b16 v[18:19], v12 offset:5376
    v_mfma_f32_16x16x32_bf16 v[148:151], v[28:31], a[116:119], v[148:151]
    v_mfma_f32_16x16x32_bf16 v[144:147], v[28:31], a[112:115], v[144:147]
    s_nop 0
    v_mfma_f32_16x16x32_bf16 v[144:147], v[24:27], a[80:83], v[144:147]
    s_waitcnt lgkmcnt(2)
    ds_read_b64_tr_b16 v[20:21], v12 offset:10496
    ds_read_b64_tr_b16 v[22:23], v12 offset:15616
    v_mfma_f32_16x16x32_bf16 v[160:163], v[32:35], a[80:83], v[160:163]
    s_add_u32 s8, s8, 4096
    s_add_u32 m0, s34, 143360
    v_mfma_f32_16x16x32_bf16 v[160:163], v[36:39], a[112:115], v[160:163]
    buffer_load_dwordx4 v3, s[48:51], s8 offen sc1 lds
    v_mfma_f32_16x16x32_bf16 v[164:167], v[36:39], a[116:119], v[164:167]
    v_mfma_f32_16x16x32_bf16 v[164:167], v[32:35], a[84:87], v[164:167]
    buffer_load_dwordx4 a[52:55], v61, s[48:51], s7 offen offset:1024 sc1
    v_mfma_f32_16x16x32_bf16 v[168:171], v[32:35], a[88:91], v[168:171]
    ds_read_b64_tr_b16 v[24:25], v13 offset:256
    ds_read_b64_tr_b16 v[26:27], v13 offset:5376
    v_mfma_f32_16x16x32_bf16 v[168:171], v[36:39], a[120:123], v[168:171]
    v_mfma_f32_16x16x32_bf16 v[172:175], v[36:39], a[124:127], v[172:175]
    v_mfma_f32_16x16x32_bf16 v[172:175], v[32:35], a[92:95], v[172:175]
    ds_read_b64_tr_b16 v[28:29], v13 offset:10496
    ds_read_b64_tr_b16 v[30:31], v13 offset:15616
    v_mfma_f32_16x16x32_bf16 v[188:191], v[40:43], a[92:95], v[188:191]
    v_mfma_f32_16x16x32_bf16 v[188:191], v[44:47], a[124:127], v[188:191]
    v_mfma_f32_16x16x32_bf16 v[184:187], v[44:47], a[120:123], v[184:187]
    s_add_u32 s6, s6, 4096
    s_add_u32 m0, s34, 61440
    v_mfma_f32_16x16x32_bf16 v[184:187], v[40:43], a[88:91], v[184:187]
    buffer_load_dwordx4 v3, s[48:51], s6 offen sc1 lds
    v_mfma_f32_16x16x32_bf16 v[180:183], v[40:43], a[84:87], v[180:183]
    ds_read_b64_tr_b16 v[32:33], v12 offset:20480
    ds_read_b64_tr_b16 v[34:35], v12 offset:25600
    v_mfma_f32_16x16x32_bf16 v[180:183], v[44:47], a[116:119], v[180:183]
    buffer_load_dwordx4 a[56:59], v62, s[48:51], s7 offen offset:1024 sc1
    v_mfma_f32_16x16x32_bf16 v[176:179], v[44:47], a[112:115], v[176:179]
    s_nop 0
    v_mfma_f32_16x16x32_bf16 v[176:179], v[40:43], a[80:83], v[176:179]
    s_waitcnt lgkmcnt(2)
    ds_read_b64_tr_b16 v[36:37], v12 offset:30720
    ds_read_b64_tr_b16 v[38:39], v12 offset:35840
    v_mfma_f32_16x16x32_bf16 v[192:195], v[16:19], a[80:83], v[192:195]
    buffer_load_dword v7, v4, s[48:51], s77 offen sc1
    v_mfma_f32_16x16x32_bf16 v[192:195], v[20:23], a[112:115], v[192:195]
    s_add_u32 s8, s8, 4096
    s_add_u32 m0, s34, 147456
    v_mfma_f32_16x16x32_bf16 v[196:199], v[20:23], a[116:119], v[196:199]
    buffer_load_dwordx4 v3, s[48:51], s8 offen sc1 lds
    v_mfma_f32_16x16x32_bf16 v[196:199], v[16:19], a[84:87], v[196:199]
    v_mfma_f32_16x16x32_bf16 v[200:203], v[16:19], a[88:91], v[200:203]
    ds_read_b64_tr_b16 v[40:41], v13 offset:20480
    ds_read_b64_tr_b16 v[42:43], v13 offset:25600
    v_mfma_f32_16x16x32_bf16 v[200:203], v[20:23], a[120:123], v[200:203]
    buffer_load_dwordx4 a[60:63], v63, s[48:51], s7 offen offset:1024 sc1
    v_mfma_f32_16x16x32_bf16 v[204:207], v[20:23], a[124:127], v[204:207]
    v_mfma_f32_16x16x32_bf16 v[204:207], v[16:19], a[92:95], v[204:207]
    s_nop 0
    ds_read_b64_tr_b16 v[44:45], v13 offset:30720
    ds_read_b64_tr_b16 v[46:47], v13 offset:35840
    v_mfma_f32_16x16x32_bf16 v[220:223], v[24:27], a[92:95], v[220:223]
    s_cmp_le_u32 s32, 2
    s_cselect_b32 s17, 3, 2
    s_mul_i32 s17, s17, 6144
    s_add_u32 s17, s17, s72
    v_mfma_f32_16x16x32_bf16 v[220:223], v[28:31], a[124:127], v[220:223]
    buffer_load_dwordx4 a[0:3], v60, s[48:51], s17 offen sc1
    v_mfma_f32_16x16x32_bf16 v[216:219], v[28:31], a[120:123], v[216:219]
    s_add_u32 s6, s6, 4096
    s_add_u32 m0, s34, 65536
    v_mfma_f32_16x16x32_bf16 v[216:219], v[24:27], a[88:91], v[216:219]
    buffer_load_dwordx4 v3, s[48:51], s6 offen sc1 lds
    v_mfma_f32_16x16x32_bf16 v[212:215], v[24:27], a[84:87], v[212:215]
    ds_read_b64_tr_b16 v[16:17], v12 offset:20544
    ds_read_b64_tr_b16 v[18:19], v12 offset:25664
    v_mfma_f32_16x16x32_bf16 v[212:215], v[28:31], a[116:119], v[212:215]
    v_mfma_f32_16x16x32_bf16 v[208:211], v[28:31], a[112:115], v[208:211]
    s_nop 0
    v_mfma_f32_16x16x32_bf16 v[208:211], v[24:27], a[80:83], v[208:211]
    s_waitcnt vmcnt(33) lgkmcnt(2)
    ds_read_b64_tr_b16 v[20:21], v12 offset:30784
    ds_read_b64_tr_b16 v[22:23], v12 offset:35904
    v_mfma_f32_16x16x32_bf16 v[64:67], v[32:35], a[144:147], v[64:67]
    s_waitcnt vmcnt(26)
    buffer_load_dwordx4 a[4:7], v61, s[48:51], s17 offen sc1
    v_mfma_f32_16x16x32_bf16 v[64:67], v[36:39], a[176:179], v[64:67]
    s_waitcnt vmcnt(26)
    s_add_u32 s8, s8, 4096
    s_add_u32 m0, s34, 151552
    v_mfma_f32_16x16x32_bf16 v[68:71], v[36:39], a[180:183], v[68:71]
    buffer_load_dwordx4 v3, s[48:51], s8 offen sc1 lds
    v_mfma_f32_16x16x32_bf16 v[68:71], v[32:35], a[148:151], v[68:71]
    v_mfma_f32_16x16x32_bf16 v[72:75], v[32:35], a[152:155], v[72:75]
    s_waitcnt vmcnt(26)
    ds_read_b64_tr_b16 v[24:25], v13 offset:20544
    ds_read_b64_tr_b16 v[26:27], v13 offset:25664
    v_mfma_f32_16x16x32_bf16 v[72:75], v[36:39], a[184:187], v[72:75]
    s_waitcnt vmcnt(23)
    buffer_load_dwordx4 a[80:83], v60, s[48:51], s7 offen offset:2048 sc1
    v_mfma_f32_16x16x32_bf16 v[76:79], v[36:39], a[188:191], v[76:79]
    v_mfma_f32_16x16x32_bf16 v[76:79], v[32:35], a[156:159], v[76:79]
    ds_read_b64_tr_b16 v[28:29], v13 offset:30784
    ds_read_b64_tr_b16 v[30:31], v13 offset:35904
    v_mfma_f32_16x16x32_bf16 v[92:95], v[40:43], a[156:159], v[92:95]
    buffer_load_dwordx4 a[84:87], v61, s[48:51], s7 offen offset:2048 sc1
    v_mfma_f32_16x16x32_bf16 v[92:95], v[44:47], a[188:191], v[92:95]
    v_mfma_f32_16x16x32_bf16 v[88:91], v[44:47], a[184:187], v[88:91]
    buffer_load_dwordx4 a[8:11], v62, s[48:51], s17 offen sc1
    v_mfma_f32_16x16x32_bf16 v[88:91], v[40:43], a[152:155], v[88:91]
    v_mfma_f32_16x16x32_bf16 v[84:87], v[40:43], a[148:151], v[84:87]
    ds_read_b64_tr_b16 v[32:33], v12 offset:20608
    ds_read_b64_tr_b16 v[34:35], v12 offset:25728
    v_mfma_f32_16x16x32_bf16 v[84:87], v[44:47], a[180:183], v[84:87]
    s_add_u32 s6, s6, 4096
    s_add_u32 m0, s34, 69632
    v_mfma_f32_16x16x32_bf16 v[80:83], v[44:47], a[176:179], v[80:83]
    buffer_load_dwordx4 v3, s[48:51], s6 offen sc1 lds
    v_mfma_f32_16x16x32_bf16 v[80:83], v[40:43], a[144:147], v[80:83]
    s_waitcnt lgkmcnt(2)
    ds_read_b64_tr_b16 v[36:37], v12 offset:30848
    ds_read_b64_tr_b16 v[38:39], v12 offset:35968
    v_mfma_f32_16x16x32_bf16 v[96:99], v[16:19], a[144:147], v[96:99]
    s_nop 0
    v_mfma_f32_16x16x32_bf16 v[96:99], v[20:23], a[176:179], v[96:99]
    buffer_load_dwordx4 a[88:91], v62, s[48:51], s7 offen offset:2048 sc1
    v_mfma_f32_16x16x32_bf16 v[100:103], v[20:23], a[180:183], v[100:103]
    s_add_u32 s8, s8, 4096
    s_add_u32 m0, s34, 155648
    v_mfma_f32_16x16x32_bf16 v[100:103], v[16:19], a[148:151], v[100:103]
    buffer_load_dwordx4 v3, s[48:51], s8 offen sc1 lds
    v_mfma_f32_16x16x32_bf16 v[104:107], v[16:19], a[152:155], v[104:107]
    ds_read_b64_tr_b16 v[40:41], v13 offset:20608
    ds_read_b64_tr_b16 v[42:43], v13 offset:25728
    v_mfma_f32_16x16x32_bf16 v[104:107], v[20:23], a[184:187], v[104:107]
    buffer_load_dwordx4 a[12:15], v63, s[48:51], s17 offen sc1
    v_mfma_f32_16x16x32_bf16 v[108:111], v[20:23], a[188:191], v[108:111]
    v_mfma_f32_16x16x32_bf16 v[108:111], v[16:19], a[156:159], v[108:111]
    ds_read_b64_tr_b16 v[44:45], v13 offset:30848
    ds_read_b64_tr_b16 v[46:47], v13 offset:35968
    v_mfma_f32_16x16x32_bf16 v[124:127], v[24:27], a[156:159], v[124:127]
    s_add_u32 s6, s6, 4096
    s_add_u32 m0, s34, 73728
    v_mfma_f32_16x16x32_bf16 v[124:127], v[28:31], a[188:191], v[124:127]
    buffer_load_dwordx4 v3, s[48:51], s6 offen sc1 lds
    v_mfma_f32_16x16x32_bf16 v[120:123], v[28:31], a[184:187], v[120:123]
    v_mfma_f32_16x16x32_bf16 v[120:123], v[24:27], a[152:155], v[120:123]
    buffer_load_dwordx4 a[92:95], v63, s[48:51], s7 offen offset:2048 sc1
    v_mfma_f32_16x16x32_bf16 v[116:119], v[24:27], a[148:151], v[116:119]
    ds_read_b64_tr_b16 v[16:17], v12 offset:20672
    ds_read_b64_tr_b16 v[18:19], v12 offset:25792
    v_mfma_f32_16x16x32_bf16 v[116:119], v[28:31], a[180:183], v[116:119]
    buffer_load_dwordx4 a[32:35], v60, s[48:51], s17 offen offset:1024 sc1
    v_mfma_f32_16x16x32_bf16 v[112:115], v[28:31], a[176:179], v[112:115]
    s_nop 0
    v_mfma_f32_16x16x32_bf16 v[112:115], v[24:27], a[144:147], v[112:115]
    s_waitcnt lgkmcnt(2)
    ds_read_b64_tr_b16 v[20:21], v12 offset:30912
    ds_read_b64_tr_b16 v[22:23], v12 offset:36032
    v_mfma_f32_16x16x32_bf16 v[128:131], v[32:35], a[144:147], v[128:131]
    s_add_u32 s8, s8, 4096
    s_add_u32 m0, s34, 159744
    v_mfma_f32_16x16x32_bf16 v[128:131], v[36:39], a[176:179], v[128:131]
    buffer_load_dwordx4 v3, s[48:51], s8 offen sc1 lds
    v_mfma_f32_16x16x32_bf16 v[132:135], v[36:39], a[180:183], v[132:135]
    v_mfma_f32_16x16x32_bf16 v[132:135], v[32:35], a[148:151], v[132:135]
    s_nop 0
    v_mfma_f32_16x16x32_bf16 v[136:139], v[32:35], a[152:155], v[136:139]
    s_nop 0
    ds_read_b64_tr_b16 v[24:25], v13 offset:20672
    ds_read_b64_tr_b16 v[26:27], v13 offset:25792
    v_mfma_f32_16x16x32_bf16 v[136:139], v[36:39], a[184:187], v[136:139]
    buffer_load_dwordx4 a[112:115], v60, s[48:51], s7 offen offset:3072 sc1
    v_mfma_f32_16x16x32_bf16 v[140:143], v[36:39], a[188:191], v[140:143]
    s_nop 0
    v_mfma_f32_16x16x32_bf16 v[140:143], v[32:35], a[156:159], v[140:143]
    s_nop 0
    ds_read_b64_tr_b16 v[28:29], v13 offset:30912
    ds_read_b64_tr_b16 v[30:31], v13 offset:36032
    v_mfma_f32_16x16x32_bf16 v[156:159], v[40:43], a[156:159], v[156:159]
    buffer_load_dwordx4 a[36:39], v61, s[48:51], s17 offen offset:1024 sc1
    v_mfma_f32_16x16x32_bf16 v[156:159], v[44:47], a[188:191], v[156:159]
    s_add_u32 s6, s6, 4096
    s_add_u32 m0, s34, 77824
    v_mfma_f32_16x16x32_bf16 v[152:155], v[44:47], a[184:187], v[152:155]
    buffer_load_dwordx4 v3, s[48:51], s6 offen sc1 lds
    v_mfma_f32_16x16x32_bf16 v[152:155], v[40:43], a[152:155], v[152:155]
    v_mfma_f32_16x16x32_bf16 v[148:151], v[40:43], a[148:151], v[148:151]
    ds_read_b64_tr_b16 v[32:33], v12 offset:20736
    ds_read_b64_tr_b16 v[34:35], v12 offset:25856
    v_mfma_f32_16x16x32_bf16 v[148:151], v[44:47], a[180:183], v[148:151]
    s_nop 0
    v_mfma_f32_16x16x32_bf16 v[144:147], v[44:47], a[176:179], v[144:147]
    buffer_load_dwordx4 a[116:119], v61, s[48:51], s7 offen offset:3072 sc1
    v_mfma_f32_16x16x32_bf16 v[144:147], v[40:43], a[144:147], v[144:147]
    s_waitcnt lgkmcnt(2)
    ds_read_b64_tr_b16 v[36:37], v12 offset:30976
    ds_read_b64_tr_b16 v[38:39], v12 offset:36096
    v_mfma_f32_16x16x32_bf16 v[160:163], v[16:19], a[144:147], v[160:163]
    buffer_load_dwordx4 a[40:43], v62, s[48:51], s17 offen offset:1024 sc1
    v_mfma_f32_16x16x32_bf16 v[160:163], v[20:23], a[176:179], v[160:163]
    v_mfma_f32_16x16x32_bf16 v[164:167], v[20:23], a[180:183], v[164:167]
    ds_read_b64_tr_b16 v[40:41], v13 offset:20736
    ds_read_b64_tr_b16 v[42:43], v13 offset:25856
    v_mfma_f32_16x16x32_bf16 v[164:167], v[16:19], a[148:151], v[164:167]
    v_mfma_f32_16x16x32_bf16 v[168:171], v[16:19], a[152:155], v[168:171]
    v_mfma_f32_16x16x32_bf16 v[168:171], v[20:23], a[184:187], v[168:171]
    ds_read_b64_tr_b16 v[44:45], v13 offset:30976
    ds_read_b64_tr_b16 v[46:47], v13 offset:36096
    v_mfma_f32_16x16x32_bf16 v[172:175], v[20:23], a[188:191], v[172:175]
    v_mfma_f32_16x16x32_bf16 v[172:175], v[16:19], a[156:159], v[172:175]
    buffer_load_dwordx4 a[44:47], v63, s[48:51], s17 offen offset:1024 sc1
    v_mfma_f32_16x16x32_bf16 v[188:191], v[24:27], a[156:159], v[188:191]
    v_mfma_f32_16x16x32_bf16 v[188:191], v[28:31], a[188:191], v[188:191]
    buffer_load_dwordx4 a[120:123], v62, s[48:51], s7 offen offset:3072 sc1
    v_mfma_f32_16x16x32_bf16 v[184:187], v[28:31], a[184:187], v[184:187]
    v_mfma_f32_16x16x32_bf16 v[184:187], v[24:27], a[152:155], v[184:187]
    v_mfma_f32_16x16x32_bf16 v[180:183], v[24:27], a[148:151], v[180:183]
    s_waitcnt lgkmcnt(0)
    s_barrier
    s_waitcnt vmcnt(24)
    v_cmp_gt_u32 vcc, 32, v7
    s_cbranch_vccnz L_slow23
L_ok23:
    v_mfma_f32_16x16x32_bf16 v[180:183], v[28:31], a[180:183], v[180:183]
    s_nop 0
    ds_read_b64_tr_b16 v[16:17], v8 offset:0
    ds_read_b64_tr_b16 v[18:19], v8 offset:5120
    v_mfma_f32_16x16x32_bf16 v[176:179], v[28:31], a[176:179], v[176:179]
    buffer_load_dwordx4 a[192:195], v1, s[48:51], s11 offen sc1
    v_mfma_f32_16x16x32_bf16 v[176:179], v[24:27], a[144:147], v[176:179]
    ds_read_b64_tr_b16 v[20:21], v8 offset:10240
    ds_read_b64_tr_b16 v[22:23], v8 offset:15360
    v_mfma_f32_16x16x32_bf16 v[192:195], v[32:35], a[144:147], v[192:195]
    s_add_u32 s6, s6, 4096
    s_add_u32 m0, s34, 81920
    v_mfma_f32_16x16x32_bf16 v[192:195], v[36:39], a[176:179], v[192:195]
    buffer_load_dwordx4 v3, s[48:51], s6 offen sc1 lds
    v_mfma_f32_16x16x32_bf16 v[196:199], v[36:39], a[180:183], v[196:199]
    v_mfma_f32_16x16x32_bf16 v[196:199], v[32:35], a[148:151], v[196:199]
    buffer_load_dwordx4 a[64:67], v60, s[48:51], s17 offen offset:2048 sc1
    v_mfma_f32_16x16x32_bf16 v[200:203], v[32:35], a[152:155], v[200:203]
    ds_read_b64_tr_b16 v[24:25], v9 offset:0
    ds_read_b64_tr_b16 v[26:27], v9 offset:5120
    v_mfma_f32_16x16x32_bf16 v[200:203], v[36:39], a[184:187], v[200:203]
    buffer_load_dwordx4 a[124:127], v63, s[48:51], s7 offen offset:3072 sc1
    v_mfma_f32_16x16x32_bf16 v[204:207], v[36:39], a[188:191], v[204:207]
    v_mfma_f32_16x16x32_bf16 v[204:207], v[32:35], a[156:159], v[204:207]
    ds_read_b64_tr_b16 v[28:29], v9 offset:10240
    ds_read_b64_tr_b16 v[30:31], v9 offset:15360
    v_mfma_f32_16x16x32_bf16 v[220:223], v[40:43], a[156:159], v[220:223]
    buffer_load_dwordx4 a[196:199], v1, s[48:51], s11 offen offset:1024 sc1
    v_mfma_f32_16x16x32_bf16 v[220:223], v[44:47], a[188:191], v[220:223]
    v_mfma_f32_16x16x32_bf16 v[216:219], v[44:47], a[184:187], v[216:219]
    buffer_load_dwordx4 a[68:71], v61, s[48:51], s17 offen offset:2048 sc1
    v_mfma_f32_16x16x32_bf16 v[216:219], v[40:43], a[152:155], v[216:219]
    v_mfma_f32_16x16x32_bf16 v[212:215], v[40:43], a[148:151], v[212:215]
    ds_read_b64_tr_b16 v[32:33], v8 offset:64
    ds_read_b64_tr_b16 v[34:35], v8 offset:5184
    v_mfma_f32_16x16x32_bf16 v[212:215], v[44:47], a[180:183], v[212:215]
    v_mfma_f32_16x16x32_bf16 v[208:211], v[44:47], a[176:179], v[208:211]
    s_nop 0
    v_mfma_f32_16x16x32_bf16 v[208:211], v[40:43], a[144:147], v[208:211]
    s_waitcnt lgkmcnt(2)
    ds_read_b64_tr_b16 v[36:37], v8 offset:10304
    ds_read_b64_tr_b16 v[38:39], v8 offset:15424
    v_mfma_f32_16x16x32_bf16 v[64:67], v[16:19], a[16:19], v[64:67]
    s_add_u32 s6, s6, 4096
    s_add_u32 m0, s34, 86016
    v_mfma_f32_16x16x32_bf16 v[64:67], v[20:23], a[48:51], v[64:67]
    buffer_load_dwordx4 v3, s[48:51], s6 offen sc1 lds
    v_mfma_f32_16x16x32_bf16 v[68:71], v[20:23], a[52:55], v[68:71]
    v_mfma_f32_16x16x32_bf16 v[68:71], v[16:19], a[20:23], v[68:71]
    buffer_load_dwordx4 a[200:203], v1, s[48:51], s11 offen offset:2048 sc1
    v_mfma_f32_16x16x32_bf16 v[72:75], v[16:19], a[24:27], v[72:75]
    ds_read_b64_tr_b16 v[40:41], v9 offset:64
    ds_read_b64_tr_b16 v[42:43], v9 offset:5184
    v_mfma_f32_16x16x32_bf16 v[72:75], v[20:23], a[56:59], v[72:75]
    s_waitcnt vmcnt(30)
    buffer_load_dwordx4 a[72:75], v62, s[48:51], s17 offen offset:2048 sc1
    v_mfma_f32_16x16x32_bf16 v[76:79], v[20:23], a[60:63], v[76:79]
    s_nop 0
    v_mfma_f32_16x16x32_bf16 v[76:79], v[16:19], a[28:31], v[76:79]
    ds_read_b64_tr_b16 v[44:45], v9 offset:10304
    ds_read_b64_tr_b16 v[46:47], v9 offset:15424
    v_mfma_f32_16x16x32_bf16 v[92:95], v[24:27], a[28:31], v[92:95]
    v_mfma_f32_16x16x32_bf16 v[92:95], v[28:31], a[60:63], v[92:95]
    v_mfma_f32_16x16x32_bf16 v[88:91], v[28:31], a[56:59], v[88:91]
    v_mfma_f32_16x16x32_bf16 v[88:91], v[24:27], a[24:27], v[88:91]
    v_mfma_f32_16x16x32_bf16 v[84:87], v[24:27], a[20:23], v[84:87]
    ds_read_b64_tr_b16 v[16:17], v8 offset:128
    ds_read_b64_tr_b16 v[18:19], v8 offset:5248
    v_mfma_f32_16x16x32_bf16 v[84:87], v[28:31], a[52:55], v[84:87]
    buffer_load_dwordx4 a[204:207], v1, s[48:51], s11 offen offset:3072 sc1
    v_mfma_f32_16x16x32_bf16 v[80:83], v[28:31], a[48:51], v[80:83]
    s_nop 0
    v_mfma_f32_16x16x32_bf16 v[80:83], v[24:27], a[16:19], v[80:83]
    s_waitcnt lgkmcnt(2)
    ds_read_b64_tr_b16 v[20:21], v8 offset:10368
    ds_read_b64_tr_b16 v[22:23], v8 offset:15488
    v_mfma_f32_16x16x32_bf16 v[96:99], v[32:35], a[16:19], v[96:99]
    buffer_load_dwordx4 a[76:79], v63, s[48:51], s17 offen offset:2048 sc1
    v_mfma_f32_16x16x32_bf16 v[96:99], v[36:39], a[48:51], v[96:99]
    s_add_u32 s6, s6, 4096
    s_add_u32 m0, s34, 90112
    v_mfma_f32_16x16x32_bf16 v[100:103], v[36:39], a[52:55], v[100:103]
    buffer_load_dwordx4 v3, s[48:51], s6 offen sc1 lds
    v_mfma_f32_16x16x32_bf16 v[100:103], v[32:35], a[20:23], v[100:103]
    v_mfma_f32_16x16x32_bf16 v[104:107], v[32:35], a[24:27], v[104:107]
    ds_read_b64_tr_b16 v[24:25], v9 offset:128
    ds_read_b64_tr_b16 v[26:27], v9 offset:5248
    v_mfma_f32_16x16x32_bf16 v[104:107], v[36:39], a[56:59], v[104:107]
    v_mfma_f32_16x16x32_bf16 v[108:111], v[36:39], a[60:63], v[108:111]
    v_mfma_f32_16x16x32_bf16 v[108:111], v[32:35], a[28:31], v[108:111]
    ds_read_b64_tr_b16 v[28:29], v9 offset:10368
    ds_read_b64_tr_b16 v[30:31], v9 offset:15488
    v_mfma_f32_16x16x32_bf16 v[124:127], v[40:43], a[28:31], v[124:127]
    buffer_load_dwordx4 a[96:99], v60, s[48:51], s17 offen offset:3072 sc1
    v_mfma_f32_16x16x32_bf16 v[124:127], v[44:47], a[60:63], v[124:127]
    s_add_u32 s11, s11, 4096
    v_mfma_f32_16x16x32_bf16 v[120:123], v[44:47], a[56:59], v[120:123]
    buffer_load_dwordx4 a[208:211], v1, s[48:51], s11 offen sc1
    v_mfma_f32_16x16x32_bf16 v[120:123], v[40:43], a[24:27], v[120:123]
    v_mfma_f32_16x16x32_bf16 v[116:119], v[40:43], a[20:23], v[116:119]
    ds_read_b64_tr_b16 v[32:33], v8 offset:192
    ds_read_b64_tr_b16 v[34:35], v8 offset:5312
    v_mfma_f32_16x16x32_bf16 v[116:119], v[44:47], a[52:55], v[116:119]
    v_mfma_f32_16x16x32_bf16 v[112:115], v[44:47], a[48:51], v[112:115]
    s_nop 0
    v_mfma_f32_16x16x32_bf16 v[112:115], v[40:43], a[16:19], v[112:115]
    s_waitcnt lgkmcnt(2)
    ds_read_b64_tr_b16 v[36:37], v8 offset:10432
    ds_read_b64_tr_b16 v[38:39], v8 offset:15552
    v_mfma_f32_16x16x32_bf16 v[128:131], v[16:19], a[16:19], v[128:131]
    buffer_load_dwordx4 a[100:103], v61, s[48:51], s17 offen offset:3072 sc1
    v_mfma_f32_16x16x32_bf16 v[128:131], v[20:23], a[48:51], v[128:131]
    s_add_u32 s6, s6, 4096
    s_add_u32 m0, s34, 94208
    v_mfma_f32_16x16x32_bf16 v[132:135], v[20:23], a[52:55], v[132:135]
    buffer_load_dwordx4 v3, s[48:51], s6 offen sc1 lds
    v_mfma_f32_16x16x32_bf16 v[132:135], v[16:19], a[20:23], v[132:135]
    v_mfma_f32_16x16x32_bf16 v[136:139], v[16:19], a[24:27], v[136:139]
    ds_read_b64_tr_b16 v[40:41], v9 offset:192
    ds_read_b64_tr_b16 v[42:43], v9 offset:5312
    v_mfma_f32_16x16x32_bf16 v[136:139], v[20:23], a[56:59], v[136:139]
    buffer_load_dwordx4 a[212:215], v1, s[48:51], s11 offen offset:1024 sc1
    v_mfma_f32_16x16x32_bf16 v[140:143], v[20:23], a[60:63], v[140:143]
    v_mfma_f32_16x16x32_bf16 v[140:143], v[16:19], a[28:31], v[140:143]
    ds_read_b64_tr_b16 v[44:45], v9 offset:10432
    ds_read_b64_tr_b16 v[46:47], v9 offset:15552
    v_mfma_f32_16x16x32_bf16 v[156:159], v[24:27], a[28:31], v[156:159]
    v_mfma_f32_16x16x32_bf16 v[156:159], v[28:31], a[60:63], v[156:159]
    buffer_load_dwordx4 a[104:107], v62, s[48:51], s17 offen offset:3072 sc1
    v_mfma_f32_16x16x32_bf16 v[152:155], v[28:31], a[56:59], v[152:155]
    v_mfma_f32_16x16x32_bf16 v[152:155], v[24:27], a[24:27], v[152:155]
    v_mfma_f32_16x16x32_bf16 v[148:151], v[24:27], a[20:23], v[148:151]
    ds_read_b64_tr_b16 v[16:17], v8 offset:256
    ds_read_b64_tr_b16 v[18:19], v8 offset:5376
    v_mfma_f32_16x16x32_bf16 v[148:151], v[28:31], a[52:55], v[148:151]
    buffer_load_dwordx4 a[216:219], v1, s[48:51], s11 offen offset:2048 sc1
    v_mfma_f32_16x16x32_bf16 v[144:147], v[28:31], a[48:51], v[144:147]
    s_nop 0
    v_mfma_f32_16x16x32_bf16 v[144:147], v[24:27], a[16:19], v[144:147]
    s_waitcnt lgkmcnt(2)
    ds_read_b64_tr_b16 v[20:21], v8 offset:10496
    ds_read_b64_tr_b16 v[22:23], v8 offset:15616
    v_mfma_f32_16x16x32_bf16 v[160:163], v[32:35], a[16:19], v[160:163]
    v_mfma_f32_16x16x32_bf16 v[160:163], v[36:39], a[48:51], v[160:163]
    v_mfma_f32_16x16x32_bf16 v[164:167], v[36:39], a[52:55], v[164:167]
    v_mfma_f32_16x16x32_bf16 v[164:167], v[32:35], a[20:23], v[164:167]
    buffer_load_dwordx4 a[108:111], v63, s[48:51], s17 offen offset:3072 sc1
    v_mfma_f32_16x16x32_bf16 v[168:171], v[32:35], a[24:27], v[168:171]
    ds_read_b64_tr_b16 v[24:25], v9 offset:256
    ds_read_b64_tr_b16 v[26:27], v9 offset:5376
    v_mfma_f32_16x16x32_bf16 v[168:171], v[36:39], a[56:59], v[168:171]
    s_add_u32 s6, s6, 4096
    s_add_u32 m0, s34, 98304
    v_mfma_f32_16x16x32_bf16 v[172:175], v[36:39], a[60:63], v[172:175]
    buffer_load_dwordx4 v3, s[48:51], s6 offen sc1 lds
    v_mfma_f32_16x16x32_bf16 v[172:175], v[32:35], a[28:31], v[172:175]
    ds_read_b64_tr_b16 v[28:29], v9 offset:10496
    ds_read_b64_tr_b16 v[30:31], v9 offset:15616
    v_mfma_f32_16x16x32_bf16 v[188:191], v[40:43], a[28:31], v[188:191]
    buffer_load_dwordx4 a[220:223], v1, s[48:51], s11 offen offset:3072 sc1
    v_mfma_f32_16x16x32_bf16 v[188:191], v[44:47], a[60:63], v[188:191]
    v_mfma_f32_16x16x32_bf16 v[184:187], v[44:47], a[56:59], v[184:187]
    v_mfma_f32_16x16x32_bf16 v[184:187], v[40:43], a[24:27], v[184:187]
    v_mfma_f32_16x16x32_bf16 v[180:183], v[40:43], a[20:23], v[180:183]
    s_add_u32 s17, s17, 4096
    ds_read_b64_tr_b16 v[32:33], v8 offset:20480
    ds_read_b64_tr_b16 v[34:35], v8 offset:25600
    v_mfma_f32_16x16x32_bf16 v[180:183], v[44:47], a[52:55], v[180:183]
    buffer_load_dwordx4 a[128:131], v60, s[48:51], s17 offen sc1
    v_mfma_f32_16x16x32_bf16 v[176:179], v[44:47], a[48:51], v[176:179]
    s_nop 0
    v_mfma_f32_16x16x32_bf16 v[176:179], v[40:43], a[16:19], v[176:179]
    s_waitcnt lgkmcnt(2)
    ds_read_b64_tr_b16 v[36:37], v8 offset:30720
    ds_read_b64_tr_b16 v[38:39], v8 offset:35840
    v_mfma_f32_16x16x32_bf16 v[192:195], v[16:19], a[16:19], v[192:195]
    v_mfma_f32_16x16x32_bf16 v[192:195], v[20:23], a[48:51], v[192:195]
    s_add_u32 s11, s11, 4096
    v_mfma_f32_16x16x32_bf16 v[196:199], v[20:23], a[52:55], v[196:199]
    buffer_load_dwordx4 a[224:227], v1, s[48:51], s11 offen sc1
    v_mfma_f32_16x16x32_bf16 v[196:199], v[16:19], a[20:23], v[196:199]
    v_mfma_f32_16x16x32_bf16 v[200:203], v[16:19], a[24:27], v[200:203]
    ds_read_b64_tr_b16 v[40:41], v9 offset:20480
    ds_read_b64_tr_b16 v[42:43], v9 offset:25600
    v_mfma_f32_16x16x32_bf16 v[200:203], v[20:23], a[56:59], v[200:203]
    v_mfma_f32_16x16x32_bf16 v[204:207], v[20:23], a[60:63], v[204:207]
    buffer_load_dwordx4 a[132:135], v61, s[48:51], s17 offen sc1
    v_mfma_f32_16x16x32_bf16 v[204:207], v[16:19], a[28:31], v[204:207]
    ds_read_b64_tr_b16 v[44:45], v9 offset:30720
    ds_read_b64_tr_b16 v[46:47], v9 offset:35840
    v_mfma_f32_16x16x32_bf16 v[220:223], v[24:27], a[28:31], v[220:223]
    v_mfma_f32_16x16x32_bf16 v[220:223], v[28:31], a[60:63], v[220:223]
    v_mfma_f32_16x16x32_bf16 v[216:219], v[28:31], a[56:59], v[216:219]
    v_mfma_f32_16x16x32_bf16 v[216:219], v[24:27], a[24:27], v[216:219]
    v_mfma_f32_16x16x32_bf16 v[212:215], v[24:27], a[20:23], v[212:215]
    ds_read_b64_tr_b16 v[16:17], v8 offset:20544
    ds_read_b64_tr_b16 v[18:19], v8 offset:25664
    v_mfma_f32_16x16x32_bf16 v[212:215], v[28:31], a[52:55], v[212:215]
    buffer_load_dwordx4 a[228:231], v1, s[48:51], s11 offen offset:1024 sc1
    v_mfma_f32_16x16x32_bf16 v[208:211], v[28:31], a[48:51], v[208:211]
    v_mfma_f32_16x16x32_bf16 v[208:211], v[24:27], a[16:19], v[208:211]
    s_waitcnt vmcnt(43) lgkmcnt(2)
    ds_read_b64_tr_b16 v[20:21], v8 offset:30784
    ds_read_b64_tr_b16 v[22:23], v8 offset:35904
    v_mfma_f32_16x16x32_bf16 v[64:67], v[32:35], a[80:83], v[64:67]
    s_waitcnt vmcnt(32)
    buffer_load_dwordx4 a[136:139], v62, s[48:51], s17 offen sc1
    v_mfma_f32_16x16x32_bf16 v[64:67], v[36:39], a[112:115], v[64:67]
    s_waitcnt vmcnt(30)
    v_mfma_f32_16x16x32_bf16 v[68:71], v[36:39], a[116:119], v[68:71]
    s_nop 0
    v_mfma_f32_16x16x32_bf16 v[68:71], v[32:35], a[84:87], v[68:71]
    s_nop 0
    v_mfma_f32_16x16x32_bf16 v[72:75], v[32:35], a[88:91], v[72:75]
    s_waitcnt vmcnt(27)
    ds_read_b64_tr_b16 v[24:25], v9 offset:20544
    ds_read_b64_tr_b16 v[26:27], v9 offset:25664
    v_mfma_f32_16x16x32_bf16 v[72:75], v[36:39], a[120:123], v[72:75]
    s_waitcnt vmcnt(23)
    v_mfma_f32_16x16x32_bf16 v[76:79], v[36:39], a[124:127], v[76:79]
    s_nop 0
    v_mfma_f32_16x16x32_bf16 v[76:79], v[32:35], a[92:95], v[76:79]
    ds_read_b64_tr_b16 v[28:29], v9 offset:30784
    ds_read_b64_tr_b16 v[30:31], v9 offset:35904
    v_mfma_f32_16x16x32_bf16 v[92:95], v[40:43], a[92:95], v[92:95]
    buffer_load_dwordx4 a[140:143], v63, s[48:51], s17 offen sc1
    v_mfma_f32_16x16x32_bf16 v[92:95], v[44:47], a[124:127], v[92:95]
    v_mfma_f32_16x16x32_bf16 v[88:91], v[44:47], a[120:123], v[88:91]
    buffer_load_dwordx4 a[232:235], v1, s[48:51], s11 offen offset:2048 sc1
    v_mfma_f32_16x16x32_bf16 v[88:91], v[40:43], a[88:91], v[88:91]
    v_mfma_f32_16x16x32_bf16 v[84:87], v[40:43], a[84:87], v[84:87]
    ds_read_b64_tr_b16 v[32:33], v8 offset:20608
    ds_read_b64_tr_b16 v[34:35], v8 offset:25728
    v_mfma_f32_16x16x32_bf16 v[84:87], v[44:47], a[116:119], v[84:87]
    v_mfma_f32_16x16x32_bf16 v[80:83], v[44:47], a[112:115], v[80:83]
    s_nop 0
    v_mfma_f32_16x16x32_bf16 v[80:83], v[40:43], a[80:83], v[80:83]
    s_waitcnt lgkmcnt(2)
    ds_read_b64_tr_b16 v[36:37], v8 offset:30848
    ds_read_b64_tr_b16 v[38:39], v8 offset:35968
    v_mfma_f32_16x16x32_bf16 v[96:99], v[16:19], a[80:83], v[96:99]
    v_mfma_f32_16x16x32_bf16 v[96:99], v[20:23], a[112:115], v[96:99]
    v_mfma_f32_16x16x32_bf16 v[100:103], v[20:23], a[116:119], v[100:103]
    buffer_load_dwordx4 a[160:163], v60, s[48:51], s17 offen offset:1024 sc1
    v_mfma_f32_16x16x32_bf16 v[100:103], v[16:19], a[84:87], v[100:103]
    v_mfma_f32_16x16x32_bf16 v[104:107], v[16:19], a[88:91], v[104:107]
    ds_read_b64_tr_b16 v[40:41], v9 offset:20608
    ds_read_b64_tr_b16 v[42:43], v9 offset:25728
    v_mfma_f32_16x16x32_bf16 v[104:107], v[20:23], a[120:123], v[104:107]
    buffer_load_dwordx4 a[236:239], v1, s[48:51], s11 offen offset:3072 sc1
    v_mfma_f32_16x16x32_bf16 v[108:111], v[20:23], a[124:127], v[108:111]
    v_mfma_f32_16x16x32_bf16 v[108:111], v[16:19], a[92:95], v[108:111]
    ds_read_b64_tr_b16 v[44:45], v9 offset:30848
    ds_read_b64_tr_b16 v[46:47], v9 offset:35968
    v_mfma_f32_16x16x32_bf16 v[124:127], v[24:27], a[92:95], v[124:127]
    v_mfma_f32_16x16x32_bf16 v[124:127], v[28:31], a[124:127], v[124:127]
    v_mfma_f32_16x16x32_bf16 v[120:123], v[28:31], a[120:123], v[120:123]
    v_mfma_f32_16x16x32_bf16 v[120:123], v[24:27], a[88:91], v[120:123]
    buffer_load_dwordx4 a[164:167], v61, s[48:51], s17 offen offset:1024 sc1
    v_mfma_f32_16x16x32_bf16 v[116:119], v[24:27], a[84:87], v[116:119]
    ds_read_b64_tr_b16 v[16:17], v8 offset:20672
    ds_read_b64_tr_b16 v[18:19], v8 offset:25792
    v_mfma_f32_16x16x32_bf16 v[116:119], v[28:31], a[116:119], v[116:119]
    s_add_u32 s11, s11, 4096
    v_mfma_f32_16x16x32_bf16 v[112:115], v[28:31], a[112:115], v[112:115]
    buffer_load_dwordx4 a[240:243], v1, s[48:51], s11 offen sc1
    v_mfma_f32_16x16x32_bf16 v[112:115], v[24:27], a[80:83], v[112:115]
    s_waitcnt lgkmcnt(2)
    ds_read_b64_tr_b16 v[20:21], v8 offset:30912
    ds_read_b64_tr_b16 v[22:23], v8 offset:36032
    v_mfma_f32_16x16x32_bf16 v[128:131], v[32:35], a[80:83], v[128:131]
    s_nop 0
    v_mfma_f32_16x16x32_bf16 v[128:131], v[36:39], a[112:115], v[128:131]
    v_mfma_f32_16x16x32_bf16 v[132:135], v[36:39], a[116:119], v[132:135]
    v_mfma_f32_16x16x32_bf16 v[132:135], v[32:35], a[84:87], v[132:135]
    v_mfma_f32_16x16x32_bf16 v[136:139], v[32:35], a[88:91], v[136:139]
    ds_read_b64_tr_b16 v[24:25], v9 offset:20672
    ds_read_b64_tr_b16 v[26:27], v9 offset:25792
    v_mfma_f32_16x16x32_bf16 v[136:139], v[36:39], a[120:123], v[136:139]
    buffer_load_dwordx4 a[168:171], v62, s[48:51], s17 offen offset:1024 sc1
    v_mfma_f32_16x16x32_bf16 v[140:143], v[36:39], a[124:127], v[140:143]
    v_mfma_f32_16x16x32_bf16 v[140:143], v[32:35], a[92:95], v[140:143]
    ds_read_b64_tr_b16 v[28:29], v9 offset:30912
    ds_read_b64_tr_b16 v[30:31], v9 offset:36032
    v_mfma_f32_16x16x32_bf16 v[156:159], v[40:43], a[92:95], v[156:159]
    buffer_load_dwordx4 a[244:247], v1, s[48:51], s11 offen offset:1024 sc1
    v_mfma_f32_16x16x32_bf16 v[156:159], v[44:47], a[124:127], v[156:159]
    v_mfma_f32_16x16x32_bf16 v[152:155], v[44:47], a[120:123], v[152:155]
    v_mfma_f32_16x16x32_bf16 v[152:155], v[40:43], a[88:91], v[152:155]
    v_mfma_f32_16x16x32_bf16 v[148:151], v[40:43], a[84:87], v[148:151]
    ds_read_b64_tr_b16 v[32:33], v8 offset:20736
    ds_read_b64_tr_b16 v[34:35], v8 offset:25856
    v_mfma_f32_16x16x32_bf16 v[148:151], v[44:47], a[116:119], v[148:151]
    v_mfma_f32_16x16x32_bf16 v[144:147], v[44:47], a[112:115], v[144:147]
    buffer_load_dwordx4 a[172:175], v63, s[48:51], s17 offen offset:1024 sc1
    v_mfma_f32_16x16x32_bf16 v[144:147], v[40:43], a[80:83], v[144:147]
    s_waitcnt lgkmcnt(2)
    ds_read_b64_tr_b16 v[36:37], v8 offset:30976
    ds_read_b64_tr_b16 v[38:39], v8 offset:36096
    v_mfma_f32_16x16x32_bf16 v[160:163], v[16:19], a[80:83], v[160:163]
    s_nop 0
    v_mfma_f32_16x16x32_bf16 v[160:163], v[20:23], a[112:115], v[160:163]
    v_mfma_f32_16x16x32_bf16 v[164:167], v[20:23], a[116:119], v[164:167]
    ds_read_b64_tr_b16 v[40:41], v9 offset:20736
    ds_read_b64_tr_b16 v[42:43], v9 offset:25856
    v_mfma_f32_16x16x32_bf16 v[164:167], v[16:19], a[84:87], v[164:167]
    buffer_load_dwordx4 a[248:251], v1, s[48:51], s11 offen offset:2048 sc1
    v_mfma_f32_16x16x32_bf16 v[168:171], v[16:19], a[88:91], v[168:171]
    v_mfma_f32_16x16x32_bf16 v[168:171], v[20:23], a[120:123], v[168:171]
    ds_read_b64_tr_b16 v[44:45], v9 offset:30976
    ds_read_b64_tr_b16 v[46:47], v9 offset:36096
    v_mfma_f32_16x16x32_bf16 v[172:175], v[20:23], a[124:127], v[172:175]
    v_mfma_f32_16x16x32_bf16 v[172:175], v[16:19], a[92:95], v[172:175]
    v_mfma_f32_16x16x32_bf16 v[188:191], v[24:27], a[92:95], v[188:191]
    v_mfma_f32_16x16x32_bf16 v[188:191], v[28:31], a[124:127], v[188:191]
    v_mfma_f32_16x16x32_bf16 v[184:187], v[28:31], a[120:123], v[184:187]
    v_mfma_f32_16x16x32_bf16 v[184:187], v[24:27], a[88:91], v[184:187]
    v_mfma_f32_16x16x32_bf16 v[180:183], v[24:27], a[84:87], v[180:183]
    s_waitcnt vmcnt(16) lgkmcnt(0)
    s_barrier
    v_mfma_f32_16x16x32_bf16 v[180:183], v[28:31], a[116:119], v[180:183]
    ds_read_b64_tr_b16 v[16:17], v10 offset:0
    ds_read_b64_tr_b16 v[18:19], v10 offset:5120
    v_mfma_f32_16x16x32_bf16 v[176:179], v[28:31], a[112:115], v[176:179]
    buffer_load_dwordx4 a[252:255], v1, s[48:51], s11 offen offset:3072 sc1
    v_mfma_f32_16x16x32_bf16 v[176:179], v[24:27], a[80:83], v[176:179]
    ds_read_b64_tr_b16 v[20:21], v10 offset:10240
    ds_read_b64_tr_b16 v[22:23], v10 offset:15360
    v_mfma_f32_16x16x32_bf16 v[192:195], v[32:35], a[80:83], v[192:195]
    s_add_u32 s8, s8, 4096
    s_add_u32 m0, s34, 0
    v_mfma_f32_16x16x32_bf16 v[192:195], v[36:39], a[112:115], v[192:195]
    buffer_load_dwordx4 v3, s[48:51], s8 offen sc1 lds
    v_mfma_f32_16x16x32_bf16 v[196:199], v[36:39], a[116:119], v[196:199]
    s_nop 0
    v_mfma_f32_16x16x32_bf16 v[196:199], v[32:35], a[84:87], v[196:199]
    v_mfma_f32_16x16x32_bf16 v[200:203], v[32:35], a[88:91], v[200:203]
    ds_read_b64_tr_b16 v[24:25], v11 offset:0
    ds_read_b64_tr_b16 v[26:27], v11 offset:5120
    v_mfma_f32_16x16x32_bf16 v[200:203], v[36:39], a[120:123], v[200:203]
    v_mfma_f32_16x16x32_bf16 v[204:207], v[36:39], a[124:127], v[204:207]
    v_mfma_f32_16x16x32_bf16 v[204:207], v[32:35], a[92:95], v[204:207]
    ds_read_b64_tr_b16 v[28:29], v11 offset:10240
    ds_read_b64_tr_b16 v[30:31], v11 offset:15360
    v_mfma_f32_16x16x32_bf16 v[220:223], v[40:43], a[92:95], v[220:223]
    s_add_u32 s11, s11, 4096
    v_mfma_f32_16x16x32_bf16 v[220:223], v[44:47], a[124:127], v[220:223]
    buffer_load_dwordx4 v[224:227], v1, s[48:51], s11 offen sc1
    v_mfma_f32_16x16x32_bf16 v[216:219], v[44:47], a[120:123], v[216:219]
    s_add_u32 s8, s8, 4096
    s_add_u32 m0, s34, 4096
    v_mfma_f32_16x16x32_bf16 v[216:219], v[40:43], a[88:91], v[216:219]
    buffer_load_dwordx4 v3, s[48:51], s8 offen sc1 lds
    v_mfma_f32_16x16x32_bf16 v[212:215], v[40:43], a[84:87], v[212:215]
    ds_read_b64_tr_b16 v[32:33], v10 offset:20480
    ds_read_b64_tr_b16 v[34:35], v10 offset:25600
    v_mfma_f32_16x16x32_bf16 v[212:215], v[44:47], a[116:119], v[212:215]
    v_mfma_f32_16x16x32_bf16 v[208:211], v[44:47], a[112:115], v[208:211]
    v_mfma_f32_16x16x32_bf16 v[208:211], v[40:43], a[80:83], v[208:211]
    s_waitcnt lgkmcnt(2)
    ds_read_b64_tr_b16 v[36:37], v10 offset:30720
    ds_read_b64_tr_b16 v[38:39], v10 offset:35840
    v_mfma_f32_16x16x32_bf16 v[64:67], v[16:19], a[0:3], v[64:67]
    s_nop 0
    v_mfma_f32_16x16x32_bf16 v[64:67], v[20:23], a[32:35], v[64:67]
    v_mfma_f32_16x16x32_bf16 v[68:71], v[20:23], a[36:39], v[68:71]
    v_mfma_f32_16x16x32_bf16 v[68:71], v[16:19], a[4:7], v[68:71]
    v_mfma_f32_16x16x32_bf16 v[72:75], v[16:19], a[8:11], v[72:75]
    ds_read_b64_tr_b16 v[40:41], v11 offset:20480
    ds_read_b64_tr_b16 v[42:43], v11 offset:25600
    v_mfma_f32_16x16x32_bf16 v[72:75], v[20:23], a[40:43], v[72:75]
    buffer_load_dwordx4 v[228:231], v1, s[48:51], s11 offen offset:1024 sc1
    v_mfma_f32_16x16x32_bf16 v[76:79], v[20:23], a[44:47], v[76:79]
    v_mfma_f32_16x16x32_bf16 v[76:79], v[16:19], a[12:15], v[76:79]
    ds_read_b64_tr_b16 v[44:45], v11 offset:30720
    ds_read_b64_tr_b16 v[46:47], v11 offset:35840
    v_mfma_f32_16x16x32_bf16 v[92:95], v[24:27], a[12:15], v[92:95]
    s_add_u32 s8, s8, 4096
    s_add_u32 m0, s34, 8192
    v_mfma_f32_16x16x32_bf16 v[92:95], v[28:31], a[44:47], v[92:95]
    buffer_load_dwordx4 v3, s[48:51], s8 offen sc1 lds
    v_mfma_f32_16x16x32_bf16 v[88:91], v[28:31], a[40:43], v[88:91]
    v_mfma_f32_16x16x32_bf16 v[88:91], v[24:27], a[8:11], v[88:91]
    v_mfma_f32_16x16x32_bf16 v[84:87], v[24:27], a[4:7], v[84:87]
    ds_read_b64_tr_b16 v[16:17], v12 offset:0
    ds_read_b64_tr_b16 v[18:19], v12 offset:5120
    v_mfma_f32_16x16x32_bf16 v[84:87], v[28:31], a[36:39], v[84:87]
    v_mfma_f32_16x16x32_bf16 v[80:83], v[28:31], a[32:35], v[80:83]
    s_nop 0
    v_mfma_f32_16x16x32_bf16 v[80:83], v[24:27], a[0:3], v[80:83]
    s_waitcnt lgkmcnt(2)
    ds_read_b64_tr_b16 v[20:21], v12 offset:10240
    ds_read_b64_tr_b16 v[22:23], v12 offset:15360
    v_mfma_f32_16x16x32_bf16 v[64:67], v[32:35], a[64:67], v[64:67]
    s_add_u32 s8, s8, 4096
    s_add_u32 m0, s34, 12288
    v_mfma_f32_16x16x32_bf16 v[64:67], v[36:39], a[96:99], v[64:67]
    buffer_load_dwordx4 v3, s[48:51], s8 offen sc1 lds
    v_mfma_f32_16x16x32_bf16 v[68:71], v[36:39], a[100:103], v[68:71]
    v_mfma_f32_16x16x32_bf16 v[68:71], v[32:35], a[68:71], v[68:71]
    buffer_load_dwordx4 v[232:235], v1, s[48:51], s11 offen offset:2048 sc1
    v_mfma_f32_16x16x32_bf16 v[72:75], v[32:35], a[72:75], v[72:75]
    ds_read_b64_tr_b16 v[24:25], v13 offset:0
    ds_read_b64_tr_b16 v[26:27], v13 offset:5120
    v_mfma_f32_16x16x32_bf16 v[72:75], v[36:39], a[104:107], v[72:75]
    v_mfma_f32_16x16x32_bf16 v[76:79], v[36:39], a[108:111], v[76:79]
    v_mfma_f32_16x16x32_bf16 v[76:79], v[32:35], a[76:79], v[76:79]
    ds_read_b64_tr_b16 v[28:29], v13 offset:10240
    ds_read_b64_tr_b16 v[30:31], v13 offset:15360
    v_mfma_f32_16x16x32_bf16 v[92:95], v[40:43], a[76:79], v[92:95]
    v_mfma_f32_16x16x32_bf16 v[92:95], v[44:47], a[108:111], v[92:95]
    buffer_load_dwordx4 v[236:239], v1, s[48:51], s11 offen offset:3072 sc1
    v_mfma_f32_16x16x32_bf16 v[88:91], v[44:47], a[104:107], v[88:91]
    s_add_u32 s8, s8, 4096
    s_add_u32 m0, s34, 16384
    v_mfma_f32_16x16x32_bf16 v[88:91], v[40:43], a[72:75], v[88:91]
    buffer_load_dwordx4 v3, s[48:51], s8 offen sc1 lds
    v_mfma_f32_16x16x32_bf16 v[84:87], v[40:43], a[68:71], v[84:87]
    ds_read_b64_tr_b16 v[32:33], v10 offset:64
    ds_read_b64_tr_b16 v[34:35], v10 offset:5184
    v_mfma_f32_16x16x32_bf16 v[84:87], v[44:47], a[100:103], v[84:87]
    v_mfma_f32_16x16x32_bf16 v[80:83], v[44:47], a[96:99], v[80:83]
    s_nop 0
    v_mfma_f32_16x16x32_bf16 v[80:83], v[40:43], a[64:67], v[80:83]
    s_waitcnt vmcnt(24) lgkmcnt(2)
    ds_read_b64_tr_b16 v[36:37], v10 offset:10304
    ds_read_b64_tr_b16 v[38:39], v10 offset:15424
    v_mfma_f32_16x16x32_bf16 v[64:67], v[16:19], a[128:131], v[64:67]
    s_waitcnt vmcnt(17)
    v_mfma_f32_16x16x32_bf16 v[64:67], v[20:23], a[160:163], v[64:67]
    s_waitcnt vmcnt(15)
    v_mfma_f32_16x16x32_bf16 v[68:71], v[20:23], a[164:167], v[68:71]
    v_mfma_f32_16x16x32_bf16 v[68:71], v[16:19], a[132:135], v[68:71]
    s_nop 0
    v_mfma_f32_16x16x32_bf16 v[72:75], v[16:19], a[136:139], v[72:75]
    s_waitcnt vmcnt(13)
    s_add_u32 s11, s11, 4096
    ds_read_b64_tr_b16 v[40:41], v11 offset:64
    ds_read_b64_tr_b16 v[42:43], v11 offset:5184
    v_mfma_f32_16x16x32_bf16 v[72:75], v[20:23], a[168:171], v[72:75]
    s_waitcnt vmcnt(11)
    buffer_load_dwordx4 a[144:147], v1, s[48:51], s11 offen sc1
    v_mfma_f32_16x16x32_bf16 v[76:79], v[20:23], a[172:175], v[76:79]
    s_nop 0
    v_mfma_f32_16x16x32_bf16 v[76:79], v[16:19], a[140:143], v[76:79]
    ds_read_b64_tr_b16 v[44:45], v11 offset:10304
    ds_read_b64_tr_b16 v[46:47], v11 offset:15424
    v_mfma_f32_16x16x32_bf16 v[92:95], v[24:27], a[140:143], v[92:95]
    s_add_u32 s8, s8, 4096
    s_add_u32 m0, s34, 20480
    v_mfma_f32_16x16x32_bf16 v[92:95], v[28:31], a[172:175], v[92:95]
    buffer_load_dwordx4 v3, s[48:51], s8 offen sc1 lds
    v_mfma_f32_16x16x32_bf16 v[88:91], v[28:31], a[168:171], v[88:91]
    v_mfma_f32_16x16x32_bf16 v[88:91], v[24:27], a[136:139], v[88:91]
    v_mfma_f32_16x16x32_bf16 v[84:87], v[24:27], a[132:135], v[84:87]
    ds_read_b64_tr_b16 v[16:17], v10 offset:20544
    ds_read_b64_tr_b16 v[18:19], v10 offset:25664
    v_mfma_f32_16x16x32_bf16 v[84:87], v[28:31], a[164:167], v[84:87]
    v_mfma_f32_16x16x32_bf16 v[80:83], v[28:31], a[160:163], v[80:83]
    s_nop 0
    v_mfma_f32_16x16x32_bf16 v[80:83], v[24:27], a[128:131], v[80:83]
    s_waitcnt lgkmcnt(2)
    ds_read_b64_tr_b16 v[20:21], v10 offset:30784
    ds_read_b64_tr_b16 v[22:23], v10 offset:35904
    v_mfma_f32_16x16x32_bf16 v[96:99], v[32:35], a[0:3], v[96:99]
    s_add_u32 s8, s8, 4096
    s_add_u32 m0, s34, 24576
    v_mfma_f32_16x16x32_bf16 v[96:99], v[36:39], a[32:35], v[96:99]
    buffer_load_dwordx4 v3, s[48:51], s8 offen sc1 lds
    v_mfma_f32_16x16x32_bf16 v[100:103], v[36:39], a[36:39], v[100:103]
    s_nop 0
    v_mfma_f32_16x16x32_bf16 v[100:103], v[32:35], a[4:7], v[100:103]
    buffer_load_dwordx4 a[148:151], v1, s[48:51], s11 offen offset:1024 sc1
    v_mfma_f32_16x16x32_bf16 v[104:107], v[32:35], a[8:11], v[104:107]
    s_nop 0
    ds_read_b64_tr_b16 v[24:25], v11 offset:20544
    ds_read_b64_tr_b16 v[26:27], v11 offset:25664
    v_mfma_f32_16x16x32_bf16 v[104:107], v[36:39], a[40:43], v[104:107]
    v_cvt_pk_bf16_f32 v64, v64, v65
    v_cvt_pk_bf16_f32 v65, v66, v67
    v_mfma_f32_16x16x32_bf16 v[108:111], v[36:39], a[44:47], v[108:111]
    v_cvt_pk_bf16_f32 v66, v80, v81
    v_cvt_pk_bf16_f32 v67, v82, v83
    v_mfma_f32_16x16x32_bf16 v[108:111], v[32:35], a[12:15], v[108:111]
    ds_read_b64_tr_b16 v[28:29], v11 offset:30784
    ds_read_b64_tr_b16 v[30:31], v11 offset:35904
    v_mfma_f32_16x16x32_bf16 v[124:127], v[40:43], a[12:15], v[124:127]
    v_cvt_pk_bf16_f32 v68, v68, v69
    v_cvt_pk_bf16_f32 v69, v70, v71
    v_mfma_f32_16x16x32_bf16 v[124:127], v[44:47], a[44:47], v[124:127]
    s_add_u32 s8, s8, 4096
    s_add_u32 m0, s34, 28672
    v_mfma_f32_16x16x32_bf16 v[120:123], v[44:47], a[40:43], v[120:123]
    buffer_load_dwordx4 v3, s[48:51], s8 offen sc1 lds
    v_mfma_f32_16x16x32_bf16 v[120:123], v[40:43], a[8:11], v[120:123]
    v_cvt_pk_bf16_f32 v70, v84, v85
    v_cvt_pk_bf16_f32 v71, v86, v87
    v_mfma_f32_16x16x32_bf16 v[116:119], v[40:43], a[4:7], v[116:119]
    ds_read_b64_tr_b16 v[32:33], v12 offset:64
    ds_read_b64_tr_b16 v[34:35], v12 offset:5184
    v_mfma_f32_16x16x32_bf16 v[116:119], v[44:47], a[36:39], v[116:119]
    buffer_load_dwordx4 a[152:155], v1, s[48:51], s11 offen offset:2048 sc1
    v_mfma_f32_16x16x32_bf16 v[112:115], v[44:47], a[32:35], v[112:115]
    s_nop 0
    v_cvt_pk_bf16_f32 v72, v72, v73
    v_cvt_pk_bf16_f32 v73, v74, v75
    v_mfma_f32_16x16x32_bf16 v[112:115], v[40:43], a[0:3], v[112:115]
    s_waitcnt lgkmcnt(2)
    ds_read_b64_tr_b16 v[36:37], v12 offset:10304
    ds_read_b64_tr_b16 v[38:39], v12 offset:15424
    v_mfma_f32_16x16x32_bf16 v[96:99], v[16:19], a[64:67], v[96:99]
    buffer_store_dwordx4 v[64:67], v1, s[48:51], s66 offen sc1
    v_mfma_f32_16x16x32_bf16 v[96:99], v[20:23], a[96:99], v[96:99]
    v_cvt_pk_bf16_f32 v74, v88, v89
    v_cvt_pk_bf16_f32 v75, v90, v91
    v_mfma_f32_16x16x32_bf16 v[100:103], v[20:23], a[100:103], v[100:103]
    s_nop 0
    v_cvt_pk_bf16_f32 v76, v76, v77
    v_cvt_pk_bf16_f32 v77, v78, v79
    v_mfma_f32_16x16x32_bf16 v[100:103], v[16:19], a[68:71], v[100:103]
    s_nop 0
    v_cvt_pk_bf16_f32 v78, v92, v93
    v_cvt_pk_bf16_f32 v79, v94, v95
    v_mfma_f32_16x16x32_bf16 v[104:107], v[16:19], a[72:75], v[104:107]
    ds_read_b64_tr_b16 v[40:41], v13 offset:64
    ds_read_b64_tr_b16 v[42:43], v13 offset:5184
    v_mfma_f32_16x16x32_bf16 v[104:107], v[20:23], a[104:107], v[104:107]
    s_add_u32 s8, s8, 4096
    s_add_u32 m0, s34, 32768
    v_mfma_f32_16x16x32_bf16 v[108:111], v[20:23], a[108:111], v[108:111]
    buffer_load_dwordx4 v3, s[48:51], s8 offen sc1 lds
    v_mfma_f32_16x16x32_bf16 v[108:111], v[16:19], a[76:79], v[108:111]
    ds_read_b64_tr_b16 v[44:45], v13 offset:10304
    ds_read_b64_tr_b16 v[46:47], v13 offset:15424
    v_mfma_f32_16x16x32_bf16 v[124:127], v[24:27], a[76:79], v[124:127]
    buffer_load_dwordx4 a[156:159], v1, s[48:51], s11 offen offset:3072 sc1
    v_mfma_f32_16x16x32_bf16 v[124:127], v[28:31], a[108:111], v[124:127]
    s_nop 0
    v_mfma_f32_16x16x32_bf16 v[120:123], v[28:31], a[104:107], v[120:123]
    buffer_store_dwordx4 v[68:71], v1, s[48:51], s67 offen sc1
    v_mfma_f32_16x16x32_bf16 v[120:123], v[24:27], a[72:75], v[120:123]
    s_nop 0
    v_mfma_f32_16x16x32_bf16 v[116:119], v[24:27], a[68:71], v[116:119]
    ds_read_b64_tr_b16 v[16:17], v11 offset:128
    ds_read_b64_tr_b16 v[18:19], v11 offset:5248
    v_mfma_f32_16x16x32_bf16 v[116:119], v[28:31], a[100:103], v[116:119]
    s_nop 0
    v_mfma_f32_16x16x32_bf16 v[112:115], v[28:31], a[96:99], v[112:115]
    buffer_store_dwordx4 v[72:75], v1, s[48:51], s68 offen sc1
    v_mfma_f32_16x16x32_bf16 v[112:115], v[24:27], a[64:67], v[112:115]
    s_waitcnt lgkmcnt(2)
    ds_read_b64_tr_b16 v[20:21], v11 offset:10368
    ds_read_b64_tr_b16 v[22:23], v11 offset:15488
    v_mfma_f32_16x16x32_bf16 v[96:99], v[32:35], a[128:131], v[96:99]
    s_add_u32 s8, s8, 4096
    s_add_u32 m0, s34, 36864
    v_mfma_f32_16x16x32_bf16 v[96:99], v[36:39], a[160:163], v[96:99]
    buffer_load_dwordx4 v3, s[48:51], s8 offen sc1 lds
    v_mfma_f32_16x16x32_bf16 v[100:103], v[36:39], a[164:167], v[100:103]
    s_add_u32 s11, s11, 4096
    v_mfma_f32_16x16x32_bf16 v[100:103], v[32:35], a[132:135], v[100:103]
    buffer_load_dwordx4 a[176:179], v1, s[48:51], s11 offen sc1
    v_mfma_f32_16x16x32_bf16 v[104:107], v[32:35], a[136:139], v[104:107]
    ds_read_b64_tr_b16 v[24:25], v10 offset:192
    ds_read_b64_tr_b16 v[26:27], v10 offset:5312
    v_mfma_f32_16x16x32_bf16 v[104:107], v[36:39], a[168:171], v[104:107]
    v_mfma_f32_16x16x32_bf16 v[108:111], v[36:39], a[172:175], v[108:111]
    buffer_store_dwordx4 v[76:79], v1, s[48:51], s69 offen sc1
    v_mfma_f32_16x16x32_bf16 v[108:111], v[32:35], a[140:143], v[108:111]
    ds_read_b64_tr_b16 v[28:29], v10 offset:10432
    ds_read_b64_tr_b16 v[30:31], v10 offset:15552
    v_mfma_f32_16x16x32_bf16 v[124:127], v[40:43], a[140:143], v[124:127]
    v_mfma_f32_16x16x32_bf16 v[124:127], v[44:47], a[172:175], v[124:127]
    v_mfma_f32_16x16x32_bf16 v[120:123], v[44:47], a[168:171], v[120:123]
    buffer_load_dwordx4 a[180:183], v1, s[48:51], s11 offen offset:1024 sc1
    v_mfma_f32_16x16x32_bf16 v[120:123], v[40:43], a[136:139], v[120:123]
    v_mfma_f32_16x16x32_bf16 v[116:119], v[40:43], a[132:135], v[116:119]
    ds_read_b64_tr_b16 v[32:33], v11 offset:20608
    ds_read_b64_tr_b16 v[34:35], v11 offset:25728
    v_mfma_f32_16x16x32_bf16 v[116:119], v[44:47], a[164:167], v[116:119]
    v_mfma_f32_16x16x32_bf16 v[112:115], v[44:47], a[160:163], v[112:115]
    s_nop 0
    v_mfma_f32_16x16x32_bf16 v[112:115], v[40:43], a[128:131], v[112:115]
    s_waitcnt lgkmcnt(2)
    ds_read_b64_tr_b16 v[36:37], v11 offset:30848
    ds_read_b64_tr_b16 v[38:39], v11 offset:35968
    v_mfma_f32_16x16x32_bf16 v[144:147], v[16:19], a[0:3], v[144:147]
    v_mfma_f32_16x16x32_bf16 v[144:147], v[20:23], a[32:35], v[144:147]
    v_mfma_f32_16x16x32_bf16 v[148:151], v[20:23], a[36:39], v[148:151]
    s_nop 0
    v_mfma_f32_16x16x32_bf16 v[148:151], v[16:19], a[4:7], v[148:151]
    s_nop 0
    v_cvt_pk_bf16_f32 v96, v96, v97
    v_cvt_pk_bf16_f32 v97, v98, v99
    v_mfma_f32_16x16x32_bf16 v[152:155], v[16:19], a[8:11], v[152:155]
    ds_read_b64_tr_b16 v[40:41], v10 offset:20672
    ds_read_b64_tr_b16 v[42:43], v10 offset:25792
    v_mfma_f32_16x16x32_bf16 v[152:155], v[20:23], a[40:43], v[152:155]
    buffer_load_dwordx4 a[184:187], v1, s[48:51], s11 offen offset:2048 sc1
    v_mfma_f32_16x16x32_bf16 v[156:159], v[20:23], a[44:47], v[156:159]
    v_cvt_pk_bf16_f32 v98, v112, v113
    v_cvt_pk_bf16_f32 v99, v114, v115
    v_mfma_f32_16x16x32_bf16 v[156:159], v[16:19], a[12:15], v[156:159]
    ds_read_b64_tr_b16 v[44:45], v10 offset:30912
    ds_read_b64_tr_b16 v[46:47], v10 offset:36032
    v_mfma_f32_16x16x32_bf16 v[172:175], v[24:27], a[12:15], v[172:175]
    v_cvt_pk_bf16_f32 v100, v100, v101
    v_cvt_pk_bf16_f32 v101, v102, v103
    v_mfma_f32_16x16x32_bf16 v[172:175], v[28:31], a[44:47], v[172:175]
    v_cvt_pk_bf16_f32 v102, v116, v117
    v_cvt_pk_bf16_f32 v103, v118, v119
    v_mfma_f32_16x16x32_bf16 v[168:171], v[28:31], a[40:43], v[168:171]
    v_cvt_pk_bf16_f32 v104, v104, v105
    v_cvt_pk_bf16_f32 v105, v106, v107
    v_mfma_f32_16x16x32_bf16 v[168:171], v[24:27], a[8:11], v[168:171]
    v_cvt_pk_bf16_f32 v106, v120, v121
    v_cvt_pk_bf16_f32 v107, v122, v123
    v_mfma_f32_16x16x32_bf16 v[164:167], v[24:27], a[4:7], v[164:167]
    ds_read_b64_tr_b16 v[16:17], v13 offset:128
    ds_read_b64_tr_b16 v[18:19], v13 offset:5248
    v_mfma_f32_16x16x32_bf16 v[164:167], v[28:31], a[36:39], v[164:167]
    s_nop 0
    v_mfma_f32_16x16x32_bf16 v[160:163], v[28:31], a[32:35], v[160:163]
    buffer_store_dwordx4 v[96:99], v1, s[48:51], s66 offen offset:1024 sc1
    v_mfma_f32_16x16x32_bf16 v[160:163], v[24:27], a[0:3], v[160:163]
    s_waitcnt lgkmcnt(2)
    ds_read_b64_tr_b16 v[20:21], v13 offset:10368
    ds_read_b64_tr_b16 v[22:23], v13 offset:15488
    v_mfma_f32_16x16x32_bf16 v[144:147], v[32:35], a[64:67], v[144:147]
    buffer_load_dwordx4 a[188:191], v1, s[48:51], s11 offen offset:3072 sc1
    v_mfma_f32_16x16x32_bf16 v[144:147], v[36:39], a[96:99], v[144:147]
    v_cvt_pk_bf16_f32 v108, v108, v109
    v_cvt_pk_bf16_f32 v109, v110, v111
    v_mfma_f32_16x16x32_bf16 v[148:151], v[36:39], a[100:103], v[148:151]
    s_nop 0
    v_cvt_pk_bf16_f32 v110, v124, v125
    v_cvt_pk_bf16_f32 v111, v126, v127
    v_mfma_f32_16x16x32_bf16 v[148:151], v[32:35], a[68:71], v[148:151]
    s_nop 0
    v_mfma_f32_16x16x32_bf16 v[152:155], v[32:35], a[72:75], v[152:155]
    ds_read_b64_tr_b16 v[24:25], v12 offset:192
    ds_read_b64_tr_b16 v[26:27], v12 offset:5312
    v_mfma_f32_16x16x32_bf16 v[152:155], v[36:39], a[104:107], v[152:155]
    s_nop 0
    v_mfma_f32_16x16x32_bf16 v[156:159], v[36:39], a[108:111], v[156:159]
    buffer_store_dwordx4 v[100:103], v1, s[48:51], s67 offen offset:1024 sc1
    v_mfma_f32_16x16x32_bf16 v[156:159], v[32:35], a[76:79], v[156:159]
    s_nop 0
    ds_read_b64_tr_b16 v[28:29], v12 offset:10432
    ds_read_b64_tr_b16 v[30:31], v12 offset:15552
    v_mfma_f32_16x16x32_bf16 v[172:175], v[40:43], a[76:79], v[172:175]
    v_mfma_f32_16x16x32_bf16 v[172:175], v[44:47], a[108:111], v[172:175]
    v_mfma_f32_16x16x32_bf16 v[168:171], v[44:47], a[104:107], v[168:171]
    s_add_u32 s11, s11, 4096
    v_mfma_f32_16x16x32_bf16 v[168:171], v[40:43], a[72:75], v[168:171]
    buffer_load_dwordx4 a[16:19], v1, s[48:51], s11 offen sc1
    v_mfma_f32_16x16x32_bf16 v[164:167], v[40:43], a[68:71], v[164:167]
    ds_read_b64_tr_b16 v[32:33], v11 offset:192
    ds_read_b64_tr_b16 v[34:35], v11 offset:5312
    v_mfma_f32_16x16x32_bf16 v[164:167], v[44:47], a[100:103], v[164:167]
    s_nop 0
    v_mfma_f32_16x16x32_bf16 v[160:163], v[44:47], a[96:99], v[160:163]
    buffer_store_dwordx4 v[104:107], v1, s[48:51], s68 offen offset:1024 sc1
    v_mfma_f32_16x16x32_bf16 v[160:163], v[40:43], a[64:67], v[160:163]
    s_waitcnt lgkmcnt(2)
    ds_read_b64_tr_b16 v[36:37], v11 offset:10432
    ds_read_b64_tr_b16 v[38:39], v11 offset:15552
    v_mfma_f32_16x16x32_bf16 v[144:147], v[16:19], a[128:131], v[144:147]
    v_mfma_f32_16x16x32_bf16 v[144:147], v[20:23], a[160:163], v[144:147]
    v_mfma_f32_16x16x32_bf16 v[148:151], v[20:23], a[164:167], v[148:151]
    v_mfma_f32_16x16x32_bf16 v[148:151], v[16:19], a[132:135], v[148:151]
    v_mfma_f32_16x16x32_bf16 v[152:155], v[16:19], a[136:139], v[152:155]
    ds_read_b64_tr_b16 v[40:41], v10 offset:256
    ds_read_b64_tr_b16 v[42:43], v10 offset:5376
    v_mfma_f32_16x16x32_bf16 v[152:155], v[20:23], a[168:171], v[152:155]
    v_mfma_f32_16x16x32_bf16 v[156:159], v[20:23], a[172:175], v[156:159]
    buffer_load_dwordx4 a[20:23], v1, s[48:51], s11 offen offset:1024 sc1
    v_mfma_f32_16x16x32_bf16 v[156:159], v[16:19], a[140:143], v[156:159]
    ds_read_b64_tr_b16 v[44:45], v10 offset:10496
    ds_read_b64_tr_b16 v[46:47], v10 offset:15616
    v_mfma_f32_16x16x32_bf16 v[172:175], v[24:27], a[140:143], v[172:175]
    buffer_store_dwordx4 v[108:111], v1, s[48:51], s69 offen offset:1024 sc1
    v_mfma_f32_16x16x32_bf16 v[172:175], v[28:31], a[172:175], v[172:175]
    v_mfma_f32_16x16x32_bf16 v[168:171], v[28:31], a[168:171], v[168:171]
    v_mfma_f32_16x16x32_bf16 v[168:171], v[24:27], a[136:139], v[168:171]
    v_mfma_f32_16x16x32_bf16 v[164:167], v[24:27], a[132:135], v[164:167]
    ds_read_b64_tr_b16 v[16:17], v11 offset:20672
    ds_read_b64_tr_b16 v[18:19], v11 offset:25792
    v_mfma_f32_16x16x32_bf16 v[164:167], v[28:31], a[164:167], v[164:167]
    v_mfma_f32_16x16x32_bf16 v[160:163], v[28:31], a[160:163], v[160:163]
    s_nop 0
    v_mfma_f32_16x16x32_bf16 v[160:163], v[24:27], a[128:131], v[160:163]
    s_waitcnt lgkmcnt(2)
    ds_read_b64_tr_b16 v[20:21], v11 offset:30912
    ds_read_b64_tr_b16 v[22:23], v11 offset:36032
    v_mfma_f32_16x16x32_bf16 v[176:179], v[32:35], a[0:3], v[176:179]
    v_mfma_f32_16x16x32_bf16 v[176:179], v[36:39], a[32:35], v[176:179]
    buffer_load_dwordx4 a[24:27], v1, s[48:51], s11 offen offset:2048 sc1
    v_mfma_f32_16x16x32_bf16 v[180:183], v[36:39], a[36:39], v[180:183]
    v_mfma_f32_16x16x32_bf16 v[180:183], v[32:35], a[4:7], v[180:183]
    v_cvt_pk_bf16_f32 v144, v144, v145
    v_cvt_pk_bf16_f32 v145, v146, v147
    v_mfma_f32_16x16x32_bf16 v[184:187], v[32:35], a[8:11], v[184:187]
    ds_read_b64_tr_b16 v[24:25], v10 offset:20736
    ds_read_b64_tr_b16 v[26:27], v10 offset:25856
    v_mfma_f32_16x16x32_bf16 v[184:187], v[36:39], a[40:43], v[184:187]
    v_cvt_pk_bf16_f32 v146, v160, v161
    v_cvt_pk_bf16_f32 v147, v162, v163
    v_mfma_f32_16x16x32_bf16 v[188:191], v[36:39], a[44:47], v[188:191]
    v_cvt_pk_bf16_f32 v148, v148, v149
    v_cvt_pk_bf16_f32 v149, v150, v151
    v_mfma_f32_16x16x32_bf16 v[188:191], v[32:35], a[12:15], v[188:191]
    ds_read_b64_tr_b16 v[28:29], v10 offset:30976
    ds_read_b64_tr_b16 v[30:31], v10 offset:36096
    v_mfma_f32_16x16x32_bf16 v[204:207], v[40:43], a[12:15], v[204:207]
    v_cvt_pk_bf16_f32 v150, v164, v165
    v_cvt_pk_bf16_f32 v151, v166, v167
    v_mfma_f32_16x16x32_bf16 v[204:207], v[44:47], a[44:47], v[204:207]
    v_cvt_pk_bf16_f32 v152, v152, v153
    v_cvt_pk_bf16_f32 v153, v154, v155
    v_mfma_f32_16x16x32_bf16 v[200:203], v[44:47], a[40:43], v[200:203]
    v_mfma_f32_16x16x32_bf16 v[200:203], v[40:43], a[8:11], v[200:203]
    buffer_load_dwordx4 a[28:31], v1, s[48:51], s11 offen offset:3072 sc1
    v_mfma_f32_16x16x32_bf16 v[196:199], v[40:43], a[4:7], v[196:199]
    ds_read_b64_tr_b16 v[32:33], v13 offset:192
    ds_read_b64_tr_b16 v[34:35], v13 offset:5312
    v_mfma_f32_16x16x32_bf16 v[196:199], v[44:47], a[36:39], v[196:199]
    v_mfma_f32_16x16x32_bf16 v[192:195], v[44:47], a[32:35], v[192:195]
    buffer_store_dwordx4 v[144:147], v1, s[48:51], s66 offen offset:2048 sc1
    v_mfma_f32_16x16x32_bf16 v[192:195], v[40:43], a[0:3], v[192:195]
    s_waitcnt lgkmcnt(2)
    ds_read_b64_tr_b16 v[36:37], v13 offset:10432
    ds_read_b64_tr_b16 v[38:39], v13 offset:15552
    v_mfma_f32_16x16x32_bf16 v[176:179], v[16:19], a[64:67], v[176:179]
    s_nop 0
    v_cvt_pk_bf16_f32 v154, v168, v169
    v_cvt_pk_bf16_f32 v155, v170, v171
    v_mfma_f32_16x16x32_bf16 v[176:179], v[20:23], a[96:99], v[176:179]
    v_cvt_pk_bf16_f32 v156, v156, v157
    v_cvt_pk_bf16_f32 v157, v158, v159
    v_mfma_f32_16x16x32_bf16 v[180:183], v[20:23], a[100:103], v[180:183]
    v_cvt_pk_bf16_f32 v158, v172, v173
    v_cvt_pk_bf16_f32 v159, v174, v175
    v_mfma_f32_16x16x32_bf16 v[180:183], v[16:19], a[68:71], v[180:183]
    v_mfma_f32_16x16x32_bf16 v[184:187], v[16:19], a[72:75], v[184:187]
    ds_read_b64_tr_b16 v[40:41], v12 offset:256
    ds_read_b64_tr_b16 v[42:43], v12 offset:5376
    v_mfma_f32_16x16x32_bf16 v[184:187], v[20:23], a[104:107], v[184:187]
    s_add_u32 s11, s11, 4096
    v_mfma_f32_16x16x32_bf16 v[188:191], v[20:23], a[108:111], v[188:191]
    buffer_load_dwordx4 a[48:51], v1, s[48:51], s11 offen sc1
    v_mfma_f32_16x16x32_bf16 v[188:191], v[16:19], a[76:79], v[188:191]
    ds_read_b64_tr_b16 v[44:45], v12 offset:10496
    ds_read_b64_tr_b16 v[46:47], v12 offset:15616
    v_mfma_f32_16x16x32_bf16 v[204:207], v[24:27], a[76:79], v[204:207]
    buffer_store_dwordx4 v[148:151], v1, s[48:51], s67 offen offset:2048 sc1
    v_mfma_f32_16x16x32_bf16 v[204:207], v[28:31], a[108:111], v[204:207]
    v_mfma_f32_16x16x32_bf16 v[200:203], v[28:31], a[104:107], v[200:203]
    v_mfma_f32_16x16x32_bf16 v[200:203], v[24:27], a[72:75], v[200:203]
    v_mfma_f32_16x16x32_bf16 v[196:199], v[24:27], a[68:71], v[196:199]
    ds_read_b64_tr_b16 v[16:17], v10 offset:128
    ds_read_b64_tr_b16 v[18:19], v10 offset:5248
    v_mfma_f32_16x16x32_bf16 v[196:199], v[28:31], a[100:103], v[196:199]
    s_nop 0
    v_mfma_f32_16x16x32_bf16 v[192:195], v[28:31], a[96:99], v[192:195]
    buffer_store_dwordx4 v[152:155], v1, s[48:51], s68 offen offset:2048 sc1
    v_mfma_f32_16x16x32_bf16 v[192:195], v[24:27], a[64:67], v[192:195]
    s_waitcnt lgkmcnt(2)
    ds_read_b64_tr_b16 v[20:21], v10 offset:10368
    ds_read_b64_tr_b16 v[22:23], v10 offset:15488
    v_mfma_f32_16x16x32_bf16 v[176:179], v[32:35], a[128:131], v[176:179]
    v_mfma_f32_16x16x32_bf16 v[176:179], v[36:39], a[160:163], v[176:179]
    buffer_load_dwordx4 a[52:55], v1, s[48:51], s11 offen offset:1024 sc1
    v_mfma_f32_16x16x32_bf16 v[180:183], v[36:39], a[164:167], v[180:183]
    v_mfma_f32_16x16x32_bf16 v[180:183], v[32:35], a[132:135], v[180:183]
    v_mfma_f32_16x16x32_bf16 v[184:187], v[32:35], a[136:139], v[184:187]
    ds_read_b64_tr_b16 v[24:25], v11 offset:256
    ds_read_b64_tr_b16 v[26:27], v11 offset:5376
    v_mfma_f32_16x16x32_bf16 v[184:187], v[36:39], a[168:171], v[184:187]
    v_mfma_f32_16x16x32_bf16 v[188:191], v[36:39], a[172:175], v[188:191]
    buffer_store_dwordx4 v[156:159], v1, s[48:51], s69 offen offset:2048 sc1
    v_mfma_f32_16x16x32_bf16 v[188:191], v[32:35], a[140:143], v[188:191]
    ds_read_b64_tr_b16 v[28:29], v11 offset:10496
    ds_read_b64_tr_b16 v[30:31], v11 offset:15616
    v_mfma_f32_16x16x32_bf16 v[204:207], v[40:43], a[140:143], v[204:207]
    v_mfma_f32_16x16x32_bf16 v[204:207], v[44:47], a[172:175], v[204:207]
    v_mfma_f32_16x16x32_bf16 v[200:203], v[44:47], a[168:171], v[200:203]
    v_mfma_f32_16x16x32_bf16 v[200:203], v[40:43], a[136:139], v[200:203]
    v_mfma_f32_16x16x32_bf16 v[196:199], v[40:43], a[132:135], v[196:199]
    ds_read_b64_tr_b16 v[32:33], v10 offset:20608
    ds_read_b64_tr_b16 v[34:35], v10 offset:25728
    v_mfma_f32_16x16x32_bf16 v[196:199], v[44:47], a[164:167], v[196:199]
    buffer_load_dwordx4 a[56:59], v1, s[48:51], s11 offen offset:2048 sc1
    v_mfma_f32_16x16x32_bf16 v[192:195], v[44:47], a[160:163], v[192:195]
    s_nop 0
    v_mfma_f32_16x16x32_bf16 v[192:195], v[40:43], a[128:131], v[192:195]
    s_waitcnt lgkmcnt(2)
    ds_read_b64_tr_b16 v[36:37], v10 offset:30848
    ds_read_b64_tr_b16 v[38:39], v10 offset:35968
    v_mfma_f32_16x16x32_bf16 v[128:131], v[16:19], a[0:3], v[128:131]
    v_mfma_f32_16x16x32_bf16 v[128:131], v[20:23], a[32:35], v[128:131]
    v_mfma_f32_16x16x32_bf16 v[132:135], v[20:23], a[36:39], v[132:135]
    v_mfma_f32_16x16x32_bf16 v[132:135], v[16:19], a[4:7], v[132:135]
    v_cvt_pk_bf16_f32 v176, v176, v177
    v_cvt_pk_bf16_f32 v177, v178, v179
    v_mfma_f32_16x16x32_bf16 v[136:139], v[16:19], a[8:11], v[136:139]
    ds_read_b64_tr_b16 v[40:41], v11 offset:20736
    ds_read_b64_tr_b16 v[42:43], v11 offset:25856
    v_mfma_f32_16x16x32_bf16 v[136:139], v[20:23], a[40:43], v[136:139]
    v_cvt_pk_bf16_f32 v178, v192, v193
    v_cvt_pk_bf16_f32 v179, v194, v195
    v_mfma_f32_16x16x32_bf16 v[140:143], v[20:23], a[44:47], v[140:143]
    v_cvt_pk_bf16_f32 v180, v180, v181
    v_cvt_pk_bf16_f32 v181, v182, v183
    v_mfma_f32_16x16x32_bf16 v[140:143], v[16:19], a[12:15], v[140:143]
    ds_read_b64_tr_b16 v[44:45], v11 offset:30976
    ds_read_b64_tr_b16 v[46:47], v11 offset:36096
    v_mfma_f32_16x16x32_bf16 v[220:223], v[24:27], a[12:15], v[220:223]
    buffer_load_dwordx4 a[60:63], v1, s[48:51], s11 offen offset:3072 sc1
    v_mfma_f32_16x16x32_bf16 v[220:223], v[28:31], a[44:47], v[220:223]
    v_cvt_pk_bf16_f32 v182, v196, v197
    v_cvt_pk_bf16_f32 v183, v198, v199
    v_mfma_f32_16x16x32_bf16 v[216:219], v[28:31], a[40:43], v[216:219]
    v_cvt_pk_bf16_f32 v184, v184, v185
    v_cvt_pk_bf16_f32 v185, v186, v187
    v_mfma_f32_16x16x32_bf16 v[216:219], v[24:27], a[8:11], v[216:219]
    v_cvt_pk_bf16_f32 v186, v200, v201
    v_cvt_pk_bf16_f32 v187, v202, v203
    v_mfma_f32_16x16x32_bf16 v[212:215], v[24:27], a[4:7], v[212:215]
    ds_read_b64_tr_b16 v[16:17], v12 offset:128
    ds_read_b64_tr_b16 v[18:19], v12 offset:5248
    v_mfma_f32_16x16x32_bf16 v[212:215], v[28:31], a[36:39], v[212:215]
    buffer_store_dwordx4 v[176:179], v1, s[48:51], s66 offen offset:3072 sc1
    v_mfma_f32_16x16x32_bf16 v[208:211], v[28:31], a[32:35], v[208:211]
    v_cvt_pk_bf16_f32 v188, v188, v189
    v_cvt_pk_bf16_f32 v189, v190, v191
    v_mfma_f32_16x16x32_bf16 v[208:211], v[24:27], a[0:3], v[208:211]
    s_waitcnt lgkmcnt(2)
    ds_read_b64_tr_b16 v[20:21], v12 offset:10368
    ds_read_b64_tr_b16 v[22:23], v12 offset:15488
    v_mfma_f32_16x16x32_bf16 v[128:131], v[32:35], a[64:67], v[128:131]
    s_nop 0
    v_mfma_f32_16x16x32_bf16 v[128:131], v[36:39], a[96:99], v[128:131]
    buffer_store_dwordx4 v[180:183], v1, s[48:51], s67 offen offset:3072 sc1
    v_mfma_f32_16x16x32_bf16 v[132:135], v[36:39], a[100:103], v[132:135]
    v_cvt_pk_bf16_f32 v190, v204, v205
    v_cvt_pk_bf16_f32 v191, v206, v207
    v_mfma_f32_16x16x32_bf16 v[132:135], v[32:35], a[68:71], v[132:135]
    v_mfma_f32_16x16x32_bf16 v[136:139], v[32:35], a[72:75], v[136:139]
    ds_read_b64_tr_b16 v[24:25], v13 offset:256
    ds_read_b64_tr_b16 v[26:27], v13 offset:5376
    v_mfma_f32_16x16x32_bf16 v[136:139], v[36:39], a[104:107], v[136:139]
    v_mfma_f32_16x16x32_bf16 v[140:143], v[36:39], a[108:111], v[140:143]
    buffer_store_dwordx4 v[184:187], v1, s[48:51], s68 offen offset:3072 sc1
    v_mfma_f32_16x16x32_bf16 v[140:143], v[32:35], a[76:79], v[140:143]
    ds_read_b64_tr_b16 v[28:29], v13 offset:10496
    ds_read_b64_tr_b16 v[30:31], v13 offset:15616
    v_mfma_f32_16x16x32_bf16 v[220:223], v[40:43], a[76:79], v[220:223]
    v_mfma_f32_16x16x32_bf16 v[220:223], v[44:47], a[108:111], v[220:223]
    v_mfma_f32_16x16x32_bf16 v[216:219], v[44:47], a[104:107], v[216:219]
    buffer_store_dwordx4 v[188:191], v1, s[48:51], s69 offen offset:3072 sc1
    v_mfma_f32_16x16x32_bf16 v[216:219], v[40:43], a[72:75], v[216:219]
    v_mfma_f32_16x16x32_bf16 v[212:215], v[40:43], a[68:71], v[212:215]
    s_waitcnt lgkmcnt(0)
    s_barrier
    v_mfma_f32_16x16x32_bf16 v[212:215], v[44:47], a[100:103], v[212:215]
    v_mfma_f32_16x16x32_bf16 v[208:211], v[44:47], a[96:99], v[208:211]
    s_add_u32 s8, s8, 4096
    s_add_u32 m0, s34, 40960
    s_nop 0
    buffer_load_dwordx4 v3, s[48:51], s8 offen sc1 lds
    v_mfma_f32_16x16x32_bf16 v[208:211], v[40:43], a[64:67], v[208:211]
    v_mfma_f32_16x16x32_bf16 v[128:131], v[16:19], a[128:131], v[128:131]
    s_add_u32 s8, s8, 4096
    s_add_u32 m0, s34, 45056
    s_nop 0
    buffer_load_dwordx4 v3, s[48:51], s8 offen sc1 lds
    v_mfma_f32_16x16x32_bf16 v[128:131], v[20:23], a[160:163], v[128:131]
    v_mfma_f32_16x16x32_bf16 v[132:135], v[20:23], a[164:167], v[132:135]
    s_add_u32 s8, s8, 4096
    s_add_u32 m0, s34, 49152
    s_nop 0
    buffer_load_dwordx4 v3, s[48:51], s8 offen sc1 lds
    v_mfma_f32_16x16x32_bf16 v[132:135], v[16:19], a[132:135], v[132:135]
    v_mfma_f32_16x16x32_bf16 v[136:139], v[16:19], a[136:139], v[136:139]
    s_add_u32 s8, s8, 4096
    s_add_u32 m0, s34, 53248
    s_nop 0
    buffer_load_dwordx4 v3, s[48:51], s8 offen sc1 lds
    v_mfma_f32_16x16x32_bf16 v[136:139], v[20:23], a[168:171], v[136:139]
    v_mfma_f32_16x16x32_bf16 v[140:143], v[20:23], a[172:175], v[140:143]
    s_add_u32 s8, s8, 4096
    s_add_u32 m0, s34, 57344
    s_nop 0
    buffer_load_dwordx4 v3, s[48:51], s8 offen sc1 lds
    v_mfma_f32_16x16x32_bf16 v[140:143], v[16:19], a[140:143], v[140:143]
    v_mfma_f32_16x16x32_bf16 v[220:223], v[24:27], a[140:143], v[220:223]
    s_add_u32 s8, s8, 4096
    s_add_u32 m0, s34, 61440
    s_nop 0
    buffer_load_dwordx4 v3, s[48:51], s8 offen sc1 lds
    v_mfma_f32_16x16x32_bf16 v[220:223], v[28:31], a[172:175], v[220:223]
    s_nop 0
    v_mfma_f32_16x16x32_bf16 v[216:219], v[28:31], a[168:171], v[216:219]
    s_add_u32 s8, s8, 4096
    s_add_u32 m0, s34, 65536
    s_nop 0
    buffer_load_dwordx4 v3, s[48:51], s8 offen sc1 lds
    v_mfma_f32_16x16x32_bf16 v[216:219], v[24:27], a[136:139], v[216:219]
    v_mfma_f32_16x16x32_bf16 v[212:215], v[24:27], a[132:135], v[212:215]
    s_add_u32 s8, s8, 4096
    s_add_u32 m0, s34, 69632
    s_nop 0
    buffer_load_dwordx4 v3, s[48:51], s8 offen sc1 lds
    v_mfma_f32_16x16x32_bf16 v[212:215], v[28:31], a[164:167], v[212:215]
    s_nop 0
    v_mfma_f32_16x16x32_bf16 v[208:211], v[28:31], a[160:163], v[208:211]
    v_mfma_f32_16x16x32_bf16 v[208:211], v[24:27], a[128:131], v[208:211]
    v_add_u32 v8, 61440, v48
    v_add_u32 v9, 122880, v48
    ds_read_b64_tr_b16 a[32:33], v9 offset:0
    ds_read_b64_tr_b16 a[34:35], v9 offset:2560
    ds_read_b64_tr_b16 a[36:37], v9 offset:5120
    ds_read_b64_tr_b16 a[38:39], v9 offset:7680
    ds_read_b64_tr_b16 a[40:41], v9 offset:10240
    ds_read_b64_tr_b16 a[42:43], v9 offset:12800
    ds_read_b64_tr_b16 a[44:45], v9 offset:15360
    ds_read_b64_tr_b16 a[46:47], v9 offset:17920
    ds_read_b64_tr_b16 a[64:65], v9 offset:15392
    ds_read_b64_tr_b16 a[66:67], v9 offset:17952
    ds_read_b64_tr_b16 a[68:69], v9 offset:10272
    ds_read_b64_tr_b16 a[70:71], v9 offset:12832
    ds_read_b64_tr_b16 a[72:73], v9 offset:5152
    ds_read_b64_tr_b16 a[74:75], v9 offset:7712
    ds_read_b64_tr_b16 a[76:77], v9 offset:32
    ds_read_b64_tr_b16 a[78:79], v9 offset:2592
    ds_read_b64_tr_b16 a[96:97], v9 offset:64
    ds_read_b64_tr_b16 a[98:99], v9 offset:2624
    ds_read_b64_tr_b16 a[100:101], v9 offset:5184
    ds_read_b64_tr_b16 a[102:103], v9 offset:7744
    ds_read_b64_tr_b16 a[104:105], v9 offset:10304
    ds_read_b64_tr_b16 a[106:107], v9 offset:12864
    ds_read_b64_tr_b16 a[108:109], v9 offset:15424
    ds_read_b64_tr_b16 a[110:111], v9 offset:17984
    v_cvt_pk_bf16_f32 v128, v128, v129
    v_cvt_pk_bf16_f32 v129, v130, v131
    v_cvt_pk_bf16_f32 v130, v208, v209
    v_cvt_pk_bf16_f32 v131, v210, v211
    v_cvt_pk_bf16_f32 v132, v132, v133
    v_cvt_pk_bf16_f32 v133, v134, v135
    v_cvt_pk_bf16_f32 v134, v212, v213
    v_cvt_pk_bf16_f32 v135, v214, v215
    v_cvt_pk_bf16_f32 v136, v136, v137
    v_cvt_pk_bf16_f32 v137, v138, v139
    v_cvt_pk_bf16_f32 v138, v216, v217
    v_cvt_pk_bf16_f32 v139, v218, v219
    v_cvt_pk_bf16_f32 v140, v140, v141
    v_cvt_pk_bf16_f32 v141, v142, v143
    v_cvt_pk_bf16_f32 v142, v220, v221
    v_cvt_pk_bf16_f32 v143, v222, v223
    v_permlane16_swap_b32 v128, v130
    v_permlane16_swap_b32 v129, v131
    v_permlane16_swap_b32 v132, v134
    v_permlane16_swap_b32 v133, v135
    v_permlane16_swap_b32 v136, v138
    v_permlane16_swap_b32 v137, v139
    v_permlane16_swap_b32 v140, v142
    v_permlane16_swap_b32 v141, v143
    buffer_store_dwordx4 v[128:131], v2, s[48:51], s66 offen sc1
    buffer_store_dwordx4 v[132:135], v2, s[48:51], s67 offen sc1
    s_waitcnt lgkmcnt(15)
    v_mfma_f32_16x16x32_bf16 v[16:19], a[32:35], a[192:195], 0
    s_add_u32 s8, s8, 4096
    s_add_u32 m0, s34, 73728
    ds_read_b64_tr_b16 a[128:129], v9 offset:15456
    ds_read_b64_tr_b16 a[130:131], v9 offset:18016
    s_waitcnt vmcnt(40)
    buffer_load_dwordx4 v3, s[48:51], s8 offen sc1 lds
    v_mfma_f32_16x16x32_bf16 v[16:19], a[36:39], a[196:199], v[16:19]
    ds_read_b64_tr_b16 a[132:133], v9 offset:10336
    ds_read_b64_tr_b16 a[134:135], v9 offset:12896
    buffer_store_dwordx4 v[136:139], v2, s[48:51], s68 offen sc1
    v_mfma_f32_16x16x32_bf16 v[16:19], a[40:43], a[200:203], v[16:19]
    s_add_u32 s11, s11, 4096
    ds_read_b64_tr_b16 a[136:137], v9 offset:5216
    ds_read_b64_tr_b16 a[138:139], v9 offset:7776
    buffer_load_dwordx4 a[80:83], v1, s[48:51], s11 offen sc1
    v_mfma_f32_16x16x32_bf16 v[16:19], a[44:47], a[204:207], v[16:19]
    s_nop 0
    s_waitcnt lgkmcnt(15)
    s_add_u32 s8, s8, 4096
    ds_read_b64_tr_b16 a[140:141], v9 offset:96
    ds_read_b64_tr_b16 a[142:143], v9 offset:2656
    v_mfma_f32_16x16x32_bf16 v[20:23], a[64:67], a[204:207], 0
    s_add_u32 m0, s34, 77824
    ds_read_b64_tr_b16 a[32:33], v9 offset:128
    ds_read_b64_tr_b16 a[34:35], v9 offset:2688
    buffer_load_dwordx4 v3, s[48:51], s8 offen sc1 lds
    v_mfma_f32_16x16x32_bf16 v[20:23], a[68:71], a[200:203], v[20:23]
    ds_read_b64_tr_b16 a[36:37], v9 offset:5248
    ds_read_b64_tr_b16 a[38:39], v9 offset:7808
    v_mfma_f32_16x16x32_bf16 v[20:23], a[72:75], a[196:199], v[20:23]
    s_waitcnt lgkmcnt(10)
    ds_read_b64_tr_b16 a[40:41], v9 offset:10368
    ds_read_b64_tr_b16 a[42:43], v9 offset:12928
    s_nop 0
    buffer_load_dwordx4 a[84:87], v1, s[48:51], s11 offen offset:1024 sc1
    v_mfma_f32_16x16x32_bf16 v[20:23], a[76:79], a[192:195], v[20:23]
    ds_read_b64_tr_b16 a[44:45], v9 offset:15488
    ds_read_b64_tr_b16 a[46:47], v9 offset:18048
    v_mfma_f32_16x16x32_bf16 v[24:27], a[96:99], a[192:195], 0
    s_add_u32 s8, s8, 4096
    ds_read_b64_tr_b16 a[64:65], v9 offset:20480
    ds_read_b64_tr_b16 a[66:67], v9 offset:23040
    v_mfma_f32_16x16x32_bf16 v[24:27], a[100:103], a[196:199], v[24:27]
    s_add_u32 m0, s34, 81920
    ds_read_b64_tr_b16 a[68:69], v9 offset:25600
    ds_read_b64_tr_b16 a[70:71], v9 offset:28160
    buffer_load_dwordx4 v3, s[48:51], s8 offen sc1 lds
    v_mfma_f32_16x16x32_bf16 v[24:27], a[104:107], a[200:203], v[24:27]
    ds_read_b64_tr_b16 a[72:73], v9 offset:30720
    ds_read_b64_tr_b16 a[74:75], v9 offset:33280
    buffer_store_dwordx4 v[140:143], v2, s[48:51], s69 offen sc1
    v_mfma_f32_16x16x32_bf16 v[24:27], a[108:111], a[204:207], v[24:27]
    ds_read_b64_tr_b16 a[76:77], v9 offset:35840
    ds_read_b64_tr_b16 a[78:79], v9 offset:38400
    buffer_load_dwordx4 a[88:91], v1, s[48:51], s11 offen offset:2048 sc1
    v_mfma_f32_16x16x32_bf16 v[28:31], a[128:131], a[204:207], 0
    s_waitcnt lgkmcnt(10)
    s_add_u32 s8, s8, 4096
    s_nop 0
    ds_read_b64_tr_b16 a[96:97], v9 offset:35872
    ds_read_b64_tr_b16 a[98:99], v9 offset:38432
    v_mfma_f32_16x16x32_bf16 v[28:31], a[132:135], a[200:203], v[28:31]
    s_add_u32 m0, s34, 86016
    ds_read_b64_tr_b16 a[100:101], v9 offset:30752
    ds_read_b64_tr_b16 a[102:103], v9 offset:33312
    buffer_load_dwordx4 v3, s[48:51], s8 offen sc1 lds
    v_mfma_f32_16x16x32_bf16 v[28:31], a[136:139], a[196:199], v[28:31]
    ds_read_b64_tr_b16 a[104:105], v9 offset:25632
    ds_read_b64_tr_b16 a[106:107], v9 offset:28192
    v_mfma_f32_16x16x32_bf16 v[28:31], a[140:143], a[192:195], v[28:31]
    ds_read_b64_tr_b16 a[108:109], v9 offset:20512
    ds_read_b64_tr_b16 a[110:111], v9 offset:23072
    buffer_load_dwordx4 a[92:95], v1, s[48:51], s11 offen offset:3072 sc1
    v_mfma_f32_16x16x32_bf16 v[32:35], a[32:35], a[192:195], 0
    ds_read_b64_tr_b16 a[128:129], v9 offset:20544
    ds_read_b64_tr_b16 a[130:131], v9 offset:23104
    v_mfma_f32_16x16x32_bf16 v[32:35], a[36:39], a[196:199], v[32:35]
    s_add_u32 s8, s8, 4096
    ds_read_b64_tr_b16 a[132:133], v9 offset:25664
    ds_read_b64_tr_b16 a[134:135], v9 offset:28224
    v_mfma_f32_16x16x32_bf16 v[32:35], a[40:43], a[200:203], v[32:35]
    s_waitcnt lgkmcnt(10)
    s_add_u32 m0, s34, 90112
    s_nop 0
    ds_read_b64_tr_b16 a[136:137], v9 offset:30784
    ds_read_b64_tr_b16 a[138:139], v9 offset:33344
    buffer_load_dwordx4 v3, s[48:51], s8 offen sc1 lds
    v_mfma_f32_16x16x32_bf16 v[32:35], a[44:47], a[204:207], v[32:35]
    ds_read_b64_tr_b16 a[140:141], v9 offset:35904
    ds_read_b64_tr_b16 a[142:143], v9 offset:38464
    v_mfma_f32_16x16x32_bf16 v[16:19], a[64:67], a[208:211], v[16:19]
    s_add_u32 s11, s11, 4096
    ds_read_b64_tr_b16 a[32:33], v9 offset:35936
    ds_read_b64_tr_b16 a[34:35], v9 offset:38496
    buffer_load_dwordx4 a[112:115], v1, s[48:51], s11 offen sc1
    v_mfma_f32_16x16x32_bf16 v[16:19], a[68:71], a[212:215], v[16:19]
    s_add_u32 s8, s8, 4096
    ds_read_b64_tr_b16 a[36:37], v9 offset:30816
    ds_read_b64_tr_b16 a[38:39], v9 offset:33376
    v_mfma_f32_16x16x32_bf16 v[16:19], a[72:75], a[216:219], v[16:19]
    s_add_u32 m0, s34, 94208
    ds_read_b64_tr_b16 a[40:41], v9 offset:25696
    ds_read_b64_tr_b16 a[42:43], v9 offset:28256
    buffer_load_dwordx4 v3, s[48:51], s8 offen sc1 lds
    v_mfma_f32_16x16x32_bf16 v[16:19], a[76:79], a[220:223], v[16:19]
    s_nop 0
    ds_read_b64_tr_b16 a[44:45], v9 offset:20576
    ds_read_b64_tr_b16 a[46:47], v9 offset:23136
    v_mfma_f32_16x16x32_bf16 v[20:23], a[96:99], a[220:223], v[20:23]
    s_waitcnt lgkmcnt(10)
    ds_read_b64_tr_b16 a[64:65], v9 offset:20608
    ds_read_b64_tr_b16 a[66:67], v9 offset:23168
    buffer_load_dwordx4 a[116:119], v1, s[48:51], s11 offen offset:1024 sc1
    v_mfma_f32_16x16x32_bf16 v[20:23], a[100:103], a[216:219], v[20:23]
    ds_read_b64_tr_b16 a[68:69], v9 offset:25728
    ds_read_b64_tr_b16 a[70:71], v9 offset:28288
    v_mfma_f32_16x16x32_bf16 v[20:23], a[104:107], a[212:215], v[20:23]
    ds_read_b64_tr_b16 a[72:73], v9 offset:30848
    ds_read_b64_tr_b16 a[74:75], v9 offset:33408
    v_mfma_f32_16x16x32_bf16 v[20:23], a[108:111], a[208:211], v[20:23]
    s_waitcnt vmcnt(49)
    s_barrier
    v_mfma_f32_16x16x32_bf16 v[24:27], a[128:131], a[208:211], v[24:27]
    s_add_u32 s8, s8, 4096
    s_add_u32 m0, s34, 98304
    ds_read_b64_tr_b16 a[76:77], v9 offset:35968
    ds_read_b64_tr_b16 a[78:79], v9 offset:38528
    buffer_load_dwordx4 v3, s[48:51], s8 offen sc1 lds
    v_mfma_f32_16x16x32_bf16 v[24:27], a[132:135], a[212:215], v[24:27]
    ds_read_b64_tr_b16 a[96:97], v48 offset:0
    ds_read_b64_tr_b16 a[98:99], v48 offset:2560
    buffer_load_dwordx4 a[120:123], v1, s[48:51], s11 offen offset:2048 sc1
    v_mfma_f32_16x16x32_bf16 v[24:27], a[136:139], a[216:219], v[24:27]
    s_waitcnt lgkmcnt(8)
    s_nop 0
    s_add_u32 s8, s8, 4096
    ds_read_b64_tr_b16 a[100:101], v48 offset:5120
    ds_read_b64_tr_b16 a[102:103], v48 offset:7680
    v_mfma_f32_16x16x32_bf16 v[24:27], a[140:143], a[220:223], v[24:27]
    s_add_u32 m0, s34, 102400
    ds_read_b64_tr_b16 a[104:105], v48 offset:10240
    ds_read_b64_tr_b16 a[106:107], v48 offset:12800
    buffer_load_dwordx4 v3, s[48:51], s8 offen sc1 lds
    v_mfma_f32_16x16x32_bf16 v[28:31], a[32:35], a[220:223], v[28:31]
    ds_read_b64_tr_b16 a[108:109], v48 offset:15360
    ds_read_b64_tr_b16 a[110:111], v48 offset:17920
    v_mfma_f32_16x16x32_bf16 v[28:31], a[36:39], a[216:219], v[28:31]
    ds_read_b64_tr_b16 a[128:129], v48 offset:15392
    ds_read_b64_tr_b16 a[130:131], v48 offset:17952
    buffer_load_dwordx4 a[124:127], v1, s[48:51], s11 offen offset:3072 sc1
    v_mfma_f32_16x16x32_bf16 v[28:31], a[40:43], a[212:215], v[28:31]
    ds_read_b64_tr_b16 a[132:133], v48 offset:10272
    ds_read_b64_tr_b16 a[134:135], v48 offset:12832
    v_mfma_f32_16x16x32_bf16 v[28:31], a[44:47], a[208:211], v[28:31]
    s_add_u32 s8, s8, 4096
    ds_read_b64_tr_b16 a[136:137], v48 offset:5152
    ds_read_b64_tr_b16 a[138:139], v48 offset:7712
    v_mfma_f32_16x16x32_bf16 v[32:35], a[64:67], a[208:211], v[32:35]
    s_waitcnt lgkmcnt(10)
    s_nop 0
    s_add_u32 m0, s34, 106496
    ds_read_b64_tr_b16 a[140:141], v48 offset:32
    ds_read_b64_tr_b16 a[142:143], v48 offset:2592
    buffer_load_dwordx4 v3, s[48:51], s8 offen sc1 lds
    v_mfma_f32_16x16x32_bf16 v[32:35], a[68:71], a[212:215], v[32:35]
    ds_read_b64_tr_b16 a[32:33], v48 offset:64
    ds_read_b64_tr_b16 a[34:35], v48 offset:2624
    v_mfma_f32_16x16x32_bf16 v[32:35], a[72:75], a[216:219], v[32:35]
    s_add_u32 s11, s11, 4096
    ds_read_b64_tr_b16 a[36:37], v48 offset:5184
    ds_read_b64_tr_b16 a[38:39], v48 offset:7744
    buffer_load_dwordx4 a[0:3], v1, s[48:51], s11 offen sc1
    v_mfma_f32_16x16x32_bf16 v[32:35], a[76:79], a[220:223], v[32:35]
    s_add_u32 s8, s8, 4096
    ds_read_b64_tr_b16 a[40:41], v48 offset:10304
    ds_read_b64_tr_b16 a[42:43], v48 offset:12864
    v_mfma_f32_16x16x32_bf16 v[16:19], a[96:99], a[224:227], v[16:19]
    s_add_u32 m0, s34, 110592
    ds_read_b64_tr_b16 a[44:45], v48 offset:15424
    ds_read_b64_tr_b16 a[46:47], v48 offset:17984
    buffer_load_dwordx4 v3, s[48:51], s8 offen sc1 lds
    v_mfma_f32_16x16x32_bf16 v[16:19], a[100:103], a[228:231], v[16:19]
    s_waitcnt lgkmcnt(10)
    ds_read_b64_tr_b16 a[64:65], v48 offset:15456
    s_nop 0
    ds_read_b64_tr_b16 a[66:67], v48 offset:18016
    v_mfma_f32_16x16x32_bf16 v[16:19], a[104:107], a[232:235], v[16:19]
    ds_read_b64_tr_b16 a[68:69], v48 offset:10336
    ds_read_b64_tr_b16 a[70:71], v48 offset:12896
    buffer_load_dwordx4 a[4:7], v1, s[48:51], s11 offen offset:1024 sc1
    v_mfma_f32_16x16x32_bf16 v[16:19], a[108:111], a[236:239], v[16:19]
    ds_read_b64_tr_b16 a[72:73], v48 offset:5216
    ds_read_b64_tr_b16 a[74:75], v48 offset:7776
    v_mfma_f32_16x16x32_bf16 v[20:23], a[128:131], a[236:239], v[20:23]
    s_add_u32 s8, s8, 4096
    ds_read_b64_tr_b16 a[76:77], v48 offset:96
    ds_read_b64_tr_b16 a[78:79], v48 offset:2656
    v_mfma_f32_16x16x32_bf16 v[20:23], a[132:135], a[232:235], v[20:23]
    s_add_u32 m0, s34, 114688
    ds_read_b64_tr_b16 a[96:97], v48 offset:128
    ds_read_b64_tr_b16 a[98:99], v48 offset:2688
    buffer_load_dwordx4 v3, s[48:51], s8 offen sc1 lds
    v_mfma_f32_16x16x32_bf16 v[20:23], a[136:139], a[228:231], v[20:23]
    s_waitcnt lgkmcnt(10)
    ds_read_b64_tr_b16 a[100:101], v48 offset:5248
    s_nop 0
    ds_read_b64_tr_b16 a[102:103], v48 offset:7808
    v_mfma_f32_16x16x32_bf16 v[20:23], a[140:143], a[224:227], v[20:23]
    s_nop 0
    ds_read_b64_tr_b16 a[104:105], v48 offset:10368
    ds_read_b64_tr_b16 a[106:107], v48 offset:12928
    s_waitcnt vmcnt(40)
    buffer_load_dwordx4 a[8:11], v1, s[48:51], s11 offen offset:2048 sc1
    v_mfma_f32_16x16x32_bf16 v[24:27], a[32:35], a[224:227], v[24:27]
    s_add_u32 s8, s8, 4096
    ds_read_b64_tr_b16 a[108:109], v48 offset:15488
    ds_read_b64_tr_b16 a[110:111], v48 offset:18048
    v_mfma_f32_16x16x32_bf16 v[24:27], a[36:39], a[228:231], v[24:27]
    s_add_u32 m0, s34, 118784
    ds_read_b64_tr_b16 a[128:129], v48 offset:20480
    ds_read_b64_tr_b16 a[130:131], v48 offset:23040
    buffer_load_dwordx4 v3, s[48:51], s8 offen sc1 lds
    v_mfma_f32_16x16x32_bf16 v[24:27], a[40:43], a[232:235], v[24:27]
    ds_read_b64_tr_b16 a[132:133], v48 offset:25600
    ds_read_b64_tr_b16 a[134:135], v48 offset:28160
    v_mfma_f32_16x16x32_bf16 v[24:27], a[44:47], a[236:239], v[24:27]
    s_waitcnt lgkmcnt(10)
    s_nop 0
    ds_read_b64_tr_b16 a[136:137], v48 offset:30720
    ds_read_b64_tr_b16 a[138:139], v48 offset:33280
    buffer_load_dwordx4 a[12:15], v1, s[48:51], s11 offen offset:3072 sc1
    v_mfma_f32_16x16x32_bf16 v[28:31], a[64:67], a[236:239], v[28:31]
    ds_read_b64_tr_b16 a[140:141], v48 offset:35840
    ds_read_b64_tr_b16 a[142:143], v48 offset:38400
    v_mfma_f32_16x16x32_bf16 v[28:31], a[68:71], a[232:235], v[28:31]
    ds_read_b64_tr_b16 a[32:33], v48 offset:35872
    ds_read_b64_tr_b16 a[34:35], v48 offset:38432
    v_mfma_f32_16x16x32_bf16 v[28:31], a[72:75], a[228:231], v[28:31]
    ds_read_b64_tr_b16 a[36:37], v48 offset:30752
    ds_read_b64_tr_b16 a[38:39], v48 offset:33312
    v_mfma_f32_16x16x32_bf16 v[28:31], a[76:79], a[224:227], v[28:31]
    s_nop 0
    ds_read_b64_tr_b16 a[40:41], v48 offset:25632
    ds_read_b64_tr_b16 a[42:43], v48 offset:28192
    v_mfma_f32_16x16x32_bf16 v[32:35], a[96:99], a[224:227], v[32:35]
    s_waitcnt lgkmcnt(10)
    ds_read_b64_tr_b16 a[44:45], v48 offset:20512
    ds_read_b64_tr_b16 a[46:47], v48 offset:23072
    v_mfma_f32_16x16x32_bf16 v[32:35], a[100:103], a[228:231], v[32:35]
    ds_read_b64_tr_b16 a[64:65], v48 offset:20544
    ds_read_b64_tr_b16 a[66:67], v48 offset:23104
    v_mfma_f32_16x16x32_bf16 v[32:35], a[104:107], a[232:235], v[32:35]
    ds_read_b64_tr_b16 a[68:69], v48 offset:25664
    ds_read_b64_tr_b16 a[70:71], v48 offset:28224
    v_mfma_f32_16x16x32_bf16 v[32:35], a[108:111], a[236:239], v[32:35]
    ds_read_b64_tr_b16 a[72:73], v48 offset:30784
    ds_read_b64_tr_b16 a[74:75], v48 offset:33344
    v_mfma_f32_16x16x32_bf16 v[16:19], a[128:131], a[240:243], v[16:19]
    s_nop 0
    ds_read_b64_tr_b16 a[76:77], v48 offset:35904
    ds_read_b64_tr_b16 a[78:79], v48 offset:38464
    v_mfma_f32_16x16x32_bf16 v[16:19], a[132:135], a[244:247], v[16:19]
    s_waitcnt lgkmcnt(10)
    ds_read_b64_tr_b16 a[96:97], v48 offset:35936
    ds_read_b64_tr_b16 a[98:99], v48 offset:38496
    v_mfma_f32_16x16x32_bf16 v[16:19], a[136:139], a[248:251], v[16:19]
    ds_read_b64_tr_b16 a[100:101], v48 offset:30816
    ds_read_b64_tr_b16 a[102:103], v48 offset:33376
    v_mfma_f32_16x16x32_bf16 v[16:19], a[140:143], a[252:255], v[16:19]
    ds_read_b64_tr_b16 a[104:105], v48 offset:25696
    ds_read_b64_tr_b16 a[106:107], v48 offset:28256
    v_mfma_f32_16x16x32_bf16 v[20:23], a[32:35], a[252:255], v[20:23]
    ds_read_b64_tr_b16 a[108:109], v48 offset:20576
    ds_read_b64_tr_b16 a[110:111], v48 offset:23136
    v_mfma_f32_16x16x32_bf16 v[20:23], a[36:39], a[248:251], v[20:23]
    ds_read_b64_tr_b16 a[128:129], v48 offset:20608
    ds_read_b64_tr_b16 a[130:131], v48 offset:23168
    v_mfma_f32_16x16x32_bf16 v[20:23], a[40:43], a[244:247], v[20:23]
    s_waitcnt lgkmcnt(10)
    ds_read_b64_tr_b16 a[132:133], v48 offset:25728
    ds_read_b64_tr_b16 a[134:135], v48 offset:28288
    v_mfma_f32_16x16x32_bf16 v[20:23], a[44:47], a[240:243], v[20:23]
    s_waitcnt vmcnt(19)
    s_barrier
    s_cmp_lg_u32 s30, 0
    s_cbranch_scc1 L_sig26
    s_mov_b32 s3, s10
    s_mov_b64 exec, 1
    v_mov_b32 v6, 0
    v_mov_b32 v7, 1
    buffer_atomic_add v7, v6, s[48:51], s3 offen
    s_mov_b64 exec, -1
L_sig26:
    v_mfma_f32_16x16x32_bf16 v[24:27], a[64:67], a[240:243], v[24:27]
    s_add_u32 s8, s8, 4096
    s_add_u32 m0, s34, 122880
    ds_read_b64_tr_b16 a[136:137], v48 offset:30848
    ds_read_b64_tr_b16 a[138:139], v48 offset:33408
    buffer_load_dwordx4 v3, s[48:51], s8 offen sc1 lds
    v_mfma_f32_16x16x32_bf16 v[24:27], a[68:71], a[244:247], v[24:27]
    ds_read_b64_tr_b16 a[140:141], v48 offset:35968
    ds_read_b64_tr_b16 a[142:143], v48 offset:38528
    v_mfma_f32_16x16x32_bf16 v[24:27], a[72:75], a[248:251], v[24:27]
    s_add_u32 s8, s8, 4096
    ds_read_b64_tr_b16 a[32:33], v48 offset:40960
    ds_read_b64_tr_b16 a[34:35], v48 offset:43520
    v_mfma_f32_16x16x32_bf16 v[24:27], a[76:79], a[252:255], v[24:27]
    s_waitcnt lgkmcnt(8)
    s_nop 0
    s_add_u32 m0, s34, 126976
    ds_read_b64_tr_b16 a[36:37], v48 offset:46080
    ds_read_b64_tr_b16 a[38:39], v48 offset:48640
    buffer_load_dwordx4 v3, s[48:51], s8 offen sc1 lds
    v_mfma_f32_16x16x32_bf16 v[28:31], a[96:99], a[252:255], v[28:31]
    ds_read_b64_tr_b16 a[40:41], v48 offset:51200
    ds_read_b64_tr_b16 a[42:43], v48 offset:53760
    v_mfma_f32_16x16x32_bf16 v[28:31], a[100:103], a[248:251], v[28:31]
    ds_read_b64_tr_b16 a[44:45], v48 offset:56320
    ds_read_b64_tr_b16 a[46:47], v48 offset:58880
    v_mfma_f32_16x16x32_bf16 v[28:31], a[104:107], a[244:247], v[28:31]
    s_add_u32 s8, s8, 4096
    ds_read_b64_tr_b16 a[64:65], v48 offset:56352
    ds_read_b64_tr_b16 a[66:67], v48 offset:58912
    v_mfma_f32_16x16x32_bf16 v[28:31], a[108:111], a[240:243], v[28:31]
    s_add_u32 m0, s34, 131072
    ds_read_b64_tr_b16 a[68:69], v48 offset:51232
    ds_read_b64_tr_b16 a[70:71], v48 offset:53792
    buffer_load_dwordx4 v3, s[48:51], s8 offen sc1 lds
    v_mfma_f32_16x16x32_bf16 v[32:35], a[128:131], a[240:243], v[32:35]
    s_nop 0
    s_waitcnt lgkmcnt(10)
    ds_read_b64_tr_b16 a[72:73], v48 offset:46112
    ds_read_b64_tr_b16 a[74:75], v48 offset:48672
    v_mfma_f32_16x16x32_bf16 v[32:35], a[132:135], a[244:247], v[32:35]
    s_add_u32 s8, s8, 4096
    ds_read_b64_tr_b16 a[76:77], v48 offset:40992
    ds_read_b64_tr_b16 a[78:79], v48 offset:43552
    v_mfma_f32_16x16x32_bf16 v[32:35], a[136:139], a[248:251], v[32:35]
    s_add_u32 m0, s34, 135168
    ds_read_b64_tr_b16 a[96:97], v48 offset:41024
    ds_read_b64_tr_b16 a[98:99], v48 offset:43584
    buffer_load_dwordx4 v3, s[48:51], s8 offen sc1 lds
    v_mfma_f32_16x16x32_bf16 v[32:35], a[140:143], a[252:255], v[32:35]
    s_nop 0
    ds_read_b64_tr_b16 a[100:101], v48 offset:46144
    ds_read_b64_tr_b16 a[102:103], v48 offset:48704
    v_mfma_f32_16x16x32_bf16 v[16:19], a[32:35], v[224:227], v[16:19]
    s_waitcnt lgkmcnt(10)
    ds_read_b64_tr_b16 a[104:105], v48 offset:51264
    ds_read_b64_tr_b16 a[106:107], v48 offset:53824
    v_mfma_f32_16x16x32_bf16 v[16:19], a[36:39], v[228:231], v[16:19]
    s_add_u32 s8, s8, 4096
    ds_read_b64_tr_b16 a[108:109], v48 offset:56384
    ds_read_b64_tr_b16 a[110:111], v48 offset:58944
    v_mfma_f32_16x16x32_bf16 v[16:19], a[40:43], v[232:235], v[16:19]
    s_add_u32 m0, s34, 139264
    ds_read_b64_tr_b16 a[128:129], v48 offset:56416
    ds_read_b64_tr_b16 a[130:131], v48 offset:58976
    buffer_load_dwordx4 v3, s[48:51], s8 offen sc1 lds
    v_mfma_f32_16x16x32_bf16 v[16:19], a[44:47], v[236:239], v[16:19]
    s_nop 0
    ds_read_b64_tr_b16 a[132:133], v48 offset:51296
    ds_read_b64_tr_b16 a[134:135], v48 offset:53856
    v_mfma_f32_16x16x32_bf16 v[20:23], a[64:67], v[236:239], v[20:23]
    s_waitcnt lgkmcnt(10)
    ds_read_b64_tr_b16 a[136:137], v48 offset:46176
    ds_read_b64_tr_b16 a[138:139], v48 offset:48736
    v_mfma_f32_16x16x32_bf16 v[20:23], a[68:71], v[232:235], v[20:23]
    s_add_u32 s8, s8, 4096
    ds_read_b64_tr_b16 a[140:141], v48 offset:41056
    ds_read_b64_tr_b16 a[142:143], v48 offset:43616
    v_mfma_f32_16x16x32_bf16 v[20:23], a[72:75], v[228:231], v[20:23]
    s_add_u32 m0, s34, 143360
    ds_read_b64_tr_b16 a[32:33], v48 offset:41088
    ds_read_b64_tr_b16 a[34:35], v48 offset:43648
    buffer_load_dwordx4 v3, s[48:51], s8 offen sc1 lds
    v_mfma_f32_16x16x32_bf16 v[20:23], a[76:79], v[224:227], v[20:23]
    s_nop 0
    ds_read_b64_tr_b16 a[36:37], v48 offset:46208
    ds_read_b64_tr_b16 a[38:39], v48 offset:48768
    v_mfma_f32_16x16x32_bf16 v[24:27], a[96:99], v[224:227], v[24:27]
    s_waitcnt lgkmcnt(10)
    s_add_u32 s8, s8, 4096
    ds_read_b64_tr_b16 a[40:41], v48 offset:51328
    ds_read_b64_tr_b16 a[42:43], v48 offset:53888
    v_mfma_f32_16x16x32_bf16 v[24:27], a[100:103], v[228:231], v[24:27]
    s_add_u32 m0, s34, 147456
    ds_read_b64_tr_b16 a[44:45], v48 offset:56448
    ds_read_b64_tr_b16 a[46:47], v48 offset:59008
    buffer_load_dwordx4 v3, s[48:51], s8 offen sc1 lds
    v_mfma_f32_16x16x32_bf16 v[24:27], a[104:107], v[232:235], v[24:27]
    ds_read_b64_tr_b16 a[64:65], v8 offset:0
    ds_read_b64_tr_b16 a[66:67], v8 offset:2560
    v_mfma_f32_16x16x32_bf16 v[24:27], a[108:111], v[236:239], v[24:27]
    s_nop 0
    ds_read_b64_tr_b16 a[68:69], v8 offset:5120
    ds_read_b64_tr_b16 a[70:71], v8 offset:7680
    v_mfma_f32_16x16x32_bf16 v[28:31], a[128:131], v[236:239], v[28:31]
    s_waitcnt lgkmcnt(10)
    s_add_u32 s8, s8, 4096
    ds_read_b64_tr_b16 a[72:73], v8 offset:10240
    ds_read_b64_tr_b16 a[74:75], v8 offset:12800
    v_mfma_f32_16x16x32_bf16 v[28:31], a[132:135], v[232:235], v[28:31]
    s_add_u32 m0, s34, 151552
    ds_read_b64_tr_b16 a[76:77], v8 offset:15360
    ds_read_b64_tr_b16 a[78:79], v8 offset:17920
    buffer_load_dwordx4 v3, s[48:51], s8 offen sc1 lds
    v_mfma_f32_16x16x32_bf16 v[28:31], a[136:139], v[228:231], v[28:31]
    ds_read_b64_tr_b16 a[96:97], v8 offset:15392
    ds_read_b64_tr_b16 a[98:99], v8 offset:17952
    v_mfma_f32_16x16x32_bf16 v[28:31], a[140:143], v[224:227], v[28:31]
    s_add_u32 s8, s8, 4096
    ds_read_b64_tr_b16 a[100:101], v8 offset:10272
    ds_read_b64_tr_b16 a[102:103], v8 offset:12832
    v_mfma_f32_16x16x32_bf16 v[32:35], a[32:35], v[224:227], v[32:35]
    s_waitcnt lgkmcnt(10)
    s_add_u32 m0, s34, 155648
    ds_read_b64_tr_b16 a[104:105], v8 offset:5152
    s_nop 0
    ds_read_b64_tr_b16 a[106:107], v8 offset:7712
    buffer_load_dwordx4 v3, s[48:51], s8 offen sc1 lds
    v_mfma_f32_16x16x32_bf16 v[32:35], a[36:39], v[228:231], v[32:35]
    ds_read_b64_tr_b16 a[108:109], v8 offset:32
    ds_read_b64_tr_b16 a[110:111], v8 offset:2592
    v_mfma_f32_16x16x32_bf16 v[32:35], a[40:43], v[232:235], v[32:35]
    ds_read_b64_tr_b16 a[128:129], v8 offset:64
    ds_read_b64_tr_b16 a[130:131], v8 offset:2624
    v_mfma_f32_16x16x32_bf16 v[32:35], a[44:47], v[236:239], v[32:35]
    s_add_u32 s8, s8, 4096
    ds_read_b64_tr_b16 a[132:133], v8 offset:5184
    ds_read_b64_tr_b16 a[134:135], v8 offset:7744
    v_mfma_f32_16x16x32_bf16 v[16:19], a[64:67], a[144:147], v[16:19]
    s_waitcnt lgkmcnt(10)
    s_add_u32 m0, s34, 159744
    ds_read_b64_tr_b16 a[136:137], v8 offset:10304
    s_nop 0
    ds_read_b64_tr_b16 a[138:139], v8 offset:12864
    buffer_load_dwordx4 v3, s[48:51], s8 offen sc1 lds
    v_mfma_f32_16x16x32_bf16 v[16:19], a[68:71], a[148:151], v[16:19]
    ds_read_b64_tr_b16 a[140:141], v8 offset:15424
    ds_read_b64_tr_b16 a[142:143], v8 offset:17984
    v_mfma_f32_16x16x32_bf16 v[16:19], a[72:75], a[152:155], v[16:19]
    ds_read_b64_tr_b16 a[32:33], v8 offset:15456
    ds_read_b64_tr_b16 a[34:35], v8 offset:18016
    v_mfma_f32_16x16x32_bf16 v[16:19], a[76:79], a[156:159], v[16:19]
    s_nop 0
    ds_read_b64_tr_b16 a[36:37], v8 offset:10336
    ds_read_b64_tr_b16 a[38:39], v8 offset:12896
    v_mfma_f32_16x16x32_bf16 v[20:23], a[96:99], a[156:159], v[20:23]
    s_waitcnt lgkmcnt(10)
    ds_read_b64_tr_b16 a[40:41], v8 offset:5216
    ds_read_b64_tr_b16 a[42:43], v8 offset:7776
    v_mfma_f32_16x16x32_bf16 v[20:23], a[100:103], a[152:155], v[20:23]
    ds_read_b64_tr_b16 a[44:45], v8 offset:96
    ds_read_b64_tr_b16 a[46:47], v8 offset:2656
    s_nop 0
    v_mfma_f32_16x16x32_bf16 v[20:23], a[104:107], a[148:151], v[20:23]
    s_nop 0
    ds_read_b64_tr_b16 a[64:65], v8 offset:128
    ds_read_b64_tr_b16 a[66:67], v8 offset:2688
    v_mfma_f32_16x16x32_bf16 v[20:23], a[108:111], a[144:147], v[20:23]
    s_waitcnt vmcnt(11)
    s_barrier
    v_mfma_f32_16x16x32_bf16 v[24:27], a[128:131], a[144:147], v[24:27]
    s_waitcnt lgkmcnt(8)
    s_add_u32 s8, s8, 4096
    s_add_u32 m0, s34, 0
    ds_read_b64_tr_b16 a[68:69], v8 offset:5248
    ds_read_b64_tr_b16 a[70:71], v8 offset:7808
    buffer_load_dwordx4 v3, s[48:51], s8 offen sc1 lds
    v_mfma_f32_16x16x32_bf16 v[24:27], a[132:135], a[148:151], v[24:27]
    ds_read_b64_tr_b16 a[72:73], v8 offset:10368
    ds_read_b64_tr_b16 a[74:75], v8 offset:12928
    v_mfma_f32_16x16x32_bf16 v[24:27], a[136:139], a[152:155], v[24:27]
    s_add_u32 s8, s8, 4096
    ds_read_b64_tr_b16 a[76:77], v8 offset:15488
    ds_read_b64_tr_b16 a[78:79], v8 offset:18048
    v_mfma_f32_16x16x32_bf16 v[24:27], a[140:143], a[156:159], v[24:27]
    s_add_u32 m0, s34, 4096
    ds_read_b64_tr_b16 a[96:97], v8 offset:20480
    ds_read_b64_tr_b16 a[98:99], v8 offset:23040
    buffer_load_dwordx4 v3, s[48:51], s8 offen sc1 lds
    v_mfma_f32_16x16x32_bf16 v[28:31], a[32:35], a[156:159], v[28:31]
    s_waitcnt lgkmcnt(8)
    s_nop 0
    ds_read_b64_tr_b16 a[100:101], v8 offset:25600
    ds_read_b64_tr_b16 a[102:103], v8 offset:28160
    v_mfma_f32_16x16x32_bf16 v[28:31], a[36:39], a[152:155], v[28:31]
    s_add_u32 s8, s8, 4096
    ds_read_b64_tr_b16 a[104:105], v8 offset:30720
    ds_read_b64_tr_b16 a[106:107], v8 offset:33280
    v_mfma_f32_16x16x32_bf16 v[28:31], a[40:43], a[148:151], v[28:31]
    s_add_u32 m0, s34, 8192
    ds_read_b64_tr_b16 a[108:109], v8 offset:35840
    ds_read_b64_tr_b16 a[110:111], v8 offset:38400
    buffer_load_dwordx4 v3, s[48:51], s8 offen sc1 lds
    v_mfma_f32_16x16x32_bf16 v[28:31], a[44:47], a[144:147], v[28:31]
    ds_read_b64_tr_b16 a[128:129], v8 offset:35872
    ds_read_b64_tr_b16 a[130:131], v8 offset:38432
    v_mfma_f32_16x16x32_bf16 v[32:35], a[64:67], a[144:147], v[32:35]
    s_waitcnt lgkmcnt(10)
    s_nop 0
    s_add_u32 s8, s8, 4096
    ds_read_b64_tr_b16 a[132:133], v8 offset:30752
    ds_read_b64_tr_b16 a[134:135], v8 offset:33312
    v_mfma_f32_16x16x32_bf16 v[32:35], a[68:71], a[148:151], v[32:35]
    s_add_u32 m0, s34, 12288
    ds_read_b64_tr_b16 a[136:137], v8 offset:25632
    ds_read_b64_tr_b16 a[138:139], v8 offset:28192
    buffer_load_dwordx4 v3, s[48:51], s8 offen sc1 lds
    v_mfma_f32_16x16x32_bf16 v[32:35], a[72:75], a[152:155], v[32:35]
    s_nop 0
    ds_read_b64_tr_b16 a[140:141], v8 offset:20512
    ds_read_b64_tr_b16 a[142:143], v8 offset:23072
    v_mfma_f32_16x16x32_bf16 v[32:35], a[76:79], a[156:159], v[32:35]
    s_waitcnt lgkmcnt(10)
    s_add_u32 s8, s8, 4096
    ds_read_b64_tr_b16 a[32:33], v8 offset:20544
    ds_read_b64_tr_b16 a[34:35], v8 offset:23104
    v_mfma_f32_16x16x32_bf16 v[16:19], a[96:99], a[176:179], v[16:19]
    s_add_u32 m0, s34, 16384
    ds_read_b64_tr_b16 a[36:37], v8 offset:25664
    ds_read_b64_tr_b16 a[38:39], v8 offset:28224
    buffer_load_dwordx4 v3, s[48:51], s8 offen sc1 lds
    v_mfma_f32_16x16x32_bf16 v[16:19], a[100:103], a[180:183], v[16:19]
    ds_read_b64_tr_b16 a[40:41], v8 offset:30784
    ds_read_b64_tr_b16 a[42:43], v8 offset:33344
    v_mfma_f32_16x16x32_bf16 v[16:19], a[104:107], a[184:187], v[16:19]
    s_waitcnt lgkmcnt(10)
    ds_read_b64_tr_b16 a[44:45], v8 offset:35904
    ds_read_b64_tr_b16 a[46:47], v8 offset:38464
    s_nop 0
    v_mfma_f32_16x16x32_bf16 v[16:19], a[108:111], a[188:191], v[16:19]
    s_add_u32 s8, s8, 4096
    ds_read_b64_tr_b16 a[64:65], v8 offset:35936
    ds_read_b64_tr_b16 a[66:67], v8 offset:38496
    v_mfma_f32_16x16x32_bf16 v[20:23], a[128:131], a[188:191], v[20:23]
    s_add_u32 m0, s34, 20480
    ds_read_b64_tr_b16 a[68:69], v8 offset:30816
    ds_read_b64_tr_b16 a[70:71], v8 offset:33376
    buffer_load_dwordx4 v3, s[48:51], s8 offen sc1 lds
    v_mfma_f32_16x16x32_bf16 v[20:23], a[132:135], a[184:187], v[20:23]
    s_waitcnt lgkmcnt(10)
    ds_read_b64_tr_b16 a[72:73], v8 offset:25696
    s_nop 0
    ds_read_b64_tr_b16 a[74:75], v8 offset:28256
    v_mfma_f32_16x16x32_bf16 v[20:23], a[136:139], a[180:183], v[20:23]
    s_add_u32 s8, s8, 4096
    ds_read_b64_tr_b16 a[76:77], v8 offset:20576
    ds_read_b64_tr_b16 a[78:79], v8 offset:23136
    v_mfma_f32_16x16x32_bf16 v[20:23], a[140:143], a[176:179], v[20:23]
    s_add_u32 m0, s34, 24576
    ds_read_b64_tr_b16 a[96:97], v8 offset:20608
    ds_read_b64_tr_b16 a[98:99], v8 offset:23168
    buffer_load_dwordx4 v3, s[48:51], s8 offen sc1 lds
    v_mfma_f32_16x16x32_bf16 v[24:27], a[32:35], a[176:179], v[24:27]
    s_waitcnt lgkmcnt(10)
    s_nop 0
    ds_read_b64_tr_b16 a[100:101], v8 offset:25728
    ds_read_b64_tr_b16 a[102:103], v8 offset:28288
    v_mfma_f32_16x16x32_bf16 v[24:27], a[36:39], a[180:183], v[24:27]
    s_add_u32 s8, s8, 4096
    ds_read_b64_tr_b16 a[104:105], v8 offset:30848
    ds_read_b64_tr_b16 a[106:107], v8 offset:33408
    v_mfma_f32_16x16x32_bf16 v[24:27], a[40:43], a[184:187], v[24:27]
    s_add_u32 m0, s34, 28672
    ds_read_b64_tr_b16 a[108:109], v8 offset:35968
    ds_read_b64_tr_b16 a[110:111], v8 offset:38528
    buffer_load_dwordx4 v3, s[48:51], s8 offen sc1 lds
    v_mfma_f32_16x16x32_bf16 v[24:27], a[44:47], a[188:191], v[24:27]
    s_nop 0
    s_waitcnt lgkmcnt(10)
    ds_read_b64_tr_b16 a[128:129], v8 offset:40960
    ds_read_b64_tr_b16 a[130:131], v8 offset:43520
    v_mfma_f32_16x16x32_bf16 v[28:31], a[64:67], a[188:191], v[28:31]
    ds_read_b64_tr_b16 a[132:133], v8 offset:46080
    ds_read_b64_tr_b16 a[134:135], v8 offset:48640
    buffer_load_dword v5, v51, s[48:51], s82 offen sc1
    v_mfma_f32_16x16x32_bf16 v[28:31], a[68:71], a[184:187], v[28:31]
    s_add_u32 s8, s8, 4096
    s_add_u32 m0, s34, 32768
    ds_read_b64_tr_b16 a[136:137], v8 offset:51200
    ds_read_b64_tr_b16 a[138:139], v8 offset:53760
    buffer_load_dwordx4 v3, s[48:51], s8 offen sc1 lds
    v_mfma_f32_16x16x32_bf16 v[28:31], a[72:75], a[180:183], v[28:31]
    s_waitcnt lgkmcnt(10)
    ds_read_b64_tr_b16 a[140:141], v8 offset:56320
    s_nop 0
    ds_read_b64_tr_b16 a[142:143], v8 offset:58880
    v_mfma_f32_16x16x32_bf16 v[28:31], a[76:79], a[176:179], v[28:31]
    s_add_u32 s8, s8, 4096
    ds_read_b64_tr_b16 a[32:33], v8 offset:56352
    ds_read_b64_tr_b16 a[34:35], v8 offset:58912
    v_mfma_f32_16x16x32_bf16 v[32:35], a[96:99], a[176:179], v[32:35]
    s_add_u32 m0, s34, 36864
    ds_read_b64_tr_b16 a[36:37], v8 offset:51232
    ds_read_b64_tr_b16 a[38:39], v8 offset:53792
    buffer_load_dwordx4 v3, s[48:51], s8 offen sc1 lds
    v_mfma_f32_16x16x32_bf16 v[32:35], a[100:103], a[180:183], v[32:35]
    s_waitcnt lgkmcnt(10)
    s_nop 0
    ds_read_b64_tr_b16 a[40:41], v8 offset:46112
    ds_read_b64_tr_b16 a[42:43], v8 offset:48672
    v_mfma_f32_16x16x32_bf16 v[32:35], a[104:107], a[184:187], v[32:35]
    ds_read_b64_tr_b16 a[44:45], v8 offset:40992
    ds_read_b64_tr_b16 a[46:47], v8 offset:43552
    v_mfma_f32_16x16x32_bf16 v[32:35], a[108:111], a[188:191], v[32:35]
    ds_read_b64_tr_b16 a[64:65], v8 offset:41024
    ds_read_b64_tr_b16 a[66:67], v8 offset:43584
    v_mfma_f32_16x16x32_bf16 v[16:19], a[128:131], a[16:19], v[16:19]
    s_waitcnt lgkmcnt(10)
    ds_read_b64_tr_b16 a[68:69], v8 offset:46144
    ds_read_b64_tr_b16 a[70:71], v8 offset:48704
    v_mfma_f32_16x16x32_bf16 v[16:19], a[132:135], a[20:23], v[16:19]
    s_nop 0
    ds_read_b64_tr_b16 a[72:73], v8 offset:51264
    ds_read_b64_tr_b16 a[74:75], v8 offset:53824
    buffer_load_dwordx4 v[36:39], v1, s[48:51], s60 offen sc1
    v_mfma_f32_16x16x32_bf16 v[16:19], a[136:139], a[24:27], v[16:19]
    ds_read_b64_tr_b16 a[76:77], v8 offset:56384
    ds_read_b64_tr_b16 a[78:79], v8 offset:58944
    buffer_load_dwordx4 v[40:43], v1, s[48:51], s60 offen offset:1024 sc1
    v_mfma_f32_16x16x32_bf16 v[16:19], a[140:143], a[28:31], v[16:19]
    s_waitcnt lgkmcnt(10)
    ds_read_b64_tr_b16 a[96:97], v8 offset:56416
    ds_read_b64_tr_b16 a[98:99], v8 offset:58976
    s_nop 0
    buffer_load_dwordx2 v[44:45], v1, s[48:51], s61 offen sc1
    v_mfma_f32_16x16x32_bf16 v[20:23], a[32:35], a[28:31], v[20:23]
    ds_read_b64_tr_b16 a[100:101], v8 offset:51296
    ds_read_b64_tr_b16 a[102:103], v8 offset:53856
    v_mfma_f32_16x16x32_bf16 v[20:23], a[36:39], a[24:27], v[20:23]
    s_nop 0
    ds_read_b64_tr_b16 a[104:105], v8 offset:46176
    ds_read_b64_tr_b16 a[106:107], v8 offset:48736
    v_mfma_f32_16x16x32_bf16 v[20:23], a[40:43], a[20:23], v[20:23]
    s_waitcnt lgkmcnt(10)
    ds_read_b64_tr_b16 a[108:109], v8 offset:41056
    ds_read_b64_tr_b16 a[110:111], v8 offset:43616
    v_mfma_f32_16x16x32_bf16 v[20:23], a[44:47], a[16:19], v[20:23]
    s_waitcnt vmcnt(14)
    s_barrier
    v_mfma_f32_16x16x32_bf16 v[24:27], a[64:67], a[16:19], v[24:27]
    ds_read_b64_tr_b16 a[128:129], v8 offset:41088
    ds_read_b64_tr_b16 a[130:131], v8 offset:43648
    v_mfma_f32_16x16x32_bf16 v[24:27], a[68:71], a[20:23], v[24:27]
    s_waitcnt lgkmcnt(8)
    ds_read_b64_tr_b16 a[132:133], v8 offset:46208
    ds_read_b64_tr_b16 a[134:135], v8 offset:48768
    v_mfma_f32_16x16x32_bf16 v[24:27], a[72:75], a[24:27], v[24:27]
    s_nop 0
    ds_read_b64_tr_b16 a[136:137], v8 offset:51328
    ds_read_b64_tr_b16 a[138:139], v8 offset:53888
    v_lshlrev_b32_e64 v176, 16, v58
    v_mfma_f32_16x16x32_bf16 v[24:27], a[76:79], a[28:31], v[24:27]
    ds_read_b64_tr_b16 a[140:141], v8 offset:56448
    ds_read_b64_tr_b16 a[142:143], v8 offset:59008
    v_and_b32 v177, s76, v58
    v_mfma_f32_16x16x32_bf16 v[28:31], a[96:99], a[28:31], v[28:31]
    s_waitcnt lgkmcnt(8)
    ds_read_b64_tr_b16 a[32:33], v9 offset:0
    ds_read_b64_tr_b16 a[34:35], v9 offset:2560
    v_mov_b32_e64 v128, 0
    v_mfma_f32_16x16x32_bf16 v[28:31], a[100:103], a[24:27], v[28:31]
    ds_read_b64_tr_b16 a[36:37], v9 offset:5120
    ds_read_b64_tr_b16 a[38:39], v9 offset:7680
    v_mov_b32_e64 v129, 0
    v_mfma_f32_16x16x32_bf16 v[28:31], a[104:107], a[20:23], v[28:31]
    ds_read_b64_tr_b16 a[40:41], v9 offset:10240
    ds_read_b64_tr_b16 a[42:43], v9 offset:12800
    v_lshlrev_b32 v178, 16, v59
    v_mfma_f32_16x16x32_bf16 v[28:31], a[108:111], a[16:19], v[28:31]
    s_waitcnt lgkmcnt(10)
    ds_read_b64_tr_b16 a[44:45], v9 offset:15360
    ds_read_b64_tr_b16 a[46:47], v9 offset:17920
    v_and_b32_e64 v179, s76, v59
    v_mfma_f32_16x16x32_bf16 v[32:35], a[128:131], a[16:19], v[32:35]
    ds_read_b64_tr_b16 a[64:65], v9 offset:15392
    ds_read_b64_tr_b16 a[66:67], v9 offset:17952
    v_mov_b32 v130, 0
    v_mfma_f32_16x16x32_bf16 v[32:35], a[132:135], a[20:23], v[32:35]
    s_waitcnt lgkmcnt(10)
    ds_read_b64_tr_b16 a[68:69], v9 offset:10272
    ds_read_b64_tr_b16 a[70:71], v9 offset:12832
    v_mov_b32_e64 v131, 0
    v_mfma_f32_16x16x32_bf16 v[32:35], a[136:139], a[24:27], v[32:35]
    ds_read_b64_tr_b16 a[72:73], v9 offset:5152
    ds_read_b64_tr_b16 a[74:75], v9 offset:7712
    v_lshlrev_b32 v180, 16, v248
    v_mfma_f32_16x16x32_bf16 v[32:35], a[140:143], a[28:31], v[32:35]
    s_waitcnt lgkmcnt(10)
    ds_read_b64_tr_b16 a[76:77], v9 offset:32
    ds_read_b64_tr_b16 a[78:79], v9 offset:2592
    v_and_b32_e64 v181, s76, v248
    v_mfma_f32_16x16x32_bf16 v[16:19], a[32:35], a[48:51], v[16:19]
    s_waitcnt vmcnt(0)
    s_barrier
    v_cmp_lt_u32 vcc, 0, v5
    s_nop 1
    s_and_b32 s81, vcc_lo, 0xff
    s_andn2_b32 s81, s81, s83
    s_or_b32 s83, s83, s81
    v_mfma_f32_16x16x32_bf16 v[16:19], a[36:39], a[52:55], v[16:19]
    ds_read_b64_tr_b16 a[96:97], v9 offset:64
    ds_read_b64_tr_b16 a[98:99], v9 offset:2624
    s_bitcmp1_b32 s81, 0
    s_cbranch_scc0 L_f0_0b
    s_add_u32 s3, s78, 0
    s_add_u32 s35, s79, 0
    buffer_load_dwordx4 v[80:83], v1, s[48:51], s3 offen sc1
    buffer_load_dwordx4 v[84:87], v1, s[48:51], s3 offen offset:1024 sc1
    buffer_load_dwordx2 v[240:241], v49, s[48:51], s35 offen sc1
L_f0_0b:
    s_waitcnt lgkmcnt(10)
    v_mfma_f32_16x16x32_bf16 v[16:19], a[40:43], a[56:59], v[16:19]
    s_nop 0
    ds_read_b64_tr_b16 a[100:101], v9 offset:5184
    ds_read_b64_tr_b16 a[102:103], v9 offset:7744
    v_mov_b32 v132, 0
    v_mfma_f32_16x16x32_bf16 v[16:19], a[44:47], a[60:63], v[16:19]
    s_waitcnt lgkmcnt(8)
    ds_read_b64_tr_b16 a[104:105], v9 offset:10304
    ds_read_b64_tr_b16 a[106:107], v9 offset:12864
    v_mov_b32_e64 v133, 0
    v_mfma_f32_16x16x32_bf16 v[20:23], a[64:67], a[60:63], v[20:23]
    ds_read_b64_tr_b16 a[108:109], v9 offset:15424
    ds_read_b64_tr_b16 a[110:111], v9 offset:17984
    v_lshlrev_b32 v182, 16, v249
    v_mfma_f32_16x16x32_bf16 v[20:23], a[68:71], a[56:59], v[20:23]
    s_waitcnt lgkmcnt(8)
    ds_read_b64_tr_b16 a[128:129], v9 offset:15456
    ds_read_b64_tr_b16 a[130:131], v9 offset:18016
    v_and_b32_e64 v183, s76, v249
    v_mfma_f32_16x16x32_bf16 v[20:23], a[72:75], a[52:55], v[20:23]
    ds_read_b64_tr_b16 a[132:133], v9 offset:10336
    ds_read_b64_tr_b16 a[134:135], v9 offset:12896
    v_mov_b32 v134, 0
    v_mfma_f32_16x16x32_bf16 v[20:23], a[76:79], a[48:51], v[20:23]
    s_waitcnt lgkmcnt(10)
    ds_read_b64_tr_b16 a[136:137], v9 offset:5216
    ds_read_b64_tr_b16 a[138:139], v9 offset:7776
    v_mov_b32 v135, 0
    v_mfma_f32_16x16x32_bf16 v[24:27], a[96:99], a[48:51], v[24:27]
    s_waitcnt lgkmcnt(10)
    ds_read_b64_tr_b16 a[140:141], v9 offset:96
    ds_read_b64_tr_b16 a[142:143], v9 offset:2656
    v_lshlrev_b32 v184, 16, v250
    v_mfma_f32_16x16x32_bf16 v[24:27], a[100:103], a[52:55], v[24:27]
    s_waitcnt lgkmcnt(10)
    ds_read_b64_tr_b16 a[32:33], v9 offset:128
    ds_read_b64_tr_b16 a[34:35], v9 offset:2688
    v_and_b32 v185, s76, v250
    v_mfma_f32_16x16x32_bf16 v[24:27], a[104:107], a[56:59], v[24:27]
    s_waitcnt lgkmcnt(10)
    ds_read_b64_tr_b16 a[36:37], v9 offset:5248
    ds_read_b64_tr_b16 a[38:39], v9 offset:7808
    v_mov_b32 v136, 0
    v_mfma_f32_16x16x32_bf16 v[24:27], a[108:111], a[60:63], v[24:27]
    s_waitcnt lgkmcnt(10)
    ds_read_b64_tr_b16 a[40:41], v9 offset:10368
    ds_read_b64_tr_b16 a[42:43], v9 offset:12928
    v_mov_b32 v137, 0
    v_mfma_f32_16x16x32_bf16 v[28:31], a[128:131], a[60:63], v[28:31]
    s_waitcnt lgkmcnt(10)
    ds_read_b64_tr_b16 a[44:45], v9 offset:15488
    ds_read_b64_tr_b16 a[46:47], v9 offset:18048
    v_lshlrev_b32 v186, 16, v251
    v_mfma_f32_16x16x32_bf16 v[28:31], a[132:135], a[56:59], v[28:31]
    s_waitcnt lgkmcnt(10)
    ds_read_b64_tr_b16 a[64:65], v9 offset:20480
    ds_read_b64_tr_b16 a[66:67], v9 offset:23040
    v_mfma_f32_16x16x32_bf16 v[28:31], a[136:139], a[52:55], v[28:31]
    ds_read_b64_tr_b16 a[68:69], v9 offset:25600
    ds_read_b64_tr_b16 a[70:71], v9 offset:28160
    s_bitcmp1_b32 s81, 1
    s_cbranch_scc0 L_f0_1b
    s_add_u32 s3, s78, 2621440
    s_add_u32 s35, s79, 2621440
    buffer_load_dwordx4 v[88:91], v1, s[48:51], s3 offen sc1
    buffer_load_dwordx4 v[92:95], v1, s[48:51], s3 offen offset:1024 sc1
    buffer_load_dwordx2 v[242:243], v49, s[48:51], s35 offen sc1
L_f0_1b:
    s_waitcnt lgkmcnt(12)
    v_mfma_f32_16x16x32_bf16 v[28:31], a[140:143], a[48:51], v[28:31]
    s_waitcnt lgkmcnt(10)
    ds_read_b64_tr_b16 a[72:73], v9 offset:30720
    ds_read_b64_tr_b16 a[74:75], v9 offset:33280
    v_and_b32 v187, s76, v251
    v_mfma_f32_16x16x32_bf16 v[32:35], a[32:35], a[48:51], v[32:35]
    s_waitcnt lgkmcnt(10)
    ds_read_b64_tr_b16 a[76:77], v9 offset:35840
    ds_read_b64_tr_b16 a[78:79], v9 offset:38400
    v_mov_b32 v138, 0
    v_mfma_f32_16x16x32_bf16 v[32:35], a[36:39], a[52:55], v[32:35]
    s_waitcnt lgkmcnt(10)
    ds_read_b64_tr_b16 a[96:97], v9 offset:35872
    ds_read_b64_tr_b16 a[98:99], v9 offset:38432
    v_mov_b32 v139, 0
    v_mfma_f32_16x16x32_bf16 v[32:35], a[40:43], a[56:59], v[32:35]
    s_waitcnt lgkmcnt(10)
    ds_read_b64_tr_b16 a[100:101], v9 offset:30752
    ds_read_b64_tr_b16 a[102:103], v9 offset:33312
    v_lshlrev_b32 v188, 16, v252
    v_mfma_f32_16x16x32_bf16 v[32:35], a[44:47], a[60:63], v[32:35]
    s_waitcnt lgkmcnt(10)
    ds_read_b64_tr_b16 a[104:105], v9 offset:25632
    ds_read_b64_tr_b16 a[106:107], v9 offset:28192
    v_and_b32 v189, s76, v252
    v_mfma_f32_16x16x32_bf16 v[16:19], a[64:67], a[80:83], v[16:19]
    s_waitcnt lgkmcnt(10)
    ds_read_b64_tr_b16 a[108:109], v9 offset:20512
    ds_read_b64_tr_b16 a[110:111], v9 offset:23072
    v_mov_b32 v140, 0
    v_mfma_f32_16x16x32_bf16 v[16:19], a[68:71], a[84:87], v[16:19]
    s_waitcnt lgkmcnt(10)
    ds_read_b64_tr_b16 a[128:129], v9 offset:20544
    ds_read_b64_tr_b16 a[130:131], v9 offset:23104
    v_mov_b32 v141, 0
    v_mfma_f32_16x16x32_bf16 v[16:19], a[72:75], a[88:91], v[16:19]
    s_waitcnt lgkmcnt(10)
    ds_read_b64_tr_b16 a[132:133], v9 offset:25664
    ds_read_b64_tr_b16 a[134:135], v9 offset:28224
    v_lshlrev_b32 v190, 16, v253
    v_mfma_f32_16x16x32_bf16 v[16:19], a[76:79], a[92:95], v[16:19]
    s_waitcnt lgkmcnt(10)
    ds_read_b64_tr_b16 a[136:137], v9 offset:30784
    ds_read_b64_tr_b16 a[138:139], v9 offset:33344
    v_and_b32_e64 v191, s76, v253
    v_mfma_f32_16x16x32_bf16 v[20:23], a[96:99], a[92:95], v[20:23]
    s_waitcnt lgkmcnt(10)
    ds_read_b64_tr_b16 a[140:141], v9 offset:35904
    ds_read_b64_tr_b16 a[142:143], v9 offset:38464
    v_mov_b32_e64 v142, 0
    v_mfma_f32_16x16x32_bf16 v[20:23], a[100:103], a[88:91], v[20:23]
    s_waitcnt lgkmcnt(10)
    ds_read_b64_tr_b16 a[32:33], v9 offset:35936
    ds_read_b64_tr_b16 a[34:35], v9 offset:38496
    v_mov_b32_e64 v143, 0
    v_mfma_f32_16x16x32_bf16 v[20:23], a[104:107], a[84:87], v[20:23]
    s_waitcnt lgkmcnt(10)
    ds_read_b64_tr_b16 a[36:37], v9 offset:30816
    ds_read_b64_tr_b16 a[38:39], v9 offset:33376
    v_mfma_f32_16x16x32_bf16 v[20:23], a[108:111], a[80:83], v[20:23]
    s_nop 0
    ds_read_b64_tr_b16 a[40:41], v9 offset:25696
    ds_read_b64_tr_b16 a[42:43], v9 offset:28256
    s_bitcmp1_b32 s81, 2
    s_cbranch_scc0 L_f0_2b
    s_add_u32 s3, s78, 5242880
    s_add_u32 s35, s79, 5242880
    buffer_load_dwordx4 v[112:115], v1, s[48:51], s3 offen sc1
    buffer_load_dwordx4 v[116:119], v1, s[48:51], s3 offen offset:1024 sc1
    buffer_load_dwordx2 v[244:245], v49, s[48:51], s35 offen sc1
L_f0_2b:
    s_waitcnt lgkmcnt(12)
    v_mfma_f32_16x16x32_bf16 v[24:27], a[128:131], a[80:83], v[24:27]
    s_waitcnt lgkmcnt(10)
    ds_read_b64_tr_b16 a[44:45], v9 offset:20576
    ds_read_b64_tr_b16 a[46:47], v9 offset:23136
    v_lshlrev_b32 v192, 16, v254
    v_mfma_f32_16x16x32_bf16 v[24:27], a[132:135], a[84:87], v[24:27]
    s_waitcnt lgkmcnt(10)
    ds_read_b64_tr_b16 a[64:65], v9 offset:20608
    ds_read_b64_tr_b16 a[66:67], v9 offset:23168
    v_and_b32 v193, s76, v254
    v_mfma_f32_16x16x32_bf16 v[24:27], a[136:139], a[88:91], v[24:27]
    s_waitcnt lgkmcnt(10)
    ds_read_b64_tr_b16 a[68:69], v9 offset:25728
    ds_read_b64_tr_b16 a[70:71], v9 offset:28288
    v_mov_b32 v144, 0
    v_mfma_f32_16x16x32_bf16 v[24:27], a[140:143], a[92:95], v[24:27]
    s_waitcnt lgkmcnt(10)
    ds_read_b64_tr_b16 a[72:73], v9 offset:30848
    ds_read_b64_tr_b16 a[74:75], v9 offset:33408
    v_mov_b32 v145, 0
    v_mfma_f32_16x16x32_bf16 v[28:31], a[32:35], a[92:95], v[28:31]
    s_waitcnt lgkmcnt(10)
    ds_read_b64_tr_b16 a[76:77], v9 offset:35968
    ds_read_b64_tr_b16 a[78:79], v9 offset:38528
    v_lshlrev_b32 v194, 16, v255
    v_mfma_f32_16x16x32_bf16 v[28:31], a[36:39], a[88:91], v[28:31]
    s_waitcnt lgkmcnt(10)
    ds_read_b64_tr_b16 a[96:97], v48 offset:0
    ds_read_b64_tr_b16 a[98:99], v48 offset:2560
    v_and_b32 v195, s76, v255
    v_mfma_f32_16x16x32_bf16 v[28:31], a[40:43], a[84:87], v[28:31]
    s_waitcnt lgkmcnt(10)
    ds_read_b64_tr_b16 a[100:101], v48 offset:5120
    ds_read_b64_tr_b16 a[102:103], v48 offset:7680
    v_mov_b32 v146, 0
    v_mfma_f32_16x16x32_bf16 v[28:31], a[44:47], a[80:83], v[28:31]
    s_waitcnt lgkmcnt(10)
    ds_read_b64_tr_b16 a[104:105], v48 offset:10240
    ds_read_b64_tr_b16 a[106:107], v48 offset:12800
    v_mov_b32 v147, 0
    v_mfma_f32_16x16x32_bf16 v[32:35], a[64:67], a[80:83], v[32:35]
    s_waitcnt lgkmcnt(10)
    ds_read_b64_tr_b16 a[108:109], v48 offset:15360
    ds_read_b64_tr_b16 a[110:111], v48 offset:17920
    v_mfma_f32_16x16x32_bf16 v[32:35], a[68:71], a[84:87], v[32:35]
    s_waitcnt lgkmcnt(10)
    ds_read_b64_tr_b16 a[128:129], v48 offset:15392
    ds_read_b64_tr_b16 a[130:131], v48 offset:17952
    v_mfma_f32_16x16x32_bf16 v[32:35], a[72:75], a[88:91], v[32:35]
    s_waitcnt lgkmcnt(10)
    ds_read_b64_tr_b16 a[132:133], v48 offset:10272
    ds_read_b64_tr_b16 a[134:135], v48 offset:12832
    v_mfma_f32_16x16x32_bf16 v[32:35], a[76:79], a[92:95], v[32:35]
    s_waitcnt lgkmcnt(10)
    ds_read_b64_tr_b16 a[136:137], v48 offset:5152
    ds_read_b64_tr_b16 a[138:139], v48 offset:7712
    v_mfma_f32_16x16x32_bf16 v[16:19], a[96:99], a[112:115], v[16:19]
    s_nop 0
    ds_read_b64_tr_b16 a[140:141], v48 offset:32
    ds_read_b64_tr_b16 a[142:143], v48 offset:2592
    s_bitcmp1_b32 s81, 3
    s_cbranch_scc0 L_f0_3b
    s_add_u32 s3, s78, 7864320
    s_add_u32 s35, s79, 7864320
    buffer_load_dwordx4 v[120:123], v1, s[48:51], s3 offen sc1
    buffer_load_dwordx4 v[124:127], v1, s[48:51], s3 offen offset:1024 sc1
    buffer_load_dwordx2 v[246:247], v49, s[48:51], s35 offen sc1
L_f0_3b:
    s_waitcnt lgkmcnt(12)
    v_mfma_f32_16x16x32_bf16 v[16:19], a[100:103], a[116:119], v[16:19]
    s_waitcnt lgkmcnt(10)
    ds_read_b64_tr_b16 a[32:33], v48 offset:64
    ds_read_b64_tr_b16 a[34:35], v48 offset:2624
    v_mfma_f32_16x16x32_bf16 v[16:19], a[104:107], a[120:123], v[16:19]
    s_waitcnt lgkmcnt(10)
    ds_read_b64_tr_b16 a[36:37], v48 offset:5184
    ds_read_b64_tr_b16 a[38:39], v48 offset:7744
    v_mfma_f32_16x16x32_bf16 v[16:19], a[108:111], a[124:127], v[16:19]
    s_waitcnt lgkmcnt(10)
    ds_read_b64_tr_b16 a[40:41], v48 offset:10304
    ds_read_b64_tr_b16 a[42:43], v48 offset:12864
    v_mfma_f32_16x16x32_bf16 v[20:23], a[128:131], a[124:127], v[20:23]
    s_waitcnt lgkmcnt(10)
    ds_read_b64_tr_b16 a[44:45], v48 offset:15424
    ds_read_b64_tr_b16 a[46:47], v48 offset:17984
    v_mfma_f32_16x16x32_bf16 v[20:23], a[132:135], a[120:123], v[20:23]
    s_waitcnt lgkmcnt(10)
    ds_read_b64_tr_b16 a[64:65], v48 offset:15456
    ds_read_b64_tr_b16 a[66:67], v48 offset:18016
    v_mfma_f32_16x16x32_bf16 v[20:23], a[136:139], a[116:119], v[20:23]
    s_waitcnt lgkmcnt(10)
    ds_read_b64_tr_b16 a[68:69], v48 offset:10336
    ds_read_b64_tr_b16 a[70:71], v48 offset:12896
    v_mfma_f32_16x16x32_bf16 v[20:23], a[140:143], a[112:115], v[20:23]
    s_waitcnt lgkmcnt(10)
    ds_read_b64_tr_b16 a[72:73], v48 offset:5216
    ds_read_b64_tr_b16 a[74:75], v48 offset:7776
    v_mfma_f32_16x16x32_bf16 v[24:27], a[32:35], a[112:115], v[24:27]
    s_waitcnt lgkmcnt(10)
    ds_read_b64_tr_b16 a[76:77], v48 offset:96
    ds_read_b64_tr_b16 a[78:79], v48 offset:2656
    v_mfma_f32_16x16x32_bf16 v[24:27], a[36:39], a[116:119], v[24:27]
    s_waitcnt lgkmcnt(10)
    ds_read_b64_tr_b16 a[96:97], v48 offset:128
    ds_read_b64_tr_b16 a[98:99], v48 offset:2688
    v_mfma_f32_16x16x32_bf16 v[24:27], a[40:43], a[120:123], v[24:27]
    s_waitcnt lgkmcnt(10)
    ds_read_b64_tr_b16 a[100:101], v48 offset:5248
    ds_read_b64_tr_b16 a[102:103], v48 offset:7808
    v_mfma_f32_16x16x32_bf16 v[24:27], a[44:47], a[124:127], v[24:27]
    s_waitcnt lgkmcnt(10)
    ds_read_b64_tr_b16 a[104:105], v48 offset:10368
    ds_read_b64_tr_b16 a[106:107], v48 offset:12928
    v_mfma_f32_16x16x32_bf16 v[28:31], a[64:67], a[124:127], v[28:31]
    s_waitcnt lgkmcnt(10)
    ds_read_b64_tr_b16 a[108:109], v48 offset:15488
    ds_read_b64_tr_b16 a[110:111], v48 offset:18048
    v_mfma_f32_16x16x32_bf16 v[28:31], a[68:71], a[120:123], v[28:31]
    s_nop 0
    ds_read_b64_tr_b16 a[128:129], v48 offset:20480
    ds_read_b64_tr_b16 a[130:131], v48 offset:23040
    s_bitcmp1_b32 s81, 4
    s_cbranch_scc0 L_f0_4b
    s_add_u32 s3, s78, 10485760
    s_add_u32 s35, s79, 10485760
    buffer_load_dwordx4 v[160:163], v1, s[48:51], s3 offen sc1
    buffer_load_dwordx4 v[164:167], v1, s[48:51], s3 offen offset:1024 sc1
    buffer_load_dwordx2 v[52:53], v49, s[48:51], s35 offen sc1
L_f0_4b:
    s_waitcnt lgkmcnt(12)
    v_mfma_f32_16x16x32_bf16 v[28:31], a[72:75], a[116:119], v[28:31]
    s_waitcnt lgkmcnt(10)
    ds_read_b64_tr_b16 a[132:133], v48 offset:25600
    ds_read_b64_tr_b16 a[134:135], v48 offset:28160
    v_mfma_f32_16x16x32_bf16 v[28:31], a[76:79], a[112:115], v[28:31]
    s_waitcnt lgkmcnt(10)
    ds_read_b64_tr_b16 a[136:137], v48 offset:30720
    ds_read_b64_tr_b16 a[138:139], v48 offset:33280
    v_mfma_f32_16x16x32_bf16 v[32:35], a[96:99], a[112:115], v[32:35]
    s_waitcnt lgkmcnt(10)
    ds_read_b64_tr_b16 a[140:141], v48 offset:35840
    ds_read_b64_tr_b16 a[142:143], v48 offset:38400
    v_mfma_f32_16x16x32_bf16 v[32:35], a[100:103], a[116:119], v[32:35]
    s_waitcnt lgkmcnt(10)
    ds_read_b64_tr_b16 a[32:33], v48 offset:35872
    ds_read_b64_tr_b16 a[34:35], v48 offset:38432
    v_mfma_f32_16x16x32_bf16 v[32:35], a[104:107], a[120:123], v[32:35]
    s_waitcnt lgkmcnt(10)
    ds_read_b64_tr_b16 a[36:37], v48 offset:30752
    ds_read_b64_tr_b16 a[38:39], v48 offset:33312
    v_mfma_f32_16x16x32_bf16 v[32:35], a[108:111], a[124:127], v[32:35]
    s_waitcnt lgkmcnt(10)
    ds_read_b64_tr_b16 a[40:41], v48 offset:25632
    ds_read_b64_tr_b16 a[42:43], v48 offset:28192
    v_mfma_f32_16x16x32_bf16 v[16:19], a[128:131], a[0:3], v[16:19]
    s_waitcnt lgkmcnt(10)
    ds_read_b64_tr_b16 a[44:45], v48 offset:20512
    ds_read_b64_tr_b16 a[46:47], v48 offset:23072
    v_mfma_f32_16x16x32_bf16 v[16:19], a[132:135], a[4:7], v[16:19]
    s_waitcnt lgkmcnt(10)
    ds_read_b64_tr_b16 a[64:65], v48 offset:20544
    ds_read_b64_tr_b16 a[66:67], v48 offset:23104
    v_mfma_f32_16x16x32_bf16 v[16:19], a[136:139], a[8:11], v[16:19]
    s_waitcnt lgkmcnt(10)
    ds_read_b64_tr_b16 a[68:69], v48 offset:25664
    ds_read_b64_tr_b16 a[70:71], v48 offset:28224
    v_mfma_f32_16x16x32_bf16 v[16:19], a[140:143], a[12:15], v[16:19]
    s_waitcnt lgkmcnt(10)
    ds_read_b64_tr_b16 a[72:73], v48 offset:30784
    ds_read_b64_tr_b16 a[74:75], v48 offset:33344
    v_mfma_f32_16x16x32_bf16 v[20:23], a[32:35], a[12:15], v[20:23]
    s_waitcnt lgkmcnt(10)
    ds_read_b64_tr_b16 a[76:77], v48 offset:35904
    ds_read_b64_tr_b16 a[78:79], v48 offset:38464
    v_mfma_f32_16x16x32_bf16 v[20:23], a[36:39], a[8:11], v[20:23]
    s_waitcnt lgkmcnt(10)
    ds_read_b64_tr_b16 a[96:97], v48 offset:35936
    ds_read_b64_tr_b16 a[98:99], v48 offset:38496
    v_mfma_f32_16x16x32_bf16 v[20:23], a[40:43], a[4:7], v[20:23]
    s_nop 0
    ds_read_b64_tr_b16 a[100:101], v48 offset:30816
    ds_read_b64_tr_b16 a[102:103], v48 offset:33376
    s_bitcmp1_b32 s81, 5
    s_cbranch_scc0 L_f0_5b
    s_add_u32 s3, s78, 13107200
    s_add_u32 s35, s79, 13107200
    buffer_load_dwordx4 v[168:171], v1, s[48:51], s3 offen sc1
    buffer_load_dwordx4 v[172:175], v1, s[48:51], s3 offen offset:1024 sc1
    buffer_load_dwordx2 v[54:55], v49, s[48:51], s35 offen sc1
L_f0_5b:
    s_waitcnt lgkmcnt(12)
    v_mfma_f32_16x16x32_bf16 v[20:23], a[44:47], a[0:3], v[20:23]
    s_waitcnt lgkmcnt(10)
    ds_read_b64_tr_b16 a[104:105], v48 offset:25696
    ds_read_b64_tr_b16 a[106:107], v48 offset:28256
    v_mfma_f32_16x16x32_bf16 v[24:27], a[64:67], a[0:3], v[24:27]
    s_waitcnt lgkmcnt(10)
    ds_read_b64_tr_b16 a[108:109], v48 offset:20576
    ds_read_b64_tr_b16 a[110:111], v48 offset:23136
    v_mfma_f32_16x16x32_bf16 v[24:27], a[68:71], a[4:7], v[24:27]
    s_waitcnt lgkmcnt(10)
    ds_read_b64_tr_b16 a[128:129], v48 offset:20608
    ds_read_b64_tr_b16 a[130:131], v48 offset:23168
    v_mfma_f32_16x16x32_bf16 v[24:27], a[72:75], a[8:11], v[24:27]
    s_waitcnt lgkmcnt(10)
    ds_read_b64_tr_b16 a[132:133], v48 offset:25728
    ds_read_b64_tr_b16 a[134:135], v48 offset:28288
    v_mfma_f32_16x16x32_bf16 v[24:27], a[76:79], a[12:15], v[24:27]
    s_waitcnt lgkmcnt(10)
    ds_read_b64_tr_b16 a[136:137], v48 offset:30848
    ds_read_b64_tr_b16 a[138:139], v48 offset:33408
    v_mfma_f32_16x16x32_bf16 v[28:31], a[96:99], a[12:15], v[28:31]
    s_waitcnt lgkmcnt(10)
    ds_read_b64_tr_b16 a[140:141], v48 offset:35968
    ds_read_b64_tr_b16 a[142:143], v48 offset:38528
    v_mfma_f32_16x16x32_bf16 v[28:31], a[100:103], a[8:11], v[28:31]
    s_waitcnt lgkmcnt(10)
    v_mfma_f32_16x16x32_bf16 v[28:31], a[104:107], a[4:7], v[28:31]
    s_waitcnt lgkmcnt(8)
    v_mfma_f32_16x16x32_bf16 v[28:31], a[108:111], a[0:3], v[28:31]
    s_waitcnt lgkmcnt(6)
    v_mfma_f32_16x16x32_bf16 v[32:35], a[128:131], a[0:3], v[32:35]
    s_waitcnt lgkmcnt(4)
    v_mfma_f32_16x16x32_bf16 v[32:35], a[132:135], a[4:7], v[32:35]
    s_waitcnt lgkmcnt(2)
    v_mfma_f32_16x16x32_bf16 v[32:35], a[136:139], a[8:11], v[32:35]
    s_waitcnt lgkmcnt(0)
    v_mfma_f32_16x16x32_bf16 v[32:35], a[140:143], a[12:15], v[32:35]
    s_nop 7
    s_bitcmp1_b32 s81, 6
    s_cbranch_scc0 L_f0_6b
    s_add_u32 s3, s78, 15728640
    s_add_u32 s35, s79, 15728640
    buffer_load_dwordx4 v[208:211], v1, s[48:51], s3 offen sc1
    buffer_load_dwordx4 v[212:215], v1, s[48:51], s3 offen offset:1024 sc1
    buffer_load_dwordx2 v[56:57], v49, s[48:51], s35 offen sc1
L_f0_6b:
    v_lshlrev_b32 v10, 16, v36
    v_and_b32 v11, s76, v36
    v_lshlrev_b32 v12, 16, v37
    v_and_b32 v13, s76, v37
    v_pk_add_f32 v[16:17], v[16:17], v[10:11]
    v_pk_add_f32 v[18:19], v[18:19], v[12:13]
    v_pk_mul_f32 v[10:11], v[16:17], s[14:15]
    v_pk_mul_f32 v[12:13], v[18:19], s[14:15]
    v_exp_f32 v10, v10
    v_exp_f32 v11, v11
    v_exp_f32 v12, v12
    v_exp_f32 v13, v13
    v_pk_add_f32 v[10:11], v[10:11], s[74:75]
    v_pk_add_f32 v[12:13], v[12:13], s[74:75]
    v_rcp_f32 v10, v10
    v_rcp_f32 v11, v11
    v_rcp_f32 v12, v12
    v_rcp_f32 v13, v13
    v_pk_mul_f32 v[16:17], v[10:11], v[16:17]
    v_pk_mul_f32 v[18:19], v[12:13], v[18:19]
    v_lshlrev_b32 v10, 16, v38
    v_and_b32 v11, s76, v38
    v_lshlrev_b32 v12, 16, v39
    v_and_b32 v13, s76, v39
    v_pk_add_f32 v[20:21], v[20:21], v[10:11]
    v_pk_add_f32 v[22:23], v[22:23], v[12:13]
    v_pk_mul_f32 v[10:11], v[20:21], s[14:15]
    v_pk_mul_f32 v[12:13], v[22:23], s[14:15]
    v_exp_f32 v10, v10
    v_exp_f32 v11, v11
    v_exp_f32 v12, v12
    v_exp_f32 v13, v13
    v_pk_add_f32 v[10:11], v[10:11], s[74:75]
    v_pk_add_f32 v[12:13], v[12:13], s[74:75]
    v_rcp_f32 v10, v10
    v_rcp_f32 v11, v11
    v_rcp_f32 v12, v12
    v_rcp_f32 v13, v13
    v_pk_mul_f32 v[20:21], v[10:11], v[20:21]
    v_pk_mul_f32 v[22:23], v[12:13], v[22:23]
    v_lshlrev_b32 v10, 16, v40
    v_and_b32 v11, s76, v40
    v_lshlrev_b32 v12, 16, v41
    v_and_b32 v13, s76, v41
    s_bitcmp1_b32 s81, 7
    s_cbranch_scc0 L_f0_7b
    s_add_u32 s3, s78, 18350080
    s_add_u32 s35, s79, 18350080
    buffer_load_dwordx4 v[216:219], v1, s[48:51], s3 offen sc1
    buffer_load_dwordx4 v[220:223], v1, s[48:51], s3 offen offset:1024 sc1
    buffer_load_dwordx2 v[46:47], v49, s[48:51], s35 offen sc1
L_f0_7b:
    v_pk_add_f32 v[24:25], v[24:25], v[10:11]
    v_pk_add_f32 v[26:27], v[26:27], v[12:13]
    v_pk_mul_f32 v[10:11], v[24:25], s[14:15]
    v_pk_mul_f32 v[12:13], v[26:27], s[14:15]
    v_exp_f32 v10, v10
    v_exp_f32 v11, v11
    v_exp_f32 v12, v12
    v_exp_f32 v13, v13
    v_pk_add_f32 v[10:11], v[10:11], s[74:75]
    v_pk_add_f32 v[12:13], v[12:13], s[74:75]
    v_rcp_f32 v10, v10
    v_rcp_f32 v11, v11
    v_rcp_f32 v12, v12
    v_rcp_f32 v13, v13
    v_pk_mul_f32 v[24:25], v[10:11], v[24:25]
    v_pk_mul_f32 v[26:27], v[12:13], v[26:27]
    v_lshlrev_b32 v10, 16, v42
    v_and_b32 v11, s76, v42
    v_lshlrev_b32 v12, 16, v43
    v_and_b32 v13, s76, v43
    v_pk_add_f32 v[28:29], v[28:29], v[10:11]
    v_pk_add_f32 v[30:31], v[30:31], v[12:13]
    v_pk_mul_f32 v[10:11], v[28:29], s[14:15]
    v_pk_mul_f32 v[12:13], v[30:31], s[14:15]
    v_exp_f32 v10, v10
    v_exp_f32 v11, v11
    v_exp_f32 v12, v12
    v_exp_f32 v13, v13
    v_pk_add_f32 v[10:11], v[10:11], s[74:75]
    v_pk_add_f32 v[12:13], v[12:13], s[74:75]
    v_rcp_f32 v10, v10
    v_rcp_f32 v11, v11
    v_rcp_f32 v12, v12
    v_rcp_f32 v13, v13
    v_pk_mul_f32 v[28:29], v[10:11], v[28:29]
    v_pk_mul_f32 v[30:31], v[12:13], v[30:31]
    v_lshlrev_b32 v10, 16, v44
    v_and_b32 v11, s76, v44
    v_lshlrev_b32 v12, 16, v45
    v_and_b32 v13, s76, v45
    v_pk_add_f32 v[32:33], v[32:33], v[10:11]
    v_pk_add_f32 v[34:35], v[34:35], v[12:13]
    v_pk_mul_f32 v[10:11], v[32:33], s[14:15]
    v_pk_mul_f32 v[12:13], v[34:35], s[14:15]
    v_exp_f32 v10, v10
    v_exp_f32 v11, v11
    v_exp_f32 v12, v12
    v_exp_f32 v13, v13
    v_pk_add_f32 v[10:11], v[10:11], s[74:75]
    v_pk_add_f32 v[12:13], v[12:13], s[74:75]
    v_rcp_f32 v10, v10
    v_rcp_f32 v11, v11
    v_rcp_f32_e64 v12, v12
    v_rcp_f32_e64 v13, v13
    v_pk_mul_f32 v[32:33], v[10:11], v[32:33]
    v_pk_mul_f32 v[34:35], v[12:13], v[34:35]
    s_cmp_eq_u32 s83, 0xff
    s_cbranch_scc1 L_fin3b
    buffer_load_dword v5, v51, s[48:51], s82 offen sc1
    s_mov_b32 s65, 60000
L_finb:
    s_waitcnt vmcnt(0)
    v_cmp_lt_u32 vcc, 0, v5
    s_nop 1
    s_and_b32 s81, vcc_lo, 0xff
    s_andn2_b32 s81, s81, s83
    s_or_b32 s83, s83, s81
    s_bitcmp1_b32 s81, 0
    s_cbranch_scc0 L_f1_0b
    s_add_u32 s3, s78, 0
    s_add_u32 s35, s79, 0
    buffer_load_dwordx4 v[80:83], v1, s[48:51], s3 offen sc1
    buffer_load_dwordx4 v[84:87], v1, s[48:51], s3 offen offset:1024 sc1
    buffer_load_dwordx2 v[240:241], v49, s[48:51], s35 offen sc1
L_f1_0b:
    s_bitcmp1_b32 s81, 1
    s_cbranch_scc0 L_f1_1b
    s_add_u32 s3, s78, 2621440
    s_add_u32 s35, s79, 2621440
    buffer_load_dwordx4 v[88:91], v1, s[48:51], s3 offen sc1
    buffer_load_dwordx4 v[92:95], v1, s[48:51], s3 offen offset:1024 sc1
    buffer_load_dwordx2 v[242:243], v49, s[48:51], s35 offen sc1
L_f1_1b:
    s_bitcmp1_b32 s81, 2
    s_cbranch_scc0 L_f1_2b
    s_add_u32 s3, s78, 5242880
    s_add_u32 s35, s79, 5242880
    buffer_load_dwordx4 v[112:115], v1, s[48:51], s3 offen sc1
    buffer_load_dwordx4 v[116:119], v1, s[48:51], s3 offen offset:1024 sc1
    buffer_load_dwordx2 v[244:245], v49, s[48:51], s35 offen sc1
L_f1_2b:
    s_bitcmp1_b32 s81, 3
    s_cbranch_scc0 L_f1_3b
    s_add_u32 s3, s78, 7864320
    s_add_u32 s35, s79, 7864320
    buffer_load_dwordx4 v[120:123], v1, s[48:51], s3 offen sc1
    buffer_load_dwordx4 v[124:127], v1, s[48:51], s3 offen offset:1024 sc1
    buffer_load_dwordx2 v[246:247], v49, s[48:51], s35 offen sc1
L_f1_3b:
    s_bitcmp1_b32 s81, 4
    s_cbranch_scc0 L_f1_4b
    s_add_u32 s3, s78, 10485760
    s_add_u32 s35, s79, 10485760
    buffer_load_dwordx4 v[160:163], v1, s[48:51], s3 offen sc1
    buffer_load_dwordx4 v[164:167], v1, s[48:51], s3 offen offset:1024 sc1
    buffer_load_dwordx2 v[52:53], v49, s[48:51], s35 offen sc1
L_f1_4b:
    s_bitcmp1_b32 s81, 5
    s_cbranch_scc0 L_f1_5b
    s_add_u32 s3, s78, 13107200
    s_add_u32 s35, s79, 13107200
    buffer_load_dwordx4 v[168:171], v1, s[48:51], s3 offen sc1
    buffer_load_dwordx4 v[172:175], v1, s[48:51], s3 offen offset:1024 sc1
    buffer_load_dwordx2 v[54:55], v49, s[48:51], s35 offen sc1
L_f1_5b:
    s_bitcmp1_b32 s81, 6
    s_cbranch_scc0 L_f1_6b
    s_add_u32 s3, s78, 15728640
    s_add_u32 s35, s79, 15728640
    buffer_load_dwordx4 v[208:211], v1, s[48:51], s3 offen sc1
    buffer_load_dwordx4 v[212:215], v1, s[48:51], s3 offen offset:1024 sc1
    buffer_load_dwordx2 v[56:57], v49, s[48:51], s35 offen sc1
L_f1_6b:
    s_bitcmp1_b32 s81, 7
    s_cbranch_scc0 L_f1_7b
    s_add_u32 s3, s78, 18350080
    s_add_u32 s35, s79, 18350080
    buffer_load_dwordx4 v[216:219], v1, s[48:51], s3 offen sc1
    buffer_load_dwordx4 v[220:223], v1, s[48:51], s3 offen offset:1024 sc1
    buffer_load_dwordx2 v[46:47], v49, s[48:51], s35 offen sc1
L_f1_7b:
    s_cmp_eq_u32 s83, 0xff
    s_cbranch_scc1 L_fin2b
    s_sleep 12
    buffer_load_dword v5, v51, s[48:51], s82 offen sc1
    s_sub_u32 s65, s65, 1
    s_cbranch_scc0 L_finb
L_fin2b:
    s_waitcnt vmcnt(0)
L_fin3b:
    s_waitcnt vmcnt(21)
    v_dot2c_f32_bf16 v128, s62, v80
    v_dot2c_f32_bf16 v129, s63, v80
    v_dot2c_f32_bf16 v130, s62, v81
    v_dot2c_f32_bf16 v131, s63, v81
    v_dot2c_f32_bf16 v132, s62, v82
    v_dot2c_f32_bf16 v133, s63, v82
    v_dot2c_f32_bf16 v134, s62, v83
    v_dot2c_f32_bf16 v135, s63, v83
    v_dot2c_f32_bf16 v136, s62, v84
    v_dot2c_f32_bf16 v137, s63, v84
    v_dot2c_f32_bf16 v138, s62, v85
    v_dot2c_f32_bf16 v139, s63, v85
    v_dot2c_f32_bf16 v140, s62, v86
    v_dot2c_f32_bf16 v141, s63, v86
    v_dot2c_f32_bf16 v142, s62, v87
    v_dot2c_f32_bf16 v143, s63, v87
    v_dot2c_f32_bf16 v144, s62, v240
    v_dot2c_f32_bf16 v145, s63, v240
    v_dot2c_f32_bf16 v146, s62, v241
    v_dot2c_f32_bf16 v147, s63, v241
    s_waitcnt vmcnt(18)
    v_dot2c_f32_bf16 v128, s62, v88
    v_dot2c_f32_bf16 v129, s63, v88
    v_dot2c_f32_bf16 v130, s62, v89
    v_dot2c_f32_bf16 v131, s63, v89
    v_dot2c_f32_bf16 v132, s62, v90
    v_dot2c_f32_bf16 v133, s63, v90
    v_dot2c_f32_bf16 v134, s62, v91
    v_dot2c_f32_bf16 v135, s63, v91
    v_dot2c_f32_bf16 v136, s62, v92
    v_dot2c_f32_bf16 v137, s63, v92
    v_dot2c_f32_bf16 v138, s62, v93
    v_dot2c_f32_bf16 v139, s63, v93
    v_dot2c_f32_bf16 v140, s62, v94
    v_dot2c_f32_bf16 v141, s63, v94
    v_dot2c_f32_bf16 v142, s62, v95
    v_dot2c_f32_bf16 v143, s63, v95
    v_dot2c_f32_bf16 v144, s62, v242
    v_dot2c_f32_bf16 v145, s63, v242
    v_dot2c_f32_bf16 v146, s62, v243
    v_dot2c_f32_bf16 v147, s63, v243
    s_waitcnt vmcnt(15)
    v_dot2c_f32_bf16 v128, s62, v112
    v_dot2c_f32_bf16 v129, s63, v112
    v_dot2c_f32_bf16 v130, s62, v113
    v_dot2c_f32_bf16 v131, s63, v113
    v_dot2c_f32_bf16 v132, s62, v114
    v_dot2c_f32_bf16 v133, s63, v114
    v_dot2c_f32_bf16 v134, s62, v115
    v_dot2c_f32_bf16 v135, s63, v115
    v_dot2c_f32_bf16 v136, s62, v116
    v_dot2c_f32_bf16 v137, s63, v116
    v_dot2c_f32_bf16 v138, s62, v117
    v_dot2c_f32_bf16 v139, s63, v117
    v_dot2c_f32_bf16 v140, s62, v118
    v_dot2c_f32_bf16 v141, s63, v118
    v_dot2c_f32_bf16 v142, s62, v119
    v_dot2c_f32_bf16 v143, s63, v119
    v_dot2c_f32_bf16 v144, s62, v244
    v_dot2c_f32_bf16 v145, s63, v244
    v_dot2c_f32_bf16 v146, s62, v245
    v_dot2c_f32_bf16 v147, s63, v245
    s_waitcnt vmcnt(12)
    v_dot2c_f32_bf16 v128, s62, v120
    v_dot2c_f32_bf16 v129, s63, v120
    v_dot2c_f32_bf16 v130, s62, v121
    v_dot2c_f32_bf16 v131, s63, v121
    v_dot2c_f32_bf16 v132, s62, v122
    v_dot2c_f32_bf16 v133, s63, v122
    v_dot2c_f32_bf16 v134, s62, v123
    v_dot2c_f32_bf16 v135, s63, v123
    v_dot2c_f32_bf16 v136, s62, v124
    v_dot2c_f32_bf16 v137, s63, v124
    v_dot2c_f32_bf16 v138, s62, v125
    v_dot2c_f32_bf16 v139, s63, v125
    v_dot2c_f32_bf16 v140, s62, v126
    v_dot2c_f32_bf16 v141, s63, v126
    v_dot2c_f32_bf16 v142, s62, v127
    v_dot2c_f32_bf16 v143, s63, v127
    v_dot2c_f32_bf16 v144, s62, v246
    v_dot2c_f32_bf16 v145, s63, v246
    v_dot2c_f32_bf16 v146, s62, v247
    v_dot2c_f32_bf16 v147, s63, v247
    s_waitcnt vmcnt(9)
    v_dot2c_f32_bf16 v128, s62, v160
    v_dot2c_f32_bf16 v129, s63, v160
    v_dot2c_f32_bf16 v130, s62, v161
    v_dot2c_f32_bf16 v131, s63, v161
    v_dot2c_f32_bf16 v132, s62, v162
    v_dot2c_f32_bf16 v133, s63, v162
    v_dot2c_f32_bf16 v134, s62, v163
    v_dot2c_f32_bf16 v135, s63, v163
    v_dot2c_f32_bf16 v136, s62, v164
    v_dot2c_f32_bf16 v137, s63, v164
    v_dot2c_f32_bf16 v138, s62, v165
    v_dot2c_f32_bf16 v139, s63, v165
    v_dot2c_f32_bf16 v140, s62, v166
    v_dot2c_f32_bf16 v141, s63, v166
    v_dot2c_f32_bf16 v142, s62, v167
    v_dot2c_f32_bf16 v143, s63, v167
    v_dot2c_f32_bf16 v144, s62, v52
    v_dot2c_f32_bf16 v145, s63, v52
    v_dot2c_f32_bf16 v146, s62, v53
    v_dot2c_f32_bf16 v147, s63, v53
    s_waitcnt vmcnt(6)
    v_dot2c_f32_bf16 v128, s62, v168
    v_dot2c_f32_bf16 v129, s63, v168
    v_dot2c_f32_bf16 v130, s62, v169
    v_dot2c_f32_bf16 v131, s63, v169
    v_dot2c_f32_bf16 v132, s62, v170
    v_dot2c_f32_bf16 v133, s63, v170
    v_dot2c_f32_bf16 v134, s62, v171
    v_dot2c_f32_bf16 v135, s63, v171
    v_dot2c_f32_bf16 v136, s62, v172
    v_dot2c_f32_bf16 v137, s63, v172
    v_dot2c_f32_bf16 v138, s62, v173
    v_dot2c_f32_bf16 v139, s63, v173
    v_dot2c_f32_bf16 v140, s62, v174
    v_dot2c_f32_bf16 v141, s63, v174
    v_dot2c_f32_bf16 v142, s62, v175
    v_dot2c_f32_bf16 v143, s63, v175
    v_dot2c_f32_bf16 v144, s62, v54
    v_dot2c_f32_bf16 v145, s63, v54
    v_dot2c_f32_bf16 v146, s62, v55
    v_dot2c_f32_bf16 v147, s63, v55
    s_waitcnt vmcnt(3)
    v_dot2c_f32_bf16 v128, s62, v208
    v_dot2c_f32_bf16 v129, s63, v208
    v_dot2c_f32_bf16 v130, s62, v209
    v_dot2c_f32_bf16 v131, s63, v209
    v_dot2c_f32_bf16 v132, s62, v210
    v_dot2c_f32_bf16 v133, s63, v210
    v_dot2c_f32_bf16 v134, s62, v211
    v_dot2c_f32_bf16 v135, s63, v211
    v_dot2c_f32_bf16 v136, s62, v212
    v_dot2c_f32_bf16 v137, s63, v212
    v_dot2c_f32_bf16 v138, s62, v213
    v_dot2c_f32_bf16 v139, s63, v213
    v_dot2c_f32_bf16 v140, s62, v214
    v_dot2c_f32_bf16 v141, s63, v214
    v_dot2c_f32_bf16 v142, s62, v215
    v_dot2c_f32_bf16 v143, s63, v215
    v_dot2c_f32_bf16 v144, s62, v56
    v_dot2c_f32_bf16 v145, s63, v56
    v_dot2c_f32_bf16 v146, s62, v57
    v_dot2c_f32_bf16 v147, s63, v57
    s_waitcnt vmcnt(0)
    v_dot2c_f32_bf16 v128, s62, v216
    v_dot2c_f32_bf16 v129, s63, v216
    v_dot2c_f32_bf16 v130, s62, v217
    v_dot2c_f32_bf16 v131, s63, v217
    v_dot2c_f32_bf16 v132, s62, v218
    v_dot2c_f32_bf16 v133, s63, v218
    v_dot2c_f32_bf16 v134, s62, v219
    v_dot2c_f32_bf16 v135, s63, v219
    v_dot2c_f32_bf16 v136, s62, v220
    v_dot2c_f32_bf16 v137, s63, v220
    v_dot2c_f32_bf16 v138, s62, v221
    v_dot2c_f32_bf16 v139, s63, v221
    v_dot2c_f32_bf16 v140, s62, v222
    v_dot2c_f32_bf16 v141, s63, v222
    v_dot2c_f32_bf16 v142, s62, v223
    v_dot2c_f32_bf16 v143, s63, v223
    v_dot2c_f32_bf16 v144, s62, v46
    v_dot2c_f32_bf16 v145, s63, v46
    v_dot2c_f32_bf16 v146, s62, v47
    v_dot2c_f32_bf16 v147, s63, v47
    v_pk_fma_f32 v[16:17], v[16:17], v[128:129], v[176:177]
    s_nop 0
    v_cvt_pk_bf16_f32 v36, v16, v17
    v_pk_fma_f32 v[18:19], v[18:19], v[130:131], v[178:179]
    v_cvt_pk_bf16_f32 v37, v18, v19
    buffer_store_dwordx2 v[36:37], v50, s[40:43], s80 offen offset:0
    v_pk_fma_f32 v[20:21], v[20:21], v[132:133], v[180:181]
    v_cvt_pk_bf16_f32 v38, v20, v21
    v_pk_fma_f32 v[22:23], v[22:23], v[134:135], v[182:183]
    v_cvt_pk_bf16_f32 v39, v22, v23
    buffer_store_dwordx2 v[38:39], v50, s[40:43], s80 offen offset:32
    v_pk_fma_f32 v[24:25], v[24:25], v[136:137], v[184:185]
    v_cvt_pk_bf16_f32 v40, v24, v25
    v_pk_fma_f32 v[26:27], v[26:27], v[138:139], v[186:187]
    v_cvt_pk_bf16_f32 v41, v26, v27
    buffer_store_dwordx2 v[40:41], v50, s[40:43], s80 offen offset:64
    v_pk_fma_f32 v[28:29], v[28:29], v[140:141], v[188:189]
    v_cvt_pk_bf16_f32 v42, v28, v29
    v_pk_fma_f32 v[30:31], v[30:31], v[142:143], v[190:191]
    v_cvt_pk_bf16_f32 v43, v30, v31
    buffer_store_dwordx2 v[42:43], v50, s[40:43], s80 offen offset:96
    v_pk_fma_f32 v[32:33], v[32:33], v[144:145], v[192:193]
    v_cvt_pk_bf16_f32 v44, v32, v33
    v_pk_fma_f32 v[34:35], v[34:35], v[146:147], v[194:195]
    v_cvt_pk_bf16_f32 v45, v34, v35
    buffer_store_dwordx2 v[44:45], v50, s[40:43], s80 offen offset:128
    s_endpgm
L_pf2:
L_slow3:
    s_mov_b32 s65, 60000
L_spin3:
    s_sleep 6
    buffer_load_dword v15, v14, s[56:59], s78 offen sc1
    s_waitcnt vmcnt(0)
    v_cmp_gt_u32 vcc, 20, v15
    s_cbranch_vccz L_ok3
    s_sub_u32 s65, s65, 1
    s_cbranch_scc0 L_spin3
    s_branch L_ok3
L_slow4:
    s_mov_b32 s65, 60000
L_spin4:
    s_sleep 6
    buffer_load_dword v13, v55, s[56:59], 0 offen sc1
    s_waitcnt vmcnt(0)
    v_cmp_gt_u32 vcc, 20, v13
    s_cbranch_vccz L_ok4
    s_sub_u32 s65, s65, 1
    s_cbranch_scc0 L_spin4
    s_branch L_ok4
L_slow5:
    s_mov_b32 s65, 60000
L_spin5:
    s_sleep 6
    buffer_load_dword v15, v14, s[48:51], s81 offen sc1
    s_waitcnt vmcnt(0)
    v_cmp_gt_u32 vcc, 32, v15
    s_cbranch_vccz L_ok5
    s_sub_u32 s65, s65, 1
    s_cbranch_scc0 L_spin5
    s_branch L_ok5
L_slow7:
    s_mov_b32 s65, 60000
L_spin7:
    s_sleep 6
    buffer_load_dword v235, v234, s[48:51], s77 offen sc1
    s_waitcnt vmcnt(0)
    v_cmp_gt_u32 vcc, 32, v235
    s_cbranch_vccz L_ok7
    s_sub_u32 s65, s65, 1
    s_cbranch_scc0 L_spin7
    s_branch L_ok7
L_slow11:
    s_mov_b32 s65, 60000
L_spin11:
    s_sleep 6
    buffer_load_dword v235, v234, s[48:51], s77 offen sc1
    s_waitcnt vmcnt(0)
    v_cmp_gt_u32 vcc, 32, v235
    s_cbranch_vccz L_ok11
    s_sub_u32 s65, s65, 1
    s_cbranch_scc0 L_spin11
    s_branch L_ok11
L_slow15:
    s_mov_b32 s65, 60000
L_spin15:
    s_sleep 6
    buffer_load_dword v57, v4, s[48:51], s71 offen sc1
    s_waitcnt vmcnt(0)
    v_cmp_gt_u32 vcc, 4, v57
    s_cbranch_vccz L_ok15
    s_sub_u32 s65, s65, 1
    s_cbranch_scc0 L_spin15
    s_branch L_ok15
L_slow17:
    s_mov_b32 s65, 60000
L_spin17:
    s_sleep 6
    buffer_load_dword v7, v4, s[48:51], s77 offen sc1
    s_waitcnt vmcnt(0)
    v_cmp_gt_u32 vcc, 32, v7
    s_cbranch_vccz L_ok17
    s_sub_u32 s65, s65, 1
    s_cbranch_scc0 L_spin17
    s_branch L_ok17
L_slow16:
    s_mov_b32 s65, 60000
L_spin16:
    s_sleep 6
    buffer_load_dword v57, v4, s[48:51], s9 offen sc1
    s_waitcnt vmcnt(0)
    v_cmp_gt_u32 vcc, 4, v57
    s_cbranch_vccz L_ok16
    s_sub_u32 s65, s65, 1
    s_cbranch_scc0 L_spin16
    s_branch L_ok16
L_slow21:
    s_mov_b32 s65, 60000
L_spin21:
    s_sleep 6
    buffer_load_dword v57, v4, s[48:51], s71 offen sc1
    s_waitcnt vmcnt(0)
    v_cmp_gt_u32 vcc, 4, v57
    s_cbranch_vccz L_ok21
    s_sub_u32 s65, s65, 1
    s_cbranch_scc0 L_spin21
    s_branch L_ok21
L_slow23:
    s_mov_b32 s65, 60000
L_spin23:
    s_sleep 6
    buffer_load_dword v7, v4, s[48:51], s77 offen sc1
    s_waitcnt vmcnt(0)
    v_cmp_gt_u32 vcc, 32, v7
    s_cbranch_vccz L_ok23
    s_sub_u32 s65, s65, 1
    s_cbranch_scc0 L_spin23
    s_branch L_ok23
L_rare0:
    s_nop 7
    s_nop 1
    v_lshrrev_b32 v51, 8, v1
    v_lshlrev_b32 v51, 4, v51
    v_max3_f32 v48, v64, v65, v66
    v_max3_f32 v48, v48, v67, v80
    v_max3_f32 v48, v48, v81, v82
    v_max_f32 v48, v48, v83
    v_mov_b32 v49, v48
    s_nop 1
    v_permlane32_swap_b32 v48, v49
    s_nop 1
    v_max_f32 v48, v48, v49
    v_mov_b32 v49, v48
    s_nop 1
    v_permlane16_swap_b32 v48, v49
    s_nop 1
    v_max_f32 v48, v48, v49
    v_add_f32 v48, 0x423c0000, v48
    v_max_f32 v48, 0, v48
    v_exp_f32 v50, -v48
    v_sub_f32 v64, v64, v48
    v_sub_f32 v65, v65, v48
    v_sub_f32 v66, v66, v48
    v_sub_f32 v67, v67, v48
    v_sub_f32 v80, v80, v48
    v_sub_f32 v81, v81, v48
    v_sub_f32 v82, v82, v48
    v_sub_f32 v83, v83, v48
    ds_bpermute_b32 v216, v51, v50 offset:0
    ds_bpermute_b32 v217, v51, v50 offset:4
    ds_bpermute_b32 v218, v51, v50 offset:8
    ds_bpermute_b32 v219, v51, v50 offset:12
    v_sub_f32 v96, v96, v48
    v_sub_f32 v97, v97, v48
    v_sub_f32 v98, v98, v48
    v_sub_f32 v99, v99, v48
    v_mul_f32 v224, v224, v50
    v_mul_f32 v14, v14, v50
    s_waitcnt lgkmcnt(0)
    v_accvgpr_read_b32 v52, a0
    v_accvgpr_read_b32 v53, a1
    v_accvgpr_read_b32 v54, a2
    v_accvgpr_read_b32 v55, a3
    v_mul_f32 v52, v52, v216
    v_mul_f32 v53, v53, v217
    v_mul_f32 v54, v54, v218
    v_mul_f32 v55, v55, v219
    v_accvgpr_write_b32 a0, v52
    v_accvgpr_write_b32 a1, v53
    v_accvgpr_write_b32 a2, v54
    v_accvgpr_write_b32 a3, v55
    v_accvgpr_read_b32 v52, a16
    v_accvgpr_read_b32 v53, a17
    v_accvgpr_read_b32 v54, a18
    v_accvgpr_read_b32 v55, a19
    v_mul_f32 v52, v52, v216
    v_mul_f32 v53, v53, v217
    v_mul_f32 v54, v54, v218
    v_mul_f32 v55, v55, v219
    v_accvgpr_write_b32 a16, v52
    v_accvgpr_write_b32 a17, v53
    v_accvgpr_write_b32 a18, v54
    v_accvgpr_write_b32 a19, v55
    v_accvgpr_read_b32 v52, a32
    v_accvgpr_read_b32 v53, a33
    v_accvgpr_read_b32 v54, a34
    v_accvgpr_read_b32 v55, a35
    v_mul_f32 v52, v52, v216
    v_mul_f32 v53, v53, v217
    v_mul_f32 v54, v54, v218
    v_mul_f32 v55, v55, v219
    v_accvgpr_write_b32 a32, v52
    v_accvgpr_write_b32 a33, v53
    v_accvgpr_write_b32 a34, v54
    v_accvgpr_write_b32 a35, v55
    v_accvgpr_read_b32 v52, a48
    v_accvgpr_read_b32 v53, a49
    v_accvgpr_read_b32 v54, a50
    v_accvgpr_read_b32 v55, a51
    v_mul_f32 v52, v52, v216
    v_mul_f32 v53, v53, v217
    v_mul_f32 v54, v54, v218
    v_mul_f32 v55, v55, v219
    v_accvgpr_write_b32 a48, v52
    v_accvgpr_write_b32 a49, v53
    v_accvgpr_write_b32 a50, v54
    v_accvgpr_write_b32 a51, v55
    v_accvgpr_read_b32 v52, a64
    v_accvgpr_read_b32 v53, a65
    v_accvgpr_read_b32 v54, a66
    v_accvgpr_read_b32 v55, a67
    v_mul_f32 v52, v52, v216
    v_mul_f32 v53, v53, v217
    v_mul_f32 v54, v54, v218
    v_mul_f32 v55, v55, v219
    v_accvgpr_write_b32 a64, v52
    v_accvgpr_write_b32 a65, v53
    v_accvgpr_write_b32 a66, v54
    v_accvgpr_write_b32 a67, v55
    v_accvgpr_read_b32 v52, a80
    v_accvgpr_read_b32 v53, a81
    v_accvgpr_read_b32 v54, a82
    v_accvgpr_read_b32 v55, a83
    v_mul_f32 v52, v52, v216
    v_mul_f32 v53, v53, v217
    v_mul_f32 v54, v54, v218
    v_mul_f32 v55, v55, v219
    v_accvgpr_write_b32 a80, v52
    v_accvgpr_write_b32 a81, v53
    v_accvgpr_write_b32 a82, v54
    v_accvgpr_write_b32 a83, v55
    v_accvgpr_read_b32 v52, a96
    v_accvgpr_read_b32 v53, a97
    v_accvgpr_read_b32 v54, a98
    v_accvgpr_read_b32 v55, a99
    v_mul_f32 v52, v52, v216
    v_mul_f32 v53, v53, v217
    v_mul_f32 v54, v54, v218
    v_mul_f32 v55, v55, v219
    v_accvgpr_write_b32 a96, v52
    v_accvgpr_write_b32 a97, v53
    v_accvgpr_write_b32 a98, v54
    v_accvgpr_write_b32 a99, v55
    v_accvgpr_read_b32 v52, a112
    v_accvgpr_read_b32 v53, a113
    v_accvgpr_read_b32 v54, a114
    v_accvgpr_read_b32 v55, a115
    v_mul_f32 v52, v52, v216
    v_mul_f32 v53, v53, v217
    v_mul_f32 v54, v54, v218
    v_mul_f32 v55, v55, v219
    v_accvgpr_write_b32 a112, v52
    v_accvgpr_write_b32 a113, v53
    v_accvgpr_write_b32 a114, v54
    v_accvgpr_write_b32 a115, v55
    v_accvgpr_read_b32 v52, a128
    v_accvgpr_read_b32 v53, a129
    v_accvgpr_read_b32 v54, a130
    v_accvgpr_read_b32 v55, a131
    v_mul_f32 v52, v52, v216
    v_mul_f32 v53, v53, v217
    v_mul_f32 v54, v54, v218
    v_mul_f32 v55, v55, v219
    v_accvgpr_write_b32 a128, v52
    v_accvgpr_write_b32 a129, v53
    v_accvgpr_write_b32 a130, v54
    v_accvgpr_write_b32 a131, v55
    v_accvgpr_read_b32 v52, a144
    v_accvgpr_read_b32 v53, a145
    v_accvgpr_read_b32 v54, a146
    v_accvgpr_read_b32 v55, a147
    v_mul_f32 v52, v52, v216
    v_mul_f32 v53, v53, v217
    v_mul_f32 v54, v54, v218
    v_mul_f32 v55, v55, v219
    v_accvgpr_write_b32 a144, v52
    v_accvgpr_write_b32 a145, v53
    v_accvgpr_write_b32 a146, v54
    v_accvgpr_write_b32 a147, v55
    v_accvgpr_read_b32 v52, a160
    v_accvgpr_read_b32 v53, a161
    v_accvgpr_read_b32 v54, a162
    v_accvgpr_read_b32 v55, a163
    v_mul_f32 v52, v52, v216
    v_mul_f32 v53, v53, v217
    v_mul_f32 v54, v54, v218
    v_mul_f32 v55, v55, v219
    v_accvgpr_write_b32 a160, v52
    v_accvgpr_write_b32 a161, v53
    v_accvgpr_write_b32 a162, v54
    v_accvgpr_write_b32 a163, v55
    v_accvgpr_read_b32 v52, a176
    v_accvgpr_read_b32 v53, a177
    v_accvgpr_read_b32 v54, a178
    v_accvgpr_read_b32 v55, a179
    v_mul_f32 v52, v52, v216
    v_mul_f32 v53, v53, v217
    v_mul_f32 v54, v54, v218
    v_mul_f32 v55, v55, v219
    v_accvgpr_write_b32 a176, v52
    v_accvgpr_write_b32 a177, v53
    v_accvgpr_write_b32 a178, v54
    v_accvgpr_write_b32 a179, v55
    v_max3_f32 v48, v68, v69, v70
    v_max3_f32 v48, v48, v71, v84
    v_max3_f32 v48, v48, v85, v86
    v_max_f32 v48, v48, v87
    v_mov_b32 v49, v48
    s_nop 1
    v_permlane32_swap_b32 v48, v49
    s_nop 1
    v_max_f32 v48, v48, v49
    v_mov_b32 v49, v48
    s_nop 1
    v_permlane16_swap_b32 v48, v49
    s_nop 1
    v_max_f32 v48, v48, v49
    v_add_f32 v48, 0x423c0000, v48
    v_max_f32 v48, 0, v48
    v_exp_f32 v50, -v48
    v_sub_f32 v68, v68, v48
    v_sub_f32 v69, v69, v48
    v_sub_f32 v70, v70, v48
    v_sub_f32 v71, v71, v48
    v_sub_f32 v84, v84, v48
    v_sub_f32 v85, v85, v48
    v_sub_f32 v86, v86, v48
    v_sub_f32 v87, v87, v48
    ds_bpermute_b32 v216, v51, v50 offset:0
    ds_bpermute_b32 v217, v51, v50 offset:4
    ds_bpermute_b32 v218, v51, v50 offset:8
    ds_bpermute_b32 v219, v51, v50 offset:12
    v_sub_f32 v100, v100, v48
    v_sub_f32 v101, v101, v48
    v_sub_f32 v102, v102, v48
    v_sub_f32 v103, v103, v48
    v_mul_f32 v225, v225, v50
    v_mul_f32 v15, v15, v50
    s_waitcnt lgkmcnt(0)
    v_accvgpr_read_b32 v52, a4
    v_accvgpr_read_b32 v53, a5
    v_accvgpr_read_b32 v54, a6
    v_accvgpr_read_b32 v55, a7
    v_mul_f32 v52, v52, v216
    v_mul_f32 v53, v53, v217
    v_mul_f32 v54, v54, v218
    v_mul_f32 v55, v55, v219
    v_accvgpr_write_b32 a4, v52
    v_accvgpr_write_b32 a5, v53
    v_accvgpr_write_b32 a6, v54
    v_accvgpr_write_b32 a7, v55
    v_accvgpr_read_b32 v52, a20
    v_accvgpr_read_b32 v53, a21
    v_accvgpr_read_b32 v54, a22
    v_accvgpr_read_b32 v55, a23
    v_mul_f32 v52, v52, v216
    v_mul_f32 v53, v53, v217
    v_mul_f32 v54, v54, v218
    v_mul_f32 v55, v55, v219
    v_accvgpr_write_b32 a20, v52
    v_accvgpr_write_b32 a21, v53
    v_accvgpr_write_b32 a22, v54
    v_accvgpr_write_b32 a23, v55
    v_accvgpr_read_b32 v52, a36
    v_accvgpr_read_b32 v53, a37
    v_accvgpr_read_b32 v54, a38
    v_accvgpr_read_b32 v55, a39
    v_mul_f32 v52, v52, v216
    v_mul_f32 v53, v53, v217
    v_mul_f32 v54, v54, v218
    v_mul_f32 v55, v55, v219
    v_accvgpr_write_b32 a36, v52
    v_accvgpr_write_b32 a37, v53
    v_accvgpr_write_b32 a38, v54
    v_accvgpr_write_b32 a39, v55
    v_accvgpr_read_b32 v52, a52
    v_accvgpr_read_b32 v53, a53
    v_accvgpr_read_b32 v54, a54
    v_accvgpr_read_b32 v55, a55
    v_mul_f32 v52, v52, v216
    v_mul_f32 v53, v53, v217
    v_mul_f32 v54, v54, v218
    v_mul_f32 v55, v55, v219
    v_accvgpr_write_b32 a52, v52
    v_accvgpr_write_b32 a53, v53
    v_accvgpr_write_b32 a54, v54
    v_accvgpr_write_b32 a55, v55
    v_accvgpr_read_b32 v52, a68
    v_accvgpr_read_b32 v53, a69
    v_accvgpr_read_b32 v54, a70
    v_accvgpr_read_b32 v55, a71
    v_mul_f32 v52, v52, v216
    v_mul_f32 v53, v53, v217
    v_mul_f32 v54, v54, v218
    v_mul_f32 v55, v55, v219
    v_accvgpr_write_b32 a68, v52
    v_accvgpr_write_b32 a69, v53
    v_accvgpr_write_b32 a70, v54
    v_accvgpr_write_b32 a71, v55
    v_accvgpr_read_b32 v52, a84
    v_accvgpr_read_b32 v53, a85
    v_accvgpr_read_b32 v54, a86
    v_accvgpr_read_b32 v55, a87
    v_mul_f32 v52, v52, v216
    v_mul_f32 v53, v53, v217
    v_mul_f32 v54, v54, v218
    v_mul_f32 v55, v55, v219
    v_accvgpr_write_b32 a84, v52
    v_accvgpr_write_b32 a85, v53
    v_accvgpr_write_b32 a86, v54
    v_accvgpr_write_b32 a87, v55
    v_accvgpr_read_b32 v52, a100
    v_accvgpr_read_b32 v53, a101
    v_accvgpr_read_b32 v54, a102
    v_accvgpr_read_b32 v55, a103
    v_mul_f32 v52, v52, v216
    v_mul_f32 v53, v53, v217
    v_mul_f32 v54, v54, v218
    v_mul_f32 v55, v55, v219
    v_accvgpr_write_b32 a100, v52
    v_accvgpr_write_b32 a101, v53
    v_accvgpr_write_b32 a102, v54
    v_accvgpr_write_b32 a103, v55
    v_accvgpr_read_b32 v52, a116
    v_accvgpr_read_b32 v53, a117
    v_accvgpr_read_b32 v54, a118
    v_accvgpr_read_b32 v55, a119
    v_mul_f32 v52, v52, v216
    v_mul_f32 v53, v53, v217
    v_mul_f32 v54, v54, v218
    v_mul_f32 v55, v55, v219
    v_accvgpr_write_b32 a116, v52
    v_accvgpr_write_b32 a117, v53
    v_accvgpr_write_b32 a118, v54
    v_accvgpr_write_b32 a119, v55
    v_accvgpr_read_b32 v52, a132
    v_accvgpr_read_b32 v53, a133
    v_accvgpr_read_b32 v54, a134
    v_accvgpr_read_b32 v55, a135
    v_mul_f32 v52, v52, v216
    v_mul_f32 v53, v53, v217
    v_mul_f32 v54, v54, v218
    v_mul_f32 v55, v55, v219
    v_accvgpr_write_b32 a132, v52
    v_accvgpr_write_b32 a133, v53
    v_accvgpr_write_b32 a134, v54
    v_accvgpr_write_b32 a135, v55
    v_accvgpr_read_b32 v52, a148
    v_accvgpr_read_b32 v53, a149
    v_accvgpr_read_b32 v54, a150
    v_accvgpr_read_b32 v55, a151
    v_mul_f32 v52, v52, v216
    v_mul_f32 v53, v53, v217
    v_mul_f32 v54, v54, v218
    v_mul_f32 v55, v55, v219
    v_accvgpr_write_b32 a148, v52
    v_accvgpr_write_b32 a149, v53
    v_accvgpr_write_b32 a150, v54
    v_accvgpr_write_b32 a151, v55
    v_accvgpr_read_b32 v52, a164
    v_accvgpr_read_b32 v53, a165
    v_accvgpr_read_b32 v54, a166
    v_accvgpr_read_b32 v55, a167
    v_mul_f32 v52, v52, v216
    v_mul_f32 v53, v53, v217
    v_mul_f32 v54, v54, v218
    v_mul_f32 v55, v55, v219
    v_accvgpr_write_b32 a164, v52
    v_accvgpr_write_b32 a165, v53
    v_accvgpr_write_b32 a166, v54
    v_accvgpr_write_b32 a167, v55
    v_accvgpr_read_b32 v52, a180
    v_accvgpr_read_b32 v53, a181
    v_accvgpr_read_b32 v54, a182
    v_accvgpr_read_b32 v55, a183
    v_mul_f32 v52, v52, v216
    v_mul_f32 v53, v53, v217
    v_mul_f32 v54, v54, v218
    v_mul_f32 v55, v55, v219
    v_accvgpr_write_b32 a180, v52
    v_accvgpr_write_b32 a181, v53
    v_accvgpr_write_b32 a182, v54
    v_accvgpr_write_b32 a183, v55
    v_max3_f32 v48, v72, v73, v74
    v_max3_f32 v48, v48, v75, v88
    v_max3_f32 v48, v48, v89, v90
    v_max_f32 v48, v48, v91
    v_mov_b32 v49, v48
    s_nop 1
    v_permlane32_swap_b32 v48, v49
    s_nop 1
    v_max_f32 v48, v48, v49
    v_mov_b32 v49, v48
    s_nop 1
    v_permlane16_swap_b32 v48, v49
    s_nop 1
    v_max_f32 v48, v48, v49
    v_add_f32 v48, 0x423c0000, v48
    v_max_f32 v48, 0, v48
    v_exp_f32 v50, -v48
    v_sub_f32 v72, v72, v48
    v_sub_f32 v73, v73, v48
    v_sub_f32 v74, v74, v48
    v_sub_f32 v75, v75, v48
    v_sub_f32 v88, v88, v48
    v_sub_f32 v89, v89, v48
    v_sub_f32 v90, v90, v48
    v_sub_f32 v91, v91, v48
    ds_bpermute_b32 v216, v51, v50 offset:0
    ds_bpermute_b32 v217, v51, v50 offset:4
    ds_bpermute_b32 v218, v51, v50 offset:8
    ds_bpermute_b32 v219, v51, v50 offset:12
    v_sub_f32 v104, v104, v48
    v_sub_f32 v105, v105, v48
    v_sub_f32 v106, v106, v48
    v_sub_f32 v107, v107, v48
    v_mul_f32 v226, v226, v50
    v_mul_f32 v56, v56, v50
    s_waitcnt lgkmcnt(0)
    v_accvgpr_read_b32 v52, a8
    v_accvgpr_read_b32 v53, a9
    v_accvgpr_read_b32 v54, a10
    v_accvgpr_read_b32 v55, a11
    v_mul_f32 v52, v52, v216
    v_mul_f32 v53, v53, v217
    v_mul_f32 v54, v54, v218
    v_mul_f32 v55, v55, v219
    v_accvgpr_write_b32 a8, v52
    v_accvgpr_write_b32 a9, v53
    v_accvgpr_write_b32 a10, v54
    v_accvgpr_write_b32 a11, v55
    v_accvgpr_read_b32 v52, a24
    v_accvgpr_read_b32 v53, a25
    v_accvgpr_read_b32 v54, a26
    v_accvgpr_read_b32 v55, a27
    v_mul_f32 v52, v52, v216
    v_mul_f32 v53, v53, v217
    v_mul_f32 v54, v54, v218
    v_mul_f32 v55, v55, v219
    v_accvgpr_write_b32 a24, v52
    v_accvgpr_write_b32 a25, v53
    v_accvgpr_write_b32 a26, v54
    v_accvgpr_write_b32 a27, v55
    v_accvgpr_read_b32 v52, a40
    v_accvgpr_read_b32 v53, a41
    v_accvgpr_read_b32 v54, a42
    v_accvgpr_read_b32 v55, a43
    v_mul_f32 v52, v52, v216
    v_mul_f32 v53, v53, v217
    v_mul_f32 v54, v54, v218
    v_mul_f32 v55, v55, v219
    v_accvgpr_write_b32 a40, v52
    v_accvgpr_write_b32 a41, v53
    v_accvgpr_write_b32 a42, v54
    v_accvgpr_write_b32 a43, v55
    v_accvgpr_read_b32 v52, a56
    v_accvgpr_read_b32 v53, a57
    v_accvgpr_read_b32 v54, a58
    v_accvgpr_read_b32 v55, a59
    v_mul_f32 v52, v52, v216
    v_mul_f32 v53, v53, v217
    v_mul_f32 v54, v54, v218
    v_mul_f32 v55, v55, v219
    v_accvgpr_write_b32 a56, v52
    v_accvgpr_write_b32 a57, v53
    v_accvgpr_write_b32 a58, v54
    v_accvgpr_write_b32 a59, v55
    v_accvgpr_read_b32 v52, a72
    v_accvgpr_read_b32 v53, a73
    v_accvgpr_read_b32 v54, a74
    v_accvgpr_read_b32 v55, a75
    v_mul_f32 v52, v52, v216
    v_mul_f32 v53, v53, v217
    v_mul_f32 v54, v54, v218
    v_mul_f32 v55, v55, v219
    v_accvgpr_write_b32 a72, v52
    v_accvgpr_write_b32 a73, v53
    v_accvgpr_write_b32 a74, v54
    v_accvgpr_write_b32 a75, v55
    v_accvgpr_read_b32 v52, a88
    v_accvgpr_read_b32 v53, a89
    v_accvgpr_read_b32 v54, a90
    v_accvgpr_read_b32 v55, a91
    v_mul_f32 v52, v52, v216
    v_mul_f32 v53, v53, v217
    v_mul_f32 v54, v54, v218
    v_mul_f32 v55, v55, v219
    v_accvgpr_write_b32 a88, v52
    v_accvgpr_write_b32 a89, v53
    v_accvgpr_write_b32 a90, v54
    v_accvgpr_write_b32 a91, v55
    v_accvgpr_read_b32 v52, a104
    v_accvgpr_read_b32 v53, a105
    v_accvgpr_read_b32 v54, a106
    v_accvgpr_read_b32 v55, a107
    v_mul_f32 v52, v52, v216
    v_mul_f32 v53, v53, v217
    v_mul_f32 v54, v54, v218
    v_mul_f32 v55, v55, v219
    v_accvgpr_write_b32 a104, v52
    v_accvgpr_write_b32 a105, v53
    v_accvgpr_write_b32 a106, v54
    v_accvgpr_write_b32 a107, v55
    v_accvgpr_read_b32 v52, a120
    v_accvgpr_read_b32 v53, a121
    v_accvgpr_read_b32 v54, a122
    v_accvgpr_read_b32 v55, a123
    v_mul_f32 v52, v52, v216
    v_mul_f32 v53, v53, v217
    v_mul_f32 v54, v54, v218
    v_mul_f32 v55, v55, v219
    v_accvgpr_write_b32 a120, v52
    v_accvgpr_write_b32 a121, v53
    v_accvgpr_write_b32 a122, v54
    v_accvgpr_write_b32 a123, v55
    v_accvgpr_read_b32 v52, a136
    v_accvgpr_read_b32 v53, a137
    v_accvgpr_read_b32 v54, a138
    v_accvgpr_read_b32 v55, a139
    v_mul_f32 v52, v52, v216
    v_mul_f32 v53, v53, v217
    v_mul_f32 v54, v54, v218
    v_mul_f32 v55, v55, v219
    v_accvgpr_write_b32 a136, v52
    v_accvgpr_write_b32 a137, v53
    v_accvgpr_write_b32 a138, v54
    v_accvgpr_write_b32 a139, v55
    v_accvgpr_read_b32 v52, a152
    v_accvgpr_read_b32 v53, a153
    v_accvgpr_read_b32 v54, a154
    v_accvgpr_read_b32 v55, a155
    v_mul_f32 v52, v52, v216
    v_mul_f32 v53, v53, v217
    v_mul_f32 v54, v54, v218
    v_mul_f32 v55, v55, v219
    v_accvgpr_write_b32 a152, v52
    v_accvgpr_write_b32 a153, v53
    v_accvgpr_write_b32 a154, v54
    v_accvgpr_write_b32 a155, v55
    v_accvgpr_read_b32 v52, a168
    v_accvgpr_read_b32 v53, a169
    v_accvgpr_read_b32 v54, a170
    v_accvgpr_read_b32 v55, a171
    v_mul_f32 v52, v52, v216
    v_mul_f32 v53, v53, v217
    v_mul_f32 v54, v54, v218
    v_mul_f32 v55, v55, v219
    v_accvgpr_write_b32 a168, v52
    v_accvgpr_write_b32 a169, v53
    v_accvgpr_write_b32 a170, v54
    v_accvgpr_write_b32 a171, v55
    v_accvgpr_read_b32 v52, a184
    v_accvgpr_read_b32 v53, a185
    v_accvgpr_read_b32 v54, a186
    v_accvgpr_read_b32 v55, a187
    v_mul_f32 v52, v52, v216
    v_mul_f32 v53, v53, v217
    v_mul_f32 v54, v54, v218
    v_mul_f32 v55, v55, v219
    v_accvgpr_write_b32 a184, v52
    v_accvgpr_write_b32 a185, v53
    v_accvgpr_write_b32 a186, v54
    v_accvgpr_write_b32 a187, v55
    v_max3_f32 v48, v76, v77, v78
    v_max3_f32 v48, v48, v79, v92
    v_max3_f32 v48, v48, v93, v94
    v_max_f32 v48, v48, v95
    v_mov_b32 v49, v48
    s_nop 1
    v_permlane32_swap_b32 v48, v49
    s_nop 1
    v_max_f32 v48, v48, v49
    v_mov_b32 v49, v48
    s_nop 1
    v_permlane16_swap_b32 v48, v49
    s_nop 1
    v_max_f32 v48, v48, v49
    v_add_f32 v48, 0x423c0000, v48
    v_max_f32 v48, 0, v48
    v_exp_f32 v50, -v48
    v_sub_f32 v76, v76, v48
    v_sub_f32 v77, v77, v48
    v_sub_f32 v78, v78, v48
    v_sub_f32 v79, v79, v48
    v_sub_f32 v92, v92, v48
    v_sub_f32 v93, v93, v48
    v_sub_f32 v94, v94, v48
    v_sub_f32 v95, v95, v48
    ds_bpermute_b32 v216, v51, v50 offset:0
    ds_bpermute_b32 v217, v51, v50 offset:4
    ds_bpermute_b32 v218, v51, v50 offset:8
    ds_bpermute_b32 v219, v51, v50 offset:12
    v_sub_f32 v108, v108, v48
    v_sub_f32 v109, v109, v48
    v_sub_f32 v110, v110, v48
    v_sub_f32 v111, v111, v48
    v_mul_f32 v227, v227, v50
    v_mul_f32 v57, v57, v50
    s_waitcnt lgkmcnt(0)
    v_accvgpr_read_b32 v52, a12
    v_accvgpr_read_b32 v53, a13
    v_accvgpr_read_b32 v54, a14
    v_accvgpr_read_b32 v55, a15
    v_mul_f32 v52, v52, v216
    v_mul_f32 v53, v53, v217
    v_mul_f32 v54, v54, v218
    v_mul_f32 v55, v55, v219
    v_accvgpr_write_b32 a12, v52
    v_accvgpr_write_b32 a13, v53
    v_accvgpr_write_b32 a14, v54
    v_accvgpr_write_b32 a15, v55
    v_accvgpr_read_b32 v52, a28
    v_accvgpr_read_b32 v53, a29
    v_accvgpr_read_b32 v54, a30
    v_accvgpr_read_b32 v55, a31
    v_mul_f32 v52, v52, v216
    v_mul_f32 v53, v53, v217
    v_mul_f32 v54, v54, v218
    v_mul_f32 v55, v55, v219
    v_accvgpr_write_b32 a28, v52
    v_accvgpr_write_b32 a29, v53
    v_accvgpr_write_b32 a30, v54
    v_accvgpr_write_b32 a31, v55
    v_accvgpr_read_b32 v52, a44
    v_accvgpr_read_b32 v53, a45
    v_accvgpr_read_b32 v54, a46
    v_accvgpr_read_b32 v55, a47
    v_mul_f32 v52, v52, v216
    v_mul_f32 v53, v53, v217
    v_mul_f32 v54, v54, v218
    v_mul_f32 v55, v55, v219
    v_accvgpr_write_b32 a44, v52
    v_accvgpr_write_b32 a45, v53
    v_accvgpr_write_b32 a46, v54
    v_accvgpr_write_b32 a47, v55
    v_accvgpr_read_b32 v52, a60
    v_accvgpr_read_b32 v53, a61
    v_accvgpr_read_b32 v54, a62
    v_accvgpr_read_b32 v55, a63
    v_mul_f32 v52, v52, v216
    v_mul_f32 v53, v53, v217
    v_mul_f32 v54, v54, v218
    v_mul_f32 v55, v55, v219
    v_accvgpr_write_b32 a60, v52
    v_accvgpr_write_b32 a61, v53
    v_accvgpr_write_b32 a62, v54
    v_accvgpr_write_b32 a63, v55
    v_accvgpr_read_b32 v52, a76
    v_accvgpr_read_b32 v53, a77
    v_accvgpr_read_b32 v54, a78
    v_accvgpr_read_b32 v55, a79
    v_mul_f32 v52, v52, v216
    v_mul_f32 v53, v53, v217
    v_mul_f32 v54, v54, v218
    v_mul_f32 v55, v55, v219
    v_accvgpr_write_b32 a76, v52
    v_accvgpr_write_b32 a77, v53
    v_accvgpr_write_b32 a78, v54
    v_accvgpr_write_b32 a79, v55
    v_accvgpr_read_b32 v52, a92
    v_accvgpr_read_b32 v53, a93
    v_accvgpr_read_b32 v54, a94
    v_accvgpr_read_b32 v55, a95
    v_mul_f32 v52, v52, v216
    v_mul_f32 v53, v53, v217
    v_mul_f32 v54, v54, v218
    v_mul_f32 v55, v55, v219
    v_accvgpr_write_b32 a92, v52
    v_accvgpr_write_b32 a93, v53
    v_accvgpr_write_b32 a94, v54
    v_accvgpr_write_b32 a95, v55
    v_accvgpr_read_b32 v52, a108
    v_accvgpr_read_b32 v53, a109
    v_accvgpr_read_b32 v54, a110
    v_accvgpr_read_b32 v55, a111
    v_mul_f32 v52, v52, v216
    v_mul_f32 v53, v53, v217
    v_mul_f32 v54, v54, v218
    v_mul_f32 v55, v55, v219
    v_accvgpr_write_b32 a108, v52
    v_accvgpr_write_b32 a109, v53
    v_accvgpr_write_b32 a110, v54
    v_accvgpr_write_b32 a111, v55
    v_accvgpr_read_b32 v52, a124
    v_accvgpr_read_b32 v53, a125
    v_accvgpr_read_b32 v54, a126
    v_accvgpr_read_b32 v55, a127
    v_mul_f32 v52, v52, v216
    v_mul_f32 v53, v53, v217
    v_mul_f32 v54, v54, v218
    v_mul_f32 v55, v55, v219
    v_accvgpr_write_b32 a124, v52
    v_accvgpr_write_b32 a125, v53
    v_accvgpr_write_b32 a126, v54
    v_accvgpr_write_b32 a127, v55
    v_accvgpr_read_b32 v52, a140
    v_accvgpr_read_b32 v53, a141
    v_accvgpr_read_b32 v54, a142
    v_accvgpr_read_b32 v55, a143
    v_mul_f32 v52, v52, v216
    v_mul_f32 v53, v53, v217
    v_mul_f32 v54, v54, v218
    v_mul_f32 v55, v55, v219
    v_accvgpr_write_b32 a140, v52
    v_accvgpr_write_b32 a141, v53
    v_accvgpr_write_b32 a142, v54
    v_accvgpr_write_b32 a143, v55
    v_accvgpr_read_b32 v52, a156
    v_accvgpr_read_b32 v53, a157
    v_accvgpr_read_b32 v54, a158
    v_accvgpr_read_b32 v55, a159
    v_mul_f32 v52, v52, v216
    v_mul_f32 v53, v53, v217
    v_mul_f32 v54, v54, v218
    v_mul_f32 v55, v55, v219
    v_accvgpr_write_b32 a156, v52
    v_accvgpr_write_b32 a157, v53
    v_accvgpr_write_b32 a158, v54
    v_accvgpr_write_b32 a159, v55
    v_accvgpr_read_b32 v52, a172
    v_accvgpr_read_b32 v53, a173
    v_accvgpr_read_b32 v54, a174
    v_accvgpr_read_b32 v55, a175
    v_mul_f32 v52, v52, v216
    v_mul_f32 v53, v53, v217
    v_mul_f32 v54, v54, v218
    v_mul_f32 v55, v55, v219
    v_accvgpr_write_b32 a172, v52
    v_accvgpr_write_b32 a173, v53
    v_accvgpr_write_b32 a174, v54
    v_accvgpr_write_b32 a175, v55
    v_accvgpr_read_b32 v52, a188
    v_accvgpr_read_b32 v53, a189
    v_accvgpr_read_b32 v54, a190
    v_accvgpr_read_b32 v55, a191
    v_mul_f32 v52, v52, v216
    v_mul_f32 v53, v53, v217
    v_mul_f32 v54, v54, v218
    v_mul_f32 v55, v55, v219
    v_accvgpr_write_b32 a188, v52
    v_accvgpr_write_b32 a189, v53
    v_accvgpr_write_b32 a190, v54
    v_accvgpr_write_b32 a191, v55
    v_exp_f32 v216, v64
    v_exp_f32 v217, v65
    v_exp_f32 v218, v66
    v_exp_f32 v219, v67
    v_exp_f32 v220, v80
    v_exp_f32 v221, v81
    v_exp_f32 v222, v82
    v_exp_f32 v223, v83
    v_add_f32 v228, v216, v217
    v_add_f32 v228, v228, v218
    v_add_f32 v228, v228, v219
    v_add_f32 v228, v228, v220
    v_add_f32 v228, v228, v221
    v_add_f32 v228, v228, v222
    v_add_f32 v228, v228, v223
    v_cvt_pk_bf16_f32 v112, v216, v217
    v_cvt_pk_bf16_f32 v113, v218, v219
    v_cvt_pk_bf16_f32 v114, v220, v221
    v_cvt_pk_bf16_f32 v115, v222, v223
    v_exp_f32 v216, v68
    v_exp_f32 v217, v69
    v_exp_f32 v218, v70
    v_exp_f32 v219, v71
    v_exp_f32 v220, v84
    v_exp_f32 v221, v85
    v_exp_f32 v222, v86
    v_exp_f32 v223, v87
    v_add_f32 v229, v216, v217
    v_add_f32 v229, v229, v218
    v_add_f32 v229, v229, v219
    v_add_f32 v229, v229, v220
    v_add_f32 v229, v229, v221
    v_add_f32 v229, v229, v222
    v_add_f32 v229, v229, v223
    v_cvt_pk_bf16_f32 v116, v216, v217
    v_cvt_pk_bf16_f32 v117, v218, v219
    v_cvt_pk_bf16_f32 v118, v220, v221
    v_cvt_pk_bf16_f32 v119, v222, v223
    v_exp_f32 v216, v72
    v_exp_f32 v217, v73
    v_exp_f32 v218, v74
    v_exp_f32 v219, v75
    v_exp_f32 v220, v88
    v_exp_f32 v221, v89
    v_exp_f32 v222, v90
    v_exp_f32 v223, v91
    v_add_f32 v230, v216, v217
    v_add_f32 v230, v230, v218
    v_add_f32 v230, v230, v219
    v_add_f32 v230, v230, v220
    v_add_f32 v230, v230, v221
    v_add_f32 v230, v230, v222
    v_add_f32 v230, v230, v223
    v_cvt_pk_bf16_f32 v120, v216, v217
    v_cvt_pk_bf16_f32 v121, v218, v219
    v_cvt_pk_bf16_f32 v122, v220, v221
    v_cvt_pk_bf16_f32 v123, v222, v223
    v_exp_f32 v216, v76
    v_exp_f32 v217, v77
    v_exp_f32 v218, v78
    v_exp_f32 v219, v79
    v_exp_f32 v220, v92
    v_exp_f32 v221, v93
    v_exp_f32 v222, v94
    v_exp_f32 v223, v95
    v_add_f32 v231, v216, v217
    v_add_f32 v231, v231, v218
    v_add_f32 v231, v231, v219
    v_add_f32 v231, v231, v220
    v_add_f32 v231, v231, v221
    v_add_f32 v231, v231, v222
    v_add_f32 v231, v231, v223
    v_cvt_pk_bf16_f32 v124, v216, v217
    v_cvt_pk_bf16_f32 v125, v218, v219
    v_cvt_pk_bf16_f32 v126, v220, v221
    v_cvt_pk_bf16_f32 v127, v222, v223
    s_nop 1
    s_branch L_back0
L_rare1:
    s_nop 7
    s_nop 1
    v_lshrrev_b32 v51, 8, v1
    v_lshlrev_b32 v51, 4, v51
    v_max3_f32 v48, v64, v65, v66
    v_max3_f32 v48, v48, v67, v80
    v_max3_f32 v48, v48, v81, v82
    v_max_f32 v48, v48, v83
    v_mov_b32 v49, v48
    s_nop 1
    v_permlane32_swap_b32 v48, v49
    s_nop 1
    v_max_f32 v48, v48, v49
    v_mov_b32 v49, v48
    s_nop 1
    v_permlane16_swap_b32 v48, v49
    s_nop 1
    v_max_f32 v48, v48, v49
    v_add_f32 v48, 0x423c0000, v48
    v_max_f32 v48, 0, v48
    v_exp_f32 v50, -v48
    v_sub_f32 v64, v64, v48
    v_sub_f32 v65, v65, v48
    v_sub_f32 v66, v66, v48
    v_sub_f32 v67, v67, v48
    v_sub_f32 v80, v80, v48
    v_sub_f32 v81, v81, v48
    v_sub_f32 v82, v82, v48
    v_sub_f32 v83, v83, v48
    ds_bpermute_b32 v216, v51, v50 offset:0
    ds_bpermute_b32 v217, v51, v50 offset:4
    ds_bpermute_b32 v218, v51, v50 offset:8
    ds_bpermute_b32 v219, v51, v50 offset:12
    v_sub_f32 v96, v96, v48
    v_sub_f32 v97, v97, v48
    v_sub_f32 v98, v98, v48
    v_sub_f32 v99, v99, v48
    v_mul_f32 v224, v224, v50
    v_mul_f32 v14, v14, v50
    s_waitcnt lgkmcnt(0)
    v_accvgpr_read_b32 v52, a0
    v_accvgpr_read_b32 v53, a1
    v_accvgpr_read_b32 v54, a2
    v_accvgpr_read_b32 v55, a3
    v_mul_f32 v52, v52, v216
    v_mul_f32 v53, v53, v217
    v_mul_f32 v54, v54, v218
    v_mul_f32 v55, v55, v219
    v_accvgpr_write_b32 a0, v52
    v_accvgpr_write_b32 a1, v53
    v_accvgpr_write_b32 a2, v54
    v_accvgpr_write_b32 a3, v55
    v_accvgpr_read_b32 v52, a16
    v_accvgpr_read_b32 v53, a17
    v_accvgpr_read_b32 v54, a18
    v_accvgpr_read_b32 v55, a19
    v_mul_f32 v52, v52, v216
    v_mul_f32 v53, v53, v217
    v_mul_f32 v54, v54, v218
    v_mul_f32 v55, v55, v219
    v_accvgpr_write_b32 a16, v52
    v_accvgpr_write_b32 a17, v53
    v_accvgpr_write_b32 a18, v54
    v_accvgpr_write_b32 a19, v55
    v_accvgpr_read_b32 v52, a32
    v_accvgpr_read_b32 v53, a33
    v_accvgpr_read_b32 v54, a34
    v_accvgpr_read_b32 v55, a35
    v_mul_f32 v52, v52, v216
    v_mul_f32 v53, v53, v217
    v_mul_f32 v54, v54, v218
    v_mul_f32 v55, v55, v219
    v_accvgpr_write_b32 a32, v52
    v_accvgpr_write_b32 a33, v53
    v_accvgpr_write_b32 a34, v54
    v_accvgpr_write_b32 a35, v55
    v_accvgpr_read_b32 v52, a48
    v_accvgpr_read_b32 v53, a49
    v_accvgpr_read_b32 v54, a50
    v_accvgpr_read_b32 v55, a51
    v_mul_f32 v52, v52, v216
    v_mul_f32 v53, v53, v217
    v_mul_f32 v54, v54, v218
    v_mul_f32 v55, v55, v219
    v_accvgpr_write_b32 a48, v52
    v_accvgpr_write_b32 a49, v53
    v_accvgpr_write_b32 a50, v54
    v_accvgpr_write_b32 a51, v55
    v_accvgpr_read_b32 v52, a64
    v_accvgpr_read_b32 v53, a65
    v_accvgpr_read_b32 v54, a66
    v_accvgpr_read_b32 v55, a67
    v_mul_f32 v52, v52, v216
    v_mul_f32 v53, v53, v217
    v_mul_f32 v54, v54, v218
    v_mul_f32 v55, v55, v219
    v_accvgpr_write_b32 a64, v52
    v_accvgpr_write_b32 a65, v53
    v_accvgpr_write_b32 a66, v54
    v_accvgpr_write_b32 a67, v55
    v_accvgpr_read_b32 v52, a80
    v_accvgpr_read_b32 v53, a81
    v_accvgpr_read_b32 v54, a82
    v_accvgpr_read_b32 v55, a83
    v_mul_f32 v52, v52, v216
    v_mul_f32 v53, v53, v217
    v_mul_f32 v54, v54, v218
    v_mul_f32 v55, v55, v219
    v_accvgpr_write_b32 a80, v52
    v_accvgpr_write_b32 a81, v53
    v_accvgpr_write_b32 a82, v54
    v_accvgpr_write_b32 a83, v55
    v_accvgpr_read_b32 v52, a96
    v_accvgpr_read_b32 v53, a97
    v_accvgpr_read_b32 v54, a98
    v_accvgpr_read_b32 v55, a99
    v_mul_f32 v52, v52, v216
    v_mul_f32 v53, v53, v217
    v_mul_f32 v54, v54, v218
    v_mul_f32 v55, v55, v219
    v_accvgpr_write_b32 a96, v52
    v_accvgpr_write_b32 a97, v53
    v_accvgpr_write_b32 a98, v54
    v_accvgpr_write_b32 a99, v55
    v_accvgpr_read_b32 v52, a112
    v_accvgpr_read_b32 v53, a113
    v_accvgpr_read_b32 v54, a114
    v_accvgpr_read_b32 v55, a115
    v_mul_f32 v52, v52, v216
    v_mul_f32 v53, v53, v217
    v_mul_f32 v54, v54, v218
    v_mul_f32 v55, v55, v219
    v_accvgpr_write_b32 a112, v52
    v_accvgpr_write_b32 a113, v53
    v_accvgpr_write_b32 a114, v54
    v_accvgpr_write_b32 a115, v55
    v_accvgpr_read_b32 v52, a128
    v_accvgpr_read_b32 v53, a129
    v_accvgpr_read_b32 v54, a130
    v_accvgpr_read_b32 v55, a131
    v_mul_f32 v52, v52, v216
    v_mul_f32 v53, v53, v217
    v_mul_f32 v54, v54, v218
    v_mul_f32 v55, v55, v219
    v_accvgpr_write_b32 a128, v52
    v_accvgpr_write_b32 a129, v53
    v_accvgpr_write_b32 a130, v54
    v_accvgpr_write_b32 a131, v55
    v_accvgpr_read_b32 v52, a144
    v_accvgpr_read_b32 v53, a145
    v_accvgpr_read_b32 v54, a146
    v_accvgpr_read_b32 v55, a147
    v_mul_f32 v52, v52, v216
    v_mul_f32 v53, v53, v217
    v_mul_f32 v54, v54, v218
    v_mul_f32 v55, v55, v219
    v_accvgpr_write_b32 a144, v52
    v_accvgpr_write_b32 a145, v53
    v_accvgpr_write_b32 a146, v54
    v_accvgpr_write_b32 a147, v55
    v_accvgpr_read_b32 v52, a160
    v_accvgpr_read_b32 v53, a161
    v_accvgpr_read_b32 v54, a162
    v_accvgpr_read_b32 v55, a163
    v_mul_f32 v52, v52, v216
    v_mul_f32 v53, v53, v217
    v_mul_f32 v54, v54, v218
    v_mul_f32 v55, v55, v219
    v_accvgpr_write_b32 a160, v52
    v_accvgpr_write_b32 a161, v53
    v_accvgpr_write_b32 a162, v54
    v_accvgpr_write_b32 a163, v55
    v_accvgpr_read_b32 v52, a176
    v_accvgpr_read_b32 v53, a177
    v_accvgpr_read_b32 v54, a178
    v_accvgpr_read_b32 v55, a179
    v_mul_f32 v52, v52, v216
    v_mul_f32 v53, v53, v217
    v_mul_f32 v54, v54, v218
    v_mul_f32 v55, v55, v219
    v_accvgpr_write_b32 a176, v52
    v_accvgpr_write_b32 a177, v53
    v_accvgpr_write_b32 a178, v54
    v_accvgpr_write_b32 a179, v55
    v_max3_f32 v48, v68, v69, v70
    v_max3_f32 v48, v48, v71, v84
    v_max3_f32 v48, v48, v85, v86
    v_max_f32 v48, v48, v87
    v_mov_b32 v49, v48
    s_nop 1
    v_permlane32_swap_b32 v48, v49
    s_nop 1
    v_max_f32 v48, v48, v49
    v_mov_b32 v49, v48
    s_nop 1
    v_permlane16_swap_b32 v48, v49
    s_nop 1
    v_max_f32 v48, v48, v49
    v_add_f32 v48, 0x423c0000, v48
    v_max_f32 v48, 0, v48
    v_exp_f32 v50, -v48
    v_sub_f32 v68, v68, v48
    v_sub_f32 v69, v69, v48
    v_sub_f32 v70, v70, v48
    v_sub_f32 v71, v71, v48
    v_sub_f32 v84, v84, v48
    v_sub_f32 v85, v85, v48
    v_sub_f32 v86, v86, v48
    v_sub_f32 v87, v87, v48
    ds_bpermute_b32 v216, v51, v50 offset:0
    ds_bpermute_b32 v217, v51, v50 offset:4
    ds_bpermute_b32 v218, v51, v50 offset:8
    ds_bpermute_b32 v219, v51, v50 offset:12
    v_sub_f32 v100, v100, v48
    v_sub_f32 v101, v101, v48
    v_sub_f32 v102, v102, v48
    v_sub_f32 v103, v103, v48
    v_mul_f32 v225, v225, v50
    v_mul_f32 v15, v15, v50
    s_waitcnt lgkmcnt(0)
    v_accvgpr_read_b32 v52, a4
    v_accvgpr_read_b32 v53, a5
    v_accvgpr_read_b32 v54, a6
    v_accvgpr_read_b32 v55, a7
    v_mul_f32 v52, v52, v216
    v_mul_f32 v53, v53, v217
    v_mul_f32 v54, v54, v218
    v_mul_f32 v55, v55, v219
    v_accvgpr_write_b32 a4, v52
    v_accvgpr_write_b32 a5, v53
    v_accvgpr_write_b32 a6, v54
    v_accvgpr_write_b32 a7, v55
    v_accvgpr_read_b32 v52, a20
    v_accvgpr_read_b32 v53, a21
    v_accvgpr_read_b32 v54, a22
    v_accvgpr_read_b32 v55, a23
    v_mul_f32 v52, v52, v216
    v_mul_f32 v53, v53, v217
    v_mul_f32 v54, v54, v218
    v_mul_f32 v55, v55, v219
    v_accvgpr_write_b32 a20, v52
    v_accvgpr_write_b32 a21, v53
    v_accvgpr_write_b32 a22, v54
    v_accvgpr_write_b32 a23, v55
    v_accvgpr_read_b32 v52, a36
    v_accvgpr_read_b32 v53, a37
    v_accvgpr_read_b32 v54, a38
    v_accvgpr_read_b32 v55, a39
    v_mul_f32 v52, v52, v216
    v_mul_f32 v53, v53, v217
    v_mul_f32 v54, v54, v218
    v_mul_f32 v55, v55, v219
    v_accvgpr_write_b32 a36, v52
    v_accvgpr_write_b32 a37, v53
    v_accvgpr_write_b32 a38, v54
    v_accvgpr_write_b32 a39, v55
    v_accvgpr_read_b32 v52, a52
    v_accvgpr_read_b32 v53, a53
    v_accvgpr_read_b32 v54, a54
    v_accvgpr_read_b32 v55, a55
    v_mul_f32 v52, v52, v216
    v_mul_f32 v53, v53, v217
    v_mul_f32 v54, v54, v218
    v_mul_f32 v55, v55, v219
    v_accvgpr_write_b32 a52, v52
    v_accvgpr_write_b32 a53, v53
    v_accvgpr_write_b32 a54, v54
    v_accvgpr_write_b32 a55, v55
    v_accvgpr_read_b32 v52, a68
    v_accvgpr_read_b32 v53, a69
    v_accvgpr_read_b32 v54, a70
    v_accvgpr_read_b32 v55, a71
    v_mul_f32 v52, v52, v216
    v_mul_f32 v53, v53, v217
    v_mul_f32 v54, v54, v218
    v_mul_f32 v55, v55, v219
    v_accvgpr_write_b32 a68, v52
    v_accvgpr_write_b32 a69, v53
    v_accvgpr_write_b32 a70, v54
    v_accvgpr_write_b32 a71, v55
    v_accvgpr_read_b32 v52, a84
    v_accvgpr_read_b32 v53, a85
    v_accvgpr_read_b32 v54, a86
    v_accvgpr_read_b32 v55, a87
    v_mul_f32 v52, v52, v216
    v_mul_f32 v53, v53, v217
    v_mul_f32 v54, v54, v218
    v_mul_f32 v55, v55, v219
    v_accvgpr_write_b32 a84, v52
    v_accvgpr_write_b32 a85, v53
    v_accvgpr_write_b32 a86, v54
    v_accvgpr_write_b32 a87, v55
    v_accvgpr_read_b32 v52, a100
    v_accvgpr_read_b32 v53, a101
    v_accvgpr_read_b32 v54, a102
    v_accvgpr_read_b32 v55, a103
    v_mul_f32 v52, v52, v216
    v_mul_f32 v53, v53, v217
    v_mul_f32 v54, v54, v218
    v_mul_f32 v55, v55, v219
    v_accvgpr_write_b32 a100, v52
    v_accvgpr_write_b32 a101, v53
    v_accvgpr_write_b32 a102, v54
    v_accvgpr_write_b32 a103, v55
    v_accvgpr_read_b32 v52, a116
    v_accvgpr_read_b32 v53, a117
    v_accvgpr_read_b32 v54, a118
    v_accvgpr_read_b32 v55, a119
    v_mul_f32 v52, v52, v216
    v_mul_f32 v53, v53, v217
    v_mul_f32 v54, v54, v218
    v_mul_f32 v55, v55, v219
    v_accvgpr_write_b32 a116, v52
    v_accvgpr_write_b32 a117, v53
    v_accvgpr_write_b32 a118, v54
    v_accvgpr_write_b32 a119, v55
    v_accvgpr_read_b32 v52, a132
    v_accvgpr_read_b32 v53, a133
    v_accvgpr_read_b32 v54, a134
    v_accvgpr_read_b32 v55, a135
    v_mul_f32 v52, v52, v216
    v_mul_f32 v53, v53, v217
    v_mul_f32 v54, v54, v218
    v_mul_f32 v55, v55, v219
    v_accvgpr_write_b32 a132, v52
    v_accvgpr_write_b32 a133, v53
    v_accvgpr_write_b32 a134, v54
    v_accvgpr_write_b32 a135, v55
    v_accvgpr_read_b32 v52, a148
    v_accvgpr_read_b32 v53, a149
    v_accvgpr_read_b32 v54, a150
    v_accvgpr_read_b32 v55, a151
    v_mul_f32 v52, v52, v216
    v_mul_f32 v53, v53, v217
    v_mul_f32 v54, v54, v218
    v_mul_f32 v55, v55, v219
    v_accvgpr_write_b32 a148, v52
    v_accvgpr_write_b32 a149, v53
    v_accvgpr_write_b32 a150, v54
    v_accvgpr_write_b32 a151, v55
    v_accvgpr_read_b32 v52, a164
    v_accvgpr_read_b32 v53, a165
    v_accvgpr_read_b32 v54, a166
    v_accvgpr_read_b32 v55, a167
    v_mul_f32 v52, v52, v216
    v_mul_f32 v53, v53, v217
    v_mul_f32 v54, v54, v218
    v_mul_f32 v55, v55, v219
    v_accvgpr_write_b32 a164, v52
    v_accvgpr_write_b32 a165, v53
    v_accvgpr_write_b32 a166, v54
    v_accvgpr_write_b32 a167, v55
    v_accvgpr_read_b32 v52, a180
    v_accvgpr_read_b32 v53, a181
    v_accvgpr_read_b32 v54, a182
    v_accvgpr_read_b32 v55, a183
    v_mul_f32 v52, v52, v216
    v_mul_f32 v53, v53, v217
    v_mul_f32 v54, v54, v218
    v_mul_f32 v55, v55, v219
    v_accvgpr_write_b32 a180, v52
    v_accvgpr_write_b32 a181, v53
    v_accvgpr_write_b32 a182, v54
    v_accvgpr_write_b32 a183, v55
    v_max3_f32 v48, v72, v73, v74
    v_max3_f32 v48, v48, v75, v88
    v_max3_f32 v48, v48, v89, v90
    v_max_f32 v48, v48, v91
    v_mov_b32 v49, v48
    s_nop 1
    v_permlane32_swap_b32 v48, v49
    s_nop 1
    v_max_f32 v48, v48, v49
    v_mov_b32 v49, v48
    s_nop 1
    v_permlane16_swap_b32 v48, v49
    s_nop 1
    v_max_f32 v48, v48, v49
    v_add_f32 v48, 0x423c0000, v48
    v_max_f32 v48, 0, v48
    v_exp_f32 v50, -v48
    v_sub_f32 v72, v72, v48
    v_sub_f32 v73, v73, v48
    v_sub_f32 v74, v74, v48
    v_sub_f32 v75, v75, v48
    v_sub_f32 v88, v88, v48
    v_sub_f32 v89, v89, v48
    v_sub_f32 v90, v90, v48
    v_sub_f32 v91, v91, v48
    ds_bpermute_b32 v216, v51, v50 offset:0
    ds_bpermute_b32 v217, v51, v50 offset:4
    ds_bpermute_b32 v218, v51, v50 offset:8
    ds_bpermute_b32 v219, v51, v50 offset:12
    v_sub_f32 v104, v104, v48
    v_sub_f32 v105, v105, v48
    v_sub_f32 v106, v106, v48
    v_sub_f32 v107, v107, v48
    v_mul_f32 v226, v226, v50
    v_mul_f32 v56, v56, v50
    s_waitcnt lgkmcnt(0)
    v_accvgpr_read_b32 v52, a8
    v_accvgpr_read_b32 v53, a9
    v_accvgpr_read_b32 v54, a10
    v_accvgpr_read_b32 v55, a11
    v_mul_f32 v52, v52, v216
    v_mul_f32 v53, v53, v217
    v_mul_f32 v54, v54, v218
    v_mul_f32 v55, v55, v219
    v_accvgpr_write_b32 a8, v52
    v_accvgpr_write_b32 a9, v53
    v_accvgpr_write_b32 a10, v54
    v_accvgpr_write_b32 a11, v55
    v_accvgpr_read_b32 v52, a24
    v_accvgpr_read_b32 v53, a25
    v_accvgpr_read_b32 v54, a26
    v_accvgpr_read_b32 v55, a27
    v_mul_f32 v52, v52, v216
    v_mul_f32 v53, v53, v217
    v_mul_f32 v54, v54, v218
    v_mul_f32 v55, v55, v219
    v_accvgpr_write_b32 a24, v52
    v_accvgpr_write_b32 a25, v53
    v_accvgpr_write_b32 a26, v54
    v_accvgpr_write_b32 a27, v55
    v_accvgpr_read_b32 v52, a40
    v_accvgpr_read_b32 v53, a41
    v_accvgpr_read_b32 v54, a42
    v_accvgpr_read_b32 v55, a43
    v_mul_f32 v52, v52, v216
    v_mul_f32 v53, v53, v217
    v_mul_f32 v54, v54, v218
    v_mul_f32 v55, v55, v219
    v_accvgpr_write_b32 a40, v52
    v_accvgpr_write_b32 a41, v53
    v_accvgpr_write_b32 a42, v54
    v_accvgpr_write_b32 a43, v55
    v_accvgpr_read_b32 v52, a56
    v_accvgpr_read_b32 v53, a57
    v_accvgpr_read_b32 v54, a58
    v_accvgpr_read_b32 v55, a59
    v_mul_f32 v52, v52, v216
    v_mul_f32 v53, v53, v217
    v_mul_f32 v54, v54, v218
    v_mul_f32 v55, v55, v219
    v_accvgpr_write_b32 a56, v52
    v_accvgpr_write_b32 a57, v53
    v_accvgpr_write_b32 a58, v54
    v_accvgpr_write_b32 a59, v55
    v_accvgpr_read_b32 v52, a72
    v_accvgpr_read_b32 v53, a73
    v_accvgpr_read_b32 v54, a74
    v_accvgpr_read_b32 v55, a75
    v_mul_f32 v52, v52, v216
    v_mul_f32 v53, v53, v217
    v_mul_f32 v54, v54, v218
    v_mul_f32 v55, v55, v219
    v_accvgpr_write_b32 a72, v52
    v_accvgpr_write_b32 a73, v53
    v_accvgpr_write_b32 a74, v54
    v_accvgpr_write_b32 a75, v55
    v_accvgpr_read_b32 v52, a88
    v_accvgpr_read_b32 v53, a89
    v_accvgpr_read_b32 v54, a90
    v_accvgpr_read_b32 v55, a91
    v_mul_f32 v52, v52, v216
    v_mul_f32 v53, v53, v217
    v_mul_f32 v54, v54, v218
    v_mul_f32 v55, v55, v219
    v_accvgpr_write_b32 a88, v52
    v_accvgpr_write_b32 a89, v53
    v_accvgpr_write_b32 a90, v54
    v_accvgpr_write_b32 a91, v55
    v_accvgpr_read_b32 v52, a104
    v_accvgpr_read_b32 v53, a105
    v_accvgpr_read_b32 v54, a106
    v_accvgpr_read_b32 v55, a107
    v_mul_f32 v52, v52, v216
    v_mul_f32 v53, v53, v217
    v_mul_f32 v54, v54, v218
    v_mul_f32 v55, v55, v219
    v_accvgpr_write_b32 a104, v52
    v_accvgpr_write_b32 a105, v53
    v_accvgpr_write_b32 a106, v54
    v_accvgpr_write_b32 a107, v55
    v_accvgpr_read_b32 v52, a120
    v_accvgpr_read_b32 v53, a121
    v_accvgpr_read_b32 v54, a122
    v_accvgpr_read_b32 v55, a123
    v_mul_f32 v52, v52, v216
    v_mul_f32 v53, v53, v217
    v_mul_f32 v54, v54, v218
    v_mul_f32 v55, v55, v219
    v_accvgpr_write_b32 a120, v52
    v_accvgpr_write_b32 a121, v53
    v_accvgpr_write_b32 a122, v54
    v_accvgpr_write_b32 a123, v55
    v_accvgpr_read_b32 v52, a136
    v_accvgpr_read_b32 v53, a137
    v_accvgpr_read_b32 v54, a138
    v_accvgpr_read_b32 v55, a139
    v_mul_f32 v52, v52, v216
    v_mul_f32 v53, v53, v217
    v_mul_f32 v54, v54, v218
    v_mul_f32 v55, v55, v219
    v_accvgpr_write_b32 a136, v52
    v_accvgpr_write_b32 a137, v53
    v_accvgpr_write_b32 a138, v54
    v_accvgpr_write_b32 a139, v55
    v_accvgpr_read_b32 v52, a152
    v_accvgpr_read_b32 v53, a153
    v_accvgpr_read_b32 v54, a154
    v_accvgpr_read_b32 v55, a155
    v_mul_f32 v52, v52, v216
    v_mul_f32 v53, v53, v217
    v_mul_f32 v54, v54, v218
    v_mul_f32 v55, v55, v219
    v_accvgpr_write_b32 a152, v52
    v_accvgpr_write_b32 a153, v53
    v_accvgpr_write_b32 a154, v54
    v_accvgpr_write_b32 a155, v55
    v_accvgpr_read_b32 v52, a168
    v_accvgpr_read_b32 v53, a169
    v_accvgpr_read_b32 v54, a170
    v_accvgpr_read_b32 v55, a171
    v_mul_f32 v52, v52, v216
    v_mul_f32 v53, v53, v217
    v_mul_f32 v54, v54, v218
    v_mul_f32 v55, v55, v219
    v_accvgpr_write_b32 a168, v52
    v_accvgpr_write_b32 a169, v53
    v_accvgpr_write_b32 a170, v54
    v_accvgpr_write_b32 a171, v55
    v_accvgpr_read_b32 v52, a184
    v_accvgpr_read_b32 v53, a185
    v_accvgpr_read_b32 v54, a186
    v_accvgpr_read_b32 v55, a187
    v_mul_f32 v52, v52, v216
    v_mul_f32 v53, v53, v217
    v_mul_f32 v54, v54, v218
    v_mul_f32 v55, v55, v219
    v_accvgpr_write_b32 a184, v52
    v_accvgpr_write_b32 a185, v53
    v_accvgpr_write_b32 a186, v54
    v_accvgpr_write_b32 a187, v55
    v_max3_f32 v48, v76, v77, v78
    v_max3_f32 v48, v48, v79, v92
    v_max3_f32 v48, v48, v93, v94
    v_max_f32 v48, v48, v95
    v_mov_b32 v49, v48
    s_nop 1
    v_permlane32_swap_b32 v48, v49
    s_nop 1
    v_max_f32 v48, v48, v49
    v_mov_b32 v49, v48
    s_nop 1
    v_permlane16_swap_b32 v48, v49
    s_nop 1
    v_max_f32 v48, v48, v49
    v_add_f32 v48, 0x423c0000, v48
    v_max_f32 v48, 0, v48
    v_exp_f32 v50, -v48
    v_sub_f32 v76, v76, v48
    v_sub_f32 v77, v77, v48
    v_sub_f32 v78, v78, v48
    v_sub_f32 v79, v79, v48
    v_sub_f32 v92, v92, v48
    v_sub_f32 v93, v93, v48
    v_sub_f32 v94, v94, v48
    v_sub_f32 v95, v95, v48
    ds_bpermute_b32 v216, v51, v50 offset:0
    ds_bpermute_b32 v217, v51, v50 offset:4
    ds_bpermute_b32 v218, v51, v50 offset:8
    ds_bpermute_b32 v219, v51, v50 offset:12
    v_sub_f32 v108, v108, v48
    v_sub_f32 v109, v109, v48
    v_sub_f32 v110, v110, v48
    v_sub_f32 v111, v111, v48
    v_mul_f32 v227, v227, v50
    v_mul_f32 v57, v57, v50
    s_waitcnt lgkmcnt(0)
    v_accvgpr_read_b32 v52, a12
    v_accvgpr_read_b32 v53, a13
    v_accvgpr_read_b32 v54, a14
    v_accvgpr_read_b32 v55, a15
    v_mul_f32 v52, v52, v216
    v_mul_f32 v53, v53, v217
    v_mul_f32 v54, v54, v218
    v_mul_f32 v55, v55, v219
    v_accvgpr_write_b32 a12, v52
    v_accvgpr_write_b32 a13, v53
    v_accvgpr_write_b32 a14, v54
    v_accvgpr_write_b32 a15, v55
    v_accvgpr_read_b32 v52, a28
    v_accvgpr_read_b32 v53, a29
    v_accvgpr_read_b32 v54, a30
    v_accvgpr_read_b32 v55, a31
    v_mul_f32 v52, v52, v216
    v_mul_f32 v53, v53, v217
    v_mul_f32 v54, v54, v218
    v_mul_f32 v55, v55, v219
    v_accvgpr_write_b32 a28, v52
    v_accvgpr_write_b32 a29, v53
    v_accvgpr_write_b32 a30, v54
    v_accvgpr_write_b32 a31, v55
    v_accvgpr_read_b32 v52, a44
    v_accvgpr_read_b32 v53, a45
    v_accvgpr_read_b32 v54, a46
    v_accvgpr_read_b32 v55, a47
    v_mul_f32 v52, v52, v216
    v_mul_f32 v53, v53, v217
    v_mul_f32 v54, v54, v218
    v_mul_f32 v55, v55, v219
    v_accvgpr_write_b32 a44, v52
    v_accvgpr_write_b32 a45, v53
    v_accvgpr_write_b32 a46, v54
    v_accvgpr_write_b32 a47, v55
    v_accvgpr_read_b32 v52, a60
    v_accvgpr_read_b32 v53, a61
    v_accvgpr_read_b32 v54, a62
    v_accvgpr_read_b32 v55, a63
    v_mul_f32 v52, v52, v216
    v_mul_f32 v53, v53, v217
    v_mul_f32 v54, v54, v218
    v_mul_f32 v55, v55, v219
    v_accvgpr_write_b32 a60, v52
    v_accvgpr_write_b32 a61, v53
    v_accvgpr_write_b32 a62, v54
    v_accvgpr_write_b32 a63, v55
    v_accvgpr_read_b32 v52, a76
    v_accvgpr_read_b32 v53, a77
    v_accvgpr_read_b32 v54, a78
    v_accvgpr_read_b32 v55, a79
    v_mul_f32 v52, v52, v216
    v_mul_f32 v53, v53, v217
    v_mul_f32 v54, v54, v218
    v_mul_f32 v55, v55, v219
    v_accvgpr_write_b32 a76, v52
    v_accvgpr_write_b32 a77, v53
    v_accvgpr_write_b32 a78, v54
    v_accvgpr_write_b32 a79, v55
    v_accvgpr_read_b32 v52, a92
    v_accvgpr_read_b32 v53, a93
    v_accvgpr_read_b32 v54, a94
    v_accvgpr_read_b32 v55, a95
    v_mul_f32 v52, v52, v216
    v_mul_f32 v53, v53, v217
    v_mul_f32 v54, v54, v218
    v_mul_f32 v55, v55, v219
    v_accvgpr_write_b32 a92, v52
    v_accvgpr_write_b32 a93, v53
    v_accvgpr_write_b32 a94, v54
    v_accvgpr_write_b32 a95, v55
    v_accvgpr_read_b32 v52, a108
    v_accvgpr_read_b32 v53, a109
    v_accvgpr_read_b32 v54, a110
    v_accvgpr_read_b32 v55, a111
    v_mul_f32 v52, v52, v216
    v_mul_f32 v53, v53, v217
    v_mul_f32 v54, v54, v218
    v_mul_f32 v55, v55, v219
    v_accvgpr_write_b32 a108, v52
    v_accvgpr_write_b32 a109, v53
    v_accvgpr_write_b32 a110, v54
    v_accvgpr_write_b32 a111, v55
    v_accvgpr_read_b32 v52, a124
    v_accvgpr_read_b32 v53, a125
    v_accvgpr_read_b32 v54, a126
    v_accvgpr_read_b32 v55, a127
    v_mul_f32 v52, v52, v216
    v_mul_f32 v53, v53, v217
    v_mul_f32 v54, v54, v218
    v_mul_f32 v55, v55, v219
    v_accvgpr_write_b32 a124, v52
    v_accvgpr_write_b32 a125, v53
    v_accvgpr_write_b32 a126, v54
    v_accvgpr_write_b32 a127, v55
    v_accvgpr_read_b32 v52, a140
    v_accvgpr_read_b32 v53, a141
    v_accvgpr_read_b32 v54, a142
    v_accvgpr_read_b32 v55, a143
    v_mul_f32 v52, v52, v216
    v_mul_f32 v53, v53, v217
    v_mul_f32 v54, v54, v218
    v_mul_f32 v55, v55, v219
    v_accvgpr_write_b32 a140, v52
    v_accvgpr_write_b32 a141, v53
    v_accvgpr_write_b32 a142, v54
    v_accvgpr_write_b32 a143, v55
    v_accvgpr_read_b32 v52, a156
    v_accvgpr_read_b32 v53, a157
    v_accvgpr_read_b32 v54, a158
    v_accvgpr_read_b32 v55, a159
    v_mul_f32 v52, v52, v216
    v_mul_f32 v53, v53, v217
    v_mul_f32 v54, v54, v218
    v_mul_f32 v55, v55, v219
    v_accvgpr_write_b32 a156, v52
    v_accvgpr_write_b32 a157, v53
    v_accvgpr_write_b32 a158, v54
    v_accvgpr_write_b32 a159, v55
    v_accvgpr_read_b32 v52, a172
    v_accvgpr_read_b32 v53, a173
    v_accvgpr_read_b32 v54, a174
    v_accvgpr_read_b32 v55, a175
    v_mul_f32 v52, v52, v216
    v_mul_f32 v53, v53, v217
    v_mul_f32 v54, v54, v218
    v_mul_f32 v55, v55, v219
    v_accvgpr_write_b32 a172, v52
    v_accvgpr_write_b32 a173, v53
    v_accvgpr_write_b32 a174, v54
    v_accvgpr_write_b32 a175, v55
    v_accvgpr_read_b32 v52, a188
    v_accvgpr_read_b32 v53, a189
    v_accvgpr_read_b32 v54, a190
    v_accvgpr_read_b32 v55, a191
    v_mul_f32 v52, v52, v216
    v_mul_f32 v53, v53, v217
    v_mul_f32 v54, v54, v218
    v_mul_f32 v55, v55, v219
    v_accvgpr_write_b32 a188, v52
    v_accvgpr_write_b32 a189, v53
    v_accvgpr_write_b32 a190, v54
    v_accvgpr_write_b32 a191, v55
    v_exp_f32 v216, v64
    v_exp_f32 v217, v65
    v_exp_f32 v218, v66
    v_exp_f32 v219, v67
    v_exp_f32 v220, v80
    v_exp_f32 v221, v81
    v_exp_f32 v222, v82
    v_exp_f32 v223, v83
    v_add_f32 v228, v216, v217
    v_add_f32 v228, v228, v218
    v_add_f32 v228, v228, v219
    v_add_f32 v228, v228, v220
    v_add_f32 v228, v228, v221
    v_add_f32 v228, v228, v222
    v_add_f32 v228, v228, v223
    v_cvt_pk_bf16_f32 v128, v216, v217
    v_cvt_pk_bf16_f32 v129, v218, v219
    v_cvt_pk_bf16_f32 v130, v220, v221
    v_cvt_pk_bf16_f32 v131, v222, v223
    v_exp_f32 v216, v68
    v_exp_f32 v217, v69
    v_exp_f32 v218, v70
    v_exp_f32 v219, v71
    v_exp_f32 v220, v84
    v_exp_f32 v221, v85
    v_exp_f32 v222, v86
    v_exp_f32 v223, v87
    v_add_f32 v229, v216, v217
    v_add_f32 v229, v229, v218
    v_add_f32 v229, v229, v219
    v_add_f32 v229, v229, v220
    v_add_f32 v229, v229, v221
    v_add_f32 v229, v229, v222
    v_add_f32 v229, v229, v223
    v_cvt_pk_bf16_f32 v132, v216, v217
    v_cvt_pk_bf16_f32 v133, v218, v219
    v_cvt_pk_bf16_f32 v134, v220, v221
    v_cvt_pk_bf16_f32 v135, v222, v223
    v_exp_f32 v216, v72
    v_exp_f32 v217, v73
    v_exp_f32 v218, v74
    v_exp_f32 v219, v75
    v_exp_f32 v220, v88
    v_exp_f32 v221, v89
    v_exp_f32 v222, v90
    v_exp_f32 v223, v91
    v_add_f32 v230, v216, v217
    v_add_f32 v230, v230, v218
    v_add_f32 v230, v230, v219
    v_add_f32 v230, v230, v220
    v_add_f32 v230, v230, v221
    v_add_f32 v230, v230, v222
    v_add_f32 v230, v230, v223
    v_cvt_pk_bf16_f32 v136, v216, v217
    v_cvt_pk_bf16_f32 v137, v218, v219
    v_cvt_pk_bf16_f32 v138, v220, v221
    v_cvt_pk_bf16_f32 v139, v222, v223
    v_exp_f32 v216, v76
    v_exp_f32 v217, v77
    v_exp_f32 v218, v78
    v_exp_f32 v219, v79
    v_exp_f32 v220, v92
    v_exp_f32 v221, v93
    v_exp_f32 v222, v94
    v_exp_f32 v223, v95
    v_add_f32 v231, v216, v217
    v_add_f32 v231, v231, v218
    v_add_f32 v231, v231, v219
    v_add_f32 v231, v231, v220
    v_add_f32 v231, v231, v221
    v_add_f32 v231, v231, v222
    v_add_f32 v231, v231, v223
    v_cvt_pk_bf16_f32 v140, v216, v217
    v_cvt_pk_bf16_f32 v141, v218, v219
    v_cvt_pk_bf16_f32 v142, v220, v221
    v_cvt_pk_bf16_f32 v143, v222, v223
    s_nop 1
    s_branch L_back1
.section .rodata,"a"
.p2align 6
.amdhsa_kernel recurrent_scan__mha_block_cached__mixer_s_mlp__prompt_kernel
  .amdhsa_next_free_vgpr 512
  .amdhsa_next_free_sgpr 102
  .amdhsa_accum_offset 256
  .amdhsa_group_segment_fixed_size 0
  .amdhsa_kernarg_size 104
  .amdhsa_user_sgpr_count 2
  .amdhsa_user_sgpr_kernarg_segment_ptr 1
  .amdhsa_system_sgpr_workgroup_id_x 1
.end_amdhsa_kernel
```
